```python
import torch

def _softmax(x, axis=-1):
    return torch.softmax(x, dim=axis)
def _gelu(x):
    return torch.nn.functional.gelu(x, approximate="tanh")
def _silu(x):
    return torch.nn.functional.silu(x)
def _sigmoid(x):
    return torch.sigmoid(x)
def _layernorm(x, axis=-1, eps=1e-5):
    m = x.mean(dim=axis, keepdim=True)
    v = x.var(dim=axis, keepdim=True, unbiased=False)
    return (x - m) / torch.sqrt(v + eps)
def _scatter_add(tgt, idx, src, axis=0):
    return tgt.clone().index_add_(axis, idx, src)
def _segment_sum(src, seg, n):
    out = torch.zeros((n,) + src.shape[1:], dtype=src.dtype)
    return out.index_add_(0, seg, src)
def _pad(x, pw):
    flat = tuple(v for pair in reversed(pw) for v in pair)
    return torch.nn.functional.pad(x, flat)

kernel_name = 'parallel_sum__sliding_local_dilated__glu_gated_glu__prompt'

def setup_inputs():

    _w = (lambda a: (lambda t: t.to(torch.bfloat16) if t.is_floating_point() else t)(torch.as_tensor(a)))
    def _A_setup():
        B, S, D = 1, 2048, 1024
        return {
            "x": _w((lambda *s: torch.randn(*s, dtype=torch.bfloat16) * 0.05)(B, S, D)),
            "wqkv": _w((lambda *s: torch.randn(*s, dtype=torch.bfloat16) * 0.05)(D, 3 * D)),
            "wo": _w((lambda *s: torch.randn(*s, dtype=torch.bfloat16) * 0.05)(D, D)),
        }
    _A_in = _A_setup()

    def _B_setup():
        B, S, D, F = 1, 2048, 1024, 3584
        return {
            "x": _w((lambda *s: torch.randn(*s, dtype=torch.bfloat16) * 0.05)(B, S, D)),
            "w_gate": _w((lambda *s: torch.randn(*s, dtype=torch.bfloat16) * 0.05)(D, F)),
            "w_up": _w((lambda *s: torch.randn(*s, dtype=torch.bfloat16) * 0.05)(D, F)),
            "w_down": _w((lambda *s: torch.randn(*s, dtype=torch.bfloat16) * 0.05)(F, D)),
        }
    _B_in = _B_setup()

    return {
        "A_x": _A_in["x"],
        "A_wqkv": _A_in["wqkv"],
        "A_wo": _A_in["wo"],
        "B_x": _B_in["x"],
        "B_w_gate": _B_in["w_gate"],
        "B_w_up": _B_in["w_up"],
        "B_w_down": _B_in["w_down"],
    }

def reference(A_x, A_wqkv, A_wo, B_x, B_w_gate, B_w_up, B_w_down):
    def _A_ref(x, wqkv, wo):
        B, S, D = x.shape
        H = 32; Dh = D // H
        W, dil = 8, 2
        qkv = (lambda x, *d: x.permute(*d))((x @ wqkv).reshape(B, S, 3, H, Dh), 2, 0, 3, 1, 4)
        q, k, v = qkv[0], qkv[1], qkv[2]
        scale = Dh ** -0.5
        pos = torch.arange(S)
        off = torch.arange(W) * dil
        idx = pos[:, None] - off[None, :]
        mask = idx >= 0
        idx_c = torch.where(mask, idx, 0).reshape(-1)
        kg = k[:, :, idx_c, :].reshape(B, H, S, W, Dh)
        vg = v[:, :, idx_c, :].reshape(B, H, S, W, Dh)
        logits = torch.einsum("bhsd,bhswd->bhsw", q, kg) * scale
        logits = torch.where(mask[None, None, :, :], logits, -1e9)
        attn = _softmax(logits, axis=-1)
        o = torch.einsum("bhsw,bhswd->bhsd", attn, vg)
        return (lambda x, *d: x.permute(*d))(o, 0, 2, 1, 3).reshape(B, S, D) @ wo

    def _B_ref(x, w_gate, w_up, w_down):
        g = torch.einsum("bsd,df->bsf", x, w_gate)
        u = torch.einsum("bsd,df->bsf", x, w_up)
        h = _sigmoid(g) * u
        return torch.einsum("bsf,fd->bsd", h, w_down)

    x = A_x
    xn = _layernorm(x, axis=-1)
    return x + _A_ref(xn, A_wqkv, A_wo) + _B_ref(xn, B_w_gate, B_w_up, B_w_down)
```

```asm
; @launch kernel=g1_kernel grid=(256,1,1) block=(256,1,1) lds=163840
.amdgcn_target "amdgcn-amd-amdhsa--gfx950"
.text
.p2align 8
L_code_start:
L_g1_w_1008:
s_lshl4_add_u32 s36, s76, s36
s_bfe_u32 s40, s2, 0x20003
s_lshl2_add_u32 s54, s3, s40
s_lshl3_add_u32 s41, s54, s44
s_lshl1_add_u32 s41, s43, s41
s_lshl_b32 s42, s41, 11
s_lshl_b32 s41, s41, 3
s_mul_i32 s37, s54, 1536
s_mul_i32 s40, s58, 768
s_add_u32 s37, s37, s40
s_lshl2_add_u32 s37, s59, s37
s_add_u32 s37, s37, 16416
s_lshr_b32 s40, s2, 3
v_min_u32 v74, 23, v0
v_mul_u32_u24 v75, 10923, v74
v_lshrrev_b32 v75, 16, v75
v_mul_u32_u24 v76, 6, v75
v_sub_u32_e64 v76, v74, v76
v_lshl_add_u32 v75, v75, 5, s40
v_mul_u32_u24 v75, 6144, v75
v_lshrrev_b32_e64 v77, 1, v76
v_lshl_add_u32 v75, v77, 11, v75
v_and_b32_e64 v76, 1, v76
v_lshl_add_u32 v18, v76, 7, v75
s_mov_b32 s32, s62
s_mov_b32 s33, s63
s_cmp_eq_u32 s58, 0
s_nop 0
s_cselect_b32 s34, 0x600000, 0
s_mul_i32 s47, s3, 786688
s_mov_b32 s35, 0x00020000
s_add_u32 s47, s47, 1572864
s_add_u32 s20, s68, 0x400000
s_addc_u32 s21, s69, 0
s_mov_b32 s22, 0x1300000
s_mov_b32 s23, 0x00020000
s_mov_b32 s24, s68
s_mov_b32 s25, s69
s_mov_b32 s26, 0x20000
s_mov_b32 s27, 0x00020000
s_mov_b32 s28, s70
s_mov_b32 s29, s71
s_mov_b32 s30, 0x100
s_mov_b32 s31, 0x00020000
s_getpc_b64 s[70:71]
L_g1_tp_1041:
s_add_u32 s70, s70, L_pf_tab-L_g1_tp_1041
s_addc_u32 s71, s71, 0
s_and_b32 s55, s2, 1
s_lshl_b32 s55, s55, 5
s_add_u32 s55, s55, s40
s_lshl_b32 s55, s55, 2
s_load_dword s70, s[70:71], s55
v_and_b32 v74, 15, v0
v_lshrrev_b32 v75, 4, v0
v_lshrrev_b32 v76, 1, v74
v_xor_b32 v76, v76, v75
v_lshlrev_b32 v76, 4, v76
v_lshl_add_u32 v77, v74, 7, v76
v_add_u32 v6, 16384, v77
v_xor_b32_e64 v7, 64, v6
v_mov_b32 v78, 0x3f803f80
v_cmp_eq_u32 vcc, 0, v74
s_nop 1
v_cndmask_b32 v76, 0, v78, vcc
s_nop 0
v_accvgpr_write_b32 a152, v76
v_accvgpr_write_b32 a153, v76
v_accvgpr_write_b32 a154, v76
v_accvgpr_write_b32 a155, v76
v_cmp_eq_u32 vcc, 1, v74
s_nop 1
v_cndmask_b32 v76, 0, v78, vcc
s_nop 0
v_accvgpr_write_b32 a156, v76
v_accvgpr_write_b32 a157, v76
v_accvgpr_write_b32 a158, v76
v_accvgpr_write_b32 a159, v76
v_lshrrev_b32 v76, 2, v74
v_lshlrev_b32 v76, 6, v76
v_and_b32_e64 v77, 3, v0
v_lshl_add_u32 v76, v77, 3, v76
v_and_b32_e64 v77, 1, v75
v_lshl_add_u32 v76, v77, 5, v76
s_lshl_b32 s40, s58, 13
s_add_u32 s40, s40, 65536
v_lshl_add_u32 v77, v75, 10, v76
v_add_u32 v10, s40, v77
v_xor_b32_e64 v11, 32, v10
v_add_u32 v12, 40960, v10
v_add_u32 v13, 40960, v11
v_lshl_add_u32 v77, v75, 9, v76
s_lshl_b32 s40, s58, 5
v_xor_b32 v77, s40, v77
v_add_u32 v14, 81920, v77
s_and_b32 s40, s59, 1
s_lshl_b32 s40, s40, 11
s_and_b32 s55, s59, 2
s_lshl_b32 s55, s55, 11
s_add_u32 s40, s40, s55
v_add_u32 v8, s40, v14
v_mul_u32_u24 v9, 48, v0
v_bfrev_b32 v76, 2
v_cmp_gt_u32 vcc, 16, v0
s_nop 1
v_cndmask_b32 v9, v76, v9, vcc
s_cmp_lt_u32 s59, 4
s_cselect_b64 vcc, -1, 0
v_cndmask_b32 v5, v76, v9, vcc
v_mov_b32 v74, 0
v_mov_b32 v75, 0
v_mov_b32 v76, 0
v_mov_b32 v77, 0
buffer_store_dword v74, v5, s[24:27], s37 offen sc1
s_mov_b32 s54, 0xffff0000
s_mov_b32 s60, s72
s_mov_b32 s61, s73
s_mov_b32 s62, 0x200000
s_mov_b32 s63, 0x00020000
s_add_u32 s64, s68, 0x1800000
s_addc_u32 s65, s69, 0
s_mov_b32 s66, 0x900000
s_mov_b32 s67, 0x00020000
s_lshr_b32 s40, s2, 4
s_lshl_b32 s40, s40, 16
s_and_b32 s69, s2, 15
s_lshl_b32 s68, s69, 7
s_lshl_b32 s69, s69, 12
s_add_u32 s69, s69, s40
s_bfe_u32 s55, s2, 0x30004
s_lshl_b32 s69, s55, 16
s_bfe_u32 s40, s2, 0x30001
s_lshl_b32 s40, s40, 13
s_add_u32 s69, s69, s40
s_and_b32 s66, s69, 0xfff80000
s_add_u32 s66, s66, 0x900000
s_and_b32 s40, s2, 1
s_lshl_b32 s40, s40, 12
s_add_u32 s69, s69, s40
s_lshr_b32 s40, s2, 7
s_lshl_b32 s72, s40, 19
s_add_u32 s69, s69, s72
s_lshl2_add_u32 s40, s55, s40
s_lshl_b32 s40, s40, 16
s_mul_i32 s72, s55, 655360
s_mul_i32 s73, s55, 917504
s_add_u32 s68, s68, s40
s_lshl_b32 s40, s58, 14
s_add_u32 s68, s68, s40
s_add_u32 s68, s68, 8192
s_lshl_b32 s40, s43, 8
s_add_u32 s69, s69, s40
v_lshrrev_b32 v46, 3, v0
v_lshrrev_b32_e64 v47, 5, v0
v_mad_u32_u24 v46, v47, 12, v46
v_and_b32 v47, 7, v0
v_lshlrev_b32 v47, 4, v47
v_lshl_add_u32 v4, v46, 11, v47
v_bfe_u32 v46, v0, 2, 2
v_lshlrev_b32 v46, 7, v46
v_lshrrev_b32 v47, 4, v0
v_lshl_add_u32 v46, v47, 5, v46
v_and_b32_e64 v47, 3, v0
v_lshl_add_u32 v46, v47, 3, v46
s_add_u32 s40, s76, 147456
v_add_u32_e64 v78, s40, v46
s_lshl_b32 s51, s59, 2
s_and_b32 s78, s59, 3
s_cmp_le_u32 s78, 0
s_cselect_b32 s78, 1, 0
s_mul_i32 s53, s78, 229376
s_add_u32 s53, s53, s38
s_mul_i32 s52, s78, 229376
s_add_u32 s52, s52, s39
s_lshr_b32 s46, s78, 1
s_mul_i32 s46, s46, 32768
s_lshl_b32 s78, s78, 12
s_add_u32 s46, s46, s78
s_add_u32 s46, s46, s76
s_add_u32 m0, s46, 65536
s_nop 0
buffer_load_dwordx4 v2, s[8:11], s53 offen nt lds
s_add_u32 m0, s46, 73600
s_nop 0
buffer_load_dwordx4 v2, s[8:11], s53 offen offset:128 nt lds
s_add_u32 m0, s46, 81920
s_nop 0
buffer_load_dwordx4 v3, s[16:19], s52 offen nt lds
s_and_b32 s78, s59, 3
s_cmp_le_u32 s78, 1
s_cselect_b32 s78, 2, 1
s_mul_i32 s48, s78, 229376
s_add_u32 s48, s48, s38
s_mul_i32 s57, s78, 229376
s_add_u32 s57, s57, s39
s_lshr_b32 s49, s78, 1
s_mul_i32 s49, s49, 32768
s_lshl_b32 s78, s78, 12
s_add_u32 s49, s49, s78
s_add_u32 s49, s49, s76
s_add_u32 m0, s49, 65536
s_nop 0
buffer_load_dwordx4 v2, s[8:11], s48 offen nt lds
s_add_u32 m0, s49, 73600
s_nop 0
buffer_load_dwordx4 v2, s[8:11], s48 offen offset:128 nt lds
s_add_u32 m0, s49, 81920
s_nop 0
buffer_load_dwordx4 v3, s[16:19], s57 offen nt lds
s_bfe_u32 s55, s2, 0x20003
s_lshl_b32 s55, s55, 13
s_add_u32 s55, s55, 8192
s_and_b32 s55, s55, 32767
s_lshl4_add_u32 s79, s55, s36
s_add_u32 m0, s55, s76
s_nop 0
s_nop 0
buffer_load_dwordx4 v1, s[4:7], s79 offen offset:0 lds
s_add_u32 s55, s55, 4096
s_and_b32 s55, s55, 32767
s_lshl4_add_u32 s79, s55, s36
s_add_u32 m0, s55, s76
s_nop 0
s_nop 0
buffer_load_dwordx4 v1, s[4:7], s79 offen offset:0 lds
s_add_u32 s55, s55, 4096
s_and_b32 s55, s55, 32767
s_lshl4_add_u32 s79, s55, s36
s_add_u32 m0, s55, s76
s_nop 0
s_nop 0
buffer_load_dwordx4 v1, s[4:7], s79 offen offset:0 lds
s_add_u32 s55, s55, 4096
s_and_b32 s55, s55, 32767
s_lshl4_add_u32 s79, s55, s36
s_add_u32 m0, s55, s76
s_nop 0
s_nop 0
buffer_load_dwordx4 v1, s[4:7], s79 offen offset:0 lds
s_add_u32 s55, s55, 4096
s_and_b32 s55, s55, 32767
s_lshl4_add_u32 s79, s55, s36
s_add_u32 m0, s55, s76
s_nop 0
s_nop 0
buffer_load_dwordx4 v1, s[4:7], s79 offen offset:0 lds
s_add_u32 s55, s55, 4096
s_and_b32 s55, s55, 32767
s_lshl4_add_u32 s79, s55, s36
s_add_u32 m0, s55, s76
s_nop 0
buffer_load_dwordx4 v1, s[4:7], s79 offen offset:0 lds
s_add_u32 m0, s46, 90112
s_nop 0
buffer_load_dwordx4 v2, s[12:15], s53 offen nt lds
s_add_u32 m0, s46, 98176
s_nop 0
buffer_load_dwordx4 v2, s[12:15], s53 offen offset:128 nt lds
s_add_u32 m0, s49, 90112
s_nop 0
buffer_load_dwordx4 v2, s[12:15], s48 offen nt lds
s_add_u32 m0, s49, 98176
s_nop 0
buffer_load_dwordx4 v2, s[12:15], s48 offen offset:128 nt lds
s_waitcnt vmcnt(4)
s_waitcnt lgkmcnt(0)
s_barrier
ds_read_b64_tr_b16 a[224:225], v10 offset:0
ds_read_b64_tr_b16 a[226:227], v10 offset:256
ds_read_b64_tr_b16 a[228:229], v10 offset:4096
ds_read_b64_tr_b16 a[230:231], v10 offset:4352
ds_read_b128 a[160:163], v6 offset:0
ds_read_b128 a[164:167], v7 offset:0
ds_read_b128 a[172:175], v7 offset:2048
ds_read_b128 a[168:171], v6 offset:2048
ds_read_b128 a[176:179], v6 offset:4096
ds_read_b128 a[180:183], v7 offset:4096
ds_read_b128 a[188:191], v7 offset:6144
ds_read_b128 a[184:187], v6 offset:6144
ds_read_b128 a[192:195], v6 offset:8192
ds_read_b128 a[196:199], v7 offset:8192
ds_read_b128 a[204:207], v7 offset:10240
ds_read_b128 a[200:203], v6 offset:10240
ds_read_b128 a[208:211], v6 offset:12288
ds_read_b128 a[212:215], v7 offset:12288
ds_read_b128 a[220:223], v7 offset:14336
ds_read_b128 a[216:219], v6 offset:14336
s_waitcnt lgkmcnt(15)
v_mfma_f32_16x16x32_bf16 v[80:83], a[224:227], a[160:163], 0
s_waitcnt lgkmcnt(14)
s_bfe_u32 s55, s2, 0x20003
ds_read_b64_tr_b16 a[232:233], v11 offset:0
v_mfma_f32_16x16x32_bf16 v[80:83], a[228:231], a[164:167], v[80:83]
s_waitcnt lgkmcnt(14)
s_lshl_b32 s55, s55, 13
ds_read_b64_tr_b16 a[234:235], v11 offset:256
v_mfma_f32_16x16x32_bf16 v[96:99], a[228:231], a[172:175], 0
s_waitcnt lgkmcnt(14)
s_add_u32 s55, s55, 8192
ds_read_b64_tr_b16 a[236:237], v11 offset:4096
v_mfma_f32_16x16x32_bf16 v[96:99], a[224:227], a[168:171], v[96:99]
s_waitcnt lgkmcnt(14)
s_and_b32 s55, s55, 32767
ds_read_b64_tr_b16 a[238:239], v11 offset:4352
v_mfma_f32_16x16x32_bf16 v[240:243], a[224:227], a[176:179], 0
s_waitcnt lgkmcnt(14)
s_lshl4_add_u32 s79, s55, s36
s_add_u32 m0, s55, s76
v_mfma_f32_16x16x32_bf16 v[240:243], a[228:231], a[180:183], v[240:243]
s_waitcnt lgkmcnt(13)
s_add_u32 m0, m0, 32640
v_mfma_f32_16x16x32_bf16 v[112:115], a[228:231], a[188:191], 0
s_waitcnt lgkmcnt(12)
buffer_load_dwordx4 v1, s[4:7], s79 offen offset:128 lds
v_mfma_f32_16x16x32_bf16 v[112:115], a[224:227], a[184:187], v[112:115]
s_waitcnt lgkmcnt(11)
s_add_u32 s55, s55, 4096
s_and_b32 s55, s55, 32767
v_mfma_f32_16x16x32_bf16 v[128:131], a[224:227], a[192:195], 0
s_waitcnt lgkmcnt(10)
s_lshl4_add_u32 s79, s55, s36
s_add_u32 m0, s55, s76
v_mfma_f32_16x16x32_bf16 v[128:131], a[228:231], a[196:199], v[128:131]
s_waitcnt lgkmcnt(9)
s_add_u32 m0, m0, 32640
v_mfma_f32_16x16x32_bf16 a[0:3], a[228:231], a[204:207], 0
s_waitcnt lgkmcnt(8)
buffer_load_dwordx4 v1, s[4:7], s79 offen offset:128 lds
v_mfma_f32_16x16x32_bf16 a[0:3], a[224:227], a[200:203], a[0:3]
s_waitcnt lgkmcnt(7)
s_add_u32 s55, s55, 4096
s_and_b32 s55, s55, 32767
v_mfma_f32_16x16x32_bf16 a[16:19], a[224:227], a[208:211], 0
s_waitcnt lgkmcnt(6)
s_lshl4_add_u32 s79, s55, s36
s_add_u32 m0, s55, s76
v_mfma_f32_16x16x32_bf16 a[16:19], a[228:231], a[212:215], a[16:19]
s_waitcnt lgkmcnt(5)
s_add_u32 m0, m0, 32640
v_mfma_f32_16x16x32_bf16 a[32:35], a[228:231], a[220:223], 0
s_waitcnt lgkmcnt(4)
buffer_load_dwordx4 v1, s[4:7], s79 offen offset:128 lds
v_mfma_f32_16x16x32_bf16 a[32:35], a[224:227], a[216:219], a[32:35]
s_waitcnt vmcnt(3) lgkmcnt(0)
s_barrier
v_mfma_f32_16x16x32_bf16 a[40:43], a[232:235], a[216:219], 0
s_add_u32 s55, s55, 4096
s_and_b32 s55, s55, 32767
ds_read_b64_tr_b16 a[224:225], v10 offset:512
v_mfma_f32_16x16x32_bf16 a[40:43], a[236:239], a[220:223], a[40:43]
s_lshl4_add_u32 s79, s55, s36
s_add_u32 m0, s55, s76
ds_read_b64_tr_b16 a[226:227], v10 offset:768
v_mfma_f32_16x16x32_bf16 a[24:27], a[236:239], a[212:215], 0
s_add_u32 m0, m0, 32640
ds_read_b64_tr_b16 a[228:229], v10 offset:4608
v_mfma_f32_16x16x32_bf16 a[24:27], a[232:235], a[208:211], a[24:27]
buffer_load_dwordx4 v1, s[4:7], s79 offen offset:128 lds
v_mfma_f32_16x16x32_bf16 a[8:11], a[232:235], a[200:203], 0
s_add_u32 s55, s55, 4096
s_and_b32 s55, s55, 32767
ds_read_b64_tr_b16 a[230:231], v10 offset:4864
v_mfma_f32_16x16x32_bf16 a[8:11], a[236:239], a[204:207], a[8:11]
s_lshl4_add_u32 s79, s55, s36
s_add_u32 m0, s55, s76
s_add_u32 m0, m0, 32640
v_mfma_f32_16x16x32_bf16 v[136:139], a[236:239], a[196:199], 0
buffer_load_dwordx4 v1, s[4:7], s79 offen offset:128 lds
v_mfma_f32_16x16x32_bf16 v[136:139], a[232:235], a[192:195], v[136:139]
s_add_u32 s55, s55, 4096
s_and_b32 s55, s55, 32767
ds_read_b64_tr_b16 a[148:149], v8 offset:0
v_mfma_f32_16x16x32_bf16 v[120:123], a[232:235], a[184:187], 0
s_lshl4_add_u32 s79, s55, s36
s_add_u32 m0, s55, s76
ds_read_b64_tr_b16 a[150:151], v8 offset:256
v_mfma_f32_16x16x32_bf16 v[120:123], a[236:239], a[188:191], v[120:123]
s_add_u32 m0, m0, 32640
v_mfma_f32_16x16x32_bf16 v[248:251], a[236:239], a[180:183], 0
buffer_load_dwordx4 v1, s[4:7], s79 offen offset:128 lds
v_mfma_f32_16x16x32_bf16 v[248:251], a[232:235], a[176:179], v[248:251]
s_and_b32 s78, s59, 3
s_cmp_le_u32 s78, 2
s_cselect_b32 s78, 3, 2
v_mfma_f32_16x16x32_bf16 v[104:107], a[232:235], a[168:171], 0
s_mul_i32 s53, s78, 229376
s_add_u32 s53, s53, s38
s_mul_i32 s52, s78, 229376
v_mfma_f32_16x16x32_bf16 v[104:107], a[236:239], a[172:175], v[104:107]
s_add_u32 s52, s52, s39
s_lshr_b32 s46, s78, 1
s_mul_i32 s46, s46, 32768
v_mfma_f32_16x16x32_bf16 v[88:91], a[236:239], a[164:167], 0
s_lshl_b32 s78, s78, 12
s_add_u32 s46, s46, s78
s_add_u32 s46, s46, s76
v_mfma_f32_16x16x32_bf16 v[88:91], a[232:235], a[160:163], v[88:91]
s_waitcnt lgkmcnt(4)
s_add_u32 m0, s46, 65536
v_mfma_f32_16x16x32_bf16 a[48:51], a[224:227], a[160:163], 0
s_waitcnt lgkmcnt(2)
buffer_load_dwordx4 v2, s[8:11], s53 offen nt lds
v_mfma_f32_16x16x32_bf16 a[48:51], a[228:231], a[164:167], a[48:51]
s_add_u32 m0, s46, 73600
ds_read_b64_tr_b16 a[232:233], v11 offset:512
v_mfma_f32_16x16x32_bf16 a[64:67], a[228:231], a[172:175], 0
buffer_load_dwordx4 v2, s[8:11], s53 offen offset:128 nt lds
v_mfma_f32_16x16x32_bf16 a[64:67], a[224:227], a[168:171], a[64:67]
s_add_u32 m0, s46, 81920
ds_read_b64_tr_b16 a[234:235], v11 offset:768
v_mfma_f32_16x16x32_bf16 a[80:83], a[224:227], a[176:179], 0
buffer_load_dwordx4 v3, s[16:19], s52 offen nt lds
v_mfma_f32_16x16x32_bf16 a[80:83], a[228:231], a[180:183], a[80:83]
s_add_u32 m0, s46, 90112
ds_read_b64_tr_b16 a[236:237], v11 offset:4608
v_mfma_f32_16x16x32_bf16 a[96:99], a[228:231], a[188:191], 0
buffer_load_dwordx4 v2, s[12:15], s53 offen nt lds
v_mfma_f32_16x16x32_bf16 a[96:99], a[224:227], a[184:187], a[96:99]
s_waitcnt lgkmcnt(3)
s_add_u32 m0, s46, 98176
ds_read_b64_tr_b16 a[238:239], v11 offset:4864
v_mfma_f32_16x16x32_bf16 a[144:147], a[152:155], a[148:151], 0
buffer_load_dwordx4 v2, s[12:15], s53 offen offset:128 nt lds
v_mfma_f32_16x16x32_bf16 a[112:115], a[224:227], a[192:195], 0
s_sub_u32 s56, s56, 1
s_cmp_eq_u32 s56, 0
s_cselect_b32 s78, -7, 1
v_mfma_f32_16x16x32_bf16 a[112:115], a[228:231], a[196:199], a[112:115]
s_mul_i32 s55, s78, 917504
s_add_u32 s38, s38, s55
s_mul_i32 s55, s78, 917504
v_mfma_f32_16x16x32_bf16 a[128:131], a[228:231], a[204:207], 0
s_add_u32 s39, s39, s55
s_lshl_b32 s55, s78, 8
s_add_u32 s36, s36, s55
v_mfma_f32_16x16x32_bf16 a[128:131], a[224:227], a[200:203], a[128:131]
s_cmp_ge_u32 s47, 6291456
s_cselect_b32 s78, 6291456, 0
s_sub_u32 s47, s47, s78
v_mfma_f32_16x16x32_bf16 v[144:147], a[224:227], a[208:211], 0
buffer_load_dword v19, v18, s[32:35], s47 offen
v_mfma_f32_16x16x32_bf16 v[144:147], a[228:231], a[212:215], v[144:147]
s_add_u32 s47, s47, 786432
s_add_u32 m0, s76, 155648
v_and_b32 v44, 7, v0
v_mfma_f32_16x16x32_bf16 v[160:163], a[228:231], a[220:223], 0
buffer_load_dwordx4 v4, s[60:63], s68 offen nt lds
v_mfma_f32_16x16x32_bf16 v[160:163], a[224:227], a[216:219], v[160:163]
s_waitcnt lgkmcnt(2)
s_add_u32 s68, s68, 0x20000
v_lshrrev_b32 v45, 4, v0
v_mfma_f32_16x16x32_bf16 v[168:171], a[232:235], a[216:219], 0
s_waitcnt lgkmcnt(0)
ds_read_b64_tr_b16 a[224:225], v14 offset:0
v_mfma_f32_16x16x32_bf16 v[168:171], a[236:239], a[220:223], v[168:171]
ds_read_b64_tr_b16 a[226:227], v14 offset:256
v_lshl_add_u32 v44, v45, 3, v44
v_mfma_f32_16x16x32_bf16 v[152:155], a[236:239], a[212:215], 0
ds_read_b64_tr_b16 a[228:229], v14 offset:4096
v_mfma_f32_16x16x32_bf16 v[152:155], a[232:235], a[208:211], v[152:155]
ds_read_b64_tr_b16 a[230:231], v14 offset:4352
v_mfma_f32_16x16x32_bf16 a[136:139], a[232:235], a[200:203], 0
v_mfma_f32_16x16x32_bf16 a[136:139], a[236:239], a[204:207], a[136:139]
v_mfma_f32_16x16x32_bf16 a[120:123], a[236:239], a[196:199], 0
v_lshlrev_b32 v44, 4, v44
v_mfma_f32_16x16x32_bf16 a[120:123], a[232:235], a[192:195], a[120:123]
v_mfma_f32_16x16x32_bf16 a[104:107], a[232:235], a[184:187], 0
v_mfma_f32_16x16x32_bf16 a[104:107], a[236:239], a[188:191], a[104:107]
v_mfma_f32_16x16x32_bf16 a[88:91], a[236:239], a[180:183], 0
v_mfma_f32_16x16x32_bf16 a[88:91], a[232:235], a[176:179], a[88:91]
v_bfe_u32 v45, v0, 3, 1
v_mfma_f32_16x16x32_bf16 a[72:75], a[232:235], a[168:171], 0
v_mfma_f32_16x16x32_bf16 a[72:75], a[236:239], a[172:175], a[72:75]
v_mfma_f32_16x16x32_bf16 a[56:59], a[236:239], a[164:167], 0
v_mfma_f32_16x16x32_bf16 a[56:59], a[232:235], a[160:163], a[56:59]
s_waitcnt lgkmcnt(2)
v_mfma_f32_16x16x32_bf16 v[176:179], a[224:227], a[160:163], 0
s_waitcnt lgkmcnt(0)
ds_read_b64_tr_b16 a[232:233], v14 offset:2048
v_lshl_add_u32 v44, v45, 11, v44
v_mfma_f32_16x16x32_bf16 v[176:179], a[228:231], a[164:167], v[176:179]
ds_read_b64_tr_b16 a[234:235], v14 offset:2304
v_mfma_f32_16x16x32_bf16 v[184:187], a[228:231], a[172:175], 0
ds_read_b64_tr_b16 a[236:237], v14 offset:6144
v_mfma_f32_16x16x32_bf16 v[184:187], a[224:227], a[168:171], v[184:187]
ds_read_b64_tr_b16 a[238:239], v14 offset:6400
v_mfma_f32_16x16x32_bf16 v[192:195], a[224:227], a[176:179], 0
v_mfma_f32_16x16x32_bf16 v[192:195], a[228:231], a[180:183], v[192:195]
buffer_load_dwordx4 v[20:23], v44, s[4:7], s42 offen offset:0
v_mfma_f32_16x16x32_bf16 v[200:203], a[228:231], a[188:191], 0
v_mfma_f32_16x16x32_bf16 v[200:203], a[224:227], a[184:187], v[200:203]
buffer_load_dwordx4 v[24:27], v44, s[4:7], s42 offen offset:512
v_mfma_f32_16x16x32_bf16 v[208:211], a[224:227], a[192:195], 0
v_mfma_f32_16x16x32_bf16 v[208:211], a[228:231], a[196:199], v[208:211]
v_mfma_f32_16x16x32_bf16 v[216:219], a[228:231], a[204:207], 0
buffer_load_dwordx4 v[28:31], v44, s[4:7], s42 offen offset:1024
v_mfma_f32_16x16x32_bf16 v[216:219], a[224:227], a[200:203], v[216:219]
v_mfma_f32_16x16x32_bf16 v[224:227], a[224:227], a[208:211], 0
buffer_load_dwordx4 v[32:35], v44, s[4:7], s42 offen offset:1536
v_mfma_f32_16x16x32_bf16 v[224:227], a[228:231], a[212:215], v[224:227]
v_mfma_f32_16x16x32_bf16 v[232:235], a[228:231], a[220:223], 0
v_mfma_f32_16x16x32_bf16 v[232:235], a[224:227], a[216:219], v[232:235]
s_waitcnt vmcnt(11) lgkmcnt(0)
s_barrier
v_mfma_f32_16x16x32_bf16 v[236:239], a[232:235], a[216:219], 0
s_add_u32 m0, s76, 0
s_add_u32 s79, s36, 0
ds_read_b64_tr_b16 a[224:225], v10 offset:24576
v_mfma_f32_16x16x32_bf16 v[236:239], a[236:239], a[220:223], v[236:239]
ds_read_b64_tr_b16 a[226:227], v10 offset:24832
v_mfma_f32_16x16x32_bf16 v[228:231], a[236:239], a[212:215], 0
ds_read_b64_tr_b16 a[228:229], v10 offset:28672
v_mfma_f32_16x16x32_bf16 v[228:231], a[232:235], a[208:211], v[228:231]
ds_read_b64_tr_b16 a[230:231], v10 offset:28928
v_mfma_f32_16x16x32_bf16 v[220:223], a[232:235], a[200:203], 0
buffer_load_dwordx4 v1, s[4:7], s79 offen lds
v_mfma_f32_16x16x32_bf16 v[220:223], a[236:239], a[204:207], v[220:223]
s_add_u32 m0, s76, 4096
s_add_u32 s79, s36, 65536
ds_read_b128 v[58:61], v6 offset:32768
v_mfma_f32_16x16x32_bf16 v[212:215], a[236:239], a[196:199], 0
v_mfma_f32_16x16x32_bf16 v[212:215], a[232:235], a[192:195], v[212:215]
v_mfma_f32_16x16x32_bf16 v[204:207], a[232:235], a[184:187], 0
v_mfma_f32_16x16x32_bf16 v[204:207], a[236:239], a[188:191], v[204:207]
v_mfma_f32_16x16x32_bf16 v[196:199], a[236:239], a[180:183], 0
v_mfma_f32_16x16x32_bf16 v[196:199], a[232:235], a[176:179], v[196:199]
buffer_load_dwordx4 v1, s[4:7], s79 offen lds
v_mfma_f32_16x16x32_bf16 v[188:191], a[232:235], a[168:171], 0
s_add_u32 m0, s76, 8192
s_add_u32 s79, s36, 131072
ds_read_b128 v[62:65], v7 offset:32768
v_mfma_f32_16x16x32_bf16 v[188:191], a[236:239], a[172:175], v[188:191]
v_mfma_f32_16x16x32_bf16 v[180:183], a[236:239], a[164:167], 0
v_mfma_f32_16x16x32_bf16 v[180:183], a[232:235], a[160:163], v[180:183]
s_waitcnt lgkmcnt(4)
v_mfma_f32_16x16x32_bf16 v[84:87], a[224:227], a[160:163], 0
s_waitcnt lgkmcnt(2)
ds_read_b64_tr_b16 a[232:233], v11 offset:24576
v_mfma_f32_16x16x32_bf16 v[84:87], a[228:231], a[164:167], v[84:87]
ds_read_b64_tr_b16 a[234:235], v11 offset:24832
v_mfma_f32_16x16x32_bf16 v[100:103], a[228:231], a[172:175], 0
buffer_load_dwordx4 v1, s[4:7], s79 offen lds
v_mfma_f32_16x16x32_bf16 v[100:103], a[224:227], a[168:171], v[100:103]
s_add_u32 m0, s76, 12288
s_add_u32 s79, s36, 196608
ds_read_b64_tr_b16 a[236:237], v11 offset:28672
v_mfma_f32_16x16x32_bf16 v[244:247], a[224:227], a[176:179], 0
ds_read_b64_tr_b16 a[238:239], v11 offset:28928
v_mfma_f32_16x16x32_bf16 v[244:247], a[228:231], a[180:183], v[244:247]
ds_read_b128 v[70:73], v7 offset:34816
v_mfma_f32_16x16x32_bf16 v[116:119], a[228:231], a[188:191], 0
v_mfma_f32_16x16x32_bf16 v[116:119], a[224:227], a[184:187], v[116:119]
v_mfma_f32_16x16x32_bf16 v[132:135], a[224:227], a[192:195], 0
v_mfma_f32_16x16x32_bf16 v[132:135], a[228:231], a[196:199], v[132:135]
buffer_load_dwordx4 v1, s[4:7], s79 offen lds
v_mfma_f32_16x16x32_bf16 a[4:7], a[228:231], a[204:207], 0
s_add_u32 m0, s76, 16384
s_add_u32 s79, s36, 262144
ds_read_b128 v[66:69], v6 offset:34816
v_mfma_f32_16x16x32_bf16 a[4:7], a[224:227], a[200:203], a[4:7]
v_mfma_f32_16x16x32_bf16 a[20:23], a[224:227], a[208:211], 0
v_mfma_f32_16x16x32_bf16 a[20:23], a[228:231], a[212:215], a[20:23]
v_mfma_f32_16x16x32_bf16 a[36:39], a[228:231], a[220:223], 0
v_mfma_f32_16x16x32_bf16 a[36:39], a[224:227], a[216:219], a[36:39]
s_waitcnt lgkmcnt(4)
v_mfma_f32_16x16x32_bf16 a[44:47], a[232:235], a[216:219], 0
s_waitcnt lgkmcnt(2)
buffer_load_dwordx4 v1, s[4:7], s79 offen lds
v_mfma_f32_16x16x32_bf16 a[44:47], a[236:239], a[220:223], a[44:47]
s_add_u32 m0, s76, 20480
s_add_u32 s79, s36, 327680
ds_read_b64_tr_b16 a[224:225], v10 offset:25088
v_mfma_f32_16x16x32_bf16 a[28:31], a[236:239], a[212:215], 0
ds_read_b64_tr_b16 a[226:227], v10 offset:25344
v_mfma_f32_16x16x32_bf16 a[28:31], a[232:235], a[208:211], a[28:31]
ds_read_b64_tr_b16 a[228:229], v10 offset:29184
v_mfma_f32_16x16x32_bf16 a[12:15], a[232:235], a[200:203], 0
ds_read_b64_tr_b16 a[230:231], v10 offset:29440
v_mfma_f32_16x16x32_bf16 a[12:15], a[236:239], a[204:207], a[12:15]
ds_read_b128 a[240:243], v6 offset:36864
v_mfma_f32_16x16x32_bf16 v[140:143], a[236:239], a[196:199], 0
v_mfma_f32_16x16x32_bf16 v[140:143], a[232:235], a[192:195], v[140:143]
buffer_load_dwordx4 v1, s[4:7], s79 offen lds
v_mfma_f32_16x16x32_bf16 v[124:127], a[232:235], a[184:187], 0
s_add_u32 m0, s76, 24576
s_add_u32 s79, s36, 393216
ds_read_b128 a[244:247], v7 offset:36864
v_mfma_f32_16x16x32_bf16 v[124:127], a[236:239], a[188:191], v[124:127]
v_mfma_f32_16x16x32_bf16 v[252:255], a[236:239], a[180:183], 0
v_mfma_f32_16x16x32_bf16 v[252:255], a[232:235], a[176:179], v[252:255]
v_mfma_f32_16x16x32_bf16 v[108:111], a[232:235], a[168:171], 0
v_mfma_f32_16x16x32_bf16 v[108:111], a[236:239], a[172:175], v[108:111]
v_mfma_f32_16x16x32_bf16 v[92:95], a[236:239], a[164:167], 0
buffer_load_dwordx4 v1, s[4:7], s79 offen lds
v_mfma_f32_16x16x32_bf16 v[92:95], a[232:235], a[160:163], v[92:95]
s_waitcnt lgkmcnt(4)
s_add_u32 m0, s76, 28672
ds_read_b128 a[252:255], v7 offset:38912
v_mfma_f32_16x16x32_bf16 a[52:55], a[224:227], a[160:163], 0
s_waitcnt lgkmcnt(3)
s_add_u32 s79, s36, 458752
ds_read_b64_tr_b16 a[232:233], v11 offset:25088
v_mfma_f32_16x16x32_bf16 a[52:55], a[228:231], a[164:167], a[52:55]
ds_read_b64_tr_b16 a[234:235], v11 offset:25344
v_mfma_f32_16x16x32_bf16 a[68:71], a[228:231], a[172:175], 0
ds_read_b64_tr_b16 a[236:237], v11 offset:29184
v_mfma_f32_16x16x32_bf16 a[68:71], a[224:227], a[168:171], a[68:71]
ds_read_b64_tr_b16 a[238:239], v11 offset:29440
v_mfma_f32_16x16x32_bf16 a[84:87], a[224:227], a[176:179], 0
v_mfma_f32_16x16x32_bf16 a[84:87], a[228:231], a[180:183], a[84:87]
buffer_load_dwordx4 v1, s[4:7], s79 offen lds
v_mfma_f32_16x16x32_bf16 a[100:103], a[228:231], a[188:191], 0
s_add_u32 s36, s36, 128
s_add_u32 m0, s76, 65536
ds_read_b128 a[248:251], v6 offset:38912
v_mfma_f32_16x16x32_bf16 a[100:103], a[224:227], a[184:187], a[100:103]
v_mfma_f32_16x16x32_bf16 a[116:119], a[224:227], a[192:195], 0
v_mfma_f32_16x16x32_bf16 a[116:119], a[228:231], a[196:199], a[116:119]
v_mfma_f32_16x16x32_bf16 a[132:135], a[228:231], a[204:207], 0
v_mfma_f32_16x16x32_bf16 a[132:135], a[224:227], a[200:203], a[132:135]
v_mfma_f32_16x16x32_bf16 v[148:151], a[224:227], a[208:211], 0
buffer_load_dwordx4 v2, s[8:11], s38 offen nt lds
v_mfma_f32_16x16x32_bf16 v[148:151], a[228:231], a[212:215], v[148:151]
s_add_u32 m0, s76, 73600
v_mfma_f32_16x16x32_bf16 v[164:167], a[228:231], a[220:223], 0
v_mfma_f32_16x16x32_bf16 v[164:167], a[224:227], a[216:219], v[164:167]
s_waitcnt vmcnt(15) lgkmcnt(1)
s_barrier
v_mfma_f32_16x16x32_bf16 v[172:175], a[232:235], a[216:219], 0
ds_read_b64_tr_b16 a[224:225], v12 offset:0
v_mfma_f32_16x16x32_bf16 v[172:175], a[236:239], a[220:223], v[172:175]
ds_read_b64_tr_b16 a[226:227], v12 offset:256
v_mfma_f32_16x16x32_bf16 v[156:159], a[236:239], a[212:215], 0
ds_read_b64_tr_b16 a[228:229], v12 offset:4096
v_mfma_f32_16x16x32_bf16 v[156:159], a[232:235], a[208:211], v[156:159]
buffer_load_dwordx4 v2, s[8:11], s38 offen offset:128 nt lds
v_mfma_f32_16x16x32_bf16 a[140:143], a[232:235], a[200:203], 0
s_add_u32 m0, s76, 81920
ds_read_b64_tr_b16 a[230:231], v12 offset:4352
v_mfma_f32_16x16x32_bf16 a[140:143], a[236:239], a[204:207], a[140:143]
v_mfma_f32_16x16x32_bf16 a[124:127], a[236:239], a[196:199], 0
v_mfma_f32_16x16x32_bf16 a[124:127], a[232:235], a[192:195], a[124:127]
ds_read_b128 a[192:195], v6 offset:40960
v_mfma_f32_16x16x32_bf16 a[108:111], a[232:235], a[184:187], 0
ds_read_b128 a[196:199], v7 offset:40960
v_mfma_f32_16x16x32_bf16 a[108:111], a[236:239], a[188:191], a[108:111]
ds_read_b128 a[204:207], v7 offset:43008
v_mfma_f32_16x16x32_bf16 a[92:95], a[236:239], a[180:183], 0
buffer_load_dwordx4 v3, s[16:19], s39 offen nt lds
v_mfma_f32_16x16x32_bf16 a[92:95], a[232:235], a[176:179], a[92:95]
s_add_u32 m0, s76, 69632
s_add_u32 s79, s38, 229376
ds_read_b128 a[200:203], v6 offset:43008
v_mfma_f32_16x16x32_bf16 a[76:79], a[232:235], a[168:171], 0
ds_read_b128 a[208:211], v6 offset:45056
v_mfma_f32_16x16x32_bf16 a[76:79], a[236:239], a[172:175], a[76:79]
ds_read_b128 a[212:215], v7 offset:45056
v_mfma_f32_16x16x32_bf16 a[60:63], a[236:239], a[164:167], 0
v_mfma_f32_16x16x32_bf16 a[60:63], a[232:235], a[160:163], a[60:63]
s_waitcnt lgkmcnt(8)
s_mov_b32 s46, 6
v_mfma_f32_16x16x32_bf16 v[80:83], a[224:227], v[58:61], v[80:83]
s_waitcnt lgkmcnt(6)
ds_read_b128 a[220:223], v7 offset:47104
v_mfma_f32_16x16x32_bf16 v[80:83], a[228:231], v[62:65], v[80:83]
buffer_load_dwordx4 v2, s[8:11], s79 offen nt lds
v_mfma_f32_16x16x32_bf16 v[96:99], a[228:231], v[70:73], v[96:99]
s_add_u32 m0, s76, 77696
ds_read_b128 a[216:219], v6 offset:47104
v_mfma_f32_16x16x32_bf16 v[96:99], a[224:227], v[66:69], v[96:99]
ds_read_b64_tr_b16 a[232:233], v13 offset:0
v_mfma_f32_16x16x32_bf16 v[240:243], a[224:227], a[240:243], v[240:243]
ds_read_b64_tr_b16 a[234:235], v13 offset:256
v_lshrrev_b32 v46, 4, v0
v_mfma_f32_16x16x32_bf16 v[240:243], a[228:231], a[244:247], v[240:243]
ds_read_b64_tr_b16 a[236:237], v13 offset:4096
v_mfma_f32_16x16x32_bf16 v[112:115], a[228:231], a[252:255], v[112:115]
ds_read_b64_tr_b16 a[238:239], v13 offset:4352
v_mfma_f32_16x16x32_bf16 v[112:115], a[224:227], a[248:251], v[112:115]
s_waitcnt lgkmcnt(11)
v_mfma_f32_16x16x32_bf16 v[128:131], a[224:227], a[192:195], v[128:131]
s_waitcnt lgkmcnt(10)
buffer_load_dwordx4 v2, s[8:11], s79 offen offset:128 nt lds
v_mfma_f32_16x16x32_bf16 v[128:131], a[228:231], a[196:199], v[128:131]
s_waitcnt lgkmcnt(9)
s_add_u32 m0, s76, 86016
s_add_u32 s79, s39, 229376
v_mfma_f32_16x16x32_bf16 a[0:3], a[228:231], a[204:207], a[0:3]
s_waitcnt lgkmcnt(8)
v_lshlrev_b32_e64 v46, 10, v46
v_mfma_f32_16x16x32_bf16 a[0:3], a[224:227], a[200:203], a[0:3]
s_waitcnt lgkmcnt(7)
v_mfma_f32_16x16x32_bf16 a[16:19], a[224:227], a[208:211], a[16:19]
s_waitcnt lgkmcnt(6)
v_and_b32_e64 v47, 15, v0
v_mfma_f32_16x16x32_bf16 a[16:19], a[228:231], a[212:215], a[16:19]
s_waitcnt lgkmcnt(5)
v_mfma_f32_16x16x32_bf16 a[32:35], a[228:231], a[220:223], a[32:35]
s_waitcnt lgkmcnt(4)
v_mfma_f32_16x16x32_bf16 a[32:35], a[224:227], a[216:219], a[32:35]
s_waitcnt lgkmcnt(2)
buffer_load_dwordx4 v3, s[16:19], s79 offen nt lds
v_mfma_f32_16x16x32_bf16 a[40:43], a[232:235], a[216:219], a[40:43]
s_waitcnt lgkmcnt(0)
s_add_u32 s39, s39, 458752
ds_read_b64_tr_b16 a[224:225], v12 offset:512
v_mfma_f32_16x16x32_bf16 a[40:43], a[236:239], a[220:223], a[40:43]
s_add_u32 m0, s76, 90112
ds_read_b64_tr_b16 a[226:227], v12 offset:768
v_lshl_add_u32 v79, v47, 4, v46
v_mfma_f32_16x16x32_bf16 a[24:27], a[236:239], a[212:215], a[24:27]
ds_read_b64_tr_b16 a[228:229], v12 offset:4608
v_mfma_f32_16x16x32_bf16 a[24:27], a[232:235], a[208:211], a[24:27]
ds_read_b64_tr_b16 a[230:231], v12 offset:4864
v_mfma_f32_16x16x32_bf16 a[8:11], a[232:235], a[200:203], a[8:11]
v_mfma_f32_16x16x32_bf16 a[8:11], a[236:239], a[204:207], a[8:11]
v_mfma_f32_16x16x32_bf16 v[136:139], a[236:239], a[196:199], v[136:139]
buffer_load_dwordx4 v2, s[12:15], s38 offen nt lds
v_mfma_f32_16x16x32_bf16 v[136:139], a[232:235], a[192:195], v[136:139]
s_add_u32 m0, s76, 98176
ds_read_b64_tr_b16 a[148:149], v8 offset:40960
v_mfma_f32_16x16x32_bf16 v[120:123], a[232:235], a[248:251], v[120:123]
ds_read_b64_tr_b16 a[150:151], v8 offset:41216
v_mfma_f32_16x16x32_bf16 v[120:123], a[236:239], a[252:255], v[120:123]
v_mfma_f32_16x16x32_bf16 v[248:251], a[236:239], a[244:247], v[248:251]
v_mfma_f32_16x16x32_bf16 v[248:251], a[232:235], a[240:243], v[248:251]
v_mfma_f32_16x16x32_bf16 v[104:107], a[232:235], v[66:69], v[104:107]
v_mfma_f32_16x16x32_bf16 v[104:107], a[236:239], v[70:73], v[104:107]
buffer_load_dwordx4 v2, s[12:15], s38 offen offset:128 nt lds
v_mfma_f32_16x16x32_bf16 v[88:91], a[236:239], v[62:65], v[88:91]
s_add_u32 m0, s76, 94208
s_add_u32 s79, s38, 229376
v_mfma_f32_16x16x32_bf16 v[88:91], a[232:235], v[58:61], v[88:91]
s_waitcnt lgkmcnt(4)
v_mfma_f32_16x16x32_bf16 a[48:51], a[224:227], v[58:61], a[48:51]
s_waitcnt lgkmcnt(2)
ds_read_b64_tr_b16 a[232:233], v13 offset:512
v_mfma_f32_16x16x32_bf16 a[48:51], a[228:231], v[62:65], a[48:51]
ds_read_b64_tr_b16 a[234:235], v13 offset:768
v_mfma_f32_16x16x32_bf16 a[64:67], a[228:231], v[70:73], a[64:67]
ds_read_b64_tr_b16 a[236:237], v13 offset:4608
v_mfma_f32_16x16x32_bf16 a[64:67], a[224:227], v[66:69], a[64:67]
ds_read_b64_tr_b16 a[238:239], v13 offset:4864
v_mfma_f32_16x16x32_bf16 a[80:83], a[224:227], a[240:243], a[80:83]
buffer_load_dwordx4 v2, s[12:15], s79 offen nt lds
v_mfma_f32_16x16x32_bf16 a[80:83], a[228:231], a[244:247], a[80:83]
s_add_u32 m0, s76, 102272
v_mfma_f32_16x16x32_bf16 a[96:99], a[228:231], a[252:255], a[96:99]
v_mfma_f32_16x16x32_bf16 a[96:99], a[224:227], a[248:251], a[96:99]
s_waitcnt lgkmcnt(4)
v_mfma_f32_16x16x32_bf16 a[144:147], a[152:155], a[148:151], a[144:147]
s_waitcnt vmcnt(17)
v_mfma_f32_16x16x32_bf16 a[112:115], a[224:227], a[192:195], a[112:115]
v_mfma_f32_16x16x32_bf16 a[112:115], a[228:231], a[196:199], a[112:115]
v_mfma_f32_16x16x32_bf16 v[36:39], v[20:23], v[20:23], 0
v_mfma_f32_16x16x32_bf16 a[128:131], a[228:231], a[204:207], a[128:131]
buffer_load_dwordx4 v2, s[12:15], s79 offen offset:128 nt lds
v_mfma_f32_16x16x32_bf16 a[128:131], a[224:227], a[200:203], a[128:131]
s_add_u32 s38, s38, 458752
s_add_u32 m0, s76, 147456
v_mfma_f32_16x16x32_bf16 v[40:43], v[20:23], a[152:155], 0
v_mfma_f32_16x16x32_bf16 v[144:147], a[224:227], a[208:211], v[144:147]
v_mfma_f32_16x16x32_bf16 v[144:147], a[228:231], a[212:215], v[144:147]
v_mfma_f32_16x16x32_bf16 v[36:39], v[24:27], v[24:27], v[36:39]
v_mfma_f32_16x16x32_bf16 v[160:163], a[228:231], a[220:223], v[160:163]
v_mfma_f32_16x16x32_bf16 v[160:163], a[224:227], a[216:219], v[160:163]
s_waitcnt lgkmcnt(2)
v_mfma_f32_16x16x32_bf16 v[40:43], v[24:27], a[152:155], v[40:43]
v_mfma_f32_16x16x32_bf16 v[168:171], a[232:235], a[216:219], v[168:171]
s_waitcnt lgkmcnt(0)
ds_read_b64_tr_b16 a[224:225], v14 offset:40960
v_mfma_f32_16x16x32_bf16 v[168:171], a[236:239], a[220:223], v[168:171]
buffer_load_dwordx4 v4, s[60:63], s68 offen nt lds
v_mfma_f32_16x16x32_bf16 v[152:155], a[236:239], a[212:215], v[152:155]
s_sub_u32 s68, s68, 0x20000
s_add_u32 s68, s68, s72
ds_read_b64_tr_b16 a[226:227], v14 offset:41216
v_mfma_f32_16x16x32_bf16 v[36:39], v[28:31], v[28:31], v[36:39]
v_mfma_f32_16x16x32_bf16 v[152:155], a[232:235], a[208:211], v[152:155]
s_mov_b32 s60, s74
s_mov_b32 s61, s75
ds_read_b64_tr_b16 a[228:229], v14 offset:45056
v_mfma_f32_16x16x32_bf16 v[40:43], v[28:31], a[152:155], v[40:43]
v_mfma_f32_16x16x32_bf16 a[136:139], a[232:235], a[200:203], a[136:139]
s_add_u32 s62, s73, 917504
s_add_u32 m0, s76, 151552
ds_read_b64_tr_b16 a[230:231], v14 offset:45312
v_mfma_f32_16x16x32_bf16 a[136:139], a[236:239], a[204:207], a[136:139]
v_mfma_f32_16x16x32_bf16 v[36:39], v[32:35], v[32:35], v[36:39]
v_mfma_f32_16x16x32_bf16 a[120:123], a[236:239], a[196:199], a[120:123]
v_mfma_f32_16x16x32_bf16 a[120:123], a[232:235], a[192:195], a[120:123]
v_mfma_f32_16x16x32_bf16 v[40:43], v[32:35], a[152:155], v[40:43]
v_mfma_f32_16x16x32_bf16 a[104:107], a[232:235], a[248:251], a[104:107]
buffer_load_dwordx4 v4, s[60:63], s68 offen nt lds
v_mfma_f32_16x16x32_bf16 a[104:107], a[236:239], a[252:255], a[104:107]
s_add_u32 s68, s68, 0x20000
v_and_b32 v77, 31, v0
v_mfma_f32_16x16x32_bf16 a[88:91], a[236:239], a[244:247], a[88:91]
v_mfma_f32_16x16x32_bf16 a[88:91], a[232:235], a[240:243], a[88:91]
v_lshrrev_b32_e64 v76, 5, v0
v_mfma_f32_16x16x32_bf16 a[72:75], a[232:235], v[66:69], a[72:75]
v_mfma_f32_16x16x32_bf16 a[72:75], a[236:239], v[70:73], a[72:75]
v_lshlrev_b32_e64 v76, 3, v76
v_mfma_f32_16x16x32_bf16 a[56:59], a[236:239], v[62:65], a[56:59]
v_mfma_f32_16x16x32_bf16 a[56:59], a[232:235], v[58:61], a[56:59]
s_waitcnt lgkmcnt(2)
v_lshl_add_u32 v76, v77, 26, v76
v_mfma_f32_16x16x32_bf16 v[176:179], a[224:227], v[58:61], v[176:179]
s_waitcnt lgkmcnt(0)
ds_read_b64_tr_b16 a[232:233], v14 offset:43008
v_mfma_f32_16x16x32_bf16 v[176:179], a[228:231], v[62:65], v[176:179]
ds_read_b64_tr_b16 a[234:235], v14 offset:43264
s_mov_b32 vcc_lo, 0x00100001
v_mfma_f32_16x16x32_bf16 v[184:187], a[228:231], v[70:73], v[184:187]
ds_read_b64_tr_b16 a[236:237], v14 offset:47104
v_mfma_f32_16x16x32_bf16 v[184:187], a[224:227], v[66:69], v[184:187]
ds_read_b64_tr_b16 a[238:239], v14 offset:47360
s_mov_b32 vcc_hi, 0x10000100
v_mfma_f32_16x16x32_bf16 v[192:195], a[224:227], a[240:243], v[192:195]
v_mfma_f32_16x16x32_bf16 v[192:195], a[228:231], a[244:247], v[192:195]
v_mfma_f32_16x16x32_bf16 v[200:203], a[228:231], a[252:255], v[200:203]
v_mfma_f32_16x16x32_bf16 v[200:203], a[224:227], a[248:251], v[200:203]
v_mfma_f32_16x16x32_bf16 v[208:211], a[224:227], a[192:195], v[208:211]
v_mfma_f32_16x16x32_bf16 v[208:211], a[228:231], a[196:199], v[208:211]
v_cndmask_b32 v44, 0, v36, vcc
v_mfma_f32_16x16x32_bf16 v[216:219], a[228:231], a[204:207], v[216:219]
v_mfma_f32_16x16x32_bf16 v[216:219], a[224:227], a[200:203], v[216:219]
s_lshl_b64 vcc, vcc, 1
v_mfma_f32_16x16x32_bf16 v[224:227], a[224:227], a[208:211], v[224:227]
v_mfma_f32_16x16x32_bf16 v[224:227], a[228:231], a[212:215], v[224:227]
v_add_f32_e64 v40, v40, v41
v_mfma_f32_16x16x32_bf16 v[232:235], a[228:231], a[220:223], v[232:235]
v_mfma_f32_16x16x32_bf16 v[232:235], a[224:227], a[216:219], v[232:235]
s_waitcnt vmcnt(12) lgkmcnt(0)
s_barrier
v_mfma_f32_16x16x32_bf16 v[236:239], a[232:235], a[216:219], v[236:239]
s_sub_u32 s56, s56, 1
ds_read_b64_tr_b16 a[224:225], v12 offset:24576
v_cndmask_b32 v44, v44, v37, vcc
v_mfma_f32_16x16x32_bf16 v[236:239], a[236:239], a[220:223], v[236:239]
s_cmp_eq_u32 s56, 0
s_cselect_b32 s78, -960, 64
ds_read_b64_tr_b16 a[226:227], v12 offset:24832
v_mfma_f32_16x16x32_bf16 v[228:231], a[236:239], a[212:215], v[228:231]
s_add_u32 m0, s76, 32768
s_add_u32 s79, s36, 0
ds_read_b64_tr_b16 a[228:229], v12 offset:28672
v_mfma_f32_16x16x32_bf16 v[228:231], a[232:235], a[208:211], v[228:231]
ds_read_b64_tr_b16 a[230:231], v12 offset:28928
s_lshl_b64 vcc, vcc, 1
v_mfma_f32_16x16x32_bf16 v[220:223], a[232:235], a[200:203], v[220:223]
buffer_load_dwordx4 v1, s[4:7], s79 offen lds
v_mfma_f32_16x16x32_bf16 v[220:223], a[236:239], a[204:207], v[220:223]
s_add_u32 m0, s76, 36864
s_add_u32 s79, s36, 65536
ds_read_b128 a[160:163], v6 offset:0
v_mfma_f32_16x16x32_bf16 v[212:215], a[236:239], a[196:199], v[212:215]
v_add_f32 v40, v40, v42
v_mfma_f32_16x16x32_bf16 v[212:215], a[232:235], a[192:195], v[212:215]
v_cndmask_b32 v44, v44, v38, vcc
s_lshl_b64 vcc, vcc, 1
v_mfma_f32_16x16x32_bf16 v[204:207], a[232:235], a[248:251], v[204:207]
ds_read_b64_tr_b16 v[54:55], v78 offset:8192
v_mfma_f32_16x16x32_bf16 v[204:207], a[236:239], a[252:255], v[204:207]
ds_read_b64_tr_b16 v[56:57], v78 offset:8704
v_mfma_f32_16x16x32_bf16 v[196:199], a[236:239], a[244:247], v[196:199]
v_add_f32_e64 v40, v40, v43
v_mfma_f32_16x16x32_bf16 v[196:199], a[232:235], a[240:243], v[196:199]
buffer_load_dwordx4 v1, s[4:7], s79 offen lds
v_mfma_f32_16x16x32_bf16 v[188:191], a[232:235], v[66:69], v[188:191]
s_add_u32 m0, s76, 40960
s_add_u32 s79, s36, 131072
ds_read_b128 a[164:167], v7 offset:0
v_mfma_f32_16x16x32_bf16 v[188:191], a[236:239], v[70:73], v[188:191]
v_cndmask_b32 v44, v44, v39, vcc
v_mfma_f32_16x16x32_bf16 v[180:183], a[236:239], v[62:65], v[180:183]
s_nop 0
v_add_f32_dpp v44, v44, v44 quad_perm:[1,0,3,2] row_mask:0xf bank_mask:0xf
v_mfma_f32_16x16x32_bf16 v[180:183], a[232:235], v[58:61], v[180:183]
s_waitcnt lgkmcnt(6)
v_mfma_f32_16x16x32_bf16 v[84:87], a[224:227], v[58:61], v[84:87]
s_waitcnt lgkmcnt(4)
ds_read_b64_tr_b16 a[232:233], v13 offset:24576
v_add_f32_dpp v44, v44, v44 quad_perm:[2,3,0,1] row_mask:0xf bank_mask:0xf
v_mfma_f32_16x16x32_bf16 v[84:87], a[228:231], v[62:65], v[84:87]
ds_read_b64_tr_b16 a[234:235], v13 offset:24832
v_mfma_f32_16x16x32_bf16 v[100:103], a[228:231], v[70:73], v[100:103]
buffer_load_dwordx4 v1, s[4:7], s79 offen lds
v_mfma_f32_16x16x32_bf16 v[100:103], a[224:227], v[66:69], v[100:103]
s_add_u32 m0, s76, 45056
s_add_u32 s79, s36, 196608
ds_read_b64_tr_b16 a[236:237], v13 offset:28672
v_mfma_f32_16x16x32_bf16 v[244:247], a[224:227], a[240:243], v[244:247]
ds_read_b64_tr_b16 a[238:239], v13 offset:28928
v_add_f32_dpp v44, v44, v44 row_half_mirror row_mask:0xf bank_mask:0xf
v_mfma_f32_16x16x32_bf16 v[244:247], a[228:231], a[244:247], v[244:247]
ds_read_b128 a[172:175], v7 offset:2048
v_add_f32_dpp v44, v44, v44 row_mirror row_mask:0xf bank_mask:0xf
v_mfma_f32_16x16x32_bf16 v[116:119], a[228:231], a[252:255], v[116:119]
s_nop 0
v_permlane16_swap_b32 v40, v44
v_mfma_f32_16x16x32_bf16 v[116:119], a[224:227], a[248:251], v[116:119]
v_mfma_f32_16x16x32_bf16 v[132:135], a[224:227], a[192:195], v[132:135]
v_add_f32_e64 v40, v40, v44
v_mfma_f32_16x16x32_bf16 v[132:135], a[228:231], a[196:199], v[132:135]
buffer_load_dwordx4 v1, s[4:7], s79 offen lds
v_mfma_f32_16x16x32_bf16 a[4:7], a[228:231], a[204:207], a[4:7]
s_add_u32 m0, s76, 49152
s_add_u32 s79, s36, 262144
ds_read_b128 a[168:171], v6 offset:2048
v_mfma_f32_16x16x32_bf16 a[4:7], a[224:227], a[200:203], a[4:7]
v_mul_f32 v40, 0x3a800000, v40
v_mfma_f32_16x16x32_bf16 a[20:23], a[224:227], a[208:211], a[20:23]
v_mov_b32_e64 v44, v40
v_mfma_f32_16x16x32_bf16 a[20:23], a[228:231], a[212:215], a[20:23]
v_mfma_f32_16x16x32_bf16 a[36:39], a[228:231], a[220:223], a[36:39]
v_permlane16_swap_b32 v40, v44
v_mfma_f32_16x16x32_bf16 a[36:39], a[224:227], a[216:219], a[36:39]
s_waitcnt lgkmcnt(4)
v_mfma_f32_16x16x32_bf16 a[44:47], a[232:235], a[216:219], a[44:47]
s_waitcnt lgkmcnt(2)
buffer_load_dwordx4 v1, s[4:7], s79 offen lds
v_mfma_f32_16x16x32_bf16 a[44:47], a[236:239], a[220:223], a[44:47]
s_add_u32 m0, s76, 53248
s_add_u32 s79, s36, 327680
ds_read_b64_tr_b16 a[224:225], v12 offset:25088
v_mfma_f32_16x16x32_bf16 a[28:31], a[236:239], a[212:215], a[28:31]
ds_read_b64_tr_b16 a[226:227], v12 offset:25344
v_fma_f32 v44, -v40, v40, v44
v_mfma_f32_16x16x32_bf16 a[28:31], a[232:235], a[208:211], a[28:31]
ds_read_b64_tr_b16 a[228:229], v12 offset:29184
v_cvt_pk_bf16_f32 v74, v40, v40
v_mfma_f32_16x16x32_bf16 a[12:15], a[232:235], a[200:203], a[12:15]
ds_read_b64_tr_b16 a[230:231], v12 offset:29440
v_max_f32 v44, 0, v44
v_mfma_f32_16x16x32_bf16 a[12:15], a[236:239], a[204:207], a[12:15]
ds_read_b128 a[176:179], v6 offset:4096
v_mfma_f32_16x16x32_bf16 v[140:143], a[236:239], a[196:199], v[140:143]
v_xor_b32 v74, 0x80008000, v74
v_mfma_f32_16x16x32_bf16 v[140:143], a[232:235], a[192:195], v[140:143]
buffer_load_dwordx4 v1, s[4:7], s79 offen lds
v_mfma_f32_16x16x32_bf16 v[124:127], a[232:235], a[248:251], v[124:127]
s_add_u32 m0, s76, 57344
s_add_u32 s79, s36, 393216
ds_read_b128 a[180:183], v7 offset:4096
v_mfma_f32_16x16x32_bf16 v[124:127], a[236:239], a[252:255], v[124:127]
buffer_store_dwordx4 v[54:57], v79, s[64:67], s69 offen sc1
v_mfma_f32_16x16x32_bf16 v[252:255], a[236:239], a[244:247], v[252:255]
v_cvt_pk_bf16_f32 v44, v44, v44
s_add_u32 s69, s69, 0x100000
v_mfma_f32_16x16x32_bf16 v[252:255], a[232:235], a[240:243], v[252:255]
v_and_b32_e64 v44, s54, v44
v_mfma_f32_16x16x32_bf16 v[108:111], a[232:235], v[66:69], v[108:111]
v_add_f32 v44, 0x3727c5ac, v44
v_mfma_f32_16x16x32_bf16 v[108:111], a[236:239], v[70:73], v[108:111]
v_mfma_f32_16x16x32_bf16 v[92:95], a[236:239], v[62:65], v[92:95]
buffer_load_dwordx4 v1, s[4:7], s79 offen lds
v_mfma_f32_16x16x32_bf16 v[92:95], a[232:235], v[58:61], v[92:95]
s_waitcnt lgkmcnt(4)
s_add_u32 m0, s76, 61440
ds_read_b128 a[188:191], v7 offset:6144
v_mfma_f32_16x16x32_bf16 a[52:55], a[224:227], v[58:61], a[52:55]
s_waitcnt lgkmcnt(3)
s_add_u32 s79, s36, 458752
ds_read_b64_tr_b16 a[232:233], v13 offset:25088
v_mfma_f32_16x16x32_bf16 a[52:55], a[228:231], v[62:65], a[52:55]
ds_read_b64_tr_b16 a[234:235], v13 offset:25344
v_cvt_pk_bf16_f32 v44, v44, v44
v_mfma_f32_16x16x32_bf16 a[68:71], a[228:231], v[70:73], a[68:71]
ds_read_b64_tr_b16 a[236:237], v13 offset:29184
v_and_b32_e64 v44, s54, v44
v_mfma_f32_16x16x32_bf16 a[68:71], a[224:227], v[66:69], a[68:71]
ds_read_b64_tr_b16 a[238:239], v13 offset:29440
v_mfma_f32_16x16x32_bf16 a[84:87], a[224:227], a[240:243], a[84:87]
v_sqrt_f32_e64 v44, v44
v_mfma_f32_16x16x32_bf16 a[84:87], a[228:231], a[244:247], a[84:87]
buffer_load_dwordx4 v1, s[4:7], s79 offen lds
v_mfma_f32_16x16x32_bf16 a[100:103], a[228:231], a[252:255], a[100:103]
s_lshl1_add_u32 s36, s78, s36
s_add_u32 m0, s76, 106496
ds_read_b128 a[184:187], v6 offset:6144
v_mfma_f32_16x16x32_bf16 a[100:103], a[224:227], a[248:251], a[100:103]
v_cvt_pk_bf16_f32 v44, v44, v44
v_mfma_f32_16x16x32_bf16 a[116:119], a[224:227], a[192:195], a[116:119]
v_and_b32 v75, s54, v44
v_mfma_f32_16x16x32_bf16 a[116:119], a[228:231], a[196:199], a[116:119]
buffer_store_dwordx2 v[74:75], v76, s[24:27], s41 offen sc1
v_mfma_f32_16x16x32_bf16 a[132:135], a[228:231], a[204:207], a[132:135]
v_mfma_f32_16x16x32_bf16 a[132:135], a[224:227], a[200:203], a[132:135]
v_mov_b32 v16, 162368
v_mfma_f32_16x16x32_bf16 v[148:151], a[224:227], a[208:211], v[148:151]
buffer_load_dwordx4 v2, s[8:11], s38 offen lds
v_mfma_f32_16x16x32_bf16 v[148:151], a[228:231], a[212:215], v[148:151]
s_add_u32 m0, s76, 114560
v_mfma_f32_16x16x32_bf16 v[164:167], a[228:231], a[220:223], v[164:167]
v_min_u32_e64 v17, 7, v0
v_mfma_f32_16x16x32_bf16 v[164:167], a[224:227], a[216:219], v[164:167]
s_waitcnt vmcnt(13) lgkmcnt(1)
s_barrier
v_mfma_f32_16x16x32_bf16 v[172:175], a[232:235], a[216:219], v[172:175]
ds_read_b64_tr_b16 a[224:225], v10 offset:0
v_mfma_f32_16x16x32_bf16 v[172:175], a[236:239], a[220:223], v[172:175]
ds_read_b64_tr_b16 a[226:227], v10 offset:256
v_lshl_add_u32 v17, v17, 2, v16
v_mfma_f32_16x16x32_bf16 v[156:159], a[236:239], a[212:215], v[156:159]
ds_read_b64_tr_b16 a[228:229], v10 offset:4096
v_mfma_f32_16x16x32_bf16 v[156:159], a[232:235], a[208:211], v[156:159]
buffer_load_dwordx4 v2, s[8:11], s38 offen offset:128 lds
v_mfma_f32_16x16x32_bf16 a[140:143], a[232:235], a[200:203], a[140:143]
s_add_u32 m0, s76, 122880
ds_read_b64_tr_b16 a[230:231], v10 offset:4352
v_mfma_f32_16x16x32_bf16 a[140:143], a[236:239], a[204:207], a[140:143]
v_mfma_f32_16x16x32_bf16 a[124:127], a[236:239], a[196:199], a[124:127]
v_mfma_f32_16x16x32_bf16 a[124:127], a[232:235], a[192:195], a[124:127]
ds_read_b128 a[192:195], v6 offset:8192
v_mfma_f32_16x16x32_bf16 a[108:111], a[232:235], a[248:251], a[108:111]
ds_read_b128 a[196:199], v7 offset:8192
v_mfma_f32_16x16x32_bf16 a[108:111], a[236:239], a[252:255], a[108:111]
ds_read_b128 a[204:207], v7 offset:10240
v_mfma_f32_16x16x32_bf16 a[92:95], a[236:239], a[244:247], a[92:95]
buffer_load_dwordx4 v3, s[16:19], s39 offen lds
v_mfma_f32_16x16x32_bf16 a[92:95], a[232:235], a[240:243], a[92:95]
s_add_u32 m0, s76, 110592
s_add_u32 s79, s38, 229376
ds_read_b128 a[200:203], v6 offset:10240
v_mfma_f32_16x16x32_bf16 a[76:79], a[232:235], v[66:69], a[76:79]
ds_read_b128 a[208:211], v6 offset:12288
v_mfma_f32_16x16x32_bf16 a[76:79], a[236:239], v[70:73], a[76:79]
ds_read_b128 a[212:215], v7 offset:12288
v_mfma_f32_16x16x32_bf16 a[60:63], a[236:239], v[62:65], a[60:63]
v_mfma_f32_16x16x32_bf16 a[60:63], a[232:235], v[58:61], a[60:63]
s_waitcnt lgkmcnt(8)
L_g1_loop_1042:
v_mfma_f32_16x16x32_bf16 v[80:83], a[224:227], a[160:163], v[80:83]
s_waitcnt lgkmcnt(6)
ds_read_b128 a[220:223], v7 offset:14336
v_mfma_f32_16x16x32_bf16 v[80:83], a[228:231], a[164:167], v[80:83]
buffer_load_dwordx4 v2, s[8:11], s79 offen lds
v_mfma_f32_16x16x32_bf16 v[96:99], a[228:231], a[172:175], v[96:99]
s_add_u32 m0, s76, 118656
ds_read_b128 a[216:219], v6 offset:14336
v_mfma_f32_16x16x32_bf16 v[96:99], a[224:227], a[168:171], v[96:99]
ds_read_b64_tr_b16 a[232:233], v11 offset:0
v_mfma_f32_16x16x32_bf16 v[240:243], a[224:227], a[176:179], v[240:243]
ds_read_b64_tr_b16 a[234:235], v11 offset:256
v_mfma_f32_16x16x32_bf16 v[240:243], a[228:231], a[180:183], v[240:243]
ds_read_b64_tr_b16 a[236:237], v11 offset:4096
v_mfma_f32_16x16x32_bf16 v[112:115], a[228:231], a[188:191], v[112:115]
ds_read_b64_tr_b16 a[238:239], v11 offset:4352
v_mfma_f32_16x16x32_bf16 v[112:115], a[224:227], a[184:187], v[112:115]
s_waitcnt lgkmcnt(11)
v_mfma_f32_16x16x32_bf16 v[128:131], a[224:227], a[192:195], v[128:131]
s_waitcnt lgkmcnt(10)
buffer_load_dwordx4 v2, s[8:11], s79 offen offset:128 lds
v_mfma_f32_16x16x32_bf16 v[128:131], a[228:231], a[196:199], v[128:131]
s_waitcnt lgkmcnt(9)
s_add_u32 m0, s76, 126976
s_add_u32 s79, s39, 229376
v_mfma_f32_16x16x32_bf16 a[0:3], a[228:231], a[204:207], a[0:3]
s_waitcnt lgkmcnt(8)
v_mfma_f32_16x16x32_bf16 a[0:3], a[224:227], a[200:203], a[0:3]
s_waitcnt lgkmcnt(7)
v_mfma_f32_16x16x32_bf16 a[16:19], a[224:227], a[208:211], a[16:19]
s_waitcnt lgkmcnt(6)
v_mfma_f32_16x16x32_bf16 a[16:19], a[228:231], a[212:215], a[16:19]
s_waitcnt lgkmcnt(5)
v_mfma_f32_16x16x32_bf16 a[32:35], a[228:231], a[220:223], a[32:35]
s_waitcnt lgkmcnt(4)
v_mfma_f32_16x16x32_bf16 a[32:35], a[224:227], a[216:219], a[32:35]
s_waitcnt lgkmcnt(2)
buffer_load_dwordx4 v3, s[16:19], s79 offen lds
v_mfma_f32_16x16x32_bf16 a[40:43], a[232:235], a[216:219], a[40:43]
s_waitcnt lgkmcnt(0)
s_mul_i32 s55, s78, 7168
ds_read_b64_tr_b16 a[224:225], v10 offset:512
v_mfma_f32_16x16x32_bf16 a[40:43], a[236:239], a[220:223], a[40:43]
s_add_u32 s39, s39, s55
s_add_u32 m0, s76, 131072
ds_read_b64_tr_b16 a[226:227], v10 offset:768
v_mfma_f32_16x16x32_bf16 a[24:27], a[236:239], a[212:215], a[24:27]
ds_read_b64_tr_b16 a[228:229], v10 offset:4608
v_mfma_f32_16x16x32_bf16 a[24:27], a[232:235], a[208:211], a[24:27]
ds_read_b64_tr_b16 a[230:231], v10 offset:4864
v_mfma_f32_16x16x32_bf16 a[8:11], a[232:235], a[200:203], a[8:11]
v_mfma_f32_16x16x32_bf16 a[8:11], a[236:239], a[204:207], a[8:11]
v_mfma_f32_16x16x32_bf16 v[136:139], a[236:239], a[196:199], v[136:139]
buffer_load_dwordx4 v2, s[12:15], s38 offen lds
v_mfma_f32_16x16x32_bf16 v[136:139], a[232:235], a[192:195], v[136:139]
s_add_u32 m0, s76, 139136
ds_read_b64_tr_b16 a[148:149], v8 offset:0
v_mfma_f32_16x16x32_bf16 v[120:123], a[232:235], a[184:187], v[120:123]
ds_read_b64_tr_b16 a[150:151], v8 offset:256
v_mfma_f32_16x16x32_bf16 v[120:123], a[236:239], a[188:191], v[120:123]
v_mfma_f32_16x16x32_bf16 v[248:251], a[236:239], a[180:183], v[248:251]
v_mfma_f32_16x16x32_bf16 v[248:251], a[232:235], a[176:179], v[248:251]
v_mfma_f32_16x16x32_bf16 v[104:107], a[232:235], a[168:171], v[104:107]
v_mfma_f32_16x16x32_bf16 v[104:107], a[236:239], a[172:175], v[104:107]
buffer_load_dwordx4 v2, s[12:15], s38 offen offset:128 lds
v_mfma_f32_16x16x32_bf16 v[88:91], a[236:239], a[164:167], v[88:91]
s_add_u32 m0, s76, 135168
s_add_u32 s79, s38, 229376
v_mfma_f32_16x16x32_bf16 v[88:91], a[232:235], a[160:163], v[88:91]
s_waitcnt lgkmcnt(4)
v_mfma_f32_16x16x32_bf16 a[48:51], a[224:227], a[160:163], a[48:51]
s_waitcnt lgkmcnt(2)
ds_read_b64_tr_b16 a[232:233], v11 offset:512
v_mfma_f32_16x16x32_bf16 a[48:51], a[228:231], a[164:167], a[48:51]
ds_read_b64_tr_b16 a[234:235], v11 offset:768
v_mfma_f32_16x16x32_bf16 a[64:67], a[228:231], a[172:175], a[64:67]
ds_read_b64_tr_b16 a[236:237], v11 offset:4608
v_mfma_f32_16x16x32_bf16 a[64:67], a[224:227], a[168:171], a[64:67]
ds_read_b64_tr_b16 a[238:239], v11 offset:4864
v_mfma_f32_16x16x32_bf16 a[80:83], a[224:227], a[176:179], a[80:83]
buffer_load_dwordx4 v2, s[12:15], s79 offen lds
v_mfma_f32_16x16x32_bf16 a[80:83], a[228:231], a[180:183], a[80:83]
s_add_u32 m0, s76, 143232
v_mfma_f32_16x16x32_bf16 a[96:99], a[228:231], a[188:191], a[96:99]
v_mfma_f32_16x16x32_bf16 a[96:99], a[224:227], a[184:187], a[96:99]
s_waitcnt lgkmcnt(4)
v_mfma_f32_16x16x32_bf16 a[144:147], a[152:155], a[148:151], a[144:147]
v_mfma_f32_16x16x32_bf16 a[112:115], a[224:227], a[192:195], a[112:115]
v_mfma_f32_16x16x32_bf16 a[112:115], a[228:231], a[196:199], a[112:115]
v_mfma_f32_16x16x32_bf16 a[128:131], a[228:231], a[204:207], a[128:131]
buffer_load_dwordx4 v2, s[12:15], s79 offen offset:128 lds
v_mfma_f32_16x16x32_bf16 a[128:131], a[224:227], a[200:203], a[128:131]
s_mul_i32 s55, s78, 7168
s_add_u32 s38, s38, s55
v_mfma_f32_16x16x32_bf16 v[144:147], a[224:227], a[208:211], v[144:147]
s_cmp_ge_u32 s47, 6291456
s_cselect_b32 s78, 6291456, 0
s_sub_u32 s47, s47, s78
v_mfma_f32_16x16x32_bf16 v[144:147], a[228:231], a[212:215], v[144:147]
s_cmp_lt_u32 s46, 2
s_cselect_b32 s34, 0, s34
v_mfma_f32_16x16x32_bf16 v[160:163], a[228:231], a[220:223], v[160:163]
v_mfma_f32_16x16x32_bf16 v[160:163], a[224:227], a[216:219], v[160:163]
s_waitcnt lgkmcnt(2)
v_mfma_f32_16x16x32_bf16 v[168:171], a[232:235], a[216:219], v[168:171]
s_waitcnt lgkmcnt(0)
ds_read_b64_tr_b16 a[224:225], v14 offset:0
v_mfma_f32_16x16x32_bf16 v[168:171], a[236:239], a[220:223], v[168:171]
buffer_load_dword v19, v18, s[32:35], s47 offen
v_mfma_f32_16x16x32_bf16 v[152:155], a[236:239], a[212:215], v[152:155]
s_add_u32 s47, s47, 786432
ds_read_b64_tr_b16 a[226:227], v14 offset:256
v_mfma_f32_16x16x32_bf16 v[152:155], a[232:235], a[208:211], v[152:155]
ds_read_b64_tr_b16 a[228:229], v14 offset:4096
v_mfma_f32_16x16x32_bf16 a[136:139], a[232:235], a[200:203], a[136:139]
ds_read_b64_tr_b16 a[230:231], v14 offset:4352
v_mfma_f32_16x16x32_bf16 a[136:139], a[236:239], a[204:207], a[136:139]
v_mfma_f32_16x16x32_bf16 a[120:123], a[236:239], a[196:199], a[120:123]
v_mfma_f32_16x16x32_bf16 a[120:123], a[232:235], a[192:195], a[120:123]
v_mfma_f32_16x16x32_bf16 a[104:107], a[232:235], a[184:187], a[104:107]
v_mfma_f32_16x16x32_bf16 a[104:107], a[236:239], a[188:191], a[104:107]
v_mfma_f32_16x16x32_bf16 a[88:91], a[236:239], a[180:183], a[88:91]
v_mfma_f32_16x16x32_bf16 a[88:91], a[232:235], a[176:179], a[88:91]
v_mfma_f32_16x16x32_bf16 a[72:75], a[232:235], a[168:171], a[72:75]
v_mfma_f32_16x16x32_bf16 a[72:75], a[236:239], a[172:175], a[72:75]
v_mfma_f32_16x16x32_bf16 a[56:59], a[236:239], a[164:167], a[56:59]
v_mfma_f32_16x16x32_bf16 a[56:59], a[232:235], a[160:163], a[56:59]
s_waitcnt lgkmcnt(2)
v_mfma_f32_16x16x32_bf16 v[176:179], a[224:227], a[160:163], v[176:179]
s_waitcnt lgkmcnt(0)
ds_read_b64_tr_b16 a[232:233], v14 offset:2048
v_mfma_f32_16x16x32_bf16 v[176:179], a[228:231], a[164:167], v[176:179]
ds_read_b64_tr_b16 a[234:235], v14 offset:2304
v_mfma_f32_16x16x32_bf16 v[184:187], a[228:231], a[172:175], v[184:187]
ds_read_b64_tr_b16 a[236:237], v14 offset:6144
v_mfma_f32_16x16x32_bf16 v[184:187], a[224:227], a[168:171], v[184:187]
ds_read_b64_tr_b16 a[238:239], v14 offset:6400
v_mfma_f32_16x16x32_bf16 v[192:195], a[224:227], a[176:179], v[192:195]
v_mfma_f32_16x16x32_bf16 v[192:195], a[228:231], a[180:183], v[192:195]
v_mfma_f32_16x16x32_bf16 v[200:203], a[228:231], a[188:191], v[200:203]
v_mfma_f32_16x16x32_bf16 v[200:203], a[224:227], a[184:187], v[200:203]
v_mfma_f32_16x16x32_bf16 v[208:211], a[224:227], a[192:195], v[208:211]
v_mfma_f32_16x16x32_bf16 v[208:211], a[228:231], a[196:199], v[208:211]
v_mfma_f32_16x16x32_bf16 v[216:219], a[228:231], a[204:207], v[216:219]
v_mfma_f32_16x16x32_bf16 v[216:219], a[224:227], a[200:203], v[216:219]
v_mfma_f32_16x16x32_bf16 v[224:227], a[224:227], a[208:211], v[224:227]
v_mfma_f32_16x16x32_bf16 v[224:227], a[228:231], a[212:215], v[224:227]
v_mfma_f32_16x16x32_bf16 v[232:235], a[228:231], a[220:223], v[232:235]
v_mfma_f32_16x16x32_bf16 v[232:235], a[224:227], a[216:219], v[232:235]
s_waitcnt vmcnt(11) lgkmcnt(0)
s_barrier
v_mfma_f32_16x16x32_bf16 v[236:239], a[232:235], a[216:219], v[236:239]
s_add_u32 m0, s76, 0
s_add_u32 s79, s36, 0
ds_read_b64_tr_b16 a[224:225], v10 offset:24576
v_mfma_f32_16x16x32_bf16 v[236:239], a[236:239], a[220:223], v[236:239]
ds_read_b64_tr_b16 a[226:227], v10 offset:24832
v_mfma_f32_16x16x32_bf16 v[228:231], a[236:239], a[212:215], v[228:231]
ds_read_b64_tr_b16 a[228:229], v10 offset:28672
v_mfma_f32_16x16x32_bf16 v[228:231], a[232:235], a[208:211], v[228:231]
ds_read_b64_tr_b16 a[230:231], v10 offset:28928
v_mfma_f32_16x16x32_bf16 v[220:223], a[232:235], a[200:203], v[220:223]
buffer_load_dwordx4 v1, s[4:7], s79 offen lds
v_mfma_f32_16x16x32_bf16 v[220:223], a[236:239], a[204:207], v[220:223]
s_add_u32 m0, s76, 4096
s_add_u32 s79, s36, 65536
ds_read_b128 v[58:61], v6 offset:32768
v_mfma_f32_16x16x32_bf16 v[212:215], a[236:239], a[196:199], v[212:215]
v_mfma_f32_16x16x32_bf16 v[212:215], a[232:235], a[192:195], v[212:215]
v_mfma_f32_16x16x32_bf16 v[204:207], a[232:235], a[184:187], v[204:207]
ds_read_b64_tr_b16 v[46:47], v78 offset:0
v_mfma_f32_16x16x32_bf16 v[204:207], a[236:239], a[188:191], v[204:207]
ds_read_b64_tr_b16 v[48:49], v78 offset:512
v_mfma_f32_16x16x32_bf16 v[196:199], a[236:239], a[180:183], v[196:199]
v_mfma_f32_16x16x32_bf16 v[196:199], a[232:235], a[176:179], v[196:199]
buffer_load_dwordx4 v1, s[4:7], s79 offen lds
v_mfma_f32_16x16x32_bf16 v[188:191], a[232:235], a[168:171], v[188:191]
s_sub_u32 s46, s46, 1
s_add_u32 m0, s76, 8192
ds_read_b128 v[62:65], v7 offset:32768
v_mfma_f32_16x16x32_bf16 v[188:191], a[236:239], a[172:175], v[188:191]
s_add_u32 s79, s36, 131072
v_mfma_f32_16x16x32_bf16 v[180:183], a[236:239], a[164:167], v[180:183]
v_mfma_f32_16x16x32_bf16 v[180:183], a[232:235], a[160:163], v[180:183]
s_waitcnt lgkmcnt(6)
v_mfma_f32_16x16x32_bf16 v[84:87], a[224:227], a[160:163], v[84:87]
s_waitcnt lgkmcnt(4)
ds_read_b64_tr_b16 a[232:233], v11 offset:24576
v_mfma_f32_16x16x32_bf16 v[84:87], a[228:231], a[164:167], v[84:87]
ds_read_b64_tr_b16 a[234:235], v11 offset:24832
v_mfma_f32_16x16x32_bf16 v[100:103], a[228:231], a[172:175], v[100:103]
buffer_load_dwordx4 v1, s[4:7], s79 offen lds
v_mfma_f32_16x16x32_bf16 v[100:103], a[224:227], a[168:171], v[100:103]
s_add_u32 m0, s76, 12288
s_add_u32 s79, s36, 196608
ds_read_b64_tr_b16 a[236:237], v11 offset:28672
v_mfma_f32_16x16x32_bf16 v[244:247], a[224:227], a[176:179], v[244:247]
ds_read_b64_tr_b16 a[238:239], v11 offset:28928
v_mfma_f32_16x16x32_bf16 v[244:247], a[228:231], a[180:183], v[244:247]
ds_read_b128 v[70:73], v7 offset:34816
v_mfma_f32_16x16x32_bf16 v[116:119], a[228:231], a[188:191], v[116:119]
v_mfma_f32_16x16x32_bf16 v[116:119], a[224:227], a[184:187], v[116:119]
v_mfma_f32_16x16x32_bf16 v[132:135], a[224:227], a[192:195], v[132:135]
ds_read_b64_tr_b16 v[50:51], v78 offset:4096
v_mfma_f32_16x16x32_bf16 v[132:135], a[228:231], a[196:199], v[132:135]
buffer_load_dwordx4 v1, s[4:7], s79 offen lds
v_mfma_f32_16x16x32_bf16 a[4:7], a[228:231], a[204:207], a[4:7]
s_add_u32 m0, s76, 16384
s_add_u32 s79, s36, 262144
ds_read_b64_tr_b16 v[52:53], v78 offset:4608
v_mfma_f32_16x16x32_bf16 a[4:7], a[224:227], a[200:203], a[4:7]
ds_read_b128 v[66:69], v6 offset:34816
v_mfma_f32_16x16x32_bf16 a[20:23], a[224:227], a[208:211], a[20:23]
v_mfma_f32_16x16x32_bf16 a[20:23], a[228:231], a[212:215], a[20:23]
v_mfma_f32_16x16x32_bf16 a[36:39], a[228:231], a[220:223], a[36:39]
v_mfma_f32_16x16x32_bf16 a[36:39], a[224:227], a[216:219], a[36:39]
s_waitcnt lgkmcnt(6)
v_mfma_f32_16x16x32_bf16 a[44:47], a[232:235], a[216:219], a[44:47]
s_waitcnt lgkmcnt(4)
buffer_load_dwordx4 v1, s[4:7], s79 offen lds
v_mfma_f32_16x16x32_bf16 a[44:47], a[236:239], a[220:223], a[44:47]
s_add_u32 m0, s76, 20480
s_add_u32 s79, s36, 327680
ds_read_b64_tr_b16 a[224:225], v10 offset:25088
v_mfma_f32_16x16x32_bf16 a[28:31], a[236:239], a[212:215], a[28:31]
ds_read_b64_tr_b16 a[226:227], v10 offset:25344
v_mfma_f32_16x16x32_bf16 a[28:31], a[232:235], a[208:211], a[28:31]
ds_read_b64_tr_b16 a[228:229], v10 offset:29184
v_mfma_f32_16x16x32_bf16 a[12:15], a[232:235], a[200:203], a[12:15]
ds_read_b64_tr_b16 a[230:231], v10 offset:29440
v_mfma_f32_16x16x32_bf16 a[12:15], a[236:239], a[204:207], a[12:15]
ds_read_b128 a[240:243], v6 offset:36864
v_mfma_f32_16x16x32_bf16 v[140:143], a[236:239], a[196:199], v[140:143]
v_mfma_f32_16x16x32_bf16 v[140:143], a[232:235], a[192:195], v[140:143]
buffer_load_dwordx4 v1, s[4:7], s79 offen lds
v_mfma_f32_16x16x32_bf16 v[124:127], a[232:235], a[184:187], v[124:127]
s_add_u32 m0, s76, 24576
s_add_u32 s79, s36, 393216
ds_read_b128 a[244:247], v7 offset:36864
v_mfma_f32_16x16x32_bf16 v[124:127], a[236:239], a[188:191], v[124:127]
v_mfma_f32_16x16x32_bf16 v[252:255], a[236:239], a[180:183], v[252:255]
v_mfma_f32_16x16x32_bf16 v[252:255], a[232:235], a[176:179], v[252:255]
v_mfma_f32_16x16x32_bf16 v[108:111], a[232:235], a[168:171], v[108:111]
v_mfma_f32_16x16x32_bf16 v[108:111], a[236:239], a[172:175], v[108:111]
v_mfma_f32_16x16x32_bf16 v[92:95], a[236:239], a[164:167], v[92:95]
buffer_load_dwordx4 v1, s[4:7], s79 offen lds
v_mfma_f32_16x16x32_bf16 v[92:95], a[232:235], a[160:163], v[92:95]
s_waitcnt lgkmcnt(4)
s_add_u32 m0, s76, 28672
ds_read_b128 a[252:255], v7 offset:38912
v_mfma_f32_16x16x32_bf16 a[52:55], a[224:227], a[160:163], a[52:55]
s_waitcnt lgkmcnt(3)
s_add_u32 s79, s36, 458752
ds_read_b64_tr_b16 a[232:233], v11 offset:25088
v_mfma_f32_16x16x32_bf16 a[52:55], a[228:231], a[164:167], a[52:55]
ds_read_b64_tr_b16 a[234:235], v11 offset:25344
v_mfma_f32_16x16x32_bf16 a[68:71], a[228:231], a[172:175], a[68:71]
ds_read_b64_tr_b16 a[236:237], v11 offset:29184
v_mfma_f32_16x16x32_bf16 a[68:71], a[224:227], a[168:171], a[68:71]
ds_read_b64_tr_b16 a[238:239], v11 offset:29440
v_mfma_f32_16x16x32_bf16 a[84:87], a[224:227], a[176:179], a[84:87]
v_mfma_f32_16x16x32_bf16 a[84:87], a[228:231], a[180:183], a[84:87]
buffer_load_dwordx4 v1, s[4:7], s79 offen lds
v_mfma_f32_16x16x32_bf16 a[100:103], a[228:231], a[188:191], a[100:103]
s_add_u32 s36, s36, 128
s_add_u32 m0, s76, 65536
ds_read_b128 a[248:251], v6 offset:38912
v_mfma_f32_16x16x32_bf16 a[100:103], a[224:227], a[184:187], a[100:103]
v_mfma_f32_16x16x32_bf16 a[116:119], a[224:227], a[192:195], a[116:119]
v_mfma_f32_16x16x32_bf16 a[116:119], a[228:231], a[196:199], a[116:119]
v_mfma_f32_16x16x32_bf16 a[132:135], a[228:231], a[204:207], a[132:135]
v_mfma_f32_16x16x32_bf16 a[132:135], a[224:227], a[200:203], a[132:135]
v_mfma_f32_16x16x32_bf16 v[148:151], a[224:227], a[208:211], v[148:151]
buffer_load_dwordx4 v2, s[8:11], s38 offen lds
v_mfma_f32_16x16x32_bf16 v[148:151], a[228:231], a[212:215], v[148:151]
s_add_u32 m0, s76, 73600
v_mfma_f32_16x16x32_bf16 v[164:167], a[228:231], a[220:223], v[164:167]
v_mfma_f32_16x16x32_bf16 v[164:167], a[224:227], a[216:219], v[164:167]
s_waitcnt vmcnt(10) lgkmcnt(1)
s_barrier
v_mfma_f32_16x16x32_bf16 v[172:175], a[232:235], a[216:219], v[172:175]
ds_read_b64_tr_b16 a[224:225], v12 offset:0
v_mfma_f32_16x16x32_bf16 v[172:175], a[236:239], a[220:223], v[172:175]
ds_read_b64_tr_b16 a[226:227], v12 offset:256
v_mfma_f32_16x16x32_bf16 v[156:159], a[236:239], a[212:215], v[156:159]
ds_read_b64_tr_b16 a[228:229], v12 offset:4096
v_mfma_f32_16x16x32_bf16 v[156:159], a[232:235], a[208:211], v[156:159]
buffer_load_dwordx4 v2, s[8:11], s38 offen offset:128 lds
v_mfma_f32_16x16x32_bf16 a[140:143], a[232:235], a[200:203], a[140:143]
s_add_u32 m0, s76, 81920
ds_read_b64_tr_b16 a[230:231], v12 offset:4352
v_mfma_f32_16x16x32_bf16 a[140:143], a[236:239], a[204:207], a[140:143]
v_mfma_f32_16x16x32_bf16 a[124:127], a[236:239], a[196:199], a[124:127]
v_mfma_f32_16x16x32_bf16 a[124:127], a[232:235], a[192:195], a[124:127]
ds_read_b128 a[192:195], v6 offset:40960
v_mfma_f32_16x16x32_bf16 a[108:111], a[232:235], a[184:187], a[108:111]
ds_read_b128 a[196:199], v7 offset:40960
v_mfma_f32_16x16x32_bf16 a[108:111], a[236:239], a[188:191], a[108:111]
ds_read_b128 a[204:207], v7 offset:43008
v_mfma_f32_16x16x32_bf16 a[92:95], a[236:239], a[180:183], a[92:95]
buffer_load_dwordx4 v3, s[16:19], s39 offen lds
v_mfma_f32_16x16x32_bf16 a[92:95], a[232:235], a[176:179], a[92:95]
s_add_u32 m0, s76, 69632
s_add_u32 s79, s38, 229376
ds_read_b128 a[200:203], v6 offset:43008
v_mfma_f32_16x16x32_bf16 a[76:79], a[232:235], a[168:171], a[76:79]
ds_read_b128 a[208:211], v6 offset:45056
v_mfma_f32_16x16x32_bf16 a[76:79], a[236:239], a[172:175], a[76:79]
ds_read_b128 a[212:215], v7 offset:45056
v_mfma_f32_16x16x32_bf16 a[60:63], a[236:239], a[164:167], a[60:63]
v_mfma_f32_16x16x32_bf16 a[60:63], a[232:235], a[160:163], a[60:63]
s_waitcnt lgkmcnt(8)
v_mfma_f32_16x16x32_bf16 v[80:83], a[224:227], v[58:61], v[80:83]
s_waitcnt lgkmcnt(6)
ds_read_b128 a[220:223], v7 offset:47104
v_mfma_f32_16x16x32_bf16 v[80:83], a[228:231], v[62:65], v[80:83]
buffer_load_dwordx4 v2, s[8:11], s79 offen lds
v_mfma_f32_16x16x32_bf16 v[96:99], a[228:231], v[70:73], v[96:99]
s_add_u32 m0, s76, 77696
ds_read_b128 a[216:219], v6 offset:47104
v_mfma_f32_16x16x32_bf16 v[96:99], a[224:227], v[66:69], v[96:99]
ds_read_b64_tr_b16 a[232:233], v13 offset:0
v_mfma_f32_16x16x32_bf16 v[240:243], a[224:227], a[240:243], v[240:243]
ds_read_b64_tr_b16 a[234:235], v13 offset:256
v_mfma_f32_16x16x32_bf16 v[240:243], a[228:231], a[244:247], v[240:243]
ds_read_b64_tr_b16 a[236:237], v13 offset:4096
v_mfma_f32_16x16x32_bf16 v[112:115], a[228:231], a[252:255], v[112:115]
ds_read_b64_tr_b16 a[238:239], v13 offset:4352
v_mfma_f32_16x16x32_bf16 v[112:115], a[224:227], a[248:251], v[112:115]
s_waitcnt lgkmcnt(11)
v_mfma_f32_16x16x32_bf16 v[128:131], a[224:227], a[192:195], v[128:131]
s_waitcnt lgkmcnt(10)
buffer_load_dwordx4 v2, s[8:11], s79 offen offset:128 lds
v_mfma_f32_16x16x32_bf16 v[128:131], a[228:231], a[196:199], v[128:131]
s_waitcnt lgkmcnt(9)
s_add_u32 m0, s76, 86016
s_add_u32 s79, s39, 229376
v_mfma_f32_16x16x32_bf16 a[0:3], a[228:231], a[204:207], a[0:3]
s_waitcnt lgkmcnt(8)
v_mfma_f32_16x16x32_bf16 a[0:3], a[224:227], a[200:203], a[0:3]
s_waitcnt lgkmcnt(7)
v_mfma_f32_16x16x32_bf16 a[16:19], a[224:227], a[208:211], a[16:19]
s_waitcnt lgkmcnt(6)
v_mfma_f32_16x16x32_bf16 a[16:19], a[228:231], a[212:215], a[16:19]
s_waitcnt lgkmcnt(5)
v_mfma_f32_16x16x32_bf16 a[32:35], a[228:231], a[220:223], a[32:35]
s_waitcnt lgkmcnt(4)
v_mfma_f32_16x16x32_bf16 a[32:35], a[224:227], a[216:219], a[32:35]
s_waitcnt lgkmcnt(2)
buffer_load_dwordx4 v3, s[16:19], s79 offen lds
v_mfma_f32_16x16x32_bf16 a[40:43], a[232:235], a[216:219], a[40:43]
s_waitcnt lgkmcnt(0)
s_add_u32 s39, s39, 458752
ds_read_b64_tr_b16 a[224:225], v12 offset:512
v_mfma_f32_16x16x32_bf16 a[40:43], a[236:239], a[220:223], a[40:43]
s_add_u32 m0, s76, 90112
ds_read_b64_tr_b16 a[226:227], v12 offset:768
v_mfma_f32_16x16x32_bf16 a[24:27], a[236:239], a[212:215], a[24:27]
ds_read_b64_tr_b16 a[228:229], v12 offset:4608
v_mfma_f32_16x16x32_bf16 a[24:27], a[232:235], a[208:211], a[24:27]
ds_read_b64_tr_b16 a[230:231], v12 offset:4864
v_mfma_f32_16x16x32_bf16 a[8:11], a[232:235], a[200:203], a[8:11]
v_mfma_f32_16x16x32_bf16 a[8:11], a[236:239], a[204:207], a[8:11]
v_mfma_f32_16x16x32_bf16 v[136:139], a[236:239], a[196:199], v[136:139]
buffer_load_dwordx4 v2, s[12:15], s38 offen lds
v_mfma_f32_16x16x32_bf16 v[136:139], a[232:235], a[192:195], v[136:139]
s_add_u32 m0, s76, 98176
ds_read_b64_tr_b16 a[148:149], v8 offset:40960
v_mfma_f32_16x16x32_bf16 v[120:123], a[232:235], a[248:251], v[120:123]
ds_read_b64_tr_b16 a[150:151], v8 offset:41216
v_mfma_f32_16x16x32_bf16 v[120:123], a[236:239], a[252:255], v[120:123]
v_mfma_f32_16x16x32_bf16 v[248:251], a[236:239], a[244:247], v[248:251]
v_mfma_f32_16x16x32_bf16 v[248:251], a[232:235], a[240:243], v[248:251]
v_mfma_f32_16x16x32_bf16 v[104:107], a[232:235], v[66:69], v[104:107]
v_mfma_f32_16x16x32_bf16 v[104:107], a[236:239], v[70:73], v[104:107]
buffer_load_dwordx4 v2, s[12:15], s38 offen offset:128 lds
v_mfma_f32_16x16x32_bf16 v[88:91], a[236:239], v[62:65], v[88:91]
s_add_u32 m0, s76, 94208
s_add_u32 s79, s38, 229376
v_mfma_f32_16x16x32_bf16 v[88:91], a[232:235], v[58:61], v[88:91]
s_waitcnt lgkmcnt(4)
v_mfma_f32_16x16x32_bf16 a[48:51], a[224:227], v[58:61], a[48:51]
s_waitcnt lgkmcnt(2)
ds_read_b64_tr_b16 a[232:233], v13 offset:512
v_mfma_f32_16x16x32_bf16 a[48:51], a[228:231], v[62:65], a[48:51]
ds_read_b64_tr_b16 a[234:235], v13 offset:768
v_mfma_f32_16x16x32_bf16 a[64:67], a[228:231], v[70:73], a[64:67]
ds_read_b64_tr_b16 a[236:237], v13 offset:4608
v_mfma_f32_16x16x32_bf16 a[64:67], a[224:227], v[66:69], a[64:67]
ds_read_b64_tr_b16 a[238:239], v13 offset:4864
v_mfma_f32_16x16x32_bf16 a[80:83], a[224:227], a[240:243], a[80:83]
buffer_load_dwordx4 v2, s[12:15], s79 offen lds
v_mfma_f32_16x16x32_bf16 a[80:83], a[228:231], a[244:247], a[80:83]
s_add_u32 m0, s76, 102272
v_mfma_f32_16x16x32_bf16 a[96:99], a[228:231], a[252:255], a[96:99]
v_mfma_f32_16x16x32_bf16 a[96:99], a[224:227], a[248:251], a[96:99]
s_waitcnt lgkmcnt(4)
v_mfma_f32_16x16x32_bf16 a[144:147], a[152:155], a[148:151], a[144:147]
v_mfma_f32_16x16x32_bf16 a[112:115], a[224:227], a[192:195], a[112:115]
v_mfma_f32_16x16x32_bf16 a[112:115], a[228:231], a[196:199], a[112:115]
v_mfma_f32_16x16x32_bf16 a[128:131], a[228:231], a[204:207], a[128:131]
buffer_load_dwordx4 v2, s[12:15], s79 offen offset:128 lds
v_mfma_f32_16x16x32_bf16 a[128:131], a[224:227], a[200:203], a[128:131]
s_add_u32 s38, s38, 458752
s_add_u32 m0, s76, 147456
v_mfma_f32_16x16x32_bf16 v[144:147], a[224:227], a[208:211], v[144:147]
v_mfma_f32_16x16x32_bf16 v[144:147], a[228:231], a[212:215], v[144:147]
v_mfma_f32_16x16x32_bf16 v[160:163], a[228:231], a[220:223], v[160:163]
v_mfma_f32_16x16x32_bf16 v[160:163], a[224:227], a[216:219], v[160:163]
s_waitcnt lgkmcnt(2)
v_mfma_f32_16x16x32_bf16 v[168:171], a[232:235], a[216:219], v[168:171]
s_waitcnt lgkmcnt(0)
ds_read_b64_tr_b16 a[224:225], v14 offset:40960
v_mfma_f32_16x16x32_bf16 v[168:171], a[236:239], a[220:223], v[168:171]
buffer_load_dwordx4 v4, s[60:63], s68 offen nt lds
v_mfma_f32_16x16x32_bf16 v[152:155], a[236:239], a[212:215], v[152:155]
s_add_u32 s68, s68, 0x20000
ds_read_b64_tr_b16 a[226:227], v14 offset:41216
v_and_b32_e64 v76, 32, v0
v_mfma_f32_16x16x32_bf16 v[152:155], a[232:235], a[208:211], v[152:155]
s_lshl_b32 s79, s58, 14
ds_read_b64_tr_b16 a[228:229], v14 offset:45056
v_mfma_f32_16x16x32_bf16 a[136:139], a[232:235], a[200:203], a[136:139]
ds_read_b64_tr_b16 a[230:231], v14 offset:45312
v_mfma_f32_16x16x32_bf16 a[136:139], a[236:239], a[204:207], a[136:139]
s_cmp_eq_u32 s46, 4
s_cselect_b32 s79, s79, 0
s_cselect_b32 s78, -512, 0
v_mfma_f32_16x16x32_bf16 a[120:123], a[236:239], a[196:199], a[120:123]
s_add_u32 s79, s79, s68
v_mad_i32_i24 v76, v76, s78, v4
s_add_u32 m0, s76, 151552
v_mfma_f32_16x16x32_bf16 a[120:123], a[232:235], a[192:195], a[120:123]
v_mfma_f32_16x16x32_bf16 a[104:107], a[232:235], a[248:251], a[104:107]
buffer_load_dwordx4 v76, s[60:63], s79 offen nt lds
v_mfma_f32_16x16x32_bf16 a[104:107], a[236:239], a[252:255], a[104:107]
s_add_u32 s68, s68, 0x20000
v_mfma_f32_16x16x32_bf16 a[88:91], a[236:239], a[244:247], a[88:91]
v_mfma_f32_16x16x32_bf16 a[88:91], a[232:235], a[240:243], a[88:91]
v_mfma_f32_16x16x32_bf16 a[72:75], a[232:235], v[66:69], a[72:75]
v_mfma_f32_16x16x32_bf16 a[72:75], a[236:239], v[70:73], a[72:75]
v_mfma_f32_16x16x32_bf16 a[56:59], a[236:239], v[62:65], a[56:59]
v_mfma_f32_16x16x32_bf16 a[56:59], a[232:235], v[58:61], a[56:59]
s_waitcnt lgkmcnt(2)
buffer_store_dwordx4 v[46:49], v79, s[64:67], s69 offen sc1
v_mfma_f32_16x16x32_bf16 v[176:179], a[224:227], v[58:61], v[176:179]
s_waitcnt lgkmcnt(0)
s_add_u32 s69, s69, 0x100000
ds_read_b64_tr_b16 a[232:233], v14 offset:43008
v_mfma_f32_16x16x32_bf16 v[176:179], a[228:231], v[62:65], v[176:179]
ds_read_b64_tr_b16 a[234:235], v14 offset:43264
v_mfma_f32_16x16x32_bf16 v[184:187], a[228:231], v[70:73], v[184:187]
ds_read_b64_tr_b16 a[236:237], v14 offset:47104
v_mfma_f32_16x16x32_bf16 v[184:187], a[224:227], v[66:69], v[184:187]
ds_read_b64_tr_b16 a[238:239], v14 offset:47360
v_mfma_f32_16x16x32_bf16 v[192:195], a[224:227], a[240:243], v[192:195]
v_mfma_f32_16x16x32_bf16 v[192:195], a[228:231], a[244:247], v[192:195]
v_mfma_f32_16x16x32_bf16 v[200:203], a[228:231], a[252:255], v[200:203]
buffer_store_dwordx4 v[50:53], v79, s[64:67], s69 offen sc1
v_mfma_f32_16x16x32_bf16 v[200:203], a[224:227], a[248:251], v[200:203]
s_add_u32 s69, s69, 0x100000
v_mfma_f32_16x16x32_bf16 v[208:211], a[224:227], a[192:195], v[208:211]
v_mfma_f32_16x16x32_bf16 v[208:211], a[228:231], a[196:199], v[208:211]
v_mfma_f32_16x16x32_bf16 v[216:219], a[228:231], a[204:207], v[216:219]
v_mfma_f32_16x16x32_bf16 v[216:219], a[224:227], a[200:203], v[216:219]
v_mfma_f32_16x16x32_bf16 v[224:227], a[224:227], a[208:211], v[224:227]
v_mfma_f32_16x16x32_bf16 v[224:227], a[228:231], a[212:215], v[224:227]
v_mfma_f32_16x16x32_bf16 v[232:235], a[228:231], a[220:223], v[232:235]
v_mfma_f32_16x16x32_bf16 v[232:235], a[224:227], a[216:219], v[232:235]
s_waitcnt vmcnt(14) lgkmcnt(0)
s_barrier
v_mfma_f32_16x16x32_bf16 v[236:239], a[232:235], a[216:219], v[236:239]
s_sub_u32 s56, s56, 1
ds_read_b64_tr_b16 a[224:225], v12 offset:24576
v_mfma_f32_16x16x32_bf16 v[236:239], a[236:239], a[220:223], v[236:239]
s_cmp_eq_u32 s56, 0
s_cselect_b32 s78, -960, 64
ds_read_b64_tr_b16 a[226:227], v12 offset:24832
v_mfma_f32_16x16x32_bf16 v[228:231], a[236:239], a[212:215], v[228:231]
s_add_u32 m0, s76, 32768
s_add_u32 s79, s36, 0
ds_read_b64_tr_b16 a[228:229], v12 offset:28672
v_mfma_f32_16x16x32_bf16 v[228:231], a[232:235], a[208:211], v[228:231]
ds_read_b64_tr_b16 a[230:231], v12 offset:28928
v_mfma_f32_16x16x32_bf16 v[220:223], a[232:235], a[200:203], v[220:223]
buffer_load_dwordx4 v1, s[4:7], s79 offen lds
v_mfma_f32_16x16x32_bf16 v[220:223], a[236:239], a[204:207], v[220:223]
s_add_u32 m0, s76, 36864
s_add_u32 s79, s36, 65536
ds_read_b128 a[160:163], v6 offset:0
v_mfma_f32_16x16x32_bf16 v[212:215], a[236:239], a[196:199], v[212:215]
v_mfma_f32_16x16x32_bf16 v[212:215], a[232:235], a[192:195], v[212:215]
v_mfma_f32_16x16x32_bf16 v[204:207], a[232:235], a[248:251], v[204:207]
v_mfma_f32_16x16x32_bf16 v[204:207], a[236:239], a[252:255], v[204:207]
v_mfma_f32_16x16x32_bf16 v[196:199], a[236:239], a[244:247], v[196:199]
v_mfma_f32_16x16x32_bf16 v[196:199], a[232:235], a[240:243], v[196:199]
buffer_load_dwordx4 v1, s[4:7], s79 offen lds
v_mfma_f32_16x16x32_bf16 v[188:191], a[232:235], v[66:69], v[188:191]
s_add_u32 m0, s76, 40960
s_add_u32 s79, s36, 131072
ds_read_b128 a[164:167], v7 offset:0
v_mfma_f32_16x16x32_bf16 v[188:191], a[236:239], v[70:73], v[188:191]
v_mfma_f32_16x16x32_bf16 v[180:183], a[236:239], v[62:65], v[180:183]
v_mfma_f32_16x16x32_bf16 v[180:183], a[232:235], v[58:61], v[180:183]
s_waitcnt lgkmcnt(4)
v_mfma_f32_16x16x32_bf16 v[84:87], a[224:227], v[58:61], v[84:87]
s_waitcnt lgkmcnt(2)
ds_read_b64_tr_b16 a[232:233], v13 offset:24576
v_mfma_f32_16x16x32_bf16 v[84:87], a[228:231], v[62:65], v[84:87]
ds_read_b64_tr_b16 a[234:235], v13 offset:24832
v_mfma_f32_16x16x32_bf16 v[100:103], a[228:231], v[70:73], v[100:103]
buffer_load_dwordx4 v1, s[4:7], s79 offen lds
v_mfma_f32_16x16x32_bf16 v[100:103], a[224:227], v[66:69], v[100:103]
s_add_u32 m0, s76, 45056
s_add_u32 s79, s36, 196608
ds_read_b64_tr_b16 a[236:237], v13 offset:28672
v_mfma_f32_16x16x32_bf16 v[244:247], a[224:227], a[240:243], v[244:247]
ds_read_b64_tr_b16 a[238:239], v13 offset:28928
v_mfma_f32_16x16x32_bf16 v[244:247], a[228:231], a[244:247], v[244:247]
ds_read_b128 a[172:175], v7 offset:2048
v_mfma_f32_16x16x32_bf16 v[116:119], a[228:231], a[252:255], v[116:119]
v_mfma_f32_16x16x32_bf16 v[116:119], a[224:227], a[248:251], v[116:119]
v_mfma_f32_16x16x32_bf16 v[132:135], a[224:227], a[192:195], v[132:135]
v_mfma_f32_16x16x32_bf16 v[132:135], a[228:231], a[196:199], v[132:135]
buffer_load_dwordx4 v1, s[4:7], s79 offen lds
v_mfma_f32_16x16x32_bf16 a[4:7], a[228:231], a[204:207], a[4:7]
s_add_u32 m0, s76, 49152
s_add_u32 s79, s36, 262144
ds_read_b128 a[168:171], v6 offset:2048
v_mfma_f32_16x16x32_bf16 a[4:7], a[224:227], a[200:203], a[4:7]
v_mfma_f32_16x16x32_bf16 a[20:23], a[224:227], a[208:211], a[20:23]
v_mfma_f32_16x16x32_bf16 a[20:23], a[228:231], a[212:215], a[20:23]
v_mfma_f32_16x16x32_bf16 a[36:39], a[228:231], a[220:223], a[36:39]
v_mfma_f32_16x16x32_bf16 a[36:39], a[224:227], a[216:219], a[36:39]
s_waitcnt lgkmcnt(4)
v_mfma_f32_16x16x32_bf16 a[44:47], a[232:235], a[216:219], a[44:47]
s_waitcnt lgkmcnt(2)
buffer_load_dwordx4 v1, s[4:7], s79 offen lds
v_mfma_f32_16x16x32_bf16 a[44:47], a[236:239], a[220:223], a[44:47]
s_add_u32 m0, s76, 53248
s_add_u32 s79, s36, 327680
ds_read_b64_tr_b16 a[224:225], v12 offset:25088
v_mfma_f32_16x16x32_bf16 a[28:31], a[236:239], a[212:215], a[28:31]
ds_read_b64_tr_b16 a[226:227], v12 offset:25344
v_mfma_f32_16x16x32_bf16 a[28:31], a[232:235], a[208:211], a[28:31]
ds_read_b64_tr_b16 a[228:229], v12 offset:29184
v_mfma_f32_16x16x32_bf16 a[12:15], a[232:235], a[200:203], a[12:15]
ds_read_b64_tr_b16 a[230:231], v12 offset:29440
v_mfma_f32_16x16x32_bf16 a[12:15], a[236:239], a[204:207], a[12:15]
ds_read_b128 a[176:179], v6 offset:4096
v_mfma_f32_16x16x32_bf16 v[140:143], a[236:239], a[196:199], v[140:143]
v_mfma_f32_16x16x32_bf16 v[140:143], a[232:235], a[192:195], v[140:143]
buffer_load_dwordx4 v1, s[4:7], s79 offen lds
v_mfma_f32_16x16x32_bf16 v[124:127], a[232:235], a[248:251], v[124:127]
s_add_u32 m0, s76, 57344
s_add_u32 s79, s36, 393216
ds_read_b128 a[180:183], v7 offset:4096
v_mfma_f32_16x16x32_bf16 v[124:127], a[236:239], a[252:255], v[124:127]
v_mfma_f32_16x16x32_bf16 v[252:255], a[236:239], a[244:247], v[252:255]
v_mfma_f32_16x16x32_bf16 v[252:255], a[232:235], a[240:243], v[252:255]
v_mfma_f32_16x16x32_bf16 v[108:111], a[232:235], v[66:69], v[108:111]
v_mfma_f32_16x16x32_bf16 v[108:111], a[236:239], v[70:73], v[108:111]
v_mfma_f32_16x16x32_bf16 v[92:95], a[236:239], v[62:65], v[92:95]
buffer_load_dwordx4 v1, s[4:7], s79 offen lds
v_mfma_f32_16x16x32_bf16 v[92:95], a[232:235], v[58:61], v[92:95]
s_waitcnt lgkmcnt(4)
s_add_u32 m0, s76, 61440
ds_read_b128 a[188:191], v7 offset:6144
v_mfma_f32_16x16x32_bf16 a[52:55], a[224:227], v[58:61], a[52:55]
s_waitcnt lgkmcnt(3)
s_add_u32 s79, s36, 458752
ds_read_b64_tr_b16 a[232:233], v13 offset:25088
v_mfma_f32_16x16x32_bf16 a[52:55], a[228:231], v[62:65], a[52:55]
ds_read_b64_tr_b16 a[234:235], v13 offset:25344
v_mfma_f32_16x16x32_bf16 a[68:71], a[228:231], v[70:73], a[68:71]
ds_read_b64_tr_b16 a[236:237], v13 offset:29184
v_mfma_f32_16x16x32_bf16 a[68:71], a[224:227], v[66:69], a[68:71]
ds_read_b64_tr_b16 a[238:239], v13 offset:29440
v_mfma_f32_16x16x32_bf16 a[84:87], a[224:227], a[240:243], a[84:87]
v_mfma_f32_16x16x32_bf16 a[84:87], a[228:231], a[244:247], a[84:87]
buffer_load_dwordx4 v1, s[4:7], s79 offen lds
v_mfma_f32_16x16x32_bf16 a[100:103], a[228:231], a[252:255], a[100:103]
s_lshl1_add_u32 s36, s78, s36
s_add_u32 m0, s76, 106496
ds_read_b128 a[184:187], v6 offset:6144
v_mfma_f32_16x16x32_bf16 a[100:103], a[224:227], a[248:251], a[100:103]
v_mfma_f32_16x16x32_bf16 a[116:119], a[224:227], a[192:195], a[116:119]
v_mfma_f32_16x16x32_bf16 a[116:119], a[228:231], a[196:199], a[116:119]
v_mfma_f32_16x16x32_bf16 a[132:135], a[228:231], a[204:207], a[132:135]
v_mfma_f32_16x16x32_bf16 a[132:135], a[224:227], a[200:203], a[132:135]
v_mfma_f32_16x16x32_bf16 v[148:151], a[224:227], a[208:211], v[148:151]
buffer_load_dwordx4 v2, s[8:11], s38 offen lds
v_mfma_f32_16x16x32_bf16 v[148:151], a[228:231], a[212:215], v[148:151]
s_add_u32 m0, s76, 114560
v_mfma_f32_16x16x32_bf16 v[164:167], a[228:231], a[220:223], v[164:167]
v_mfma_f32_16x16x32_bf16 v[164:167], a[224:227], a[216:219], v[164:167]
s_waitcnt vmcnt(13) lgkmcnt(1)
s_barrier
v_mfma_f32_16x16x32_bf16 v[172:175], a[232:235], a[216:219], v[172:175]
ds_read_b64_tr_b16 a[224:225], v10 offset:0
v_mfma_f32_16x16x32_bf16 v[172:175], a[236:239], a[220:223], v[172:175]
ds_read_b64_tr_b16 a[226:227], v10 offset:256
v_mfma_f32_16x16x32_bf16 v[156:159], a[236:239], a[212:215], v[156:159]
ds_read_b64_tr_b16 a[228:229], v10 offset:4096
v_mfma_f32_16x16x32_bf16 v[156:159], a[232:235], a[208:211], v[156:159]
buffer_load_dwordx4 v2, s[8:11], s38 offen offset:128 lds
v_mfma_f32_16x16x32_bf16 a[140:143], a[232:235], a[200:203], a[140:143]
s_add_u32 m0, s76, 122880
ds_read_b64_tr_b16 a[230:231], v10 offset:4352
v_mfma_f32_16x16x32_bf16 a[140:143], a[236:239], a[204:207], a[140:143]
v_mfma_f32_16x16x32_bf16 a[124:127], a[236:239], a[196:199], a[124:127]
v_mfma_f32_16x16x32_bf16 a[124:127], a[232:235], a[192:195], a[124:127]
ds_read_b128 a[192:195], v6 offset:8192
v_mfma_f32_16x16x32_bf16 a[108:111], a[232:235], a[248:251], a[108:111]
ds_read_b128 a[196:199], v7 offset:8192
v_mfma_f32_16x16x32_bf16 a[108:111], a[236:239], a[252:255], a[108:111]
ds_read_b128 a[204:207], v7 offset:10240
v_mfma_f32_16x16x32_bf16 a[92:95], a[236:239], a[244:247], a[92:95]
buffer_load_dwordx4 v3, s[16:19], s39 offen lds
v_mfma_f32_16x16x32_bf16 a[92:95], a[232:235], a[240:243], a[92:95]
s_add_u32 m0, s76, 110592
s_add_u32 s79, s38, 229376
ds_read_b128 a[200:203], v6 offset:10240
v_mfma_f32_16x16x32_bf16 a[76:79], a[232:235], v[66:69], a[76:79]
ds_read_b128 a[208:211], v6 offset:12288
v_mfma_f32_16x16x32_bf16 a[76:79], a[236:239], v[70:73], a[76:79]
ds_read_b128 a[212:215], v7 offset:12288
v_mfma_f32_16x16x32_bf16 a[60:63], a[236:239], v[62:65], a[60:63]
v_mfma_f32_16x16x32_bf16 a[60:63], a[232:235], v[58:61], a[60:63]
s_waitcnt lgkmcnt(8)
s_cmp_lg_u32 s46, 0
s_cbranch_scc1 L_g1_loop_1042
v_mfma_f32_16x16x32_bf16 v[80:83], a[224:227], a[160:163], v[80:83]
s_waitcnt lgkmcnt(6)
ds_read_b128 a[220:223], v7 offset:14336
v_mfma_f32_16x16x32_bf16 v[80:83], a[228:231], a[164:167], v[80:83]
buffer_load_dwordx4 v2, s[8:11], s79 offen lds
v_mfma_f32_16x16x32_bf16 v[96:99], a[228:231], a[172:175], v[96:99]
s_add_u32 m0, s76, 118656
ds_read_b128 a[216:219], v6 offset:14336
v_mov_b32_e64 v36, 0
v_mfma_f32_16x16x32_bf16 v[96:99], a[224:227], a[168:171], v[96:99]
ds_read_b64_tr_b16 a[232:233], v11 offset:0
v_mfma_f32_16x16x32_bf16 v[240:243], a[224:227], a[176:179], v[240:243]
ds_read_b64_tr_b16 a[234:235], v11 offset:256
v_mfma_f32_16x16x32_bf16 v[240:243], a[228:231], a[180:183], v[240:243]
ds_read_b64_tr_b16 a[236:237], v11 offset:4096
v_mov_b32_e64 v37, 0
v_mfma_f32_16x16x32_bf16 v[112:115], a[228:231], a[188:191], v[112:115]
ds_read_b64_tr_b16 a[238:239], v11 offset:4352
v_mfma_f32_16x16x32_bf16 v[112:115], a[224:227], a[184:187], v[112:115]
s_waitcnt lgkmcnt(11)
ds_read_b32 v16, v17 offset:0
v_mfma_f32_16x16x32_bf16 v[128:131], a[224:227], a[192:195], v[128:131]
s_waitcnt lgkmcnt(11)
buffer_load_dwordx4 v2, s[8:11], s79 offen offset:128 lds
v_mfma_f32_16x16x32_bf16 v[128:131], a[228:231], a[196:199], v[128:131]
s_waitcnt lgkmcnt(10)
s_add_u32 m0, s76, 126976
s_add_u32 s79, s39, 229376
v_mfma_f32_16x16x32_bf16 a[0:3], a[228:231], a[204:207], a[0:3]
s_waitcnt lgkmcnt(9)
v_mov_b32_e64 v51, 0
v_mfma_f32_16x16x32_bf16 a[0:3], a[224:227], a[200:203], a[0:3]
s_waitcnt lgkmcnt(8)
v_mfma_f32_16x16x32_bf16 a[16:19], a[224:227], a[208:211], a[16:19]
s_waitcnt lgkmcnt(7)
v_mov_b32_e64 v52, 0
v_mfma_f32_16x16x32_bf16 a[16:19], a[228:231], a[212:215], a[16:19]
s_waitcnt lgkmcnt(6)
v_mfma_f32_16x16x32_bf16 a[32:35], a[228:231], a[220:223], a[32:35]
s_waitcnt lgkmcnt(5)
v_mfma_f32_16x16x32_bf16 a[32:35], a[224:227], a[216:219], a[32:35]
s_waitcnt lgkmcnt(3)
buffer_load_dwordx4 v3, s[16:19], s79 offen lds
v_mfma_f32_16x16x32_bf16 a[40:43], a[232:235], a[216:219], a[40:43]
s_waitcnt lgkmcnt(1)
s_mul_i32 s55, s78, 7168
ds_read_b64_tr_b16 a[224:225], v10 offset:512
v_mfma_f32_16x16x32_bf16 a[40:43], a[236:239], a[220:223], a[40:43]
s_add_u32 s39, s39, s55
s_add_u32 m0, s76, 131072
ds_read_b64_tr_b16 a[226:227], v10 offset:768
v_mfma_f32_16x16x32_bf16 a[24:27], a[236:239], a[212:215], a[24:27]
ds_read_b64_tr_b16 a[228:229], v10 offset:4608
v_mov_b32 v53, 0
v_mfma_f32_16x16x32_bf16 a[24:27], a[232:235], a[208:211], a[24:27]
ds_read_b64_tr_b16 a[230:231], v10 offset:4864
v_mov_b32_e64 v55, 0
v_mfma_f32_16x16x32_bf16 a[8:11], a[232:235], a[200:203], a[8:11]
v_mfma_f32_16x16x32_bf16 a[8:11], a[236:239], a[204:207], a[8:11]
v_mfma_f32_16x16x32_bf16 v[136:139], a[236:239], a[196:199], v[136:139]
buffer_load_dwordx4 v2, s[12:15], s38 offen lds
v_mfma_f32_16x16x32_bf16 v[136:139], a[232:235], a[192:195], v[136:139]
s_add_u32 m0, s76, 139136
ds_read_b64_tr_b16 a[148:149], v8 offset:0
v_mov_b32_e64 v56, 0
v_mfma_f32_16x16x32_bf16 v[120:123], a[232:235], a[184:187], v[120:123]
ds_read_b64_tr_b16 a[150:151], v8 offset:256
s_and_b32 s71, s3, 7
v_mfma_f32_16x16x32_bf16 v[120:123], a[236:239], a[188:191], v[120:123]
v_mfma_f32_16x16x32_bf16 v[248:251], a[236:239], a[180:183], v[248:251]
s_lshl_b32 s71, s71, 16
v_mov_b32_e64 v57, 0
v_mfma_f32_16x16x32_bf16 v[248:251], a[232:235], a[176:179], v[248:251]
v_mfma_f32_16x16x32_bf16 v[104:107], a[232:235], a[168:171], v[104:107]
s_xor_b32 s70, s70, s71
v_mfma_f32_16x16x32_bf16 v[104:107], a[236:239], a[172:175], v[104:107]
buffer_load_dwordx4 v2, s[12:15], s38 offen offset:128 lds
v_mfma_f32_16x16x32_bf16 v[88:91], a[236:239], a[164:167], v[88:91]
s_add_u32 m0, s76, 135168
s_add_u32 s79, s38, 229376
s_lshl_b32 s71, s43, 14
v_mfma_f32_16x16x32_bf16 v[88:91], a[232:235], a[160:163], v[88:91]
s_waitcnt lgkmcnt(4)
v_mfma_f32_16x16x32_bf16 a[48:51], a[224:227], a[160:163], a[48:51]
s_waitcnt lgkmcnt(2)
ds_read_b64_tr_b16 a[232:233], v11 offset:512
v_mfma_f32_16x16x32_bf16 a[48:51], a[228:231], a[164:167], a[48:51]
ds_read_b64_tr_b16 a[234:235], v11 offset:768
s_add_u32 s70, s70, s71
v_mfma_f32_16x16x32_bf16 a[64:67], a[228:231], a[172:175], a[64:67]
ds_read_b64_tr_b16 a[236:237], v11 offset:4608
v_mfma_f32_16x16x32_bf16 a[64:67], a[224:227], a[168:171], a[64:67]
ds_read_b64_tr_b16 a[238:239], v11 offset:4864
s_mov_b32 s72, s64
v_mfma_f32_16x16x32_bf16 a[80:83], a[224:227], a[176:179], a[80:83]
buffer_load_dwordx4 v2, s[12:15], s79 offen lds
v_mfma_f32_16x16x32_bf16 a[80:83], a[228:231], a[180:183], a[80:83]
s_add_u32 m0, s76, 143232
s_mov_b32 s73, s65
v_mfma_f32_16x16x32_bf16 a[96:99], a[228:231], a[188:191], a[96:99]
v_mfma_f32_16x16x32_bf16 a[96:99], a[224:227], a[184:187], a[96:99]
s_waitcnt lgkmcnt(4)
v_mfma_f32_16x16x32_bf16 a[144:147], a[152:155], a[148:151], a[144:147]
s_mov_b32 s75, 0x00020000
v_mfma_f32_16x16x32_bf16 a[112:115], a[224:227], a[192:195], a[112:115]
v_mfma_f32_16x16x32_bf16 a[112:115], a[228:231], a[196:199], a[112:115]
v_lshlrev_b32_e64 v15, 7, v0
v_mfma_f32_16x16x32_bf16 a[128:131], a[228:231], a[204:207], a[128:131]
buffer_load_dwordx4 v2, s[12:15], s79 offen offset:128 lds
v_mfma_f32_16x16x32_bf16 a[128:131], a[224:227], a[200:203], a[128:131]
s_mul_i32 s55, s78, 7168
s_add_u32 s38, s38, s55
v_mfma_f32_16x16x32_bf16 v[144:147], a[224:227], a[208:211], v[144:147]
s_cmp_ge_u32 s47, 6291456
s_cselect_b32 s78, 6291456, 0
s_sub_u32 s47, s47, s78
v_mfma_f32_16x16x32_bf16 v[144:147], a[228:231], a[212:215], v[144:147]
s_cmp_lt_u32 s46, 2
s_cselect_b32 s34, 0, s34
v_cmp_gt_u32 vcc, 32, v16
v_mfma_f32_16x16x32_bf16 v[160:163], a[228:231], a[220:223], v[160:163]
v_mfma_f32_16x16x32_bf16 v[160:163], a[224:227], a[216:219], v[160:163]
s_waitcnt lgkmcnt(2)
v_mfma_f32_16x16x32_bf16 v[168:171], a[232:235], a[216:219], v[168:171]
s_waitcnt lgkmcnt(0)
ds_read_b64_tr_b16 a[224:225], v14 offset:0
v_mfma_f32_16x16x32_bf16 v[168:171], a[236:239], a[220:223], v[168:171]
buffer_load_dword v19, v18, s[32:35], s47 offen
v_mfma_f32_16x16x32_bf16 v[152:155], a[236:239], a[212:215], v[152:155]
s_add_u32 s47, s47, 786432
ds_read_b64_tr_b16 a[226:227], v14 offset:256
v_mfma_f32_16x16x32_bf16 v[152:155], a[232:235], a[208:211], v[152:155]
ds_read_b64_tr_b16 a[228:229], v14 offset:4096
v_mfma_f32_16x16x32_bf16 a[136:139], a[232:235], a[200:203], a[136:139]
ds_read_b64_tr_b16 a[230:231], v14 offset:4352
v_mfma_f32_16x16x32_bf16 a[136:139], a[236:239], a[204:207], a[136:139]
s_cmp_eq_u64 vcc, 0
s_cselect_b32 s74, 0x900000, 0
s_cselect_b32 s49, 32, 0
v_mfma_f32_16x16x32_bf16 a[120:123], a[236:239], a[196:199], a[120:123]
s_add_u32 s71, s70, 8192
v_mfma_f32_16x16x32_bf16 a[120:123], a[232:235], a[192:195], a[120:123]
v_mfma_f32_16x16x32_bf16 a[104:107], a[232:235], a[184:187], a[104:107]
v_mfma_f32_16x16x32_bf16 a[104:107], a[236:239], a[188:191], a[104:107]
v_mfma_f32_16x16x32_bf16 a[88:91], a[236:239], a[180:183], a[88:91]
v_mfma_f32_16x16x32_bf16 a[88:91], a[232:235], a[176:179], a[88:91]
v_mfma_f32_16x16x32_bf16 a[72:75], a[232:235], a[168:171], a[72:75]
v_mfma_f32_16x16x32_bf16 a[72:75], a[236:239], a[172:175], a[72:75]
v_accvgpr_read_b32 v77, a144
v_mfma_f32_16x16x32_bf16 a[56:59], a[236:239], a[164:167], a[56:59]
v_mfma_f32_16x16x32_bf16 a[56:59], a[232:235], a[160:163], a[56:59]
s_waitcnt lgkmcnt(2)
v_or_b32_e64 v77, 1, v77
v_mfma_f32_16x16x32_bf16 v[176:179], a[224:227], a[160:163], v[176:179]
s_waitcnt lgkmcnt(0)
ds_read_b64_tr_b16 a[232:233], v14 offset:2048
v_mfma_f32_16x16x32_bf16 v[176:179], a[228:231], a[164:167], v[176:179]
buffer_store_dword v77, v5, s[24:27], s37 offen sc1
v_mfma_f32_16x16x32_bf16 v[184:187], a[228:231], a[172:175], v[184:187]
ds_read_b64_tr_b16 a[234:235], v14 offset:2304
v_mfma_f32_16x16x32_bf16 v[184:187], a[224:227], a[168:171], v[184:187]
ds_read_b64_tr_b16 a[236:237], v14 offset:6144
v_mfma_f32_16x16x32_bf16 v[192:195], a[224:227], a[176:179], v[192:195]
ds_read_b64_tr_b16 a[238:239], v14 offset:6400
v_mfma_f32_16x16x32_bf16 v[192:195], a[228:231], a[180:183], v[192:195]
buffer_load_dword v19, v15, s[72:75], s70 offen sc1
v_mfma_f32_16x16x32_bf16 v[200:203], a[228:231], a[188:191], v[200:203]
v_mfma_f32_16x16x32_bf16 v[200:203], a[224:227], a[184:187], v[200:203]
v_mfma_f32_16x16x32_bf16 v[208:211], a[224:227], a[192:195], v[208:211]
v_mfma_f32_16x16x32_bf16 v[208:211], a[228:231], a[196:199], v[208:211]
buffer_load_dword v19, v15, s[72:75], s71 offen sc1
v_mfma_f32_16x16x32_bf16 v[216:219], a[228:231], a[204:207], v[216:219]
v_mfma_f32_16x16x32_bf16 v[216:219], a[224:227], a[200:203], v[216:219]
v_mfma_f32_16x16x32_bf16 v[224:227], a[224:227], a[208:211], v[224:227]
v_mfma_f32_16x16x32_bf16 v[224:227], a[228:231], a[212:215], v[224:227]
v_mfma_f32_16x16x32_bf16 v[232:235], a[228:231], a[220:223], v[232:235]
v_mfma_f32_16x16x32_bf16 v[232:235], a[224:227], a[216:219], v[232:235]
s_waitcnt vmcnt(14) lgkmcnt(0)
s_barrier
v_mfma_f32_16x16x32_bf16 v[236:239], a[232:235], a[216:219], v[236:239]
ds_read_b64_tr_b16 a[224:225], v10 offset:24576
v_mfma_f32_16x16x32_bf16 v[236:239], a[236:239], a[220:223], v[236:239]
ds_read_b64_tr_b16 a[226:227], v10 offset:24832
v_mfma_f32_16x16x32_bf16 v[228:231], a[236:239], a[212:215], v[228:231]
ds_read_b64_tr_b16 a[228:229], v10 offset:28672
v_mfma_f32_16x16x32_bf16 v[228:231], a[232:235], a[208:211], v[228:231]
ds_read_b64_tr_b16 a[230:231], v10 offset:28928
v_mfma_f32_16x16x32_bf16 v[220:223], a[232:235], a[200:203], v[220:223]
v_mfma_f32_16x16x32_bf16 v[220:223], a[236:239], a[204:207], v[220:223]
ds_read_b128 v[58:61], v6 offset:32768
v_mfma_f32_16x16x32_bf16 v[212:215], a[236:239], a[196:199], v[212:215]
v_mfma_f32_16x16x32_bf16 v[212:215], a[232:235], a[192:195], v[212:215]
v_mfma_f32_16x16x32_bf16 v[204:207], a[232:235], a[184:187], v[204:207]
v_mfma_f32_16x16x32_bf16 v[204:207], a[236:239], a[188:191], v[204:207]
v_mfma_f32_16x16x32_bf16 v[196:199], a[236:239], a[180:183], v[196:199]
v_mfma_f32_16x16x32_bf16 v[196:199], a[232:235], a[176:179], v[196:199]
ds_read_b128 v[62:65], v7 offset:32768
v_mfma_f32_16x16x32_bf16 v[188:191], a[232:235], a[168:171], v[188:191]
v_mfma_f32_16x16x32_bf16 v[188:191], a[236:239], a[172:175], v[188:191]
v_mfma_f32_16x16x32_bf16 v[180:183], a[236:239], a[164:167], v[180:183]
v_mfma_f32_16x16x32_bf16 v[180:183], a[232:235], a[160:163], v[180:183]
s_waitcnt lgkmcnt(4)
v_mfma_f32_16x16x32_bf16 v[84:87], a[224:227], a[160:163], v[84:87]
s_waitcnt lgkmcnt(2)
ds_read_b64_tr_b16 a[232:233], v11 offset:24576
v_mfma_f32_16x16x32_bf16 v[84:87], a[228:231], a[164:167], v[84:87]
ds_read_b64_tr_b16 a[234:235], v11 offset:24832
v_mfma_f32_16x16x32_bf16 v[100:103], a[228:231], a[172:175], v[100:103]
ds_read_b64_tr_b16 a[236:237], v11 offset:28672
v_mfma_f32_16x16x32_bf16 v[100:103], a[224:227], a[168:171], v[100:103]
ds_read_b64_tr_b16 a[238:239], v11 offset:28928
v_mfma_f32_16x16x32_bf16 v[244:247], a[224:227], a[176:179], v[244:247]
ds_read_b128 v[70:73], v7 offset:34816
v_mfma_f32_16x16x32_bf16 v[244:247], a[228:231], a[180:183], v[244:247]
v_mfma_f32_16x16x32_bf16 v[116:119], a[228:231], a[188:191], v[116:119]
v_mfma_f32_16x16x32_bf16 v[116:119], a[224:227], a[184:187], v[116:119]
v_mfma_f32_16x16x32_bf16 v[132:135], a[224:227], a[192:195], v[132:135]
v_mfma_f32_16x16x32_bf16 v[132:135], a[228:231], a[196:199], v[132:135]
ds_read_b128 v[66:69], v6 offset:34816
s_and_b32 s75, s2, 1
v_mfma_f32_16x16x32_bf16 a[4:7], a[228:231], a[204:207], a[4:7]
s_sub_u32 s34, 0, s75
v_mfma_f32_16x16x32_bf16 a[4:7], a[224:227], a[200:203], a[4:7]
s_and_b32 s47, s34, 0x15
v_mfma_f32_16x16x32_bf16 a[20:23], a[224:227], a[208:211], a[20:23]
s_xor_b32 s47, s2, s47
v_mfma_f32_16x16x32_bf16 a[20:23], a[228:231], a[212:215], a[20:23]
s_bfe_u32 s76, s47, 0x20001
s_and_b32 s38, s3, 7
v_mfma_f32_16x16x32_bf16 a[36:39], a[228:231], a[220:223], a[36:39]
s_lshr_b32 s46, s2, 6
v_mfma_f32_16x16x32_bf16 a[36:39], a[224:227], a[216:219], a[36:39]
s_waitcnt lgkmcnt(4)
s_lshl_b32 s33, s46, 13
v_mfma_f32_16x16x32_bf16 a[44:47], a[232:235], a[216:219], a[44:47]
s_waitcnt lgkmcnt(2)
ds_read_b64_tr_b16 a[224:225], v10 offset:25088
s_lshl_b32 s32, s76, 15
v_mfma_f32_16x16x32_bf16 a[44:47], a[236:239], a[220:223], a[44:47]
ds_read_b64_tr_b16 a[226:227], v10 offset:25344
s_lshl2_add_u32 s76, s76, s46
v_mfma_f32_16x16x32_bf16 a[28:31], a[236:239], a[212:215], a[28:31]
ds_read_b64_tr_b16 a[228:229], v10 offset:29184
s_bfe_u32 s77, s47, 0x30003
v_mfma_f32_16x16x32_bf16 a[28:31], a[232:235], a[208:211], a[28:31]
ds_read_b64_tr_b16 a[230:231], v10 offset:29440
s_lshl_b32 s39, s43, 12
v_mfma_f32_16x16x32_bf16 a[12:15], a[232:235], a[200:203], a[12:15]
ds_read_b128 a[240:243], v6 offset:36864
s_lshl1_add_u32 s46, s76, s75
v_mfma_f32_16x16x32_bf16 a[12:15], a[236:239], a[204:207], a[12:15]
s_lshl_b32 s68, s46, 17
s_lshl_b32 s46, s75, 12
v_mfma_f32_16x16x32_bf16 v[140:143], a[236:239], a[196:199], v[140:143]
s_add_u32 s46, s46, s33
v_mfma_f32_16x16x32_bf16 v[140:143], a[232:235], a[192:195], v[140:143]
ds_read_b128 a[244:247], v7 offset:36864
s_add_u32 s46, s46, s32
v_mfma_f32_16x16x32_bf16 v[124:127], a[232:235], a[184:187], v[124:127]
s_lshl_b32 s47, s38, 17
s_add_u32 s46, s46, s47
v_mfma_f32_16x16x32_bf16 v[124:127], a[236:239], a[188:191], v[124:127]
s_lshl_b32 s33, s43, 20
v_mfma_f32_16x16x32_bf16 v[252:255], a[236:239], a[180:183], v[252:255]
s_add_u32 s33, s33, s46
v_mfma_f32_16x16x32_bf16 v[252:255], a[232:235], a[176:179], v[252:255]
s_xor_b32 s33, s33, 4096
s_mul_i32 s32, s43, 0x81000
v_mfma_f32_16x16x32_bf16 v[108:111], a[232:235], a[168:171], v[108:111]
s_and_b32 s32, s32, 0x101000
v_mfma_f32_16x16x32_bf16 v[108:111], a[236:239], a[172:175], v[108:111]
s_xor_b32 s32, s32, s46
v_mfma_f32_16x16x32_bf16 v[92:95], a[236:239], a[164:167], v[92:95]
ds_read_b128 a[252:255], v7 offset:38912
s_lshl_b32 s35, s38, 6
v_mfma_f32_16x16x32_bf16 v[92:95], a[232:235], a[160:163], v[92:95]
s_waitcnt lgkmcnt(5)
s_lshl2_add_u32 s46, s77, s43
v_mfma_f32_16x16x32_bf16 a[52:55], a[224:227], a[160:163], a[52:55]
s_waitcnt lgkmcnt(3)
ds_read_b64_tr_b16 a[232:233], v11 offset:25088
s_lshl_b32 s47, s46, 6
v_mfma_f32_16x16x32_bf16 a[52:55], a[228:231], a[164:167], a[52:55]
ds_read_b64_tr_b16 a[234:235], v11 offset:25344
s_add_u32 s68, s68, s47
v_mfma_f32_16x16x32_bf16 a[68:71], a[228:231], a[172:175], a[68:71]
ds_read_b64_tr_b16 a[236:237], v11 offset:29184
s_lshl_b32 s37, s38, 16
v_mfma_f32_16x16x32_bf16 a[68:71], a[224:227], a[168:171], a[68:71]
ds_read_b64_tr_b16 a[238:239], v11 offset:29440
s_lshl_b32 s46, s77, 13
v_mfma_f32_16x16x32_bf16 a[84:87], a[224:227], a[176:179], a[84:87]
s_add_u32 s37, s37, s46
s_lshl_b32 s46, s43, 11
v_mfma_f32_16x16x32_bf16 a[84:87], a[228:231], a[180:183], a[84:87]
ds_read_b128 a[248:251], v6 offset:38912
s_add_u32 s37, s37, s46
v_mfma_f32_16x16x32_bf16 a[100:103], a[228:231], a[188:191], a[100:103]
s_mov_b32 s66, 0x900000
s_lshl3_add_u32 s46, s76, s77
v_mfma_f32_16x16x32_bf16 a[100:103], a[224:227], a[184:187], a[100:103]
s_lshl1_add_u32 s46, s46, s75
v_mfma_f32_16x16x32_bf16 a[116:119], a[224:227], a[192:195], a[116:119]
s_lshl2_add_u32 s46, s46, s43
v_mfma_f32_16x16x32_bf16 a[116:119], a[228:231], a[196:199], a[116:119]
s_xor_b32 s47, s46, 4
v_mfma_f32_16x16x32_bf16 a[132:135], a[228:231], a[204:207], a[132:135]
s_lshl_b32 s70, s46, 13
s_lshl_b32 s69, s47, 13
v_mfma_f32_16x16x32_bf16 a[132:135], a[224:227], a[200:203], a[132:135]
s_lshl_b32 s72, s46, 5
v_mfma_f32_16x16x32_bf16 v[148:151], a[224:227], a[208:211], v[148:151]
s_lshl_b32 s71, s47, 5
v_mfma_f32_16x16x32_bf16 v[148:151], a[228:231], a[212:215], v[148:151]
s_lshl_b32 s73, s76, 11
v_mfma_f32_16x16x32_bf16 v[164:167], a[228:231], a[220:223], v[164:167]
s_add_u32 s73, s73, 32768
s_add_u32 s12, s20, 0x2400000
s_addc_u32 s13, s21, 0
v_mfma_f32_16x16x32_bf16 v[164:167], a[224:227], a[216:219], v[164:167]
s_waitcnt vmcnt(4) lgkmcnt(1)
s_barrier
v_mfma_f32_16x16x32_bf16 v[172:175], a[232:235], a[216:219], v[172:175]
ds_read_b64_tr_b16 a[224:225], v12 offset:0
s_mov_b32 s14, 0x800000
v_mfma_f32_16x16x32_bf16 v[172:175], a[236:239], a[220:223], v[172:175]
ds_read_b64_tr_b16 a[226:227], v12 offset:256
s_mov_b32 s15, 0x00020000
v_mfma_f32_16x16x32_bf16 v[156:159], a[236:239], a[212:215], v[156:159]
ds_read_b64_tr_b16 a[228:229], v12 offset:4096
v_mfma_f32_16x16x32_bf16 v[156:159], a[232:235], a[208:211], v[156:159]
ds_read_b64_tr_b16 a[230:231], v12 offset:4352
v_mfma_f32_16x16x32_bf16 a[140:143], a[232:235], a[200:203], a[140:143]
s_add_u32 s16, s20, 0x3c00000
s_addc_u32 s17, s21, 0
s_mov_b32 s18, 0x14000
v_mfma_f32_16x16x32_bf16 a[140:143], a[236:239], a[204:207], a[140:143]
s_mov_b32 s19, 0x00020000
s_mov_b32 s60, s20
s_mov_b32 s61, s21
v_mfma_f32_16x16x32_bf16 a[124:127], a[236:239], a[196:199], a[124:127]
s_mov_b32 s62, 0
s_mov_b32 s63, 0x00020000
v_mfma_f32_16x16x32_bf16 a[124:127], a[232:235], a[192:195], a[124:127]
ds_read_b128 a[192:195], v6 offset:40960
s_lshl_b32 s74, s59, 12
v_mfma_f32_16x16x32_bf16 a[108:111], a[232:235], a[184:187], a[108:111]
ds_read_b128 a[196:199], v7 offset:40960
s_lshl_b32 s46, s3, 7
v_mfma_f32_16x16x32_bf16 a[108:111], a[236:239], a[188:191], a[108:111]
ds_read_b128 a[204:207], v7 offset:43008
s_add_u32 s74, s74, s46
v_mfma_f32_16x16x32_bf16 a[92:95], a[236:239], a[180:183], a[92:95]
ds_read_b128 a[200:203], v6 offset:43008
s_and_b32 s46, s45, 3
v_mfma_f32_16x16x32_bf16 a[92:95], a[232:235], a[176:179], a[92:95]
s_lshl_b32 s46, s46, 4
s_add_u32 s74, s74, s46
v_mfma_f32_16x16x32_bf16 a[76:79], a[232:235], a[168:171], a[76:79]
ds_read_b128 a[208:211], v6 offset:45056
s_add_u32 s74, s74, 34816
v_mfma_f32_16x16x32_bf16 a[76:79], a[236:239], a[172:175], a[76:79]
ds_read_b128 a[212:215], v7 offset:45056
v_mfma_f32_16x16x32_bf16 a[60:63], a[236:239], a[164:167], a[60:63]
v_mfma_f32_16x16x32_bf16 a[60:63], a[232:235], a[160:163], a[60:63]
s_waitcnt lgkmcnt(8)
v_mfma_f32_16x16x32_bf16 v[80:83], a[224:227], v[58:61], v[80:83]
s_waitcnt lgkmcnt(6)
ds_read_b128 a[220:223], v7 offset:47104
s_mov_b32 s8, s100
v_mfma_f32_16x16x32_bf16 v[80:83], a[228:231], v[62:65], v[80:83]
ds_read_b128 a[216:219], v6 offset:47104
s_mov_b32 s9, s101
v_mfma_f32_16x16x32_bf16 v[96:99], a[228:231], v[70:73], v[96:99]
ds_read_b64_tr_b16 a[232:233], v13 offset:0
s_mov_b32 s10, 0x400000
v_mfma_f32_16x16x32_bf16 v[96:99], a[224:227], v[66:69], v[96:99]
ds_read_b64_tr_b16 a[234:235], v13 offset:256
s_mov_b32 s11, 0x00020000
v_mfma_f32_16x16x32_bf16 v[240:243], a[224:227], a[240:243], v[240:243]
ds_read_b64_tr_b16 a[236:237], v13 offset:4096
v_mfma_f32_16x16x32_bf16 v[240:243], a[228:231], a[244:247], v[240:243]
ds_read_b64_tr_b16 a[238:239], v13 offset:4352
v_mfma_f32_16x16x32_bf16 v[112:115], a[228:231], a[252:255], v[112:115]
v_mfma_f32_16x16x32_bf16 v[112:115], a[224:227], a[248:251], v[112:115]
v_mfma_f32_16x16x32_bf16 a[176:179], a[152:155], a[224:227], 0
v_mfma_f32_16x16x32_bf16 a[176:179], a[152:155], a[228:231], a[176:179]
s_waitcnt lgkmcnt(10)
v_mfma_f32_16x16x32_bf16 v[128:131], a[228:231], a[196:199], v[128:131]
v_mfma_f32_16x16x32_bf16 v[128:131], a[224:227], a[192:195], v[128:131]
s_waitcnt lgkmcnt(8)
v_mfma_f32_16x16x32_bf16 a[0:3], a[224:227], a[200:203], a[0:3]
v_mfma_f32_16x16x32_bf16 a[0:3], a[228:231], a[204:207], a[0:3]
s_waitcnt lgkmcnt(6)
v_mfma_f32_16x16x32_bf16 a[16:19], a[228:231], a[212:215], a[16:19]
v_mfma_f32_16x16x32_bf16 a[16:19], a[224:227], a[208:211], a[16:19]
s_waitcnt lgkmcnt(4)
v_mfma_f32_16x16x32_bf16 a[32:35], a[224:227], a[216:219], a[32:35]
v_mfma_f32_16x16x32_bf16 a[32:35], a[228:231], a[220:223], a[32:35]
s_waitcnt lgkmcnt(2)
v_mfma_f32_16x16x32_bf16 a[40:43], a[232:235], a[216:219], a[40:43]
s_waitcnt lgkmcnt(0)
ds_read_b64_tr_b16 a[224:225], v12 offset:512
v_mfma_f32_16x16x32_bf16 a[40:43], a[236:239], a[220:223], a[40:43]
ds_read_b64_tr_b16 a[226:227], v12 offset:768
v_mfma_f32_16x16x32_bf16 a[24:27], a[236:239], a[212:215], a[24:27]
ds_read_b64_tr_b16 a[228:229], v12 offset:4608
v_and_b32_e64 v76, 15, v0
v_mfma_f32_16x16x32_bf16 a[24:27], a[232:235], a[208:211], a[24:27]
ds_read_b64_tr_b16 a[230:231], v12 offset:4864
v_mfma_f32_16x16x32_bf16 a[8:11], a[232:235], a[200:203], a[8:11]
v_mfma_f32_16x16x32_bf16 a[8:11], a[236:239], a[204:207], a[8:11]
v_lshlrev_b32_e64 v76, 3, v76
v_mfma_f32_16x16x32_bf16 v[136:139], a[236:239], a[196:199], v[136:139]
v_mfma_f32_16x16x32_bf16 v[136:139], a[232:235], a[192:195], v[136:139]
v_mfma_f32_16x16x32_bf16 a[180:183], a[152:155], a[232:235], 0
s_add_u32 s52, s44, 128
v_mfma_f32_16x16x32_bf16 a[180:183], a[152:155], a[236:239], a[180:183]
v_mfma_f32_16x16x32_bf16 v[120:123], a[236:239], a[252:255], v[120:123]
v_mfma_f32_16x16x32_bf16 v[120:123], a[232:235], a[248:251], v[120:123]
v_mfma_f32_16x16x32_bf16 v[248:251], a[232:235], a[240:243], v[248:251]
s_lshl_b32 s52, s52, 3
v_mfma_f32_16x16x32_bf16 v[248:251], a[236:239], a[244:247], v[248:251]
v_mfma_f32_16x16x32_bf16 v[104:107], a[236:239], v[70:73], v[104:107]
v_mfma_f32_16x16x32_bf16 v[104:107], a[232:235], v[66:69], v[104:107]
buffer_load_dwordx2 v[20:21], v76, s[24:27], s52 offen offset:0 sc1
v_mfma_f32_16x16x32_bf16 v[88:91], a[232:235], v[58:61], v[88:91]
v_mfma_f32_16x16x32_bf16 v[88:91], a[236:239], v[62:65], v[88:91]
s_waitcnt lgkmcnt(2)
v_mfma_f32_16x16x32_bf16 a[48:51], a[224:227], v[58:61], a[48:51]
s_waitcnt lgkmcnt(0)
buffer_load_dwordx2 v[22:23], v76, s[24:27], s52 offen offset:128 sc1
v_mfma_f32_16x16x32_bf16 a[48:51], a[228:231], v[62:65], a[48:51]
ds_read_b64_tr_b16 a[232:233], v13 offset:512
v_mfma_f32_16x16x32_bf16 a[64:67], a[228:231], v[70:73], a[64:67]
ds_read_b64_tr_b16 a[234:235], v13 offset:768
v_mfma_f32_16x16x32_bf16 a[64:67], a[224:227], v[66:69], a[64:67]
ds_read_b64_tr_b16 a[236:237], v13 offset:4608
v_mfma_f32_16x16x32_bf16 a[80:83], a[224:227], a[240:243], a[80:83]
buffer_load_dwordx2 v[24:25], v76, s[24:27], s52 offen offset:256 sc1
v_mfma_f32_16x16x32_bf16 a[80:83], a[228:231], a[244:247], a[80:83]
ds_read_b64_tr_b16 a[238:239], v13 offset:4864
v_mfma_f32_16x16x32_bf16 a[96:99], a[228:231], a[252:255], a[96:99]
v_mfma_f32_16x16x32_bf16 a[96:99], a[224:227], a[248:251], a[96:99]
buffer_load_dwordx2 v[26:27], v76, s[24:27], s52 offen offset:384 sc1
v_mfma_f32_16x16x32_bf16 a[184:187], a[152:155], a[224:227], 0
v_mfma_f32_16x16x32_bf16 a[184:187], a[152:155], a[228:231], a[184:187]
v_mfma_f32_16x16x32_bf16 a[112:115], a[228:231], a[196:199], a[112:115]
buffer_load_dwordx2 v[28:29], v76, s[24:27], s52 offen offset:512 sc1
v_mfma_f32_16x16x32_bf16 a[112:115], a[224:227], a[192:195], a[112:115]
v_mfma_f32_16x16x32_bf16 a[128:131], a[224:227], a[200:203], a[128:131]
v_mfma_f32_16x16x32_bf16 a[128:131], a[228:231], a[204:207], a[128:131]
v_mfma_f32_16x16x32_bf16 v[144:147], a[228:231], a[212:215], v[144:147]
buffer_load_dwordx2 v[30:31], v76, s[24:27], s52 offen offset:640 sc1
v_mfma_f32_16x16x32_bf16 v[144:147], a[224:227], a[208:211], v[144:147]
v_mfma_f32_16x16x32_bf16 v[160:163], a[224:227], a[216:219], v[160:163]
v_mfma_f32_16x16x32_bf16 v[160:163], a[228:231], a[220:223], v[160:163]
s_waitcnt lgkmcnt(2)
buffer_load_dwordx2 v[32:33], v76, s[24:27], s52 offen offset:768 sc1
v_mfma_f32_16x16x32_bf16 v[168:171], a[232:235], a[216:219], v[168:171]
s_waitcnt lgkmcnt(0)
ds_read_b64_tr_b16 a[224:225], v14 offset:40960
v_mfma_f32_16x16x32_bf16 v[168:171], a[236:239], a[220:223], v[168:171]
ds_read_b64_tr_b16 a[226:227], v14 offset:41216
v_mfma_f32_16x16x32_bf16 v[152:155], a[236:239], a[212:215], v[152:155]
buffer_load_dwordx2 v[34:35], v76, s[24:27], s52 offen offset:896 sc1
v_mfma_f32_16x16x32_bf16 v[152:155], a[232:235], a[208:211], v[152:155]
ds_read_b64_tr_b16 a[228:229], v14 offset:45056
v_mfma_f32_16x16x32_bf16 a[136:139], a[232:235], a[200:203], a[136:139]
ds_read_b64_tr_b16 a[230:231], v14 offset:45312
v_mfma_f32_16x16x32_bf16 a[136:139], a[236:239], a[204:207], a[136:139]
v_mfma_f32_16x16x32_bf16 a[120:123], a[236:239], a[196:199], a[120:123]
v_mfma_f32_16x16x32_bf16 a[120:123], a[232:235], a[192:195], a[120:123]
v_mfma_f32_16x16x32_bf16 a[188:191], a[152:155], a[232:235], 0
v_mfma_f32_16x16x32_bf16 a[188:191], a[152:155], a[236:239], a[188:191]
v_mfma_f32_16x16x32_bf16 a[104:107], a[236:239], a[252:255], a[104:107]
v_mfma_f32_16x16x32_bf16 a[104:107], a[232:235], a[248:251], a[104:107]
v_mfma_f32_16x16x32_bf16 a[88:91], a[232:235], a[240:243], a[88:91]
v_mfma_f32_16x16x32_bf16 a[88:91], a[236:239], a[244:247], a[88:91]
v_mfma_f32_16x16x32_bf16 a[72:75], a[236:239], v[70:73], a[72:75]
v_mfma_f32_16x16x32_bf16 a[72:75], a[232:235], v[66:69], a[72:75]
v_mfma_f32_16x16x32_bf16 a[56:59], a[232:235], v[58:61], a[56:59]
s_bfe_u32 s53, s2, 0x20003
v_mfma_f32_16x16x32_bf16 a[56:59], a[236:239], v[62:65], a[56:59]
s_waitcnt lgkmcnt(2)
s_lshl2_add_u32 s53, s3, s53
v_mfma_f32_16x16x32_bf16 v[176:179], a[224:227], v[58:61], v[176:179]
s_waitcnt lgkmcnt(0)
ds_read_b64_tr_b16 a[232:233], v14 offset:43008
v_mfma_f32_16x16x32_bf16 v[176:179], a[228:231], v[62:65], v[176:179]
ds_read_b64_tr_b16 a[234:235], v14 offset:43264
s_lshl1_add_u32 s53, s53, s58
v_mfma_f32_16x16x32_bf16 v[184:187], a[228:231], v[70:73], v[184:187]
ds_read_b64_tr_b16 a[236:237], v14 offset:47104
v_mfma_f32_16x16x32_bf16 v[184:187], a[224:227], v[66:69], v[184:187]
ds_read_b64_tr_b16 a[238:239], v14 offset:47360
s_mul_i32 s53, s53, 768
v_mfma_f32_16x16x32_bf16 v[192:195], a[224:227], a[240:243], v[192:195]
v_mfma_f32_16x16x32_bf16 v[192:195], a[228:231], a[244:247], v[192:195]
s_add_u32 s53, s53, 16384
v_mfma_f32_16x16x32_bf16 v[200:203], a[228:231], a[252:255], v[200:203]
buffer_load_dwordx4 v[40:43], v9, s[24:27], s53 offen offset:0 sc1
v_mfma_f32_16x16x32_bf16 v[200:203], a[224:227], a[248:251], v[200:203]
v_mfma_f32_16x16x32_bf16 a[148:151], a[152:155], a[224:227], 0
buffer_load_dwordx4 v[44:47], v9, s[24:27], s53 offen offset:16 sc1
v_mfma_f32_16x16x32_bf16 a[148:151], a[152:155], a[228:231], a[148:151]
v_mfma_f32_16x16x32_bf16 v[208:211], a[228:231], a[196:199], v[208:211]
buffer_load_dwordx4 v[48:51], v9, s[24:27], s53 offen offset:32 sc1
v_mfma_f32_16x16x32_bf16 v[208:211], a[224:227], a[192:195], v[208:211]
v_mfma_f32_16x16x32_bf16 v[216:219], a[224:227], a[200:203], v[216:219]
v_mfma_f32_16x16x32_bf16 v[216:219], a[228:231], a[204:207], v[216:219]
v_mfma_f32_16x16x32_bf16 v[224:227], a[228:231], a[212:215], v[224:227]
v_mfma_f32_16x16x32_bf16 v[224:227], a[224:227], a[208:211], v[224:227]
v_mfma_f32_16x16x32_bf16 v[232:235], a[224:227], a[216:219], v[232:235]
v_mfma_f32_16x16x32_bf16 v[232:235], a[228:231], a[220:223], v[232:235]
s_waitcnt lgkmcnt(2)
v_mfma_f32_16x16x32_bf16 v[236:239], a[232:235], a[216:219], v[236:239]
s_waitcnt lgkmcnt(0)
ds_read_b64_tr_b16 a[224:225], v12 offset:24576
v_and_b32 v78, 15, v0
v_mfma_f32_16x16x32_bf16 v[236:239], a[236:239], a[220:223], v[236:239]
ds_read_b64_tr_b16 a[226:227], v12 offset:24832
v_mfma_f32_16x16x32_bf16 v[228:231], a[236:239], a[212:215], v[228:231]
ds_read_b64_tr_b16 a[228:229], v12 offset:28672
v_lshrrev_b32_e64 v79, 4, v0
v_mfma_f32_16x16x32_bf16 v[228:231], a[232:235], a[208:211], v[228:231]
ds_read_b64_tr_b16 a[230:231], v12 offset:28928
v_mfma_f32_16x16x32_bf16 v[220:223], a[232:235], a[200:203], v[220:223]
v_mfma_f32_16x16x32_bf16 v[220:223], a[236:239], a[204:207], v[220:223]
v_lshlrev_b32_e64 v78, 11, v78
v_mfma_f32_16x16x32_bf16 v[212:215], a[236:239], a[196:199], v[212:215]
v_mfma_f32_16x16x32_bf16 v[212:215], a[232:235], a[192:195], v[212:215]
v_lshl_add_u32 v78, v79, 3, v78
v_mfma_f32_16x16x32_bf16 a[148:151], a[156:159], a[232:235], a[148:151]
v_mfma_f32_16x16x32_bf16 a[148:151], a[156:159], a[236:239], a[148:151]
v_mfma_f32_16x16x32_bf16 v[204:207], a[236:239], a[252:255], v[204:207]
s_add_u32 s47, s68, 0
v_mfma_f32_16x16x32_bf16 v[204:207], a[232:235], a[248:251], v[204:207]
v_mfma_f32_16x16x32_bf16 v[196:199], a[232:235], a[240:243], v[196:199]
buffer_load_dwordx2 a[160:161], v78, s[4:7], s47 offen offset:0
v_mfma_f32_16x16x32_bf16 v[196:199], a[236:239], a[244:247], v[196:199]
v_mfma_f32_16x16x32_bf16 v[188:191], a[236:239], v[70:73], v[188:191]
v_mfma_f32_16x16x32_bf16 v[188:191], a[232:235], v[66:69], v[188:191]
buffer_load_dwordx2 a[162:163], v78, s[4:7], s47 offen offset:32
v_mfma_f32_16x16x32_bf16 v[180:183], a[232:235], v[58:61], v[180:183]
v_mfma_f32_16x16x32_bf16 v[180:183], a[236:239], v[62:65], v[180:183]
s_waitcnt lgkmcnt(2)
s_add_u32 s47, s68, 32768
v_mfma_f32_16x16x32_bf16 v[84:87], a[224:227], v[58:61], v[84:87]
s_waitcnt lgkmcnt(0)
ds_read_b64_tr_b16 a[232:233], v13 offset:24576
v_mfma_f32_16x16x32_bf16 v[84:87], a[228:231], v[62:65], v[84:87]
ds_read_b64_tr_b16 a[234:235], v13 offset:24832
v_mfma_f32_16x16x32_bf16 v[100:103], a[228:231], v[70:73], v[100:103]
buffer_load_dwordx2 a[164:165], v78, s[4:7], s47 offen offset:0
v_mfma_f32_16x16x32_bf16 v[100:103], a[224:227], v[66:69], v[100:103]
ds_read_b64_tr_b16 a[236:237], v13 offset:28672
v_mfma_f32_16x16x32_bf16 v[244:247], a[224:227], a[240:243], v[244:247]
buffer_load_dwordx2 a[166:167], v78, s[4:7], s47 offen offset:32
v_mfma_f32_16x16x32_bf16 v[244:247], a[228:231], a[244:247], v[244:247]
ds_read_b64_tr_b16 a[238:239], v13 offset:28928
v_mfma_f32_16x16x32_bf16 v[116:119], a[228:231], a[252:255], v[116:119]
v_mfma_f32_16x16x32_bf16 v[116:119], a[224:227], a[248:251], v[116:119]
s_add_u32 s47, s68, 65536
v_mfma_f32_16x16x32_bf16 a[176:179], a[156:159], a[224:227], a[176:179]
v_mfma_f32_16x16x32_bf16 a[176:179], a[156:159], a[228:231], a[176:179]
buffer_load_dwordx2 a[168:169], v78, s[4:7], s47 offen offset:0
v_mfma_f32_16x16x32_bf16 v[132:135], a[228:231], a[196:199], v[132:135]
v_mfma_f32_16x16x32_bf16 v[132:135], a[224:227], a[192:195], v[132:135]
v_mfma_f32_16x16x32_bf16 a[4:7], a[224:227], a[200:203], a[4:7]
buffer_load_dwordx2 a[170:171], v78, s[4:7], s47 offen offset:32
v_mfma_f32_16x16x32_bf16 a[4:7], a[228:231], a[204:207], a[4:7]
v_mfma_f32_16x16x32_bf16 a[20:23], a[228:231], a[212:215], a[20:23]
s_add_u32 s47, s68, 98304
v_mfma_f32_16x16x32_bf16 a[20:23], a[224:227], a[208:211], a[20:23]
v_mfma_f32_16x16x32_bf16 a[36:39], a[224:227], a[216:219], a[36:39]
v_mfma_f32_16x16x32_bf16 a[36:39], a[228:231], a[220:223], a[36:39]
s_waitcnt lgkmcnt(2)
buffer_load_dwordx2 a[172:173], v78, s[4:7], s47 offen offset:0
v_mfma_f32_16x16x32_bf16 a[44:47], a[232:235], a[216:219], a[44:47]
s_waitcnt lgkmcnt(0)
ds_read_b64_tr_b16 a[224:225], v12 offset:25088
v_mfma_f32_16x16x32_bf16 a[44:47], a[236:239], a[220:223], a[44:47]
buffer_load_dwordx2 a[174:175], v78, s[4:7], s47 offen offset:32
v_mfma_f32_16x16x32_bf16 a[28:31], a[236:239], a[212:215], a[28:31]
ds_read_b64_tr_b16 a[226:227], v12 offset:25344
v_mfma_f32_16x16x32_bf16 a[28:31], a[232:235], a[208:211], a[28:31]
ds_read_b64_tr_b16 a[228:229], v12 offset:29184
v_mfma_f32_16x16x32_bf16 a[12:15], a[232:235], a[200:203], a[12:15]
ds_read_b64_tr_b16 a[230:231], v12 offset:29440
v_mfma_f32_16x16x32_bf16 a[12:15], a[236:239], a[204:207], a[12:15]
v_mfma_f32_16x16x32_bf16 v[140:143], a[236:239], a[196:199], v[140:143]
v_mfma_f32_16x16x32_bf16 v[140:143], a[232:235], a[192:195], v[140:143]
v_mfma_f32_16x16x32_bf16 a[180:183], a[156:159], a[232:235], a[180:183]
v_mfma_f32_16x16x32_bf16 a[180:183], a[156:159], a[236:239], a[180:183]
v_mfma_f32_16x16x32_bf16 v[124:127], a[236:239], a[252:255], v[124:127]
v_mfma_f32_16x16x32_bf16 v[124:127], a[232:235], a[248:251], v[124:127]
v_mfma_f32_16x16x32_bf16 v[252:255], a[232:235], a[240:243], v[252:255]
v_mfma_f32_16x16x32_bf16 v[252:255], a[236:239], a[244:247], v[252:255]
v_mfma_f32_16x16x32_bf16 v[108:111], a[236:239], v[70:73], v[108:111]
v_mfma_f32_16x16x32_bf16 v[108:111], a[232:235], v[66:69], v[108:111]
v_mfma_f32_16x16x32_bf16 v[92:95], a[232:235], v[58:61], v[92:95]
v_mfma_f32_16x16x32_bf16 v[92:95], a[236:239], v[62:65], v[92:95]
s_waitcnt lgkmcnt(2)
v_mfma_f32_16x16x32_bf16 a[52:55], a[224:227], v[58:61], a[52:55]
s_waitcnt lgkmcnt(0)
ds_read_b64_tr_b16 a[232:233], v13 offset:25088
v_mfma_f32_16x16x32_bf16 a[52:55], a[228:231], v[62:65], a[52:55]
ds_read_b64_tr_b16 a[234:235], v13 offset:25344
v_mfma_f32_16x16x32_bf16 a[68:71], a[228:231], v[70:73], a[68:71]
ds_read_b64_tr_b16 a[236:237], v13 offset:29184
v_mfma_f32_16x16x32_bf16 a[68:71], a[224:227], v[66:69], a[68:71]
ds_read_b64_tr_b16 a[238:239], v13 offset:29440
v_mfma_f32_16x16x32_bf16 a[84:87], a[224:227], a[240:243], a[84:87]
v_mfma_f32_16x16x32_bf16 a[84:87], a[228:231], a[244:247], a[84:87]
v_mfma_f32_16x16x32_bf16 a[100:103], a[228:231], a[252:255], a[100:103]
v_mfma_f32_16x16x32_bf16 a[100:103], a[224:227], a[248:251], a[100:103]
v_mfma_f32_16x16x32_bf16 a[184:187], a[156:159], a[224:227], a[184:187]
v_mfma_f32_16x16x32_bf16 a[184:187], a[156:159], a[228:231], a[184:187]
v_mfma_f32_16x16x32_bf16 a[116:119], a[228:231], a[196:199], a[116:119]
v_mfma_f32_16x16x32_bf16 a[116:119], a[224:227], a[192:195], a[116:119]
v_mfma_f32_16x16x32_bf16 a[132:135], a[224:227], a[200:203], a[132:135]
v_mfma_f32_16x16x32_bf16 a[132:135], a[228:231], a[204:207], a[132:135]
v_mfma_f32_16x16x32_bf16 v[148:151], a[228:231], a[212:215], v[148:151]
v_mfma_f32_16x16x32_bf16 v[148:151], a[224:227], a[208:211], v[148:151]
v_mfma_f32_16x16x32_bf16 v[164:167], a[224:227], a[216:219], v[164:167]
v_mfma_f32_16x16x32_bf16 v[164:167], a[228:231], a[220:223], v[164:167]
s_waitcnt lgkmcnt(2)
v_mfma_f32_16x16x32_bf16 a[60:63], a[232:235], v[58:61], a[60:63]
s_waitcnt lgkmcnt(0)
v_mfma_f32_16x16x32_bf16 a[60:63], a[236:239], v[62:65], a[60:63]
v_mfma_f32_16x16x32_bf16 a[76:79], a[236:239], v[70:73], a[76:79]
v_mfma_f32_16x16x32_bf16 a[76:79], a[232:235], v[66:69], a[76:79]
v_mfma_f32_16x16x32_bf16 a[92:95], a[232:235], a[240:243], a[92:95]
v_mfma_f32_16x16x32_bf16 a[92:95], a[236:239], a[244:247], a[92:95]
v_mov_b32 v59, 0
v_mfma_f32_16x16x32_bf16 a[108:111], a[236:239], a[252:255], a[108:111]
v_mov_b32_e64 v60, 0
v_mfma_f32_16x16x32_bf16 a[108:111], a[232:235], a[248:251], a[108:111]
v_mfma_f32_16x16x32_bf16 a[188:191], a[156:159], a[232:235], a[188:191]
v_mov_b32_e64 v61, 0
v_mfma_f32_16x16x32_bf16 a[188:191], a[156:159], a[236:239], a[188:191]
v_mfma_f32_16x16x32_bf16 a[124:127], a[236:239], a[196:199], a[124:127]
v_mov_b32_e64 v63, 0
v_mfma_f32_16x16x32_bf16 a[124:127], a[232:235], a[192:195], a[124:127]
v_mov_b32_e64 v64, 0
v_mfma_f32_16x16x32_bf16 a[140:143], a[232:235], a[200:203], a[140:143]
v_mfma_f32_16x16x32_bf16 a[140:143], a[236:239], a[204:207], a[140:143]
v_mov_b32_e64 v65, 0
v_mfma_f32_16x16x32_bf16 v[156:159], a[236:239], a[212:215], v[156:159]
v_mfma_f32_16x16x32_bf16 v[156:159], a[232:235], a[208:211], v[156:159]
v_mfma_f32_16x16x32_bf16 v[172:175], a[232:235], a[216:219], v[172:175]
v_mfma_f32_16x16x32_bf16 v[172:175], a[236:239], a[220:223], v[172:175]
s_waitcnt vmcnt(8)
s_nop 0
v_min3_u32 v74, v40, v41, v42
v_min3_u32 v75, v43, v44, v45
v_min3_u32 v74, v74, v46, v47
v_min3_u32 v75, v75, v48, v49
v_min3_u32 v74, v74, v50, v51
v_min_u32_e64 v74, v74, v75
v_cmp_eq_u32 vcc, 0, v74
s_nop 0
s_and_b32 s40, vcc_lo, 0xffff
s_cselect_b32 s40, 0, s49
s_cmp_lt_u32 s40, 32
s_cbranch_scc1 L_g1_cs_1047
L_g1_ok_1045:
v_lshlrev_b32 v18, 4, v0
v_rcp_f32 v1, v21
v_rcp_f32 v2, v23
v_rcp_f32 v3, v25
v_rcp_f32 v4, v27
v_rcp_f32_e64 v5, v29
s_xor_b32 s47, s37, 0x300000
buffer_load_dwordx4 a[192:195], v18, s[64:67], s47 offen offset:0 sc1
v_rcp_f32 v6, v31
v_rcp_f32 v7, v33
v_rcp_f32_e64 v8, v35
v_mul_f32 v10, 0xbfb8aa3b, v1
v_mul_f32 v11, 0xbfb8aa3b, v2
v_mul_f32 v12, 0xbfb8aa3b, v3
v_mul_f32 v13, 0xbfb8aa3b, v4
v_mul_f32 v14, 0xbfb8aa3b, v5
v_mul_f32 v15, 0xbfb8aa3b, v6
v_mul_f32 v16, 0xbfb8aa3b, v7
v_mul_f32 v17, 0xbfb8aa3b, v8
s_and_b32 s40, s59, 1
s_lshl_b32 s53, s40, 14
s_lshr_b32 s40, s59, 1
s_lshl_b32 s40, s40, 15
buffer_load_dwordx4 a[196:199], v18, s[64:67], s47 offen offset:1024 sc1
s_add_u32 s53, s53, s40
s_lshl_b32 s40, s3, 17
s_add_u32 s53, s53, s40
s_and_b32 s41, s45, 3
s_lshl_b32 s41, s41, 20
s_add_u32 s54, s53, s41
s_add_u32 s54, s54, 0x802000
s_bfe_u32 s41, s2, 0x10003
s_lshl_b32 s41, s41, 20
s_add_u32 s55, s53, s41
s_add_u32 s55, s55, 0x1002000
s_lshl_b32 s40, s58, 9
s_add_u32 s55, s55, s40
v_lshrrev_b32_e64 v76, 5, v0
v_lshl_add_u32 v19, v76, 9, v18
s_xor_b32 s47, s37, 0x380000
buffer_load_dwordx4 a[200:203], v18, s[64:67], s47 offen offset:0 sc1
s_mov_b32 s42, 0xffff0000
v_add_f32 v48, v48, v50
v_add_f32 v49, v49, v51
v_mov_b32_e64 v51, 0
v_accvgpr_read_b32 v74, a176
v_accvgpr_read_b32 v75, a177
v_add_f32 v40, v40, v74
v_add_f32 v41, v41, v75
v_cvt_pk_bf16_f32 v76, v40, v40
v_cvt_pk_bf16_f32 v77, v41, v41
v_and_b32 v76, s42, v76
v_and_b32 v77, s42, v77
v_sub_f32 v76, v40, v76
v_sub_f32 v77, v41, v77
v_cvt_pk_bf16_f32 v40, v40, v76
buffer_load_dwordx4 a[204:207], v18, s[64:67], s47 offen offset:1024 sc1
v_cvt_pk_bf16_f32 v41, v41, v77
v_accvgpr_read_b32 v74, a180
v_accvgpr_read_b32 v75, a181
v_add_f32 v42, v42, v74
v_add_f32 v43, v43, v75
v_cvt_pk_bf16_f32 v76, v42, v42
v_cvt_pk_bf16_f32 v77, v43, v43
v_and_b32 v76, s42, v76
v_and_b32 v77, s42, v77
v_sub_f32 v76, v42, v76
v_sub_f32 v77, v43, v77
v_cvt_pk_bf16_f32 v42, v42, v76
v_cvt_pk_bf16_f32 v43, v43, v77
v_accvgpr_read_b32 v74, a184
v_accvgpr_read_b32 v75, a185
s_xor_b32 s47, s37, 0x400000
buffer_load_dwordx4 a[208:211], v18, s[64:67], s47 offen offset:0 sc1
v_add_f32 v44, v44, v74
v_add_f32 v45, v45, v75
v_cvt_pk_bf16_f32 v76, v44, v44
v_cvt_pk_bf16_f32 v77, v45, v45
v_and_b32 v76, s42, v76
v_and_b32 v77, s42, v77
v_sub_f32 v76, v44, v76
v_sub_f32 v77, v45, v77
v_cvt_pk_bf16_f32 v44, v44, v76
v_cvt_pk_bf16_f32 v45, v45, v77
v_accvgpr_read_b32 v74, a188
v_accvgpr_read_b32 v75, a189
v_add_f32 v46, v46, v74
v_add_f32 v47, v47, v75
v_cvt_pk_bf16_f32 v76, v46, v46
buffer_load_dwordx4 a[212:215], v18, s[64:67], s47 offen offset:1024 sc1
v_cvt_pk_bf16_f32 v77, v47, v47
v_and_b32 v76, s42, v76
v_and_b32 v77, s42, v77
v_sub_f32 v76, v46, v76
v_sub_f32 v77, v47, v77
v_cvt_pk_bf16_f32 v46, v46, v76
v_cvt_pk_bf16_f32 v47, v47, v77
v_accvgpr_read_b32 v74, a148
v_accvgpr_read_b32 v75, a149
v_add_f32 v48, v48, v74
v_add_f32 v49, v49, v75
v_cvt_pk_bf16_f32 v76, v48, v48
v_cvt_pk_bf16_f32 v77, v49, v49
v_and_b32 v76, s42, v76
v_and_b32 v77, s42, v77
s_xor_b32 s47, s37, 0x500000
buffer_load_dwordx4 a[216:219], v18, s[64:67], s47 offen offset:0 sc1
v_sub_f32 v76, v48, v76
v_sub_f32 v77, v49, v77
v_cvt_pk_bf16_f32 v48, v48, v76
v_cvt_pk_bf16_f32 v49, v49, v77
v_mov_b32 v50, v40
v_mov_b32 v54, v41
v_mov_b32 v58, v42
v_mov_b32 v62, v43
v_mfma_f32_16x16x32_bf16 v[80:83], v[50:53], v[20:23], v[80:83]
v_mfma_f32_16x16x32_bf16 v[84:87], v[54:57], v[20:23], v[84:87]
v_mfma_f32_16x16x32_bf16 v[88:91], v[58:61], v[20:23], v[88:91]
v_mfma_f32_16x16x32_bf16 v[92:95], v[62:65], v[20:23], v[92:95]
s_nop 4
v_pk_mul_f32 v[80:81], v[80:81], v[10:11] op_sel:[0,0] op_sel_hi:[1,0]
s_nop 0
v_pk_mul_f32 v[88:89], v[88:89], v[10:11] op_sel:[0,0] op_sel_hi:[1,0]
v_pk_mul_f32 v[82:83], v[82:83], v[10:11] op_sel:[0,0] op_sel_hi:[1,0]
buffer_load_dwordx4 a[220:223], v18, s[64:67], s47 offen offset:1024 sc1
v_pk_mul_f32 v[90:91], v[90:91], v[10:11] op_sel:[0,0] op_sel_hi:[1,0]
v_exp_f32_e64 v80, v80
v_mfma_f32_16x16x32_bf16 v[96:99], v[50:53], v[22:25], v[96:99]
v_exp_f32_e64 v88, v88
v_mfma_f32_16x16x32_bf16 v[100:103], v[54:57], v[22:25], v[100:103]
v_exp_f32 v81, v81
v_exp_f32 v89, v89
v_exp_f32 v82, v82
v_exp_f32 v90, v90
v_exp_f32_e64 v83, v83
v_mfma_f32_16x16x32_bf16 v[104:107], v[58:61], v[22:25], v[104:107]
v_exp_f32_e64 v91, v91
v_pk_fma_f32 v[80:81], v[80:81], v[20:21], v[20:21] op_sel:[0,1,1] op_sel_hi:[1,1,1]
v_pk_fma_f32 v[88:89], v[88:89], v[20:21], v[20:21] op_sel:[0,1,1] op_sel_hi:[1,1,1]
v_pk_fma_f32 v[82:83], v[82:83], v[20:21], v[20:21] op_sel:[0,1,1] op_sel_hi:[1,1,1]
s_xor_b32 s47, s37, 0x700000
buffer_load_dwordx4 a[224:227], v18, s[64:67], s47 offen offset:0 sc1
v_pk_fma_f32 v[90:91], v[90:91], v[20:21], v[20:21] op_sel:[0,1,1] op_sel_hi:[1,1,1]
v_rcp_f32_e64 v80, v80
v_mfma_f32_16x16x32_bf16 v[108:111], v[62:65], v[22:25], v[108:111]
v_rcp_f32 v88, v88
v_rcp_f32 v81, v81
v_rcp_f32 v89, v89
v_rcp_f32 v82, v82
v_rcp_f32 v90, v90
v_rcp_f32 v83, v83
v_rcp_f32_e64 v91, v91
v_pk_mul_f32 v[84:85], v[84:85], v[80:81]
v_pk_mul_f32 v[92:93], v[92:93], v[88:89]
v_pk_mul_f32 v[86:87], v[86:87], v[82:83]
v_pk_mul_f32 v[94:95], v[94:95], v[90:91]
s_add_u32 s40, s54, 0
s_nop 0
buffer_load_dwordx4 a[228:231], v18, s[64:67], s47 offen offset:1024 sc1
v_cvt_pk_bf16_f32 v80, v84, v85
v_cvt_pk_bf16_f32 v82, v92, v93
v_cvt_pk_bf16_f32 v81, v86, v87
v_cvt_pk_bf16_f32 v83, v94, v95
buffer_store_dwordx4 v[80:83], v18, s[20:23], s40 offen sc1
v_pk_mul_f32 v[96:97], v[96:97], v[10:11] op_sel:[0,1] op_sel_hi:[1,1]
v_pk_mul_f32 v[104:105], v[104:105], v[10:11] op_sel:[0,1] op_sel_hi:[1,1]
v_pk_mul_f32 v[98:99], v[98:99], v[10:11] op_sel:[0,1] op_sel_hi:[1,1]
v_pk_mul_f32 v[106:107], v[106:107], v[10:11] op_sel:[0,1] op_sel_hi:[1,1]
v_exp_f32_e64 v96, v96
v_mfma_f32_16x16x32_bf16 v[240:243], v[50:53], v[24:27], v[240:243]
v_exp_f32_e64 v104, v104
v_mfma_f32_16x16x32_bf16 v[244:247], v[54:57], v[24:27], v[244:247]
v_exp_f32 v97, v97
v_exp_f32 v105, v105
s_xor_b32 s47, s37, 0x800000
buffer_load_dwordx4 a[232:235], v18, s[64:67], s47 offen offset:0 sc1
v_exp_f32 v98, v98
v_exp_f32 v106, v106
v_exp_f32_e64 v99, v99
v_mfma_f32_16x16x32_bf16 v[248:251], v[58:61], v[24:27], v[248:251]
v_exp_f32_e64 v107, v107
v_pk_fma_f32 v[96:97], v[96:97], v[22:23], v[22:23] op_sel:[0,1,1] op_sel_hi:[1,1,1]
v_pk_fma_f32 v[104:105], v[104:105], v[22:23], v[22:23] op_sel:[0,1,1] op_sel_hi:[1,1,1]
v_pk_fma_f32 v[98:99], v[98:99], v[22:23], v[22:23] op_sel:[0,1,1] op_sel_hi:[1,1,1]
v_pk_fma_f32 v[106:107], v[106:107], v[22:23], v[22:23] op_sel:[0,1,1] op_sel_hi:[1,1,1]
v_rcp_f32_e64 v96, v96
v_mfma_f32_16x16x32_bf16 v[252:255], v[62:65], v[24:27], v[252:255]
v_rcp_f32 v104, v104
v_rcp_f32 v97, v97
v_rcp_f32 v105, v105
v_rcp_f32 v98, v98
buffer_load_dwordx4 a[236:239], v18, s[64:67], s47 offen offset:1024 sc1
v_rcp_f32 v106, v106
v_rcp_f32 v99, v99
v_rcp_f32_e64 v107, v107
v_pk_mul_f32 v[100:101], v[100:101], v[96:97]
v_pk_mul_f32 v[108:109], v[108:109], v[104:105]
v_pk_mul_f32 v[102:103], v[102:103], v[98:99]
v_pk_mul_f32 v[110:111], v[110:111], v[106:107]
s_add_u32 s40, s54, 1024
v_cvt_pk_bf16_f32 v96, v100, v101
v_cvt_pk_bf16_f32 v98, v108, v109
v_cvt_pk_bf16_f32 v97, v102, v103
v_cvt_pk_bf16_f32 v99, v110, v111
buffer_store_dwordx4 v[96:99], v18, s[20:23], s40 offen sc1
v_pk_mul_f32 v[240:241], v[240:241], v[12:13] op_sel:[0,0] op_sel_hi:[1,0]
v_pk_mul_f32 v[248:249], v[248:249], v[12:13] op_sel:[0,0] op_sel_hi:[1,0]
s_xor_b32 s47, s37, 0x220000
buffer_load_dwordx4 a[240:243], v18, s[64:67], s47 offen offset:0 sc1
v_pk_mul_f32 v[242:243], v[242:243], v[12:13] op_sel:[0,0] op_sel_hi:[1,0]
v_pk_mul_f32 v[250:251], v[250:251], v[12:13] op_sel:[0,0] op_sel_hi:[1,0]
v_exp_f32_e64 v240, v240
v_mfma_f32_16x16x32_bf16 v[112:115], v[50:53], v[26:29], v[112:115]
v_exp_f32_e64 v248, v248
v_mfma_f32_16x16x32_bf16 v[116:119], v[54:57], v[26:29], v[116:119]
v_exp_f32 v241, v241
v_exp_f32 v249, v249
v_exp_f32 v242, v242
v_exp_f32 v250, v250
v_exp_f32_e64 v243, v243
v_mfma_f32_16x16x32_bf16 v[120:123], v[58:61], v[26:29], v[120:123]
v_exp_f32_e64 v251, v251
v_pk_fma_f32 v[240:241], v[240:241], v[24:25], v[24:25] op_sel:[0,1,1] op_sel_hi:[1,1,1]
v_pk_fma_f32 v[248:249], v[248:249], v[24:25], v[24:25] op_sel:[0,1,1] op_sel_hi:[1,1,1]
buffer_load_dwordx4 a[244:247], v18, s[64:67], s47 offen offset:1024 sc1
v_pk_fma_f32 v[242:243], v[242:243], v[24:25], v[24:25] op_sel:[0,1,1] op_sel_hi:[1,1,1]
v_pk_fma_f32 v[250:251], v[250:251], v[24:25], v[24:25] op_sel:[0,1,1] op_sel_hi:[1,1,1]
v_rcp_f32_e64 v240, v240
v_mfma_f32_16x16x32_bf16 v[124:127], v[62:65], v[26:29], v[124:127]
v_rcp_f32 v248, v248
v_rcp_f32 v241, v241
v_rcp_f32 v249, v249
v_rcp_f32 v242, v242
v_rcp_f32 v250, v250
v_rcp_f32 v243, v243
v_rcp_f32_e64 v251, v251
v_pk_mul_f32 v[244:245], v[244:245], v[240:241]
v_pk_mul_f32 v[252:253], v[252:253], v[248:249]
v_pk_mul_f32 v[246:247], v[246:247], v[242:243]
v_pk_mul_f32 v[254:255], v[254:255], v[250:251]
s_xor_b32 s47, s37, 0x2a0000
buffer_load_dwordx4 a[248:251], v18, s[64:67], s47 offen offset:0 sc1
s_add_u32 s40, s54, 2048
v_cvt_pk_bf16_f32 v240, v244, v245
v_cvt_pk_bf16_f32 v242, v252, v253
v_cvt_pk_bf16_f32 v241, v246, v247
v_cvt_pk_bf16_f32 v243, v254, v255
buffer_store_dwordx4 v[240:243], v18, s[20:23], s40 offen sc1
v_pk_mul_f32 v[112:113], v[112:113], v[12:13] op_sel:[0,1] op_sel_hi:[1,1]
v_pk_mul_f32 v[120:121], v[120:121], v[12:13] op_sel:[0,1] op_sel_hi:[1,1]
v_pk_mul_f32 v[114:115], v[114:115], v[12:13] op_sel:[0,1] op_sel_hi:[1,1]
v_pk_mul_f32 v[122:123], v[122:123], v[12:13] op_sel:[0,1] op_sel_hi:[1,1]
v_exp_f32_e64 v112, v112
v_mfma_f32_16x16x32_bf16 v[128:131], v[50:53], v[28:31], v[128:131]
v_exp_f32_e64 v120, v120
v_mfma_f32_16x16x32_bf16 v[132:135], v[54:57], v[28:31], v[132:135]
v_exp_f32_e64 v113, v113
buffer_load_dwordx4 a[252:255], v18, s[64:67], s47 offen offset:1024 sc1
v_exp_f32 v121, v121
v_exp_f32 v114, v114
v_exp_f32 v122, v122
v_exp_f32 v115, v115
v_mfma_f32_16x16x32_bf16 v[136:139], v[58:61], v[28:31], v[136:139]
v_exp_f32_e64 v123, v123
v_pk_fma_f32 v[112:113], v[112:113], v[26:27], v[26:27] op_sel:[0,1,1] op_sel_hi:[1,1,1]
v_pk_fma_f32 v[120:121], v[120:121], v[26:27], v[26:27] op_sel:[0,1,1] op_sel_hi:[1,1,1]
v_pk_fma_f32 v[114:115], v[114:115], v[26:27], v[26:27] op_sel:[0,1,1] op_sel_hi:[1,1,1]
v_pk_fma_f32 v[122:123], v[122:123], v[26:27], v[26:27] op_sel:[0,1,1] op_sel_hi:[1,1,1]
v_rcp_f32_e64 v112, v112
v_mfma_f32_16x16x32_bf16 v[140:143], v[62:65], v[28:31], v[140:143]
v_rcp_f32 v120, v120
v_rcp_f32 v113, v113
v_rcp_f32_e64 v121, v121
s_xor_b32 s47, s37, 0x200000
buffer_load_dwordx4 a[176:179], v18, s[64:67], s47 offen offset:0 sc1
v_rcp_f32 v114, v114
v_rcp_f32 v122, v122
v_rcp_f32 v115, v115
v_rcp_f32 v123, v123
v_pk_mul_f32 v[116:117], v[116:117], v[112:113]
v_pk_mul_f32 v[124:125], v[124:125], v[120:121]
v_pk_mul_f32 v[118:119], v[118:119], v[114:115]
v_pk_mul_f32 v[126:127], v[126:127], v[122:123]
s_add_u32 s40, s54, 3072
v_cvt_pk_bf16_f32 v112, v116, v117
v_cvt_pk_bf16_f32 v114, v124, v125
v_cvt_pk_bf16_f32 v113, v118, v119
v_cvt_pk_bf16_f32 v115, v126, v127
buffer_store_dwordx4 v[112:115], v18, s[20:23], s40 offen sc1
v_pk_mul_f32 v[128:129], v[128:129], v[14:15] op_sel:[0,0] op_sel_hi:[1,0]
buffer_load_dwordx4 a[180:183], v18, s[64:67], s47 offen offset:1024 sc1
v_pk_mul_f32 v[136:137], v[136:137], v[14:15] op_sel:[0,0] op_sel_hi:[1,0]
v_pk_mul_f32 v[130:131], v[130:131], v[14:15] op_sel:[0,0] op_sel_hi:[1,0]
v_pk_mul_f32 v[138:139], v[138:139], v[14:15] op_sel:[0,0] op_sel_hi:[1,0]
v_exp_f32_e64 v128, v128
v_mfma_f32_16x16x32_bf16 a[0:3], v[50:53], v[30:33], a[0:3]
v_exp_f32_e64 v136, v136
v_mfma_f32_16x16x32_bf16 a[4:7], v[54:57], v[30:33], a[4:7]
v_exp_f32 v129, v129
v_exp_f32 v137, v137
v_exp_f32 v130, v130
v_exp_f32 v138, v138
v_exp_f32_e64 v131, v131
v_mfma_f32_16x16x32_bf16 a[8:11], v[58:61], v[30:33], a[8:11]
v_exp_f32_e64 v139, v139
v_pk_fma_f32 v[128:129], v[128:129], v[28:29], v[28:29] op_sel:[0,1,1] op_sel_hi:[1,1,1]
s_xor_b32 s47, s37, 0x280000
buffer_load_dwordx4 a[184:187], v18, s[64:67], s47 offen offset:0 sc1
v_pk_fma_f32 v[136:137], v[136:137], v[28:29], v[28:29] op_sel:[0,1,1] op_sel_hi:[1,1,1]
v_pk_fma_f32 v[130:131], v[130:131], v[28:29], v[28:29] op_sel:[0,1,1] op_sel_hi:[1,1,1]
v_pk_fma_f32 v[138:139], v[138:139], v[28:29], v[28:29] op_sel:[0,1,1] op_sel_hi:[1,1,1]
v_rcp_f32_e64 v128, v128
v_mfma_f32_16x16x32_bf16 a[12:15], v[62:65], v[30:33], a[12:15]
v_rcp_f32 v136, v136
v_rcp_f32 v129, v129
v_rcp_f32 v137, v137
v_rcp_f32 v130, v130
v_rcp_f32 v138, v138
v_rcp_f32 v131, v131
v_rcp_f32_e64 v139, v139
v_pk_mul_f32 v[132:133], v[132:133], v[128:129]
v_pk_mul_f32 v[140:141], v[140:141], v[136:137]
v_pk_mul_f32 v[134:135], v[134:135], v[130:131]
buffer_load_dwordx4 a[188:191], v18, s[64:67], s47 offen offset:1024 sc1
v_pk_mul_f32 v[142:143], v[142:143], v[138:139]
s_add_u32 s40, s54, 4096
v_cvt_pk_bf16_f32 v128, v132, v133
v_cvt_pk_bf16_f32 v130, v140, v141
v_cvt_pk_bf16_f32 v129, v134, v135
v_cvt_pk_bf16_f32 v131, v142, v143
buffer_store_dwordx4 v[128:131], v18, s[20:23], s40 offen sc1
v_accvgpr_read_b32 v96, a0
v_accvgpr_read_b32 v97, a1
v_mfma_f32_16x16x32_bf16 a[16:19], v[50:53], v[32:35], a[16:19]
v_accvgpr_read_b32 v98, a2
v_accvgpr_read_b32 v99, a3
v_accvgpr_read_b32 v100, a4
v_accvgpr_read_b32 v101, a5
v_accvgpr_read_b32 v102, a6
v_accvgpr_read_b32 v103, a7
v_accvgpr_read_b32 v104, a8
v_mfma_f32_16x16x32_bf16 a[20:23], v[54:57], v[32:35], a[20:23]
v_accvgpr_read_b32 v105, a9
v_accvgpr_read_b32 v106, a10
s_waitcnt vmcnt(25)
s_nop 0
v_accvgpr_read_b32 v107, a11
v_accvgpr_read_b32 v240, a160
v_accvgpr_read_b32 v241, a161
v_accvgpr_read_b32 v242, a162
v_accvgpr_read_b32 v243, a163
v_accvgpr_read_b32 v108, a12
v_accvgpr_read_b32 v109, a13
v_accvgpr_read_b32 v110, a14
v_accvgpr_read_b32 v111, a15
v_accvgpr_read_b32 v244, a164
v_accvgpr_read_b32 v245, a165
v_accvgpr_read_b32 v246, a166
v_accvgpr_read_b32 v247, a167
v_mfma_f32_16x16x32_bf16 a[24:27], v[58:61], v[32:35], a[24:27]
v_pk_mul_f32 v[96:97], v[96:97], v[14:15] op_sel:[0,1] op_sel_hi:[1,1]
v_pk_mul_f32 v[104:105], v[104:105], v[14:15] op_sel:[0,1] op_sel_hi:[1,1]
v_pk_mul_f32 v[98:99], v[98:99], v[14:15] op_sel:[0,1] op_sel_hi:[1,1]
v_accvgpr_read_b32 v248, a168
v_accvgpr_read_b32 v249, a169
v_accvgpr_read_b32 v250, a170
v_accvgpr_read_b32 v251, a171
v_pk_mul_f32 v[106:107], v[106:107], v[14:15] op_sel:[0,1] op_sel_hi:[1,1]
s_xor_b32 s47, s37, 0x320000
buffer_load_dwordx4 a[0:3], v18, s[64:67], s47 offen offset:0 sc1
v_exp_f32 v96, v96
v_exp_f32 v104, v104
v_exp_f32_e64 v97, v97
v_accvgpr_read_b32 v252, a172
v_accvgpr_read_b32 v253, a173
v_accvgpr_read_b32 v254, a174
v_accvgpr_read_b32 v255, a175
v_mfma_f32_16x16x32_bf16 a[28:31], v[62:65], v[32:35], a[28:31]
v_exp_f32 v105, v105
v_exp_f32 v98, v98
v_exp_f32 v106, v106
v_exp_f32 v99, v99
v_exp_f32_e64 v107, v107
v_pk_fma_f32 v[96:97], v[96:97], v[30:31], v[30:31] op_sel:[0,1,1] op_sel_hi:[1,1,1]
v_pk_fma_f32 v[104:105], v[104:105], v[30:31], v[30:31] op_sel:[0,1,1] op_sel_hi:[1,1,1]
v_pk_fma_f32 v[98:99], v[98:99], v[30:31], v[30:31] op_sel:[0,1,1] op_sel_hi:[1,1,1]
v_pk_fma_f32 v[106:107], v[106:107], v[30:31], v[30:31] op_sel:[0,1,1] op_sel_hi:[1,1,1]
v_rcp_f32 v96, v96
v_rcp_f32 v104, v104
buffer_load_dwordx4 a[4:7], v18, s[64:67], s47 offen offset:1024 sc1
v_rcp_f32 v97, v97
v_rcp_f32 v105, v105
v_rcp_f32 v98, v98
v_rcp_f32 v106, v106
v_rcp_f32 v99, v99
v_rcp_f32 v107, v107
v_pk_mul_f32 v[100:101], v[100:101], v[96:97]
v_pk_mul_f32 v[108:109], v[108:109], v[104:105]
v_pk_mul_f32 v[102:103], v[102:103], v[98:99]
v_pk_mul_f32 v[110:111], v[110:111], v[106:107]
s_add_u32 s40, s54, 5120
v_cvt_pk_bf16_f32 v96, v100, v101
v_cvt_pk_bf16_f32 v98, v108, v109
v_cvt_pk_bf16_f32 v97, v102, v103
v_cvt_pk_bf16_f32 v99, v110, v111
s_xor_b32 s47, s37, 0x3a0000
buffer_load_dwordx4 a[8:11], v18, s[64:67], s47 offen offset:0 sc1
buffer_store_dwordx4 v[96:99], v18, s[20:23], s40 offen sc1
v_accvgpr_read_b32 v80, a16
v_accvgpr_read_b32 v81, a17
v_mfma_f32_16x16x32_bf16 a[32:35], v[50:53], v[34:37], a[32:35]
v_accvgpr_read_b32 v82, a18
v_accvgpr_read_b32 v83, a19
v_accvgpr_read_b32 v84, a20
v_accvgpr_read_b32 v85, a21
v_accvgpr_read_b32 v86, a22
v_accvgpr_read_b32 v87, a23
v_accvgpr_read_b32 v88, a24
v_mfma_f32_16x16x32_bf16 a[36:39], v[54:57], v[34:37], a[36:39]
v_accvgpr_read_b32 v89, a25
v_accvgpr_read_b32 v90, a26
v_accvgpr_read_b32 v91, a27
buffer_load_dwordx4 a[12:15], v18, s[64:67], s47 offen offset:1024 sc1
v_accvgpr_read_b32 v92, a28
v_accvgpr_read_b32 v93, a29
v_accvgpr_read_b32 v94, a30
v_accvgpr_read_b32 v95, a31
v_mfma_f32_16x16x32_bf16 a[40:43], v[58:61], v[34:37], a[40:43]
v_pk_mul_f32 v[80:81], v[80:81], v[16:17] op_sel:[0,0] op_sel_hi:[1,0]
v_pk_mul_f32 v[88:89], v[88:89], v[16:17] op_sel:[0,0] op_sel_hi:[1,0]
v_pk_mul_f32 v[82:83], v[82:83], v[16:17] op_sel:[0,0] op_sel_hi:[1,0]
v_pk_mul_f32 v[90:91], v[90:91], v[16:17] op_sel:[0,0] op_sel_hi:[1,0]
v_exp_f32 v80, v80
v_exp_f32 v88, v88
v_exp_f32_e64 v81, v81
v_mfma_f32_16x16x32_bf16 a[44:47], v[62:65], v[34:37], a[44:47]
v_exp_f32 v89, v89
v_exp_f32 v82, v82
s_xor_b32 s47, s37, 0x420000
buffer_load_dwordx4 a[16:19], v18, s[64:67], s47 offen offset:0 sc1
v_exp_f32 v90, v90
v_exp_f32 v83, v83
v_exp_f32_e64 v91, v91
v_pk_fma_f32 v[80:81], v[80:81], v[32:33], v[32:33] op_sel:[0,1,1] op_sel_hi:[1,1,1]
v_pk_fma_f32 v[88:89], v[88:89], v[32:33], v[32:33] op_sel:[0,1,1] op_sel_hi:[1,1,1]
v_pk_fma_f32 v[82:83], v[82:83], v[32:33], v[32:33] op_sel:[0,1,1] op_sel_hi:[1,1,1]
v_pk_fma_f32 v[90:91], v[90:91], v[32:33], v[32:33] op_sel:[0,1,1] op_sel_hi:[1,1,1]
v_rcp_f32 v80, v80
v_rcp_f32 v88, v88
v_rcp_f32 v81, v81
v_rcp_f32 v89, v89
v_rcp_f32 v82, v82
v_rcp_f32 v90, v90
v_rcp_f32 v83, v83
v_rcp_f32 v91, v91
buffer_load_dwordx4 a[20:23], v18, s[64:67], s47 offen offset:1024 sc1
v_pk_mul_f32 v[84:85], v[84:85], v[80:81]
v_pk_mul_f32 v[92:93], v[92:93], v[88:89]
v_pk_mul_f32 v[86:87], v[86:87], v[82:83]
v_pk_mul_f32 v[94:95], v[94:95], v[90:91]
s_add_u32 s40, s54, 6144
v_cvt_pk_bf16_f32 v80, v84, v85
v_cvt_pk_bf16_f32 v82, v92, v93
v_cvt_pk_bf16_f32 v81, v86, v87
v_cvt_pk_bf16_f32 v83, v94, v95
buffer_store_dwordx4 v[80:83], v18, s[20:23], s40 offen sc1
v_accvgpr_read_b32 v96, a32
v_accvgpr_read_b32 v97, a33
v_mov_b32_e64 v50, v44
v_accvgpr_read_b32 v98, a34
v_accvgpr_read_b32 v99, a35
s_xor_b32 s47, s37, 0x520000
buffer_load_dwordx4 a[24:27], v18, s[64:67], s47 offen offset:0 sc1
v_accvgpr_read_b32 v100, a36
v_mov_b32_e64 v54, v45
v_accvgpr_read_b32 v101, a37
v_accvgpr_read_b32 v102, a38
v_accvgpr_read_b32 v103, a39
v_accvgpr_read_b32 v104, a40
v_mov_b32_e64 v58, v46
v_accvgpr_read_b32 v105, a41
v_accvgpr_read_b32 v106, a42
v_accvgpr_read_b32 v107, a43
v_mov_b32_e64 v62, v47
v_accvgpr_read_b32 v108, a44
v_accvgpr_read_b32 v109, a45
v_accvgpr_read_b32 v110, a46
v_accvgpr_read_b32 v111, a47
buffer_load_dwordx4 a[28:31], v18, s[64:67], s47 offen offset:1024 sc1
v_mfma_f32_16x16x32_bf16 a[48:51], v[50:53], v[20:23], a[48:51]
v_pk_mul_f32 v[96:97], v[96:97], v[16:17] op_sel:[0,1] op_sel_hi:[1,1]
v_pk_mul_f32 v[104:105], v[104:105], v[16:17] op_sel:[0,1] op_sel_hi:[1,1]
v_pk_mul_f32 v[98:99], v[98:99], v[16:17] op_sel:[0,1] op_sel_hi:[1,1]
v_pk_mul_f32 v[106:107], v[106:107], v[16:17] op_sel:[0,1] op_sel_hi:[1,1]
v_exp_f32_e64 v96, v96
v_mfma_f32_16x16x32_bf16 a[52:55], v[54:57], v[20:23], a[52:55]
v_exp_f32 v104, v104
v_exp_f32 v97, v97
v_mfma_f32_16x16x32_bf16 a[56:59], v[58:61], v[20:23], a[56:59]
v_exp_f32 v105, v105
v_exp_f32 v98, v98
v_exp_f32_e64 v106, v106
v_mfma_f32_16x16x32_bf16 a[60:63], v[62:65], v[20:23], a[60:63]
v_exp_f32_e64 v99, v99
s_xor_b32 s47, s37, 0x720000
buffer_load_dwordx4 a[32:35], v18, s[64:67], s47 offen offset:0 sc1
v_exp_f32_e64 v107, v107
v_pk_fma_f32 v[96:97], v[96:97], v[34:35], v[34:35] op_sel:[0,1,1] op_sel_hi:[1,1,1]
v_pk_fma_f32 v[104:105], v[104:105], v[34:35], v[34:35] op_sel:[0,1,1] op_sel_hi:[1,1,1]
v_pk_fma_f32 v[98:99], v[98:99], v[34:35], v[34:35] op_sel:[0,1,1] op_sel_hi:[1,1,1]
v_pk_fma_f32 v[106:107], v[106:107], v[34:35], v[34:35] op_sel:[0,1,1] op_sel_hi:[1,1,1]
v_rcp_f32 v96, v96
v_rcp_f32 v104, v104
v_rcp_f32 v97, v97
v_rcp_f32 v105, v105
v_rcp_f32 v98, v98
v_rcp_f32 v106, v106
v_rcp_f32 v99, v99
v_rcp_f32 v107, v107
v_pk_mul_f32 v[100:101], v[100:101], v[96:97]
v_pk_mul_f32 v[108:109], v[108:109], v[104:105]
buffer_load_dwordx4 a[36:39], v18, s[64:67], s47 offen offset:1024 sc1
v_pk_mul_f32 v[102:103], v[102:103], v[98:99]
v_pk_mul_f32 v[110:111], v[110:111], v[106:107]
s_add_u32 s40, s54, 7168
v_cvt_pk_bf16_f32 v96, v100, v101
v_cvt_pk_bf16_f32 v98, v108, v109
v_cvt_pk_bf16_f32 v97, v102, v103
v_cvt_pk_bf16_f32 v99, v110, v111
buffer_store_dwordx4 v[96:99], v18, s[20:23], s40 offen sc1
v_accvgpr_read_b32 v80, a48
v_accvgpr_read_b32 v81, a49
v_mfma_f32_16x16x32_bf16 a[64:67], v[50:53], v[22:25], a[64:67]
v_accvgpr_read_b32 v82, a50
v_accvgpr_read_b32 v83, a51
v_accvgpr_read_b32 v84, a52
v_accvgpr_read_b32 v85, a53
s_xor_b32 s47, s37, 0x820000
buffer_load_dwordx4 a[40:43], v18, s[64:67], s47 offen offset:0 sc1
v_accvgpr_read_b32 v86, a54
v_accvgpr_read_b32 v87, a55
v_accvgpr_read_b32 v88, a56
v_mfma_f32_16x16x32_bf16 a[68:71], v[54:57], v[22:25], a[68:71]
v_accvgpr_read_b32 v89, a57
v_accvgpr_read_b32 v90, a58
v_accvgpr_read_b32 v91, a59
v_accvgpr_read_b32 v92, a60
v_accvgpr_read_b32 v93, a61
v_accvgpr_read_b32 v94, a62
v_accvgpr_read_b32 v95, a63
v_mfma_f32_16x16x32_bf16 a[72:75], v[58:61], v[22:25], a[72:75]
v_pk_mul_f32 v[80:81], v[80:81], v[10:11] op_sel:[0,0] op_sel_hi:[1,0]
v_pk_mul_f32 v[88:89], v[88:89], v[10:11] op_sel:[0,0] op_sel_hi:[1,0]
v_pk_mul_f32 v[82:83], v[82:83], v[10:11] op_sel:[0,0] op_sel_hi:[1,0]
buffer_load_dwordx4 a[44:47], v18, s[64:67], s47 offen offset:1024 sc1
v_pk_mul_f32 v[90:91], v[90:91], v[10:11] op_sel:[0,0] op_sel_hi:[1,0]
v_exp_f32 v80, v80
v_exp_f32 v88, v88
v_exp_f32_e64 v81, v81
v_mfma_f32_16x16x32_bf16 a[76:79], v[62:65], v[22:25], a[76:79]
v_exp_f32 v89, v89
v_exp_f32 v82, v82
v_exp_f32 v90, v90
v_exp_f32 v83, v83
v_exp_f32_e64 v91, v91
v_pk_fma_f32 v[80:81], v[80:81], v[20:21], v[20:21] op_sel:[0,1,1] op_sel_hi:[1,1,1]
v_pk_fma_f32 v[88:89], v[88:89], v[20:21], v[20:21] op_sel:[0,1,1] op_sel_hi:[1,1,1]
v_pk_fma_f32 v[82:83], v[82:83], v[20:21], v[20:21] op_sel:[0,1,1] op_sel_hi:[1,1,1]
v_pk_fma_f32 v[90:91], v[90:91], v[20:21], v[20:21] op_sel:[0,1,1] op_sel_hi:[1,1,1]
v_rcp_f32_e64 v80, v80
s_xor_b32 s47, s37, 0x440000
buffer_load_dwordx4 a[48:51], v18, s[64:67], s47 offen offset:0 sc1
v_rcp_f32 v88, v88
v_rcp_f32 v81, v81
v_rcp_f32 v89, v89
v_rcp_f32 v82, v82
v_rcp_f32 v90, v90
v_rcp_f32 v83, v83
v_rcp_f32_e64 v91, v91
v_pk_mul_f32 v[84:85], v[84:85], v[80:81]
v_pk_mul_f32 v[92:93], v[92:93], v[88:89]
v_pk_mul_f32 v[86:87], v[86:87], v[82:83]
v_pk_mul_f32 v[94:95], v[94:95], v[90:91]
s_add_u32 s40, s54, 4286578688
v_cvt_pk_bf16_f32 v80, v84, v85
v_cvt_pk_bf16_f32 v82, v92, v93
v_cvt_pk_bf16_f32 v81, v86, v87
buffer_load_dwordx4 a[52:55], v18, s[64:67], s47 offen offset:1024 sc1
v_cvt_pk_bf16_f32 v83, v94, v95
buffer_store_dwordx4 v[80:83], v18, s[20:23], s40 offen sc1
v_accvgpr_read_b32 v96, a64
v_accvgpr_read_b32 v97, a65
v_mfma_f32_16x16x32_bf16 a[80:83], v[50:53], v[24:27], a[80:83]
v_accvgpr_read_b32 v98, a66
v_accvgpr_read_b32 v99, a67
v_accvgpr_read_b32 v100, a68
v_accvgpr_read_b32 v101, a69
v_accvgpr_read_b32 v102, a70
v_accvgpr_read_b32 v103, a71
v_accvgpr_read_b32 v104, a72
v_mfma_f32_16x16x32_bf16 a[84:87], v[54:57], v[24:27], a[84:87]
v_accvgpr_read_b32 v105, a73
v_accvgpr_read_b32 v106, a74
s_xor_b32 s47, s37, 0x540000
buffer_load_dwordx4 a[56:59], v18, s[64:67], s47 offen offset:0 sc1
v_accvgpr_read_b32 v107, a75
v_accvgpr_read_b32 v108, a76
v_accvgpr_read_b32 v109, a77
v_accvgpr_read_b32 v110, a78
v_accvgpr_read_b32 v111, a79
v_mfma_f32_16x16x32_bf16 a[88:91], v[58:61], v[24:27], a[88:91]
v_pk_mul_f32 v[96:97], v[96:97], v[10:11] op_sel:[0,1] op_sel_hi:[1,1]
v_pk_mul_f32 v[104:105], v[104:105], v[10:11] op_sel:[0,1] op_sel_hi:[1,1]
v_pk_mul_f32 v[98:99], v[98:99], v[10:11] op_sel:[0,1] op_sel_hi:[1,1]
v_pk_mul_f32 v[106:107], v[106:107], v[10:11] op_sel:[0,1] op_sel_hi:[1,1]
v_exp_f32 v96, v96
v_exp_f32 v104, v104
v_exp_f32_e64 v97, v97
v_mfma_f32_16x16x32_bf16 a[92:95], v[62:65], v[24:27], a[92:95]
v_exp_f32_e64 v105, v105
buffer_load_dwordx4 a[60:63], v18, s[64:67], s47 offen offset:1024 sc1
v_exp_f32 v98, v98
v_exp_f32 v106, v106
v_exp_f32 v99, v99
v_exp_f32 v107, v107
v_pk_fma_f32 v[96:97], v[96:97], v[22:23], v[22:23] op_sel:[0,1,1] op_sel_hi:[1,1,1]
v_pk_fma_f32 v[104:105], v[104:105], v[22:23], v[22:23] op_sel:[0,1,1] op_sel_hi:[1,1,1]
v_pk_fma_f32 v[98:99], v[98:99], v[22:23], v[22:23] op_sel:[0,1,1] op_sel_hi:[1,1,1]
v_pk_fma_f32 v[106:107], v[106:107], v[22:23], v[22:23] op_sel:[0,1,1] op_sel_hi:[1,1,1]
v_rcp_f32 v96, v96
v_rcp_f32 v104, v104
v_rcp_f32 v97, v97
v_rcp_f32 v105, v105
v_rcp_f32 v98, v98
v_rcp_f32 v106, v106
v_rcp_f32_e64 v99, v99
s_xor_b32 s47, s37, 0x740000
buffer_load_dwordx4 a[64:67], v18, s[64:67], s47 offen offset:0 sc1
v_rcp_f32_e64 v107, v107
v_pk_mul_f32 v[100:101], v[100:101], v[96:97]
v_mov_b32_e64 v76, 1
s_waitcnt vmcnt(8)
s_mov_b64 exec, 1
buffer_store_dword v76, off, s[16:19], s74 sc1
s_mov_b64 exec, -1
s_nop 0
v_pk_mul_f32 v[108:109], v[108:109], v[104:105]
v_pk_mul_f32 v[102:103], v[102:103], v[98:99]
v_pk_mul_f32 v[110:111], v[110:111], v[106:107]
s_add_u32 s40, s54, 4286579712
v_cvt_pk_bf16_f32 v96, v100, v101
v_cvt_pk_bf16_f32 v98, v108, v109
v_cvt_pk_bf16_f32 v97, v102, v103
v_cvt_pk_bf16_f32 v99, v110, v111
buffer_store_dwordx4 v[96:99], v18, s[20:23], s40 offen sc1
v_accvgpr_read_b32 v80, a80
v_accvgpr_read_b32 v81, a81
v_mfma_f32_16x16x32_bf16 a[96:99], v[50:53], v[26:29], a[96:99]
v_accvgpr_read_b32 v82, a82
buffer_load_dwordx4 a[68:71], v18, s[64:67], s47 offen offset:1024 sc1
v_accvgpr_read_b32 v83, a83
v_accvgpr_read_b32 v84, a84
v_accvgpr_read_b32 v85, a85
v_accvgpr_read_b32 v86, a86
v_accvgpr_read_b32 v87, a87
v_accvgpr_read_b32 v88, a88
v_mfma_f32_16x16x32_bf16 a[100:103], v[54:57], v[26:29], a[100:103]
v_accvgpr_read_b32 v89, a89
v_accvgpr_read_b32 v90, a90
v_accvgpr_read_b32 v91, a91
v_accvgpr_read_b32 v92, a92
v_accvgpr_read_b32 v93, a93
v_accvgpr_read_b32 v94, a94
v_accvgpr_read_b32 v95, a95
v_mfma_f32_16x16x32_bf16 a[104:107], v[58:61], v[26:29], a[104:107]
s_xor_b32 s47, s37, 0x840000
buffer_load_dwordx4 a[72:75], v18, s[64:67], s47 offen offset:0 sc1
v_pk_mul_f32 v[80:81], v[80:81], v[12:13] op_sel:[0,0] op_sel_hi:[1,0]
v_pk_mul_f32 v[88:89], v[88:89], v[12:13] op_sel:[0,0] op_sel_hi:[1,0]
v_pk_mul_f32 v[82:83], v[82:83], v[12:13] op_sel:[0,0] op_sel_hi:[1,0]
v_pk_mul_f32 v[90:91], v[90:91], v[12:13] op_sel:[0,0] op_sel_hi:[1,0]
v_exp_f32 v80, v80
v_exp_f32 v88, v88
v_exp_f32_e64 v81, v81
v_mfma_f32_16x16x32_bf16 a[108:111], v[62:65], v[26:29], a[108:111]
v_exp_f32 v89, v89
v_exp_f32 v82, v82
v_exp_f32 v90, v90
v_exp_f32 v83, v83
v_exp_f32_e64 v91, v91
v_pk_fma_f32 v[80:81], v[80:81], v[24:25], v[24:25] op_sel:[0,1,1] op_sel_hi:[1,1,1]
v_pk_fma_f32 v[88:89], v[88:89], v[24:25], v[24:25] op_sel:[0,1,1] op_sel_hi:[1,1,1]
buffer_load_dwordx4 a[76:79], v18, s[64:67], s47 offen offset:1024 sc1
v_pk_fma_f32 v[82:83], v[82:83], v[24:25], v[24:25] op_sel:[0,1,1] op_sel_hi:[1,1,1]
v_pk_fma_f32 v[90:91], v[90:91], v[24:25], v[24:25] op_sel:[0,1,1] op_sel_hi:[1,1,1]
v_rcp_f32 v80, v80
v_rcp_f32 v88, v88
v_rcp_f32 v81, v81
v_rcp_f32 v89, v89
v_rcp_f32 v82, v82
v_rcp_f32 v90, v90
v_rcp_f32 v83, v83
v_rcp_f32 v91, v91
v_pk_mul_f32 v[84:85], v[84:85], v[80:81]
v_pk_mul_f32 v[92:93], v[92:93], v[88:89]
v_pk_mul_f32 v[86:87], v[86:87], v[82:83]
v_pk_mul_f32 v[94:95], v[94:95], v[90:91]
s_add_u32 s40, s54, 4286580736
s_xor_b32 s47, s37, 0x240000
buffer_load_dwordx4 a[80:83], v18, s[64:67], s47 offen offset:0 sc1
v_cvt_pk_bf16_f32 v80, v84, v85
v_cvt_pk_bf16_f32 v82, v92, v93
v_cvt_pk_bf16_f32 v81, v86, v87
v_cvt_pk_bf16_f32 v83, v94, v95
buffer_store_dwordx4 v[80:83], v18, s[20:23], s40 offen sc1
v_accvgpr_read_b32 v96, a96
v_accvgpr_read_b32 v97, a97
v_mfma_f32_16x16x32_bf16 a[112:115], v[50:53], v[28:31], a[112:115]
v_accvgpr_read_b32 v98, a98
v_accvgpr_read_b32 v99, a99
v_accvgpr_read_b32 v100, a100
v_accvgpr_read_b32 v101, a101
v_accvgpr_read_b32 v102, a102
v_accvgpr_read_b32 v103, a103
v_accvgpr_read_b32 v104, a104
buffer_load_dwordx4 a[84:87], v18, s[64:67], s47 offen offset:1024 sc1
v_mfma_f32_16x16x32_bf16 a[116:119], v[54:57], v[28:31], a[116:119]
v_accvgpr_read_b32 v105, a105
v_accvgpr_read_b32 v106, a106
v_accvgpr_read_b32 v107, a107
v_accvgpr_read_b32 v108, a108
v_accvgpr_read_b32 v109, a109
v_accvgpr_read_b32 v110, a110
v_accvgpr_read_b32 v111, a111
v_mfma_f32_16x16x32_bf16 a[120:123], v[58:61], v[28:31], a[120:123]
v_pk_mul_f32 v[96:97], v[96:97], v[12:13] op_sel:[0,1] op_sel_hi:[1,1]
v_pk_mul_f32 v[104:105], v[104:105], v[12:13] op_sel:[0,1] op_sel_hi:[1,1]
v_pk_mul_f32 v[98:99], v[98:99], v[12:13] op_sel:[0,1] op_sel_hi:[1,1]
v_pk_mul_f32 v[106:107], v[106:107], v[12:13] op_sel:[0,1] op_sel_hi:[1,1]
v_exp_f32 v96, v96
v_exp_f32 v104, v104
s_xor_b32 s47, s37, 0x2c0000
buffer_load_dwordx4 a[88:91], v18, s[64:67], s47 offen offset:0 sc1
v_exp_f32_e64 v97, v97
v_mfma_f32_16x16x32_bf16 a[124:127], v[62:65], v[28:31], a[124:127]
v_exp_f32 v105, v105
v_exp_f32 v98, v98
v_exp_f32 v106, v106
v_exp_f32 v99, v99
v_exp_f32_e64 v107, v107
v_pk_fma_f32 v[96:97], v[96:97], v[26:27], v[26:27] op_sel:[0,1,1] op_sel_hi:[1,1,1]
v_pk_fma_f32 v[104:105], v[104:105], v[26:27], v[26:27] op_sel:[0,1,1] op_sel_hi:[1,1,1]
v_pk_fma_f32 v[98:99], v[98:99], v[26:27], v[26:27] op_sel:[0,1,1] op_sel_hi:[1,1,1]
v_pk_fma_f32 v[106:107], v[106:107], v[26:27], v[26:27] op_sel:[0,1,1] op_sel_hi:[1,1,1]
v_rcp_f32 v96, v96
v_rcp_f32 v104, v104
v_rcp_f32 v97, v97
v_rcp_f32 v105, v105
buffer_load_dwordx4 a[92:95], v18, s[64:67], s47 offen offset:1024 sc1
v_rcp_f32 v98, v98
v_rcp_f32 v106, v106
v_rcp_f32 v99, v99
v_rcp_f32 v107, v107
v_pk_mul_f32 v[100:101], v[100:101], v[96:97]
v_pk_mul_f32 v[108:109], v[108:109], v[104:105]
v_pk_mul_f32 v[102:103], v[102:103], v[98:99]
v_pk_mul_f32 v[110:111], v[110:111], v[106:107]
s_add_u32 s40, s54, 4286581760
v_cvt_pk_bf16_f32 v96, v100, v101
v_cvt_pk_bf16_f32 v98, v108, v109
v_cvt_pk_bf16_f32 v97, v102, v103
v_cvt_pk_bf16_f32 v99, v110, v111
buffer_store_dwordx4 v[96:99], v18, s[20:23], s40 offen sc1
v_accvgpr_read_b32 v80, a112
s_xor_b32 s47, s37, 0x340000
buffer_load_dwordx4 a[96:99], v18, s[64:67], s47 offen offset:0 sc1
v_accvgpr_read_b32 v81, a113
v_mfma_f32_16x16x32_bf16 a[128:131], v[50:53], v[30:33], a[128:131]
v_accvgpr_read_b32 v82, a114
v_accvgpr_read_b32 v83, a115
v_accvgpr_read_b32 v84, a116
v_accvgpr_read_b32 v85, a117
v_accvgpr_read_b32 v86, a118
v_accvgpr_read_b32 v87, a119
v_accvgpr_read_b32 v88, a120
v_mfma_f32_16x16x32_bf16 a[132:135], v[54:57], v[30:33], a[132:135]
v_accvgpr_read_b32 v89, a121
v_accvgpr_read_b32 v90, a122
v_accvgpr_read_b32 v91, a123
v_accvgpr_read_b32 v92, a124
v_accvgpr_read_b32 v93, a125
buffer_load_dwordx4 a[100:103], v18, s[64:67], s47 offen offset:1024 sc1
v_accvgpr_read_b32 v94, a126
v_accvgpr_read_b32 v95, a127
v_mfma_f32_16x16x32_bf16 a[136:139], v[58:61], v[30:33], a[136:139]
v_pk_mul_f32 v[80:81], v[80:81], v[14:15] op_sel:[0,0] op_sel_hi:[1,0]
v_pk_mul_f32 v[88:89], v[88:89], v[14:15] op_sel:[0,0] op_sel_hi:[1,0]
v_pk_mul_f32 v[82:83], v[82:83], v[14:15] op_sel:[0,0] op_sel_hi:[1,0]
v_pk_mul_f32 v[90:91], v[90:91], v[14:15] op_sel:[0,0] op_sel_hi:[1,0]
v_exp_f32 v80, v80
v_exp_f32 v88, v88
v_exp_f32_e64 v81, v81
v_mfma_f32_16x16x32_bf16 a[140:143], v[62:65], v[30:33], a[140:143]
v_exp_f32 v89, v89
v_exp_f32 v82, v82
v_exp_f32 v90, v90
v_exp_f32 v83, v83
s_xor_b32 s47, s37, 0x3c0000
buffer_load_dwordx4 a[104:107], v18, s[64:67], s47 offen offset:0 sc1
v_exp_f32_e64 v91, v91
v_pk_fma_f32 v[80:81], v[80:81], v[28:29], v[28:29] op_sel:[0,1,1] op_sel_hi:[1,1,1]
v_pk_fma_f32 v[88:89], v[88:89], v[28:29], v[28:29] op_sel:[0,1,1] op_sel_hi:[1,1,1]
v_pk_fma_f32 v[82:83], v[82:83], v[28:29], v[28:29] op_sel:[0,1,1] op_sel_hi:[1,1,1]
v_pk_fma_f32 v[90:91], v[90:91], v[28:29], v[28:29] op_sel:[0,1,1] op_sel_hi:[1,1,1]
v_rcp_f32 v80, v80
v_rcp_f32 v88, v88
v_rcp_f32 v81, v81
v_rcp_f32 v89, v89
v_rcp_f32 v82, v82
v_rcp_f32 v90, v90
v_rcp_f32 v83, v83
v_rcp_f32 v91, v91
v_pk_mul_f32 v[84:85], v[84:85], v[80:81]
v_pk_mul_f32 v[92:93], v[92:93], v[88:89]
buffer_load_dwordx4 a[108:111], v18, s[64:67], s47 offen offset:1024 sc1
v_pk_mul_f32 v[86:87], v[86:87], v[82:83]
v_pk_mul_f32 v[94:95], v[94:95], v[90:91]
s_add_u32 s40, s54, 4286582784
v_cvt_pk_bf16_f32 v80, v84, v85
v_cvt_pk_bf16_f32 v82, v92, v93
v_cvt_pk_bf16_f32 v81, v86, v87
v_cvt_pk_bf16_f32 v83, v94, v95
buffer_store_dwordx4 v[80:83], v18, s[20:23], s40 offen sc1
v_accvgpr_read_b32 v96, a128
v_accvgpr_read_b32 v97, a129
v_mfma_f32_16x16x32_bf16 v[144:147], v[50:53], v[32:35], v[144:147]
v_accvgpr_read_b32 v98, a130
v_accvgpr_read_b32 v99, a131
v_accvgpr_read_b32 v100, a132
v_accvgpr_read_b32 v101, a133
s_xor_b32 s47, s37, 0x600000
buffer_load_dwordx4 a[112:115], v18, s[64:67], s47 offen offset:0 sc1
v_accvgpr_read_b32 v102, a134
v_accvgpr_read_b32 v103, a135
v_accvgpr_read_b32 v104, a136
v_mfma_f32_16x16x32_bf16 v[148:151], v[54:57], v[32:35], v[148:151]
v_accvgpr_read_b32 v105, a137
v_accvgpr_read_b32 v106, a138
v_accvgpr_read_b32 v107, a139
v_accvgpr_read_b32 v108, a140
v_accvgpr_read_b32 v109, a141
v_accvgpr_read_b32 v110, a142
v_accvgpr_read_b32 v111, a143
v_mfma_f32_16x16x32_bf16 v[152:155], v[58:61], v[32:35], v[152:155]
v_pk_mul_f32 v[96:97], v[96:97], v[14:15] op_sel:[0,1] op_sel_hi:[1,1]
v_pk_mul_f32 v[104:105], v[104:105], v[14:15] op_sel:[0,1] op_sel_hi:[1,1]
v_pk_mul_f32 v[98:99], v[98:99], v[14:15] op_sel:[0,1] op_sel_hi:[1,1]
buffer_load_dwordx4 a[116:119], v18, s[64:67], s47 offen offset:1024 sc1
v_pk_mul_f32 v[106:107], v[106:107], v[14:15] op_sel:[0,1] op_sel_hi:[1,1]
v_exp_f32 v96, v96
v_exp_f32 v104, v104
v_exp_f32_e64 v97, v97
v_mfma_f32_16x16x32_bf16 v[156:159], v[62:65], v[32:35], v[156:159]
v_exp_f32 v105, v105
v_exp_f32 v98, v98
v_exp_f32 v106, v106
v_exp_f32 v99, v99
v_exp_f32 v107, v107
v_xor_b32 v76, s35, v18
v_and_b32 v78, 0x3c0, v76
v_add_u32 v76, v76, v78
v_mov_b32 v78, 2
s_mov_b32 exec_lo, 0xf
s_mov_b32 exec_hi, 0xf
buffer_load_dword v78, v76, s[16:19], s73 offen sc1
s_mov_b64 exec, -1
s_nop 0
v_pk_fma_f32 v[96:97], v[96:97], v[30:31], v[30:31] op_sel:[0,1,1] op_sel_hi:[1,1,1]
v_pk_fma_f32 v[104:105], v[104:105], v[30:31], v[30:31] op_sel:[0,1,1] op_sel_hi:[1,1,1]
v_pk_fma_f32 v[98:99], v[98:99], v[30:31], v[30:31] op_sel:[0,1,1] op_sel_hi:[1,1,1]
v_pk_fma_f32 v[106:107], v[106:107], v[30:31], v[30:31] op_sel:[0,1,1] op_sel_hi:[1,1,1]
v_rcp_f32_e64 v96, v96
s_xor_b32 s47, s37, 0x680000
buffer_load_dwordx4 a[120:123], v18, s[64:67], s47 offen offset:0 sc1
v_rcp_f32 v104, v104
v_rcp_f32 v97, v97
v_rcp_f32 v105, v105
v_rcp_f32 v98, v98
v_rcp_f32 v106, v106
v_rcp_f32 v99, v99
v_rcp_f32_e64 v107, v107
v_pk_mul_f32 v[100:101], v[100:101], v[96:97]
v_pk_mul_f32 v[108:109], v[108:109], v[104:105]
v_pk_mul_f32 v[102:103], v[102:103], v[98:99]
v_pk_mul_f32 v[110:111], v[110:111], v[106:107]
s_add_u32 s40, s54, 4286583808
v_cvt_pk_bf16_f32 v96, v100, v101
v_cvt_pk_bf16_f32 v98, v108, v109
v_cvt_pk_bf16_f32 v97, v102, v103
buffer_load_dwordx4 a[124:127], v18, s[64:67], s47 offen offset:1024 sc1
v_cvt_pk_bf16_f32 v99, v110, v111
buffer_store_dwordx4 v[96:99], v18, s[20:23], s40 offen sc1
v_pk_mul_f32 v[144:145], v[144:145], v[16:17] op_sel:[0,0] op_sel_hi:[1,0]
v_pk_mul_f32 v[152:153], v[152:153], v[16:17] op_sel:[0,0] op_sel_hi:[1,0]
v_pk_mul_f32 v[146:147], v[146:147], v[16:17] op_sel:[0,0] op_sel_hi:[1,0]
v_pk_mul_f32 v[154:155], v[154:155], v[16:17] op_sel:[0,0] op_sel_hi:[1,0]
v_exp_f32_e64 v144, v144
v_mfma_f32_16x16x32_bf16 v[160:163], v[50:53], v[34:37], v[160:163]
v_exp_f32_e64 v152, v152
v_mfma_f32_16x16x32_bf16 v[164:167], v[54:57], v[34:37], v[164:167]
v_exp_f32 v145, v145
v_exp_f32 v153, v153
v_exp_f32 v146, v146
v_exp_f32 v154, v154
v_exp_f32_e64 v147, v147
v_mfma_f32_16x16x32_bf16 v[168:171], v[58:61], v[34:37], v[168:171]
v_exp_f32_e64 v155, v155
v_pk_fma_f32 v[144:145], v[144:145], v[32:33], v[32:33] op_sel:[0,1,1] op_sel_hi:[1,1,1]
v_pk_fma_f32 v[152:153], v[152:153], v[32:33], v[32:33] op_sel:[0,1,1] op_sel_hi:[1,1,1]
v_pk_fma_f32 v[146:147], v[146:147], v[32:33], v[32:33] op_sel:[0,1,1] op_sel_hi:[1,1,1]
v_pk_fma_f32 v[154:155], v[154:155], v[32:33], v[32:33] op_sel:[0,1,1] op_sel_hi:[1,1,1]
v_rcp_f32_e64 v144, v144
v_mfma_f32_16x16x32_bf16 v[172:175], v[62:65], v[34:37], v[172:175]
v_rcp_f32 v152, v152
v_rcp_f32 v145, v145
v_rcp_f32 v153, v153
v_rcp_f32 v146, v146
v_rcp_f32 v154, v154
v_rcp_f32 v147, v147
v_rcp_f32_e64 v155, v155
v_pk_mul_f32 v[148:149], v[148:149], v[144:145]
v_pk_mul_f32 v[156:157], v[156:157], v[152:153]
v_pk_mul_f32 v[150:151], v[150:151], v[146:147]
v_pk_mul_f32 v[158:159], v[158:159], v[154:155]
s_add_u32 s40, s54, 4286584832
v_cvt_pk_bf16_f32 v144, v148, v149
v_cvt_pk_bf16_f32 v146, v156, v157
v_cvt_pk_bf16_f32 v145, v150, v151
v_cvt_pk_bf16_f32 v147, v158, v159
buffer_store_dwordx4 v[144:147], v18, s[20:23], s40 offen sc1
v_pk_mul_f32 v[160:161], v[160:161], v[16:17] op_sel:[0,1] op_sel_hi:[1,1]
v_mov_b32_e64 v50, v48
v_pk_mul_f32 v[168:169], v[168:169], v[16:17] op_sel:[0,1] op_sel_hi:[1,1]
v_pk_mul_f32 v[162:163], v[162:163], v[16:17] op_sel:[0,1] op_sel_hi:[1,1]
v_pk_mul_f32 v[170:171], v[170:171], v[16:17] op_sel:[0,1] op_sel_hi:[1,1]
v_mov_b32 v54, v49
v_exp_f32 v160, v160
v_exp_f32 v168, v168
v_exp_f32 v161, v161
v_mfma_f32_16x16x32_bf16 v[176:179], v[50:53], v[20:23], v[176:179]
v_exp_f32 v169, v169
v_exp_f32 v162, v162
v_exp_f32 v170, v170
v_exp_f32 v163, v163
v_mfma_f32_16x16x32_bf16 v[180:183], v[54:57], v[20:23], v[180:183]
v_exp_f32_e64 v171, v171
v_pk_fma_f32 v[160:161], v[160:161], v[34:35], v[34:35] op_sel:[0,1,1] op_sel_hi:[1,1,1]
v_pk_fma_f32 v[168:169], v[168:169], v[34:35], v[34:35] op_sel:[0,1,1] op_sel_hi:[1,1,1]
v_pk_fma_f32 v[162:163], v[162:163], v[34:35], v[34:35] op_sel:[0,1,1] op_sel_hi:[1,1,1]
v_pk_fma_f32 v[170:171], v[170:171], v[34:35], v[34:35] op_sel:[0,1,1] op_sel_hi:[1,1,1]
v_rcp_f32_e64 v160, v160
v_mfma_f32_16x16x32_bf16 v[184:187], v[50:53], v[22:25], v[184:187]
v_mfma_f32_16x16x32_bf16 v[188:191], v[54:57], v[22:25], v[188:191]
v_rcp_f32 v168, v168
v_rcp_f32 v161, v161
v_rcp_f32 v169, v169
v_rcp_f32 v162, v162
v_rcp_f32 v170, v170
v_rcp_f32 v163, v163
v_rcp_f32_e64 v171, v171
v_pk_mul_f32 v[164:165], v[164:165], v[160:161]
v_pk_mul_f32 v[172:173], v[172:173], v[168:169]
v_pk_mul_f32 v[166:167], v[166:167], v[162:163]
v_pk_mul_f32 v[174:175], v[174:175], v[170:171]
s_add_u32 s40, s54, 4286585856
v_cvt_pk_bf16_f32 v160, v164, v165
v_cvt_pk_bf16_f32 v162, v172, v173
v_cvt_pk_bf16_f32 v161, v166, v167
v_cvt_pk_bf16_f32 v163, v174, v175
buffer_store_dwordx4 v[160:163], v18, s[20:23], s40 offen sc1
v_pk_mul_f32 v[176:177], v[176:177], v[10:11] op_sel:[0,0] op_sel_hi:[1,0]
v_pk_mul_f32 v[184:185], v[184:185], v[10:11] op_sel:[0,1] op_sel_hi:[1,1]
v_pk_mul_f32 v[178:179], v[178:179], v[10:11] op_sel:[0,0] op_sel_hi:[1,0]
v_pk_mul_f32 v[186:187], v[186:187], v[10:11] op_sel:[0,1] op_sel_hi:[1,1]
v_exp_f32_e64 v176, v176
v_mfma_f32_16x16x32_bf16 v[192:195], v[50:53], v[24:27], v[192:195]
v_exp_f32_e64 v184, v184
v_mfma_f32_16x16x32_bf16 v[196:199], v[54:57], v[24:27], v[196:199]
v_exp_f32 v177, v177
v_exp_f32 v185, v185
v_exp_f32 v178, v178
v_exp_f32 v186, v186
v_exp_f32_e64 v179, v179
v_mfma_f32_16x16x32_bf16 v[200:203], v[50:53], v[26:29], v[200:203]
v_exp_f32_e64 v187, v187
v_pk_fma_f32 v[176:177], v[176:177], v[20:21], v[20:21] op_sel:[0,1,1] op_sel_hi:[1,1,1]
v_pk_fma_f32 v[184:185], v[184:185], v[22:23], v[22:23] op_sel:[0,1,1] op_sel_hi:[1,1,1]
v_pk_fma_f32 v[178:179], v[178:179], v[20:21], v[20:21] op_sel:[0,1,1] op_sel_hi:[1,1,1]
v_pk_fma_f32 v[186:187], v[186:187], v[22:23], v[22:23] op_sel:[0,1,1] op_sel_hi:[1,1,1]
v_rcp_f32_e64 v176, v176
v_mfma_f32_16x16x32_bf16 v[204:207], v[54:57], v[26:29], v[204:207]
v_rcp_f32 v184, v184
v_rcp_f32 v177, v177
v_rcp_f32 v185, v185
v_rcp_f32 v178, v178
v_rcp_f32 v186, v186
v_rcp_f32 v179, v179
v_rcp_f32_e64 v187, v187
v_pk_mul_f32 v[180:181], v[180:181], v[176:177]
v_pk_mul_f32 v[188:189], v[188:189], v[184:185]
v_pk_mul_f32 v[182:183], v[182:183], v[178:179]
v_pk_mul_f32 v[190:191], v[190:191], v[186:187]
s_add_u32 s40, s55, 0
s_nop 0
v_cvt_pk_bf16_f32 v176, v180, v181
v_cvt_pk_bf16_f32 v178, v188, v189
v_cvt_pk_bf16_f32 v177, v182, v183
v_cvt_pk_bf16_f32 v179, v190, v191
v_permlane32_swap_b32 v176, v178
s_nop 0
v_permlane32_swap_b32 v177, v179
s_nop 0
buffer_store_dwordx4 v[176:179], v19, s[20:23], s40 offen sc1
v_pk_mul_f32 v[192:193], v[192:193], v[12:13] op_sel:[0,0] op_sel_hi:[1,0]
v_pk_mul_f32 v[200:201], v[200:201], v[12:13] op_sel:[0,1] op_sel_hi:[1,1]
v_pk_mul_f32 v[194:195], v[194:195], v[12:13] op_sel:[0,0] op_sel_hi:[1,0]
v_pk_mul_f32 v[202:203], v[202:203], v[12:13] op_sel:[0,1] op_sel_hi:[1,1]
v_exp_f32_e64 v192, v192
v_mfma_f32_16x16x32_bf16 v[208:211], v[50:53], v[28:31], v[208:211]
v_exp_f32_e64 v200, v200
v_mfma_f32_16x16x32_bf16 v[212:215], v[54:57], v[28:31], v[212:215]
v_exp_f32 v193, v193
v_exp_f32 v201, v201
v_exp_f32 v194, v194
v_exp_f32 v202, v202
v_exp_f32_e64 v195, v195
s_waitcnt vmcnt(6)
v_cmp_gt_u32 vcc, 1, v78
s_nop 0
s_cmp_lg_u32 vcc_hi, 0
s_cselect_b32 s62, 0, 0x1200000
v_mfma_f32_16x16x32_bf16 v[216:219], v[50:53], v[30:33], v[216:219]
s_add_u32 m0, s39, 0
s_xor_b32 s46, s32, 0xc00000
buffer_load_dwordx4 v18, s[60:63], s46 offen offset:0 sc1 lds
v_exp_f32 v203, v203
v_pk_fma_f32 v[192:193], v[192:193], v[24:25], v[24:25] op_sel:[0,1,1] op_sel_hi:[1,1,1]
v_pk_fma_f32 v[200:201], v[200:201], v[26:27], v[26:27] op_sel:[0,1,1] op_sel_hi:[1,1,1]
v_pk_fma_f32 v[194:195], v[194:195], v[24:25], v[24:25] op_sel:[0,1,1] op_sel_hi:[1,1,1]
v_pk_fma_f32 v[202:203], v[202:203], v[26:27], v[26:27] op_sel:[0,1,1] op_sel_hi:[1,1,1]
v_rcp_f32_e64 v192, v192
v_mfma_f32_16x16x32_bf16 v[220:223], v[54:57], v[30:33], v[220:223]
buffer_load_dwordx4 v18, s[60:63], s46 offen offset:1024 sc1 lds
v_rcp_f32 v200, v200
v_rcp_f32 v193, v193
v_rcp_f32 v201, v201
v_rcp_f32 v194, v194
v_rcp_f32 v202, v202
v_rcp_f32 v195, v195
v_rcp_f32_e64 v203, v203
v_pk_mul_f32 v[196:197], v[196:197], v[192:193]
buffer_load_dwordx4 v18, s[60:63], s46 offen offset:2048 sc1 lds
v_pk_mul_f32 v[204:205], v[204:205], v[200:201]
v_pk_mul_f32 v[198:199], v[198:199], v[194:195]
v_pk_mul_f32 v[206:207], v[206:207], v[202:203]
s_add_u32 s40, s55, 2048
v_cvt_pk_bf16_f32 v192, v196, v197
v_cvt_pk_bf16_f32 v194, v204, v205
v_cvt_pk_bf16_f32 v193, v198, v199
v_cvt_pk_bf16_f32 v195, v206, v207
buffer_load_dwordx4 v18, s[60:63], s46 offen offset:3072 sc1 lds
v_permlane32_swap_b32 v192, v194
v_permlane32_swap_b32 v193, v195
buffer_store_dwordx4 v[192:195], v19, s[20:23], s40 offen sc1
v_pk_mul_f32 v[208:209], v[208:209], v[14:15] op_sel:[0,0] op_sel_hi:[1,0]
v_pk_mul_f32 v[216:217], v[216:217], v[14:15] op_sel:[0,1] op_sel_hi:[1,1]
v_pk_mul_f32 v[210:211], v[210:211], v[14:15] op_sel:[0,0] op_sel_hi:[1,0]
v_pk_mul_f32 v[218:219], v[218:219], v[14:15] op_sel:[0,1] op_sel_hi:[1,1]
v_exp_f32_e64 v208, v208
s_add_u32 m0, s39, 16384
s_xor_b32 s46, s32, 0xe00000
buffer_load_dwordx4 v18, s[60:63], s46 offen offset:0 sc1 lds
v_mfma_f32_16x16x32_bf16 v[224:227], v[50:53], v[32:35], v[224:227]
v_exp_f32_e64 v216, v216
v_mfma_f32_16x16x32_bf16 v[228:231], v[54:57], v[32:35], v[228:231]
v_exp_f32 v209, v209
v_exp_f32 v217, v217
v_exp_f32 v210, v210
v_exp_f32 v218, v218
v_exp_f32_e64 v211, v211
buffer_load_dwordx4 v18, s[60:63], s46 offen offset:1024 sc1 lds
v_mfma_f32_16x16x32_bf16 v[232:235], v[50:53], v[34:37], v[232:235]
v_exp_f32_e64 v219, v219
v_pk_fma_f32 v[208:209], v[208:209], v[28:29], v[28:29] op_sel:[0,1,1] op_sel_hi:[1,1,1]
v_pk_fma_f32 v[216:217], v[216:217], v[30:31], v[30:31] op_sel:[0,1,1] op_sel_hi:[1,1,1]
v_pk_fma_f32 v[210:211], v[210:211], v[28:29], v[28:29] op_sel:[0,1,1] op_sel_hi:[1,1,1]
v_pk_fma_f32 v[218:219], v[218:219], v[30:31], v[30:31] op_sel:[0,1,1] op_sel_hi:[1,1,1]
v_rcp_f32_e64 v208, v208
v_mfma_f32_16x16x32_bf16 v[236:239], v[54:57], v[34:37], v[236:239]
buffer_load_dwordx4 v18, s[60:63], s46 offen offset:2048 sc1 lds
v_rcp_f32 v216, v216
v_rcp_f32 v209, v209
v_rcp_f32 v217, v217
v_rcp_f32 v210, v210
v_rcp_f32 v218, v218
v_rcp_f32 v211, v211
v_rcp_f32_e64 v219, v219
v_pk_mul_f32 v[212:213], v[212:213], v[208:209]
buffer_load_dwordx4 v18, s[60:63], s46 offen offset:3072 sc1 lds
v_pk_mul_f32 v[220:221], v[220:221], v[216:217]
v_pk_mul_f32 v[214:215], v[214:215], v[210:211]
v_pk_mul_f32 v[222:223], v[222:223], v[218:219]
s_add_u32 s40, s55, 4096
v_cvt_pk_bf16_f32 v208, v212, v213
v_cvt_pk_bf16_f32 v210, v220, v221
v_cvt_pk_bf16_f32 v209, v214, v215
v_cvt_pk_bf16_f32 v211, v222, v223
v_permlane32_swap_b32 v208, v210
s_nop 0
v_permlane32_swap_b32 v209, v211
s_nop 0
buffer_store_dwordx4 v[208:211], v19, s[20:23], s40 offen sc1
v_pk_mul_f32 v[224:225], v[224:225], v[16:17] op_sel:[0,0] op_sel_hi:[1,0]
v_pk_mul_f32 v[232:233], v[232:233], v[16:17] op_sel:[0,1] op_sel_hi:[1,1]
v_pk_mul_f32 v[226:227], v[226:227], v[16:17] op_sel:[0,0] op_sel_hi:[1,0]
v_pk_mul_f32 v[234:235], v[234:235], v[16:17] op_sel:[0,1] op_sel_hi:[1,1]
v_exp_f32 v224, v224
v_exp_f32 v232, v232
v_exp_f32 v225, v225
v_exp_f32 v233, v233
v_exp_f32 v226, v226
v_exp_f32 v234, v234
v_exp_f32 v227, v227
v_exp_f32 v235, v235
v_pk_fma_f32 v[224:225], v[224:225], v[32:33], v[32:33] op_sel:[0,1,1] op_sel_hi:[1,1,1]
v_pk_fma_f32 v[232:233], v[232:233], v[34:35], v[34:35] op_sel:[0,1,1] op_sel_hi:[1,1,1]
v_pk_fma_f32 v[226:227], v[226:227], v[32:33], v[32:33] op_sel:[0,1,1] op_sel_hi:[1,1,1]
v_pk_fma_f32 v[234:235], v[234:235], v[34:35], v[34:35] op_sel:[0,1,1] op_sel_hi:[1,1,1]
v_rcp_f32 v224, v224
v_rcp_f32 v232, v232
v_rcp_f32 v225, v225
v_rcp_f32 v233, v233
v_rcp_f32 v226, v226
v_rcp_f32 v234, v234
v_rcp_f32 v227, v227
v_rcp_f32 v235, v235
v_pk_mul_f32 v[228:229], v[228:229], v[224:225]
v_pk_mul_f32 v[236:237], v[236:237], v[232:233]
v_pk_mul_f32 v[230:231], v[230:231], v[226:227]
v_pk_mul_f32 v[238:239], v[238:239], v[234:235]
s_add_u32 s40, s55, 6144
v_cvt_pk_bf16_f32 v224, v228, v229
v_cvt_pk_bf16_f32 v226, v236, v237
v_cvt_pk_bf16_f32 v225, v230, v231
v_cvt_pk_bf16_f32 v227, v238, v239
v_permlane32_swap_b32 v224, v226
s_nop 0
v_permlane32_swap_b32 v225, v227
buffer_store_dwordx4 v[224:227], v19, s[20:23], s40 offen sc1
s_branch L_g1_fin_1002
s_nop 7
s_nop 7
L_g1_cs_1047:
s_cmp_lt_u32 s49, 32
s_cbranch_scc1 L_g1_spin_1046
buffer_load_dwordx4 v[40:43], v9, s[24:27], s53 offen offset:0 sc1
buffer_load_dwordx4 v[44:47], v9, s[24:27], s53 offen offset:16 sc1
buffer_load_dwordx4 v[48:51], v9, s[24:27], s53 offen offset:32 sc1
s_waitcnt vmcnt(0)
s_nop 0
v_min3_u32 v74, v40, v41, v42
v_min3_u32 v75, v43, v44, v45
v_min3_u32 v74, v74, v46, v47
v_min3_u32 v75, v75, v48, v49
v_min3_u32 v74, v74, v50, v51
v_min_u32_e64 v74, v74, v75
v_cmp_eq_u32 vcc, 0, v74
s_nop 0
s_and_b32 s40, vcc_lo, 0xffff
s_cbranch_scc1 L_g1_cs_1047
s_branch L_g1_ok_1045
L_g1_spin_1046:
s_sleep 4
v_min_u32 v76, 7, v0
v_lshlrev_b32_e64 v76, 2, v76
buffer_load_dword v74, v76, s[28:31], 0 offen sc1
s_waitcnt vmcnt(0)
v_cmp_gt_u32 vcc, 32, v74
s_nop 0
s_cmp_eq_u64 vcc, 0
s_cselect_b32 s49, 32, 0
s_nop 1
s_cmp_lt_u32 s49, 32
s_cbranch_scc1 L_g1_spin_1046
v_and_b32 v76, 15, v0
v_lshlrev_b32 v76, 3, v76
s_add_u32 s52, s44, 128
s_lshl_b32 s52, s52, 3
s_nop 0
buffer_load_dwordx2 v[20:21], v76, s[24:27], s52 offen offset:0 sc1
buffer_load_dwordx2 v[22:23], v76, s[24:27], s52 offen offset:128 sc1
buffer_load_dwordx2 v[24:25], v76, s[24:27], s52 offen offset:256 sc1
buffer_load_dwordx2 v[26:27], v76, s[24:27], s52 offen offset:384 sc1
buffer_load_dwordx2 v[28:29], v76, s[24:27], s52 offen offset:512 sc1
buffer_load_dwordx2 v[30:31], v76, s[24:27], s52 offen offset:640 sc1
buffer_load_dwordx2 v[32:33], v76, s[24:27], s52 offen offset:768 sc1
buffer_load_dwordx2 v[34:35], v76, s[24:27], s52 offen offset:896 sc1
s_bfe_u32 s53, s2, 0x20003
s_lshl2_add_u32 s53, s3, s53
s_lshl1_add_u32 s53, s53, s58
s_mul_i32 s53, s53, 768
s_add_u32 s53, s53, 16384
buffer_load_dwordx4 v[40:43], v9, s[24:27], s53 offen offset:0 sc1
buffer_load_dwordx4 v[44:47], v9, s[24:27], s53 offen offset:16 sc1
buffer_load_dwordx4 v[48:51], v9, s[24:27], s53 offen offset:32 sc1
s_waitcnt vmcnt(0)
s_nop 0
v_min3_u32 v74, v40, v41, v42
v_min3_u32 v75, v43, v44, v45
v_min3_u32 v74, v74, v46, v47
v_min3_u32 v75, v75, v48, v49
v_min3_u32 v74, v74, v50, v51
v_min_u32_e64 v74, v74, v75
v_cmp_eq_u32 vcc, 0, v74
s_nop 0
s_and_b32 s40, vcc_lo, 0xffff
s_cbranch_scc1 L_g1_spin_1046
s_branch L_g1_ok_1045
.globl g1_kernel
.p2align 8
.type g1_kernel,@function
g1_kernel:
s_cmp_ge_u32 s2, 256
s_cbranch_scc0 L_g1_go_1003
s_endpgm
L_g1_go_1003:
s_load_dwordx4 s[60:63], s[0:1], 0
s_load_dwordx4 s[64:67], s[0:1], 32
s_load_dwordx2 s[68:69], s[0:1], 72
s_load_dwordx2 s[70:71], s[0:1], 64
s_load_dwordx2 s[72:73], s[0:1], 16
s_load_dwordx2 s[74:75], s[0:1], 48
s_load_dwordx2 s[100:101], s[0:1], 56
v_lshrrev_b32 v74, 6, v0
v_and_b32 v0, 63, v0
v_readfirstlane_b32 s43, v74
s_lshr_b32 s59, s2, 5
s_lshl_b32 s44, s59, 8
s_and_b32 s3, s2, 7
v_lshlrev_b32 v79, 4, v0
s_getpc_b64 s[32:33]
L_g1_pc_1004:
s_sub_u32 s32, s32, L_g1_pc_1004-L_code_start
s_subb_u32 s33, s33, 0
s_lshr_b32 s40, s2, 3
s_mul_i32 s40, s40, ((L_code_end-L_code_start+4095)>>12)<<7
v_min_u32 v74, ((L_code_end-L_code_start+4095)>>12)-1, v0
v_lshl_add_u32 v74, v74, 7, s40
v_min_u32 v74, L_code_end-L_code_start-4, v74
global_load_dword v19, v74, s[32:33]
s_bfe_u32 s54, s2, 0x10003
s_lshr_b32 s58, s43, 1
s_lshl_b32 s76, s43, 10
s_lshl2_add_u32 s45, s3, s58
s_lshl1_add_u32 s45, s54, s45
s_mul_i32 s38, s3, 918400
s_mul_i32 s39, s3, 786688
s_lshl_b32 s40, s54, 7
s_add_u32 s39, s39, s40
s_lshl_b32 s41, s54, 6
s_add_u32 s41, s41, s38
s_add_u32 s41, s41, 512
s_mul_i32 s42, s54, 384
s_add_u32 s42, s42, 256
s_bitcmp1_b32 s2, 4
s_cselect_b32 s39, s41, s39
s_cselect_b32 s40, s42, s40
s_cselect_b32 s50, 7, 6
s_cselect_b64 vcc, -1, 0
s_add_u32 s38, s38, s40
s_lshl_b32 s50, s50, 15
s_sub_u32 s56, 8, s3
s_and_b32 s40, s43, 1
s_lshl_b32 s41, s40, 2
v_lshrrev_b32 v74, 4, v0
v_add_u32 v74, s41, v74
v_and_b32 v75, 7, v0
v_xor_b32 v74, v74, v75
v_lshlrev_b32 v74, 4, v74
v_lshrrev_b32 v75, 3, v0
v_lshl_add_u32 v1, v75, 11, v74
s_lshl_b32 s36, s44, 11
s_lshl_b32 s41, s3, 8
s_add_u32 s36, s36, s41
v_and_b32 v74, 48, v79
v_lshrrev_b32 v75, 5, v0
s_lshl_b32 s41, s40, 5
v_xor_b32_e64 v76, s41, v74
v_lshl_add_u32 v76, v75, 6, v76
v_bfe_u32 v77, v0, 2, 3
s_lshl_b32 s41, s43, 3
v_add_u32 v77, s41, v77
v_mul_u32_u24 v2, 7168, v77
v_add_u32_e64 v2, v2, v76
v_mul_u32_u24 v3, 6144, v77
v_add_u32 v3, v3, v76
v_lshlrev_b32 v75, 5, v75
v_xor_b32 v74, v74, v75
v_lshrrev_b32 v77, 2, v0
s_lshl_b32 s41, s40, 4
v_add_u32 v77, s41, v77
v_mul_u32_u24 v77, 7168, v77
v_add_u32 v77, v77, v74
v_cndmask_b32 v3, v3, v77, vcc
s_bfe_u32 s55, s2, 0x20003
s_lshl_b32 s55, s55, 13
s_add_u32 s55, s55, s76
s_and_b32 s40, s59, 3
s_mul_i32 s53, s40, 229376
s_add_u32 s53, s53, s38
s_mul_i32 s52, s40, s50
s_add_u32 s52, s52, s39
s_lshr_b32 s46, s40, 1
s_mul_i32 s46, s46, 32768
s_lshl_b32 s40, s40, 12
s_add_u32 s46, s46, s40
s_add_u32 s46, s46, s76
s_lshl4_add_u32 s40, s55, s36
s_add_u32 s41, s40, 65536
s_mov_b32 m0, s55
s_waitcnt lgkmcnt(0)
s_mov_b32 s4, s60
s_mov_b32 s5, s61
s_nop 0
s_mov_b32 s6, 0x400000
s_mov_b32 s7, 0x00020000
buffer_load_dwordx4 v1, s[4:7], s40 offen offset:0 lds
s_mov_b32 s8, s64
s_mov_b32 s9, s65
s_mov_b32 s10, 0x700000
s_mov_b32 s11, 0x00020000
s_add_u32 m0, s55, 4096
s_nop 0
buffer_load_dwordx4 v1, s[4:7], s41 offen offset:0 lds
s_mov_b32 s12, s66
s_mov_b32 s13, s67
s_mov_b32 s14, 0x700000
s_mov_b32 s15, 0x00020000
s_bitcmp1_b32 s2, 4
s_cbranch_scc1 L_g1_tb_1009
s_mov_b32 s16, s62
s_mov_b32 s17, s63
s_nop 0
s_mov_b32 s18, 0x600000
s_mov_b32 s19, 0x00020000
s_add_u32 m0, s46, 65536
s_nop 0
buffer_load_dwordx4 v3, s[16:19], s52 offen nt lds
s_add_u32 m0, s46, 71680
s_nop 0
buffer_load_dwordx4 v3, s[16:19], s52 offen offset:2048 nt lds
s_add_u32 m0, s46, 81920
s_add_u32 s79, s52, 4096
buffer_load_dwordx4 v3, s[16:19], s79 offen nt lds
s_add_u32 m0, s46, 90112
s_nop 0
buffer_load_dwordx4 v2, s[8:11], s53 offen nt lds
s_add_u32 m0, s46, 98304
s_nop 0
buffer_load_dwordx4 v2, s[12:15], s53 offen nt lds
s_add_u32 m0, s55, 32640
s_nop 0
buffer_load_dwordx4 v1, s[4:7], s40 offen offset:128 lds
s_add_u32 m0, s55, 36736
s_nop 0
buffer_load_dwordx4 v1, s[4:7], s41 offen offset:128 lds
s_bitcmp1_b32 s43, 0
s_cbranch_scc1 L_g1_w_1006
s_branch L_g1_w_1005
L_g1_tb_1009:
s_add_u32 m0, s46, 65536
s_nop 0
buffer_load_dwordx4 v2, s[8:11], s53 offen nt lds
s_add_u32 m0, s46, 73600
s_nop 0
buffer_load_dwordx4 v2, s[8:11], s53 offen offset:128 nt lds
s_cmp_eq_u32 s58, 0
s_cselect_b32 s16, s64, s66
s_cselect_b32 s17, s65, s67
s_mov_b32 s18, 0x700000
s_mov_b32 s19, 0x00020000
s_add_u32 m0, s46, 81920
s_nop 0
buffer_load_dwordx4 v3, s[16:19], s52 offen nt lds
s_add_u32 m0, s46, 90112
s_nop 0
buffer_load_dwordx4 v2, s[12:15], s53 offen nt lds
s_add_u32 m0, s46, 98176
s_nop 0
buffer_load_dwordx4 v2, s[12:15], s53 offen offset:128 nt lds
s_add_u32 m0, s55, 32640
s_nop 0
buffer_load_dwordx4 v1, s[4:7], s40 offen offset:128 lds
s_add_u32 m0, s55, 36736
s_nop 0
buffer_load_dwordx4 v1, s[4:7], s41 offen offset:128 lds
s_bitcmp1_b32 s43, 0
s_cbranch_scc1 L_g1_w_1008
s_branch L_g1_w_1007
L_g1_w_1005:
s_lshl4_add_u32 s36, s76, s36
s_bfe_u32 s40, s2, 0x20003
s_lshl2_add_u32 s54, s3, s40
s_lshl3_add_u32 s41, s54, s44
s_lshl1_add_u32 s41, s43, s41
s_lshl_b32 s42, s41, 11
s_lshl_b32 s41, s41, 3
s_mul_i32 s37, s54, 1536
s_mul_i32 s40, s58, 768
s_add_u32 s37, s37, s40
s_lshl2_add_u32 s37, s59, s37
s_add_u32 s37, s37, 16384
s_lshr_b32 s40, s2, 3
v_min_u32 v74, 27, v0
v_mul_u32_u24 v75, 9363, v74
v_lshrrev_b32 v75, 16, v75
v_mul_u32_u24 v76, 7, v75
v_sub_u32_e64 v76, v74, v76
v_lshl_add_u32 v75, v75, 5, s40
v_mul_u32_u24 v75, 7168, v75
v_lshl_add_u32 v18, v76, 7, v75
s_cmp_eq_u32 s58, 0
s_cselect_b32 s32, s64, s66
s_cselect_b32 s33, s65, s67
s_cselect_b32 s77, 1, -1
s_mov_b32 s34, 0x700000
s_mul_i32 s47, s3, 918400
s_mov_b32 s35, 0x00020000
s_add_u32 s47, s47, 1835008
s_add_u32 s20, s68, 0x400000
s_addc_u32 s21, s69, 0
s_mov_b32 s22, 0x1300000
s_mov_b32 s23, 0x00020000
s_mov_b32 s24, s68
s_mov_b32 s25, s69
s_mov_b32 s26, 0x20000
s_mov_b32 s27, 0x00020000
s_mov_b32 s28, s70
s_mov_b32 s29, s71
s_mov_b32 s30, 0x100
s_mov_b32 s31, 0x00020000
s_getpc_b64 s[70:71]
L_g1_tp_1010:
s_add_u32 s70, s70, L_pf_tab-L_g1_tp_1010
s_addc_u32 s71, s71, 0
s_and_b32 s55, s2, 1
s_lshl_b32 s55, s55, 5
s_add_u32 s55, s55, s40
s_lshl_b32 s55, s55, 2
s_load_dword s70, s[70:71], s55
v_and_b32 v74, 15, v0
v_lshrrev_b32 v75, 4, v0
v_lshrrev_b32 v76, 1, v74
v_xor_b32 v76, v76, v75
v_lshlrev_b32 v76, 4, v76
v_lshl_add_u32 v77, v74, 7, v76
v_add_u32 v6, 0, v77
v_xor_b32 v7, 64, v6
v_mov_b32 v78, 0x3f803f80
v_cmp_eq_u32 vcc, 0, v74
s_nop 1
v_cndmask_b32 v76, 0, v78, vcc
s_nop 0
v_accvgpr_write_b32 a152, v76
v_accvgpr_write_b32 a153, v76
v_accvgpr_write_b32 a154, v76
v_accvgpr_write_b32 a155, v76
v_cmp_eq_u32 vcc, 1, v74
s_nop 1
v_cndmask_b32 v76, 0, v78, vcc
s_nop 0
v_accvgpr_write_b32 a156, v76
v_accvgpr_write_b32 a157, v76
v_accvgpr_write_b32 a158, v76
v_accvgpr_write_b32 a159, v76
v_lshrrev_b32 v76, 2, v74
v_lshlrev_b32 v76, 6, v76
v_and_b32_e64 v77, 3, v0
v_lshl_add_u32 v76, v77, 3, v76
v_and_b32_e64 v77, 1, v75
v_lshl_add_u32 v76, v77, 5, v76
s_lshl_b32 s40, s58, 9
s_add_u32 s40, s40, 65536
v_lshl_add_u32 v77, v75, 10, v76
v_add_u32 v10, s40, v77
v_xor_b32_e64 v11, 32, v10
v_add_u32 v12, 40960, v10
v_add_u32 v13, 40960, v11
s_lshr_b32 s40, s59, 1
s_and_b32 s55, s59, 1
s_cmp_eq_u32 s59, 7
s_cselect_b32 s40, 4, s40
s_cselect_b32 s55, 0, s55
s_lshl_b32 s40, s40, 13
s_lshl_b32 s55, s55, 5
v_xor_b32 v8, s55, v10
v_add_u32 v8, s40, v8
v_mul_u32_u24 v9, 48, v0
v_bfrev_b32 v76, 2
v_cmp_gt_u32 vcc, 16, v0
s_nop 1
v_cndmask_b32 v9, v76, v9, vcc
v_mov_b32 v74, 0
v_mov_b32 v75, 0
v_mov_b32 v76, 0
v_mov_b32 v77, 0
buffer_store_dword v74, v9, s[24:27], s37 offen sc1
v_mov_b32 v78, 162304
ds_write_b64 v78, v[74:75]
s_add_u32 s60, s68, 0x4000000
s_addc_u32 s61, s69, 0
s_nop 0
s_mov_b32 s62, 0x14000
s_mov_b32 s63, 0x00020000
s_mul_i32 s40, s2, 320
s_mov_b64 exec, 0xfffff
buffer_store_dwordx4 v[74:77], v79, s[60:63], s40 offen sc1
s_mov_b64 exec, -1
s_mov_b32 s54, 0xffff0000
s_mov_b32 s60, s72
s_mov_b32 s61, s73
s_nop 0
s_mov_b32 s62, 0x200000
s_mov_b32 s63, 0x00020000
s_add_u32 s64, s68, 0x1800000
s_addc_u32 s65, s69, 0
s_mov_b32 s66, 0x900000
s_mov_b32 s67, 0x00020000
s_lshr_b32 s40, s2, 4
s_lshl_b32 s40, s40, 16
s_and_b32 s69, s2, 15
s_lshl_b32 s68, s69, 7
s_lshl_b32 s69, s69, 12
s_add_u32 s69, s69, s40
s_bfe_u32 s55, s2, 0x30004
s_lshl_b32 s69, s55, 16
s_bfe_u32 s40, s2, 0x30001
s_lshl_b32 s40, s40, 13
s_add_u32 s69, s69, s40
s_and_b32 s66, s69, 0xfff80000
s_add_u32 s66, s66, 0x900000
s_and_b32 s40, s2, 1
s_lshl_b32 s40, s40, 12
s_add_u32 s69, s69, s40
s_lshr_b32 s40, s2, 7
s_lshl_b32 s72, s40, 19
s_add_u32 s69, s69, s72
s_lshl2_add_u32 s40, s55, s40
s_lshl_b32 s40, s40, 16
s_mul_i32 s72, s55, 655360
s_mul_i32 s73, s55, 917504
s_add_u32 s68, s68, s40
s_lshl_b32 s40, s58, 14
s_add_u32 s68, s68, s40
s_lshl_b32 s40, s43, 8
s_add_u32 s69, s69, s40
v_lshrrev_b32 v46, 3, v0
v_lshrrev_b32_e64 v47, 5, v0
v_mad_u32_u24 v46, v47, 12, v46
v_and_b32 v47, 7, v0
v_lshlrev_b32 v47, 4, v47
v_lshl_add_u32 v4, v46, 11, v47
v_bfe_u32 v46, v0, 2, 2
v_lshlrev_b32 v46, 7, v46
v_lshrrev_b32 v47, 4, v0
v_lshl_add_u32 v46, v47, 5, v46
v_and_b32_e64 v47, 3, v0
v_lshl_add_u32 v46, v47, 3, v46
s_add_u32 s40, s76, 147456
v_add_u32_e64 v78, s40, v46
s_lshl_b32 s51, s59, 2
s_and_b32 s78, s59, 3
s_cmp_le_u32 s78, 0
s_cselect_b32 s78, 1, 0
s_mul_i32 s53, s78, 229376
s_add_u32 s53, s53, s38
s_mul_i32 s52, s78, 196608
s_add_u32 s52, s52, s39
s_lshr_b32 s46, s78, 1
s_mul_i32 s46, s46, 32768
s_lshl_b32 s78, s78, 12
s_add_u32 s46, s46, s78
s_add_u32 s46, s46, s76
s_add_u32 m0, s46, 65536
s_nop 0
buffer_load_dwordx4 v3, s[16:19], s52 offen nt lds
s_add_u32 m0, s46, 71680
s_nop 0
buffer_load_dwordx4 v3, s[16:19], s52 offen offset:2048 nt lds
s_add_u32 m0, s46, 81920
s_add_u32 s79, s52, 4096
buffer_load_dwordx4 v3, s[16:19], s79 offen nt lds
s_and_b32 s78, s59, 3
s_cmp_le_u32 s78, 1
s_cselect_b32 s78, 2, 1
s_mul_i32 s48, s78, 229376
s_add_u32 s48, s48, s38
s_mul_i32 s57, s78, 196608
s_add_u32 s57, s57, s39
s_lshr_b32 s49, s78, 1
s_mul_i32 s49, s49, 32768
s_lshl_b32 s78, s78, 12
s_add_u32 s49, s49, s78
s_add_u32 s49, s49, s76
s_add_u32 m0, s49, 65536
s_nop 0
buffer_load_dwordx4 v3, s[16:19], s57 offen nt lds
s_add_u32 m0, s49, 71680
s_nop 0
s_nop 0
buffer_load_dwordx4 v3, s[16:19], s57 offen offset:2048 nt lds
s_add_u32 m0, s49, 81920
s_add_u32 s79, s57, 4096
buffer_load_dwordx4 v3, s[16:19], s79 offen nt lds
s_bfe_u32 s55, s2, 0x20003
s_lshl_b32 s55, s55, 13
s_add_u32 s55, s55, 8192
s_and_b32 s55, s55, 32767
s_lshl4_add_u32 s79, s55, s36
s_add_u32 m0, s55, s76
s_nop 0
buffer_load_dwordx4 v1, s[4:7], s79 offen offset:0 lds
s_add_u32 s55, s55, 4096
s_and_b32 s55, s55, 32767
s_lshl4_add_u32 s79, s55, s36
s_add_u32 m0, s55, s76
s_nop 0
s_nop 0
buffer_load_dwordx4 v1, s[4:7], s79 offen offset:0 lds
s_add_u32 s55, s55, 4096
s_and_b32 s55, s55, 32767
s_lshl4_add_u32 s79, s55, s36
s_add_u32 m0, s55, s76
s_nop 0
s_nop 0
buffer_load_dwordx4 v1, s[4:7], s79 offen offset:0 lds
s_add_u32 s55, s55, 4096
s_and_b32 s55, s55, 32767
s_lshl4_add_u32 s79, s55, s36
s_add_u32 m0, s55, s76
s_nop 0
s_nop 0
buffer_load_dwordx4 v1, s[4:7], s79 offen offset:0 lds
s_add_u32 s55, s55, 4096
s_and_b32 s55, s55, 32767
s_lshl4_add_u32 s79, s55, s36
s_add_u32 m0, s55, s76
s_nop 0
s_nop 0
buffer_load_dwordx4 v1, s[4:7], s79 offen offset:0 lds
s_add_u32 s55, s55, 4096
s_and_b32 s55, s55, 32767
s_lshl4_add_u32 s79, s55, s36
s_add_u32 m0, s55, s76
s_nop 0
buffer_load_dwordx4 v1, s[4:7], s79 offen offset:0 lds
s_add_u32 m0, s46, 90112
s_nop 0
buffer_load_dwordx4 v2, s[8:11], s53 offen nt lds
s_add_u32 m0, s46, 98304
s_nop 0
buffer_load_dwordx4 v2, s[12:15], s53 offen nt lds
s_add_u32 m0, s49, 90112
s_nop 0
buffer_load_dwordx4 v2, s[8:11], s48 offen nt lds
s_add_u32 m0, s49, 98304
s_nop 0
buffer_load_dwordx4 v2, s[12:15], s48 offen nt lds
s_waitcnt vmcnt(4)
s_waitcnt lgkmcnt(0)
s_barrier
ds_read_b64_tr_b16 a[224:225], v10 offset:0
ds_read_b64_tr_b16 a[226:227], v10 offset:256
ds_read_b64_tr_b16 a[228:229], v10 offset:4096
ds_read_b64_tr_b16 a[230:231], v10 offset:4352
ds_read_b128 a[160:163], v6 offset:0
ds_read_b128 a[164:167], v7 offset:0
ds_read_b128 a[172:175], v7 offset:2048
ds_read_b128 a[168:171], v6 offset:2048
ds_read_b128 a[176:179], v6 offset:4096
ds_read_b128 a[180:183], v7 offset:4096
ds_read_b128 a[188:191], v7 offset:6144
ds_read_b128 a[184:187], v6 offset:6144
ds_read_b128 a[192:195], v6 offset:8192
ds_read_b128 a[196:199], v7 offset:8192
ds_read_b128 a[204:207], v7 offset:10240
ds_read_b128 a[200:203], v6 offset:10240
ds_read_b128 a[208:211], v6 offset:12288
ds_read_b128 a[212:215], v7 offset:12288
ds_read_b128 a[220:223], v7 offset:14336
ds_read_b128 a[216:219], v6 offset:14336
s_waitcnt lgkmcnt(15)
v_mfma_f32_16x16x32_bf16 a[0:3], a[224:227], a[160:163], 0
s_waitcnt lgkmcnt(14)
s_bfe_u32 s55, s2, 0x20003
ds_read_b64_tr_b16 a[232:233], v11 offset:0
v_mfma_f32_16x16x32_bf16 a[0:3], a[228:231], a[164:167], a[0:3]
s_waitcnt lgkmcnt(14)
s_lshl_b32 s55, s55, 13
ds_read_b64_tr_b16 a[234:235], v11 offset:256
v_mfma_f32_16x16x32_bf16 a[24:27], a[228:231], a[172:175], 0
s_waitcnt lgkmcnt(14)
s_add_u32 s55, s55, 8192
ds_read_b64_tr_b16 a[236:237], v11 offset:4096
v_mfma_f32_16x16x32_bf16 a[24:27], a[224:227], a[168:171], a[24:27]
s_waitcnt lgkmcnt(14)
s_and_b32 s55, s55, 32767
ds_read_b64_tr_b16 a[238:239], v11 offset:4352
v_mfma_f32_16x16x32_bf16 a[48:51], a[224:227], a[176:179], 0
s_waitcnt lgkmcnt(14)
s_lshl4_add_u32 s79, s55, s36
s_add_u32 m0, s55, s76
v_mfma_f32_16x16x32_bf16 a[48:51], a[228:231], a[180:183], a[48:51]
s_waitcnt lgkmcnt(13)
s_add_u32 m0, m0, 32640
v_mfma_f32_16x16x32_bf16 a[72:75], a[228:231], a[188:191], 0
s_waitcnt lgkmcnt(12)
buffer_load_dwordx4 v1, s[4:7], s79 offen offset:128 lds
v_mfma_f32_16x16x32_bf16 a[72:75], a[224:227], a[184:187], a[72:75]
s_waitcnt lgkmcnt(11)
s_add_u32 s55, s55, 4096
s_and_b32 s55, s55, 32767
v_mfma_f32_16x16x32_bf16 a[96:99], a[224:227], a[192:195], 0
s_waitcnt lgkmcnt(10)
s_lshl4_add_u32 s79, s55, s36
s_add_u32 m0, s55, s76
v_mfma_f32_16x16x32_bf16 a[96:99], a[228:231], a[196:199], a[96:99]
s_waitcnt lgkmcnt(9)
s_add_u32 m0, m0, 32640
v_mfma_f32_16x16x32_bf16 a[120:123], a[228:231], a[204:207], 0
s_waitcnt lgkmcnt(8)
buffer_load_dwordx4 v1, s[4:7], s79 offen offset:128 lds
v_mfma_f32_16x16x32_bf16 a[120:123], a[224:227], a[200:203], a[120:123]
s_waitcnt lgkmcnt(7)
s_add_u32 s55, s55, 4096
s_and_b32 s55, s55, 32767
v_mfma_f32_16x16x32_bf16 v[208:211], a[224:227], a[208:211], 0
s_waitcnt lgkmcnt(6)
s_lshl4_add_u32 s79, s55, s36
s_add_u32 m0, s55, s76
v_mfma_f32_16x16x32_bf16 v[208:211], a[228:231], a[212:215], v[208:211]
s_waitcnt lgkmcnt(5)
s_add_u32 m0, m0, 32640
v_mfma_f32_16x16x32_bf16 v[232:235], a[228:231], a[220:223], 0
s_waitcnt lgkmcnt(4)
buffer_load_dwordx4 v1, s[4:7], s79 offen offset:128 lds
v_mfma_f32_16x16x32_bf16 v[232:235], a[224:227], a[216:219], v[232:235]
s_waitcnt vmcnt(3) lgkmcnt(0)
s_barrier
v_mfma_f32_16x16x32_bf16 v[236:239], a[232:235], a[216:219], 0
s_add_u32 s55, s55, 4096
s_and_b32 s55, s55, 32767
ds_read_b64_tr_b16 a[224:225], v10 offset:8192
v_mfma_f32_16x16x32_bf16 v[236:239], a[236:239], a[220:223], v[236:239]
s_lshl4_add_u32 s79, s55, s36
s_add_u32 m0, s55, s76
ds_read_b64_tr_b16 a[226:227], v10 offset:8448
v_mfma_f32_16x16x32_bf16 v[212:215], a[236:239], a[212:215], 0
s_add_u32 m0, m0, 32640
ds_read_b64_tr_b16 a[228:229], v10 offset:12288
v_mfma_f32_16x16x32_bf16 v[212:215], a[232:235], a[208:211], v[212:215]
buffer_load_dwordx4 v1, s[4:7], s79 offen offset:128 lds
v_mfma_f32_16x16x32_bf16 a[124:127], a[232:235], a[200:203], 0
s_add_u32 s55, s55, 4096
s_and_b32 s55, s55, 32767
ds_read_b64_tr_b16 a[230:231], v10 offset:12544
v_mfma_f32_16x16x32_bf16 a[124:127], a[236:239], a[204:207], a[124:127]
s_lshl4_add_u32 s79, s55, s36
s_add_u32 m0, s55, s76
s_add_u32 m0, m0, 32640
v_mfma_f32_16x16x32_bf16 a[100:103], a[236:239], a[196:199], 0
buffer_load_dwordx4 v1, s[4:7], s79 offen offset:128 lds
v_mfma_f32_16x16x32_bf16 a[100:103], a[232:235], a[192:195], a[100:103]
s_add_u32 s55, s55, 4096
s_and_b32 s55, s55, 32767
ds_read_b64_tr_b16 a[148:149], v8 offset:0
v_mfma_f32_16x16x32_bf16 a[76:79], a[232:235], a[184:187], 0
s_lshl4_add_u32 s79, s55, s36
s_add_u32 m0, s55, s76
ds_read_b64_tr_b16 a[150:151], v8 offset:256
v_mfma_f32_16x16x32_bf16 a[76:79], a[236:239], a[188:191], a[76:79]
s_add_u32 m0, m0, 32640
v_mfma_f32_16x16x32_bf16 a[52:55], a[236:239], a[180:183], 0
buffer_load_dwordx4 v1, s[4:7], s79 offen offset:128 lds
v_mfma_f32_16x16x32_bf16 a[52:55], a[232:235], a[176:179], a[52:55]
s_and_b32 s78, s59, 3
s_cmp_le_u32 s78, 2
s_cselect_b32 s78, 3, 2
v_mfma_f32_16x16x32_bf16 a[28:31], a[232:235], a[168:171], 0
s_mul_i32 s53, s78, 229376
s_add_u32 s53, s53, s38
s_mul_i32 s52, s78, 196608
v_mfma_f32_16x16x32_bf16 a[28:31], a[236:239], a[172:175], a[28:31]
s_add_u32 s52, s52, s39
s_lshr_b32 s46, s78, 1
s_mul_i32 s46, s46, 32768
v_mfma_f32_16x16x32_bf16 a[4:7], a[236:239], a[164:167], 0
s_lshl_b32 s78, s78, 12
s_add_u32 s46, s46, s78
s_add_u32 s46, s46, s76
v_mfma_f32_16x16x32_bf16 a[4:7], a[232:235], a[160:163], a[4:7]
s_waitcnt lgkmcnt(4)
s_add_u32 m0, s46, 65536
v_mfma_f32_16x16x32_bf16 a[8:11], a[224:227], a[160:163], 0
s_waitcnt lgkmcnt(2)
buffer_load_dwordx4 v3, s[16:19], s52 offen nt lds
v_mfma_f32_16x16x32_bf16 a[8:11], a[228:231], a[164:167], a[8:11]
s_add_u32 m0, s46, 71680
ds_read_b64_tr_b16 a[232:233], v11 offset:8192
v_mfma_f32_16x16x32_bf16 a[32:35], a[228:231], a[172:175], 0
buffer_load_dwordx4 v3, s[16:19], s52 offen offset:2048 nt lds
v_mfma_f32_16x16x32_bf16 a[32:35], a[224:227], a[168:171], a[32:35]
s_add_u32 m0, s46, 81920
s_add_u32 s79, s52, 4096
ds_read_b64_tr_b16 a[234:235], v11 offset:8448
v_mfma_f32_16x16x32_bf16 a[56:59], a[224:227], a[176:179], 0
buffer_load_dwordx4 v3, s[16:19], s79 offen nt lds
v_mfma_f32_16x16x32_bf16 a[56:59], a[228:231], a[180:183], a[56:59]
s_add_u32 m0, s46, 90112
ds_read_b64_tr_b16 a[236:237], v11 offset:12288
v_mfma_f32_16x16x32_bf16 a[80:83], a[228:231], a[188:191], 0
buffer_load_dwordx4 v2, s[8:11], s53 offen nt lds
v_mfma_f32_16x16x32_bf16 a[80:83], a[224:227], a[184:187], a[80:83]
s_waitcnt lgkmcnt(3)
s_add_u32 m0, s46, 98304
ds_read_b64_tr_b16 a[238:239], v11 offset:12544
v_mfma_f32_16x16x32_bf16 a[144:147], a[152:155], a[148:151], 0
buffer_load_dwordx4 v2, s[12:15], s53 offen nt lds
v_mfma_f32_16x16x32_bf16 a[104:107], a[224:227], a[192:195], 0
s_sub_u32 s56, s56, 1
s_cmp_eq_u32 s56, 0
s_cselect_b32 s78, -7, 1
v_mfma_f32_16x16x32_bf16 a[104:107], a[228:231], a[196:199], a[104:107]
s_mul_i32 s55, s78, 917504
s_add_u32 s38, s38, s55
ds_read_b64_tr_b16 a[148:149], v8 offset:4096
v_mfma_f32_16x16x32_bf16 a[128:131], a[228:231], a[204:207], 0
s_mul_i32 s55, s78, 786432
s_add_u32 s39, s39, s55
ds_read_b64_tr_b16 a[150:151], v8 offset:4352
v_mfma_f32_16x16x32_bf16 a[128:131], a[224:227], a[200:203], a[128:131]
s_lshl_b32 s55, s78, 8
s_add_u32 s36, s36, s55
v_and_b32_e64 v44, 7, v0
v_mfma_f32_16x16x32_bf16 v[216:219], a[224:227], a[208:211], 0
s_cmp_ge_u32 s47, 7340032
s_cselect_b32 s78, 7340032, 0
s_sub_u32 s47, s47, s78
v_mfma_f32_16x16x32_bf16 v[216:219], a[228:231], a[212:215], v[216:219]
buffer_load_dword v19, v18, s[32:35], s47 offen
v_mfma_f32_16x16x32_bf16 v[240:243], a[228:231], a[220:223], 0
s_add_u32 s47, s47, 917504
s_add_u32 m0, s76, 155648
v_lshrrev_b32 v45, 4, v0
v_mfma_f32_16x16x32_bf16 v[240:243], a[224:227], a[216:219], v[240:243]
s_waitcnt lgkmcnt(4)
buffer_load_dwordx4 v4, s[60:63], s68 offen nt lds
v_mfma_f32_16x16x32_bf16 v[244:247], a[232:235], a[216:219], 0
s_waitcnt lgkmcnt(2)
s_add_u32 s68, s68, 0x20000
ds_read_b64_tr_b16 a[224:225], v10 offset:16384
v_mfma_f32_16x16x32_bf16 v[244:247], a[236:239], a[220:223], v[244:247]
ds_read_b64_tr_b16 a[226:227], v10 offset:16640
v_lshl_add_u32 v44, v45, 3, v44
v_mfma_f32_16x16x32_bf16 v[220:223], a[236:239], a[212:215], 0
ds_read_b64_tr_b16 a[228:229], v10 offset:20480
v_mfma_f32_16x16x32_bf16 v[220:223], a[232:235], a[208:211], v[220:223]
ds_read_b64_tr_b16 a[230:231], v10 offset:20736
v_mfma_f32_16x16x32_bf16 a[132:135], a[232:235], a[200:203], 0
v_mfma_f32_16x16x32_bf16 a[132:135], a[236:239], a[204:207], a[132:135]
v_mfma_f32_16x16x32_bf16 a[108:111], a[236:239], a[196:199], 0
v_lshlrev_b32_e64 v44, 4, v44
v_mfma_f32_16x16x32_bf16 a[108:111], a[232:235], a[192:195], a[108:111]
s_waitcnt lgkmcnt(4)
v_mfma_f32_16x16x32_bf16 a[144:147], a[152:155], a[148:151], a[144:147]
v_mfma_f32_16x16x32_bf16 a[84:87], a[232:235], a[184:187], 0
v_mfma_f32_16x16x32_bf16 a[84:87], a[236:239], a[188:191], a[84:87]
v_mfma_f32_16x16x32_bf16 a[60:63], a[236:239], a[180:183], 0
v_bfe_u32 v45, v0, 3, 1
v_mfma_f32_16x16x32_bf16 a[60:63], a[232:235], a[176:179], a[60:63]
v_mfma_f32_16x16x32_bf16 a[36:39], a[232:235], a[168:171], 0
v_mfma_f32_16x16x32_bf16 a[36:39], a[236:239], a[172:175], a[36:39]
v_mfma_f32_16x16x32_bf16 a[12:15], a[236:239], a[164:167], 0
v_mfma_f32_16x16x32_bf16 a[12:15], a[232:235], a[160:163], a[12:15]
s_waitcnt lgkmcnt(2)
v_lshl_add_u32 v44, v45, 11, v44
v_mfma_f32_16x16x32_bf16 a[16:19], a[160:163], a[224:227], 0
s_waitcnt lgkmcnt(0)
ds_read_b64_tr_b16 a[232:233], v11 offset:16384
v_mfma_f32_16x16x32_bf16 a[16:19], a[164:167], a[228:231], a[16:19]
ds_read_b64_tr_b16 a[234:235], v11 offset:16640
v_mfma_f32_16x16x32_bf16 a[40:43], a[172:175], a[228:231], 0
ds_read_b64_tr_b16 a[236:237], v11 offset:20480
v_mfma_f32_16x16x32_bf16 a[40:43], a[168:171], a[224:227], a[40:43]
ds_read_b64_tr_b16 a[238:239], v11 offset:20736
v_mfma_f32_16x16x32_bf16 a[64:67], a[176:179], a[224:227], 0
buffer_load_dwordx4 v[20:23], v44, s[4:7], s42 offen offset:0
v_mfma_f32_16x16x32_bf16 a[64:67], a[180:183], a[228:231], a[64:67]
v_mfma_f32_16x16x32_bf16 a[88:91], a[188:191], a[228:231], 0
buffer_load_dwordx4 v[24:27], v44, s[4:7], s42 offen offset:512
v_mfma_f32_16x16x32_bf16 a[88:91], a[184:187], a[224:227], a[88:91]
v_mfma_f32_16x16x32_bf16 a[112:115], a[192:195], a[224:227], 0
v_mfma_f32_16x16x32_bf16 a[112:115], a[196:199], a[228:231], a[112:115]
buffer_load_dwordx4 v[28:31], v44, s[4:7], s42 offen offset:1024
v_mfma_f32_16x16x32_bf16 a[136:139], a[204:207], a[228:231], 0
v_mfma_f32_16x16x32_bf16 a[136:139], a[200:203], a[224:227], a[136:139]
buffer_load_dwordx4 v[32:35], v44, s[4:7], s42 offen offset:1536
v_mfma_f32_16x16x32_bf16 v[224:227], a[208:211], a[224:227], 0
v_mfma_f32_16x16x32_bf16 v[224:227], a[212:215], a[228:231], v[224:227]
v_mfma_f32_16x16x32_bf16 v[248:251], a[220:223], a[228:231], 0
v_mfma_f32_16x16x32_bf16 v[248:251], a[216:219], a[224:227], v[248:251]
s_waitcnt vmcnt(11) lgkmcnt(0)
s_barrier
v_mfma_f32_16x16x32_bf16 v[252:255], a[216:219], a[232:235], 0
s_add_u32 m0, s76, 0
s_add_u32 s79, s36, 0
ds_read_b64_tr_b16 a[224:225], v10 offset:24576
v_mfma_f32_16x16x32_bf16 v[252:255], a[220:223], a[236:239], v[252:255]
buffer_load_dwordx4 v1, s[4:7], s79 offen lds
v_mfma_f32_16x16x32_bf16 v[228:231], a[212:215], a[236:239], 0
s_add_u32 m0, s76, 4096
s_add_u32 s79, s36, 65536
ds_read_b64_tr_b16 a[226:227], v10 offset:24832
v_mfma_f32_16x16x32_bf16 v[228:231], a[208:211], a[232:235], v[228:231]
ds_read_b64_tr_b16 a[228:229], v10 offset:28672
v_mfma_f32_16x16x32_bf16 a[140:143], a[200:203], a[232:235], 0
ds_read_b64_tr_b16 a[230:231], v10 offset:28928
v_mfma_f32_16x16x32_bf16 a[140:143], a[204:207], a[236:239], a[140:143]
ds_read_b128 v[58:61], v6 offset:32768
v_mfma_f32_16x16x32_bf16 a[116:119], a[196:199], a[236:239], 0
v_mfma_f32_16x16x32_bf16 a[116:119], a[192:195], a[232:235], a[116:119]
v_mfma_f32_16x16x32_bf16 a[92:95], a[184:187], a[232:235], 0
buffer_load_dwordx4 v1, s[4:7], s79 offen lds
v_mfma_f32_16x16x32_bf16 a[92:95], a[188:191], a[236:239], a[92:95]
s_add_u32 m0, s76, 8192
s_add_u32 s79, s36, 131072
v_mfma_f32_16x16x32_bf16 a[68:71], a[180:183], a[236:239], 0
v_mfma_f32_16x16x32_bf16 a[68:71], a[176:179], a[232:235], a[68:71]
ds_read_b128 v[62:65], v7 offset:32768
v_mfma_f32_16x16x32_bf16 a[44:47], a[168:171], a[232:235], 0
v_mfma_f32_16x16x32_bf16 a[44:47], a[172:175], a[236:239], a[44:47]
v_mfma_f32_16x16x32_bf16 a[20:23], a[164:167], a[236:239], 0
v_mfma_f32_16x16x32_bf16 a[20:23], a[160:163], a[232:235], a[20:23]
s_waitcnt lgkmcnt(4)
buffer_load_dwordx4 v1, s[4:7], s79 offen lds
v_mfma_f32_16x16x32_bf16 v[80:83], a[224:227], a[160:163], 0
s_waitcnt lgkmcnt(2)
s_add_u32 m0, s76, 12288
ds_read_b64_tr_b16 a[232:233], v10 offset:32768
v_mfma_f32_16x16x32_bf16 v[80:83], a[228:231], a[164:167], v[80:83]
s_add_u32 s79, s36, 196608
ds_read_b64_tr_b16 a[234:235], v10 offset:33024
v_mfma_f32_16x16x32_bf16 v[96:99], a[228:231], a[172:175], 0
ds_read_b64_tr_b16 a[236:237], v10 offset:36864
v_mfma_f32_16x16x32_bf16 v[96:99], a[224:227], a[168:171], v[96:99]
ds_read_b64_tr_b16 a[238:239], v10 offset:37120
v_mfma_f32_16x16x32_bf16 v[112:115], a[224:227], a[176:179], 0
ds_read_b128 v[70:73], v7 offset:34816
v_mfma_f32_16x16x32_bf16 v[112:115], a[228:231], a[180:183], v[112:115]
v_mfma_f32_16x16x32_bf16 v[128:131], a[228:231], a[188:191], 0
buffer_load_dwordx4 v1, s[4:7], s79 offen lds
v_mfma_f32_16x16x32_bf16 v[128:131], a[224:227], a[184:187], v[128:131]
s_add_u32 m0, s76, 16384
s_add_u32 s79, s36, 262144
v_mfma_f32_16x16x32_bf16 v[144:147], a[224:227], a[192:195], 0
v_mfma_f32_16x16x32_bf16 v[144:147], a[228:231], a[196:199], v[144:147]
ds_read_b128 v[66:69], v6 offset:34816
v_mfma_f32_16x16x32_bf16 v[160:163], a[228:231], a[204:207], 0
v_mfma_f32_16x16x32_bf16 v[160:163], a[224:227], a[200:203], v[160:163]
v_mfma_f32_16x16x32_bf16 v[176:179], a[224:227], a[208:211], 0
v_mfma_f32_16x16x32_bf16 v[176:179], a[228:231], a[212:215], v[176:179]
buffer_load_dwordx4 v1, s[4:7], s79 offen lds
v_mfma_f32_16x16x32_bf16 v[192:195], a[228:231], a[220:223], 0
s_add_u32 m0, s76, 20480
s_add_u32 s79, s36, 327680
v_mfma_f32_16x16x32_bf16 v[192:195], a[224:227], a[216:219], v[192:195]
s_waitcnt lgkmcnt(4)
v_mfma_f32_16x16x32_bf16 v[196:199], a[232:235], a[216:219], 0
s_waitcnt lgkmcnt(2)
ds_read_b64_tr_b16 a[224:225], v11 offset:24576
v_mfma_f32_16x16x32_bf16 v[196:199], a[236:239], a[220:223], v[196:199]
ds_read_b64_tr_b16 a[226:227], v11 offset:24832
v_mfma_f32_16x16x32_bf16 v[180:183], a[236:239], a[212:215], 0
ds_read_b64_tr_b16 a[228:229], v11 offset:28672
v_mfma_f32_16x16x32_bf16 v[180:183], a[232:235], a[208:211], v[180:183]
ds_read_b64_tr_b16 a[230:231], v11 offset:28928
v_mfma_f32_16x16x32_bf16 v[164:167], a[232:235], a[200:203], 0
buffer_load_dwordx4 v1, s[4:7], s79 offen lds
v_mfma_f32_16x16x32_bf16 v[164:167], a[236:239], a[204:207], v[164:167]
s_add_u32 m0, s76, 24576
s_add_u32 s79, s36, 393216
ds_read_b128 a[240:243], v6 offset:36864
v_mfma_f32_16x16x32_bf16 v[148:151], a[236:239], a[196:199], 0
v_mfma_f32_16x16x32_bf16 v[148:151], a[232:235], a[192:195], v[148:151]
ds_read_b128 a[244:247], v7 offset:36864
v_mfma_f32_16x16x32_bf16 v[132:135], a[232:235], a[184:187], 0
v_mfma_f32_16x16x32_bf16 v[132:135], a[236:239], a[188:191], v[132:135]
v_mfma_f32_16x16x32_bf16 v[116:119], a[236:239], a[180:183], 0
v_mfma_f32_16x16x32_bf16 v[116:119], a[232:235], a[176:179], v[116:119]
buffer_load_dwordx4 v1, s[4:7], s79 offen lds
v_mfma_f32_16x16x32_bf16 v[100:103], a[232:235], a[168:171], 0
s_add_u32 m0, s76, 28672
s_add_u32 s79, s36, 458752
v_mfma_f32_16x16x32_bf16 v[100:103], a[236:239], a[172:175], v[100:103]
v_mfma_f32_16x16x32_bf16 v[84:87], a[236:239], a[164:167], 0
ds_read_b128 a[252:255], v7 offset:38912
v_mfma_f32_16x16x32_bf16 v[84:87], a[232:235], a[160:163], v[84:87]
s_waitcnt lgkmcnt(5)
v_mfma_f32_16x16x32_bf16 v[88:91], a[224:227], a[160:163], 0
s_waitcnt lgkmcnt(3)
ds_read_b64_tr_b16 a[232:233], v11 offset:32768
v_mfma_f32_16x16x32_bf16 v[88:91], a[228:231], a[164:167], v[88:91]
ds_read_b64_tr_b16 a[234:235], v11 offset:33024
v_mfma_f32_16x16x32_bf16 v[104:107], a[228:231], a[172:175], 0
buffer_load_dwordx4 v1, s[4:7], s79 offen lds
v_mfma_f32_16x16x32_bf16 v[104:107], a[224:227], a[168:171], v[104:107]
s_add_u32 s36, s36, 128
s_add_u32 m0, s76, 65536
ds_read_b64_tr_b16 a[236:237], v11 offset:36864
v_mfma_f32_16x16x32_bf16 v[120:123], a[224:227], a[176:179], 0
ds_read_b64_tr_b16 a[238:239], v11 offset:37120
v_mfma_f32_16x16x32_bf16 v[120:123], a[228:231], a[180:183], v[120:123]
ds_read_b128 a[248:251], v6 offset:38912
v_mfma_f32_16x16x32_bf16 v[136:139], a[228:231], a[188:191], 0
v_mfma_f32_16x16x32_bf16 v[136:139], a[224:227], a[184:187], v[136:139]
v_mfma_f32_16x16x32_bf16 v[152:155], a[224:227], a[192:195], 0
v_mfma_f32_16x16x32_bf16 v[152:155], a[228:231], a[196:199], v[152:155]
buffer_load_dwordx4 v3, s[16:19], s39 offen nt lds
v_mfma_f32_16x16x32_bf16 v[168:171], a[228:231], a[204:207], 0
s_add_u32 m0, s76, 71680
v_mfma_f32_16x16x32_bf16 v[168:171], a[224:227], a[200:203], v[168:171]
v_mfma_f32_16x16x32_bf16 v[184:187], a[224:227], a[208:211], 0
v_mfma_f32_16x16x32_bf16 v[184:187], a[228:231], a[212:215], v[184:187]
v_mfma_f32_16x16x32_bf16 v[200:203], a[228:231], a[220:223], 0
v_mfma_f32_16x16x32_bf16 v[200:203], a[224:227], a[216:219], v[200:203]
s_waitcnt vmcnt(15) lgkmcnt(1)
s_barrier
v_mfma_f32_16x16x32_bf16 v[204:207], a[232:235], a[216:219], 0
buffer_load_dwordx4 v3, s[16:19], s39 offen offset:2048 nt lds
v_mfma_f32_16x16x32_bf16 v[204:207], a[236:239], a[220:223], v[204:207]
s_add_u32 m0, s76, 81920
s_add_u32 s79, s39, 4096
ds_read_b64_tr_b16 a[224:225], v12 offset:0
v_mfma_f32_16x16x32_bf16 v[188:191], a[236:239], a[212:215], 0
ds_read_b64_tr_b16 a[226:227], v12 offset:256
v_mfma_f32_16x16x32_bf16 v[188:191], a[232:235], a[208:211], v[188:191]
ds_read_b64_tr_b16 a[228:229], v12 offset:4096
v_mfma_f32_16x16x32_bf16 v[172:175], a[232:235], a[200:203], 0
ds_read_b64_tr_b16 a[230:231], v12 offset:4352
v_mfma_f32_16x16x32_bf16 v[172:175], a[236:239], a[204:207], v[172:175]
v_mfma_f32_16x16x32_bf16 v[156:159], a[236:239], a[196:199], 0
v_mfma_f32_16x16x32_bf16 v[156:159], a[232:235], a[192:195], v[156:159]
buffer_load_dwordx4 v3, s[16:19], s79 offen nt lds
v_mfma_f32_16x16x32_bf16 v[140:143], a[232:235], a[184:187], 0
s_add_u32 m0, s76, 69632
s_add_u32 s79, s39, 196608
ds_read_b128 a[192:195], v6 offset:40960
v_mfma_f32_16x16x32_bf16 v[140:143], a[236:239], a[188:191], v[140:143]
ds_read_b128 a[196:199], v7 offset:40960
v_mfma_f32_16x16x32_bf16 v[124:127], a[236:239], a[180:183], 0
ds_read_b128 a[204:207], v7 offset:43008
v_mfma_f32_16x16x32_bf16 v[124:127], a[232:235], a[176:179], v[124:127]
ds_read_b128 a[200:203], v6 offset:43008
v_mfma_f32_16x16x32_bf16 v[108:111], a[232:235], a[168:171], 0
ds_read_b128 a[208:211], v6 offset:45056
v_mfma_f32_16x16x32_bf16 v[108:111], a[236:239], a[172:175], v[108:111]
ds_read_b128 a[212:215], v7 offset:45056
v_mfma_f32_16x16x32_bf16 v[92:95], a[236:239], a[164:167], 0
buffer_load_dwordx4 v3, s[16:19], s79 offen nt lds
v_mfma_f32_16x16x32_bf16 v[92:95], a[232:235], a[160:163], v[92:95]
s_waitcnt lgkmcnt(8)
s_add_u32 m0, s76, 75776
s_mov_b32 s46, 6
v_mfma_f32_16x16x32_bf16 a[0:3], a[224:227], v[58:61], a[0:3]
s_waitcnt lgkmcnt(6)
ds_read_b128 a[220:223], v7 offset:47104
v_mfma_f32_16x16x32_bf16 a[0:3], a[228:231], v[62:65], a[0:3]
ds_read_b128 a[216:219], v6 offset:47104
v_mfma_f32_16x16x32_bf16 a[24:27], a[228:231], v[70:73], a[24:27]
ds_read_b64_tr_b16 a[232:233], v13 offset:0
v_mfma_f32_16x16x32_bf16 a[24:27], a[224:227], v[66:69], a[24:27]
ds_read_b64_tr_b16 a[234:235], v13 offset:256
v_mfma_f32_16x16x32_bf16 a[48:51], a[224:227], a[240:243], a[48:51]
ds_read_b64_tr_b16 a[236:237], v13 offset:4096
v_lshrrev_b32_e64 v46, 4, v0
v_mfma_f32_16x16x32_bf16 a[48:51], a[228:231], a[244:247], a[48:51]
buffer_load_dwordx4 v3, s[16:19], s79 offen offset:2048 nt lds
v_mfma_f32_16x16x32_bf16 a[72:75], a[228:231], a[252:255], a[72:75]
s_add_u32 m0, s76, 86016
s_add_u32 s79, s39, 200704
ds_read_b64_tr_b16 a[238:239], v13 offset:4352
v_mfma_f32_16x16x32_bf16 a[72:75], a[224:227], a[248:251], a[72:75]
s_waitcnt lgkmcnt(11)
v_mfma_f32_16x16x32_bf16 a[96:99], a[224:227], a[192:195], a[96:99]
s_waitcnt lgkmcnt(10)
v_lshlrev_b32_e64 v46, 10, v46
v_mfma_f32_16x16x32_bf16 a[96:99], a[228:231], a[196:199], a[96:99]
s_waitcnt lgkmcnt(9)
v_mfma_f32_16x16x32_bf16 a[120:123], a[228:231], a[204:207], a[120:123]
s_waitcnt lgkmcnt(8)
v_mfma_f32_16x16x32_bf16 a[120:123], a[224:227], a[200:203], a[120:123]
s_waitcnt lgkmcnt(7)
v_mfma_f32_16x16x32_bf16 v[208:211], a[224:227], a[208:211], v[208:211]
s_waitcnt lgkmcnt(6)
buffer_load_dwordx4 v3, s[16:19], s79 offen nt lds
v_mfma_f32_16x16x32_bf16 v[208:211], a[228:231], a[212:215], v[208:211]
s_waitcnt lgkmcnt(5)
s_add_u32 s39, s39, 393216
s_add_u32 m0, s76, 90112
v_mfma_f32_16x16x32_bf16 v[232:235], a[228:231], a[220:223], v[232:235]
s_waitcnt lgkmcnt(4)
v_and_b32_e64 v47, 15, v0
v_mfma_f32_16x16x32_bf16 v[232:235], a[224:227], a[216:219], v[232:235]
s_waitcnt lgkmcnt(2)
v_mfma_f32_16x16x32_bf16 v[236:239], a[232:235], a[216:219], v[236:239]
s_waitcnt lgkmcnt(0)
ds_read_b64_tr_b16 a[224:225], v12 offset:8192
v_lshl_add_u32 v79, v47, 4, v46
v_mfma_f32_16x16x32_bf16 v[236:239], a[236:239], a[220:223], v[236:239]
ds_read_b64_tr_b16 a[226:227], v12 offset:8448
v_mfma_f32_16x16x32_bf16 v[212:215], a[236:239], a[212:215], v[212:215]
ds_read_b64_tr_b16 a[228:229], v12 offset:12288
v_mfma_f32_16x16x32_bf16 v[212:215], a[232:235], a[208:211], v[212:215]
buffer_load_dwordx4 v2, s[8:11], s38 offen nt lds
v_mfma_f32_16x16x32_bf16 a[124:127], a[232:235], a[200:203], a[124:127]
s_add_u32 m0, s76, 98304
ds_read_b64_tr_b16 a[230:231], v12 offset:12544
v_mfma_f32_16x16x32_bf16 a[124:127], a[236:239], a[204:207], a[124:127]
v_mfma_f32_16x16x32_bf16 a[100:103], a[236:239], a[196:199], a[100:103]
ds_read_b64_tr_b16 a[148:149], v8 offset:40960
v_mfma_f32_16x16x32_bf16 a[100:103], a[232:235], a[192:195], a[100:103]
ds_read_b64_tr_b16 a[150:151], v8 offset:41216
v_mfma_f32_16x16x32_bf16 a[76:79], a[232:235], a[248:251], a[76:79]
v_mfma_f32_16x16x32_bf16 a[76:79], a[236:239], a[252:255], a[76:79]
v_mfma_f32_16x16x32_bf16 a[52:55], a[236:239], a[244:247], a[52:55]
buffer_load_dwordx4 v2, s[12:15], s38 offen nt lds
v_mfma_f32_16x16x32_bf16 a[52:55], a[232:235], a[240:243], a[52:55]
s_add_u32 m0, s76, 94208
s_add_u32 s79, s38, 229376
v_mfma_f32_16x16x32_bf16 a[28:31], a[232:235], v[66:69], a[28:31]
v_mfma_f32_16x16x32_bf16 a[28:31], a[236:239], v[70:73], a[28:31]
v_mfma_f32_16x16x32_bf16 a[4:7], a[236:239], v[62:65], a[4:7]
v_mfma_f32_16x16x32_bf16 a[4:7], a[232:235], v[58:61], a[4:7]
s_waitcnt lgkmcnt(4)
v_mfma_f32_16x16x32_bf16 a[8:11], a[224:227], v[58:61], a[8:11]
s_waitcnt lgkmcnt(2)
ds_read_b64_tr_b16 a[232:233], v13 offset:8192
v_mfma_f32_16x16x32_bf16 a[8:11], a[228:231], v[62:65], a[8:11]
buffer_load_dwordx4 v2, s[8:11], s79 offen nt lds
v_mfma_f32_16x16x32_bf16 a[32:35], a[228:231], v[70:73], a[32:35]
s_add_u32 m0, s76, 102400
ds_read_b64_tr_b16 a[234:235], v13 offset:8448
v_mfma_f32_16x16x32_bf16 a[32:35], a[224:227], v[66:69], a[32:35]
ds_read_b64_tr_b16 a[236:237], v13 offset:12288
v_mfma_f32_16x16x32_bf16 a[56:59], a[224:227], a[240:243], a[56:59]
ds_read_b64_tr_b16 a[238:239], v13 offset:12544
v_mfma_f32_16x16x32_bf16 a[56:59], a[228:231], a[244:247], a[56:59]
v_mfma_f32_16x16x32_bf16 a[80:83], a[228:231], a[252:255], a[80:83]
v_mfma_f32_16x16x32_bf16 a[80:83], a[224:227], a[248:251], a[80:83]
s_waitcnt lgkmcnt(4)
v_mfma_f32_16x16x32_bf16 a[144:147], a[152:155], a[148:151], a[144:147]
buffer_load_dwordx4 v2, s[12:15], s79 offen nt lds
v_mfma_f32_16x16x32_bf16 a[104:107], a[224:227], a[192:195], a[104:107]
s_add_u32 s38, s38, 458752
s_add_u32 m0, s76, 147456
s_waitcnt vmcnt(18)
v_mfma_f32_16x16x32_bf16 a[104:107], a[228:231], a[196:199], a[104:107]
ds_read_b64_tr_b16 a[148:149], v8 offset:45056
v_mfma_f32_16x16x32_bf16 v[36:39], v[20:23], v[20:23], 0
v_mfma_f32_16x16x32_bf16 a[128:131], a[228:231], a[204:207], a[128:131]
ds_read_b64_tr_b16 a[150:151], v8 offset:45312
v_mfma_f32_16x16x32_bf16 a[128:131], a[224:227], a[200:203], a[128:131]
v_mfma_f32_16x16x32_bf16 v[40:43], v[20:23], a[152:155], 0
v_mfma_f32_16x16x32_bf16 v[216:219], a[224:227], a[208:211], v[216:219]
v_mfma_f32_16x16x32_bf16 v[216:219], a[228:231], a[212:215], v[216:219]
v_mfma_f32_16x16x32_bf16 v[36:39], v[24:27], v[24:27], v[36:39]
v_mfma_f32_16x16x32_bf16 v[240:243], a[228:231], a[220:223], v[240:243]
buffer_load_dwordx4 v4, s[60:63], s68 offen nt lds
v_mfma_f32_16x16x32_bf16 v[240:243], a[224:227], a[216:219], v[240:243]
s_waitcnt lgkmcnt(4)
s_sub_u32 s68, s68, 0x20000
s_add_u32 s68, s68, s72
v_mfma_f32_16x16x32_bf16 v[40:43], v[24:27], a[152:155], v[40:43]
v_mfma_f32_16x16x32_bf16 v[244:247], a[232:235], a[216:219], v[244:247]
s_waitcnt lgkmcnt(2)
s_mov_b32 s60, s74
ds_read_b64_tr_b16 a[224:225], v12 offset:16384
v_mfma_f32_16x16x32_bf16 v[244:247], a[236:239], a[220:223], v[244:247]
s_mov_b32 s61, s75
s_add_u32 s62, s73, 917504
ds_read_b64_tr_b16 a[226:227], v12 offset:16640
v_mfma_f32_16x16x32_bf16 v[36:39], v[28:31], v[28:31], v[36:39]
v_mfma_f32_16x16x32_bf16 v[220:223], a[236:239], a[212:215], v[220:223]
s_add_u32 m0, s76, 151552
ds_read_b64_tr_b16 a[228:229], v12 offset:20480
v_mfma_f32_16x16x32_bf16 v[220:223], a[232:235], a[208:211], v[220:223]
ds_read_b64_tr_b16 a[230:231], v12 offset:20736
v_mfma_f32_16x16x32_bf16 v[40:43], v[28:31], a[152:155], v[40:43]
v_mfma_f32_16x16x32_bf16 a[132:135], a[232:235], a[200:203], a[132:135]
v_mfma_f32_16x16x32_bf16 a[132:135], a[236:239], a[204:207], a[132:135]
buffer_load_dwordx4 v4, s[60:63], s68 offen nt lds
v_mfma_f32_16x16x32_bf16 a[108:111], a[236:239], a[196:199], a[108:111]
s_add_u32 s68, s68, 0x20000
v_mfma_f32_16x16x32_bf16 v[36:39], v[32:35], v[32:35], v[36:39]
v_mfma_f32_16x16x32_bf16 a[108:111], a[232:235], a[192:195], a[108:111]
s_waitcnt lgkmcnt(4)
v_mfma_f32_16x16x32_bf16 v[40:43], v[32:35], a[152:155], v[40:43]
v_mfma_f32_16x16x32_bf16 a[144:147], a[152:155], a[148:151], a[144:147]
v_mfma_f32_16x16x32_bf16 a[84:87], a[232:235], a[248:251], a[84:87]
v_and_b32_e64 v77, 31, v0
v_mfma_f32_16x16x32_bf16 a[84:87], a[236:239], a[252:255], a[84:87]
v_mfma_f32_16x16x32_bf16 a[60:63], a[236:239], a[244:247], a[60:63]
v_lshrrev_b32_e64 v76, 5, v0
v_mfma_f32_16x16x32_bf16 a[60:63], a[232:235], a[240:243], a[60:63]
v_mfma_f32_16x16x32_bf16 a[36:39], a[232:235], v[66:69], a[36:39]
v_lshlrev_b32_e64 v76, 3, v76
v_mfma_f32_16x16x32_bf16 a[36:39], a[236:239], v[70:73], a[36:39]
v_mfma_f32_16x16x32_bf16 a[12:15], a[236:239], v[62:65], a[12:15]
v_lshl_add_u32 v76, v77, 26, v76
v_mfma_f32_16x16x32_bf16 a[12:15], a[232:235], v[58:61], a[12:15]
s_waitcnt lgkmcnt(2)
v_mfma_f32_16x16x32_bf16 a[16:19], v[58:61], a[224:227], a[16:19]
s_waitcnt lgkmcnt(0)
ds_read_b64_tr_b16 a[232:233], v13 offset:16384
s_mov_b32 vcc_lo, 0x00100001
v_mfma_f32_16x16x32_bf16 a[16:19], v[62:65], a[228:231], a[16:19]
ds_read_b64_tr_b16 a[234:235], v13 offset:16640
v_mfma_f32_16x16x32_bf16 a[40:43], v[70:73], a[228:231], a[40:43]
ds_read_b64_tr_b16 a[236:237], v13 offset:20480
s_mov_b32 vcc_hi, 0x10000100
v_mfma_f32_16x16x32_bf16 a[40:43], v[66:69], a[224:227], a[40:43]
ds_read_b64_tr_b16 a[238:239], v13 offset:20736
v_mfma_f32_16x16x32_bf16 a[64:67], a[240:243], a[224:227], a[64:67]
v_mfma_f32_16x16x32_bf16 a[64:67], a[244:247], a[228:231], a[64:67]
v_mfma_f32_16x16x32_bf16 a[88:91], a[252:255], a[228:231], a[88:91]
v_mfma_f32_16x16x32_bf16 a[88:91], a[248:251], a[224:227], a[88:91]
v_mfma_f32_16x16x32_bf16 a[112:115], a[192:195], a[224:227], a[112:115]
v_cndmask_b32 v44, 0, v36, vcc
v_mfma_f32_16x16x32_bf16 a[112:115], a[196:199], a[228:231], a[112:115]
v_mfma_f32_16x16x32_bf16 a[136:139], a[204:207], a[228:231], a[136:139]
s_lshl_b64 vcc, vcc, 1
v_mfma_f32_16x16x32_bf16 a[136:139], a[200:203], a[224:227], a[136:139]
v_mfma_f32_16x16x32_bf16 v[224:227], a[208:211], a[224:227], v[224:227]
v_add_f32_e64 v40, v40, v41
v_mfma_f32_16x16x32_bf16 v[224:227], a[212:215], a[228:231], v[224:227]
v_mfma_f32_16x16x32_bf16 v[248:251], a[220:223], a[228:231], v[248:251]
v_cndmask_b32 v44, v44, v37, vcc
v_mfma_f32_16x16x32_bf16 v[248:251], a[216:219], a[224:227], v[248:251]
s_waitcnt vmcnt(12) lgkmcnt(0)
s_barrier
v_mfma_f32_16x16x32_bf16 v[252:255], a[216:219], a[232:235], v[252:255]
s_sub_u32 s56, s56, 1
ds_read_b64_tr_b16 a[224:225], v12 offset:24576
s_lshl_b64 vcc, vcc, 1
v_mfma_f32_16x16x32_bf16 v[252:255], a[220:223], a[236:239], v[252:255]
s_cmp_eq_u32 s56, 0
s_cselect_b32 s78, -960, 64
ds_read_b64_tr_b16 a[226:227], v12 offset:24832
v_mfma_f32_16x16x32_bf16 v[228:231], a[212:215], a[236:239], v[228:231]
s_add_u32 m0, s76, 32768
s_add_u32 s79, s36, 0
ds_read_b64_tr_b16 a[228:229], v12 offset:28672
v_mfma_f32_16x16x32_bf16 v[228:231], a[208:211], a[232:235], v[228:231]
buffer_load_dwordx4 v1, s[4:7], s79 offen lds
v_mfma_f32_16x16x32_bf16 a[140:143], a[200:203], a[232:235], a[140:143]
s_add_u32 m0, s76, 36864
s_add_u32 s79, s36, 65536
ds_read_b64_tr_b16 a[230:231], v12 offset:28928
v_mfma_f32_16x16x32_bf16 a[140:143], a[204:207], a[236:239], a[140:143]
ds_read_b128 a[160:163], v6 offset:0
v_add_f32 v40, v40, v42
v_mfma_f32_16x16x32_bf16 a[116:119], a[196:199], a[236:239], a[116:119]
v_cndmask_b32 v44, v44, v38, vcc
s_lshl_b64 vcc, vcc, 1
v_mfma_f32_16x16x32_bf16 a[116:119], a[192:195], a[232:235], a[116:119]
v_mfma_f32_16x16x32_bf16 a[92:95], a[248:251], a[232:235], a[92:95]
ds_read_b64_tr_b16 v[54:55], v78 offset:8192
v_mfma_f32_16x16x32_bf16 a[92:95], a[252:255], a[236:239], a[92:95]
ds_read_b64_tr_b16 v[56:57], v78 offset:8704
v_add_f32_e64 v40, v40, v43
v_mfma_f32_16x16x32_bf16 a[68:71], a[244:247], a[236:239], a[68:71]
buffer_load_dwordx4 v1, s[4:7], s79 offen lds
v_mfma_f32_16x16x32_bf16 a[68:71], a[240:243], a[232:235], a[68:71]
s_add_u32 m0, s76, 40960
s_add_u32 s79, s36, 131072
ds_read_b128 a[164:167], v7 offset:0
v_mfma_f32_16x16x32_bf16 a[44:47], v[66:69], a[232:235], a[44:47]
v_cndmask_b32 v44, v44, v39, vcc
v_mfma_f32_16x16x32_bf16 a[44:47], v[70:73], a[236:239], a[44:47]
s_nop 0
v_add_f32_dpp v44, v44, v44 quad_perm:[1,0,3,2] row_mask:0xf bank_mask:0xf
v_mfma_f32_16x16x32_bf16 a[20:23], v[62:65], a[236:239], a[20:23]
v_mfma_f32_16x16x32_bf16 a[20:23], v[58:61], a[232:235], a[20:23]
s_waitcnt lgkmcnt(6)
v_add_f32_dpp v44, v44, v44 quad_perm:[2,3,0,1] row_mask:0xf bank_mask:0xf
v_mfma_f32_16x16x32_bf16 v[80:83], a[224:227], v[58:61], v[80:83]
s_waitcnt lgkmcnt(4)
ds_read_b64_tr_b16 a[232:233], v12 offset:32768
v_mfma_f32_16x16x32_bf16 v[80:83], a[228:231], v[62:65], v[80:83]
buffer_load_dwordx4 v1, s[4:7], s79 offen lds
v_mfma_f32_16x16x32_bf16 v[96:99], a[228:231], v[70:73], v[96:99]
s_add_u32 m0, s76, 45056
s_add_u32 s79, s36, 196608
ds_read_b64_tr_b16 a[234:235], v12 offset:33024
v_mfma_f32_16x16x32_bf16 v[96:99], a[224:227], v[66:69], v[96:99]
ds_read_b64_tr_b16 a[236:237], v12 offset:36864
v_add_f32_dpp v44, v44, v44 row_half_mirror row_mask:0xf bank_mask:0xf
v_mfma_f32_16x16x32_bf16 v[112:115], a[224:227], a[240:243], v[112:115]
ds_read_b64_tr_b16 a[238:239], v12 offset:37120
v_add_f32_dpp v44, v44, v44 row_mirror row_mask:0xf bank_mask:0xf
v_mfma_f32_16x16x32_bf16 v[112:115], a[228:231], a[244:247], v[112:115]
ds_read_b128 a[172:175], v7 offset:2048
v_permlane16_swap_b32 v40, v44
v_mfma_f32_16x16x32_bf16 v[128:131], a[228:231], a[252:255], v[128:131]
v_mfma_f32_16x16x32_bf16 v[128:131], a[224:227], a[248:251], v[128:131]
v_add_f32 v40, v40, v44
v_mfma_f32_16x16x32_bf16 v[144:147], a[224:227], a[192:195], v[144:147]
buffer_load_dwordx4 v1, s[4:7], s79 offen lds
v_mfma_f32_16x16x32_bf16 v[144:147], a[228:231], a[196:199], v[144:147]
s_add_u32 m0, s76, 49152
s_add_u32 s79, s36, 262144
ds_read_b128 a[168:171], v6 offset:2048
v_mfma_f32_16x16x32_bf16 v[160:163], a[228:231], a[204:207], v[160:163]
v_mul_f32 v40, 0x3a800000, v40
v_mfma_f32_16x16x32_bf16 v[160:163], a[224:227], a[200:203], v[160:163]
v_mov_b32_e64 v44, v40
v_mfma_f32_16x16x32_bf16 v[176:179], a[224:227], a[208:211], v[176:179]
v_mfma_f32_16x16x32_bf16 v[176:179], a[228:231], a[212:215], v[176:179]
v_permlane16_swap_b32 v40, v44
v_mfma_f32_16x16x32_bf16 v[192:195], a[228:231], a[220:223], v[192:195]
v_mfma_f32_16x16x32_bf16 v[192:195], a[224:227], a[216:219], v[192:195]
s_waitcnt lgkmcnt(4)
buffer_load_dwordx4 v1, s[4:7], s79 offen lds
v_mfma_f32_16x16x32_bf16 v[196:199], a[232:235], a[216:219], v[196:199]
s_waitcnt lgkmcnt(2)
s_add_u32 m0, s76, 53248
ds_read_b64_tr_b16 a[224:225], v13 offset:24576
v_mfma_f32_16x16x32_bf16 v[196:199], a[236:239], a[220:223], v[196:199]
s_add_u32 s79, s36, 327680
ds_read_b64_tr_b16 a[226:227], v13 offset:24832
v_fma_f32 v44, -v40, v40, v44
v_mfma_f32_16x16x32_bf16 v[180:183], a[236:239], a[212:215], v[180:183]
ds_read_b64_tr_b16 a[228:229], v13 offset:28672
v_cvt_pk_bf16_f32 v74, v40, v40
v_mfma_f32_16x16x32_bf16 v[180:183], a[232:235], a[208:211], v[180:183]
ds_read_b64_tr_b16 a[230:231], v13 offset:28928
v_max_f32 v44, 0, v44
v_mfma_f32_16x16x32_bf16 v[164:167], a[232:235], a[200:203], v[164:167]
ds_read_b128 a[176:179], v6 offset:4096
v_mfma_f32_16x16x32_bf16 v[164:167], a[236:239], a[204:207], v[164:167]
v_xor_b32 v74, 0x80008000, v74
v_mfma_f32_16x16x32_bf16 v[148:151], a[236:239], a[196:199], v[148:151]
buffer_load_dwordx4 v1, s[4:7], s79 offen lds
v_mfma_f32_16x16x32_bf16 v[148:151], a[232:235], a[192:195], v[148:151]
s_add_u32 m0, s76, 57344
s_add_u32 s79, s36, 393216
ds_read_b128 a[180:183], v7 offset:4096
v_mfma_f32_16x16x32_bf16 v[132:135], a[232:235], a[248:251], v[132:135]
buffer_store_dwordx4 v[54:57], v79, s[64:67], s69 offen sc1
v_mfma_f32_16x16x32_bf16 v[132:135], a[236:239], a[252:255], v[132:135]
v_cvt_pk_bf16_f32 v44, v44, v44
s_add_u32 s69, s69, 0x100000
v_mfma_f32_16x16x32_bf16 v[116:119], a[236:239], a[244:247], v[116:119]
v_and_b32_e64 v44, s54, v44
v_mfma_f32_16x16x32_bf16 v[116:119], a[232:235], a[240:243], v[116:119]
v_add_f32 v44, 0x3727c5ac, v44
v_mfma_f32_16x16x32_bf16 v[100:103], a[232:235], v[66:69], v[100:103]
v_mfma_f32_16x16x32_bf16 v[100:103], a[236:239], v[70:73], v[100:103]
buffer_load_dwordx4 v1, s[4:7], s79 offen lds
v_mfma_f32_16x16x32_bf16 v[84:87], a[236:239], v[62:65], v[84:87]
s_add_u32 m0, s76, 61440
s_add_u32 s79, s36, 458752
ds_read_b128 a[188:191], v7 offset:6144
v_mfma_f32_16x16x32_bf16 v[84:87], a[232:235], v[58:61], v[84:87]
s_waitcnt lgkmcnt(5)
v_cvt_pk_bf16_f32 v44, v44, v44
v_mfma_f32_16x16x32_bf16 v[88:91], a[224:227], v[58:61], v[88:91]
s_waitcnt lgkmcnt(3)
ds_read_b64_tr_b16 a[232:233], v13 offset:32768
v_and_b32_e64 v44, s54, v44
v_mfma_f32_16x16x32_bf16 v[88:91], a[228:231], v[62:65], v[88:91]
ds_read_b64_tr_b16 a[234:235], v13 offset:33024
v_mfma_f32_16x16x32_bf16 v[104:107], a[228:231], v[70:73], v[104:107]
ds_read_b64_tr_b16 a[236:237], v13 offset:36864
v_mfma_f32_16x16x32_bf16 v[104:107], a[224:227], v[66:69], v[104:107]
ds_read_b64_tr_b16 a[238:239], v13 offset:37120
v_mfma_f32_16x16x32_bf16 v[120:123], a[224:227], a[240:243], v[120:123]
buffer_load_dwordx4 v1, s[4:7], s79 offen lds
v_mfma_f32_16x16x32_bf16 v[120:123], a[228:231], a[244:247], v[120:123]
s_lshl1_add_u32 s36, s78, s36
s_add_u32 m0, s76, 106496
ds_read_b128 a[184:187], v6 offset:6144
v_mfma_f32_16x16x32_bf16 v[136:139], a[228:231], a[252:255], v[136:139]
v_sqrt_f32 v44, v44
v_mfma_f32_16x16x32_bf16 v[136:139], a[224:227], a[248:251], v[136:139]
v_cvt_pk_bf16_f32 v44, v44, v44
v_mfma_f32_16x16x32_bf16 v[152:155], a[224:227], a[192:195], v[152:155]
v_and_b32_e64 v75, s54, v44
v_mfma_f32_16x16x32_bf16 v[152:155], a[228:231], a[196:199], v[152:155]
buffer_store_dwordx2 v[74:75], v76, s[24:27], s41 offen sc1
v_mfma_f32_16x16x32_bf16 v[168:171], a[228:231], a[204:207], v[168:171]
v_mov_b32 v16, 162368
v_mfma_f32_16x16x32_bf16 v[168:171], a[224:227], a[200:203], v[168:171]
buffer_load_dwordx4 v3, s[16:19], s39 offen lds
v_mfma_f32_16x16x32_bf16 v[184:187], a[224:227], a[208:211], v[184:187]
s_add_u32 m0, s76, 112640
v_mfma_f32_16x16x32_bf16 v[184:187], a[228:231], a[212:215], v[184:187]
v_min_u32_e64 v17, 7, v0
v_mfma_f32_16x16x32_bf16 v[200:203], a[228:231], a[220:223], v[200:203]
v_mfma_f32_16x16x32_bf16 v[200:203], a[224:227], a[216:219], v[200:203]
s_waitcnt vmcnt(13) lgkmcnt(1)
s_barrier
v_mfma_f32_16x16x32_bf16 v[204:207], a[232:235], a[216:219], v[204:207]
ds_read_b64_tr_b16 a[224:225], v10 offset:0
v_lshl_add_u32 v17, v17, 2, v16
v_mfma_f32_16x16x32_bf16 v[204:207], a[236:239], a[220:223], v[204:207]
ds_read_b64_tr_b16 a[226:227], v10 offset:256
v_mfma_f32_16x16x32_bf16 v[188:191], a[236:239], a[212:215], v[188:191]
buffer_load_dwordx4 v3, s[16:19], s39 offen offset:2048 lds
v_mfma_f32_16x16x32_bf16 v[188:191], a[232:235], a[208:211], v[188:191]
s_add_u32 m0, s76, 122880
s_add_u32 s79, s39, 4096
ds_read_b64_tr_b16 a[228:229], v10 offset:4096
v_mfma_f32_16x16x32_bf16 v[172:175], a[232:235], a[200:203], v[172:175]
ds_read_b64_tr_b16 a[230:231], v10 offset:4352
v_mfma_f32_16x16x32_bf16 v[172:175], a[236:239], a[204:207], v[172:175]
v_mfma_f32_16x16x32_bf16 v[156:159], a[236:239], a[196:199], v[156:159]
v_mfma_f32_16x16x32_bf16 v[156:159], a[232:235], a[192:195], v[156:159]
ds_read_b128 a[192:195], v6 offset:8192
v_mfma_f32_16x16x32_bf16 v[140:143], a[232:235], a[248:251], v[140:143]
ds_read_b128 a[196:199], v7 offset:8192
v_mfma_f32_16x16x32_bf16 v[140:143], a[236:239], a[252:255], v[140:143]
buffer_load_dwordx4 v3, s[16:19], s79 offen lds
v_mfma_f32_16x16x32_bf16 v[124:127], a[236:239], a[244:247], v[124:127]
s_add_u32 m0, s76, 110592
s_add_u32 s79, s39, 196608
ds_read_b128 a[204:207], v7 offset:10240
v_mfma_f32_16x16x32_bf16 v[124:127], a[232:235], a[240:243], v[124:127]
ds_read_b128 a[200:203], v6 offset:10240
v_mfma_f32_16x16x32_bf16 v[108:111], a[232:235], v[66:69], v[108:111]
ds_read_b128 a[208:211], v6 offset:12288
v_mfma_f32_16x16x32_bf16 v[108:111], a[236:239], v[70:73], v[108:111]
ds_read_b128 a[212:215], v7 offset:12288
v_mfma_f32_16x16x32_bf16 v[92:95], a[236:239], v[62:65], v[92:95]
v_mfma_f32_16x16x32_bf16 v[92:95], a[232:235], v[58:61], v[92:95]
s_waitcnt lgkmcnt(8)
L_g1_loop_1012:
v_mfma_f32_16x16x32_bf16 a[0:3], a[224:227], a[160:163], a[0:3]
s_waitcnt lgkmcnt(6)
buffer_load_dwordx4 v3, s[16:19], s79 offen lds
v_mfma_f32_16x16x32_bf16 a[0:3], a[228:231], a[164:167], a[0:3]
s_add_u32 m0, s76, 116736
ds_read_b128 a[220:223], v7 offset:14336
v_mfma_f32_16x16x32_bf16 a[24:27], a[228:231], a[172:175], a[24:27]
ds_read_b128 a[216:219], v6 offset:14336
v_mfma_f32_16x16x32_bf16 a[24:27], a[224:227], a[168:171], a[24:27]
ds_read_b64_tr_b16 a[232:233], v11 offset:0
v_mfma_f32_16x16x32_bf16 a[48:51], a[224:227], a[176:179], a[48:51]
ds_read_b64_tr_b16 a[234:235], v11 offset:256
v_mfma_f32_16x16x32_bf16 a[48:51], a[228:231], a[180:183], a[48:51]
ds_read_b64_tr_b16 a[236:237], v11 offset:4096
v_mfma_f32_16x16x32_bf16 a[72:75], a[228:231], a[188:191], a[72:75]
ds_read_b64_tr_b16 a[238:239], v11 offset:4352
v_mfma_f32_16x16x32_bf16 a[72:75], a[224:227], a[184:187], a[72:75]
s_waitcnt lgkmcnt(11)
buffer_load_dwordx4 v3, s[16:19], s79 offen offset:2048 lds
v_mfma_f32_16x16x32_bf16 a[96:99], a[224:227], a[192:195], a[96:99]
s_waitcnt lgkmcnt(10)
s_add_u32 m0, s76, 126976
s_add_u32 s79, s39, 200704
v_mfma_f32_16x16x32_bf16 a[96:99], a[228:231], a[196:199], a[96:99]
s_waitcnt lgkmcnt(9)
v_mfma_f32_16x16x32_bf16 a[120:123], a[228:231], a[204:207], a[120:123]
s_waitcnt lgkmcnt(8)
v_mfma_f32_16x16x32_bf16 a[120:123], a[224:227], a[200:203], a[120:123]
s_waitcnt lgkmcnt(7)
v_mfma_f32_16x16x32_bf16 v[208:211], a[224:227], a[208:211], v[208:211]
s_waitcnt lgkmcnt(6)
v_mfma_f32_16x16x32_bf16 v[208:211], a[228:231], a[212:215], v[208:211]
s_waitcnt lgkmcnt(5)
v_mfma_f32_16x16x32_bf16 v[232:235], a[228:231], a[220:223], v[232:235]
s_waitcnt lgkmcnt(4)
buffer_load_dwordx4 v3, s[16:19], s79 offen lds
v_mfma_f32_16x16x32_bf16 v[232:235], a[224:227], a[216:219], v[232:235]
s_waitcnt lgkmcnt(2)
s_mul_i32 s55, s78, 6144
s_add_u32 s39, s39, s55
v_mfma_f32_16x16x32_bf16 v[236:239], a[232:235], a[216:219], v[236:239]
s_waitcnt lgkmcnt(0)
s_add_u32 m0, s76, 131072
ds_read_b64_tr_b16 a[224:225], v10 offset:8192
v_mfma_f32_16x16x32_bf16 v[236:239], a[236:239], a[220:223], v[236:239]
ds_read_b64_tr_b16 a[226:227], v10 offset:8448
v_mfma_f32_16x16x32_bf16 v[212:215], a[236:239], a[212:215], v[212:215]
ds_read_b64_tr_b16 a[228:229], v10 offset:12288
v_mfma_f32_16x16x32_bf16 v[212:215], a[232:235], a[208:211], v[212:215]
ds_read_b64_tr_b16 a[230:231], v10 offset:12544
v_mfma_f32_16x16x32_bf16 a[124:127], a[232:235], a[200:203], a[124:127]
v_mfma_f32_16x16x32_bf16 a[124:127], a[236:239], a[204:207], a[124:127]
buffer_load_dwordx4 v2, s[8:11], s38 offen lds
v_mfma_f32_16x16x32_bf16 a[100:103], a[236:239], a[196:199], a[100:103]
s_add_u32 m0, s76, 139264
ds_read_b64_tr_b16 a[148:149], v8 offset:0
v_mfma_f32_16x16x32_bf16 a[100:103], a[232:235], a[192:195], a[100:103]
ds_read_b64_tr_b16 a[150:151], v8 offset:256
v_mfma_f32_16x16x32_bf16 a[76:79], a[232:235], a[184:187], a[76:79]
v_mfma_f32_16x16x32_bf16 a[76:79], a[236:239], a[188:191], a[76:79]
v_mfma_f32_16x16x32_bf16 a[52:55], a[236:239], a[180:183], a[52:55]
v_mfma_f32_16x16x32_bf16 a[52:55], a[232:235], a[176:179], a[52:55]
v_mfma_f32_16x16x32_bf16 a[28:31], a[232:235], a[168:171], a[28:31]
buffer_load_dwordx4 v2, s[12:15], s38 offen lds
v_mfma_f32_16x16x32_bf16 a[28:31], a[236:239], a[172:175], a[28:31]
s_add_u32 m0, s76, 135168
s_add_u32 s79, s38, 229376
v_mfma_f32_16x16x32_bf16 a[4:7], a[236:239], a[164:167], a[4:7]
v_mfma_f32_16x16x32_bf16 a[4:7], a[232:235], a[160:163], a[4:7]
s_waitcnt lgkmcnt(4)
v_mfma_f32_16x16x32_bf16 a[8:11], a[224:227], a[160:163], a[8:11]
s_waitcnt lgkmcnt(2)
ds_read_b64_tr_b16 a[232:233], v11 offset:8192
v_mfma_f32_16x16x32_bf16 a[8:11], a[228:231], a[164:167], a[8:11]
ds_read_b64_tr_b16 a[234:235], v11 offset:8448
v_mfma_f32_16x16x32_bf16 a[32:35], a[228:231], a[172:175], a[32:35]
ds_read_b64_tr_b16 a[236:237], v11 offset:12288
v_mfma_f32_16x16x32_bf16 a[32:35], a[224:227], a[168:171], a[32:35]
buffer_load_dwordx4 v2, s[8:11], s79 offen lds
v_mfma_f32_16x16x32_bf16 a[56:59], a[224:227], a[176:179], a[56:59]
s_add_u32 m0, s76, 143360
ds_read_b64_tr_b16 a[238:239], v11 offset:12544
v_mfma_f32_16x16x32_bf16 a[56:59], a[228:231], a[180:183], a[56:59]
v_mfma_f32_16x16x32_bf16 a[80:83], a[228:231], a[188:191], a[80:83]
v_mfma_f32_16x16x32_bf16 a[80:83], a[224:227], a[184:187], a[80:83]
s_waitcnt lgkmcnt(4)
v_mfma_f32_16x16x32_bf16 a[144:147], a[152:155], a[148:151], a[144:147]
v_mfma_f32_16x16x32_bf16 a[104:107], a[224:227], a[192:195], a[104:107]
v_mfma_f32_16x16x32_bf16 a[104:107], a[228:231], a[196:199], a[104:107]
buffer_load_dwordx4 v2, s[12:15], s79 offen lds
v_mfma_f32_16x16x32_bf16 a[128:131], a[228:231], a[204:207], a[128:131]
s_mul_i32 s55, s78, 7168
s_add_u32 s38, s38, s55
ds_read_b64_tr_b16 a[148:149], v8 offset:4096
v_mfma_f32_16x16x32_bf16 a[128:131], a[224:227], a[200:203], a[128:131]
s_cmp_ge_u32 s47, 7340032
s_cselect_b32 s78, 7340032, 0
ds_read_b64_tr_b16 a[150:151], v8 offset:4352
v_mfma_f32_16x16x32_bf16 v[216:219], a[224:227], a[208:211], v[216:219]
s_sub_u32 s47, s47, s78
s_cmp_lt_u32 s46, 2
s_cselect_b32 s34, 0, s34
v_mfma_f32_16x16x32_bf16 v[216:219], a[228:231], a[212:215], v[216:219]
v_mfma_f32_16x16x32_bf16 v[240:243], a[228:231], a[220:223], v[240:243]
v_mfma_f32_16x16x32_bf16 v[240:243], a[224:227], a[216:219], v[240:243]
s_waitcnt lgkmcnt(4)
v_mfma_f32_16x16x32_bf16 v[244:247], a[232:235], a[216:219], v[244:247]
s_waitcnt lgkmcnt(2)
buffer_load_dword v19, v18, s[32:35], s47 offen
v_mfma_f32_16x16x32_bf16 v[244:247], a[236:239], a[220:223], v[244:247]
s_add_u32 s47, s47, 917504
ds_read_b64_tr_b16 a[224:225], v10 offset:16384
v_mfma_f32_16x16x32_bf16 v[220:223], a[236:239], a[212:215], v[220:223]
ds_read_b64_tr_b16 a[226:227], v10 offset:16640
v_mfma_f32_16x16x32_bf16 v[220:223], a[232:235], a[208:211], v[220:223]
ds_read_b64_tr_b16 a[228:229], v10 offset:20480
v_mfma_f32_16x16x32_bf16 a[132:135], a[232:235], a[200:203], a[132:135]
ds_read_b64_tr_b16 a[230:231], v10 offset:20736
v_mfma_f32_16x16x32_bf16 a[132:135], a[236:239], a[204:207], a[132:135]
v_mfma_f32_16x16x32_bf16 a[108:111], a[236:239], a[196:199], a[108:111]
v_mfma_f32_16x16x32_bf16 a[108:111], a[232:235], a[192:195], a[108:111]
s_waitcnt lgkmcnt(4)
v_mfma_f32_16x16x32_bf16 a[144:147], a[152:155], a[148:151], a[144:147]
v_mfma_f32_16x16x32_bf16 a[84:87], a[232:235], a[184:187], a[84:87]
v_mfma_f32_16x16x32_bf16 a[84:87], a[236:239], a[188:191], a[84:87]
v_mfma_f32_16x16x32_bf16 a[60:63], a[236:239], a[180:183], a[60:63]
v_mfma_f32_16x16x32_bf16 a[60:63], a[232:235], a[176:179], a[60:63]
v_mfma_f32_16x16x32_bf16 a[36:39], a[232:235], a[168:171], a[36:39]
v_mfma_f32_16x16x32_bf16 a[36:39], a[236:239], a[172:175], a[36:39]
v_mfma_f32_16x16x32_bf16 a[12:15], a[236:239], a[164:167], a[12:15]
v_mfma_f32_16x16x32_bf16 a[12:15], a[232:235], a[160:163], a[12:15]
s_waitcnt lgkmcnt(2)
v_mfma_f32_16x16x32_bf16 a[16:19], a[160:163], a[224:227], a[16:19]
s_waitcnt lgkmcnt(0)
ds_read_b64_tr_b16 a[232:233], v11 offset:16384
v_mfma_f32_16x16x32_bf16 a[16:19], a[164:167], a[228:231], a[16:19]
ds_read_b64_tr_b16 a[234:235], v11 offset:16640
v_mfma_f32_16x16x32_bf16 a[40:43], a[172:175], a[228:231], a[40:43]
ds_read_b64_tr_b16 a[236:237], v11 offset:20480
v_mfma_f32_16x16x32_bf16 a[40:43], a[168:171], a[224:227], a[40:43]
ds_read_b64_tr_b16 a[238:239], v11 offset:20736
v_mfma_f32_16x16x32_bf16 a[64:67], a[176:179], a[224:227], a[64:67]
v_mfma_f32_16x16x32_bf16 a[64:67], a[180:183], a[228:231], a[64:67]
v_mfma_f32_16x16x32_bf16 a[88:91], a[188:191], a[228:231], a[88:91]
v_mfma_f32_16x16x32_bf16 a[88:91], a[184:187], a[224:227], a[88:91]
v_mfma_f32_16x16x32_bf16 a[112:115], a[192:195], a[224:227], a[112:115]
v_mfma_f32_16x16x32_bf16 a[112:115], a[196:199], a[228:231], a[112:115]
v_mfma_f32_16x16x32_bf16 a[136:139], a[204:207], a[228:231], a[136:139]
v_mfma_f32_16x16x32_bf16 a[136:139], a[200:203], a[224:227], a[136:139]
v_mfma_f32_16x16x32_bf16 v[224:227], a[208:211], a[224:227], v[224:227]
v_mfma_f32_16x16x32_bf16 v[224:227], a[212:215], a[228:231], v[224:227]
v_mfma_f32_16x16x32_bf16 v[248:251], a[220:223], a[228:231], v[248:251]
v_mfma_f32_16x16x32_bf16 v[248:251], a[216:219], a[224:227], v[248:251]
s_waitcnt vmcnt(11) lgkmcnt(0)
s_barrier
v_mfma_f32_16x16x32_bf16 v[252:255], a[216:219], a[232:235], v[252:255]
s_add_u32 m0, s76, 0
s_add_u32 s79, s36, 0
ds_read_b64_tr_b16 a[224:225], v10 offset:24576
v_mfma_f32_16x16x32_bf16 v[252:255], a[220:223], a[236:239], v[252:255]
buffer_load_dwordx4 v1, s[4:7], s79 offen lds
v_mfma_f32_16x16x32_bf16 v[228:231], a[212:215], a[236:239], v[228:231]
s_add_u32 m0, s76, 4096
s_add_u32 s79, s36, 65536
ds_read_b64_tr_b16 a[226:227], v10 offset:24832
v_mfma_f32_16x16x32_bf16 v[228:231], a[208:211], a[232:235], v[228:231]
ds_read_b64_tr_b16 a[228:229], v10 offset:28672
v_mfma_f32_16x16x32_bf16 a[140:143], a[200:203], a[232:235], a[140:143]
ds_read_b64_tr_b16 a[230:231], v10 offset:28928
v_mfma_f32_16x16x32_bf16 a[140:143], a[204:207], a[236:239], a[140:143]
ds_read_b128 v[58:61], v6 offset:32768
v_mfma_f32_16x16x32_bf16 a[116:119], a[196:199], a[236:239], a[116:119]
v_mfma_f32_16x16x32_bf16 a[116:119], a[192:195], a[232:235], a[116:119]
v_mfma_f32_16x16x32_bf16 a[92:95], a[184:187], a[232:235], a[92:95]
buffer_load_dwordx4 v1, s[4:7], s79 offen lds
v_mfma_f32_16x16x32_bf16 a[92:95], a[188:191], a[236:239], a[92:95]
s_sub_u32 s46, s46, 1
ds_read_b64_tr_b16 v[46:47], v78 offset:0
v_mfma_f32_16x16x32_bf16 a[68:71], a[180:183], a[236:239], a[68:71]
s_cmp_eq_u32 s46, s77
s_cbranch_scc1 L_g1_sig_1013
L_g1_sgr_1014:
ds_read_b64_tr_b16 v[48:49], v78 offset:512
v_mfma_f32_16x16x32_bf16 a[68:71], a[176:179], a[232:235], a[68:71]
s_add_u32 m0, s76, 8192
s_add_u32 s79, s36, 131072
ds_read_b128 v[62:65], v7 offset:32768
v_mfma_f32_16x16x32_bf16 a[44:47], a[168:171], a[232:235], a[44:47]
v_mfma_f32_16x16x32_bf16 a[44:47], a[172:175], a[236:239], a[44:47]
v_mfma_f32_16x16x32_bf16 a[20:23], a[164:167], a[236:239], a[20:23]
v_mfma_f32_16x16x32_bf16 a[20:23], a[160:163], a[232:235], a[20:23]
s_waitcnt lgkmcnt(6)
buffer_load_dwordx4 v1, s[4:7], s79 offen lds
v_mfma_f32_16x16x32_bf16 v[80:83], a[224:227], a[160:163], v[80:83]
s_waitcnt lgkmcnt(4)
s_add_u32 m0, s76, 12288
ds_read_b64_tr_b16 a[232:233], v10 offset:32768
v_mfma_f32_16x16x32_bf16 v[80:83], a[228:231], a[164:167], v[80:83]
s_add_u32 s79, s36, 196608
ds_read_b64_tr_b16 a[234:235], v10 offset:33024
v_mfma_f32_16x16x32_bf16 v[96:99], a[228:231], a[172:175], v[96:99]
ds_read_b64_tr_b16 a[236:237], v10 offset:36864
v_mfma_f32_16x16x32_bf16 v[96:99], a[224:227], a[168:171], v[96:99]
ds_read_b64_tr_b16 a[238:239], v10 offset:37120
v_mfma_f32_16x16x32_bf16 v[112:115], a[224:227], a[176:179], v[112:115]
ds_read_b128 v[70:73], v7 offset:34816
v_mfma_f32_16x16x32_bf16 v[112:115], a[228:231], a[180:183], v[112:115]
v_mfma_f32_16x16x32_bf16 v[128:131], a[228:231], a[188:191], v[128:131]
buffer_load_dwordx4 v1, s[4:7], s79 offen lds
v_mfma_f32_16x16x32_bf16 v[128:131], a[224:227], a[184:187], v[128:131]
s_add_u32 m0, s76, 16384
s_add_u32 s79, s36, 262144
v_mfma_f32_16x16x32_bf16 v[144:147], a[224:227], a[192:195], v[144:147]
ds_read_b64_tr_b16 v[50:51], v78 offset:4096
v_mfma_f32_16x16x32_bf16 v[144:147], a[228:231], a[196:199], v[144:147]
ds_read_b64_tr_b16 v[52:53], v78 offset:4608
v_mfma_f32_16x16x32_bf16 v[160:163], a[228:231], a[204:207], v[160:163]
ds_read_b128 v[66:69], v6 offset:34816
v_mfma_f32_16x16x32_bf16 v[160:163], a[224:227], a[200:203], v[160:163]
v_mfma_f32_16x16x32_bf16 v[176:179], a[224:227], a[208:211], v[176:179]
v_mfma_f32_16x16x32_bf16 v[176:179], a[228:231], a[212:215], v[176:179]
buffer_load_dwordx4 v1, s[4:7], s79 offen lds
v_mfma_f32_16x16x32_bf16 v[192:195], a[228:231], a[220:223], v[192:195]
s_add_u32 m0, s76, 20480
s_add_u32 s79, s36, 327680
v_mfma_f32_16x16x32_bf16 v[192:195], a[224:227], a[216:219], v[192:195]
s_waitcnt lgkmcnt(6)
v_mfma_f32_16x16x32_bf16 v[196:199], a[232:235], a[216:219], v[196:199]
s_waitcnt lgkmcnt(4)
ds_read_b64_tr_b16 a[224:225], v11 offset:24576
v_mfma_f32_16x16x32_bf16 v[196:199], a[236:239], a[220:223], v[196:199]
ds_read_b64_tr_b16 a[226:227], v11 offset:24832
v_mfma_f32_16x16x32_bf16 v[180:183], a[236:239], a[212:215], v[180:183]
ds_read_b64_tr_b16 a[228:229], v11 offset:28672
v_mfma_f32_16x16x32_bf16 v[180:183], a[232:235], a[208:211], v[180:183]
ds_read_b64_tr_b16 a[230:231], v11 offset:28928
v_mfma_f32_16x16x32_bf16 v[164:167], a[232:235], a[200:203], v[164:167]
buffer_load_dwordx4 v1, s[4:7], s79 offen lds
v_mfma_f32_16x16x32_bf16 v[164:167], a[236:239], a[204:207], v[164:167]
s_add_u32 m0, s76, 24576
s_add_u32 s79, s36, 393216
ds_read_b128 a[240:243], v6 offset:36864
v_mfma_f32_16x16x32_bf16 v[148:151], a[236:239], a[196:199], v[148:151]
v_mfma_f32_16x16x32_bf16 v[148:151], a[232:235], a[192:195], v[148:151]
ds_read_b128 a[244:247], v7 offset:36864
v_mfma_f32_16x16x32_bf16 v[132:135], a[232:235], a[184:187], v[132:135]
v_mfma_f32_16x16x32_bf16 v[132:135], a[236:239], a[188:191], v[132:135]
v_mfma_f32_16x16x32_bf16 v[116:119], a[236:239], a[180:183], v[116:119]
v_mfma_f32_16x16x32_bf16 v[116:119], a[232:235], a[176:179], v[116:119]
buffer_load_dwordx4 v1, s[4:7], s79 offen lds
v_mfma_f32_16x16x32_bf16 v[100:103], a[232:235], a[168:171], v[100:103]
s_add_u32 m0, s76, 28672
s_add_u32 s79, s36, 458752
v_mfma_f32_16x16x32_bf16 v[100:103], a[236:239], a[172:175], v[100:103]
v_mfma_f32_16x16x32_bf16 v[84:87], a[236:239], a[164:167], v[84:87]
ds_read_b128 a[252:255], v7 offset:38912
v_mfma_f32_16x16x32_bf16 v[84:87], a[232:235], a[160:163], v[84:87]
s_waitcnt lgkmcnt(5)
v_mfma_f32_16x16x32_bf16 v[88:91], a[224:227], a[160:163], v[88:91]
s_waitcnt lgkmcnt(3)
ds_read_b64_tr_b16 a[232:233], v11 offset:32768
v_mfma_f32_16x16x32_bf16 v[88:91], a[228:231], a[164:167], v[88:91]
ds_read_b64_tr_b16 a[234:235], v11 offset:33024
v_mfma_f32_16x16x32_bf16 v[104:107], a[228:231], a[172:175], v[104:107]
buffer_load_dwordx4 v1, s[4:7], s79 offen lds
v_mfma_f32_16x16x32_bf16 v[104:107], a[224:227], a[168:171], v[104:107]
s_add_u32 s36, s36, 128
s_add_u32 m0, s76, 65536
ds_read_b64_tr_b16 a[236:237], v11 offset:36864
v_mfma_f32_16x16x32_bf16 v[120:123], a[224:227], a[176:179], v[120:123]
ds_read_b64_tr_b16 a[238:239], v11 offset:37120
v_mfma_f32_16x16x32_bf16 v[120:123], a[228:231], a[180:183], v[120:123]
ds_read_b128 a[248:251], v6 offset:38912
v_mfma_f32_16x16x32_bf16 v[136:139], a[228:231], a[188:191], v[136:139]
v_mfma_f32_16x16x32_bf16 v[136:139], a[224:227], a[184:187], v[136:139]
v_mfma_f32_16x16x32_bf16 v[152:155], a[224:227], a[192:195], v[152:155]
v_mfma_f32_16x16x32_bf16 v[152:155], a[228:231], a[196:199], v[152:155]
buffer_load_dwordx4 v3, s[16:19], s39 offen lds
v_mfma_f32_16x16x32_bf16 v[168:171], a[228:231], a[204:207], v[168:171]
s_add_u32 m0, s76, 71680
v_mfma_f32_16x16x32_bf16 v[168:171], a[224:227], a[200:203], v[168:171]
v_mfma_f32_16x16x32_bf16 v[184:187], a[224:227], a[208:211], v[184:187]
v_mfma_f32_16x16x32_bf16 v[184:187], a[228:231], a[212:215], v[184:187]
v_mfma_f32_16x16x32_bf16 v[200:203], a[228:231], a[220:223], v[200:203]
v_mfma_f32_16x16x32_bf16 v[200:203], a[224:227], a[216:219], v[200:203]
s_waitcnt vmcnt(10) lgkmcnt(1)
s_barrier
v_mfma_f32_16x16x32_bf16 v[204:207], a[232:235], a[216:219], v[204:207]
buffer_load_dwordx4 v3, s[16:19], s39 offen offset:2048 lds
v_mfma_f32_16x16x32_bf16 v[204:207], a[236:239], a[220:223], v[204:207]
s_add_u32 m0, s76, 81920
s_add_u32 s79, s39, 4096
ds_read_b64_tr_b16 a[224:225], v12 offset:0
v_mfma_f32_16x16x32_bf16 v[188:191], a[236:239], a[212:215], v[188:191]
ds_read_b64_tr_b16 a[226:227], v12 offset:256
v_mfma_f32_16x16x32_bf16 v[188:191], a[232:235], a[208:211], v[188:191]
ds_read_b64_tr_b16 a[228:229], v12 offset:4096
v_mfma_f32_16x16x32_bf16 v[172:175], a[232:235], a[200:203], v[172:175]
ds_read_b64_tr_b16 a[230:231], v12 offset:4352
v_mfma_f32_16x16x32_bf16 v[172:175], a[236:239], a[204:207], v[172:175]
v_mfma_f32_16x16x32_bf16 v[156:159], a[236:239], a[196:199], v[156:159]
v_mfma_f32_16x16x32_bf16 v[156:159], a[232:235], a[192:195], v[156:159]
buffer_load_dwordx4 v3, s[16:19], s79 offen lds
v_mfma_f32_16x16x32_bf16 v[140:143], a[232:235], a[184:187], v[140:143]
s_add_u32 m0, s76, 69632
s_add_u32 s79, s39, 196608
ds_read_b128 a[192:195], v6 offset:40960
v_mfma_f32_16x16x32_bf16 v[140:143], a[236:239], a[188:191], v[140:143]
ds_read_b128 a[196:199], v7 offset:40960
v_mfma_f32_16x16x32_bf16 v[124:127], a[236:239], a[180:183], v[124:127]
ds_read_b128 a[204:207], v7 offset:43008
v_mfma_f32_16x16x32_bf16 v[124:127], a[232:235], a[176:179], v[124:127]
ds_read_b128 a[200:203], v6 offset:43008
v_mfma_f32_16x16x32_bf16 v[108:111], a[232:235], a[168:171], v[108:111]
ds_read_b128 a[208:211], v6 offset:45056
v_mfma_f32_16x16x32_bf16 v[108:111], a[236:239], a[172:175], v[108:111]
ds_read_b128 a[212:215], v7 offset:45056
v_mfma_f32_16x16x32_bf16 v[92:95], a[236:239], a[164:167], v[92:95]
buffer_load_dwordx4 v3, s[16:19], s79 offen lds
v_mfma_f32_16x16x32_bf16 v[92:95], a[232:235], a[160:163], v[92:95]
s_waitcnt lgkmcnt(8)
s_add_u32 m0, s76, 75776
v_mfma_f32_16x16x32_bf16 a[0:3], a[224:227], v[58:61], a[0:3]
s_waitcnt lgkmcnt(6)
ds_read_b128 a[220:223], v7 offset:47104
v_mfma_f32_16x16x32_bf16 a[0:3], a[228:231], v[62:65], a[0:3]
ds_read_b128 a[216:219], v6 offset:47104
v_mfma_f32_16x16x32_bf16 a[24:27], a[228:231], v[70:73], a[24:27]
ds_read_b64_tr_b16 a[232:233], v13 offset:0
v_mfma_f32_16x16x32_bf16 a[24:27], a[224:227], v[66:69], a[24:27]
ds_read_b64_tr_b16 a[234:235], v13 offset:256
v_mfma_f32_16x16x32_bf16 a[48:51], a[224:227], a[240:243], a[48:51]
ds_read_b64_tr_b16 a[236:237], v13 offset:4096
v_mfma_f32_16x16x32_bf16 a[48:51], a[228:231], a[244:247], a[48:51]
buffer_load_dwordx4 v3, s[16:19], s79 offen offset:2048 lds
v_mfma_f32_16x16x32_bf16 a[72:75], a[228:231], a[252:255], a[72:75]
s_add_u32 m0, s76, 86016
s_add_u32 s79, s39, 200704
ds_read_b64_tr_b16 a[238:239], v13 offset:4352
v_mfma_f32_16x16x32_bf16 a[72:75], a[224:227], a[248:251], a[72:75]
s_waitcnt lgkmcnt(11)
v_mfma_f32_16x16x32_bf16 a[96:99], a[224:227], a[192:195], a[96:99]
s_waitcnt lgkmcnt(10)
v_mfma_f32_16x16x32_bf16 a[96:99], a[228:231], a[196:199], a[96:99]
s_waitcnt lgkmcnt(9)
v_mfma_f32_16x16x32_bf16 a[120:123], a[228:231], a[204:207], a[120:123]
s_waitcnt lgkmcnt(8)
v_mfma_f32_16x16x32_bf16 a[120:123], a[224:227], a[200:203], a[120:123]
s_waitcnt lgkmcnt(7)
v_mfma_f32_16x16x32_bf16 v[208:211], a[224:227], a[208:211], v[208:211]
s_waitcnt lgkmcnt(6)
buffer_load_dwordx4 v3, s[16:19], s79 offen lds
v_mfma_f32_16x16x32_bf16 v[208:211], a[228:231], a[212:215], v[208:211]
s_waitcnt lgkmcnt(5)
s_add_u32 s39, s39, 393216
s_add_u32 m0, s76, 90112
v_mfma_f32_16x16x32_bf16 v[232:235], a[228:231], a[220:223], v[232:235]
s_waitcnt lgkmcnt(4)
v_mfma_f32_16x16x32_bf16 v[232:235], a[224:227], a[216:219], v[232:235]
s_waitcnt lgkmcnt(2)
v_mfma_f32_16x16x32_bf16 v[236:239], a[232:235], a[216:219], v[236:239]
s_waitcnt lgkmcnt(0)
ds_read_b64_tr_b16 a[224:225], v12 offset:8192
v_mfma_f32_16x16x32_bf16 v[236:239], a[236:239], a[220:223], v[236:239]
ds_read_b64_tr_b16 a[226:227], v12 offset:8448
v_mfma_f32_16x16x32_bf16 v[212:215], a[236:239], a[212:215], v[212:215]
ds_read_b64_tr_b16 a[228:229], v12 offset:12288
v_mfma_f32_16x16x32_bf16 v[212:215], a[232:235], a[208:211], v[212:215]
buffer_load_dwordx4 v2, s[8:11], s38 offen lds
v_mfma_f32_16x16x32_bf16 a[124:127], a[232:235], a[200:203], a[124:127]
s_add_u32 m0, s76, 98304
ds_read_b64_tr_b16 a[230:231], v12 offset:12544
v_mfma_f32_16x16x32_bf16 a[124:127], a[236:239], a[204:207], a[124:127]
v_mfma_f32_16x16x32_bf16 a[100:103], a[236:239], a[196:199], a[100:103]
ds_read_b64_tr_b16 a[148:149], v8 offset:40960
v_mfma_f32_16x16x32_bf16 a[100:103], a[232:235], a[192:195], a[100:103]
ds_read_b64_tr_b16 a[150:151], v8 offset:41216
v_mfma_f32_16x16x32_bf16 a[76:79], a[232:235], a[248:251], a[76:79]
v_mfma_f32_16x16x32_bf16 a[76:79], a[236:239], a[252:255], a[76:79]
v_mfma_f32_16x16x32_bf16 a[52:55], a[236:239], a[244:247], a[52:55]
buffer_load_dwordx4 v2, s[12:15], s38 offen lds
v_mfma_f32_16x16x32_bf16 a[52:55], a[232:235], a[240:243], a[52:55]
s_add_u32 m0, s76, 94208
s_add_u32 s79, s38, 229376
v_mfma_f32_16x16x32_bf16 a[28:31], a[232:235], v[66:69], a[28:31]
v_mfma_f32_16x16x32_bf16 a[28:31], a[236:239], v[70:73], a[28:31]
v_mfma_f32_16x16x32_bf16 a[4:7], a[236:239], v[62:65], a[4:7]
v_mfma_f32_16x16x32_bf16 a[4:7], a[232:235], v[58:61], a[4:7]
s_waitcnt lgkmcnt(4)
v_mfma_f32_16x16x32_bf16 a[8:11], a[224:227], v[58:61], a[8:11]
s_waitcnt lgkmcnt(2)
ds_read_b64_tr_b16 a[232:233], v13 offset:8192
v_mfma_f32_16x16x32_bf16 a[8:11], a[228:231], v[62:65], a[8:11]
buffer_load_dwordx4 v2, s[8:11], s79 offen lds
v_mfma_f32_16x16x32_bf16 a[32:35], a[228:231], v[70:73], a[32:35]
s_cmp_lt_i32 s46, s58
s_cbranch_scc1 L_g1_pl_1015
L_g1_plr_1016:
ds_read_b64_tr_b16 a[234:235], v13 offset:8448
v_mfma_f32_16x16x32_bf16 a[32:35], a[224:227], v[66:69], a[32:35]
s_add_u32 m0, s76, 102400
ds_read_b64_tr_b16 a[236:237], v13 offset:12288
v_mfma_f32_16x16x32_bf16 a[56:59], a[224:227], a[240:243], a[56:59]
ds_read_b64_tr_b16 a[238:239], v13 offset:12544
v_mfma_f32_16x16x32_bf16 a[56:59], a[228:231], a[244:247], a[56:59]
v_mfma_f32_16x16x32_bf16 a[80:83], a[228:231], a[252:255], a[80:83]
v_mfma_f32_16x16x32_bf16 a[80:83], a[224:227], a[248:251], a[80:83]
s_waitcnt lgkmcnt(4)
v_mfma_f32_16x16x32_bf16 a[144:147], a[152:155], a[148:151], a[144:147]
buffer_load_dwordx4 v2, s[12:15], s79 offen lds
v_mfma_f32_16x16x32_bf16 a[104:107], a[224:227], a[192:195], a[104:107]
s_add_u32 s38, s38, 458752
s_add_u32 m0, s76, 147456
v_mfma_f32_16x16x32_bf16 a[104:107], a[228:231], a[196:199], a[104:107]
ds_read_b64_tr_b16 a[148:149], v8 offset:45056
v_mfma_f32_16x16x32_bf16 a[128:131], a[228:231], a[204:207], a[128:131]
ds_read_b64_tr_b16 a[150:151], v8 offset:45312
v_mfma_f32_16x16x32_bf16 a[128:131], a[224:227], a[200:203], a[128:131]
v_mfma_f32_16x16x32_bf16 v[216:219], a[224:227], a[208:211], v[216:219]
v_mfma_f32_16x16x32_bf16 v[216:219], a[228:231], a[212:215], v[216:219]
v_mfma_f32_16x16x32_bf16 v[240:243], a[228:231], a[220:223], v[240:243]
buffer_load_dwordx4 v4, s[60:63], s68 offen nt lds
v_mfma_f32_16x16x32_bf16 v[240:243], a[224:227], a[216:219], v[240:243]
s_waitcnt lgkmcnt(4)
s_add_u32 s68, s68, 0x20000
v_and_b32_e64 v76, 32, v0
v_mfma_f32_16x16x32_bf16 v[244:247], a[232:235], a[216:219], v[244:247]
s_waitcnt lgkmcnt(2)
s_lshl_b32 s79, s58, 14
ds_read_b64_tr_b16 a[224:225], v12 offset:16384
v_mfma_f32_16x16x32_bf16 v[244:247], a[236:239], a[220:223], v[244:247]
ds_read_b64_tr_b16 a[226:227], v12 offset:16640
v_mfma_f32_16x16x32_bf16 v[220:223], a[236:239], a[212:215], v[220:223]
ds_read_b64_tr_b16 a[228:229], v12 offset:20480
v_mfma_f32_16x16x32_bf16 v[220:223], a[232:235], a[208:211], v[220:223]
ds_read_b64_tr_b16 a[230:231], v12 offset:20736
v_mfma_f32_16x16x32_bf16 a[132:135], a[232:235], a[200:203], a[132:135]
s_cmp_eq_u32 s46, 4
s_cselect_b32 s79, s79, 0
s_cselect_b32 s78, -512, 0
v_mfma_f32_16x16x32_bf16 a[132:135], a[236:239], a[204:207], a[132:135]
s_add_u32 s79, s79, s68
v_mad_i32_i24 v76, v76, s78, v4
s_add_u32 m0, s76, 151552
v_mfma_f32_16x16x32_bf16 a[108:111], a[236:239], a[196:199], a[108:111]
buffer_load_dwordx4 v76, s[60:63], s79 offen nt lds
v_mfma_f32_16x16x32_bf16 a[108:111], a[232:235], a[192:195], a[108:111]
s_waitcnt lgkmcnt(4)
s_add_u32 s68, s68, 0x20000
v_mfma_f32_16x16x32_bf16 a[144:147], a[152:155], a[148:151], a[144:147]
v_mfma_f32_16x16x32_bf16 a[84:87], a[232:235], a[248:251], a[84:87]
v_mfma_f32_16x16x32_bf16 a[84:87], a[236:239], a[252:255], a[84:87]
v_mfma_f32_16x16x32_bf16 a[60:63], a[236:239], a[244:247], a[60:63]
v_mfma_f32_16x16x32_bf16 a[60:63], a[232:235], a[240:243], a[60:63]
v_mfma_f32_16x16x32_bf16 a[36:39], a[232:235], v[66:69], a[36:39]
buffer_store_dwordx4 v[46:49], v79, s[64:67], s69 offen sc1
v_mfma_f32_16x16x32_bf16 a[36:39], a[236:239], v[70:73], a[36:39]
s_add_u32 s69, s69, 0x100000
v_mfma_f32_16x16x32_bf16 a[12:15], a[236:239], v[62:65], a[12:15]
v_mfma_f32_16x16x32_bf16 a[12:15], a[232:235], v[58:61], a[12:15]
s_waitcnt lgkmcnt(2)
v_mfma_f32_16x16x32_bf16 a[16:19], v[58:61], a[224:227], a[16:19]
s_waitcnt lgkmcnt(0)
ds_read_b64_tr_b16 a[232:233], v13 offset:16384
v_mfma_f32_16x16x32_bf16 a[16:19], v[62:65], a[228:231], a[16:19]
ds_read_b64_tr_b16 a[234:235], v13 offset:16640
v_mfma_f32_16x16x32_bf16 a[40:43], v[70:73], a[228:231], a[40:43]
ds_read_b64_tr_b16 a[236:237], v13 offset:20480
v_mfma_f32_16x16x32_bf16 a[40:43], v[66:69], a[224:227], a[40:43]
buffer_store_dwordx4 v[50:53], v79, s[64:67], s69 offen sc1
v_mfma_f32_16x16x32_bf16 a[64:67], a[240:243], a[224:227], a[64:67]
s_add_u32 s69, s69, 0x100000
ds_read_b64_tr_b16 a[238:239], v13 offset:20736
v_mfma_f32_16x16x32_bf16 a[64:67], a[244:247], a[228:231], a[64:67]
v_mfma_f32_16x16x32_bf16 a[88:91], a[252:255], a[228:231], a[88:91]
v_mfma_f32_16x16x32_bf16 a[88:91], a[248:251], a[224:227], a[88:91]
v_mfma_f32_16x16x32_bf16 a[112:115], a[192:195], a[224:227], a[112:115]
v_mfma_f32_16x16x32_bf16 a[112:115], a[196:199], a[228:231], a[112:115]
v_mfma_f32_16x16x32_bf16 a[136:139], a[204:207], a[228:231], a[136:139]
v_mfma_f32_16x16x32_bf16 a[136:139], a[200:203], a[224:227], a[136:139]
v_mfma_f32_16x16x32_bf16 v[224:227], a[208:211], a[224:227], v[224:227]
v_mfma_f32_16x16x32_bf16 v[224:227], a[212:215], a[228:231], v[224:227]
v_mfma_f32_16x16x32_bf16 v[248:251], a[220:223], a[228:231], v[248:251]
v_mfma_f32_16x16x32_bf16 v[248:251], a[216:219], a[224:227], v[248:251]
s_waitcnt vmcnt(14) lgkmcnt(0)
s_barrier
v_mfma_f32_16x16x32_bf16 v[252:255], a[216:219], a[232:235], v[252:255]
s_sub_u32 s56, s56, 1
ds_read_b64_tr_b16 a[224:225], v12 offset:24576
v_mfma_f32_16x16x32_bf16 v[252:255], a[220:223], a[236:239], v[252:255]
s_cmp_eq_u32 s56, 0
s_cselect_b32 s78, -960, 64
ds_read_b64_tr_b16 a[226:227], v12 offset:24832
v_mfma_f32_16x16x32_bf16 v[228:231], a[212:215], a[236:239], v[228:231]
s_add_u32 m0, s76, 32768
s_add_u32 s79, s36, 0
ds_read_b64_tr_b16 a[228:229], v12 offset:28672
v_mfma_f32_16x16x32_bf16 v[228:231], a[208:211], a[232:235], v[228:231]
buffer_load_dwordx4 v1, s[4:7], s79 offen lds
v_mfma_f32_16x16x32_bf16 a[140:143], a[200:203], a[232:235], a[140:143]
s_add_u32 m0, s76, 36864
s_add_u32 s79, s36, 65536
ds_read_b64_tr_b16 a[230:231], v12 offset:28928
v_mfma_f32_16x16x32_bf16 a[140:143], a[204:207], a[236:239], a[140:143]
ds_read_b128 a[160:163], v6 offset:0
v_mfma_f32_16x16x32_bf16 a[116:119], a[196:199], a[236:239], a[116:119]
v_mfma_f32_16x16x32_bf16 a[116:119], a[192:195], a[232:235], a[116:119]
v_mfma_f32_16x16x32_bf16 a[92:95], a[248:251], a[232:235], a[92:95]
v_mfma_f32_16x16x32_bf16 a[92:95], a[252:255], a[236:239], a[92:95]
v_mfma_f32_16x16x32_bf16 a[68:71], a[244:247], a[236:239], a[68:71]
buffer_load_dwordx4 v1, s[4:7], s79 offen lds
v_mfma_f32_16x16x32_bf16 a[68:71], a[240:243], a[232:235], a[68:71]
s_add_u32 m0, s76, 40960
s_add_u32 s79, s36, 131072
ds_read_b128 a[164:167], v7 offset:0
v_mfma_f32_16x16x32_bf16 a[44:47], v[66:69], a[232:235], a[44:47]
v_mfma_f32_16x16x32_bf16 a[44:47], v[70:73], a[236:239], a[44:47]
v_mfma_f32_16x16x32_bf16 a[20:23], v[62:65], a[236:239], a[20:23]
v_mfma_f32_16x16x32_bf16 a[20:23], v[58:61], a[232:235], a[20:23]
s_waitcnt lgkmcnt(4)
v_mfma_f32_16x16x32_bf16 v[80:83], a[224:227], v[58:61], v[80:83]
s_waitcnt lgkmcnt(2)
ds_read_b64_tr_b16 a[232:233], v12 offset:32768
v_mfma_f32_16x16x32_bf16 v[80:83], a[228:231], v[62:65], v[80:83]
buffer_load_dwordx4 v1, s[4:7], s79 offen lds
v_mfma_f32_16x16x32_bf16 v[96:99], a[228:231], v[70:73], v[96:99]
s_add_u32 m0, s76, 45056
s_add_u32 s79, s36, 196608
ds_read_b64_tr_b16 a[234:235], v12 offset:33024
v_mfma_f32_16x16x32_bf16 v[96:99], a[224:227], v[66:69], v[96:99]
ds_read_b64_tr_b16 a[236:237], v12 offset:36864
v_mfma_f32_16x16x32_bf16 v[112:115], a[224:227], a[240:243], v[112:115]
ds_read_b64_tr_b16 a[238:239], v12 offset:37120
v_mfma_f32_16x16x32_bf16 v[112:115], a[228:231], a[244:247], v[112:115]
ds_read_b128 a[172:175], v7 offset:2048
v_mfma_f32_16x16x32_bf16 v[128:131], a[228:231], a[252:255], v[128:131]
v_mfma_f32_16x16x32_bf16 v[128:131], a[224:227], a[248:251], v[128:131]
v_mfma_f32_16x16x32_bf16 v[144:147], a[224:227], a[192:195], v[144:147]
buffer_load_dwordx4 v1, s[4:7], s79 offen lds
v_mfma_f32_16x16x32_bf16 v[144:147], a[228:231], a[196:199], v[144:147]
s_add_u32 m0, s76, 49152
s_add_u32 s79, s36, 262144
ds_read_b128 a[168:171], v6 offset:2048
v_mfma_f32_16x16x32_bf16 v[160:163], a[228:231], a[204:207], v[160:163]
v_mfma_f32_16x16x32_bf16 v[160:163], a[224:227], a[200:203], v[160:163]
v_mfma_f32_16x16x32_bf16 v[176:179], a[224:227], a[208:211], v[176:179]
v_mfma_f32_16x16x32_bf16 v[176:179], a[228:231], a[212:215], v[176:179]
v_mfma_f32_16x16x32_bf16 v[192:195], a[228:231], a[220:223], v[192:195]
v_mfma_f32_16x16x32_bf16 v[192:195], a[224:227], a[216:219], v[192:195]
s_waitcnt lgkmcnt(4)
buffer_load_dwordx4 v1, s[4:7], s79 offen lds
v_mfma_f32_16x16x32_bf16 v[196:199], a[232:235], a[216:219], v[196:199]
s_waitcnt lgkmcnt(2)
s_add_u32 m0, s76, 53248
ds_read_b64_tr_b16 a[224:225], v13 offset:24576
v_mfma_f32_16x16x32_bf16 v[196:199], a[236:239], a[220:223], v[196:199]
s_add_u32 s79, s36, 327680
ds_read_b64_tr_b16 a[226:227], v13 offset:24832
v_mfma_f32_16x16x32_bf16 v[180:183], a[236:239], a[212:215], v[180:183]
ds_read_b64_tr_b16 a[228:229], v13 offset:28672
v_mfma_f32_16x16x32_bf16 v[180:183], a[232:235], a[208:211], v[180:183]
ds_read_b64_tr_b16 a[230:231], v13 offset:28928
v_mfma_f32_16x16x32_bf16 v[164:167], a[232:235], a[200:203], v[164:167]
ds_read_b128 a[176:179], v6 offset:4096
v_mfma_f32_16x16x32_bf16 v[164:167], a[236:239], a[204:207], v[164:167]
v_mfma_f32_16x16x32_bf16 v[148:151], a[236:239], a[196:199], v[148:151]
buffer_load_dwordx4 v1, s[4:7], s79 offen lds
v_mfma_f32_16x16x32_bf16 v[148:151], a[232:235], a[192:195], v[148:151]
s_add_u32 m0, s76, 57344
s_add_u32 s79, s36, 393216
ds_read_b128 a[180:183], v7 offset:4096
v_mfma_f32_16x16x32_bf16 v[132:135], a[232:235], a[248:251], v[132:135]
v_mfma_f32_16x16x32_bf16 v[132:135], a[236:239], a[252:255], v[132:135]
v_mfma_f32_16x16x32_bf16 v[116:119], a[236:239], a[244:247], v[116:119]
v_mfma_f32_16x16x32_bf16 v[116:119], a[232:235], a[240:243], v[116:119]
v_mfma_f32_16x16x32_bf16 v[100:103], a[232:235], v[66:69], v[100:103]
v_mfma_f32_16x16x32_bf16 v[100:103], a[236:239], v[70:73], v[100:103]
buffer_load_dwordx4 v1, s[4:7], s79 offen lds
v_mfma_f32_16x16x32_bf16 v[84:87], a[236:239], v[62:65], v[84:87]
s_add_u32 m0, s76, 61440
s_add_u32 s79, s36, 458752
ds_read_b128 a[188:191], v7 offset:6144
v_mfma_f32_16x16x32_bf16 v[84:87], a[232:235], v[58:61], v[84:87]
s_waitcnt lgkmcnt(5)
v_mfma_f32_16x16x32_bf16 v[88:91], a[224:227], v[58:61], v[88:91]
s_waitcnt lgkmcnt(3)
ds_read_b64_tr_b16 a[232:233], v13 offset:32768
v_mfma_f32_16x16x32_bf16 v[88:91], a[228:231], v[62:65], v[88:91]
ds_read_b64_tr_b16 a[234:235], v13 offset:33024
v_mfma_f32_16x16x32_bf16 v[104:107], a[228:231], v[70:73], v[104:107]
ds_read_b64_tr_b16 a[236:237], v13 offset:36864
v_mfma_f32_16x16x32_bf16 v[104:107], a[224:227], v[66:69], v[104:107]
ds_read_b64_tr_b16 a[238:239], v13 offset:37120
v_mfma_f32_16x16x32_bf16 v[120:123], a[224:227], a[240:243], v[120:123]
buffer_load_dwordx4 v1, s[4:7], s79 offen lds
v_mfma_f32_16x16x32_bf16 v[120:123], a[228:231], a[244:247], v[120:123]
s_lshl1_add_u32 s36, s78, s36
s_add_u32 m0, s76, 106496
ds_read_b128 a[184:187], v6 offset:6144
v_mfma_f32_16x16x32_bf16 v[136:139], a[228:231], a[252:255], v[136:139]
v_mfma_f32_16x16x32_bf16 v[136:139], a[224:227], a[248:251], v[136:139]
v_mfma_f32_16x16x32_bf16 v[152:155], a[224:227], a[192:195], v[152:155]
v_mfma_f32_16x16x32_bf16 v[152:155], a[228:231], a[196:199], v[152:155]
v_mfma_f32_16x16x32_bf16 v[168:171], a[228:231], a[204:207], v[168:171]
v_mfma_f32_16x16x32_bf16 v[168:171], a[224:227], a[200:203], v[168:171]
buffer_load_dwordx4 v3, s[16:19], s39 offen lds
v_mfma_f32_16x16x32_bf16 v[184:187], a[224:227], a[208:211], v[184:187]
s_add_u32 m0, s76, 112640
v_mfma_f32_16x16x32_bf16 v[184:187], a[228:231], a[212:215], v[184:187]
v_mfma_f32_16x16x32_bf16 v[200:203], a[228:231], a[220:223], v[200:203]
v_mfma_f32_16x16x32_bf16 v[200:203], a[224:227], a[216:219], v[200:203]
s_waitcnt vmcnt(13) lgkmcnt(1)
s_barrier
v_mfma_f32_16x16x32_bf16 v[204:207], a[232:235], a[216:219], v[204:207]
ds_read_b64_tr_b16 a[224:225], v10 offset:0
v_mfma_f32_16x16x32_bf16 v[204:207], a[236:239], a[220:223], v[204:207]
ds_read_b64_tr_b16 a[226:227], v10 offset:256
v_mfma_f32_16x16x32_bf16 v[188:191], a[236:239], a[212:215], v[188:191]
buffer_load_dwordx4 v3, s[16:19], s39 offen offset:2048 lds
v_mfma_f32_16x16x32_bf16 v[188:191], a[232:235], a[208:211], v[188:191]
s_add_u32 m0, s76, 122880
s_add_u32 s79, s39, 4096
ds_read_b64_tr_b16 a[228:229], v10 offset:4096
v_mfma_f32_16x16x32_bf16 v[172:175], a[232:235], a[200:203], v[172:175]
ds_read_b64_tr_b16 a[230:231], v10 offset:4352
v_mfma_f32_16x16x32_bf16 v[172:175], a[236:239], a[204:207], v[172:175]
v_mfma_f32_16x16x32_bf16 v[156:159], a[236:239], a[196:199], v[156:159]
v_mfma_f32_16x16x32_bf16 v[156:159], a[232:235], a[192:195], v[156:159]
ds_read_b128 a[192:195], v6 offset:8192
v_mfma_f32_16x16x32_bf16 v[140:143], a[232:235], a[248:251], v[140:143]
ds_read_b128 a[196:199], v7 offset:8192
v_mfma_f32_16x16x32_bf16 v[140:143], a[236:239], a[252:255], v[140:143]
buffer_load_dwordx4 v3, s[16:19], s79 offen lds
v_mfma_f32_16x16x32_bf16 v[124:127], a[236:239], a[244:247], v[124:127]
s_add_u32 m0, s76, 110592
s_add_u32 s79, s39, 196608
ds_read_b128 a[204:207], v7 offset:10240
v_mfma_f32_16x16x32_bf16 v[124:127], a[232:235], a[240:243], v[124:127]
ds_read_b128 a[200:203], v6 offset:10240
v_mfma_f32_16x16x32_bf16 v[108:111], a[232:235], v[66:69], v[108:111]
ds_read_b128 a[208:211], v6 offset:12288
v_mfma_f32_16x16x32_bf16 v[108:111], a[236:239], v[70:73], v[108:111]
ds_read_b128 a[212:215], v7 offset:12288
v_mfma_f32_16x16x32_bf16 v[92:95], a[236:239], v[62:65], v[92:95]
v_mfma_f32_16x16x32_bf16 v[92:95], a[232:235], v[58:61], v[92:95]
s_waitcnt lgkmcnt(8)
s_cmp_lg_u32 s46, 0
s_cbranch_scc1 L_g1_loop_1012
v_mfma_f32_16x16x32_bf16 a[0:3], a[224:227], a[160:163], a[0:3]
s_waitcnt lgkmcnt(6)
buffer_load_dwordx4 v3, s[16:19], s79 offen lds
v_mfma_f32_16x16x32_bf16 a[0:3], a[228:231], a[164:167], a[0:3]
s_add_u32 m0, s76, 116736
ds_read_b128 a[220:223], v7 offset:14336
v_mfma_f32_16x16x32_bf16 a[24:27], a[228:231], a[172:175], a[24:27]
ds_read_b128 a[216:219], v6 offset:14336
v_mov_b32_e64 v38, 0
v_mfma_f32_16x16x32_bf16 a[24:27], a[224:227], a[168:171], a[24:27]
ds_read_b64_tr_b16 a[232:233], v11 offset:0
v_mfma_f32_16x16x32_bf16 a[48:51], a[224:227], a[176:179], a[48:51]
ds_read_b64_tr_b16 a[234:235], v11 offset:256
v_mfma_f32_16x16x32_bf16 a[48:51], a[228:231], a[180:183], a[48:51]
ds_read_b64_tr_b16 a[236:237], v11 offset:4096
v_mov_b32_e64 v39, 0
v_mfma_f32_16x16x32_bf16 a[72:75], a[228:231], a[188:191], a[72:75]
ds_read_b64_tr_b16 a[238:239], v11 offset:4352
v_mfma_f32_16x16x32_bf16 a[72:75], a[224:227], a[184:187], a[72:75]
s_waitcnt lgkmcnt(11)
buffer_load_dwordx4 v3, s[16:19], s79 offen offset:2048 lds
v_mfma_f32_16x16x32_bf16 a[96:99], a[224:227], a[192:195], a[96:99]
s_waitcnt lgkmcnt(10)
s_add_u32 m0, s76, 126976
ds_read_b32 v16, v17 offset:0
v_mfma_f32_16x16x32_bf16 a[96:99], a[228:231], a[196:199], a[96:99]
s_waitcnt lgkmcnt(10)
s_add_u32 s79, s39, 200704
v_mov_b32 v51, 0
v_mfma_f32_16x16x32_bf16 a[120:123], a[228:231], a[204:207], a[120:123]
s_waitcnt lgkmcnt(9)
v_mfma_f32_16x16x32_bf16 a[120:123], a[224:227], a[200:203], a[120:123]
s_waitcnt lgkmcnt(8)
v_mfma_f32_16x16x32_bf16 v[208:211], a[224:227], a[208:211], v[208:211]
s_waitcnt lgkmcnt(7)
v_mov_b32 v52, 0
v_mfma_f32_16x16x32_bf16 v[208:211], a[228:231], a[212:215], v[208:211]
s_waitcnt lgkmcnt(6)
v_mfma_f32_16x16x32_bf16 v[232:235], a[228:231], a[220:223], v[232:235]
s_waitcnt lgkmcnt(5)
buffer_load_dwordx4 v3, s[16:19], s79 offen lds
v_mfma_f32_16x16x32_bf16 v[232:235], a[224:227], a[216:219], v[232:235]
s_waitcnt lgkmcnt(3)
s_mul_i32 s55, s78, 6144
s_add_u32 s39, s39, s55
v_mfma_f32_16x16x32_bf16 v[236:239], a[232:235], a[216:219], v[236:239]
s_waitcnt lgkmcnt(1)
s_add_u32 m0, s76, 131072
ds_read_b64_tr_b16 a[224:225], v10 offset:8192
v_mfma_f32_16x16x32_bf16 v[236:239], a[236:239], a[220:223], v[236:239]
ds_read_b64_tr_b16 a[226:227], v10 offset:8448
v_mov_b32 v53, 0
v_mfma_f32_16x16x32_bf16 v[212:215], a[236:239], a[212:215], v[212:215]
ds_read_b64_tr_b16 a[228:229], v10 offset:12288
v_mfma_f32_16x16x32_bf16 v[212:215], a[232:235], a[208:211], v[212:215]
ds_read_b64_tr_b16 a[230:231], v10 offset:12544
v_mov_b32_e64 v55, 0
v_mfma_f32_16x16x32_bf16 a[124:127], a[232:235], a[200:203], a[124:127]
v_mfma_f32_16x16x32_bf16 a[124:127], a[236:239], a[204:207], a[124:127]
buffer_load_dwordx4 v2, s[8:11], s38 offen lds
v_mfma_f32_16x16x32_bf16 a[100:103], a[236:239], a[196:199], a[100:103]
s_add_u32 m0, s76, 139264
ds_read_b64_tr_b16 a[148:149], v8 offset:0
v_mfma_f32_16x16x32_bf16 a[100:103], a[232:235], a[192:195], a[100:103]
ds_read_b64_tr_b16 a[150:151], v8 offset:256
v_mov_b32_e64 v56, 0
v_mfma_f32_16x16x32_bf16 a[76:79], a[232:235], a[184:187], a[76:79]
s_and_b32 s71, s3, 7
v_mfma_f32_16x16x32_bf16 a[76:79], a[236:239], a[188:191], a[76:79]
v_mfma_f32_16x16x32_bf16 a[52:55], a[236:239], a[180:183], a[52:55]
s_lshl_b32 s71, s71, 16
v_mov_b32_e64 v57, 0
v_mfma_f32_16x16x32_bf16 a[52:55], a[232:235], a[176:179], a[52:55]
v_mfma_f32_16x16x32_bf16 a[28:31], a[232:235], a[168:171], a[28:31]
buffer_load_dwordx4 v2, s[12:15], s38 offen lds
v_mfma_f32_16x16x32_bf16 a[28:31], a[236:239], a[172:175], a[28:31]
s_add_u32 m0, s76, 135168
s_add_u32 s79, s38, 229376
s_xor_b32 s70, s70, s71
v_mfma_f32_16x16x32_bf16 a[4:7], a[236:239], a[164:167], a[4:7]
s_lshl_b32 s71, s43, 14
v_mfma_f32_16x16x32_bf16 a[4:7], a[232:235], a[160:163], a[4:7]
s_waitcnt lgkmcnt(4)
v_mfma_f32_16x16x32_bf16 a[8:11], a[224:227], a[160:163], a[8:11]
s_waitcnt lgkmcnt(2)
ds_read_b64_tr_b16 a[232:233], v11 offset:8192
v_mfma_f32_16x16x32_bf16 a[8:11], a[228:231], a[164:167], a[8:11]
ds_read_b64_tr_b16 a[234:235], v11 offset:8448
s_add_u32 s70, s70, s71
v_mfma_f32_16x16x32_bf16 a[32:35], a[228:231], a[172:175], a[32:35]
ds_read_b64_tr_b16 a[236:237], v11 offset:12288
v_mfma_f32_16x16x32_bf16 a[32:35], a[224:227], a[168:171], a[32:35]
buffer_load_dwordx4 v2, s[8:11], s79 offen lds
v_mfma_f32_16x16x32_bf16 a[56:59], a[224:227], a[176:179], a[56:59]
s_add_u32 m0, s76, 143360
ds_read_b64_tr_b16 a[238:239], v11 offset:12544
s_mov_b32 s72, s64
v_mfma_f32_16x16x32_bf16 a[56:59], a[228:231], a[180:183], a[56:59]
s_getpc_b64 s[60:61]
L_g1_pc_1011:
s_sub_u32 s60, s60, L_g1_pc_1011-L_code_start
s_subb_u32 s61, s61, 0
v_mfma_f32_16x16x32_bf16 a[80:83], a[228:231], a[188:191], a[80:83]
s_mov_b32 s73, s65
s_lshr_b32 s40, s2, 3
v_mfma_f32_16x16x32_bf16 a[80:83], a[224:227], a[184:187], a[80:83]
s_waitcnt lgkmcnt(4)
v_mfma_f32_16x16x32_bf16 a[144:147], a[152:155], a[148:151], a[144:147]
s_mov_b32 s75, 0x00020000
v_mfma_f32_16x16x32_bf16 a[104:107], a[224:227], a[192:195], a[104:107]
s_mul_i32 s40, s40, ((L_code_end-L_code_start+4095)>>12)<<7
v_mfma_f32_16x16x32_bf16 a[104:107], a[228:231], a[196:199], a[104:107]
buffer_load_dwordx4 v2, s[12:15], s79 offen lds
v_mfma_f32_16x16x32_bf16 a[128:131], a[228:231], a[204:207], a[128:131]
s_mul_i32 s55, s78, 7168
s_add_u32 s38, s38, s55
ds_read_b64_tr_b16 a[148:149], v8 offset:4096
v_mfma_f32_16x16x32_bf16 a[128:131], a[224:227], a[200:203], a[128:131]
s_cmp_ge_u32 s47, 7340032
s_cselect_b32 s78, 7340032, 0
ds_read_b64_tr_b16 a[150:151], v8 offset:4352
v_mfma_f32_16x16x32_bf16 v[216:219], a[224:227], a[208:211], v[216:219]
s_sub_u32 s47, s47, s78
s_cmp_lt_u32 s46, 2
s_cselect_b32 s34, 0, s34
v_mfma_f32_16x16x32_bf16 v[216:219], a[228:231], a[212:215], v[216:219]
v_lshlrev_b32 v15, 7, v0
v_min_u32 v75, ((L_code_end-L_code_start+4095)>>12)-1, v0
v_mfma_f32_16x16x32_bf16 v[240:243], a[228:231], a[220:223], v[240:243]
v_cmp_gt_u32 vcc, 32, v16
v_mfma_f32_16x16x32_bf16 v[240:243], a[224:227], a[216:219], v[240:243]
s_waitcnt lgkmcnt(4)
v_lshl_add_u32 v75, v75, 7, s40
v_mfma_f32_16x16x32_bf16 v[244:247], a[232:235], a[216:219], v[244:247]
s_waitcnt lgkmcnt(2)
buffer_load_dword v19, v18, s[32:35], s47 offen
v_mfma_f32_16x16x32_bf16 v[244:247], a[236:239], a[220:223], v[244:247]
s_add_u32 s47, s47, 917504
ds_read_b64_tr_b16 a[224:225], v10 offset:16384
v_min_u32 v75, L_code_end-L_code_start-4, v75
v_mfma_f32_16x16x32_bf16 v[220:223], a[236:239], a[212:215], v[220:223]
ds_read_b64_tr_b16 a[226:227], v10 offset:16640
v_mfma_f32_16x16x32_bf16 v[220:223], a[232:235], a[208:211], v[220:223]
ds_read_b64_tr_b16 a[228:229], v10 offset:20480
v_mfma_f32_16x16x32_bf16 a[132:135], a[232:235], a[200:203], a[132:135]
ds_read_b64_tr_b16 a[230:231], v10 offset:20736
v_mfma_f32_16x16x32_bf16 a[132:135], a[236:239], a[204:207], a[132:135]
s_cmp_eq_u64 vcc, 0
s_cselect_b32 s74, 0x900000, 0
s_cselect_b32 s49, 32, 0
v_mfma_f32_16x16x32_bf16 a[108:111], a[236:239], a[196:199], a[108:111]
global_load_dword v19, v75, s[60:61]
v_mfma_f32_16x16x32_bf16 a[108:111], a[232:235], a[192:195], a[108:111]
s_waitcnt lgkmcnt(4)
s_add_u32 s71, s70, 8192
v_mfma_f32_16x16x32_bf16 a[144:147], a[152:155], a[148:151], a[144:147]
v_mfma_f32_16x16x32_bf16 a[84:87], a[232:235], a[184:187], a[84:87]
v_mfma_f32_16x16x32_bf16 a[84:87], a[236:239], a[188:191], a[84:87]
v_mfma_f32_16x16x32_bf16 a[60:63], a[236:239], a[180:183], a[60:63]
v_mfma_f32_16x16x32_bf16 a[60:63], a[232:235], a[176:179], a[60:63]
v_mfma_f32_16x16x32_bf16 a[36:39], a[232:235], a[168:171], a[36:39]
s_nop 2
v_accvgpr_read_b32 v77, a144
v_mfma_f32_16x16x32_bf16 a[36:39], a[236:239], a[172:175], a[36:39]
v_mfma_f32_16x16x32_bf16 a[12:15], a[236:239], a[164:167], a[12:15]
v_or_b32 v77, 1, v77
v_mfma_f32_16x16x32_bf16 a[12:15], a[232:235], a[160:163], a[12:15]
s_waitcnt lgkmcnt(2)
v_mfma_f32_16x16x32_bf16 a[16:19], a[160:163], a[224:227], a[16:19]
s_waitcnt lgkmcnt(0)
buffer_store_dword v77, v9, s[24:27], s37 offen sc1
v_mfma_f32_16x16x32_bf16 a[16:19], a[164:167], a[228:231], a[16:19]
ds_read_b64_tr_b16 a[232:233], v11 offset:16384
v_mfma_f32_16x16x32_bf16 a[40:43], a[172:175], a[228:231], a[40:43]
ds_read_b64_tr_b16 a[234:235], v11 offset:16640
v_mfma_f32_16x16x32_bf16 a[40:43], a[168:171], a[224:227], a[40:43]
ds_read_b64_tr_b16 a[236:237], v11 offset:20480
v_mfma_f32_16x16x32_bf16 a[64:67], a[176:179], a[224:227], a[64:67]
buffer_load_dword v19, v15, s[72:75], s70 offen sc1
v_mfma_f32_16x16x32_bf16 a[64:67], a[180:183], a[228:231], a[64:67]
ds_read_b64_tr_b16 a[238:239], v11 offset:20736
v_mfma_f32_16x16x32_bf16 a[88:91], a[188:191], a[228:231], a[88:91]
v_mfma_f32_16x16x32_bf16 a[88:91], a[184:187], a[224:227], a[88:91]
v_mfma_f32_16x16x32_bf16 a[112:115], a[192:195], a[224:227], a[112:115]
buffer_load_dword v19, v15, s[72:75], s71 offen sc1
v_mfma_f32_16x16x32_bf16 a[112:115], a[196:199], a[228:231], a[112:115]
v_mfma_f32_16x16x32_bf16 a[136:139], a[204:207], a[228:231], a[136:139]
v_mfma_f32_16x16x32_bf16 a[136:139], a[200:203], a[224:227], a[136:139]
v_mfma_f32_16x16x32_bf16 v[224:227], a[208:211], a[224:227], v[224:227]
v_mfma_f32_16x16x32_bf16 v[224:227], a[212:215], a[228:231], v[224:227]
v_mfma_f32_16x16x32_bf16 v[248:251], a[220:223], a[228:231], v[248:251]
v_mfma_f32_16x16x32_bf16 v[248:251], a[216:219], a[224:227], v[248:251]
s_waitcnt vmcnt(15) lgkmcnt(0)
s_barrier
v_mfma_f32_16x16x32_bf16 v[252:255], a[216:219], a[232:235], v[252:255]
ds_read_b64_tr_b16 a[224:225], v10 offset:24576
v_mfma_f32_16x16x32_bf16 v[252:255], a[220:223], a[236:239], v[252:255]
ds_read_b64_tr_b16 a[226:227], v10 offset:24832
v_mfma_f32_16x16x32_bf16 v[228:231], a[212:215], a[236:239], v[228:231]
ds_read_b64_tr_b16 a[228:229], v10 offset:28672
v_mfma_f32_16x16x32_bf16 v[228:231], a[208:211], a[232:235], v[228:231]
ds_read_b64_tr_b16 a[230:231], v10 offset:28928
v_mfma_f32_16x16x32_bf16 a[140:143], a[200:203], a[232:235], a[140:143]
v_mfma_f32_16x16x32_bf16 a[140:143], a[204:207], a[236:239], a[140:143]
ds_read_b128 v[58:61], v6 offset:32768
v_mfma_f32_16x16x32_bf16 a[116:119], a[196:199], a[236:239], a[116:119]
v_mfma_f32_16x16x32_bf16 a[116:119], a[192:195], a[232:235], a[116:119]
v_mfma_f32_16x16x32_bf16 a[92:95], a[184:187], a[232:235], a[92:95]
v_mfma_f32_16x16x32_bf16 a[92:95], a[188:191], a[236:239], a[92:95]
v_mfma_f32_16x16x32_bf16 a[68:71], a[180:183], a[236:239], a[68:71]
v_mfma_f32_16x16x32_bf16 a[68:71], a[176:179], a[232:235], a[68:71]
ds_read_b128 v[62:65], v7 offset:32768
v_mfma_f32_16x16x32_bf16 a[44:47], a[168:171], a[232:235], a[44:47]
v_mfma_f32_16x16x32_bf16 a[44:47], a[172:175], a[236:239], a[44:47]
v_mfma_f32_16x16x32_bf16 a[20:23], a[164:167], a[236:239], a[20:23]
v_mfma_f32_16x16x32_bf16 a[20:23], a[160:163], a[232:235], a[20:23]
s_waitcnt lgkmcnt(4)
v_mfma_f32_16x16x32_bf16 v[80:83], a[224:227], a[160:163], v[80:83]
s_waitcnt lgkmcnt(2)
ds_read_b64_tr_b16 a[232:233], v10 offset:32768
v_mfma_f32_16x16x32_bf16 v[80:83], a[228:231], a[164:167], v[80:83]
ds_read_b64_tr_b16 a[234:235], v10 offset:33024
v_mfma_f32_16x16x32_bf16 v[96:99], a[228:231], a[172:175], v[96:99]
ds_read_b64_tr_b16 a[236:237], v10 offset:36864
v_mfma_f32_16x16x32_bf16 v[96:99], a[224:227], a[168:171], v[96:99]
ds_read_b64_tr_b16 a[238:239], v10 offset:37120
v_mfma_f32_16x16x32_bf16 v[112:115], a[224:227], a[176:179], v[112:115]
ds_read_b128 v[70:73], v7 offset:34816
v_mfma_f32_16x16x32_bf16 v[112:115], a[228:231], a[180:183], v[112:115]
v_mfma_f32_16x16x32_bf16 v[128:131], a[228:231], a[188:191], v[128:131]
v_mfma_f32_16x16x32_bf16 v[128:131], a[224:227], a[184:187], v[128:131]
v_mfma_f32_16x16x32_bf16 v[144:147], a[224:227], a[192:195], v[144:147]
s_and_b32 s75, s2, 1
v_mfma_f32_16x16x32_bf16 v[144:147], a[228:231], a[196:199], v[144:147]
ds_read_b128 v[66:69], v6 offset:34816
s_sub_u32 s34, 0, s75
v_mfma_f32_16x16x32_bf16 v[160:163], a[228:231], a[204:207], v[160:163]
s_and_b32 s47, s34, 0x15
v_mfma_f32_16x16x32_bf16 v[160:163], a[224:227], a[200:203], v[160:163]
s_xor_b32 s47, s2, s47
v_mfma_f32_16x16x32_bf16 v[176:179], a[224:227], a[208:211], v[176:179]
s_bfe_u32 s76, s47, 0x20001
s_and_b32 s38, s3, 7
v_mfma_f32_16x16x32_bf16 v[176:179], a[228:231], a[212:215], v[176:179]
s_lshr_b32 s46, s2, 6
v_mfma_f32_16x16x32_bf16 v[192:195], a[228:231], a[220:223], v[192:195]
s_lshl_b32 s33, s46, 13
v_mfma_f32_16x16x32_bf16 v[192:195], a[224:227], a[216:219], v[192:195]
s_waitcnt lgkmcnt(4)
s_lshl_b32 s32, s76, 15
v_mfma_f32_16x16x32_bf16 v[196:199], a[232:235], a[216:219], v[196:199]
s_waitcnt lgkmcnt(2)
ds_read_b64_tr_b16 a[224:225], v11 offset:24576
s_lshl2_add_u32 s76, s76, s46
v_mfma_f32_16x16x32_bf16 v[196:199], a[236:239], a[220:223], v[196:199]
ds_read_b64_tr_b16 a[226:227], v11 offset:24832
s_bfe_u32 s77, s47, 0x30003
v_mfma_f32_16x16x32_bf16 v[180:183], a[236:239], a[212:215], v[180:183]
ds_read_b64_tr_b16 a[228:229], v11 offset:28672
s_lshl_b32 s39, s43, 12
v_mfma_f32_16x16x32_bf16 v[180:183], a[232:235], a[208:211], v[180:183]
ds_read_b64_tr_b16 a[230:231], v11 offset:28928
s_lshl1_add_u32 s46, s76, s75
v_mfma_f32_16x16x32_bf16 v[164:167], a[232:235], a[200:203], v[164:167]
ds_read_b128 a[240:243], v6 offset:36864
s_lshl_b32 s68, s46, 17
v_mfma_f32_16x16x32_bf16 v[164:167], a[236:239], a[204:207], v[164:167]
s_lshl_b32 s46, s75, 12
s_add_u32 s46, s46, s33
v_mfma_f32_16x16x32_bf16 v[148:151], a[236:239], a[196:199], v[148:151]
s_add_u32 s46, s46, s32
s_lshl_b32 s47, s38, 17
v_mfma_f32_16x16x32_bf16 v[148:151], a[232:235], a[192:195], v[148:151]
ds_read_b128 a[244:247], v7 offset:36864
s_add_u32 s46, s46, s47
v_mfma_f32_16x16x32_bf16 v[132:135], a[232:235], a[184:187], v[132:135]
s_lshl_b32 s33, s43, 20
v_mfma_f32_16x16x32_bf16 v[132:135], a[236:239], a[188:191], v[132:135]
s_add_u32 s33, s33, s46
v_mfma_f32_16x16x32_bf16 v[116:119], a[236:239], a[180:183], v[116:119]
s_xor_b32 s33, s33, 4096
s_mul_i32 s32, s43, 0x81000
v_mfma_f32_16x16x32_bf16 v[116:119], a[232:235], a[176:179], v[116:119]
s_and_b32 s32, s32, 0x101000
v_mfma_f32_16x16x32_bf16 v[100:103], a[232:235], a[168:171], v[100:103]
s_xor_b32 s32, s32, s46
v_mfma_f32_16x16x32_bf16 v[100:103], a[236:239], a[172:175], v[100:103]
s_lshl_b32 s35, s38, 6
v_mfma_f32_16x16x32_bf16 v[84:87], a[236:239], a[164:167], v[84:87]
ds_read_b128 a[252:255], v7 offset:38912
s_lshl2_add_u32 s46, s77, s43
v_mfma_f32_16x16x32_bf16 v[84:87], a[232:235], a[160:163], v[84:87]
s_waitcnt lgkmcnt(5)
s_lshl_b32 s47, s46, 6
s_add_u32 s68, s68, s47
v_mfma_f32_16x16x32_bf16 v[88:91], a[224:227], a[160:163], v[88:91]
s_waitcnt lgkmcnt(3)
ds_read_b64_tr_b16 a[232:233], v11 offset:32768
s_lshl_b32 s37, s38, 16
v_mfma_f32_16x16x32_bf16 v[88:91], a[228:231], a[164:167], v[88:91]
ds_read_b64_tr_b16 a[234:235], v11 offset:33024
s_lshl_b32 s46, s77, 13
v_mfma_f32_16x16x32_bf16 v[104:107], a[228:231], a[172:175], v[104:107]
ds_read_b64_tr_b16 a[236:237], v11 offset:36864
s_add_u32 s37, s37, s46
v_mfma_f32_16x16x32_bf16 v[104:107], a[224:227], a[168:171], v[104:107]
ds_read_b64_tr_b16 a[238:239], v11 offset:37120
s_lshl_b32 s46, s43, 11
v_mfma_f32_16x16x32_bf16 v[120:123], a[224:227], a[176:179], v[120:123]
s_add_u32 s37, s37, s46
s_mov_b32 s66, 0x900000
v_mfma_f32_16x16x32_bf16 v[120:123], a[228:231], a[180:183], v[120:123]
ds_read_b128 a[248:251], v6 offset:38912
s_lshl3_add_u32 s46, s76, s77
v_mfma_f32_16x16x32_bf16 v[136:139], a[228:231], a[188:191], v[136:139]
s_lshl1_add_u32 s46, s46, s75
v_mfma_f32_16x16x32_bf16 v[136:139], a[224:227], a[184:187], v[136:139]
s_lshl2_add_u32 s46, s46, s43
v_mfma_f32_16x16x32_bf16 v[152:155], a[224:227], a[192:195], v[152:155]
s_xor_b32 s47, s46, 4
v_mfma_f32_16x16x32_bf16 v[152:155], a[228:231], a[196:199], v[152:155]
s_lshl_b32 s70, s46, 13
s_lshl_b32 s69, s47, 13
v_mfma_f32_16x16x32_bf16 v[168:171], a[228:231], a[204:207], v[168:171]
s_lshl_b32 s72, s46, 5
v_mfma_f32_16x16x32_bf16 v[168:171], a[224:227], a[200:203], v[168:171]
s_lshl_b32 s71, s47, 5
v_mfma_f32_16x16x32_bf16 v[184:187], a[224:227], a[208:211], v[184:187]
s_lshl_b32 s73, s76, 11
v_mfma_f32_16x16x32_bf16 v[184:187], a[228:231], a[212:215], v[184:187]
s_add_u32 s73, s73, 32768
s_add_u32 s12, s20, 0x2400000
s_addc_u32 s13, s21, 0
v_mfma_f32_16x16x32_bf16 v[200:203], a[228:231], a[220:223], v[200:203]
s_mov_b32 s14, 0x800000
v_mfma_f32_16x16x32_bf16 v[200:203], a[224:227], a[216:219], v[200:203]
s_waitcnt vmcnt(5) lgkmcnt(1)
s_barrier
v_mfma_f32_16x16x32_bf16 v[204:207], a[232:235], a[216:219], v[204:207]
ds_read_b64_tr_b16 a[224:225], v12 offset:0
s_mov_b32 s15, 0x00020000
v_mfma_f32_16x16x32_bf16 v[204:207], a[236:239], a[220:223], v[204:207]
ds_read_b64_tr_b16 a[226:227], v12 offset:256
v_mfma_f32_16x16x32_bf16 v[188:191], a[236:239], a[212:215], v[188:191]
ds_read_b64_tr_b16 a[228:229], v12 offset:4096
v_mfma_f32_16x16x32_bf16 v[188:191], a[232:235], a[208:211], v[188:191]
ds_read_b64_tr_b16 a[230:231], v12 offset:4352
v_mfma_f32_16x16x32_bf16 v[172:175], a[232:235], a[200:203], v[172:175]
s_add_u32 s16, s20, 0x3c00000
s_addc_u32 s17, s21, 0
s_mov_b32 s18, 0x14000
v_mfma_f32_16x16x32_bf16 v[172:175], a[236:239], a[204:207], v[172:175]
s_mov_b32 s19, 0x00020000
s_mov_b32 s60, s20
s_mov_b32 s61, s21
v_mfma_f32_16x16x32_bf16 v[156:159], a[236:239], a[196:199], v[156:159]
s_mov_b32 s62, 0
s_mov_b32 s63, 0x00020000
s_lshl_b32 s74, s59, 12
v_mfma_f32_16x16x32_bf16 v[156:159], a[232:235], a[192:195], v[156:159]
ds_read_b128 a[192:195], v6 offset:40960
s_lshl_b32 s46, s3, 7
v_mfma_f32_16x16x32_bf16 v[140:143], a[232:235], a[184:187], v[140:143]
ds_read_b128 a[196:199], v7 offset:40960
s_add_u32 s74, s74, s46
v_mfma_f32_16x16x32_bf16 v[140:143], a[236:239], a[188:191], v[140:143]
ds_read_b128 a[204:207], v7 offset:43008
s_and_b32 s46, s45, 3
v_mfma_f32_16x16x32_bf16 v[124:127], a[236:239], a[180:183], v[124:127]
ds_read_b128 a[200:203], v6 offset:43008
s_lshl_b32 s46, s46, 4
v_mfma_f32_16x16x32_bf16 v[124:127], a[232:235], a[176:179], v[124:127]
s_add_u32 s74, s74, s46
s_add_u32 s74, s74, 33792
v_mfma_f32_16x16x32_bf16 v[108:111], a[232:235], a[168:171], v[108:111]
ds_read_b128 a[208:211], v6 offset:45056
v_mfma_f32_16x16x32_bf16 v[108:111], a[236:239], a[172:175], v[108:111]
ds_read_b128 a[212:215], v7 offset:45056
v_mfma_f32_16x16x32_bf16 v[92:95], a[236:239], a[164:167], v[92:95]
v_mfma_f32_16x16x32_bf16 v[92:95], a[232:235], a[160:163], v[92:95]
s_waitcnt lgkmcnt(8)
v_mfma_f32_16x16x32_bf16 a[0:3], a[224:227], v[58:61], a[0:3]
s_waitcnt lgkmcnt(6)
ds_read_b128 a[220:223], v7 offset:47104
s_mov_b32 s8, s100
v_mfma_f32_16x16x32_bf16 a[0:3], a[228:231], v[62:65], a[0:3]
ds_read_b128 a[216:219], v6 offset:47104
s_mov_b32 s9, s101
v_mfma_f32_16x16x32_bf16 a[24:27], a[228:231], v[70:73], a[24:27]
ds_read_b64_tr_b16 a[232:233], v13 offset:0
s_mov_b32 s10, 0x400000
v_mfma_f32_16x16x32_bf16 a[24:27], a[224:227], v[66:69], a[24:27]
ds_read_b64_tr_b16 a[234:235], v13 offset:256
s_mov_b32 s11, 0x00020000
v_mfma_f32_16x16x32_bf16 a[48:51], a[224:227], a[240:243], a[48:51]
ds_read_b64_tr_b16 a[236:237], v13 offset:4096
v_mfma_f32_16x16x32_bf16 a[48:51], a[228:231], a[244:247], a[48:51]
ds_read_b64_tr_b16 a[238:239], v13 offset:4352
v_mfma_f32_16x16x32_bf16 a[72:75], a[228:231], a[252:255], a[72:75]
v_mfma_f32_16x16x32_bf16 a[72:75], a[224:227], a[248:251], a[72:75]
v_mfma_f32_16x16x32_bf16 a[176:179], a[152:155], a[224:227], 0
v_mfma_f32_16x16x32_bf16 a[176:179], a[152:155], a[228:231], a[176:179]
s_waitcnt lgkmcnt(10)
v_mfma_f32_16x16x32_bf16 a[96:99], a[228:231], a[196:199], a[96:99]
v_mfma_f32_16x16x32_bf16 a[96:99], a[224:227], a[192:195], a[96:99]
s_waitcnt lgkmcnt(8)
v_mfma_f32_16x16x32_bf16 a[120:123], a[224:227], a[200:203], a[120:123]
v_mfma_f32_16x16x32_bf16 a[120:123], a[228:231], a[204:207], a[120:123]
s_waitcnt lgkmcnt(6)
v_mfma_f32_16x16x32_bf16 v[208:211], a[228:231], a[212:215], v[208:211]
v_mfma_f32_16x16x32_bf16 v[208:211], a[224:227], a[208:211], v[208:211]
s_waitcnt lgkmcnt(4)
v_mfma_f32_16x16x32_bf16 v[232:235], a[224:227], a[216:219], v[232:235]
v_mfma_f32_16x16x32_bf16 v[232:235], a[228:231], a[220:223], v[232:235]
s_waitcnt lgkmcnt(2)
v_mfma_f32_16x16x32_bf16 v[236:239], a[232:235], a[216:219], v[236:239]
s_waitcnt lgkmcnt(0)
ds_read_b64_tr_b16 a[224:225], v12 offset:8192
v_mfma_f32_16x16x32_bf16 v[236:239], a[236:239], a[220:223], v[236:239]
ds_read_b64_tr_b16 a[226:227], v12 offset:8448
v_mfma_f32_16x16x32_bf16 v[212:215], a[236:239], a[212:215], v[212:215]
ds_read_b64_tr_b16 a[228:229], v12 offset:12288
v_and_b32 v76, 15, v0
v_mfma_f32_16x16x32_bf16 v[212:215], a[232:235], a[208:211], v[212:215]
ds_read_b64_tr_b16 a[230:231], v12 offset:12544
v_mfma_f32_16x16x32_bf16 a[124:127], a[232:235], a[200:203], a[124:127]
v_mfma_f32_16x16x32_bf16 a[124:127], a[236:239], a[204:207], a[124:127]
v_lshlrev_b32_e64 v76, 3, v76
v_mfma_f32_16x16x32_bf16 a[100:103], a[236:239], a[196:199], a[100:103]
v_mfma_f32_16x16x32_bf16 a[100:103], a[232:235], a[192:195], a[100:103]
v_mfma_f32_16x16x32_bf16 a[176:179], a[156:159], a[232:235], a[176:179]
s_add_u32 s52, s44, 0
v_mfma_f32_16x16x32_bf16 a[176:179], a[156:159], a[236:239], a[176:179]
v_mfma_f32_16x16x32_bf16 a[76:79], a[236:239], a[252:255], a[76:79]
v_mfma_f32_16x16x32_bf16 a[76:79], a[232:235], a[248:251], a[76:79]
v_mfma_f32_16x16x32_bf16 a[52:55], a[232:235], a[240:243], a[52:55]
s_lshl_b32 s52, s52, 3
v_mfma_f32_16x16x32_bf16 a[52:55], a[236:239], a[244:247], a[52:55]
v_mfma_f32_16x16x32_bf16 a[28:31], a[236:239], v[70:73], a[28:31]
v_mfma_f32_16x16x32_bf16 a[28:31], a[232:235], v[66:69], a[28:31]
buffer_load_dwordx2 v[22:23], v76, s[24:27], s52 offen offset:0 sc1
v_mfma_f32_16x16x32_bf16 a[4:7], a[232:235], v[58:61], a[4:7]
v_mfma_f32_16x16x32_bf16 a[4:7], a[236:239], v[62:65], a[4:7]
s_waitcnt lgkmcnt(2)
v_mfma_f32_16x16x32_bf16 a[8:11], a[224:227], v[58:61], a[8:11]
s_waitcnt lgkmcnt(0)
buffer_load_dwordx2 v[24:25], v76, s[24:27], s52 offen offset:128 sc1
v_mfma_f32_16x16x32_bf16 a[8:11], a[228:231], v[62:65], a[8:11]
ds_read_b64_tr_b16 a[232:233], v13 offset:8192
v_mfma_f32_16x16x32_bf16 a[32:35], a[228:231], v[70:73], a[32:35]
ds_read_b64_tr_b16 a[234:235], v13 offset:8448
v_mfma_f32_16x16x32_bf16 a[32:35], a[224:227], v[66:69], a[32:35]
ds_read_b64_tr_b16 a[236:237], v13 offset:12288
v_mfma_f32_16x16x32_bf16 a[56:59], a[224:227], a[240:243], a[56:59]
buffer_load_dwordx2 v[26:27], v76, s[24:27], s52 offen offset:256 sc1
v_mfma_f32_16x16x32_bf16 a[56:59], a[228:231], a[244:247], a[56:59]
ds_read_b64_tr_b16 a[238:239], v13 offset:12544
v_mfma_f32_16x16x32_bf16 a[80:83], a[228:231], a[252:255], a[80:83]
v_mfma_f32_16x16x32_bf16 a[80:83], a[224:227], a[248:251], a[80:83]
buffer_load_dwordx2 v[28:29], v76, s[24:27], s52 offen offset:384 sc1
v_mfma_f32_16x16x32_bf16 a[180:183], a[152:155], a[224:227], 0
v_mfma_f32_16x16x32_bf16 a[180:183], a[152:155], a[228:231], a[180:183]
v_mfma_f32_16x16x32_bf16 a[104:107], a[228:231], a[196:199], a[104:107]
buffer_load_dwordx2 v[30:31], v76, s[24:27], s52 offen offset:512 sc1
v_mfma_f32_16x16x32_bf16 a[104:107], a[224:227], a[192:195], a[104:107]
v_mfma_f32_16x16x32_bf16 a[128:131], a[224:227], a[200:203], a[128:131]
v_mfma_f32_16x16x32_bf16 a[128:131], a[228:231], a[204:207], a[128:131]
v_mfma_f32_16x16x32_bf16 v[216:219], a[228:231], a[212:215], v[216:219]
buffer_load_dwordx2 v[32:33], v76, s[24:27], s52 offen offset:640 sc1
v_mfma_f32_16x16x32_bf16 v[216:219], a[224:227], a[208:211], v[216:219]
v_mfma_f32_16x16x32_bf16 v[240:243], a[224:227], a[216:219], v[240:243]
v_mfma_f32_16x16x32_bf16 v[240:243], a[228:231], a[220:223], v[240:243]
s_waitcnt lgkmcnt(2)
buffer_load_dwordx2 v[34:35], v76, s[24:27], s52 offen offset:768 sc1
v_mfma_f32_16x16x32_bf16 v[244:247], a[232:235], a[216:219], v[244:247]
s_waitcnt lgkmcnt(0)
ds_read_b64_tr_b16 a[224:225], v12 offset:16384
v_mfma_f32_16x16x32_bf16 v[244:247], a[236:239], a[220:223], v[244:247]
ds_read_b64_tr_b16 a[226:227], v12 offset:16640
v_mfma_f32_16x16x32_bf16 v[220:223], a[236:239], a[212:215], v[220:223]
buffer_load_dwordx2 v[36:37], v76, s[24:27], s52 offen offset:896 sc1
v_mfma_f32_16x16x32_bf16 v[220:223], a[232:235], a[208:211], v[220:223]
ds_read_b64_tr_b16 a[228:229], v12 offset:20480
v_mfma_f32_16x16x32_bf16 a[132:135], a[232:235], a[200:203], a[132:135]
ds_read_b64_tr_b16 a[230:231], v12 offset:20736
v_mfma_f32_16x16x32_bf16 a[132:135], a[236:239], a[204:207], a[132:135]
v_mfma_f32_16x16x32_bf16 a[108:111], a[236:239], a[196:199], a[108:111]
v_mfma_f32_16x16x32_bf16 a[108:111], a[232:235], a[192:195], a[108:111]
v_mfma_f32_16x16x32_bf16 a[180:183], a[156:159], a[232:235], a[180:183]
v_mfma_f32_16x16x32_bf16 a[180:183], a[156:159], a[236:239], a[180:183]
v_mfma_f32_16x16x32_bf16 a[84:87], a[236:239], a[252:255], a[84:87]
v_mfma_f32_16x16x32_bf16 a[84:87], a[232:235], a[248:251], a[84:87]
v_mfma_f32_16x16x32_bf16 a[60:63], a[232:235], a[240:243], a[60:63]
v_mfma_f32_16x16x32_bf16 a[60:63], a[236:239], a[244:247], a[60:63]
v_mfma_f32_16x16x32_bf16 a[36:39], a[236:239], v[70:73], a[36:39]
v_mfma_f32_16x16x32_bf16 a[36:39], a[232:235], v[66:69], a[36:39]
v_mfma_f32_16x16x32_bf16 a[12:15], a[232:235], v[58:61], a[12:15]
s_bfe_u32 s53, s2, 0x20003
v_mfma_f32_16x16x32_bf16 a[12:15], a[236:239], v[62:65], a[12:15]
s_waitcnt lgkmcnt(2)
s_lshl2_add_u32 s53, s3, s53
v_mfma_f32_16x16x32_bf16 a[16:19], v[58:61], a[224:227], a[16:19]
s_waitcnt lgkmcnt(0)
ds_read_b64_tr_b16 a[232:233], v13 offset:16384
v_mfma_f32_16x16x32_bf16 a[16:19], v[62:65], a[228:231], a[16:19]
ds_read_b64_tr_b16 a[234:235], v13 offset:16640
s_lshl1_add_u32 s53, s53, s58
v_mfma_f32_16x16x32_bf16 a[40:43], v[70:73], a[228:231], a[40:43]
ds_read_b64_tr_b16 a[236:237], v13 offset:20480
v_mfma_f32_16x16x32_bf16 a[40:43], v[66:69], a[224:227], a[40:43]
ds_read_b64_tr_b16 a[238:239], v13 offset:20736
s_mul_i32 s53, s53, 768
v_mfma_f32_16x16x32_bf16 a[64:67], a[240:243], a[224:227], a[64:67]
v_mfma_f32_16x16x32_bf16 a[64:67], a[244:247], a[228:231], a[64:67]
s_add_u32 s53, s53, 16384
v_mfma_f32_16x16x32_bf16 a[88:91], a[252:255], a[228:231], a[88:91]
buffer_load_dwordx4 v[40:43], v9, s[24:27], s53 offen offset:0 sc1
v_mfma_f32_16x16x32_bf16 a[88:91], a[248:251], a[224:227], a[88:91]
v_mfma_f32_16x16x32_bf16 a[184:187], a[152:155], a[224:227], 0
buffer_load_dwordx4 v[44:47], v9, s[24:27], s53 offen offset:16 sc1
v_mfma_f32_16x16x32_bf16 a[184:187], a[152:155], a[228:231], a[184:187]
v_mfma_f32_16x16x32_bf16 a[112:115], a[196:199], a[228:231], a[112:115]
buffer_load_dwordx4 v[48:51], v9, s[24:27], s53 offen offset:32 sc1
v_mfma_f32_16x16x32_bf16 a[112:115], a[192:195], a[224:227], a[112:115]
v_mfma_f32_16x16x32_bf16 a[136:139], a[200:203], a[224:227], a[136:139]
v_mfma_f32_16x16x32_bf16 a[136:139], a[204:207], a[228:231], a[136:139]
v_mfma_f32_16x16x32_bf16 v[224:227], a[212:215], a[228:231], v[224:227]
v_mfma_f32_16x16x32_bf16 v[224:227], a[208:211], a[224:227], v[224:227]
v_mfma_f32_16x16x32_bf16 v[248:251], a[216:219], a[224:227], v[248:251]
v_mfma_f32_16x16x32_bf16 v[248:251], a[220:223], a[228:231], v[248:251]
s_waitcnt lgkmcnt(2)
v_mfma_f32_16x16x32_bf16 v[252:255], a[216:219], a[232:235], v[252:255]
s_waitcnt lgkmcnt(0)
ds_read_b64_tr_b16 a[224:225], v12 offset:24576
v_and_b32_e64 v78, 15, v0
v_mfma_f32_16x16x32_bf16 v[252:255], a[220:223], a[236:239], v[252:255]
ds_read_b64_tr_b16 a[226:227], v12 offset:24832
v_mfma_f32_16x16x32_bf16 v[228:231], a[212:215], a[236:239], v[228:231]
ds_read_b64_tr_b16 a[228:229], v12 offset:28672
v_lshrrev_b32_e64 v79, 4, v0
v_mfma_f32_16x16x32_bf16 v[228:231], a[208:211], a[232:235], v[228:231]
ds_read_b64_tr_b16 a[230:231], v12 offset:28928
v_mfma_f32_16x16x32_bf16 a[140:143], a[200:203], a[232:235], a[140:143]
v_mfma_f32_16x16x32_bf16 a[140:143], a[204:207], a[236:239], a[140:143]
v_lshlrev_b32_e64 v78, 11, v78
v_mfma_f32_16x16x32_bf16 a[116:119], a[196:199], a[236:239], a[116:119]
v_mfma_f32_16x16x32_bf16 a[116:119], a[192:195], a[232:235], a[116:119]
v_lshl_add_u32 v78, v79, 3, v78
v_mfma_f32_16x16x32_bf16 a[184:187], a[156:159], a[232:235], a[184:187]
v_mfma_f32_16x16x32_bf16 a[184:187], a[156:159], a[236:239], a[184:187]
v_mfma_f32_16x16x32_bf16 a[92:95], a[252:255], a[236:239], a[92:95]
s_add_u32 s47, s68, 0
v_mfma_f32_16x16x32_bf16 a[92:95], a[248:251], a[232:235], a[92:95]
v_mfma_f32_16x16x32_bf16 a[68:71], a[240:243], a[232:235], a[68:71]
buffer_load_dwordx2 a[160:161], v78, s[4:7], s47 offen offset:0
v_mfma_f32_16x16x32_bf16 a[68:71], a[244:247], a[236:239], a[68:71]
v_mfma_f32_16x16x32_bf16 a[44:47], v[70:73], a[236:239], a[44:47]
v_mfma_f32_16x16x32_bf16 a[44:47], v[66:69], a[232:235], a[44:47]
buffer_load_dwordx2 a[162:163], v78, s[4:7], s47 offen offset:32
v_mfma_f32_16x16x32_bf16 a[20:23], v[58:61], a[232:235], a[20:23]
v_mfma_f32_16x16x32_bf16 a[20:23], v[62:65], a[236:239], a[20:23]
s_waitcnt lgkmcnt(2)
s_add_u32 s47, s68, 32768
v_mfma_f32_16x16x32_bf16 v[80:83], a[224:227], v[58:61], v[80:83]
s_waitcnt lgkmcnt(0)
ds_read_b64_tr_b16 a[232:233], v12 offset:32768
v_mfma_f32_16x16x32_bf16 v[80:83], a[228:231], v[62:65], v[80:83]
ds_read_b64_tr_b16 a[234:235], v12 offset:33024
v_mfma_f32_16x16x32_bf16 v[96:99], a[228:231], v[70:73], v[96:99]
buffer_load_dwordx2 a[164:165], v78, s[4:7], s47 offen offset:0
v_mfma_f32_16x16x32_bf16 v[96:99], a[224:227], v[66:69], v[96:99]
ds_read_b64_tr_b16 a[236:237], v12 offset:36864
v_mfma_f32_16x16x32_bf16 v[112:115], a[224:227], a[240:243], v[112:115]
buffer_load_dwordx2 a[166:167], v78, s[4:7], s47 offen offset:32
v_mfma_f32_16x16x32_bf16 v[112:115], a[228:231], a[244:247], v[112:115]
ds_read_b64_tr_b16 a[238:239], v12 offset:37120
v_mfma_f32_16x16x32_bf16 v[128:131], a[228:231], a[252:255], v[128:131]
v_mfma_f32_16x16x32_bf16 v[128:131], a[224:227], a[248:251], v[128:131]
s_add_u32 s47, s68, 65536
v_mfma_f32_16x16x32_bf16 a[188:191], a[152:155], a[224:227], 0
v_mfma_f32_16x16x32_bf16 a[188:191], a[152:155], a[228:231], a[188:191]
buffer_load_dwordx2 a[168:169], v78, s[4:7], s47 offen offset:0
v_mfma_f32_16x16x32_bf16 v[144:147], a[228:231], a[196:199], v[144:147]
v_mfma_f32_16x16x32_bf16 v[144:147], a[224:227], a[192:195], v[144:147]
v_mfma_f32_16x16x32_bf16 v[160:163], a[224:227], a[200:203], v[160:163]
buffer_load_dwordx2 a[170:171], v78, s[4:7], s47 offen offset:32
v_mfma_f32_16x16x32_bf16 v[160:163], a[228:231], a[204:207], v[160:163]
v_mfma_f32_16x16x32_bf16 v[176:179], a[228:231], a[212:215], v[176:179]
s_add_u32 s47, s68, 98304
v_mfma_f32_16x16x32_bf16 v[176:179], a[224:227], a[208:211], v[176:179]
v_mfma_f32_16x16x32_bf16 v[192:195], a[224:227], a[216:219], v[192:195]
v_mfma_f32_16x16x32_bf16 v[192:195], a[228:231], a[220:223], v[192:195]
s_waitcnt lgkmcnt(2)
buffer_load_dwordx2 a[172:173], v78, s[4:7], s47 offen offset:0
v_mfma_f32_16x16x32_bf16 v[196:199], a[232:235], a[216:219], v[196:199]
s_waitcnt lgkmcnt(0)
ds_read_b64_tr_b16 a[224:225], v13 offset:24576
v_mfma_f32_16x16x32_bf16 v[196:199], a[236:239], a[220:223], v[196:199]
buffer_load_dwordx2 a[174:175], v78, s[4:7], s47 offen offset:32
v_mfma_f32_16x16x32_bf16 v[180:183], a[236:239], a[212:215], v[180:183]
ds_read_b64_tr_b16 a[226:227], v13 offset:24832
v_mfma_f32_16x16x32_bf16 v[180:183], a[232:235], a[208:211], v[180:183]
ds_read_b64_tr_b16 a[228:229], v13 offset:28672
v_mfma_f32_16x16x32_bf16 v[164:167], a[232:235], a[200:203], v[164:167]
ds_read_b64_tr_b16 a[230:231], v13 offset:28928
v_mfma_f32_16x16x32_bf16 v[164:167], a[236:239], a[204:207], v[164:167]
v_mfma_f32_16x16x32_bf16 v[148:151], a[236:239], a[196:199], v[148:151]
v_mfma_f32_16x16x32_bf16 v[148:151], a[232:235], a[192:195], v[148:151]
v_mfma_f32_16x16x32_bf16 a[188:191], a[156:159], a[232:235], a[188:191]
v_mfma_f32_16x16x32_bf16 a[188:191], a[156:159], a[236:239], a[188:191]
v_mfma_f32_16x16x32_bf16 v[132:135], a[236:239], a[252:255], v[132:135]
v_mfma_f32_16x16x32_bf16 v[132:135], a[232:235], a[248:251], v[132:135]
v_mfma_f32_16x16x32_bf16 v[116:119], a[232:235], a[240:243], v[116:119]
v_mfma_f32_16x16x32_bf16 v[116:119], a[236:239], a[244:247], v[116:119]
v_mfma_f32_16x16x32_bf16 v[100:103], a[236:239], v[70:73], v[100:103]
v_mfma_f32_16x16x32_bf16 v[100:103], a[232:235], v[66:69], v[100:103]
v_mfma_f32_16x16x32_bf16 v[84:87], a[232:235], v[58:61], v[84:87]
v_mfma_f32_16x16x32_bf16 v[84:87], a[236:239], v[62:65], v[84:87]
s_waitcnt lgkmcnt(2)
v_mfma_f32_16x16x32_bf16 v[88:91], a[224:227], v[58:61], v[88:91]
s_waitcnt lgkmcnt(0)
ds_read_b64_tr_b16 a[232:233], v13 offset:32768
v_mfma_f32_16x16x32_bf16 v[88:91], a[228:231], v[62:65], v[88:91]
ds_read_b64_tr_b16 a[234:235], v13 offset:33024
v_mfma_f32_16x16x32_bf16 v[104:107], a[228:231], v[70:73], v[104:107]
ds_read_b64_tr_b16 a[236:237], v13 offset:36864
v_mfma_f32_16x16x32_bf16 v[104:107], a[224:227], v[66:69], v[104:107]
ds_read_b64_tr_b16 a[238:239], v13 offset:37120
v_mfma_f32_16x16x32_bf16 v[120:123], a[224:227], a[240:243], v[120:123]
v_mfma_f32_16x16x32_bf16 v[120:123], a[228:231], a[244:247], v[120:123]
v_mfma_f32_16x16x32_bf16 v[136:139], a[228:231], a[252:255], v[136:139]
v_mfma_f32_16x16x32_bf16 v[136:139], a[224:227], a[248:251], v[136:139]
v_mfma_f32_16x16x32_bf16 a[148:151], a[152:155], a[224:227], 0
v_mfma_f32_16x16x32_bf16 a[148:151], a[152:155], a[228:231], a[148:151]
v_mfma_f32_16x16x32_bf16 v[152:155], a[228:231], a[196:199], v[152:155]
v_mfma_f32_16x16x32_bf16 v[152:155], a[224:227], a[192:195], v[152:155]
v_mfma_f32_16x16x32_bf16 v[168:171], a[224:227], a[200:203], v[168:171]
v_mfma_f32_16x16x32_bf16 v[168:171], a[228:231], a[204:207], v[168:171]
v_mfma_f32_16x16x32_bf16 v[184:187], a[228:231], a[212:215], v[184:187]
v_mfma_f32_16x16x32_bf16 v[184:187], a[224:227], a[208:211], v[184:187]
v_mfma_f32_16x16x32_bf16 v[200:203], a[224:227], a[216:219], v[200:203]
v_mfma_f32_16x16x32_bf16 v[200:203], a[228:231], a[220:223], v[200:203]
s_waitcnt lgkmcnt(2)
v_mfma_f32_16x16x32_bf16 v[92:95], a[232:235], v[58:61], v[92:95]
s_waitcnt lgkmcnt(0)
v_mfma_f32_16x16x32_bf16 v[92:95], a[236:239], v[62:65], v[92:95]
v_mfma_f32_16x16x32_bf16 v[108:111], a[236:239], v[70:73], v[108:111]
v_mfma_f32_16x16x32_bf16 v[108:111], a[232:235], v[66:69], v[108:111]
v_mfma_f32_16x16x32_bf16 v[124:127], a[232:235], a[240:243], v[124:127]
v_mfma_f32_16x16x32_bf16 v[124:127], a[236:239], a[244:247], v[124:127]
v_mov_b32 v59, 0
v_mfma_f32_16x16x32_bf16 v[140:143], a[236:239], a[252:255], v[140:143]
v_mov_b32_e64 v60, 0
v_mfma_f32_16x16x32_bf16 v[140:143], a[232:235], a[248:251], v[140:143]
v_mov_b32_e64 v61, 0
v_mfma_f32_16x16x32_bf16 a[148:151], a[156:159], a[232:235], a[148:151]
v_mov_b32_e64 v63, 0
v_mfma_f32_16x16x32_bf16 a[148:151], a[156:159], a[236:239], a[148:151]
v_mov_b32_e64 v64, 0
v_mfma_f32_16x16x32_bf16 v[156:159], a[236:239], a[196:199], v[156:159]
v_mov_b32_e64 v65, 0
v_mfma_f32_16x16x32_bf16 v[156:159], a[232:235], a[192:195], v[156:159]
v_mov_b32_e64 v67, 0
v_mfma_f32_16x16x32_bf16 v[172:175], a[232:235], a[200:203], v[172:175]
v_mov_b32_e64 v68, 0
v_mfma_f32_16x16x32_bf16 v[172:175], a[236:239], a[204:207], v[172:175]
v_mov_b32_e64 v69, 0
v_mfma_f32_16x16x32_bf16 v[188:191], a[236:239], a[212:215], v[188:191]
v_mov_b32_e64 v71, 0
v_mfma_f32_16x16x32_bf16 v[188:191], a[232:235], a[208:211], v[188:191]
v_mov_b32_e64 v72, 0
v_mfma_f32_16x16x32_bf16 v[204:207], a[232:235], a[216:219], v[204:207]
v_mov_b32_e64 v73, 0
v_mfma_f32_16x16x32_bf16 v[204:207], a[236:239], a[220:223], v[204:207]
s_waitcnt vmcnt(8)
s_nop 0
v_min3_u32 v74, v40, v41, v42
v_min3_u32 v75, v43, v44, v45
v_min3_u32 v74, v74, v46, v47
v_min3_u32 v75, v75, v48, v49
v_min3_u32 v74, v74, v50, v51
v_min_u32_e64 v74, v74, v75
v_cmp_eq_u32 vcc, 0, v74
s_nop 0
s_and_b32 s40, vcc_lo, 0xffff
s_cselect_b32 s40, 0, s49
s_cmp_lt_u32 s40, 32
s_cbranch_scc1 L_g1_cs_1019
L_g1_ok_1017:
v_lshlrev_b32 v18, 4, v0
v_rcp_f32 v2, v23
v_rcp_f32 v3, v25
v_rcp_f32 v4, v27
v_rcp_f32 v5, v29
v_rcp_f32_e64 v6, v31
s_xor_b32 s47, s37, 0x300000
buffer_load_dwordx4 a[192:195], v18, s[64:67], s47 offen offset:0 sc1
v_rcp_f32 v7, v33
v_rcp_f32 v8, v35
v_rcp_f32_e64 v9, v37
s_mul_i32 s55, s43, 640
s_add_u32 s55, s55, 159744
v_and_b32_e64 v77, 15, v0
v_lshl_add_u32 v77, v77, 2, s55
ds_write_b32 v77, v2 offset:64
ds_write_b32 v77, v3 offset:128
ds_write_b32 v77, v4 offset:192
ds_write_b32 v77, v5 offset:256
ds_write_b32 v77, v6 offset:320
ds_write_b32 v77, v7 offset:384
ds_write_b32 v77, v8 offset:448
ds_write_b32 v77, v9 offset:512
v_lshrrev_b32_e64 v19, 4, v0
v_lshl_add_u32 v19, v19, 4, s55
v_mul_f32 v10, 0xbfb8aa3b, v2
v_mul_f32 v11, 0xbfb8aa3b, v3
v_mul_f32 v12, 0xbfb8aa3b, v4
v_mul_f32 v13, 0xbfb8aa3b, v5
v_mul_f32 v14, 0xbfb8aa3b, v6
buffer_load_dwordx4 a[196:199], v18, s[64:67], s47 offen offset:1024 sc1
v_mul_f32 v15, 0xbfb8aa3b, v7
v_mul_f32 v16, 0xbfb8aa3b, v8
v_mul_f32 v17, 0xbfb8aa3b, v9
s_and_b32 s40, s59, 1
s_lshl_b32 s53, s40, 14
s_lshr_b32 s40, s59, 1
s_lshl_b32 s40, s40, 15
s_add_u32 s53, s53, s40
s_lshl_b32 s40, s3, 17
s_add_u32 s53, s53, s40
s_and_b32 s41, s45, 3
s_lshl_b32 s41, s41, 20
s_add_u32 s54, s53, s41
s_add_u32 s53, s54, 0x400000
s_add_u32 s54, s54, 0xc00000
s_mov_b32 s42, 0xffff0000
v_add_f32 v48, v48, v50
v_add_f32 v49, v49, v51
v_mov_b32_e64 v51, 0
v_accvgpr_read_b32 v74, a176
v_accvgpr_read_b32 v75, a177
v_add_f32_e64 v40, v40, v74
s_xor_b32 s47, s37, 0x380000
buffer_load_dwordx4 a[200:203], v18, s[64:67], s47 offen offset:0 sc1
v_add_f32_e64 v41, v41, v75
v_cvt_pk_bf16_f32 v76, v40, v40
v_cvt_pk_bf16_f32 v77, v41, v41
v_and_b32 v76, s42, v76
v_and_b32 v77, s42, v77
v_sub_f32 v76, v40, v76
v_sub_f32 v77, v41, v77
v_cvt_pk_bf16_f32 v40, v40, v76
v_cvt_pk_bf16_f32 v41, v41, v77
v_accvgpr_read_b32 v74, a180
v_accvgpr_read_b32 v75, a181
v_add_f32 v42, v42, v74
v_add_f32 v43, v43, v75
v_cvt_pk_bf16_f32 v76, v42, v42
v_cvt_pk_bf16_f32 v77, v43, v43
v_and_b32 v76, s42, v76
v_and_b32 v77, s42, v77
v_sub_f32 v76, v42, v76
v_sub_f32 v77, v43, v77
v_cvt_pk_bf16_f32 v42, v42, v76
v_cvt_pk_bf16_f32 v43, v43, v77
v_accvgpr_read_b32 v74, a184
buffer_load_dwordx4 a[204:207], v18, s[64:67], s47 offen offset:1024 sc1
v_accvgpr_read_b32 v75, a185
v_add_f32 v44, v44, v74
v_add_f32 v45, v45, v75
v_cvt_pk_bf16_f32 v76, v44, v44
v_cvt_pk_bf16_f32 v77, v45, v45
v_and_b32 v76, s42, v76
v_and_b32 v77, s42, v77
v_sub_f32 v76, v44, v76
v_sub_f32 v77, v45, v77
v_cvt_pk_bf16_f32 v44, v44, v76
v_cvt_pk_bf16_f32 v45, v45, v77
v_accvgpr_read_b32 v74, a188
v_accvgpr_read_b32 v75, a189
v_add_f32 v46, v46, v74
v_add_f32 v47, v47, v75
v_cvt_pk_bf16_f32 v76, v46, v46
v_cvt_pk_bf16_f32 v77, v47, v47
v_and_b32 v76, s42, v76
v_and_b32 v77, s42, v77
v_sub_f32 v76, v46, v76
v_sub_f32 v77, v47, v77
v_cvt_pk_bf16_f32 v46, v46, v76
s_xor_b32 s47, s37, 0x400000
buffer_load_dwordx4 a[208:211], v18, s[64:67], s47 offen offset:0 sc1
v_cvt_pk_bf16_f32 v47, v47, v77
v_accvgpr_read_b32 v74, a148
v_accvgpr_read_b32 v75, a149
v_add_f32 v48, v48, v74
v_add_f32 v49, v49, v75
v_cvt_pk_bf16_f32 v76, v48, v48
v_cvt_pk_bf16_f32 v77, v49, v49
v_and_b32 v76, s42, v76
v_and_b32 v77, s42, v77
v_sub_f32 v76, v48, v76
v_sub_f32 v77, v49, v77
v_cvt_pk_bf16_f32 v48, v48, v76
v_cvt_pk_bf16_f32 v49, v49, v77
s_lshl_b32 s52, s59, 16
s_lshl_b32 s41, s45, 11
s_add_u32 s41, s41, 18874368
s_add_u32 s52, s52, s41
v_lshlrev_b32 v79, 3, v0
s_min_u32 s40, s59, 1
s_lshl_b32 s41, s40, 16
s_sub_u32 s51, s52, s41
s_lshl_b32 s41, s40, 12
buffer_load_dwordx4 a[212:215], v18, s[64:67], s47 offen offset:1024 sc1
s_sub_u32 s50, s74, s41
s_add_u32 s50, s50, 2048
v_mov_b32 v50, v46
v_mov_b32 v54, v47
v_mov_b32 v58, v48
v_mov_b32_e64 v62, v49
v_mfma_f32_16x16x32_bf16 v[80:83], v[50:53], v[22:25], v[80:83]
v_mfma_f32_16x16x32_bf16 v[84:87], v[54:57], v[22:25], v[84:87]
v_mfma_f32_16x16x32_bf16 v[88:91], v[58:61], v[22:25], v[88:91]
v_mfma_f32_16x16x32_bf16 v[92:95], v[62:65], v[22:25], v[92:95]
s_nop 4
v_pk_mul_f32 v[80:81], v[80:81], v[10:11] op_sel:[0,0] op_sel_hi:[1,0]
s_nop 0
v_pk_mul_f32 v[88:89], v[88:89], v[10:11] op_sel:[0,0] op_sel_hi:[1,0]
v_pk_mul_f32 v[82:83], v[82:83], v[10:11] op_sel:[0,0] op_sel_hi:[1,0]
v_pk_mul_f32 v[90:91], v[90:91], v[10:11] op_sel:[0,0] op_sel_hi:[1,0]
v_exp_f32_e64 v80, v80
v_mfma_f32_16x16x32_bf16 v[96:99], v[50:53], v[24:27], v[96:99]
v_exp_f32_e64 v88, v88
v_mfma_f32_16x16x32_bf16 v[100:103], v[54:57], v[24:27], v[100:103]
v_exp_f32 v81, v81
v_exp_f32 v89, v89
v_exp_f32 v82, v82
v_exp_f32 v90, v90
s_xor_b32 s47, s37, 0x500000
buffer_load_dwordx4 a[216:219], v18, s[64:67], s47 offen offset:0 sc1
v_exp_f32_e64 v83, v83
v_mfma_f32_16x16x32_bf16 v[104:107], v[58:61], v[24:27], v[104:107]
v_exp_f32_e64 v91, v91
v_pk_fma_f32 v[80:81], v[80:81], v[22:23], v[22:23] op_sel:[0,1,1] op_sel_hi:[1,1,1]
v_pk_fma_f32 v[88:89], v[88:89], v[22:23], v[22:23] op_sel:[0,1,1] op_sel_hi:[1,1,1]
v_pk_fma_f32 v[82:83], v[82:83], v[22:23], v[22:23] op_sel:[0,1,1] op_sel_hi:[1,1,1]
v_pk_fma_f32 v[90:91], v[90:91], v[22:23], v[22:23] op_sel:[0,1,1] op_sel_hi:[1,1,1]
v_rcp_f32_e64 v80, v80
v_mfma_f32_16x16x32_bf16 v[108:111], v[62:65], v[24:27], v[108:111]
v_rcp_f32 v88, v88
v_rcp_f32 v81, v81
v_rcp_f32 v89, v89
v_rcp_f32 v82, v82
v_rcp_f32 v90, v90
v_rcp_f32 v83, v83
v_rcp_f32_e64 v91, v91
v_pk_mul_f32 v[84:85], v[84:85], v[80:81]
v_pk_mul_f32 v[92:93], v[92:93], v[88:89]
v_pk_mul_f32 v[86:87], v[86:87], v[82:83]
v_pk_mul_f32 v[94:95], v[94:95], v[90:91]
s_add_u32 s40, s54, 0
s_nop 0
v_cvt_pk_bf16_f32 v80, v84, v85
buffer_load_dwordx4 a[220:223], v18, s[64:67], s47 offen offset:1024 sc1
v_cvt_pk_bf16_f32 v82, v92, v93
v_cvt_pk_bf16_f32 v81, v86, v87
v_cvt_pk_bf16_f32 v83, v94, v95
buffer_store_dwordx4 v[80:83], v18, s[20:23], s40 offen sc1
v_pk_mul_f32 v[96:97], v[96:97], v[10:11] op_sel:[0,1] op_sel_hi:[1,1]
v_pk_mul_f32 v[104:105], v[104:105], v[10:11] op_sel:[0,1] op_sel_hi:[1,1]
v_pk_mul_f32 v[98:99], v[98:99], v[10:11] op_sel:[0,1] op_sel_hi:[1,1]
v_pk_mul_f32 v[106:107], v[106:107], v[10:11] op_sel:[0,1] op_sel_hi:[1,1]
v_exp_f32_e64 v96, v96
v_mfma_f32_16x16x32_bf16 v[112:115], v[50:53], v[26:29], v[112:115]
v_exp_f32_e64 v104, v104
v_mfma_f32_16x16x32_bf16 v[116:119], v[54:57], v[26:29], v[116:119]
v_exp_f32 v97, v97
v_exp_f32 v105, v105
v_exp_f32 v98, v98
v_exp_f32 v106, v106
v_exp_f32_e64 v99, v99
v_mfma_f32_16x16x32_bf16 v[120:123], v[58:61], v[26:29], v[120:123]
v_exp_f32_e64 v107, v107
v_pk_fma_f32 v[96:97], v[96:97], v[24:25], v[24:25] op_sel:[0,1,1] op_sel_hi:[1,1,1]
v_pk_fma_f32 v[104:105], v[104:105], v[24:25], v[24:25] op_sel:[0,1,1] op_sel_hi:[1,1,1]
v_pk_fma_f32 v[98:99], v[98:99], v[24:25], v[24:25] op_sel:[0,1,1] op_sel_hi:[1,1,1]
s_xor_b32 s47, s37, 0x700000
buffer_load_dwordx4 a[224:227], v18, s[64:67], s47 offen offset:0 sc1
v_pk_fma_f32 v[106:107], v[106:107], v[24:25], v[24:25] op_sel:[0,1,1] op_sel_hi:[1,1,1]
v_rcp_f32_e64 v96, v96
v_mfma_f32_16x16x32_bf16 v[124:127], v[62:65], v[26:29], v[124:127]
v_rcp_f32 v104, v104
v_rcp_f32 v97, v97
v_rcp_f32 v105, v105
v_rcp_f32 v98, v98
v_rcp_f32 v106, v106
v_rcp_f32 v99, v99
v_rcp_f32_e64 v107, v107
v_pk_mul_f32 v[100:101], v[100:101], v[96:97]
v_pk_mul_f32 v[108:109], v[108:109], v[104:105]
v_pk_mul_f32 v[102:103], v[102:103], v[98:99]
v_pk_mul_f32 v[110:111], v[110:111], v[106:107]
s_add_u32 s40, s54, 1024
v_cvt_pk_bf16_f32 v96, v100, v101
v_cvt_pk_bf16_f32 v98, v108, v109
v_cvt_pk_bf16_f32 v97, v102, v103
v_cvt_pk_bf16_f32 v99, v110, v111
buffer_store_dwordx4 v[96:99], v18, s[20:23], s40 offen sc1
v_pk_mul_f32 v[112:113], v[112:113], v[12:13] op_sel:[0,0] op_sel_hi:[1,0]
v_pk_mul_f32 v[120:121], v[120:121], v[12:13] op_sel:[0,0] op_sel_hi:[1,0]
buffer_load_dwordx4 a[228:231], v18, s[64:67], s47 offen offset:1024 sc1
v_pk_mul_f32 v[114:115], v[114:115], v[12:13] op_sel:[0,0] op_sel_hi:[1,0]
v_pk_mul_f32 v[122:123], v[122:123], v[12:13] op_sel:[0,0] op_sel_hi:[1,0]
v_exp_f32_e64 v112, v112
v_mfma_f32_16x16x32_bf16 v[128:131], v[50:53], v[28:31], v[128:131]
v_exp_f32_e64 v120, v120
v_mfma_f32_16x16x32_bf16 v[132:135], v[54:57], v[28:31], v[132:135]
v_exp_f32 v113, v113
v_exp_f32 v121, v121
v_exp_f32 v114, v114
v_exp_f32 v122, v122
v_exp_f32_e64 v115, v115
v_mfma_f32_16x16x32_bf16 v[136:139], v[58:61], v[28:31], v[136:139]
v_exp_f32_e64 v123, v123
v_pk_fma_f32 v[112:113], v[112:113], v[26:27], v[26:27] op_sel:[0,1,1] op_sel_hi:[1,1,1]
v_pk_fma_f32 v[120:121], v[120:121], v[26:27], v[26:27] op_sel:[0,1,1] op_sel_hi:[1,1,1]
v_pk_fma_f32 v[114:115], v[114:115], v[26:27], v[26:27] op_sel:[0,1,1] op_sel_hi:[1,1,1]
v_pk_fma_f32 v[122:123], v[122:123], v[26:27], v[26:27] op_sel:[0,1,1] op_sel_hi:[1,1,1]
v_rcp_f32_e64 v112, v112
v_mfma_f32_16x16x32_bf16 v[140:143], v[62:65], v[28:31], v[140:143]
v_rcp_f32 v120, v120
v_rcp_f32 v113, v113
v_rcp_f32_e64 v121, v121
s_xor_b32 s47, s37, 0x800000
buffer_load_dwordx4 a[232:235], v18, s[64:67], s47 offen offset:0 sc1
v_rcp_f32 v114, v114
v_rcp_f32 v122, v122
v_rcp_f32 v115, v115
v_rcp_f32 v123, v123
v_pk_mul_f32 v[116:117], v[116:117], v[112:113]
v_pk_mul_f32 v[124:125], v[124:125], v[120:121]
v_pk_mul_f32 v[118:119], v[118:119], v[114:115]
v_pk_mul_f32 v[126:127], v[126:127], v[122:123]
s_add_u32 s40, s54, 2048
v_cvt_pk_bf16_f32 v112, v116, v117
v_cvt_pk_bf16_f32 v114, v124, v125
v_cvt_pk_bf16_f32 v113, v118, v119
v_cvt_pk_bf16_f32 v115, v126, v127
buffer_store_dwordx4 v[112:115], v18, s[20:23], s40 offen sc1
v_pk_mul_f32 v[128:129], v[128:129], v[12:13] op_sel:[0,1] op_sel_hi:[1,1]
v_pk_mul_f32 v[136:137], v[136:137], v[12:13] op_sel:[0,1] op_sel_hi:[1,1]
v_pk_mul_f32 v[130:131], v[130:131], v[12:13] op_sel:[0,1] op_sel_hi:[1,1]
v_pk_mul_f32 v[138:139], v[138:139], v[12:13] op_sel:[0,1] op_sel_hi:[1,1]
v_exp_f32_e64 v128, v128
v_mfma_f32_16x16x32_bf16 v[144:147], v[50:53], v[30:33], v[144:147]
v_exp_f32_e64 v136, v136
v_mfma_f32_16x16x32_bf16 v[148:151], v[54:57], v[30:33], v[148:151]
buffer_load_dwordx4 a[236:239], v18, s[64:67], s47 offen offset:1024 sc1
v_exp_f32 v129, v129
v_exp_f32 v137, v137
v_exp_f32 v130, v130
v_exp_f32 v138, v138
v_exp_f32_e64 v131, v131
v_mfma_f32_16x16x32_bf16 v[152:155], v[58:61], v[30:33], v[152:155]
v_exp_f32_e64 v139, v139
v_pk_fma_f32 v[128:129], v[128:129], v[28:29], v[28:29] op_sel:[0,1,1] op_sel_hi:[1,1,1]
v_pk_fma_f32 v[136:137], v[136:137], v[28:29], v[28:29] op_sel:[0,1,1] op_sel_hi:[1,1,1]
v_pk_fma_f32 v[130:131], v[130:131], v[28:29], v[28:29] op_sel:[0,1,1] op_sel_hi:[1,1,1]
v_pk_fma_f32 v[138:139], v[138:139], v[28:29], v[28:29] op_sel:[0,1,1] op_sel_hi:[1,1,1]
v_rcp_f32_e64 v128, v128
v_mfma_f32_16x16x32_bf16 v[156:159], v[62:65], v[30:33], v[156:159]
v_rcp_f32 v136, v136
v_rcp_f32 v129, v129
v_rcp_f32 v137, v137
v_rcp_f32 v130, v130
v_rcp_f32 v138, v138
v_rcp_f32 v131, v131
v_rcp_f32_e64 v139, v139
v_pk_mul_f32 v[132:133], v[132:133], v[128:129]
v_pk_mul_f32 v[140:141], v[140:141], v[136:137]
s_xor_b32 s47, s37, 0x220000
buffer_load_dwordx4 a[240:243], v18, s[64:67], s47 offen offset:0 sc1
v_pk_mul_f32 v[134:135], v[134:135], v[130:131]
v_pk_mul_f32 v[142:143], v[142:143], v[138:139]
s_add_u32 s40, s54, 3072
v_cvt_pk_bf16_f32 v128, v132, v133
v_cvt_pk_bf16_f32 v130, v140, v141
v_cvt_pk_bf16_f32 v129, v134, v135
v_cvt_pk_bf16_f32 v131, v142, v143
buffer_store_dwordx4 v[128:131], v18, s[20:23], s40 offen sc1
v_pk_mul_f32 v[144:145], v[144:145], v[14:15] op_sel:[0,0] op_sel_hi:[1,0]
v_pk_mul_f32 v[152:153], v[152:153], v[14:15] op_sel:[0,0] op_sel_hi:[1,0]
v_pk_mul_f32 v[146:147], v[146:147], v[14:15] op_sel:[0,0] op_sel_hi:[1,0]
v_pk_mul_f32 v[154:155], v[154:155], v[14:15] op_sel:[0,0] op_sel_hi:[1,0]
v_exp_f32_e64 v144, v144
v_mfma_f32_16x16x32_bf16 v[160:163], v[50:53], v[32:35], v[160:163]
v_exp_f32_e64 v152, v152
v_mfma_f32_16x16x32_bf16 v[164:167], v[54:57], v[32:35], v[164:167]
v_exp_f32 v145, v145
v_exp_f32 v153, v153
v_exp_f32 v146, v146
v_exp_f32 v154, v154
v_exp_f32_e64 v147, v147
v_mfma_f32_16x16x32_bf16 v[168:171], v[58:61], v[32:35], v[168:171]
buffer_load_dwordx4 a[244:247], v18, s[64:67], s47 offen offset:1024 sc1
v_exp_f32_e64 v155, v155
v_pk_fma_f32 v[144:145], v[144:145], v[30:31], v[30:31] op_sel:[0,1,1] op_sel_hi:[1,1,1]
v_pk_fma_f32 v[152:153], v[152:153], v[30:31], v[30:31] op_sel:[0,1,1] op_sel_hi:[1,1,1]
v_pk_fma_f32 v[146:147], v[146:147], v[30:31], v[30:31] op_sel:[0,1,1] op_sel_hi:[1,1,1]
v_pk_fma_f32 v[154:155], v[154:155], v[30:31], v[30:31] op_sel:[0,1,1] op_sel_hi:[1,1,1]
v_rcp_f32_e64 v144, v144
v_mfma_f32_16x16x32_bf16 v[172:175], v[62:65], v[32:35], v[172:175]
v_rcp_f32 v152, v152
v_rcp_f32 v145, v145
v_rcp_f32 v153, v153
v_rcp_f32 v146, v146
v_rcp_f32 v154, v154
v_rcp_f32 v147, v147
v_rcp_f32_e64 v155, v155
v_pk_mul_f32 v[148:149], v[148:149], v[144:145]
v_pk_mul_f32 v[156:157], v[156:157], v[152:153]
v_pk_mul_f32 v[150:151], v[150:151], v[146:147]
v_pk_mul_f32 v[158:159], v[158:159], v[154:155]
s_add_u32 s40, s54, 4096
v_cvt_pk_bf16_f32 v144, v148, v149
v_cvt_pk_bf16_f32 v146, v156, v157
v_cvt_pk_bf16_f32 v145, v150, v151
s_xor_b32 s47, s37, 0x2a0000
buffer_load_dwordx4 a[248:251], v18, s[64:67], s47 offen offset:0 sc1
v_cvt_pk_bf16_f32 v147, v158, v159
buffer_store_dwordx4 v[144:147], v18, s[20:23], s40 offen sc1
v_pk_mul_f32 v[160:161], v[160:161], v[14:15] op_sel:[0,1] op_sel_hi:[1,1]
v_pk_mul_f32 v[168:169], v[168:169], v[14:15] op_sel:[0,1] op_sel_hi:[1,1]
v_pk_mul_f32 v[162:163], v[162:163], v[14:15] op_sel:[0,1] op_sel_hi:[1,1]
v_pk_mul_f32 v[170:171], v[170:171], v[14:15] op_sel:[0,1] op_sel_hi:[1,1]
v_exp_f32_e64 v160, v160
v_mfma_f32_16x16x32_bf16 v[176:179], v[50:53], v[34:37], v[176:179]
v_exp_f32_e64 v168, v168
v_mfma_f32_16x16x32_bf16 v[180:183], v[54:57], v[34:37], v[180:183]
v_exp_f32 v161, v161
v_exp_f32 v169, v169
v_exp_f32 v162, v162
v_exp_f32 v170, v170
v_exp_f32_e64 v163, v163
v_mfma_f32_16x16x32_bf16 v[184:187], v[58:61], v[34:37], v[184:187]
v_exp_f32_e64 v171, v171
v_pk_fma_f32 v[160:161], v[160:161], v[32:33], v[32:33] op_sel:[0,1,1] op_sel_hi:[1,1,1]
v_pk_fma_f32 v[168:169], v[168:169], v[32:33], v[32:33] op_sel:[0,1,1] op_sel_hi:[1,1,1]
v_pk_fma_f32 v[162:163], v[162:163], v[32:33], v[32:33] op_sel:[0,1,1] op_sel_hi:[1,1,1]
v_pk_fma_f32 v[170:171], v[170:171], v[32:33], v[32:33] op_sel:[0,1,1] op_sel_hi:[1,1,1]
v_rcp_f32_e64 v160, v160
buffer_load_dwordx4 a[252:255], v18, s[64:67], s47 offen offset:1024 sc1
v_mfma_f32_16x16x32_bf16 v[188:191], v[62:65], v[34:37], v[188:191]
v_rcp_f32 v168, v168
v_rcp_f32 v161, v161
v_rcp_f32 v169, v169
v_rcp_f32 v162, v162
v_rcp_f32 v170, v170
v_rcp_f32 v163, v163
v_rcp_f32_e64 v171, v171
v_pk_mul_f32 v[164:165], v[164:165], v[160:161]
v_pk_mul_f32 v[172:173], v[172:173], v[168:169]
v_pk_mul_f32 v[166:167], v[166:167], v[162:163]
v_pk_mul_f32 v[174:175], v[174:175], v[170:171]
s_add_u32 s40, s54, 5120
v_cvt_pk_bf16_f32 v160, v164, v165
v_cvt_pk_bf16_f32 v162, v172, v173
v_cvt_pk_bf16_f32 v161, v166, v167
v_cvt_pk_bf16_f32 v163, v174, v175
buffer_store_dwordx4 v[160:163], v18, s[20:23], s40 offen sc1
v_pk_mul_f32 v[176:177], v[176:177], v[16:17] op_sel:[0,0] op_sel_hi:[1,0]
v_pk_mul_f32 v[184:185], v[184:185], v[16:17] op_sel:[0,0] op_sel_hi:[1,0]
v_pk_mul_f32 v[178:179], v[178:179], v[16:17] op_sel:[0,0] op_sel_hi:[1,0]
v_pk_mul_f32 v[186:187], v[186:187], v[16:17] op_sel:[0,0] op_sel_hi:[1,0]
s_xor_b32 s47, s37, 0x200000
buffer_load_dwordx4 a[176:179], v18, s[64:67], s47 offen offset:0 sc1
v_exp_f32_e64 v176, v176
v_mfma_f32_16x16x32_bf16 v[192:195], v[50:53], v[36:39], v[192:195]
v_exp_f32_e64 v184, v184
v_mfma_f32_16x16x32_bf16 v[196:199], v[54:57], v[36:39], v[196:199]
v_exp_f32 v177, v177
v_exp_f32 v185, v185
v_exp_f32 v178, v178
v_exp_f32 v186, v186
v_exp_f32_e64 v179, v179
v_mfma_f32_16x16x32_bf16 v[200:203], v[58:61], v[36:39], v[200:203]
v_exp_f32_e64 v187, v187
v_pk_fma_f32 v[176:177], v[176:177], v[34:35], v[34:35] op_sel:[0,1,1] op_sel_hi:[1,1,1]
v_pk_fma_f32 v[184:185], v[184:185], v[34:35], v[34:35] op_sel:[0,1,1] op_sel_hi:[1,1,1]
v_pk_fma_f32 v[178:179], v[178:179], v[34:35], v[34:35] op_sel:[0,1,1] op_sel_hi:[1,1,1]
v_pk_fma_f32 v[186:187], v[186:187], v[34:35], v[34:35] op_sel:[0,1,1] op_sel_hi:[1,1,1]
v_rcp_f32_e64 v176, v176
v_mfma_f32_16x16x32_bf16 v[204:207], v[62:65], v[36:39], v[204:207]
v_rcp_f32 v184, v184
v_rcp_f32 v177, v177
v_rcp_f32 v185, v185
v_rcp_f32 v178, v178
v_rcp_f32_e64 v186, v186
buffer_load_dwordx4 a[180:183], v18, s[64:67], s47 offen offset:1024 sc1
v_rcp_f32 v179, v179
v_rcp_f32 v187, v187
v_pk_mul_f32 v[180:181], v[180:181], v[176:177]
v_pk_mul_f32 v[188:189], v[188:189], v[184:185]
v_pk_mul_f32 v[182:183], v[182:183], v[178:179]
v_pk_mul_f32 v[190:191], v[190:191], v[186:187]
s_add_u32 s40, s54, 6144
v_cvt_pk_bf16_f32 v176, v180, v181
v_cvt_pk_bf16_f32 v178, v188, v189
v_cvt_pk_bf16_f32 v177, v182, v183
v_cvt_pk_bf16_f32 v179, v190, v191
buffer_store_dwordx4 v[176:179], v18, s[20:23], s40 offen sc1
v_pk_mul_f32 v[192:193], v[192:193], v[16:17] op_sel:[0,1] op_sel_hi:[1,1]
ds_read_b128 v[10:13], v19 offset:512
v_pk_mul_f32 v[200:201], v[200:201], v[16:17] op_sel:[0,1] op_sel_hi:[1,1]
v_pk_mul_f32 v[194:195], v[194:195], v[16:17] op_sel:[0,1] op_sel_hi:[1,1]
v_mov_b32_e64 v58, v42
v_pk_mul_f32 v[202:203], v[202:203], v[16:17] op_sel:[0,1] op_sel_hi:[1,1]
v_mov_b32 v62, v43
v_exp_f32 v192, v192
v_exp_f32 v200, v200
v_mov_b32 v66, v44
s_xor_b32 s47, s37, 0x280000
buffer_load_dwordx4 a[184:187], v18, s[64:67], s47 offen offset:0 sc1
v_exp_f32 v193, v193
v_mov_b32 v70, v45
v_exp_f32 v201, v201
v_mov_b32 v50, v40
v_exp_f32 v194, v194
v_exp_f32 v202, v202
v_mov_b32 v54, v41
v_exp_f32 v195, v195
v_mfma_f32_16x16x32_bf16 v[240:243], v[58:61], v[36:39], v[240:243]
v_exp_f32_e64 v203, v203
v_pk_fma_f32 v[192:193], v[192:193], v[36:37], v[36:37] op_sel:[0,1,1] op_sel_hi:[1,1,1]
v_pk_fma_f32 v[200:201], v[200:201], v[36:37], v[36:37] op_sel:[0,1,1] op_sel_hi:[1,1,1]
v_pk_fma_f32 v[194:195], v[194:195], v[36:37], v[36:37] op_sel:[0,1,1] op_sel_hi:[1,1,1]
v_pk_fma_f32 v[202:203], v[202:203], v[36:37], v[36:37] op_sel:[0,1,1] op_sel_hi:[1,1,1]
v_rcp_f32_e64 v192, v192
v_mfma_f32_16x16x32_bf16 v[244:247], v[62:65], v[36:39], v[244:247]
v_mfma_f32_16x16x32_bf16 v[232:235], v[50:53], v[36:39], v[232:235]
v_mfma_f32_16x16x32_bf16 v[236:239], v[54:57], v[36:39], v[236:239]
v_mfma_f32_16x16x32_bf16 v[248:251], v[36:39], v[66:69], v[248:251]
v_rcp_f32_e64 v200, v200
v_mfma_f32_16x16x32_bf16 v[252:255], v[36:39], v[70:73], v[252:255]
v_rcp_f32_e64 v193, v193
buffer_load_dwordx4 a[188:191], v18, s[64:67], s47 offen offset:1024 sc1
v_rcp_f32 v201, v201
v_rcp_f32 v194, v194
v_rcp_f32 v202, v202
v_rcp_f32 v195, v195
v_rcp_f32_e64 v203, v203
v_pk_mul_f32 v[196:197], v[196:197], v[192:193]
v_pk_mul_f32 v[204:205], v[204:205], v[200:201]
v_pk_mul_f32 v[198:199], v[198:199], v[194:195]
v_pk_mul_f32 v[206:207], v[206:207], v[202:203]
s_add_u32 s40, s54, 7168
v_cvt_pk_bf16_f32 v192, v196, v197
v_cvt_pk_bf16_f32 v194, v204, v205
v_cvt_pk_bf16_f32 v193, v198, v199
v_cvt_pk_bf16_f32 v195, v206, v207
buffer_store_dwordx4 v[192:195], v18, s[20:23], s40 offen sc1
v_pk_mul_f32 v[240:241], v[240:241], v[8:9] op_sel:[0,1] op_sel_hi:[1,1]
ds_read_b128 v[14:17], v19 offset:64
v_pk_mul_f32 v[244:245], v[244:245], v[8:9] op_sel:[0,1] op_sel_hi:[1,1]
v_pk_mul_f32 v[242:243], v[242:243], v[8:9] op_sel:[0,1] op_sel_hi:[1,1]
v_pk_mul_f32 v[246:247], v[246:247], v[8:9] op_sel:[0,1] op_sel_hi:[1,1]
v_cvt_pk_bf16_f32 v112, v240, v241
v_mfma_f32_16x16x32_bf16 a[8:11], v[58:61], v[22:25], a[8:11]
v_cvt_pk_bf16_f32 v114, v244, v245
v_mfma_f32_16x16x32_bf16 a[12:15], v[62:65], v[22:25], a[12:15]
v_cvt_pk_bf16_f32 v113, v242, v243
v_cvt_pk_bf16_f32 v115, v246, v247
v_cvt_pk_bf16_f32 v144, v232, v233
v_mfma_f32_16x16x32_bf16 a[0:3], v[50:53], v[22:25], a[0:3]
v_cvt_pk_bf16_f32 v146, v236, v237
v_cvt_pk_bf16_f32 v145, v234, v235
v_cvt_pk_bf16_f32 v147, v238, v239
v_mfma_f32_16x16x32_bf16 a[4:7], v[54:57], v[22:25], a[4:7]
v_mul_f32 v9, 0x3e8293ee, v9
s_waitcnt lgkmcnt(1)
v_mfma_f32_16x16x32_bf16 a[16:19], v[22:25], v[66:69], a[16:19]
s_nop 0
v_pk_mul_f32 v[248:249], v[248:249], v[10:11]
v_pk_mul_f32 v[252:253], v[252:253], v[10:11]
v_pk_mul_f32 v[250:251], v[250:251], v[12:13]
v_pk_mul_f32 v[254:255], v[254:255], v[12:13]
v_cvt_pk_bf16_f32 v164, v248, v249
v_mfma_f32_16x16x32_bf16 a[20:23], v[22:25], v[70:73], a[20:23]
v_cvt_pk_bf16_f32 v182, v252, v253
v_cvt_pk_bf16_f32 v165, v250, v251
v_cvt_pk_bf16_f32 v183, v254, v255
s_lshl_b32 s41, s58, 11
s_add_u32 s41, s41, 147456
s_lshl2_add_u32 s40, s58, 162304
s_waitcnt vmcnt(28)
v_add_u32_e64 v236, s41, v18
v_accvgpr_read_b32 v240, a160
v_accvgpr_read_b32 v241, a161
v_accvgpr_read_b32 v242, a162
v_accvgpr_read_b32 v243, a163
s_add_u32 s41, s41, 1024
v_mov_b32 v238, s40
v_add_u32 v237, s41, v79
ds_write_b128 v236, v[112:115]
v_accvgpr_read_b32 v244, a164
v_accvgpr_read_b32 v245, a165
v_accvgpr_read_b32 v246, a166
v_accvgpr_read_b32 v247, a167
ds_write_b64 v237, v[164:165] offset:0
ds_write_b64 v237, v[182:183] offset:512
ds_write_b32 v238, v238
v_accvgpr_read_b32 v184, a8
v_accvgpr_read_b32 v248, a168
v_accvgpr_read_b32 v249, a169
v_accvgpr_read_b32 v250, a170
v_accvgpr_read_b32 v251, a171
v_accvgpr_read_b32 v188, a12
ds_read_b128 v[10:13], v19 offset:128
v_accvgpr_read_b32 v185, a9
v_accvgpr_read_b32 v189, a13
v_accvgpr_read_b32 v252, a172
v_accvgpr_read_b32 v253, a173
v_accvgpr_read_b32 v254, a174
v_accvgpr_read_b32 v255, a175
v_accvgpr_read_b32 v186, a10
v_mfma_f32_16x16x32_bf16 a[32:35], v[58:61], v[24:27], a[32:35]
v_accvgpr_read_b32 v190, a14
v_accvgpr_read_b32 v187, a11
v_accvgpr_read_b32 v191, a15
v_pk_mul_f32 v[184:185], v[184:185], v[2:3] op_sel:[0,0] op_sel_hi:[1,0]
v_pk_mul_f32 v[188:189], v[188:189], v[2:3] op_sel:[0,0] op_sel_hi:[1,0]
v_pk_mul_f32 v[186:187], v[186:187], v[2:3] op_sel:[0,0] op_sel_hi:[1,0]
v_pk_mul_f32 v[190:191], v[190:191], v[2:3] op_sel:[0,0] op_sel_hi:[1,0]
v_cvt_pk_bf16_f32 v84, v184, v185
v_mfma_f32_16x16x32_bf16 a[36:39], v[62:65], v[24:27], a[36:39]
v_mfma_f32_16x16x32_bf16 a[24:27], v[50:53], v[24:27], a[24:27]
v_cvt_pk_bf16_f32 v86, v188, v189
v_cvt_pk_bf16_f32 v85, v186, v187
v_cvt_pk_bf16_f32 v87, v190, v191
v_mfma_f32_16x16x32_bf16 a[28:31], v[54:57], v[24:27], a[28:31]
v_accvgpr_read_b32 v196, a0
v_accvgpr_read_b32 v200, a4
v_accvgpr_read_b32 v197, a1
v_accvgpr_read_b32 v201, a5
v_mfma_f32_16x16x32_bf16 a[40:43], v[24:27], v[66:69], a[40:43]
v_accvgpr_read_b32 v198, a2
v_accvgpr_read_b32 v202, a6
v_accvgpr_read_b32 v199, a3
v_mfma_f32_16x16x32_bf16 a[44:47], v[24:27], v[70:73], a[44:47]
v_accvgpr_read_b32 v203, a7
v_cvt_pk_bf16_f32 v116, v196, v197
v_cvt_pk_bf16_f32 v118, v200, v201
v_cvt_pk_bf16_f32 v117, v198, v199
v_cvt_pk_bf16_f32 v119, v202, v203
v_mul_f32 v2, 0x3e8293ee, v2
s_waitcnt lgkmcnt(1)
s_nop 0
s_xor_b32 s47, s37, 0x320000
buffer_load_dwordx4 a[0:3], v18, s[64:67], s47 offen offset:0 sc1
v_accvgpr_read_b32 v204, a16
v_accvgpr_read_b32 v192, a20
v_accvgpr_read_b32 v205, a17
v_accvgpr_read_b32 v193, a21
v_accvgpr_read_b32 v206, a18
v_accvgpr_read_b32 v194, a22
v_accvgpr_read_b32 v207, a19
v_accvgpr_read_b32 v195, a23
v_pk_mul_f32 v[204:205], v[204:205], v[14:15]
v_pk_mul_f32 v[192:193], v[192:193], v[14:15]
v_pk_mul_f32 v[206:207], v[206:207], v[16:17]
v_pk_mul_f32 v[194:195], v[194:195], v[16:17]
buffer_load_dwordx4 a[4:7], v18, s[64:67], s47 offen offset:1024 sc1
v_cvt_pk_bf16_f32 v150, v204, v205
v_cvt_pk_bf16_f32 v168, v192, v193
v_cvt_pk_bf16_f32 v151, v206, v207
v_cvt_pk_bf16_f32 v169, v194, v195
v_accvgpr_read_b32 v184, a32
v_accvgpr_read_b32 v188, a36
ds_read_b128 v[14:17], v19 offset:192
v_accvgpr_read_b32 v185, a33
v_accvgpr_read_b32 v189, a37
v_accvgpr_read_b32 v186, a34
v_mov_b32_e64 v76, 1
s_waitcnt vmcnt(2)
s_mov_b64 exec, 1
buffer_store_dword v76, off, s[16:19], s74 sc1
s_mov_b64 exec, -1
v_mfma_f32_16x16x32_bf16 a[56:59], v[58:61], v[26:29], a[56:59]
s_nop 0
v_accvgpr_read_b32 v190, a38
v_accvgpr_read_b32 v187, a35
s_xor_b32 s47, s37, 0x3a0000
buffer_load_dwordx4 a[8:11], v18, s[64:67], s47 offen offset:0 sc1
v_accvgpr_read_b32 v191, a39
v_pk_mul_f32 v[184:185], v[184:185], v[2:3] op_sel:[0,1] op_sel_hi:[1,1]
v_pk_mul_f32 v[188:189], v[188:189], v[2:3] op_sel:[0,1] op_sel_hi:[1,1]
v_pk_mul_f32 v[186:187], v[186:187], v[2:3] op_sel:[0,1] op_sel_hi:[1,1]
v_pk_mul_f32 v[190:191], v[190:191], v[2:3] op_sel:[0,1] op_sel_hi:[1,1]
v_cvt_pk_bf16_f32 v88, v184, v185
v_mfma_f32_16x16x32_bf16 a[60:63], v[62:65], v[26:29], a[60:63]
v_mfma_f32_16x16x32_bf16 a[48:51], v[50:53], v[26:29], a[48:51]
v_cvt_pk_bf16_f32 v90, v188, v189
v_cvt_pk_bf16_f32 v89, v186, v187
v_cvt_pk_bf16_f32 v91, v190, v191
v_mfma_f32_16x16x32_bf16 a[52:55], v[54:57], v[26:29], a[52:55]
v_accvgpr_read_b32 v196, a24
buffer_load_dwordx4 a[12:15], v18, s[64:67], s47 offen offset:1024 sc1
v_accvgpr_read_b32 v200, a28
v_accvgpr_read_b32 v197, a25
v_accvgpr_read_b32 v201, a29
v_mfma_f32_16x16x32_bf16 a[64:67], v[26:29], v[66:69], a[64:67]
v_accvgpr_read_b32 v198, a26
v_accvgpr_read_b32 v202, a30
v_accvgpr_read_b32 v199, a27
v_mfma_f32_16x16x32_bf16 a[68:71], v[26:29], v[70:73], a[68:71]
v_accvgpr_read_b32 v203, a31
v_cvt_pk_bf16_f32 v120, v196, v197
v_cvt_pk_bf16_f32 v122, v200, v201
v_cvt_pk_bf16_f32 v121, v198, v199
v_cvt_pk_bf16_f32 v123, v202, v203
v_mul_f32 v3, 0x3e8293ee, v3
s_waitcnt lgkmcnt(1)
s_nop 0
s_xor_b32 s47, s37, 0x420000
buffer_load_dwordx4 a[16:19], v18, s[64:67], s47 offen offset:0 sc1
v_accvgpr_read_b32 v204, a40
v_accvgpr_read_b32 v192, a44
v_accvgpr_read_b32 v205, a41
v_accvgpr_read_b32 v193, a45
v_accvgpr_read_b32 v206, a42
v_accvgpr_read_b32 v194, a46
v_accvgpr_read_b32 v207, a43
v_accvgpr_read_b32 v195, a47
v_pk_mul_f32 v[204:205], v[204:205], v[10:11]
v_pk_mul_f32 v[192:193], v[192:193], v[10:11]
v_pk_mul_f32 v[206:207], v[206:207], v[12:13]
v_pk_mul_f32 v[194:195], v[194:195], v[12:13]
buffer_load_dwordx4 a[20:23], v18, s[64:67], s47 offen offset:1024 sc1
v_cvt_pk_bf16_f32 v152, v204, v205
v_cvt_pk_bf16_f32 v170, v192, v193
v_cvt_pk_bf16_f32 v153, v206, v207
v_cvt_pk_bf16_f32 v171, v194, v195
v_accvgpr_read_b32 v184, a56
v_accvgpr_read_b32 v188, a60
ds_read_b128 v[10:13], v19 offset:256
v_accvgpr_read_b32 v185, a57
v_accvgpr_read_b32 v189, a61
v_accvgpr_read_b32 v186, a58
v_mfma_f32_16x16x32_bf16 a[80:83], v[58:61], v[28:31], a[80:83]
v_accvgpr_read_b32 v190, a62
v_accvgpr_read_b32 v187, a59
s_xor_b32 s47, s37, 0x520000
buffer_load_dwordx4 a[24:27], v18, s[64:67], s47 offen offset:0 sc1
v_accvgpr_read_b32 v191, a63
v_pk_mul_f32 v[184:185], v[184:185], v[4:5] op_sel:[0,0] op_sel_hi:[1,0]
v_pk_mul_f32 v[188:189], v[188:189], v[4:5] op_sel:[0,0] op_sel_hi:[1,0]
v_pk_mul_f32 v[186:187], v[186:187], v[4:5] op_sel:[0,0] op_sel_hi:[1,0]
v_pk_mul_f32 v[190:191], v[190:191], v[4:5] op_sel:[0,0] op_sel_hi:[1,0]
v_cvt_pk_bf16_f32 v92, v184, v185
v_mfma_f32_16x16x32_bf16 a[84:87], v[62:65], v[28:31], a[84:87]
v_mfma_f32_16x16x32_bf16 a[72:75], v[50:53], v[28:31], a[72:75]
v_cvt_pk_bf16_f32 v94, v188, v189
v_cvt_pk_bf16_f32 v93, v186, v187
v_cvt_pk_bf16_f32 v95, v190, v191
v_mfma_f32_16x16x32_bf16 a[76:79], v[54:57], v[28:31], a[76:79]
v_accvgpr_read_b32 v196, a48
buffer_load_dwordx4 a[28:31], v18, s[64:67], s47 offen offset:1024 sc1
v_accvgpr_read_b32 v200, a52
v_accvgpr_read_b32 v197, a49
v_accvgpr_read_b32 v201, a53
v_mfma_f32_16x16x32_bf16 a[88:91], v[28:31], v[66:69], a[88:91]
v_accvgpr_read_b32 v198, a50
v_accvgpr_read_b32 v202, a54
v_accvgpr_read_b32 v199, a51
v_mfma_f32_16x16x32_bf16 a[92:95], v[28:31], v[70:73], a[92:95]
v_accvgpr_read_b32 v203, a55
v_cvt_pk_bf16_f32 v124, v196, v197
v_cvt_pk_bf16_f32 v126, v200, v201
v_cvt_pk_bf16_f32 v125, v198, v199
v_cvt_pk_bf16_f32 v127, v202, v203
s_xor_b32 s47, s37, 0x720000
buffer_load_dwordx4 a[32:35], v18, s[64:67], s47 offen offset:0 sc1
v_mul_f32 v4, 0x3e8293ee, v4
s_waitcnt lgkmcnt(1)
s_nop 0
v_accvgpr_read_b32 v204, a64
v_accvgpr_read_b32 v192, a68
v_accvgpr_read_b32 v205, a65
v_accvgpr_read_b32 v193, a69
v_accvgpr_read_b32 v206, a66
v_accvgpr_read_b32 v194, a70
v_accvgpr_read_b32 v207, a67
v_accvgpr_read_b32 v195, a71
v_pk_mul_f32 v[204:205], v[204:205], v[14:15]
v_pk_mul_f32 v[192:193], v[192:193], v[14:15]
v_pk_mul_f32 v[206:207], v[206:207], v[16:17]
buffer_load_dwordx4 a[36:39], v18, s[64:67], s47 offen offset:1024 sc1
v_pk_mul_f32 v[194:195], v[194:195], v[16:17]
v_cvt_pk_bf16_f32 v154, v204, v205
v_cvt_pk_bf16_f32 v172, v192, v193
v_cvt_pk_bf16_f32 v155, v206, v207
v_cvt_pk_bf16_f32 v173, v194, v195
v_accvgpr_read_b32 v184, a80
v_accvgpr_read_b32 v188, a84
ds_read_b128 v[14:17], v19 offset:320
v_accvgpr_read_b32 v185, a81
v_accvgpr_read_b32 v189, a85
v_accvgpr_read_b32 v186, a82
v_mfma_f32_16x16x32_bf16 a[104:107], v[58:61], v[30:33], a[104:107]
v_accvgpr_read_b32 v190, a86
s_xor_b32 s47, s37, 0x820000
buffer_load_dwordx4 a[40:43], v18, s[64:67], s47 offen offset:0 sc1
v_accvgpr_read_b32 v187, a83
v_accvgpr_read_b32 v191, a87
v_pk_mul_f32 v[184:185], v[184:185], v[4:5] op_sel:[0,1] op_sel_hi:[1,1]
v_pk_mul_f32 v[188:189], v[188:189], v[4:5] op_sel:[0,1] op_sel_hi:[1,1]
v_pk_mul_f32 v[186:187], v[186:187], v[4:5] op_sel:[0,1] op_sel_hi:[1,1]
v_pk_mul_f32 v[190:191], v[190:191], v[4:5] op_sel:[0,1] op_sel_hi:[1,1]
v_cvt_pk_bf16_f32 v96, v184, v185
v_mfma_f32_16x16x32_bf16 a[108:111], v[62:65], v[30:33], a[108:111]
v_mfma_f32_16x16x32_bf16 a[96:99], v[50:53], v[30:33], a[96:99]
v_cvt_pk_bf16_f32 v98, v188, v189
v_cvt_pk_bf16_f32 v97, v186, v187
v_cvt_pk_bf16_f32 v99, v190, v191
v_mfma_f32_16x16x32_bf16 a[100:103], v[54:57], v[30:33], a[100:103]
buffer_load_dwordx4 a[44:47], v18, s[64:67], s47 offen offset:1024 sc1
v_accvgpr_read_b32 v196, a72
v_accvgpr_read_b32 v200, a76
v_accvgpr_read_b32 v197, a73
v_accvgpr_read_b32 v201, a77
v_mfma_f32_16x16x32_bf16 a[112:115], v[30:33], v[66:69], a[112:115]
v_accvgpr_read_b32 v198, a74
v_accvgpr_read_b32 v202, a78
v_accvgpr_read_b32 v199, a75
v_mfma_f32_16x16x32_bf16 a[116:119], v[30:33], v[70:73], a[116:119]
v_accvgpr_read_b32 v203, a79
v_cvt_pk_bf16_f32 v128, v196, v197
v_cvt_pk_bf16_f32 v130, v200, v201
v_cvt_pk_bf16_f32 v129, v198, v199
s_xor_b32 s47, s37, 0x440000
buffer_load_dwordx4 a[48:51], v18, s[64:67], s47 offen offset:0 sc1
v_cvt_pk_bf16_f32 v131, v202, v203
v_mul_f32 v5, 0x3e8293ee, v5
s_waitcnt lgkmcnt(1)
s_nop 0
v_accvgpr_read_b32 v204, a88
v_accvgpr_read_b32 v192, a92
v_accvgpr_read_b32 v205, a89
v_accvgpr_read_b32 v193, a93
v_accvgpr_read_b32 v206, a90
v_accvgpr_read_b32 v194, a94
v_accvgpr_read_b32 v207, a91
v_accvgpr_read_b32 v195, a95
v_pk_mul_f32 v[204:205], v[204:205], v[10:11]
v_pk_mul_f32 v[192:193], v[192:193], v[10:11]
buffer_load_dwordx4 a[52:55], v18, s[64:67], s47 offen offset:1024 sc1
v_pk_mul_f32 v[206:207], v[206:207], v[12:13]
v_pk_mul_f32 v[194:195], v[194:195], v[12:13]
v_cvt_pk_bf16_f32 v156, v204, v205
v_cvt_pk_bf16_f32 v174, v192, v193
v_cvt_pk_bf16_f32 v157, v206, v207
v_cvt_pk_bf16_f32 v175, v194, v195
v_accvgpr_read_b32 v184, a104
v_accvgpr_read_b32 v188, a108
ds_read_b128 v[10:13], v19 offset:384
v_accvgpr_read_b32 v185, a105
v_accvgpr_read_b32 v189, a109
v_accvgpr_read_b32 v186, a106
v_mfma_f32_16x16x32_bf16 a[128:131], v[58:61], v[32:35], a[128:131]
s_xor_b32 s47, s37, 0x540000
buffer_load_dwordx4 a[56:59], v18, s[64:67], s47 offen offset:0 sc1
v_accvgpr_read_b32 v190, a110
v_accvgpr_read_b32 v187, a107
v_accvgpr_read_b32 v191, a111
v_pk_mul_f32 v[184:185], v[184:185], v[6:7] op_sel:[0,0] op_sel_hi:[1,0]
v_pk_mul_f32 v[188:189], v[188:189], v[6:7] op_sel:[0,0] op_sel_hi:[1,0]
v_pk_mul_f32 v[186:187], v[186:187], v[6:7] op_sel:[0,0] op_sel_hi:[1,0]
v_pk_mul_f32 v[190:191], v[190:191], v[6:7] op_sel:[0,0] op_sel_hi:[1,0]
v_cvt_pk_bf16_f32 v100, v184, v185
v_mfma_f32_16x16x32_bf16 a[132:135], v[62:65], v[32:35], a[132:135]
v_mfma_f32_16x16x32_bf16 a[120:123], v[50:53], v[32:35], a[120:123]
v_cvt_pk_bf16_f32 v102, v188, v189
v_cvt_pk_bf16_f32 v101, v186, v187
v_cvt_pk_bf16_f32 v103, v190, v191
buffer_load_dwordx4 a[60:63], v18, s[64:67], s47 offen offset:1024 sc1
v_mfma_f32_16x16x32_bf16 a[124:127], v[54:57], v[32:35], a[124:127]
v_accvgpr_read_b32 v196, a96
v_accvgpr_read_b32 v200, a100
v_accvgpr_read_b32 v197, a97
v_accvgpr_read_b32 v201, a101
v_mfma_f32_16x16x32_bf16 a[136:139], v[32:35], v[66:69], a[136:139]
v_accvgpr_read_b32 v198, a98
v_accvgpr_read_b32 v202, a102
v_accvgpr_read_b32 v199, a99
v_mfma_f32_16x16x32_bf16 a[140:143], v[32:35], v[70:73], a[140:143]
v_accvgpr_read_b32 v203, a103
v_cvt_pk_bf16_f32 v132, v196, v197
v_cvt_pk_bf16_f32 v134, v200, v201
s_xor_b32 s47, s37, 0x740000
buffer_load_dwordx4 a[64:67], v18, s[64:67], s47 offen offset:0 sc1
v_cvt_pk_bf16_f32 v133, v198, v199
v_cvt_pk_bf16_f32 v135, v202, v203
v_mul_f32 v6, 0x3e8293ee, v6
s_waitcnt lgkmcnt(1)
s_nop 0
v_accvgpr_read_b32 v204, a112
v_accvgpr_read_b32 v192, a116
v_accvgpr_read_b32 v205, a113
v_accvgpr_read_b32 v193, a117
v_accvgpr_read_b32 v206, a114
v_accvgpr_read_b32 v194, a118
v_accvgpr_read_b32 v207, a115
v_accvgpr_read_b32 v195, a119
v_pk_mul_f32 v[204:205], v[204:205], v[14:15]
buffer_load_dwordx4 a[68:71], v18, s[64:67], s47 offen offset:1024 sc1
v_pk_mul_f32 v[192:193], v[192:193], v[14:15]
v_pk_mul_f32 v[206:207], v[206:207], v[16:17]
v_pk_mul_f32 v[194:195], v[194:195], v[16:17]
v_cvt_pk_bf16_f32 v158, v204, v205
v_cvt_pk_bf16_f32 v176, v192, v193
v_cvt_pk_bf16_f32 v159, v206, v207
v_cvt_pk_bf16_f32 v177, v194, v195
v_accvgpr_read_b32 v184, a128
v_accvgpr_read_b32 v188, a132
ds_read_b128 v[14:17], v19 offset:448
v_accvgpr_read_b32 v185, a129
v_accvgpr_read_b32 v189, a133
v_accvgpr_read_b32 v186, a130
s_xor_b32 s47, s37, 0x840000
buffer_load_dwordx4 a[72:75], v18, s[64:67], s47 offen offset:0 sc1
v_mfma_f32_16x16x32_bf16 v[216:219], v[58:61], v[34:37], v[216:219]
v_accvgpr_read_b32 v190, a134
v_accvgpr_read_b32 v187, a131
v_accvgpr_read_b32 v191, a135
v_pk_mul_f32 v[184:185], v[184:185], v[6:7] op_sel:[0,1] op_sel_hi:[1,1]
v_pk_mul_f32 v[188:189], v[188:189], v[6:7] op_sel:[0,1] op_sel_hi:[1,1]
v_pk_mul_f32 v[186:187], v[186:187], v[6:7] op_sel:[0,1] op_sel_hi:[1,1]
v_pk_mul_f32 v[190:191], v[190:191], v[6:7] op_sel:[0,1] op_sel_hi:[1,1]
v_cvt_pk_bf16_f32 v104, v184, v185
buffer_load_dwordx4 v[80:83], v18, s[20:23], s51 offen sc1
v_mfma_f32_16x16x32_bf16 v[220:223], v[62:65], v[34:37], v[220:223]
v_mfma_f32_16x16x32_bf16 v[208:211], v[50:53], v[34:37], v[208:211]
buffer_load_dwordx2 v[148:149], v79, s[20:23], s51 offen offset:1024 sc1
v_cvt_pk_bf16_f32 v106, v188, v189
v_cvt_pk_bf16_f32 v105, v186, v187
buffer_load_dwordx4 a[76:79], v18, s[64:67], s47 offen offset:1024 sc1
v_cvt_pk_bf16_f32 v107, v190, v191
buffer_load_dwordx2 v[166:167], v79, s[20:23], s51 offen offset:1536 sc1
v_mfma_f32_16x16x32_bf16 v[212:215], v[54:57], v[34:37], v[212:215]
v_accvgpr_read_b32 v196, a120
v_accvgpr_read_b32 v200, a124
v_accvgpr_read_b32 v197, a121
v_accvgpr_read_b32 v201, a125
v_mfma_f32_16x16x32_bf16 v[224:227], v[34:37], v[66:69], v[224:227]
v_accvgpr_read_b32 v198, a122
v_accvgpr_read_b32 v202, a126
v_accvgpr_read_b32 v199, a123
v_mfma_f32_16x16x32_bf16 v[228:231], v[34:37], v[70:73], v[228:231]
v_accvgpr_read_b32 v203, a127
v_cvt_pk_bf16_f32 v136, v196, v197
s_xor_b32 s47, s37, 0x240000
buffer_load_dwordx4 a[80:83], v18, s[64:67], s47 offen offset:0 sc1
v_cvt_pk_bf16_f32 v138, v200, v201
v_cvt_pk_bf16_f32 v137, v198, v199
v_cvt_pk_bf16_f32 v139, v202, v203
v_mul_f32 v7, 0x3e8293ee, v7
s_waitcnt lgkmcnt(1)
s_nop 0
v_accvgpr_read_b32 v204, a136
v_accvgpr_read_b32 v192, a140
v_accvgpr_read_b32 v205, a137
v_accvgpr_read_b32 v193, a141
v_accvgpr_read_b32 v206, a138
v_accvgpr_read_b32 v194, a142
v_accvgpr_read_b32 v207, a139
v_accvgpr_read_b32 v195, a143
buffer_load_dwordx4 a[84:87], v18, s[64:67], s47 offen offset:1024 sc1
v_pk_mul_f32 v[204:205], v[204:205], v[10:11]
v_pk_mul_f32 v[192:193], v[192:193], v[10:11]
v_pk_mul_f32 v[206:207], v[206:207], v[12:13]
v_pk_mul_f32 v[194:195], v[194:195], v[12:13]
v_cvt_pk_bf16_f32 v160, v204, v205
v_cvt_pk_bf16_f32 v178, v192, v193
v_cvt_pk_bf16_f32 v161, v206, v207
v_cvt_pk_bf16_f32 v179, v194, v195
v_pk_mul_f32 v[216:217], v[216:217], v[8:9] op_sel:[0,0] op_sel_hi:[1,0]
v_pk_mul_f32 v[220:221], v[220:221], v[8:9] op_sel:[0,0] op_sel_hi:[1,0]
v_pk_mul_f32 v[218:219], v[218:219], v[8:9] op_sel:[0,0] op_sel_hi:[1,0]
v_pk_mul_f32 v[222:223], v[222:223], v[8:9] op_sel:[0,0] op_sel_hi:[1,0]
v_cvt_pk_bf16_f32 v108, v216, v217
s_xor_b32 s47, s37, 0x2c0000
buffer_load_dwordx4 a[88:91], v18, s[64:67], s47 offen offset:0 sc1
v_cvt_pk_bf16_f32 v110, v220, v221
v_cvt_pk_bf16_f32 v109, v218, v219
v_cvt_pk_bf16_f32 v111, v222, v223
v_cvt_pk_bf16_f32 v140, v208, v209
v_cvt_pk_bf16_f32 v142, v212, v213
v_cvt_pk_bf16_f32 v141, v210, v211
v_cvt_pk_bf16_f32 v143, v214, v215
v_mul_f32 v8, 0x3e8293ee, v8
s_waitcnt lgkmcnt(0)
s_nop 0
v_pk_mul_f32 v[224:225], v[224:225], v[14:15]
v_pk_mul_f32 v[228:229], v[228:229], v[14:15]
v_pk_mul_f32 v[226:227], v[226:227], v[16:17]
v_pk_mul_f32 v[230:231], v[230:231], v[16:17]
buffer_load_dwordx4 a[92:95], v18, s[64:67], s47 offen offset:1024 sc1
v_cvt_pk_bf16_f32 v162, v224, v225
v_cvt_pk_bf16_f32 v180, v228, v229
v_cvt_pk_bf16_f32 v163, v226, v227
v_cvt_pk_bf16_f32 v181, v230, v231
v_and_b32 v74, 15, v0
v_lshrrev_b32 v75, 4, v0
v_lshlrev_b32 v75, 2, v75
v_sub_u32 v74, v74, v75
v_mov_b32 v77, 0xf149f2ca
s_mov_b32 s42, 0x80000001
s_brev_b32 s41, 1
v_subrev_u32 v75, 0, v74
v_and_b32_e64 v75, s42, v75
s_xor_b32 s47, s37, 0x340000
buffer_load_dwordx4 a[96:99], v18, s[64:67], s47 offen offset:0 sc1
v_cmp_eq_u32 vcc, 0, v75
s_nop 1
v_cndmask_b32 v228, v77, 0, vcc
v_cmp_eq_u32 vcc, s41, v75
s_nop 1
v_cndmask_b32 v224, v77, 0, vcc
v_subrev_u32 v75, 1, v74
v_and_b32 v75, s42, v75
v_cmp_eq_u32 vcc, 0, v75
s_nop 1
v_cndmask_b32 v229, v77, 0, vcc
v_cmp_eq_u32 vcc, s41, v75
s_nop 1
v_cndmask_b32 v225, v77, 0, vcc
v_subrev_u32 v75, 2, v74
v_and_b32 v75, s42, v75
v_cmp_eq_u32 vcc, 0, v75
s_nop 1
v_cndmask_b32 v230, v77, 0, vcc
buffer_load_dwordx4 a[100:103], v18, s[64:67], s47 offen offset:1024 sc1
v_cmp_eq_u32 vcc, s41, v75
s_nop 1
v_cndmask_b32 v226, v77, 0, vcc
v_subrev_u32 v75, 3, v74
v_and_b32 v75, s42, v75
v_cmp_eq_u32 vcc, 0, v75
s_nop 1
v_cndmask_b32 v231, v77, 0, vcc
v_cmp_eq_u32 vcc, s41, v75
s_nop 1
v_cndmask_b32 v227, v77, 0, vcc
s_cmp_eq_u32 s44, 0
s_cselect_b64 vcc, -1, 0
v_cndmask_b32 v232, v224, v77, vcc
v_cndmask_b32 v233, v225, v77, vcc
v_cndmask_b32 v234, v226, v77, vcc
v_cndmask_b32 v235, v227, v77, vcc
s_xor_b32 s47, s37, 0x3c0000
buffer_load_dwordx4 a[104:107], v18, s[64:67], s47 offen offset:0 sc1
v_cvt_pk_bf16_f32 v40, v224, v225
v_cvt_pk_bf16_f32 v41, v226, v227
v_cvt_pk_bf16_f32 v42, v228, v229
v_cvt_pk_bf16_f32 v43, v230, v231
v_mov_b32 v44, 0x3f803f80
v_pk_ashrrev_i16 v40, 15, v40 op_sel_hi:[0,1]
v_mov_b32 v45, 0x3f803f80
v_pk_ashrrev_i16 v41, 15, v41 op_sel_hi:[0,1]
v_mov_b32 v46, 0x3f803f80
v_pk_ashrrev_i16 v42, 15, v42 op_sel_hi:[0,1]
v_mov_b32 v47, 0x3f803f80
buffer_load_dwordx4 a[108:111], v18, s[64:67], s47 offen offset:1024 sc1
v_pk_ashrrev_i16 v43, 15, v43 op_sel_hi:[0,1]
s_nop 1
v_mfma_f32_16x16x32_bf16 v[184:187], v[84:87], v[120:123], v[224:227]
v_mfma_f32_16x16x32_bf16 v[188:191], v[88:91], v[120:123], v[228:231]
s_nop 6
v_max_f32 v202, v184, v185
v_max_f32 v203, v186, v187
v_max3_f32 v202, v202, v188, v189
v_max3_f32 v203, v203, v190, v191
v_xor_b32_e64 v76, s35, v18
v_and_b32 v78, 0x3c0, v76
v_add_u32 v76, v76, v78
v_mov_b32 v78, 2
s_mov_b32 exec_lo, 0xf
s_mov_b32 exec_hi, 0xf
buffer_load_dword v78, v76, s[16:19], s73 offen sc1
s_mov_b64 exec, -1
v_max_f32 v200, v202, v203
v_max_f32_e64 v201, v202, v203
v_mfma_f32_16x16x32_bf16 v[204:207], v[88:91], v[124:127], v[224:227]
s_nop 0
v_permlane16_swap_b32 v200, v201
v_max_f32_e64 v184, v200, v201
v_mfma_f32_16x16x32_bf16 v[208:211], v[92:95], v[124:127], v[228:231]
s_xor_b32 s47, s37, 0x600000
buffer_load_dwordx4 a[112:115], v18, s[64:67], s47 offen offset:0 sc1
v_max_f32 v201, v200, v201
s_nop 1
v_permlane32_swap_b32 v184, v201
v_max_f32 v200, v184, v201
v_pk_add_f32 v[202:203], v[202:203], v[200:201] op_sel_hi:[1,0] neg_lo:[0,1] neg_hi:[0,1]
v_max_f32_e64 v222, v204, v205
v_pk_mul_f32 v[202:203], v[202:203], v[2:3] op_sel:[0,1] op_sel_hi:[1,1]
v_max_f32 v223, v206, v207
v_exp_f32 v202, v202
v_max3_f32 v222, v222, v208, v209
v_exp_f32_e64 v203, v203
v_max3_f32 v223, v223, v210, v211
v_cvt_pk_bf16_f32 v202, v202, v202
v_max_f32_e64 v220, v222, v223
buffer_load_dwordx4 a[116:119], v18, s[64:67], s47 offen offset:1024 sc1
v_cvt_pk_bf16_f32 v203, v203, v203
v_max_f32_e64 v221, v222, v223
v_bfi_b32 v192, v40, 0, v202
s_nop 0
v_permlane16_swap_b32 v220, v221
v_mfma_f32_16x16x32_bf16 v[20:23], v[92:95], v[128:131], v[224:227]
v_bfi_b32 v193, v41, 0, v203
v_max_f32_e64 v204, v220, v221
v_bfi_b32 v194, v42, 0, v202
v_max_f32_e64 v221, v220, v221
v_mfma_f32_16x16x32_bf16 v[24:27], v[96:99], v[128:131], v[228:231]
v_bfi_b32 v195, v43, 0, v203
v_permlane32_swap_b32 v204, v221
v_max_f32 v220, v204, v221
s_xor_b32 s47, s37, 0x680000
buffer_load_dwordx4 a[120:123], v18, s[64:67], s47 offen offset:0 sc1
v_mfma_f32_16x16x32_bf16 v[196:199], v[44:47], v[192:195], 0
v_pk_add_f32 v[222:223], v[222:223], v[220:221] op_sel_hi:[1,0] neg_lo:[0,1] neg_hi:[0,1]
v_pk_mul_f32 v[222:223], v[222:223], v[4:5] op_sel:[0,0] op_sel_hi:[1,0]
v_max_f32_e64 v38, v20, v21
v_mfma_f32_16x16x32_bf16 v[184:187], v[150:153], v[192:195], 0
v_exp_f32 v222, v222
v_max_f32 v39, v22, v23
v_exp_f32_e64 v223, v223
v_max3_f32 v38, v38, v24, v25
v_mfma_f32_16x16x32_bf16 v[188:191], v[168:171], v[192:195], 0
v_cvt_pk_bf16_f32 v222, v222, v222
v_max3_f32 v39, v39, v26, v27
s_add_u32 s40, s53, 1024
buffer_load_dwordx4 a[124:127], v18, s[64:67], s47 offen offset:1024 sc1
v_cvt_pk_bf16_f32 v223, v223, v223
v_max_f32_e64 v36, v38, v39
v_bfi_b32 v212, v40, 0, v222
v_max_f32 v37, v38, v39
v_rcp_f32 v200, v196
v_bfi_b32 v213, v41, 0, v223
v_permlane16_swap_b32 v36, v37
v_mfma_f32_16x16x32_bf16 v[48:51], v[96:99], v[132:135], v[224:227]
v_bfi_b32 v214, v42, 0, v222
v_max_f32 v20, v36, v37
v_pk_mul_f32 v[184:185], v[184:185], v[200:201] op_sel:[0,0] op_sel_hi:[1,0]
v_bfi_b32 v215, v43, 0, v223
v_max_f32_e64 v37, v36, v37
v_mfma_f32_16x16x32_bf16 v[52:55], v[100:103], v[132:135], v[228:231]
v_pk_mul_f32 v[186:187], v[186:187], v[200:201] op_sel:[0,0] op_sel_hi:[1,0]
v_permlane32_swap_b32 v20, v37
v_pk_mul_f32 v[188:189], v[188:189], v[200:201] op_sel:[0,0] op_sel_hi:[1,0]
s_nop 1
v_mfma_f32_16x16x32_bf16 v[216:219], v[44:47], v[212:215], 0
v_max_f32_e64 v36, v20, v37
v_pk_mul_f32 v[190:191], v[190:191], v[200:201] op_sel:[0,0] op_sel_hi:[1,0]
v_pk_add_f32 v[38:39], v[38:39], v[36:37] op_sel_hi:[1,0] neg_lo:[0,1] neg_hi:[0,1]
v_cvt_pk_bf16_f32 v192, v184, v185
v_mfma_f32_16x16x32_bf16 v[204:207], v[152:155], v[212:215], 0
v_pk_mul_f32 v[38:39], v[38:39], v[4:5] op_sel:[0,1] op_sel_hi:[1,1]
v_max_f32_e64 v66, v48, v49
v_cvt_pk_bf16_f32 v194, v188, v189
v_exp_f32 v38, v38
v_max_f32 v67, v50, v51
v_cvt_pk_bf16_f32 v193, v186, v187
v_mfma_f32_16x16x32_bf16 v[208:211], v[170:173], v[212:215], 0
v_exp_f32_e64 v39, v39
v_max3_f32 v66, v66, v52, v53
v_cvt_pk_bf16_f32 v195, v190, v191
s_add_u32 s41, s53, 2048
v_cvt_pk_bf16_f32 v38, v38, v38
v_max3_f32 v67, v67, v54, v55
buffer_store_dwordx4 v[192:195], v18, s[20:23], s40 offen sc1
v_cvt_pk_bf16_f32 v39, v39, v39
v_max_f32_e64 v64, v66, v67
v_mfma_f32_16x16x32_bf16 v[184:187], v[100:103], v[136:139], v[224:227]
v_rcp_f32_e64 v220, v216
v_bfi_b32 v28, v40, 0, v38
v_max_f32_e64 v65, v66, v67
v_bfi_b32 v29, v41, 0, v39
s_nop 0
v_permlane16_swap_b32 v64, v65
v_mfma_f32_16x16x32_bf16 v[188:191], v[104:107], v[136:139], v[228:231]
v_pk_mul_f32 v[204:205], v[204:205], v[220:221] op_sel:[0,0] op_sel_hi:[1,0]
v_bfi_b32 v30, v42, 0, v38
v_max_f32_e64 v48, v64, v65
v_pk_mul_f32 v[206:207], v[206:207], v[220:221] op_sel:[0,0] op_sel_hi:[1,0]
v_bfi_b32 v31, v43, 0, v39
v_max_f32_e64 v65, v64, v65
v_pk_mul_f32 v[208:209], v[208:209], v[220:221] op_sel:[0,0] op_sel_hi:[1,0]
s_nop 0
v_permlane32_swap_b32 v48, v65
v_pk_mul_f32 v[210:211], v[210:211], v[220:221] op_sel:[0,0] op_sel_hi:[1,0]
s_nop 1
v_mfma_f32_16x16x32_bf16 v[32:35], v[44:47], v[28:31], 0
v_max_f32 v64, v48, v65
v_max_f32_e64 v202, v184, v185
v_cvt_pk_bf16_f32 v212, v204, v205
v_pk_add_f32 v[66:67], v[66:67], v[64:65] op_sel_hi:[1,0] neg_lo:[0,1] neg_hi:[0,1]
v_max_f32_e64 v203, v186, v187
v_cvt_pk_bf16_f32 v214, v208, v209
v_mfma_f32_16x16x32_bf16 v[20:23], v[154:157], v[28:31], 0
v_pk_mul_f32 v[66:67], v[66:67], v[6:7] op_sel:[0,0] op_sel_hi:[1,0]
v_max3_f32 v202, v202, v188, v189
v_cvt_pk_bf16_f32 v213, v206, v207
v_exp_f32_e64 v66, v66
v_max3_f32 v203, v203, v190, v191
v_cvt_pk_bf16_f32 v215, v210, v211
v_mfma_f32_16x16x32_bf16 v[24:27], v[172:175], v[28:31], 0
v_exp_f32 v67, v67
v_max_f32 v200, v202, v203
buffer_store_dwordx4 v[212:215], v18, s[20:23], s41 offen sc1
s_add_u32 s42, s53, 3072
v_cvt_pk_bf16_f32 v66, v66, v66
v_max_f32_e64 v201, v202, v203
v_mfma_f32_16x16x32_bf16 v[204:207], v[104:107], v[140:143], v[224:227]
v_cvt_pk_bf16_f32 v67, v67, v67
v_permlane16_swap_b32 v200, v201
v_rcp_f32 v36, v32
v_bfi_b32 v56, v40, 0, v66
v_max_f32_e64 v184, v200, v201
v_mfma_f32_16x16x32_bf16 v[208:211], v[108:111], v[140:143], v[228:231]
v_bfi_b32 v57, v41, 0, v67
v_max_f32_e64 v201, v200, v201
v_pk_mul_f32 v[20:21], v[20:21], v[36:37] op_sel:[0,0] op_sel_hi:[1,0]
v_bfi_b32 v58, v42, 0, v66
v_permlane32_swap_b32 v184, v201
v_pk_mul_f32 v[22:23], v[22:23], v[36:37] op_sel:[0,0] op_sel_hi:[1,0]
v_bfi_b32 v59, v43, 0, v67
v_max_f32 v200, v184, v201
v_pk_mul_f32 v[24:25], v[24:25], v[36:37] op_sel:[0,0] op_sel_hi:[1,0]
v_pk_add_f32 v[202:203], v[202:203], v[200:201] op_sel_hi:[1,0] neg_lo:[0,1] neg_hi:[0,1]
v_max_f32_e64 v222, v204, v205
v_pk_mul_f32 v[26:27], v[26:27], v[36:37] op_sel:[0,0] op_sel_hi:[1,0]
s_nop 1
v_mfma_f32_16x16x32_bf16 v[60:63], v[44:47], v[56:59], 0
v_pk_mul_f32 v[202:203], v[202:203], v[6:7] op_sel:[0,1] op_sel_hi:[1,1]
v_max_f32 v223, v206, v207
v_cvt_pk_bf16_f32 v28, v20, v21
v_exp_f32_e64 v202, v202
v_max3_f32 v222, v222, v208, v209
v_cvt_pk_bf16_f32 v30, v24, v25
v_mfma_f32_16x16x32_bf16 v[48:51], v[156:159], v[56:59], 0
v_exp_f32_e64 v203, v203
v_max3_f32 v223, v223, v210, v211
v_cvt_pk_bf16_f32 v29, v22, v23
v_cvt_pk_bf16_f32 v202, v202, v202
v_max_f32_e64 v220, v222, v223
v_cvt_pk_bf16_f32 v31, v26, v27
v_mfma_f32_16x16x32_bf16 v[52:55], v[174:177], v[56:59], 0
v_cvt_pk_bf16_f32 v203, v203, v203
v_max_f32_e64 v221, v222, v223
buffer_store_dwordx4 v[28:31], v18, s[20:23], s42 offen sc1
s_add_u32 s55, s53, 4096
v_bfi_b32 v192, v40, 0, v202
v_permlane16_swap_b32 v220, v221
v_mfma_f32_16x16x32_bf16 v[20:23], v[108:111], v[144:147], v[224:227]
v_bfi_b32 v193, v41, 0, v203
v_max_f32 v204, v220, v221
v_rcp_f32_e64 v64, v60
v_bfi_b32 v194, v42, 0, v202
v_max_f32_e64 v221, v220, v221
v_mfma_f32_16x16x32_bf16 v[24:27], v[112:115], v[144:147], v[228:231]
v_bfi_b32 v195, v43, 0, v203
v_permlane32_swap_b32 v204, v221
v_pk_mul_f32 v[48:49], v[48:49], v[64:65] op_sel:[0,0] op_sel_hi:[1,0]
v_max_f32 v220, v204, v221
v_pk_mul_f32 v[50:51], v[50:51], v[64:65] op_sel:[0,0] op_sel_hi:[1,0]
s_nop 1
v_mfma_f32_16x16x32_bf16 v[196:199], v[44:47], v[192:195], 0
s_waitcnt vmcnt(7)
v_cmp_gt_u32 vcc, 1, v78
s_nop 0
s_cmp_lg_u32 vcc_hi, 0
s_cselect_b32 s62, 0, 0x1200000
v_pk_add_f32 v[222:223], v[222:223], v[220:221] op_sel_hi:[1,0] neg_lo:[0,1] neg_hi:[0,1]
s_add_u32 m0, s39, 0
s_xor_b32 s46, s32, 0xc00000
buffer_load_dwordx4 v18, s[60:63], s46 offen offset:0 sc1 lds
v_pk_mul_f32 v[52:53], v[52:53], v[64:65] op_sel:[0,0] op_sel_hi:[1,0]
v_pk_mul_f32 v[222:223], v[222:223], v[8:9] op_sel:[0,0] op_sel_hi:[1,0]
v_max_f32_e64 v38, v20, v21
v_pk_mul_f32 v[54:55], v[54:55], v[64:65] op_sel:[0,0] op_sel_hi:[1,0]
s_nop 1
v_mfma_f32_16x16x32_bf16 v[184:187], v[158:161], v[192:195], 0
v_exp_f32 v222, v222
v_max_f32_e64 v39, v22, v23
buffer_load_dwordx4 v18, s[60:63], s46 offen offset:1024 sc1 lds
v_cvt_pk_bf16_f32 v56, v48, v49
v_exp_f32_e64 v223, v223
v_max3_f32 v38, v38, v24, v25
v_cvt_pk_bf16_f32 v58, v52, v53
v_mfma_f32_16x16x32_bf16 v[188:191], v[176:179], v[192:195], 0
v_cvt_pk_bf16_f32 v222, v222, v222
v_max3_f32 v39, v39, v26, v27
v_cvt_pk_bf16_f32 v57, v50, v51
buffer_load_dwordx4 v18, s[60:63], s46 offen offset:2048 sc1 lds
s_add_u32 s40, s53, 5120
v_cvt_pk_bf16_f32 v223, v223, v223
v_max_f32_e64 v36, v38, v39
v_cvt_pk_bf16_f32 v59, v54, v55
v_bfi_b32 v212, v40, 0, v222
v_max_f32_e64 v37, v38, v39
buffer_store_dwordx4 v[56:59], v18, s[20:23], s55 offen sc1
v_rcp_f32_e64 v200, v196
buffer_load_dwordx4 v18, s[60:63], s46 offen offset:3072 sc1 lds
v_bfi_b32 v213, v41, 0, v223
v_permlane16_swap_b32 v36, v37
s_waitcnt vmcnt(21)
v_max3_u32 v239, v80, v81, v82
v_max3_u32 v238, v83, v148, v149
v_max3_u32 v239, v239, v166, v167
v_max_u32 v239, v239, v238
v_cmp_eq_u32 vcc, -1, v239
s_nop 0
s_cmp_lg_u64 vcc, 0
s_cbranch_scc1 L_h_sp_1020
L_h_ok_1021:
v_bfi_b32 v214, v42, 0, v222
v_max_f32 v20, v36, v37
v_mfma_f32_16x16x32_bf16 v[48:51], v[80:83], v[116:119], v[232:235]
v_pk_mul_f32 v[184:185], v[184:185], v[200:201] op_sel:[0,0] op_sel_hi:[1,0]
v_bfi_b32 v215, v43, 0, v223
s_add_u32 m0, s39, 16384
s_xor_b32 s46, s32, 0xe00000
buffer_load_dwordx4 v18, s[60:63], s46 offen offset:0 sc1 lds
v_max_f32_e64 v37, v36, v37
v_pk_mul_f32 v[186:187], v[186:187], v[200:201] op_sel:[0,0] op_sel_hi:[1,0]
s_nop 0
v_permlane32_swap_b32 v20, v37
v_mfma_f32_16x16x32_bf16 v[52:55], v[84:87], v[116:119], v[228:231]
v_pk_mul_f32 v[188:189], v[188:189], v[200:201] op_sel:[0,0] op_sel_hi:[1,0]
s_nop 1
v_mfma_f32_16x16x32_bf16 v[216:219], v[44:47], v[212:215], 0
v_max_f32 v36, v20, v37
v_pk_mul_f32 v[190:191], v[190:191], v[200:201] op_sel:[0,0] op_sel_hi:[1,0]
buffer_load_dwordx4 v18, s[60:63], s46 offen offset:1024 sc1 lds
v_pk_add_f32 v[38:39], v[38:39], v[36:37] op_sel_hi:[1,0] neg_lo:[0,1] neg_hi:[0,1]
v_cvt_pk_bf16_f32 v192, v184, v185
v_mfma_f32_16x16x32_bf16 v[204:207], v[160:163], v[212:215], 0
v_pk_mul_f32 v[38:39], v[38:39], v[8:9] op_sel:[0,1] op_sel_hi:[1,1]
v_cvt_pk_bf16_f32 v194, v188, v189
v_exp_f32 v38, v38
v_max_f32 v66, v48, v49
v_cvt_pk_bf16_f32 v193, v186, v187
buffer_load_dwordx4 v18, s[60:63], s46 offen offset:2048 sc1 lds
v_mfma_f32_16x16x32_bf16 v[208:211], v[178:181], v[212:215], 0
v_exp_f32 v39, v39
v_max_f32 v67, v50, v51
v_cvt_pk_bf16_f32 v195, v190, v191
s_add_u32 s41, s53, 6144
v_cvt_pk_bf16_f32 v38, v38, v38
v_max3_f32 v66, v66, v52, v53
buffer_store_dwordx4 v[192:195], v18, s[20:23], s40 offen sc1
buffer_load_dwordx4 v18, s[60:63], s46 offen offset:3072 sc1 lds
v_cvt_pk_bf16_f32 v39, v39, v39
v_max3_f32 v67, v67, v54, v55
v_rcp_f32_e64 v220, v216
v_bfi_b32 v28, v40, 0, v38
v_max_f32_e64 v64, v66, v67
v_bfi_b32 v29, v41, 0, v39
v_max_f32_e64 v65, v66, v67
v_pk_mul_f32 v[204:205], v[204:205], v[220:221] op_sel:[0,0] op_sel_hi:[1,0]
v_bfi_b32 v30, v42, 0, v38
v_permlane16_swap_b32 v64, v65
v_pk_mul_f32 v[206:207], v[206:207], v[220:221] op_sel:[0,0] op_sel_hi:[1,0]
v_bfi_b32 v31, v43, 0, v39
v_max_f32 v48, v64, v65
v_pk_mul_f32 v[208:209], v[208:209], v[220:221] op_sel:[0,0] op_sel_hi:[1,0]
v_max_f32_e64 v65, v64, v65
v_pk_mul_f32 v[210:211], v[210:211], v[220:221] op_sel:[0,0] op_sel_hi:[1,0]
s_nop 1
v_mfma_f32_16x16x32_bf16 v[32:35], v[44:47], v[28:31], 0
v_permlane32_swap_b32 v48, v65
v_cvt_pk_bf16_f32 v212, v204, v205
v_max_f32_e64 v64, v48, v65
v_cvt_pk_bf16_f32 v214, v208, v209
v_mfma_f32_16x16x32_bf16 v[20:23], v[162:165], v[28:31], 0
v_pk_add_f32 v[66:67], v[66:67], v[64:65] op_sel_hi:[1,0] neg_lo:[0,1] neg_hi:[0,1]
v_cvt_pk_bf16_f32 v213, v206, v207
v_pk_mul_f32 v[66:67], v[66:67], v[2:3] op_sel:[0,0] op_sel_hi:[1,0]
v_cvt_pk_bf16_f32 v215, v210, v211
v_mfma_f32_16x16x32_bf16 v[24:27], v[180:183], v[28:31], 0
v_exp_f32_e64 v66, v66
buffer_store_dwordx4 v[212:215], v18, s[20:23], s41 offen sc1
s_add_u32 s42, s53, 7168
v_exp_f32_e64 v67, v67
v_cvt_pk_bf16_f32 v66, v66, v66
v_rcp_f32_e64 v36, v32
v_cvt_pk_bf16_f32 v67, v67, v67
v_bfi_b32 v56, v40, 0, v66
v_pk_mul_f32 v[20:21], v[20:21], v[36:37] op_sel:[0,0] op_sel_hi:[1,0]
v_bfi_b32 v57, v41, 0, v67
v_pk_mul_f32 v[22:23], v[22:23], v[36:37] op_sel:[0,0] op_sel_hi:[1,0]
v_bfi_b32 v58, v42, 0, v66
v_pk_mul_f32 v[24:25], v[24:25], v[36:37] op_sel:[0,0] op_sel_hi:[1,0]
v_bfi_b32 v59, v43, 0, v67
v_pk_mul_f32 v[26:27], v[26:27], v[36:37] op_sel:[0,0] op_sel_hi:[1,0]
v_cvt_pk_bf16_f32 v28, v20, v21
v_mfma_f32_16x16x32_bf16 v[60:63], v[44:47], v[56:59], 0
v_cvt_pk_bf16_f32 v30, v24, v25
v_cvt_pk_bf16_f32 v29, v22, v23
v_mfma_f32_16x16x32_bf16 v[48:51], v[148:151], v[56:59], 0
v_cvt_pk_bf16_f32 v31, v26, v27
buffer_store_dwordx4 v[28:31], v18, s[20:23], s42 offen sc1
v_mfma_f32_16x16x32_bf16 v[52:55], v[166:169], v[56:59], 0
s_add_u32 s55, s53, 0
s_nop 0
v_rcp_f32 v64, v60
s_nop 1
v_pk_mul_f32 v[48:49], v[48:49], v[64:65] op_sel:[0,0] op_sel_hi:[1,0]
v_pk_mul_f32 v[50:51], v[50:51], v[64:65] op_sel:[0,0] op_sel_hi:[1,0]
s_nop 0
s_nop 0
v_pk_mul_f32 v[52:53], v[52:53], v[64:65] op_sel:[0,0] op_sel_hi:[1,0]
v_pk_mul_f32 v[54:55], v[54:55], v[64:65] op_sel:[0,0] op_sel_hi:[1,0]
v_cvt_pk_bf16_f32 v56, v48, v49
v_cvt_pk_bf16_f32 v58, v52, v53
v_cvt_pk_bf16_f32 v57, v50, v51
v_cvt_pk_bf16_f32 v59, v54, v55
buffer_store_dwordx4 v[56:59], v18, s[20:23], s55 offen sc1
s_branch L_g1_fin_1002
s_nop 7
s_nop 7
L_g1_sig_1013:
v_mov_b32 v74, 1
v_mov_b32 v75, 0
s_mov_b64 exec, 1
buffer_atomic_add v74, v75, s[28:31], s51 offen sc1
s_mov_b64 exec, -1
s_branch L_g1_sgr_1014
L_g1_pl_1015:
v_lshlrev_b32_e64 v74, 2, v0
s_mov_b32 m0, 162368
s_mov_b64 exec, 0xff
buffer_load_dword v74, s[28:31], 0 offen sc1 lds
s_mov_b64 exec, -1
s_branch L_g1_plr_1016
L_g1_cs_1019:
s_cmp_lt_u32 s49, 32
s_cbranch_scc1 L_g1_spin_1018
buffer_load_dwordx4 v[40:43], v9, s[24:27], s53 offen offset:0 sc1
buffer_load_dwordx4 v[44:47], v9, s[24:27], s53 offen offset:16 sc1
buffer_load_dwordx4 v[48:51], v9, s[24:27], s53 offen offset:32 sc1
s_waitcnt vmcnt(0)
s_nop 0
v_min3_u32 v74, v40, v41, v42
v_min3_u32 v75, v43, v44, v45
v_min3_u32 v74, v74, v46, v47
v_min3_u32 v75, v75, v48, v49
v_min3_u32 v74, v74, v50, v51
v_min_u32_e64 v74, v74, v75
v_cmp_eq_u32 vcc, 0, v74
s_nop 0
s_and_b32 s40, vcc_lo, 0xffff
s_cbranch_scc1 L_g1_cs_1019
s_branch L_g1_ok_1017
L_g1_spin_1018:
s_sleep 4
v_min_u32 v76, 7, v0
v_lshlrev_b32_e64 v76, 2, v76
buffer_load_dword v74, v76, s[28:31], 0 offen sc1
s_waitcnt vmcnt(0)
v_cmp_gt_u32 vcc, 32, v74
s_nop 0
s_cmp_eq_u64 vcc, 0
s_cselect_b32 s49, 32, 0
s_nop 1
s_cmp_lt_u32 s49, 32
s_cbranch_scc1 L_g1_spin_1018
v_and_b32 v76, 15, v0
v_lshlrev_b32 v76, 3, v76
s_add_u32 s52, s44, 0
s_lshl_b32 s52, s52, 3
buffer_load_dwordx2 v[22:23], v76, s[24:27], s52 offen offset:0 sc1
buffer_load_dwordx2 v[24:25], v76, s[24:27], s52 offen offset:128 sc1
buffer_load_dwordx2 v[26:27], v76, s[24:27], s52 offen offset:256 sc1
buffer_load_dwordx2 v[28:29], v76, s[24:27], s52 offen offset:384 sc1
buffer_load_dwordx2 v[30:31], v76, s[24:27], s52 offen offset:512 sc1
buffer_load_dwordx2 v[32:33], v76, s[24:27], s52 offen offset:640 sc1
buffer_load_dwordx2 v[34:35], v76, s[24:27], s52 offen offset:768 sc1
buffer_load_dwordx2 v[36:37], v76, s[24:27], s52 offen offset:896 sc1
s_bfe_u32 s53, s2, 0x20003
s_lshl2_add_u32 s53, s3, s53
s_lshl1_add_u32 s53, s53, s58
s_mul_i32 s53, s53, 768
s_add_u32 s53, s53, 16384
buffer_load_dwordx4 v[40:43], v9, s[24:27], s53 offen offset:0 sc1
buffer_load_dwordx4 v[44:47], v9, s[24:27], s53 offen offset:16 sc1
buffer_load_dwordx4 v[48:51], v9, s[24:27], s53 offen offset:32 sc1
s_waitcnt vmcnt(0)
s_nop 0
v_min3_u32 v74, v40, v41, v42
v_min3_u32 v75, v43, v44, v45
v_min3_u32 v74, v74, v46, v47
v_min3_u32 v75, v75, v48, v49
v_min3_u32 v74, v74, v50, v51
v_min_u32_e64 v74, v74, v75
v_cmp_eq_u32 vcc, 0, v74
s_nop 0
s_and_b32 s40, vcc_lo, 0xffff
s_cbranch_scc1 L_g1_spin_1018
s_branch L_g1_ok_1017
L_h_sp_1020:
s_sleep 2
buffer_load_dword v239, off, s[16:19], s50 sc1
s_waitcnt vmcnt(0)
v_readfirstlane_b32 s49, v239
s_nop 0
s_cmp_eq_u32 s49, 0
s_cbranch_scc1 L_h_sp_1020
buffer_load_dwordx4 v[80:83], v18, s[20:23], s51 offen sc1
buffer_load_dwordx2 v[148:149], v79, s[20:23], s51 offen offset:1024 sc1
buffer_load_dwordx2 v[166:167], v79, s[20:23], s51 offen offset:1536 sc1
s_waitcnt vmcnt(0)
s_branch L_h_ok_1021
L_g1_w_1006:
s_lshl4_add_u32 s36, s76, s36
s_bfe_u32 s40, s2, 0x20003
s_lshl2_add_u32 s54, s3, s40
s_lshl3_add_u32 s41, s54, s44
s_lshl1_add_u32 s41, s43, s41
s_lshl_b32 s42, s41, 11
s_lshl_b32 s41, s41, 3
s_mul_i32 s37, s54, 1536
s_mul_i32 s40, s58, 768
s_add_u32 s37, s37, s40
s_lshl2_add_u32 s37, s59, s37
s_add_u32 s37, s37, 16416
s_lshr_b32 s40, s2, 3
v_min_u32 v74, 23, v0
v_mul_u32_u24 v75, 10923, v74
v_lshrrev_b32 v75, 16, v75
v_mul_u32_u24 v76, 6, v75
v_sub_u32_e64 v76, v74, v76
v_lshl_add_u32 v75, v75, 5, s40
v_mul_u32_u24 v75, 6144, v75
v_lshrrev_b32_e64 v77, 1, v76
v_lshl_add_u32 v75, v77, 11, v75
v_and_b32_e64 v76, 1, v76
v_lshl_add_u32 v18, v76, 7, v75
s_mov_b32 s32, s62
s_mov_b32 s33, s63
s_cmp_eq_u32 s58, 0
s_nop 0
s_cselect_b32 s34, 0x600000, 0
s_mul_i32 s47, s3, 786688
s_mov_b32 s35, 0x00020000
s_add_u32 s47, s47, 1572864
s_add_u32 s20, s68, 0x400000
s_addc_u32 s21, s69, 0
s_mov_b32 s22, 0x1300000
s_mov_b32 s23, 0x00020000
s_mov_b32 s24, s68
s_mov_b32 s25, s69
s_mov_b32 s26, 0x20000
s_mov_b32 s27, 0x00020000
s_mov_b32 s28, s70
s_mov_b32 s29, s71
s_mov_b32 s30, 0x100
s_mov_b32 s31, 0x00020000
s_getpc_b64 s[70:71]
L_g1_tp_1022:
s_add_u32 s70, s70, L_pf_tab-L_g1_tp_1022
s_addc_u32 s71, s71, 0
s_and_b32 s55, s2, 1
s_lshl_b32 s55, s55, 5
s_add_u32 s55, s55, s40
s_lshl_b32 s55, s55, 2
s_load_dword s70, s[70:71], s55
v_and_b32 v74, 15, v0
v_lshrrev_b32 v75, 4, v0
v_lshrrev_b32 v76, 1, v74
v_xor_b32 v76, v76, v75
v_lshlrev_b32 v76, 4, v76
v_lshl_add_u32 v77, v74, 7, v76
v_add_u32 v6, 16384, v77
v_xor_b32_e64 v7, 64, v6
v_mov_b32 v78, 0x3f803f80
v_cmp_eq_u32 vcc, 0, v74
s_nop 1
v_cndmask_b32 v76, 0, v78, vcc
s_nop 0
v_accvgpr_write_b32 a152, v76
v_accvgpr_write_b32 a153, v76
v_accvgpr_write_b32 a154, v76
v_accvgpr_write_b32 a155, v76
v_cmp_eq_u32 vcc, 1, v74
s_nop 1
v_cndmask_b32 v76, 0, v78, vcc
s_nop 0
v_accvgpr_write_b32 a156, v76
v_accvgpr_write_b32 a157, v76
v_accvgpr_write_b32 a158, v76
v_accvgpr_write_b32 a159, v76
v_lshrrev_b32 v76, 2, v74
v_lshlrev_b32 v76, 6, v76
v_and_b32_e64 v77, 3, v0
v_lshl_add_u32 v76, v77, 3, v76
v_and_b32_e64 v77, 1, v75
v_lshl_add_u32 v76, v77, 5, v76
s_lshl_b32 s40, s58, 9
s_add_u32 s40, s40, 65536
v_lshl_add_u32 v77, v75, 10, v76
v_add_u32 v10, s40, v77
v_xor_b32_e64 v11, 32, v10
v_add_u32 v12, 40960, v10
v_add_u32 v13, 40960, v11
s_and_b32 s40, s59, 1
s_lshl_b32 s40, s40, 13
s_and_b32 s55, s59, 2
s_lshl_b32 s55, s55, 11
s_add_u32 s40, s40, s55
s_add_u32 s40, s40, 24576
v_add_u32 v8, s40, v11
v_mul_u32_u24 v9, 48, v0
v_bfrev_b32 v76, 2
v_cmp_gt_u32 vcc, 16, v0
s_nop 1
v_cndmask_b32 v9, v76, v9, vcc
s_cmp_lt_u32 s59, 4
s_cselect_b64 vcc, -1, 0
v_cndmask_b32 v5, v76, v9, vcc
v_mov_b32 v74, 0
v_mov_b32 v75, 0
v_mov_b32 v76, 0
v_mov_b32 v77, 0
buffer_store_dword v74, v5, s[24:27], s37 offen sc1
s_lshl_b32 s40, s59, 16
s_lshl_b32 s55, s45, 11
s_add_u32 s40, s40, s55
s_add_u32 s40, s40, 18874368
v_mov_b32 v52, -1
v_mov_b32 v53, -1
v_mov_b32 v54, -1
v_mov_b32_e64 v55, -1
buffer_store_dwordx4 v[52:55], v79, s[20:23], s40 offen offset:0 sc1
buffer_store_dwordx4 v[52:55], v79, s[20:23], s40 offen offset:1024 sc1
s_mov_b32 s54, 0xffff0000
s_mov_b32 s60, s72
s_mov_b32 s61, s73
s_mov_b32 s62, 0x200000
s_mov_b32 s63, 0x00020000
s_add_u32 s64, s68, 0x1800000
s_addc_u32 s65, s69, 0
s_mov_b32 s66, 0x900000
s_mov_b32 s67, 0x00020000
s_lshr_b32 s40, s2, 4
s_lshl_b32 s40, s40, 16
s_and_b32 s69, s2, 15
s_lshl_b32 s68, s69, 7
s_lshl_b32 s69, s69, 12
s_add_u32 s69, s69, s40
s_bfe_u32 s55, s2, 0x30004
s_lshl_b32 s69, s55, 16
s_bfe_u32 s40, s2, 0x30001
s_lshl_b32 s40, s40, 13
s_add_u32 s69, s69, s40
s_and_b32 s66, s69, 0xfff80000
s_add_u32 s66, s66, 0x900000
s_and_b32 s40, s2, 1
s_lshl_b32 s40, s40, 12
s_add_u32 s69, s69, s40
s_lshr_b32 s40, s2, 7
s_lshl_b32 s72, s40, 19
s_add_u32 s69, s69, s72
s_lshl2_add_u32 s40, s55, s40
s_lshl_b32 s40, s40, 16
s_mul_i32 s72, s55, 655360
s_mul_i32 s73, s55, 917504
s_add_u32 s68, s68, s40
s_lshl_b32 s40, s58, 14
s_add_u32 s68, s68, s40
s_add_u32 s68, s68, 8192
s_lshl_b32 s40, s43, 8
s_add_u32 s69, s69, s40
v_lshrrev_b32 v46, 3, v0
v_lshrrev_b32_e64 v47, 5, v0
v_mad_u32_u24 v46, v47, 12, v46
v_and_b32 v47, 7, v0
v_lshlrev_b32 v47, 4, v47
v_lshl_add_u32 v4, v46, 11, v47
v_bfe_u32 v46, v0, 2, 2
v_lshlrev_b32 v46, 7, v46
v_lshrrev_b32 v47, 4, v0
v_lshl_add_u32 v46, v47, 5, v46
v_and_b32_e64 v47, 3, v0
v_lshl_add_u32 v46, v47, 3, v46
s_add_u32 s40, s76, 147456
v_add_u32_e64 v78, s40, v46
s_lshl_b32 s51, s59, 2
s_and_b32 s78, s59, 3
s_cmp_le_u32 s78, 0
s_cselect_b32 s78, 1, 0
s_mul_i32 s53, s78, 229376
s_add_u32 s53, s53, s38
s_mul_i32 s52, s78, 196608
s_add_u32 s52, s52, s39
s_lshr_b32 s46, s78, 1
s_mul_i32 s46, s46, 32768
s_lshl_b32 s78, s78, 12
s_add_u32 s46, s46, s78
s_add_u32 s46, s46, s76
s_add_u32 m0, s46, 65536
s_nop 0
buffer_load_dwordx4 v3, s[16:19], s52 offen nt lds
s_add_u32 m0, s46, 71680
s_nop 0
buffer_load_dwordx4 v3, s[16:19], s52 offen offset:2048 nt lds
s_add_u32 m0, s46, 81920
s_add_u32 s79, s52, 4096
buffer_load_dwordx4 v3, s[16:19], s79 offen nt lds
s_and_b32 s78, s59, 3
s_cmp_le_u32 s78, 1
s_cselect_b32 s78, 2, 1
s_mul_i32 s48, s78, 229376
s_add_u32 s48, s48, s38
s_mul_i32 s57, s78, 196608
s_add_u32 s57, s57, s39
s_lshr_b32 s49, s78, 1
s_mul_i32 s49, s49, 32768
s_lshl_b32 s78, s78, 12
s_add_u32 s49, s49, s78
s_add_u32 s49, s49, s76
s_add_u32 m0, s49, 65536
s_nop 0
buffer_load_dwordx4 v3, s[16:19], s57 offen nt lds
s_add_u32 m0, s49, 71680
s_nop 0
s_nop 0
buffer_load_dwordx4 v3, s[16:19], s57 offen offset:2048 nt lds
s_add_u32 m0, s49, 81920
s_add_u32 s79, s57, 4096
buffer_load_dwordx4 v3, s[16:19], s79 offen nt lds
s_bfe_u32 s55, s2, 0x20003
s_lshl_b32 s55, s55, 13
s_add_u32 s55, s55, 8192
s_and_b32 s55, s55, 32767
s_lshl4_add_u32 s79, s55, s36
s_add_u32 m0, s55, s76
s_nop 0
buffer_load_dwordx4 v1, s[4:7], s79 offen offset:0 lds
s_add_u32 s55, s55, 4096
s_and_b32 s55, s55, 32767
s_lshl4_add_u32 s79, s55, s36
s_add_u32 m0, s55, s76
s_nop 0
s_nop 0
buffer_load_dwordx4 v1, s[4:7], s79 offen offset:0 lds
s_add_u32 s55, s55, 4096
s_and_b32 s55, s55, 32767
s_lshl4_add_u32 s79, s55, s36
s_add_u32 m0, s55, s76
s_nop 0
s_nop 0
buffer_load_dwordx4 v1, s[4:7], s79 offen offset:0 lds
s_add_u32 s55, s55, 4096
s_and_b32 s55, s55, 32767
s_lshl4_add_u32 s79, s55, s36
s_add_u32 m0, s55, s76
s_nop 0
s_nop 0
buffer_load_dwordx4 v1, s[4:7], s79 offen offset:0 lds
s_add_u32 s55, s55, 4096
s_and_b32 s55, s55, 32767
s_lshl4_add_u32 s79, s55, s36
s_add_u32 m0, s55, s76
s_nop 0
s_nop 0
buffer_load_dwordx4 v1, s[4:7], s79 offen offset:0 lds
s_add_u32 s55, s55, 4096
s_and_b32 s55, s55, 32767
s_lshl4_add_u32 s79, s55, s36
s_add_u32 m0, s55, s76
s_nop 0
buffer_load_dwordx4 v1, s[4:7], s79 offen offset:0 lds
s_add_u32 m0, s46, 90112
s_nop 0
buffer_load_dwordx4 v2, s[8:11], s53 offen nt lds
s_add_u32 m0, s46, 98304
s_nop 0
buffer_load_dwordx4 v2, s[12:15], s53 offen nt lds
s_add_u32 m0, s49, 90112
s_nop 0
buffer_load_dwordx4 v2, s[8:11], s48 offen nt lds
s_add_u32 m0, s49, 98304
s_nop 0
buffer_load_dwordx4 v2, s[12:15], s48 offen nt lds
s_waitcnt vmcnt(4)
s_waitcnt lgkmcnt(0)
s_barrier
ds_read_b64_tr_b16 a[224:225], v10 offset:0
ds_read_b64_tr_b16 a[226:227], v10 offset:256
ds_read_b64_tr_b16 a[228:229], v10 offset:4096
ds_read_b64_tr_b16 a[230:231], v10 offset:4352
ds_read_b128 a[160:163], v6 offset:0
ds_read_b128 a[164:167], v7 offset:0
ds_read_b128 a[172:175], v7 offset:2048
ds_read_b128 a[168:171], v6 offset:2048
ds_read_b128 a[176:179], v6 offset:4096
ds_read_b128 a[180:183], v7 offset:4096
ds_read_b128 a[188:191], v7 offset:6144
ds_read_b128 a[184:187], v6 offset:6144
ds_read_b128 a[192:195], v6 offset:8192
ds_read_b128 a[196:199], v7 offset:8192
ds_read_b128 a[204:207], v7 offset:10240
ds_read_b128 a[200:203], v6 offset:10240
ds_read_b128 a[208:211], v6 offset:12288
ds_read_b128 a[212:215], v7 offset:12288
ds_read_b128 a[220:223], v7 offset:14336
ds_read_b128 a[216:219], v6 offset:14336
s_waitcnt lgkmcnt(15)
v_mfma_f32_16x16x32_bf16 a[0:3], a[224:227], a[160:163], 0
s_waitcnt lgkmcnt(14)
s_bfe_u32 s55, s2, 0x20003
ds_read_b64_tr_b16 a[232:233], v11 offset:0
v_mfma_f32_16x16x32_bf16 a[0:3], a[228:231], a[164:167], a[0:3]
s_waitcnt lgkmcnt(14)
s_lshl_b32 s55, s55, 13
ds_read_b64_tr_b16 a[234:235], v11 offset:256
v_mfma_f32_16x16x32_bf16 a[24:27], a[228:231], a[172:175], 0
s_waitcnt lgkmcnt(14)
s_add_u32 s55, s55, 8192
ds_read_b64_tr_b16 a[236:237], v11 offset:4096
v_mfma_f32_16x16x32_bf16 a[24:27], a[224:227], a[168:171], a[24:27]
s_waitcnt lgkmcnt(14)
s_and_b32 s55, s55, 32767
ds_read_b64_tr_b16 a[238:239], v11 offset:4352
v_mfma_f32_16x16x32_bf16 a[48:51], a[224:227], a[176:179], 0
s_waitcnt lgkmcnt(14)
s_lshl4_add_u32 s79, s55, s36
s_add_u32 m0, s55, s76
v_mfma_f32_16x16x32_bf16 a[48:51], a[228:231], a[180:183], a[48:51]
s_waitcnt lgkmcnt(13)
s_add_u32 m0, m0, 32640
v_mfma_f32_16x16x32_bf16 a[72:75], a[228:231], a[188:191], 0
s_waitcnt lgkmcnt(12)
buffer_load_dwordx4 v1, s[4:7], s79 offen offset:128 lds
v_mfma_f32_16x16x32_bf16 a[72:75], a[224:227], a[184:187], a[72:75]
s_waitcnt lgkmcnt(11)
s_add_u32 s55, s55, 4096
s_and_b32 s55, s55, 32767
v_mfma_f32_16x16x32_bf16 a[96:99], a[224:227], a[192:195], 0
s_waitcnt lgkmcnt(10)
s_lshl4_add_u32 s79, s55, s36
s_add_u32 m0, s55, s76
v_mfma_f32_16x16x32_bf16 a[96:99], a[228:231], a[196:199], a[96:99]
s_waitcnt lgkmcnt(9)
s_add_u32 m0, m0, 32640
v_mfma_f32_16x16x32_bf16 a[120:123], a[228:231], a[204:207], 0
s_waitcnt lgkmcnt(8)
buffer_load_dwordx4 v1, s[4:7], s79 offen offset:128 lds
v_mfma_f32_16x16x32_bf16 a[120:123], a[224:227], a[200:203], a[120:123]
s_waitcnt lgkmcnt(7)
s_add_u32 s55, s55, 4096
s_and_b32 s55, s55, 32767
v_mfma_f32_16x16x32_bf16 v[208:211], a[224:227], a[208:211], 0
s_waitcnt lgkmcnt(6)
s_lshl4_add_u32 s79, s55, s36
s_add_u32 m0, s55, s76
v_mfma_f32_16x16x32_bf16 v[208:211], a[228:231], a[212:215], v[208:211]
s_waitcnt lgkmcnt(5)
s_add_u32 m0, m0, 32640
v_mfma_f32_16x16x32_bf16 v[232:235], a[228:231], a[220:223], 0
s_waitcnt lgkmcnt(4)
buffer_load_dwordx4 v1, s[4:7], s79 offen offset:128 lds
v_mfma_f32_16x16x32_bf16 v[232:235], a[224:227], a[216:219], v[232:235]
s_waitcnt vmcnt(3) lgkmcnt(0)
s_barrier
v_mfma_f32_16x16x32_bf16 v[236:239], a[232:235], a[216:219], 0
s_add_u32 s55, s55, 4096
s_and_b32 s55, s55, 32767
ds_read_b64_tr_b16 a[224:225], v10 offset:8192
v_mfma_f32_16x16x32_bf16 v[236:239], a[236:239], a[220:223], v[236:239]
s_lshl4_add_u32 s79, s55, s36
s_add_u32 m0, s55, s76
ds_read_b64_tr_b16 a[226:227], v10 offset:8448
v_mfma_f32_16x16x32_bf16 v[212:215], a[236:239], a[212:215], 0
s_add_u32 m0, m0, 32640
ds_read_b64_tr_b16 a[228:229], v10 offset:12288
v_mfma_f32_16x16x32_bf16 v[212:215], a[232:235], a[208:211], v[212:215]
buffer_load_dwordx4 v1, s[4:7], s79 offen offset:128 lds
v_mfma_f32_16x16x32_bf16 a[124:127], a[232:235], a[200:203], 0
s_add_u32 s55, s55, 4096
s_and_b32 s55, s55, 32767
ds_read_b64_tr_b16 a[230:231], v10 offset:12544
v_mfma_f32_16x16x32_bf16 a[124:127], a[236:239], a[204:207], a[124:127]
s_lshl4_add_u32 s79, s55, s36
s_add_u32 m0, s55, s76
s_add_u32 m0, m0, 32640
v_mfma_f32_16x16x32_bf16 a[100:103], a[236:239], a[196:199], 0
buffer_load_dwordx4 v1, s[4:7], s79 offen offset:128 lds
v_mfma_f32_16x16x32_bf16 a[100:103], a[232:235], a[192:195], a[100:103]
s_add_u32 s55, s55, 4096
s_and_b32 s55, s55, 32767
ds_read_b64_tr_b16 a[148:149], v8 offset:0
v_mfma_f32_16x16x32_bf16 a[76:79], a[232:235], a[184:187], 0
s_lshl4_add_u32 s79, s55, s36
s_add_u32 m0, s55, s76
ds_read_b64_tr_b16 a[150:151], v8 offset:256
v_mfma_f32_16x16x32_bf16 a[76:79], a[236:239], a[188:191], a[76:79]
s_add_u32 m0, m0, 32640
v_mfma_f32_16x16x32_bf16 a[52:55], a[236:239], a[180:183], 0
buffer_load_dwordx4 v1, s[4:7], s79 offen offset:128 lds
v_mfma_f32_16x16x32_bf16 a[52:55], a[232:235], a[176:179], a[52:55]
s_and_b32 s78, s59, 3
s_cmp_le_u32 s78, 2
s_cselect_b32 s78, 3, 2
v_mfma_f32_16x16x32_bf16 a[28:31], a[232:235], a[168:171], 0
s_mul_i32 s53, s78, 229376
s_add_u32 s53, s53, s38
s_mul_i32 s52, s78, 196608
v_mfma_f32_16x16x32_bf16 a[28:31], a[236:239], a[172:175], a[28:31]
s_add_u32 s52, s52, s39
s_lshr_b32 s46, s78, 1
s_mul_i32 s46, s46, 32768
v_mfma_f32_16x16x32_bf16 a[4:7], a[236:239], a[164:167], 0
s_lshl_b32 s78, s78, 12
s_add_u32 s46, s46, s78
s_add_u32 s46, s46, s76
v_mfma_f32_16x16x32_bf16 a[4:7], a[232:235], a[160:163], a[4:7]
s_waitcnt lgkmcnt(4)
s_add_u32 m0, s46, 65536
v_mfma_f32_16x16x32_bf16 a[8:11], a[224:227], a[160:163], 0
s_waitcnt lgkmcnt(2)
buffer_load_dwordx4 v3, s[16:19], s52 offen nt lds
v_mfma_f32_16x16x32_bf16 a[8:11], a[228:231], a[164:167], a[8:11]
s_add_u32 m0, s46, 71680
ds_read_b64_tr_b16 a[232:233], v11 offset:8192
v_mfma_f32_16x16x32_bf16 a[32:35], a[228:231], a[172:175], 0
buffer_load_dwordx4 v3, s[16:19], s52 offen offset:2048 nt lds
v_mfma_f32_16x16x32_bf16 a[32:35], a[224:227], a[168:171], a[32:35]
s_add_u32 m0, s46, 81920
s_add_u32 s79, s52, 4096
ds_read_b64_tr_b16 a[234:235], v11 offset:8448
v_mfma_f32_16x16x32_bf16 a[56:59], a[224:227], a[176:179], 0
buffer_load_dwordx4 v3, s[16:19], s79 offen nt lds
v_mfma_f32_16x16x32_bf16 a[56:59], a[228:231], a[180:183], a[56:59]
s_add_u32 m0, s46, 90112
ds_read_b64_tr_b16 a[236:237], v11 offset:12288
v_mfma_f32_16x16x32_bf16 a[80:83], a[228:231], a[188:191], 0
buffer_load_dwordx4 v2, s[8:11], s53 offen nt lds
v_mfma_f32_16x16x32_bf16 a[80:83], a[224:227], a[184:187], a[80:83]
s_waitcnt lgkmcnt(3)
s_add_u32 m0, s46, 98304
ds_read_b64_tr_b16 a[238:239], v11 offset:12544
v_mfma_f32_16x16x32_bf16 a[144:147], a[152:155], a[148:151], 0
buffer_load_dwordx4 v2, s[12:15], s53 offen nt lds
v_mfma_f32_16x16x32_bf16 a[104:107], a[224:227], a[192:195], 0
s_sub_u32 s56, s56, 1
s_cmp_eq_u32 s56, 0
s_cselect_b32 s78, -7, 1
v_mfma_f32_16x16x32_bf16 a[104:107], a[228:231], a[196:199], a[104:107]
s_mul_i32 s55, s78, 917504
s_add_u32 s38, s38, s55
s_mul_i32 s55, s78, 786432
v_mfma_f32_16x16x32_bf16 a[128:131], a[228:231], a[204:207], 0
s_add_u32 s39, s39, s55
s_lshl_b32 s55, s78, 8
s_add_u32 s36, s36, s55
v_mfma_f32_16x16x32_bf16 a[128:131], a[224:227], a[200:203], a[128:131]
s_cmp_ge_u32 s47, 6291456
s_cselect_b32 s78, 6291456, 0
s_sub_u32 s47, s47, s78
v_mfma_f32_16x16x32_bf16 v[216:219], a[224:227], a[208:211], 0
buffer_load_dword v19, v18, s[32:35], s47 offen
v_mfma_f32_16x16x32_bf16 v[216:219], a[228:231], a[212:215], v[216:219]
s_add_u32 s47, s47, 786432
s_add_u32 m0, s76, 155648
v_and_b32 v44, 7, v0
v_mfma_f32_16x16x32_bf16 v[240:243], a[228:231], a[220:223], 0
buffer_load_dwordx4 v4, s[60:63], s68 offen nt lds
v_mfma_f32_16x16x32_bf16 v[240:243], a[224:227], a[216:219], v[240:243]
s_waitcnt lgkmcnt(2)
s_add_u32 s68, s68, 0x20000
v_lshrrev_b32 v45, 4, v0
v_mfma_f32_16x16x32_bf16 v[244:247], a[232:235], a[216:219], 0
s_waitcnt lgkmcnt(0)
ds_read_b64_tr_b16 a[224:225], v10 offset:16384
v_mfma_f32_16x16x32_bf16 v[244:247], a[236:239], a[220:223], v[244:247]
ds_read_b64_tr_b16 a[226:227], v10 offset:16640
v_lshl_add_u32 v44, v45, 3, v44
v_mfma_f32_16x16x32_bf16 v[220:223], a[236:239], a[212:215], 0
ds_read_b64_tr_b16 a[228:229], v10 offset:20480
v_mfma_f32_16x16x32_bf16 v[220:223], a[232:235], a[208:211], v[220:223]
ds_read_b64_tr_b16 a[230:231], v10 offset:20736
v_mfma_f32_16x16x32_bf16 a[132:135], a[232:235], a[200:203], 0
v_mfma_f32_16x16x32_bf16 a[132:135], a[236:239], a[204:207], a[132:135]
v_mfma_f32_16x16x32_bf16 a[108:111], a[236:239], a[196:199], 0
v_lshlrev_b32 v44, 4, v44
v_mfma_f32_16x16x32_bf16 a[108:111], a[232:235], a[192:195], a[108:111]
v_mfma_f32_16x16x32_bf16 a[84:87], a[232:235], a[184:187], 0
v_mfma_f32_16x16x32_bf16 a[84:87], a[236:239], a[188:191], a[84:87]
v_mfma_f32_16x16x32_bf16 a[60:63], a[236:239], a[180:183], 0
v_mfma_f32_16x16x32_bf16 a[60:63], a[232:235], a[176:179], a[60:63]
v_bfe_u32 v45, v0, 3, 1
v_mfma_f32_16x16x32_bf16 a[36:39], a[232:235], a[168:171], 0
v_mfma_f32_16x16x32_bf16 a[36:39], a[236:239], a[172:175], a[36:39]
v_mfma_f32_16x16x32_bf16 a[12:15], a[236:239], a[164:167], 0
v_mfma_f32_16x16x32_bf16 a[12:15], a[232:235], a[160:163], a[12:15]
s_waitcnt lgkmcnt(2)
v_mfma_f32_16x16x32_bf16 a[16:19], a[160:163], a[224:227], 0
s_waitcnt lgkmcnt(0)
ds_read_b64_tr_b16 a[232:233], v11 offset:16384
v_lshl_add_u32 v44, v45, 11, v44
v_mfma_f32_16x16x32_bf16 a[16:19], a[164:167], a[228:231], a[16:19]
ds_read_b64_tr_b16 a[234:235], v11 offset:16640
v_mfma_f32_16x16x32_bf16 a[40:43], a[172:175], a[228:231], 0
ds_read_b64_tr_b16 a[236:237], v11 offset:20480
v_mfma_f32_16x16x32_bf16 a[40:43], a[168:171], a[224:227], a[40:43]
ds_read_b64_tr_b16 a[238:239], v11 offset:20736
v_mfma_f32_16x16x32_bf16 a[64:67], a[176:179], a[224:227], 0
v_mfma_f32_16x16x32_bf16 a[64:67], a[180:183], a[228:231], a[64:67]
buffer_load_dwordx4 v[20:23], v44, s[4:7], s42 offen offset:0
v_mfma_f32_16x16x32_bf16 a[88:91], a[188:191], a[228:231], 0
v_mfma_f32_16x16x32_bf16 a[88:91], a[184:187], a[224:227], a[88:91]
buffer_load_dwordx4 v[24:27], v44, s[4:7], s42 offen offset:512
v_mfma_f32_16x16x32_bf16 a[112:115], a[192:195], a[224:227], 0
v_mfma_f32_16x16x32_bf16 a[112:115], a[196:199], a[228:231], a[112:115]
v_mfma_f32_16x16x32_bf16 a[136:139], a[204:207], a[228:231], 0
buffer_load_dwordx4 v[28:31], v44, s[4:7], s42 offen offset:1024
v_mfma_f32_16x16x32_bf16 a[136:139], a[200:203], a[224:227], a[136:139]
v_mfma_f32_16x16x32_bf16 v[224:227], a[208:211], a[224:227], 0
buffer_load_dwordx4 v[32:35], v44, s[4:7], s42 offen offset:1536
v_mfma_f32_16x16x32_bf16 v[224:227], a[212:215], a[228:231], v[224:227]
v_mfma_f32_16x16x32_bf16 v[248:251], a[220:223], a[228:231], 0
v_mfma_f32_16x16x32_bf16 v[248:251], a[216:219], a[224:227], v[248:251]
s_waitcnt vmcnt(11) lgkmcnt(0)
s_barrier
v_mfma_f32_16x16x32_bf16 v[252:255], a[216:219], a[232:235], 0
s_add_u32 m0, s76, 0
s_add_u32 s79, s36, 0
ds_read_b64_tr_b16 a[224:225], v10 offset:24576
v_mfma_f32_16x16x32_bf16 v[252:255], a[220:223], a[236:239], v[252:255]
ds_read_b64_tr_b16 a[226:227], v10 offset:24832
v_mfma_f32_16x16x32_bf16 v[228:231], a[212:215], a[236:239], 0
ds_read_b64_tr_b16 a[228:229], v10 offset:28672
v_mfma_f32_16x16x32_bf16 v[228:231], a[208:211], a[232:235], v[228:231]
ds_read_b64_tr_b16 a[230:231], v10 offset:28928
v_mfma_f32_16x16x32_bf16 a[140:143], a[200:203], a[232:235], 0
buffer_load_dwordx4 v1, s[4:7], s79 offen lds
v_mfma_f32_16x16x32_bf16 a[140:143], a[204:207], a[236:239], a[140:143]
s_add_u32 m0, s76, 4096
s_add_u32 s79, s36, 65536
ds_read_b128 v[58:61], v6 offset:32768
v_mfma_f32_16x16x32_bf16 a[116:119], a[196:199], a[236:239], 0
v_mfma_f32_16x16x32_bf16 a[116:119], a[192:195], a[232:235], a[116:119]
v_mfma_f32_16x16x32_bf16 a[92:95], a[184:187], a[232:235], 0
v_mfma_f32_16x16x32_bf16 a[92:95], a[188:191], a[236:239], a[92:95]
v_mfma_f32_16x16x32_bf16 a[68:71], a[180:183], a[236:239], 0
v_mfma_f32_16x16x32_bf16 a[68:71], a[176:179], a[232:235], a[68:71]
buffer_load_dwordx4 v1, s[4:7], s79 offen lds
v_mfma_f32_16x16x32_bf16 a[44:47], a[168:171], a[232:235], 0
s_add_u32 m0, s76, 8192
s_add_u32 s79, s36, 131072
ds_read_b128 v[62:65], v7 offset:32768
v_mfma_f32_16x16x32_bf16 a[44:47], a[172:175], a[236:239], a[44:47]
v_mfma_f32_16x16x32_bf16 a[20:23], a[164:167], a[236:239], 0
v_mfma_f32_16x16x32_bf16 a[20:23], a[160:163], a[232:235], a[20:23]
s_waitcnt lgkmcnt(4)
v_mfma_f32_16x16x32_bf16 v[80:83], a[224:227], a[160:163], 0
s_waitcnt lgkmcnt(2)
ds_read_b64_tr_b16 a[232:233], v10 offset:32768
v_mfma_f32_16x16x32_bf16 v[80:83], a[228:231], a[164:167], v[80:83]
ds_read_b64_tr_b16 a[234:235], v10 offset:33024
v_mfma_f32_16x16x32_bf16 v[96:99], a[228:231], a[172:175], 0
buffer_load_dwordx4 v1, s[4:7], s79 offen lds
v_mfma_f32_16x16x32_bf16 v[96:99], a[224:227], a[168:171], v[96:99]
s_add_u32 m0, s76, 12288
s_add_u32 s79, s36, 196608
ds_read_b64_tr_b16 a[236:237], v10 offset:36864
v_mfma_f32_16x16x32_bf16 v[112:115], a[224:227], a[176:179], 0
ds_read_b64_tr_b16 a[238:239], v10 offset:37120
v_mfma_f32_16x16x32_bf16 v[112:115], a[228:231], a[180:183], v[112:115]
ds_read_b128 v[70:73], v7 offset:34816
v_mfma_f32_16x16x32_bf16 v[128:131], a[228:231], a[188:191], 0
v_mfma_f32_16x16x32_bf16 v[128:131], a[224:227], a[184:187], v[128:131]
v_mfma_f32_16x16x32_bf16 v[144:147], a[224:227], a[192:195], 0
v_mfma_f32_16x16x32_bf16 v[144:147], a[228:231], a[196:199], v[144:147]
buffer_load_dwordx4 v1, s[4:7], s79 offen lds
v_mfma_f32_16x16x32_bf16 v[160:163], a[228:231], a[204:207], 0
s_add_u32 m0, s76, 16384
s_add_u32 s79, s36, 262144
ds_read_b128 v[66:69], v6 offset:34816
v_mfma_f32_16x16x32_bf16 v[160:163], a[224:227], a[200:203], v[160:163]
v_mfma_f32_16x16x32_bf16 v[176:179], a[224:227], a[208:211], 0
v_mfma_f32_16x16x32_bf16 v[176:179], a[228:231], a[212:215], v[176:179]
v_mfma_f32_16x16x32_bf16 v[192:195], a[228:231], a[220:223], 0
v_mfma_f32_16x16x32_bf16 v[192:195], a[224:227], a[216:219], v[192:195]
s_waitcnt lgkmcnt(4)
v_mfma_f32_16x16x32_bf16 v[196:199], a[232:235], a[216:219], 0
s_waitcnt lgkmcnt(2)
buffer_load_dwordx4 v1, s[4:7], s79 offen lds
v_mfma_f32_16x16x32_bf16 v[196:199], a[236:239], a[220:223], v[196:199]
s_add_u32 m0, s76, 20480
s_add_u32 s79, s36, 327680
ds_read_b64_tr_b16 a[224:225], v11 offset:24576
v_mfma_f32_16x16x32_bf16 v[180:183], a[236:239], a[212:215], 0
ds_read_b64_tr_b16 a[226:227], v11 offset:24832
v_mfma_f32_16x16x32_bf16 v[180:183], a[232:235], a[208:211], v[180:183]
ds_read_b64_tr_b16 a[228:229], v11 offset:28672
v_mfma_f32_16x16x32_bf16 v[164:167], a[232:235], a[200:203], 0
ds_read_b64_tr_b16 a[230:231], v11 offset:28928
v_mfma_f32_16x16x32_bf16 v[164:167], a[236:239], a[204:207], v[164:167]
ds_read_b128 a[240:243], v6 offset:36864
v_mfma_f32_16x16x32_bf16 v[148:151], a[236:239], a[196:199], 0
v_mfma_f32_16x16x32_bf16 v[148:151], a[232:235], a[192:195], v[148:151]
buffer_load_dwordx4 v1, s[4:7], s79 offen lds
v_mfma_f32_16x16x32_bf16 v[132:135], a[232:235], a[184:187], 0
s_add_u32 m0, s76, 24576
s_add_u32 s79, s36, 393216
ds_read_b128 a[244:247], v7 offset:36864
v_mfma_f32_16x16x32_bf16 v[132:135], a[236:239], a[188:191], v[132:135]
v_mfma_f32_16x16x32_bf16 v[116:119], a[236:239], a[180:183], 0
v_mfma_f32_16x16x32_bf16 v[116:119], a[232:235], a[176:179], v[116:119]
v_mfma_f32_16x16x32_bf16 v[100:103], a[232:235], a[168:171], 0
v_mfma_f32_16x16x32_bf16 v[100:103], a[236:239], a[172:175], v[100:103]
v_mfma_f32_16x16x32_bf16 v[84:87], a[236:239], a[164:167], 0
buffer_load_dwordx4 v1, s[4:7], s79 offen lds
v_mfma_f32_16x16x32_bf16 v[84:87], a[232:235], a[160:163], v[84:87]
s_waitcnt lgkmcnt(4)
s_add_u32 m0, s76, 28672
ds_read_b128 a[252:255], v7 offset:38912
v_mfma_f32_16x16x32_bf16 v[88:91], a[224:227], a[160:163], 0
s_waitcnt lgkmcnt(3)
s_add_u32 s79, s36, 458752
ds_read_b64_tr_b16 a[232:233], v11 offset:32768
v_mfma_f32_16x16x32_bf16 v[88:91], a[228:231], a[164:167], v[88:91]
ds_read_b64_tr_b16 a[234:235], v11 offset:33024
v_mfma_f32_16x16x32_bf16 v[104:107], a[228:231], a[172:175], 0
ds_read_b64_tr_b16 a[236:237], v11 offset:36864
v_mfma_f32_16x16x32_bf16 v[104:107], a[224:227], a[168:171], v[104:107]
ds_read_b64_tr_b16 a[238:239], v11 offset:37120
v_mfma_f32_16x16x32_bf16 v[120:123], a[224:227], a[176:179], 0
v_mfma_f32_16x16x32_bf16 v[120:123], a[228:231], a[180:183], v[120:123]
buffer_load_dwordx4 v1, s[4:7], s79 offen lds
v_mfma_f32_16x16x32_bf16 v[136:139], a[228:231], a[188:191], 0
s_add_u32 s36, s36, 128
s_add_u32 m0, s76, 65536
ds_read_b128 a[248:251], v6 offset:38912
v_mfma_f32_16x16x32_bf16 v[136:139], a[224:227], a[184:187], v[136:139]
v_mfma_f32_16x16x32_bf16 v[152:155], a[224:227], a[192:195], 0
v_mfma_f32_16x16x32_bf16 v[152:155], a[228:231], a[196:199], v[152:155]
v_mfma_f32_16x16x32_bf16 v[168:171], a[228:231], a[204:207], 0
v_mfma_f32_16x16x32_bf16 v[168:171], a[224:227], a[200:203], v[168:171]
v_mfma_f32_16x16x32_bf16 v[184:187], a[224:227], a[208:211], 0
buffer_load_dwordx4 v3, s[16:19], s39 offen nt lds
v_mfma_f32_16x16x32_bf16 v[184:187], a[228:231], a[212:215], v[184:187]
s_add_u32 m0, s76, 71680
v_mfma_f32_16x16x32_bf16 v[200:203], a[228:231], a[220:223], 0
v_mfma_f32_16x16x32_bf16 v[200:203], a[224:227], a[216:219], v[200:203]
s_waitcnt vmcnt(15) lgkmcnt(1)
s_barrier
v_mfma_f32_16x16x32_bf16 v[204:207], a[232:235], a[216:219], 0
ds_read_b64_tr_b16 a[224:225], v12 offset:0
v_mfma_f32_16x16x32_bf16 v[204:207], a[236:239], a[220:223], v[204:207]
ds_read_b64_tr_b16 a[226:227], v12 offset:256
v_mfma_f32_16x16x32_bf16 v[188:191], a[236:239], a[212:215], 0
ds_read_b64_tr_b16 a[228:229], v12 offset:4096
v_mfma_f32_16x16x32_bf16 v[188:191], a[232:235], a[208:211], v[188:191]
buffer_load_dwordx4 v3, s[16:19], s39 offen offset:2048 nt lds
v_mfma_f32_16x16x32_bf16 v[172:175], a[232:235], a[200:203], 0
s_add_u32 m0, s76, 81920
s_add_u32 s79, s39, 4096
ds_read_b64_tr_b16 a[230:231], v12 offset:4352
v_mfma_f32_16x16x32_bf16 v[172:175], a[236:239], a[204:207], v[172:175]
v_mfma_f32_16x16x32_bf16 v[156:159], a[236:239], a[196:199], 0
v_mfma_f32_16x16x32_bf16 v[156:159], a[232:235], a[192:195], v[156:159]
ds_read_b128 a[192:195], v6 offset:40960
v_mfma_f32_16x16x32_bf16 v[140:143], a[232:235], a[184:187], 0
ds_read_b128 a[196:199], v7 offset:40960
v_mfma_f32_16x16x32_bf16 v[140:143], a[236:239], a[188:191], v[140:143]
ds_read_b128 a[204:207], v7 offset:43008
v_mfma_f32_16x16x32_bf16 v[124:127], a[236:239], a[180:183], 0
buffer_load_dwordx4 v3, s[16:19], s79 offen nt lds
v_mfma_f32_16x16x32_bf16 v[124:127], a[232:235], a[176:179], v[124:127]
s_add_u32 m0, s76, 69632
s_add_u32 s79, s39, 196608
ds_read_b128 a[200:203], v6 offset:43008
v_mfma_f32_16x16x32_bf16 v[108:111], a[232:235], a[168:171], 0
ds_read_b128 a[208:211], v6 offset:45056
v_mfma_f32_16x16x32_bf16 v[108:111], a[236:239], a[172:175], v[108:111]
ds_read_b128 a[212:215], v7 offset:45056
v_mfma_f32_16x16x32_bf16 v[92:95], a[236:239], a[164:167], 0
v_mfma_f32_16x16x32_bf16 v[92:95], a[232:235], a[160:163], v[92:95]
s_waitcnt lgkmcnt(8)
s_mov_b32 s46, 6
v_mfma_f32_16x16x32_bf16 a[0:3], a[224:227], v[58:61], a[0:3]
s_waitcnt lgkmcnt(6)
ds_read_b128 a[220:223], v7 offset:47104
v_mfma_f32_16x16x32_bf16 a[0:3], a[228:231], v[62:65], a[0:3]
buffer_load_dwordx4 v3, s[16:19], s79 offen nt lds
v_mfma_f32_16x16x32_bf16 a[24:27], a[228:231], v[70:73], a[24:27]
s_add_u32 m0, s76, 75776
ds_read_b128 a[216:219], v6 offset:47104
v_mfma_f32_16x16x32_bf16 a[24:27], a[224:227], v[66:69], a[24:27]
ds_read_b64_tr_b16 a[232:233], v13 offset:0
v_mfma_f32_16x16x32_bf16 a[48:51], a[224:227], a[240:243], a[48:51]
ds_read_b64_tr_b16 a[234:235], v13 offset:256
v_lshrrev_b32 v46, 4, v0
v_mfma_f32_16x16x32_bf16 a[48:51], a[228:231], a[244:247], a[48:51]
ds_read_b64_tr_b16 a[236:237], v13 offset:4096
v_mfma_f32_16x16x32_bf16 a[72:75], a[228:231], a[252:255], a[72:75]
ds_read_b64_tr_b16 a[238:239], v13 offset:4352
v_mfma_f32_16x16x32_bf16 a[72:75], a[224:227], a[248:251], a[72:75]
s_waitcnt lgkmcnt(11)
v_mfma_f32_16x16x32_bf16 a[96:99], a[224:227], a[192:195], a[96:99]
s_waitcnt lgkmcnt(10)
buffer_load_dwordx4 v3, s[16:19], s79 offen offset:2048 nt lds
v_mfma_f32_16x16x32_bf16 a[96:99], a[228:231], a[196:199], a[96:99]
s_waitcnt lgkmcnt(9)
s_add_u32 m0, s76, 86016
s_add_u32 s79, s39, 200704
v_mfma_f32_16x16x32_bf16 a[120:123], a[228:231], a[204:207], a[120:123]
s_waitcnt lgkmcnt(8)
v_lshlrev_b32_e64 v46, 10, v46
v_mfma_f32_16x16x32_bf16 a[120:123], a[224:227], a[200:203], a[120:123]
s_waitcnt lgkmcnt(7)
v_mfma_f32_16x16x32_bf16 v[208:211], a[224:227], a[208:211], v[208:211]
s_waitcnt lgkmcnt(6)
v_and_b32_e64 v47, 15, v0
v_mfma_f32_16x16x32_bf16 v[208:211], a[228:231], a[212:215], v[208:211]
s_waitcnt lgkmcnt(5)
v_mfma_f32_16x16x32_bf16 v[232:235], a[228:231], a[220:223], v[232:235]
s_waitcnt lgkmcnt(4)
v_mfma_f32_16x16x32_bf16 v[232:235], a[224:227], a[216:219], v[232:235]
s_waitcnt lgkmcnt(2)
buffer_load_dwordx4 v3, s[16:19], s79 offen nt lds
v_mfma_f32_16x16x32_bf16 v[236:239], a[232:235], a[216:219], v[236:239]
s_waitcnt lgkmcnt(0)
s_add_u32 s39, s39, 393216
ds_read_b64_tr_b16 a[224:225], v12 offset:8192
v_mfma_f32_16x16x32_bf16 v[236:239], a[236:239], a[220:223], v[236:239]
s_add_u32 m0, s76, 90112
ds_read_b64_tr_b16 a[226:227], v12 offset:8448
v_lshl_add_u32 v79, v47, 4, v46
v_mfma_f32_16x16x32_bf16 v[212:215], a[236:239], a[212:215], v[212:215]
ds_read_b64_tr_b16 a[228:229], v12 offset:12288
v_mfma_f32_16x16x32_bf16 v[212:215], a[232:235], a[208:211], v[212:215]
ds_read_b64_tr_b16 a[230:231], v12 offset:12544
v_mfma_f32_16x16x32_bf16 a[124:127], a[232:235], a[200:203], a[124:127]
v_mfma_f32_16x16x32_bf16 a[124:127], a[236:239], a[204:207], a[124:127]
v_mfma_f32_16x16x32_bf16 a[100:103], a[236:239], a[196:199], a[100:103]
buffer_load_dwordx4 v2, s[8:11], s38 offen nt lds
v_mfma_f32_16x16x32_bf16 a[100:103], a[232:235], a[192:195], a[100:103]
s_add_u32 m0, s76, 98304
ds_read_b64_tr_b16 a[148:149], v8 offset:40960
v_mfma_f32_16x16x32_bf16 a[76:79], a[232:235], a[248:251], a[76:79]
ds_read_b64_tr_b16 a[150:151], v8 offset:41216
v_mfma_f32_16x16x32_bf16 a[76:79], a[236:239], a[252:255], a[76:79]
v_mfma_f32_16x16x32_bf16 a[52:55], a[236:239], a[244:247], a[52:55]
v_mfma_f32_16x16x32_bf16 a[52:55], a[232:235], a[240:243], a[52:55]
v_mfma_f32_16x16x32_bf16 a[28:31], a[232:235], v[66:69], a[28:31]
v_mfma_f32_16x16x32_bf16 a[28:31], a[236:239], v[70:73], a[28:31]
buffer_load_dwordx4 v2, s[12:15], s38 offen nt lds
v_mfma_f32_16x16x32_bf16 a[4:7], a[236:239], v[62:65], a[4:7]
s_add_u32 m0, s76, 94208
s_add_u32 s79, s38, 229376
v_mfma_f32_16x16x32_bf16 a[4:7], a[232:235], v[58:61], a[4:7]
s_waitcnt lgkmcnt(4)
v_mfma_f32_16x16x32_bf16 a[8:11], a[224:227], v[58:61], a[8:11]
s_waitcnt lgkmcnt(2)
ds_read_b64_tr_b16 a[232:233], v13 offset:8192
v_mfma_f32_16x16x32_bf16 a[8:11], a[228:231], v[62:65], a[8:11]
ds_read_b64_tr_b16 a[234:235], v13 offset:8448
v_mfma_f32_16x16x32_bf16 a[32:35], a[228:231], v[70:73], a[32:35]
ds_read_b64_tr_b16 a[236:237], v13 offset:12288
v_mfma_f32_16x16x32_bf16 a[32:35], a[224:227], v[66:69], a[32:35]
ds_read_b64_tr_b16 a[238:239], v13 offset:12544
v_mfma_f32_16x16x32_bf16 a[56:59], a[224:227], a[240:243], a[56:59]
buffer_load_dwordx4 v2, s[8:11], s79 offen nt lds
v_mfma_f32_16x16x32_bf16 a[56:59], a[228:231], a[244:247], a[56:59]
s_add_u32 m0, s76, 102400
v_mfma_f32_16x16x32_bf16 a[80:83], a[228:231], a[252:255], a[80:83]
v_mfma_f32_16x16x32_bf16 a[80:83], a[224:227], a[248:251], a[80:83]
s_waitcnt lgkmcnt(4)
v_mfma_f32_16x16x32_bf16 a[144:147], a[152:155], a[148:151], a[144:147]
s_waitcnt vmcnt(17)
v_mfma_f32_16x16x32_bf16 a[104:107], a[224:227], a[192:195], a[104:107]
v_mfma_f32_16x16x32_bf16 a[104:107], a[228:231], a[196:199], a[104:107]
v_mfma_f32_16x16x32_bf16 v[36:39], v[20:23], v[20:23], 0
v_mfma_f32_16x16x32_bf16 a[128:131], a[228:231], a[204:207], a[128:131]
buffer_load_dwordx4 v2, s[12:15], s79 offen nt lds
v_mfma_f32_16x16x32_bf16 a[128:131], a[224:227], a[200:203], a[128:131]
s_add_u32 s38, s38, 458752
s_add_u32 m0, s76, 147456
v_mfma_f32_16x16x32_bf16 v[40:43], v[20:23], a[152:155], 0
v_mfma_f32_16x16x32_bf16 v[216:219], a[224:227], a[208:211], v[216:219]
v_mfma_f32_16x16x32_bf16 v[216:219], a[228:231], a[212:215], v[216:219]
v_mfma_f32_16x16x32_bf16 v[36:39], v[24:27], v[24:27], v[36:39]
v_mfma_f32_16x16x32_bf16 v[240:243], a[228:231], a[220:223], v[240:243]
v_mfma_f32_16x16x32_bf16 v[240:243], a[224:227], a[216:219], v[240:243]
s_waitcnt lgkmcnt(2)
v_mfma_f32_16x16x32_bf16 v[40:43], v[24:27], a[152:155], v[40:43]
v_mfma_f32_16x16x32_bf16 v[244:247], a[232:235], a[216:219], v[244:247]
s_waitcnt lgkmcnt(0)
ds_read_b64_tr_b16 a[224:225], v12 offset:16384
v_mfma_f32_16x16x32_bf16 v[244:247], a[236:239], a[220:223], v[244:247]
buffer_load_dwordx4 v4, s[60:63], s68 offen nt lds
v_mfma_f32_16x16x32_bf16 v[220:223], a[236:239], a[212:215], v[220:223]
s_sub_u32 s68, s68, 0x20000
s_add_u32 s68, s68, s72
ds_read_b64_tr_b16 a[226:227], v12 offset:16640
v_mfma_f32_16x16x32_bf16 v[36:39], v[28:31], v[28:31], v[36:39]
v_mfma_f32_16x16x32_bf16 v[220:223], a[232:235], a[208:211], v[220:223]
s_mov_b32 s60, s74
s_mov_b32 s61, s75
ds_read_b64_tr_b16 a[228:229], v12 offset:20480
v_mfma_f32_16x16x32_bf16 v[40:43], v[28:31], a[152:155], v[40:43]
v_mfma_f32_16x16x32_bf16 a[132:135], a[232:235], a[200:203], a[132:135]
s_add_u32 s62, s73, 917504
s_add_u32 m0, s76, 151552
ds_read_b64_tr_b16 a[230:231], v12 offset:20736
v_mfma_f32_16x16x32_bf16 a[132:135], a[236:239], a[204:207], a[132:135]
v_mfma_f32_16x16x32_bf16 v[36:39], v[32:35], v[32:35], v[36:39]
v_mfma_f32_16x16x32_bf16 a[108:111], a[236:239], a[196:199], a[108:111]
v_mfma_f32_16x16x32_bf16 a[108:111], a[232:235], a[192:195], a[108:111]
v_mfma_f32_16x16x32_bf16 v[40:43], v[32:35], a[152:155], v[40:43]
v_mfma_f32_16x16x32_bf16 a[84:87], a[232:235], a[248:251], a[84:87]
buffer_load_dwordx4 v4, s[60:63], s68 offen nt lds
v_mfma_f32_16x16x32_bf16 a[84:87], a[236:239], a[252:255], a[84:87]
s_add_u32 s68, s68, 0x20000
v_and_b32 v77, 31, v0
v_mfma_f32_16x16x32_bf16 a[60:63], a[236:239], a[244:247], a[60:63]
v_mfma_f32_16x16x32_bf16 a[60:63], a[232:235], a[240:243], a[60:63]
v_lshrrev_b32_e64 v76, 5, v0
v_mfma_f32_16x16x32_bf16 a[36:39], a[232:235], v[66:69], a[36:39]
v_mfma_f32_16x16x32_bf16 a[36:39], a[236:239], v[70:73], a[36:39]
v_lshlrev_b32_e64 v76, 3, v76
v_mfma_f32_16x16x32_bf16 a[12:15], a[236:239], v[62:65], a[12:15]
v_mfma_f32_16x16x32_bf16 a[12:15], a[232:235], v[58:61], a[12:15]
s_waitcnt lgkmcnt(2)
v_lshl_add_u32 v76, v77, 26, v76
v_mfma_f32_16x16x32_bf16 a[16:19], v[58:61], a[224:227], a[16:19]
s_waitcnt lgkmcnt(0)
ds_read_b64_tr_b16 a[232:233], v13 offset:16384
v_mfma_f32_16x16x32_bf16 a[16:19], v[62:65], a[228:231], a[16:19]
ds_read_b64_tr_b16 a[234:235], v13 offset:16640
s_mov_b32 vcc_lo, 0x00100001
v_mfma_f32_16x16x32_bf16 a[40:43], v[70:73], a[228:231], a[40:43]
ds_read_b64_tr_b16 a[236:237], v13 offset:20480
v_mfma_f32_16x16x32_bf16 a[40:43], v[66:69], a[224:227], a[40:43]
ds_read_b64_tr_b16 a[238:239], v13 offset:20736
s_mov_b32 vcc_hi, 0x10000100
v_mfma_f32_16x16x32_bf16 a[64:67], a[240:243], a[224:227], a[64:67]
v_mfma_f32_16x16x32_bf16 a[64:67], a[244:247], a[228:231], a[64:67]
v_mfma_f32_16x16x32_bf16 a[88:91], a[252:255], a[228:231], a[88:91]
v_mfma_f32_16x16x32_bf16 a[88:91], a[248:251], a[224:227], a[88:91]
v_mfma_f32_16x16x32_bf16 a[112:115], a[192:195], a[224:227], a[112:115]
v_mfma_f32_16x16x32_bf16 a[112:115], a[196:199], a[228:231], a[112:115]
v_cndmask_b32 v44, 0, v36, vcc
v_mfma_f32_16x16x32_bf16 a[136:139], a[204:207], a[228:231], a[136:139]
v_mfma_f32_16x16x32_bf16 a[136:139], a[200:203], a[224:227], a[136:139]
s_lshl_b64 vcc, vcc, 1
v_mfma_f32_16x16x32_bf16 v[224:227], a[208:211], a[224:227], v[224:227]
v_mfma_f32_16x16x32_bf16 v[224:227], a[212:215], a[228:231], v[224:227]
v_add_f32_e64 v40, v40, v41
v_mfma_f32_16x16x32_bf16 v[248:251], a[220:223], a[228:231], v[248:251]
v_mfma_f32_16x16x32_bf16 v[248:251], a[216:219], a[224:227], v[248:251]
s_waitcnt vmcnt(12) lgkmcnt(0)
s_barrier
v_mfma_f32_16x16x32_bf16 v[252:255], a[216:219], a[232:235], v[252:255]
s_sub_u32 s56, s56, 1
ds_read_b64_tr_b16 a[224:225], v12 offset:24576
v_cndmask_b32 v44, v44, v37, vcc
v_mfma_f32_16x16x32_bf16 v[252:255], a[220:223], a[236:239], v[252:255]
s_cmp_eq_u32 s56, 0
s_cselect_b32 s78, -960, 64
ds_read_b64_tr_b16 a[226:227], v12 offset:24832
v_mfma_f32_16x16x32_bf16 v[228:231], a[212:215], a[236:239], v[228:231]
s_add_u32 m0, s76, 32768
s_add_u32 s79, s36, 0
ds_read_b64_tr_b16 a[228:229], v12 offset:28672
v_mfma_f32_16x16x32_bf16 v[228:231], a[208:211], a[232:235], v[228:231]
ds_read_b64_tr_b16 a[230:231], v12 offset:28928
s_lshl_b64 vcc, vcc, 1
v_mfma_f32_16x16x32_bf16 a[140:143], a[200:203], a[232:235], a[140:143]
buffer_load_dwordx4 v1, s[4:7], s79 offen lds
v_mfma_f32_16x16x32_bf16 a[140:143], a[204:207], a[236:239], a[140:143]
s_add_u32 m0, s76, 36864
s_add_u32 s79, s36, 65536
ds_read_b128 a[160:163], v6 offset:0
v_mfma_f32_16x16x32_bf16 a[116:119], a[196:199], a[236:239], a[116:119]
v_add_f32 v40, v40, v42
v_mfma_f32_16x16x32_bf16 a[116:119], a[192:195], a[232:235], a[116:119]
v_cndmask_b32 v44, v44, v38, vcc
s_lshl_b64 vcc, vcc, 1
v_mfma_f32_16x16x32_bf16 a[92:95], a[248:251], a[232:235], a[92:95]
ds_read_b64_tr_b16 v[54:55], v78 offset:8192
v_mfma_f32_16x16x32_bf16 a[92:95], a[252:255], a[236:239], a[92:95]
ds_read_b64_tr_b16 v[56:57], v78 offset:8704
v_mfma_f32_16x16x32_bf16 a[68:71], a[244:247], a[236:239], a[68:71]
v_add_f32_e64 v40, v40, v43
v_mfma_f32_16x16x32_bf16 a[68:71], a[240:243], a[232:235], a[68:71]
buffer_load_dwordx4 v1, s[4:7], s79 offen lds
v_mfma_f32_16x16x32_bf16 a[44:47], v[66:69], a[232:235], a[44:47]
s_add_u32 m0, s76, 40960
s_add_u32 s79, s36, 131072
ds_read_b128 a[164:167], v7 offset:0
v_mfma_f32_16x16x32_bf16 a[44:47], v[70:73], a[236:239], a[44:47]
v_cndmask_b32 v44, v44, v39, vcc
v_mfma_f32_16x16x32_bf16 a[20:23], v[62:65], a[236:239], a[20:23]
s_nop 0
v_add_f32_dpp v44, v44, v44 quad_perm:[1,0,3,2] row_mask:0xf bank_mask:0xf
v_mfma_f32_16x16x32_bf16 a[20:23], v[58:61], a[232:235], a[20:23]
s_waitcnt lgkmcnt(6)
v_mfma_f32_16x16x32_bf16 v[80:83], a[224:227], v[58:61], v[80:83]
s_waitcnt lgkmcnt(4)
ds_read_b64_tr_b16 a[232:233], v12 offset:32768
v_add_f32_dpp v44, v44, v44 quad_perm:[2,3,0,1] row_mask:0xf bank_mask:0xf
v_mfma_f32_16x16x32_bf16 v[80:83], a[228:231], v[62:65], v[80:83]
ds_read_b64_tr_b16 a[234:235], v12 offset:33024
v_mfma_f32_16x16x32_bf16 v[96:99], a[228:231], v[70:73], v[96:99]
buffer_load_dwordx4 v1, s[4:7], s79 offen lds
v_mfma_f32_16x16x32_bf16 v[96:99], a[224:227], v[66:69], v[96:99]
s_add_u32 m0, s76, 45056
s_add_u32 s79, s36, 196608
ds_read_b64_tr_b16 a[236:237], v12 offset:36864
v_mfma_f32_16x16x32_bf16 v[112:115], a[224:227], a[240:243], v[112:115]
ds_read_b64_tr_b16 a[238:239], v12 offset:37120
v_add_f32_dpp v44, v44, v44 row_half_mirror row_mask:0xf bank_mask:0xf
v_mfma_f32_16x16x32_bf16 v[112:115], a[228:231], a[244:247], v[112:115]
ds_read_b128 a[172:175], v7 offset:2048
v_add_f32_dpp v44, v44, v44 row_mirror row_mask:0xf bank_mask:0xf
v_mfma_f32_16x16x32_bf16 v[128:131], a[228:231], a[252:255], v[128:131]
s_nop 0
v_permlane16_swap_b32 v40, v44
v_mfma_f32_16x16x32_bf16 v[128:131], a[224:227], a[248:251], v[128:131]
v_mfma_f32_16x16x32_bf16 v[144:147], a[224:227], a[192:195], v[144:147]
v_add_f32_e64 v40, v40, v44
v_mfma_f32_16x16x32_bf16 v[144:147], a[228:231], a[196:199], v[144:147]
buffer_load_dwordx4 v1, s[4:7], s79 offen lds
v_mfma_f32_16x16x32_bf16 v[160:163], a[228:231], a[204:207], v[160:163]
s_add_u32 m0, s76, 49152
s_add_u32 s79, s36, 262144
ds_read_b128 a[168:171], v6 offset:2048
v_mfma_f32_16x16x32_bf16 v[160:163], a[224:227], a[200:203], v[160:163]
v_mul_f32 v40, 0x3a800000, v40
v_mfma_f32_16x16x32_bf16 v[176:179], a[224:227], a[208:211], v[176:179]
v_mov_b32_e64 v44, v40
v_mfma_f32_16x16x32_bf16 v[176:179], a[228:231], a[212:215], v[176:179]
v_mfma_f32_16x16x32_bf16 v[192:195], a[228:231], a[220:223], v[192:195]
v_permlane16_swap_b32 v40, v44
v_mfma_f32_16x16x32_bf16 v[192:195], a[224:227], a[216:219], v[192:195]
s_waitcnt lgkmcnt(4)
v_mfma_f32_16x16x32_bf16 v[196:199], a[232:235], a[216:219], v[196:199]
s_waitcnt lgkmcnt(2)
buffer_load_dwordx4 v1, s[4:7], s79 offen lds
v_mfma_f32_16x16x32_bf16 v[196:199], a[236:239], a[220:223], v[196:199]
s_add_u32 m0, s76, 53248
s_add_u32 s79, s36, 327680
ds_read_b64_tr_b16 a[224:225], v13 offset:24576
v_mfma_f32_16x16x32_bf16 v[180:183], a[236:239], a[212:215], v[180:183]
ds_read_b64_tr_b16 a[226:227], v13 offset:24832
v_fma_f32 v44, -v40, v40, v44
v_mfma_f32_16x16x32_bf16 v[180:183], a[232:235], a[208:211], v[180:183]
ds_read_b64_tr_b16 a[228:229], v13 offset:28672
v_cvt_pk_bf16_f32 v74, v40, v40
v_mfma_f32_16x16x32_bf16 v[164:167], a[232:235], a[200:203], v[164:167]
ds_read_b64_tr_b16 a[230:231], v13 offset:28928
v_max_f32 v44, 0, v44
v_mfma_f32_16x16x32_bf16 v[164:167], a[236:239], a[204:207], v[164:167]
ds_read_b128 a[176:179], v6 offset:4096
v_mfma_f32_16x16x32_bf16 v[148:151], a[236:239], a[196:199], v[148:151]
v_xor_b32 v74, 0x80008000, v74
v_mfma_f32_16x16x32_bf16 v[148:151], a[232:235], a[192:195], v[148:151]
buffer_load_dwordx4 v1, s[4:7], s79 offen lds
v_mfma_f32_16x16x32_bf16 v[132:135], a[232:235], a[248:251], v[132:135]
s_add_u32 m0, s76, 57344
s_add_u32 s79, s36, 393216
ds_read_b128 a[180:183], v7 offset:4096
v_mfma_f32_16x16x32_bf16 v[132:135], a[236:239], a[252:255], v[132:135]
buffer_store_dwordx4 v[54:57], v79, s[64:67], s69 offen sc1
v_mfma_f32_16x16x32_bf16 v[116:119], a[236:239], a[244:247], v[116:119]
v_cvt_pk_bf16_f32 v44, v44, v44
s_add_u32 s69, s69, 0x100000
v_mfma_f32_16x16x32_bf16 v[116:119], a[232:235], a[240:243], v[116:119]
v_and_b32_e64 v44, s54, v44
v_mfma_f32_16x16x32_bf16 v[100:103], a[232:235], v[66:69], v[100:103]
v_add_f32 v44, 0x3727c5ac, v44
v_mfma_f32_16x16x32_bf16 v[100:103], a[236:239], v[70:73], v[100:103]
v_mfma_f32_16x16x32_bf16 v[84:87], a[236:239], v[62:65], v[84:87]
buffer_load_dwordx4 v1, s[4:7], s79 offen lds
v_mfma_f32_16x16x32_bf16 v[84:87], a[232:235], v[58:61], v[84:87]
s_waitcnt lgkmcnt(4)
s_add_u32 m0, s76, 61440
ds_read_b128 a[188:191], v7 offset:6144
v_mfma_f32_16x16x32_bf16 v[88:91], a[224:227], v[58:61], v[88:91]
s_waitcnt lgkmcnt(3)
s_add_u32 s79, s36, 458752
ds_read_b64_tr_b16 a[232:233], v13 offset:32768
v_mfma_f32_16x16x32_bf16 v[88:91], a[228:231], v[62:65], v[88:91]
ds_read_b64_tr_b16 a[234:235], v13 offset:33024
v_cvt_pk_bf16_f32 v44, v44, v44
v_mfma_f32_16x16x32_bf16 v[104:107], a[228:231], v[70:73], v[104:107]
ds_read_b64_tr_b16 a[236:237], v13 offset:36864
v_and_b32_e64 v44, s54, v44
v_mfma_f32_16x16x32_bf16 v[104:107], a[224:227], v[66:69], v[104:107]
ds_read_b64_tr_b16 a[238:239], v13 offset:37120
v_mfma_f32_16x16x32_bf16 v[120:123], a[224:227], a[240:243], v[120:123]
v_sqrt_f32_e64 v44, v44
v_mfma_f32_16x16x32_bf16 v[120:123], a[228:231], a[244:247], v[120:123]
buffer_load_dwordx4 v1, s[4:7], s79 offen lds
v_mfma_f32_16x16x32_bf16 v[136:139], a[228:231], a[252:255], v[136:139]
s_lshl1_add_u32 s36, s78, s36
s_add_u32 m0, s76, 106496
ds_read_b128 a[184:187], v6 offset:6144
v_mfma_f32_16x16x32_bf16 v[136:139], a[224:227], a[248:251], v[136:139]
v_cvt_pk_bf16_f32 v44, v44, v44
v_mfma_f32_16x16x32_bf16 v[152:155], a[224:227], a[192:195], v[152:155]
v_and_b32 v75, s54, v44
v_mfma_f32_16x16x32_bf16 v[152:155], a[228:231], a[196:199], v[152:155]
buffer_store_dwordx2 v[74:75], v76, s[24:27], s41 offen sc1
v_mfma_f32_16x16x32_bf16 v[168:171], a[228:231], a[204:207], v[168:171]
v_mfma_f32_16x16x32_bf16 v[168:171], a[224:227], a[200:203], v[168:171]
v_mov_b32 v16, 162368
v_mfma_f32_16x16x32_bf16 v[184:187], a[224:227], a[208:211], v[184:187]
buffer_load_dwordx4 v3, s[16:19], s39 offen lds
v_mfma_f32_16x16x32_bf16 v[184:187], a[228:231], a[212:215], v[184:187]
s_add_u32 m0, s76, 112640
v_mfma_f32_16x16x32_bf16 v[200:203], a[228:231], a[220:223], v[200:203]
v_min_u32_e64 v17, 7, v0
v_mfma_f32_16x16x32_bf16 v[200:203], a[224:227], a[216:219], v[200:203]
s_waitcnt vmcnt(13) lgkmcnt(1)
s_barrier
v_mfma_f32_16x16x32_bf16 v[204:207], a[232:235], a[216:219], v[204:207]
ds_read_b64_tr_b16 a[224:225], v10 offset:0
v_mfma_f32_16x16x32_bf16 v[204:207], a[236:239], a[220:223], v[204:207]
ds_read_b64_tr_b16 a[226:227], v10 offset:256
v_lshl_add_u32 v17, v17, 2, v16
v_mfma_f32_16x16x32_bf16 v[188:191], a[236:239], a[212:215], v[188:191]
ds_read_b64_tr_b16 a[228:229], v10 offset:4096
v_mfma_f32_16x16x32_bf16 v[188:191], a[232:235], a[208:211], v[188:191]
buffer_load_dwordx4 v3, s[16:19], s39 offen offset:2048 lds
v_mfma_f32_16x16x32_bf16 v[172:175], a[232:235], a[200:203], v[172:175]
s_add_u32 m0, s76, 122880
s_add_u32 s79, s39, 4096
ds_read_b64_tr_b16 a[230:231], v10 offset:4352
v_mfma_f32_16x16x32_bf16 v[172:175], a[236:239], a[204:207], v[172:175]
v_mfma_f32_16x16x32_bf16 v[156:159], a[236:239], a[196:199], v[156:159]
v_mfma_f32_16x16x32_bf16 v[156:159], a[232:235], a[192:195], v[156:159]
ds_read_b128 a[192:195], v6 offset:8192
v_mfma_f32_16x16x32_bf16 v[140:143], a[232:235], a[248:251], v[140:143]
ds_read_b128 a[196:199], v7 offset:8192
v_mfma_f32_16x16x32_bf16 v[140:143], a[236:239], a[252:255], v[140:143]
ds_read_b128 a[204:207], v7 offset:10240
v_mfma_f32_16x16x32_bf16 v[124:127], a[236:239], a[244:247], v[124:127]
buffer_load_dwordx4 v3, s[16:19], s79 offen lds
v_mfma_f32_16x16x32_bf16 v[124:127], a[232:235], a[240:243], v[124:127]
s_add_u32 m0, s76, 110592
s_add_u32 s79, s39, 196608
ds_read_b128 a[200:203], v6 offset:10240
v_mfma_f32_16x16x32_bf16 v[108:111], a[232:235], v[66:69], v[108:111]
ds_read_b128 a[208:211], v6 offset:12288
v_mfma_f32_16x16x32_bf16 v[108:111], a[236:239], v[70:73], v[108:111]
ds_read_b128 a[212:215], v7 offset:12288
v_mfma_f32_16x16x32_bf16 v[92:95], a[236:239], v[62:65], v[92:95]
v_mfma_f32_16x16x32_bf16 v[92:95], a[232:235], v[58:61], v[92:95]
s_waitcnt lgkmcnt(8)
L_g1_loop_1023:
v_mfma_f32_16x16x32_bf16 a[0:3], a[224:227], a[160:163], a[0:3]
s_waitcnt lgkmcnt(6)
ds_read_b128 a[220:223], v7 offset:14336
v_mfma_f32_16x16x32_bf16 a[0:3], a[228:231], a[164:167], a[0:3]
buffer_load_dwordx4 v3, s[16:19], s79 offen lds
v_mfma_f32_16x16x32_bf16 a[24:27], a[228:231], a[172:175], a[24:27]
s_add_u32 m0, s76, 116736
ds_read_b128 a[216:219], v6 offset:14336
v_mfma_f32_16x16x32_bf16 a[24:27], a[224:227], a[168:171], a[24:27]
ds_read_b64_tr_b16 a[232:233], v11 offset:0
v_mfma_f32_16x16x32_bf16 a[48:51], a[224:227], a[176:179], a[48:51]
ds_read_b64_tr_b16 a[234:235], v11 offset:256
v_mfma_f32_16x16x32_bf16 a[48:51], a[228:231], a[180:183], a[48:51]
ds_read_b64_tr_b16 a[236:237], v11 offset:4096
v_mfma_f32_16x16x32_bf16 a[72:75], a[228:231], a[188:191], a[72:75]
ds_read_b64_tr_b16 a[238:239], v11 offset:4352
v_mfma_f32_16x16x32_bf16 a[72:75], a[224:227], a[184:187], a[72:75]
s_waitcnt lgkmcnt(11)
v_mfma_f32_16x16x32_bf16 a[96:99], a[224:227], a[192:195], a[96:99]
s_waitcnt lgkmcnt(10)
buffer_load_dwordx4 v3, s[16:19], s79 offen offset:2048 lds
v_mfma_f32_16x16x32_bf16 a[96:99], a[228:231], a[196:199], a[96:99]
s_waitcnt lgkmcnt(9)
s_add_u32 m0, s76, 126976
s_add_u32 s79, s39, 200704
v_mfma_f32_16x16x32_bf16 a[120:123], a[228:231], a[204:207], a[120:123]
s_waitcnt lgkmcnt(8)
v_mfma_f32_16x16x32_bf16 a[120:123], a[224:227], a[200:203], a[120:123]
s_waitcnt lgkmcnt(7)
v_mfma_f32_16x16x32_bf16 v[208:211], a[224:227], a[208:211], v[208:211]
s_waitcnt lgkmcnt(6)
v_mfma_f32_16x16x32_bf16 v[208:211], a[228:231], a[212:215], v[208:211]
s_waitcnt lgkmcnt(5)
v_mfma_f32_16x16x32_bf16 v[232:235], a[228:231], a[220:223], v[232:235]
s_waitcnt lgkmcnt(4)
v_mfma_f32_16x16x32_bf16 v[232:235], a[224:227], a[216:219], v[232:235]
s_waitcnt lgkmcnt(2)
buffer_load_dwordx4 v3, s[16:19], s79 offen lds
v_mfma_f32_16x16x32_bf16 v[236:239], a[232:235], a[216:219], v[236:239]
s_waitcnt lgkmcnt(0)
s_mul_i32 s55, s78, 6144
ds_read_b64_tr_b16 a[224:225], v10 offset:8192
v_mfma_f32_16x16x32_bf16 v[236:239], a[236:239], a[220:223], v[236:239]
s_add_u32 s39, s39, s55
s_add_u32 m0, s76, 131072
ds_read_b64_tr_b16 a[226:227], v10 offset:8448
v_mfma_f32_16x16x32_bf16 v[212:215], a[236:239], a[212:215], v[212:215]
ds_read_b64_tr_b16 a[228:229], v10 offset:12288
v_mfma_f32_16x16x32_bf16 v[212:215], a[232:235], a[208:211], v[212:215]
ds_read_b64_tr_b16 a[230:231], v10 offset:12544
v_mfma_f32_16x16x32_bf16 a[124:127], a[232:235], a[200:203], a[124:127]
v_mfma_f32_16x16x32_bf16 a[124:127], a[236:239], a[204:207], a[124:127]
v_mfma_f32_16x16x32_bf16 a[100:103], a[236:239], a[196:199], a[100:103]
buffer_load_dwordx4 v2, s[8:11], s38 offen lds
v_mfma_f32_16x16x32_bf16 a[100:103], a[232:235], a[192:195], a[100:103]
s_add_u32 m0, s76, 139264
ds_read_b64_tr_b16 a[148:149], v8 offset:0
v_mfma_f32_16x16x32_bf16 a[76:79], a[232:235], a[184:187], a[76:79]
ds_read_b64_tr_b16 a[150:151], v8 offset:256
v_mfma_f32_16x16x32_bf16 a[76:79], a[236:239], a[188:191], a[76:79]
v_mfma_f32_16x16x32_bf16 a[52:55], a[236:239], a[180:183], a[52:55]
v_mfma_f32_16x16x32_bf16 a[52:55], a[232:235], a[176:179], a[52:55]
v_mfma_f32_16x16x32_bf16 a[28:31], a[232:235], a[168:171], a[28:31]
v_mfma_f32_16x16x32_bf16 a[28:31], a[236:239], a[172:175], a[28:31]
buffer_load_dwordx4 v2, s[12:15], s38 offen lds
v_mfma_f32_16x16x32_bf16 a[4:7], a[236:239], a[164:167], a[4:7]
s_add_u32 m0, s76, 135168
s_add_u32 s79, s38, 229376
v_mfma_f32_16x16x32_bf16 a[4:7], a[232:235], a[160:163], a[4:7]
s_waitcnt lgkmcnt(4)
v_mfma_f32_16x16x32_bf16 a[8:11], a[224:227], a[160:163], a[8:11]
s_waitcnt lgkmcnt(2)
ds_read_b64_tr_b16 a[232:233], v11 offset:8192
v_mfma_f32_16x16x32_bf16 a[8:11], a[228:231], a[164:167], a[8:11]
ds_read_b64_tr_b16 a[234:235], v11 offset:8448
v_mfma_f32_16x16x32_bf16 a[32:35], a[228:231], a[172:175], a[32:35]
ds_read_b64_tr_b16 a[236:237], v11 offset:12288
v_mfma_f32_16x16x32_bf16 a[32:35], a[224:227], a[168:171], a[32:35]
ds_read_b64_tr_b16 a[238:239], v11 offset:12544
v_mfma_f32_16x16x32_bf16 a[56:59], a[224:227], a[176:179], a[56:59]
buffer_load_dwordx4 v2, s[8:11], s79 offen lds
v_mfma_f32_16x16x32_bf16 a[56:59], a[228:231], a[180:183], a[56:59]
s_add_u32 m0, s76, 143360
v_mfma_f32_16x16x32_bf16 a[80:83], a[228:231], a[188:191], a[80:83]
v_mfma_f32_16x16x32_bf16 a[80:83], a[224:227], a[184:187], a[80:83]
s_waitcnt lgkmcnt(4)
v_mfma_f32_16x16x32_bf16 a[144:147], a[152:155], a[148:151], a[144:147]
v_mfma_f32_16x16x32_bf16 a[104:107], a[224:227], a[192:195], a[104:107]
v_mfma_f32_16x16x32_bf16 a[104:107], a[228:231], a[196:199], a[104:107]
v_mfma_f32_16x16x32_bf16 a[128:131], a[228:231], a[204:207], a[128:131]
buffer_load_dwordx4 v2, s[12:15], s79 offen lds
v_mfma_f32_16x16x32_bf16 a[128:131], a[224:227], a[200:203], a[128:131]
s_mul_i32 s55, s78, 7168
s_add_u32 s38, s38, s55
v_mfma_f32_16x16x32_bf16 v[216:219], a[224:227], a[208:211], v[216:219]
s_cmp_ge_u32 s47, 6291456
s_cselect_b32 s78, 6291456, 0
s_sub_u32 s47, s47, s78
v_mfma_f32_16x16x32_bf16 v[216:219], a[228:231], a[212:215], v[216:219]
s_cmp_lt_u32 s46, 2
s_cselect_b32 s34, 0, s34
v_mfma_f32_16x16x32_bf16 v[240:243], a[228:231], a[220:223], v[240:243]
v_mfma_f32_16x16x32_bf16 v[240:243], a[224:227], a[216:219], v[240:243]
s_waitcnt lgkmcnt(2)
v_mfma_f32_16x16x32_bf16 v[244:247], a[232:235], a[216:219], v[244:247]
s_waitcnt lgkmcnt(0)
ds_read_b64_tr_b16 a[224:225], v10 offset:16384
v_mfma_f32_16x16x32_bf16 v[244:247], a[236:239], a[220:223], v[244:247]
buffer_load_dword v19, v18, s[32:35], s47 offen
v_mfma_f32_16x16x32_bf16 v[220:223], a[236:239], a[212:215], v[220:223]
s_add_u32 s47, s47, 786432
ds_read_b64_tr_b16 a[226:227], v10 offset:16640
v_mfma_f32_16x16x32_bf16 v[220:223], a[232:235], a[208:211], v[220:223]
ds_read_b64_tr_b16 a[228:229], v10 offset:20480
v_mfma_f32_16x16x32_bf16 a[132:135], a[232:235], a[200:203], a[132:135]
ds_read_b64_tr_b16 a[230:231], v10 offset:20736
v_mfma_f32_16x16x32_bf16 a[132:135], a[236:239], a[204:207], a[132:135]
v_mfma_f32_16x16x32_bf16 a[108:111], a[236:239], a[196:199], a[108:111]
v_mfma_f32_16x16x32_bf16 a[108:111], a[232:235], a[192:195], a[108:111]
v_mfma_f32_16x16x32_bf16 a[84:87], a[232:235], a[184:187], a[84:87]
v_mfma_f32_16x16x32_bf16 a[84:87], a[236:239], a[188:191], a[84:87]
v_mfma_f32_16x16x32_bf16 a[60:63], a[236:239], a[180:183], a[60:63]
v_mfma_f32_16x16x32_bf16 a[60:63], a[232:235], a[176:179], a[60:63]
v_mfma_f32_16x16x32_bf16 a[36:39], a[232:235], a[168:171], a[36:39]
v_mfma_f32_16x16x32_bf16 a[36:39], a[236:239], a[172:175], a[36:39]
v_mfma_f32_16x16x32_bf16 a[12:15], a[236:239], a[164:167], a[12:15]
v_mfma_f32_16x16x32_bf16 a[12:15], a[232:235], a[160:163], a[12:15]
s_waitcnt lgkmcnt(2)
v_mfma_f32_16x16x32_bf16 a[16:19], a[160:163], a[224:227], a[16:19]
s_waitcnt lgkmcnt(0)
ds_read_b64_tr_b16 a[232:233], v11 offset:16384
v_mfma_f32_16x16x32_bf16 a[16:19], a[164:167], a[228:231], a[16:19]
ds_read_b64_tr_b16 a[234:235], v11 offset:16640
v_mfma_f32_16x16x32_bf16 a[40:43], a[172:175], a[228:231], a[40:43]
ds_read_b64_tr_b16 a[236:237], v11 offset:20480
v_mfma_f32_16x16x32_bf16 a[40:43], a[168:171], a[224:227], a[40:43]
ds_read_b64_tr_b16 a[238:239], v11 offset:20736
v_mfma_f32_16x16x32_bf16 a[64:67], a[176:179], a[224:227], a[64:67]
v_mfma_f32_16x16x32_bf16 a[64:67], a[180:183], a[228:231], a[64:67]
v_mfma_f32_16x16x32_bf16 a[88:91], a[188:191], a[228:231], a[88:91]
v_mfma_f32_16x16x32_bf16 a[88:91], a[184:187], a[224:227], a[88:91]
v_mfma_f32_16x16x32_bf16 a[112:115], a[192:195], a[224:227], a[112:115]
v_mfma_f32_16x16x32_bf16 a[112:115], a[196:199], a[228:231], a[112:115]
v_mfma_f32_16x16x32_bf16 a[136:139], a[204:207], a[228:231], a[136:139]
v_mfma_f32_16x16x32_bf16 a[136:139], a[200:203], a[224:227], a[136:139]
v_mfma_f32_16x16x32_bf16 v[224:227], a[208:211], a[224:227], v[224:227]
v_mfma_f32_16x16x32_bf16 v[224:227], a[212:215], a[228:231], v[224:227]
v_mfma_f32_16x16x32_bf16 v[248:251], a[220:223], a[228:231], v[248:251]
v_mfma_f32_16x16x32_bf16 v[248:251], a[216:219], a[224:227], v[248:251]
s_waitcnt vmcnt(11) lgkmcnt(0)
s_barrier
v_mfma_f32_16x16x32_bf16 v[252:255], a[216:219], a[232:235], v[252:255]
s_add_u32 m0, s76, 0
s_add_u32 s79, s36, 0
ds_read_b64_tr_b16 a[224:225], v10 offset:24576
v_mfma_f32_16x16x32_bf16 v[252:255], a[220:223], a[236:239], v[252:255]
ds_read_b64_tr_b16 a[226:227], v10 offset:24832
v_mfma_f32_16x16x32_bf16 v[228:231], a[212:215], a[236:239], v[228:231]
ds_read_b64_tr_b16 a[228:229], v10 offset:28672
v_mfma_f32_16x16x32_bf16 v[228:231], a[208:211], a[232:235], v[228:231]
ds_read_b64_tr_b16 a[230:231], v10 offset:28928
v_mfma_f32_16x16x32_bf16 a[140:143], a[200:203], a[232:235], a[140:143]
buffer_load_dwordx4 v1, s[4:7], s79 offen lds
v_mfma_f32_16x16x32_bf16 a[140:143], a[204:207], a[236:239], a[140:143]
s_add_u32 m0, s76, 4096
s_add_u32 s79, s36, 65536
ds_read_b128 v[58:61], v6 offset:32768
v_mfma_f32_16x16x32_bf16 a[116:119], a[196:199], a[236:239], a[116:119]
v_mfma_f32_16x16x32_bf16 a[116:119], a[192:195], a[232:235], a[116:119]
v_mfma_f32_16x16x32_bf16 a[92:95], a[184:187], a[232:235], a[92:95]
ds_read_b64_tr_b16 v[46:47], v78 offset:0
v_mfma_f32_16x16x32_bf16 a[92:95], a[188:191], a[236:239], a[92:95]
ds_read_b64_tr_b16 v[48:49], v78 offset:512
v_mfma_f32_16x16x32_bf16 a[68:71], a[180:183], a[236:239], a[68:71]
v_mfma_f32_16x16x32_bf16 a[68:71], a[176:179], a[232:235], a[68:71]
buffer_load_dwordx4 v1, s[4:7], s79 offen lds
v_mfma_f32_16x16x32_bf16 a[44:47], a[168:171], a[232:235], a[44:47]
s_sub_u32 s46, s46, 1
s_add_u32 m0, s76, 8192
ds_read_b128 v[62:65], v7 offset:32768
v_mfma_f32_16x16x32_bf16 a[44:47], a[172:175], a[236:239], a[44:47]
s_add_u32 s79, s36, 131072
v_mfma_f32_16x16x32_bf16 a[20:23], a[164:167], a[236:239], a[20:23]
v_mfma_f32_16x16x32_bf16 a[20:23], a[160:163], a[232:235], a[20:23]
s_waitcnt lgkmcnt(6)
v_mfma_f32_16x16x32_bf16 v[80:83], a[224:227], a[160:163], v[80:83]
s_waitcnt lgkmcnt(4)
ds_read_b64_tr_b16 a[232:233], v10 offset:32768
v_mfma_f32_16x16x32_bf16 v[80:83], a[228:231], a[164:167], v[80:83]
ds_read_b64_tr_b16 a[234:235], v10 offset:33024
v_mfma_f32_16x16x32_bf16 v[96:99], a[228:231], a[172:175], v[96:99]
buffer_load_dwordx4 v1, s[4:7], s79 offen lds
v_mfma_f32_16x16x32_bf16 v[96:99], a[224:227], a[168:171], v[96:99]
s_add_u32 m0, s76, 12288
s_add_u32 s79, s36, 196608
ds_read_b64_tr_b16 a[236:237], v10 offset:36864
v_mfma_f32_16x16x32_bf16 v[112:115], a[224:227], a[176:179], v[112:115]
ds_read_b64_tr_b16 a[238:239], v10 offset:37120
v_mfma_f32_16x16x32_bf16 v[112:115], a[228:231], a[180:183], v[112:115]
ds_read_b128 v[70:73], v7 offset:34816
v_mfma_f32_16x16x32_bf16 v[128:131], a[228:231], a[188:191], v[128:131]
v_mfma_f32_16x16x32_bf16 v[128:131], a[224:227], a[184:187], v[128:131]
v_mfma_f32_16x16x32_bf16 v[144:147], a[224:227], a[192:195], v[144:147]
ds_read_b64_tr_b16 v[50:51], v78 offset:4096
v_mfma_f32_16x16x32_bf16 v[144:147], a[228:231], a[196:199], v[144:147]
buffer_load_dwordx4 v1, s[4:7], s79 offen lds
v_mfma_f32_16x16x32_bf16 v[160:163], a[228:231], a[204:207], v[160:163]
s_add_u32 m0, s76, 16384
s_add_u32 s79, s36, 262144
ds_read_b64_tr_b16 v[52:53], v78 offset:4608
v_mfma_f32_16x16x32_bf16 v[160:163], a[224:227], a[200:203], v[160:163]
ds_read_b128 v[66:69], v6 offset:34816
v_mfma_f32_16x16x32_bf16 v[176:179], a[224:227], a[208:211], v[176:179]
v_mfma_f32_16x16x32_bf16 v[176:179], a[228:231], a[212:215], v[176:179]
v_mfma_f32_16x16x32_bf16 v[192:195], a[228:231], a[220:223], v[192:195]
v_mfma_f32_16x16x32_bf16 v[192:195], a[224:227], a[216:219], v[192:195]
s_waitcnt lgkmcnt(6)
v_mfma_f32_16x16x32_bf16 v[196:199], a[232:235], a[216:219], v[196:199]
s_waitcnt lgkmcnt(4)
buffer_load_dwordx4 v1, s[4:7], s79 offen lds
v_mfma_f32_16x16x32_bf16 v[196:199], a[236:239], a[220:223], v[196:199]
s_add_u32 m0, s76, 20480
s_add_u32 s79, s36, 327680
ds_read_b64_tr_b16 a[224:225], v11 offset:24576
v_mfma_f32_16x16x32_bf16 v[180:183], a[236:239], a[212:215], v[180:183]
ds_read_b64_tr_b16 a[226:227], v11 offset:24832
v_mfma_f32_16x16x32_bf16 v[180:183], a[232:235], a[208:211], v[180:183]
ds_read_b64_tr_b16 a[228:229], v11 offset:28672
v_mfma_f32_16x16x32_bf16 v[164:167], a[232:235], a[200:203], v[164:167]
ds_read_b64_tr_b16 a[230:231], v11 offset:28928
v_mfma_f32_16x16x32_bf16 v[164:167], a[236:239], a[204:207], v[164:167]
ds_read_b128 a[240:243], v6 offset:36864
v_mfma_f32_16x16x32_bf16 v[148:151], a[236:239], a[196:199], v[148:151]
v_mfma_f32_16x16x32_bf16 v[148:151], a[232:235], a[192:195], v[148:151]
buffer_load_dwordx4 v1, s[4:7], s79 offen lds
v_mfma_f32_16x16x32_bf16 v[132:135], a[232:235], a[184:187], v[132:135]
s_add_u32 m0, s76, 24576
s_add_u32 s79, s36, 393216
ds_read_b128 a[244:247], v7 offset:36864
v_mfma_f32_16x16x32_bf16 v[132:135], a[236:239], a[188:191], v[132:135]
v_mfma_f32_16x16x32_bf16 v[116:119], a[236:239], a[180:183], v[116:119]
v_mfma_f32_16x16x32_bf16 v[116:119], a[232:235], a[176:179], v[116:119]
v_mfma_f32_16x16x32_bf16 v[100:103], a[232:235], a[168:171], v[100:103]
v_mfma_f32_16x16x32_bf16 v[100:103], a[236:239], a[172:175], v[100:103]
v_mfma_f32_16x16x32_bf16 v[84:87], a[236:239], a[164:167], v[84:87]
buffer_load_dwordx4 v1, s[4:7], s79 offen lds
v_mfma_f32_16x16x32_bf16 v[84:87], a[232:235], a[160:163], v[84:87]
s_waitcnt lgkmcnt(4)
s_add_u32 m0, s76, 28672
ds_read_b128 a[252:255], v7 offset:38912
v_mfma_f32_16x16x32_bf16 v[88:91], a[224:227], a[160:163], v[88:91]
s_waitcnt lgkmcnt(3)
s_add_u32 s79, s36, 458752
ds_read_b64_tr_b16 a[232:233], v11 offset:32768
v_mfma_f32_16x16x32_bf16 v[88:91], a[228:231], a[164:167], v[88:91]
ds_read_b64_tr_b16 a[234:235], v11 offset:33024
v_mfma_f32_16x16x32_bf16 v[104:107], a[228:231], a[172:175], v[104:107]
ds_read_b64_tr_b16 a[236:237], v11 offset:36864
v_mfma_f32_16x16x32_bf16 v[104:107], a[224:227], a[168:171], v[104:107]
ds_read_b64_tr_b16 a[238:239], v11 offset:37120
v_mfma_f32_16x16x32_bf16 v[120:123], a[224:227], a[176:179], v[120:123]
v_mfma_f32_16x16x32_bf16 v[120:123], a[228:231], a[180:183], v[120:123]
buffer_load_dwordx4 v1, s[4:7], s79 offen lds
v_mfma_f32_16x16x32_bf16 v[136:139], a[228:231], a[188:191], v[136:139]
s_add_u32 s36, s36, 128
s_add_u32 m0, s76, 65536
ds_read_b128 a[248:251], v6 offset:38912
v_mfma_f32_16x16x32_bf16 v[136:139], a[224:227], a[184:187], v[136:139]
v_mfma_f32_16x16x32_bf16 v[152:155], a[224:227], a[192:195], v[152:155]
v_mfma_f32_16x16x32_bf16 v[152:155], a[228:231], a[196:199], v[152:155]
v_mfma_f32_16x16x32_bf16 v[168:171], a[228:231], a[204:207], v[168:171]
v_mfma_f32_16x16x32_bf16 v[168:171], a[224:227], a[200:203], v[168:171]
v_mfma_f32_16x16x32_bf16 v[184:187], a[224:227], a[208:211], v[184:187]
buffer_load_dwordx4 v3, s[16:19], s39 offen lds
v_mfma_f32_16x16x32_bf16 v[184:187], a[228:231], a[212:215], v[184:187]
s_add_u32 m0, s76, 71680
v_mfma_f32_16x16x32_bf16 v[200:203], a[228:231], a[220:223], v[200:203]
v_mfma_f32_16x16x32_bf16 v[200:203], a[224:227], a[216:219], v[200:203]
s_waitcnt vmcnt(10) lgkmcnt(1)
s_barrier
v_mfma_f32_16x16x32_bf16 v[204:207], a[232:235], a[216:219], v[204:207]
ds_read_b64_tr_b16 a[224:225], v12 offset:0
v_mfma_f32_16x16x32_bf16 v[204:207], a[236:239], a[220:223], v[204:207]
ds_read_b64_tr_b16 a[226:227], v12 offset:256
v_mfma_f32_16x16x32_bf16 v[188:191], a[236:239], a[212:215], v[188:191]
ds_read_b64_tr_b16 a[228:229], v12 offset:4096
v_mfma_f32_16x16x32_bf16 v[188:191], a[232:235], a[208:211], v[188:191]
buffer_load_dwordx4 v3, s[16:19], s39 offen offset:2048 lds
v_mfma_f32_16x16x32_bf16 v[172:175], a[232:235], a[200:203], v[172:175]
s_add_u32 m0, s76, 81920
s_add_u32 s79, s39, 4096
ds_read_b64_tr_b16 a[230:231], v12 offset:4352
v_mfma_f32_16x16x32_bf16 v[172:175], a[236:239], a[204:207], v[172:175]
v_mfma_f32_16x16x32_bf16 v[156:159], a[236:239], a[196:199], v[156:159]
v_mfma_f32_16x16x32_bf16 v[156:159], a[232:235], a[192:195], v[156:159]
ds_read_b128 a[192:195], v6 offset:40960
v_mfma_f32_16x16x32_bf16 v[140:143], a[232:235], a[184:187], v[140:143]
ds_read_b128 a[196:199], v7 offset:40960
v_mfma_f32_16x16x32_bf16 v[140:143], a[236:239], a[188:191], v[140:143]
ds_read_b128 a[204:207], v7 offset:43008
v_mfma_f32_16x16x32_bf16 v[124:127], a[236:239], a[180:183], v[124:127]
buffer_load_dwordx4 v3, s[16:19], s79 offen lds
v_mfma_f32_16x16x32_bf16 v[124:127], a[232:235], a[176:179], v[124:127]
s_add_u32 m0, s76, 69632
s_add_u32 s79, s39, 196608
ds_read_b128 a[200:203], v6 offset:43008
v_mfma_f32_16x16x32_bf16 v[108:111], a[232:235], a[168:171], v[108:111]
ds_read_b128 a[208:211], v6 offset:45056
v_mfma_f32_16x16x32_bf16 v[108:111], a[236:239], a[172:175], v[108:111]
ds_read_b128 a[212:215], v7 offset:45056
v_mfma_f32_16x16x32_bf16 v[92:95], a[236:239], a[164:167], v[92:95]
v_mfma_f32_16x16x32_bf16 v[92:95], a[232:235], a[160:163], v[92:95]
s_waitcnt lgkmcnt(8)
v_mfma_f32_16x16x32_bf16 a[0:3], a[224:227], v[58:61], a[0:3]
s_waitcnt lgkmcnt(6)
ds_read_b128 a[220:223], v7 offset:47104
v_mfma_f32_16x16x32_bf16 a[0:3], a[228:231], v[62:65], a[0:3]
buffer_load_dwordx4 v3, s[16:19], s79 offen lds
v_mfma_f32_16x16x32_bf16 a[24:27], a[228:231], v[70:73], a[24:27]
s_add_u32 m0, s76, 75776
ds_read_b128 a[216:219], v6 offset:47104
v_mfma_f32_16x16x32_bf16 a[24:27], a[224:227], v[66:69], a[24:27]
ds_read_b64_tr_b16 a[232:233], v13 offset:0
v_mfma_f32_16x16x32_bf16 a[48:51], a[224:227], a[240:243], a[48:51]
ds_read_b64_tr_b16 a[234:235], v13 offset:256
v_mfma_f32_16x16x32_bf16 a[48:51], a[228:231], a[244:247], a[48:51]
ds_read_b64_tr_b16 a[236:237], v13 offset:4096
v_mfma_f32_16x16x32_bf16 a[72:75], a[228:231], a[252:255], a[72:75]
ds_read_b64_tr_b16 a[238:239], v13 offset:4352
v_mfma_f32_16x16x32_bf16 a[72:75], a[224:227], a[248:251], a[72:75]
s_waitcnt lgkmcnt(11)
v_mfma_f32_16x16x32_bf16 a[96:99], a[224:227], a[192:195], a[96:99]
s_waitcnt lgkmcnt(10)
buffer_load_dwordx4 v3, s[16:19], s79 offen offset:2048 lds
v_mfma_f32_16x16x32_bf16 a[96:99], a[228:231], a[196:199], a[96:99]
s_waitcnt lgkmcnt(9)
s_add_u32 m0, s76, 86016
s_add_u32 s79, s39, 200704
v_mfma_f32_16x16x32_bf16 a[120:123], a[228:231], a[204:207], a[120:123]
s_waitcnt lgkmcnt(8)
v_mfma_f32_16x16x32_bf16 a[120:123], a[224:227], a[200:203], a[120:123]
s_waitcnt lgkmcnt(7)
v_mfma_f32_16x16x32_bf16 v[208:211], a[224:227], a[208:211], v[208:211]
s_waitcnt lgkmcnt(6)
v_mfma_f32_16x16x32_bf16 v[208:211], a[228:231], a[212:215], v[208:211]
s_waitcnt lgkmcnt(5)
v_mfma_f32_16x16x32_bf16 v[232:235], a[228:231], a[220:223], v[232:235]
s_waitcnt lgkmcnt(4)
v_mfma_f32_16x16x32_bf16 v[232:235], a[224:227], a[216:219], v[232:235]
s_waitcnt lgkmcnt(2)
buffer_load_dwordx4 v3, s[16:19], s79 offen lds
v_mfma_f32_16x16x32_bf16 v[236:239], a[232:235], a[216:219], v[236:239]
s_waitcnt lgkmcnt(0)
s_add_u32 s39, s39, 393216
ds_read_b64_tr_b16 a[224:225], v12 offset:8192
v_mfma_f32_16x16x32_bf16 v[236:239], a[236:239], a[220:223], v[236:239]
s_add_u32 m0, s76, 90112
ds_read_b64_tr_b16 a[226:227], v12 offset:8448
v_mfma_f32_16x16x32_bf16 v[212:215], a[236:239], a[212:215], v[212:215]
ds_read_b64_tr_b16 a[228:229], v12 offset:12288
v_mfma_f32_16x16x32_bf16 v[212:215], a[232:235], a[208:211], v[212:215]
ds_read_b64_tr_b16 a[230:231], v12 offset:12544
v_mfma_f32_16x16x32_bf16 a[124:127], a[232:235], a[200:203], a[124:127]
v_mfma_f32_16x16x32_bf16 a[124:127], a[236:239], a[204:207], a[124:127]
v_mfma_f32_16x16x32_bf16 a[100:103], a[236:239], a[196:199], a[100:103]
buffer_load_dwordx4 v2, s[8:11], s38 offen lds
v_mfma_f32_16x16x32_bf16 a[100:103], a[232:235], a[192:195], a[100:103]
s_add_u32 m0, s76, 98304
ds_read_b64_tr_b16 a[148:149], v8 offset:40960
v_mfma_f32_16x16x32_bf16 a[76:79], a[232:235], a[248:251], a[76:79]
ds_read_b64_tr_b16 a[150:151], v8 offset:41216
v_mfma_f32_16x16x32_bf16 a[76:79], a[236:239], a[252:255], a[76:79]
v_mfma_f32_16x16x32_bf16 a[52:55], a[236:239], a[244:247], a[52:55]
v_mfma_f32_16x16x32_bf16 a[52:55], a[232:235], a[240:243], a[52:55]
v_mfma_f32_16x16x32_bf16 a[28:31], a[232:235], v[66:69], a[28:31]
v_mfma_f32_16x16x32_bf16 a[28:31], a[236:239], v[70:73], a[28:31]
buffer_load_dwordx4 v2, s[12:15], s38 offen lds
v_mfma_f32_16x16x32_bf16 a[4:7], a[236:239], v[62:65], a[4:7]
s_add_u32 m0, s76, 94208
s_add_u32 s79, s38, 229376
v_mfma_f32_16x16x32_bf16 a[4:7], a[232:235], v[58:61], a[4:7]
s_waitcnt lgkmcnt(4)
v_mfma_f32_16x16x32_bf16 a[8:11], a[224:227], v[58:61], a[8:11]
s_waitcnt lgkmcnt(2)
ds_read_b64_tr_b16 a[232:233], v13 offset:8192
v_mfma_f32_16x16x32_bf16 a[8:11], a[228:231], v[62:65], a[8:11]
ds_read_b64_tr_b16 a[234:235], v13 offset:8448
v_mfma_f32_16x16x32_bf16 a[32:35], a[228:231], v[70:73], a[32:35]
ds_read_b64_tr_b16 a[236:237], v13 offset:12288
v_mfma_f32_16x16x32_bf16 a[32:35], a[224:227], v[66:69], a[32:35]
ds_read_b64_tr_b16 a[238:239], v13 offset:12544
v_mfma_f32_16x16x32_bf16 a[56:59], a[224:227], a[240:243], a[56:59]
buffer_load_dwordx4 v2, s[8:11], s79 offen lds
v_mfma_f32_16x16x32_bf16 a[56:59], a[228:231], a[244:247], a[56:59]
s_add_u32 m0, s76, 102400
v_mfma_f32_16x16x32_bf16 a[80:83], a[228:231], a[252:255], a[80:83]
v_mfma_f32_16x16x32_bf16 a[80:83], a[224:227], a[248:251], a[80:83]
s_waitcnt lgkmcnt(4)
v_mfma_f32_16x16x32_bf16 a[144:147], a[152:155], a[148:151], a[144:147]
v_mfma_f32_16x16x32_bf16 a[104:107], a[224:227], a[192:195], a[104:107]
v_mfma_f32_16x16x32_bf16 a[104:107], a[228:231], a[196:199], a[104:107]
v_mfma_f32_16x16x32_bf16 a[128:131], a[228:231], a[204:207], a[128:131]
buffer_load_dwordx4 v2, s[12:15], s79 offen lds
v_mfma_f32_16x16x32_bf16 a[128:131], a[224:227], a[200:203], a[128:131]
s_add_u32 s38, s38, 458752
s_add_u32 m0, s76, 147456
v_mfma_f32_16x16x32_bf16 v[216:219], a[224:227], a[208:211], v[216:219]
v_mfma_f32_16x16x32_bf16 v[216:219], a[228:231], a[212:215], v[216:219]
v_mfma_f32_16x16x32_bf16 v[240:243], a[228:231], a[220:223], v[240:243]
v_mfma_f32_16x16x32_bf16 v[240:243], a[224:227], a[216:219], v[240:243]
s_waitcnt lgkmcnt(2)
v_mfma_f32_16x16x32_bf16 v[244:247], a[232:235], a[216:219], v[244:247]
s_waitcnt lgkmcnt(0)
ds_read_b64_tr_b16 a[224:225], v12 offset:16384
v_mfma_f32_16x16x32_bf16 v[244:247], a[236:239], a[220:223], v[244:247]
buffer_load_dwordx4 v4, s[60:63], s68 offen nt lds
v_mfma_f32_16x16x32_bf16 v[220:223], a[236:239], a[212:215], v[220:223]
s_add_u32 s68, s68, 0x20000
ds_read_b64_tr_b16 a[226:227], v12 offset:16640
v_and_b32_e64 v76, 32, v0
v_mfma_f32_16x16x32_bf16 v[220:223], a[232:235], a[208:211], v[220:223]
s_lshl_b32 s79, s58, 14
ds_read_b64_tr_b16 a[228:229], v12 offset:20480
v_mfma_f32_16x16x32_bf16 a[132:135], a[232:235], a[200:203], a[132:135]
ds_read_b64_tr_b16 a[230:231], v12 offset:20736
v_mfma_f32_16x16x32_bf16 a[132:135], a[236:239], a[204:207], a[132:135]
s_cmp_eq_u32 s46, 4
s_cselect_b32 s79, s79, 0
s_cselect_b32 s78, -512, 0
v_mfma_f32_16x16x32_bf16 a[108:111], a[236:239], a[196:199], a[108:111]
s_add_u32 s79, s79, s68
v_mad_i32_i24 v76, v76, s78, v4
s_add_u32 m0, s76, 151552
v_mfma_f32_16x16x32_bf16 a[108:111], a[232:235], a[192:195], a[108:111]
v_mfma_f32_16x16x32_bf16 a[84:87], a[232:235], a[248:251], a[84:87]
buffer_load_dwordx4 v76, s[60:63], s79 offen nt lds
v_mfma_f32_16x16x32_bf16 a[84:87], a[236:239], a[252:255], a[84:87]
s_add_u32 s68, s68, 0x20000
v_mfma_f32_16x16x32_bf16 a[60:63], a[236:239], a[244:247], a[60:63]
v_mfma_f32_16x16x32_bf16 a[60:63], a[232:235], a[240:243], a[60:63]
v_mfma_f32_16x16x32_bf16 a[36:39], a[232:235], v[66:69], a[36:39]
v_mfma_f32_16x16x32_bf16 a[36:39], a[236:239], v[70:73], a[36:39]
v_mfma_f32_16x16x32_bf16 a[12:15], a[236:239], v[62:65], a[12:15]
v_mfma_f32_16x16x32_bf16 a[12:15], a[232:235], v[58:61], a[12:15]
s_waitcnt lgkmcnt(2)
buffer_store_dwordx4 v[46:49], v79, s[64:67], s69 offen sc1
v_mfma_f32_16x16x32_bf16 a[16:19], v[58:61], a[224:227], a[16:19]
s_waitcnt lgkmcnt(0)
s_add_u32 s69, s69, 0x100000
ds_read_b64_tr_b16 a[232:233], v13 offset:16384
v_mfma_f32_16x16x32_bf16 a[16:19], v[62:65], a[228:231], a[16:19]
ds_read_b64_tr_b16 a[234:235], v13 offset:16640
v_mfma_f32_16x16x32_bf16 a[40:43], v[70:73], a[228:231], a[40:43]
ds_read_b64_tr_b16 a[236:237], v13 offset:20480
v_mfma_f32_16x16x32_bf16 a[40:43], v[66:69], a[224:227], a[40:43]
ds_read_b64_tr_b16 a[238:239], v13 offset:20736
v_mfma_f32_16x16x32_bf16 a[64:67], a[240:243], a[224:227], a[64:67]
v_mfma_f32_16x16x32_bf16 a[64:67], a[244:247], a[228:231], a[64:67]
v_mfma_f32_16x16x32_bf16 a[88:91], a[252:255], a[228:231], a[88:91]
buffer_store_dwordx4 v[50:53], v79, s[64:67], s69 offen sc1
v_mfma_f32_16x16x32_bf16 a[88:91], a[248:251], a[224:227], a[88:91]
s_add_u32 s69, s69, 0x100000
v_mfma_f32_16x16x32_bf16 a[112:115], a[192:195], a[224:227], a[112:115]
v_mfma_f32_16x16x32_bf16 a[112:115], a[196:199], a[228:231], a[112:115]
v_mfma_f32_16x16x32_bf16 a[136:139], a[204:207], a[228:231], a[136:139]
v_mfma_f32_16x16x32_bf16 a[136:139], a[200:203], a[224:227], a[136:139]
v_mfma_f32_16x16x32_bf16 v[224:227], a[208:211], a[224:227], v[224:227]
v_mfma_f32_16x16x32_bf16 v[224:227], a[212:215], a[228:231], v[224:227]
v_mfma_f32_16x16x32_bf16 v[248:251], a[220:223], a[228:231], v[248:251]
v_mfma_f32_16x16x32_bf16 v[248:251], a[216:219], a[224:227], v[248:251]
s_waitcnt vmcnt(14) lgkmcnt(0)
s_barrier
v_mfma_f32_16x16x32_bf16 v[252:255], a[216:219], a[232:235], v[252:255]
s_sub_u32 s56, s56, 1
ds_read_b64_tr_b16 a[224:225], v12 offset:24576
v_mfma_f32_16x16x32_bf16 v[252:255], a[220:223], a[236:239], v[252:255]
s_cmp_eq_u32 s56, 0
s_cselect_b32 s78, -960, 64
ds_read_b64_tr_b16 a[226:227], v12 offset:24832
v_mfma_f32_16x16x32_bf16 v[228:231], a[212:215], a[236:239], v[228:231]
s_add_u32 m0, s76, 32768
s_add_u32 s79, s36, 0
ds_read_b64_tr_b16 a[228:229], v12 offset:28672
v_mfma_f32_16x16x32_bf16 v[228:231], a[208:211], a[232:235], v[228:231]
ds_read_b64_tr_b16 a[230:231], v12 offset:28928
v_mfma_f32_16x16x32_bf16 a[140:143], a[200:203], a[232:235], a[140:143]
buffer_load_dwordx4 v1, s[4:7], s79 offen lds
v_mfma_f32_16x16x32_bf16 a[140:143], a[204:207], a[236:239], a[140:143]
s_add_u32 m0, s76, 36864
s_add_u32 s79, s36, 65536
ds_read_b128 a[160:163], v6 offset:0
v_mfma_f32_16x16x32_bf16 a[116:119], a[196:199], a[236:239], a[116:119]
v_mfma_f32_16x16x32_bf16 a[116:119], a[192:195], a[232:235], a[116:119]
v_mfma_f32_16x16x32_bf16 a[92:95], a[248:251], a[232:235], a[92:95]
v_mfma_f32_16x16x32_bf16 a[92:95], a[252:255], a[236:239], a[92:95]
v_mfma_f32_16x16x32_bf16 a[68:71], a[244:247], a[236:239], a[68:71]
v_mfma_f32_16x16x32_bf16 a[68:71], a[240:243], a[232:235], a[68:71]
buffer_load_dwordx4 v1, s[4:7], s79 offen lds
v_mfma_f32_16x16x32_bf16 a[44:47], v[66:69], a[232:235], a[44:47]
s_add_u32 m0, s76, 40960
s_add_u32 s79, s36, 131072
ds_read_b128 a[164:167], v7 offset:0
v_mfma_f32_16x16x32_bf16 a[44:47], v[70:73], a[236:239], a[44:47]
v_mfma_f32_16x16x32_bf16 a[20:23], v[62:65], a[236:239], a[20:23]
v_mfma_f32_16x16x32_bf16 a[20:23], v[58:61], a[232:235], a[20:23]
s_waitcnt lgkmcnt(4)
v_mfma_f32_16x16x32_bf16 v[80:83], a[224:227], v[58:61], v[80:83]
s_waitcnt lgkmcnt(2)
ds_read_b64_tr_b16 a[232:233], v12 offset:32768
v_mfma_f32_16x16x32_bf16 v[80:83], a[228:231], v[62:65], v[80:83]
ds_read_b64_tr_b16 a[234:235], v12 offset:33024
v_mfma_f32_16x16x32_bf16 v[96:99], a[228:231], v[70:73], v[96:99]
buffer_load_dwordx4 v1, s[4:7], s79 offen lds
v_mfma_f32_16x16x32_bf16 v[96:99], a[224:227], v[66:69], v[96:99]
s_add_u32 m0, s76, 45056
s_add_u32 s79, s36, 196608
ds_read_b64_tr_b16 a[236:237], v12 offset:36864
v_mfma_f32_16x16x32_bf16 v[112:115], a[224:227], a[240:243], v[112:115]
ds_read_b64_tr_b16 a[238:239], v12 offset:37120
v_mfma_f32_16x16x32_bf16 v[112:115], a[228:231], a[244:247], v[112:115]
ds_read_b128 a[172:175], v7 offset:2048
v_mfma_f32_16x16x32_bf16 v[128:131], a[228:231], a[252:255], v[128:131]
v_mfma_f32_16x16x32_bf16 v[128:131], a[224:227], a[248:251], v[128:131]
v_mfma_f32_16x16x32_bf16 v[144:147], a[224:227], a[192:195], v[144:147]
v_mfma_f32_16x16x32_bf16 v[144:147], a[228:231], a[196:199], v[144:147]
buffer_load_dwordx4 v1, s[4:7], s79 offen lds
v_mfma_f32_16x16x32_bf16 v[160:163], a[228:231], a[204:207], v[160:163]
s_add_u32 m0, s76, 49152
s_add_u32 s79, s36, 262144
ds_read_b128 a[168:171], v6 offset:2048
v_mfma_f32_16x16x32_bf16 v[160:163], a[224:227], a[200:203], v[160:163]
v_mfma_f32_16x16x32_bf16 v[176:179], a[224:227], a[208:211], v[176:179]
v_mfma_f32_16x16x32_bf16 v[176:179], a[228:231], a[212:215], v[176:179]
v_mfma_f32_16x16x32_bf16 v[192:195], a[228:231], a[220:223], v[192:195]
v_mfma_f32_16x16x32_bf16 v[192:195], a[224:227], a[216:219], v[192:195]
s_waitcnt lgkmcnt(4)
v_mfma_f32_16x16x32_bf16 v[196:199], a[232:235], a[216:219], v[196:199]
s_waitcnt lgkmcnt(2)
buffer_load_dwordx4 v1, s[4:7], s79 offen lds
v_mfma_f32_16x16x32_bf16 v[196:199], a[236:239], a[220:223], v[196:199]
s_add_u32 m0, s76, 53248
s_add_u32 s79, s36, 327680
ds_read_b64_tr_b16 a[224:225], v13 offset:24576
v_mfma_f32_16x16x32_bf16 v[180:183], a[236:239], a[212:215], v[180:183]
ds_read_b64_tr_b16 a[226:227], v13 offset:24832
v_mfma_f32_16x16x32_bf16 v[180:183], a[232:235], a[208:211], v[180:183]
ds_read_b64_tr_b16 a[228:229], v13 offset:28672
v_mfma_f32_16x16x32_bf16 v[164:167], a[232:235], a[200:203], v[164:167]
ds_read_b64_tr_b16 a[230:231], v13 offset:28928
v_mfma_f32_16x16x32_bf16 v[164:167], a[236:239], a[204:207], v[164:167]
ds_read_b128 a[176:179], v6 offset:4096
v_mfma_f32_16x16x32_bf16 v[148:151], a[236:239], a[196:199], v[148:151]
v_mfma_f32_16x16x32_bf16 v[148:151], a[232:235], a[192:195], v[148:151]
buffer_load_dwordx4 v1, s[4:7], s79 offen lds
v_mfma_f32_16x16x32_bf16 v[132:135], a[232:235], a[248:251], v[132:135]
s_add_u32 m0, s76, 57344
s_add_u32 s79, s36, 393216
ds_read_b128 a[180:183], v7 offset:4096
v_mfma_f32_16x16x32_bf16 v[132:135], a[236:239], a[252:255], v[132:135]
v_mfma_f32_16x16x32_bf16 v[116:119], a[236:239], a[244:247], v[116:119]
v_mfma_f32_16x16x32_bf16 v[116:119], a[232:235], a[240:243], v[116:119]
v_mfma_f32_16x16x32_bf16 v[100:103], a[232:235], v[66:69], v[100:103]
v_mfma_f32_16x16x32_bf16 v[100:103], a[236:239], v[70:73], v[100:103]
v_mfma_f32_16x16x32_bf16 v[84:87], a[236:239], v[62:65], v[84:87]
buffer_load_dwordx4 v1, s[4:7], s79 offen lds
v_mfma_f32_16x16x32_bf16 v[84:87], a[232:235], v[58:61], v[84:87]
s_waitcnt lgkmcnt(4)
s_add_u32 m0, s76, 61440
ds_read_b128 a[188:191], v7 offset:6144
v_mfma_f32_16x16x32_bf16 v[88:91], a[224:227], v[58:61], v[88:91]
s_waitcnt lgkmcnt(3)
s_add_u32 s79, s36, 458752
ds_read_b64_tr_b16 a[232:233], v13 offset:32768
v_mfma_f32_16x16x32_bf16 v[88:91], a[228:231], v[62:65], v[88:91]
ds_read_b64_tr_b16 a[234:235], v13 offset:33024
v_mfma_f32_16x16x32_bf16 v[104:107], a[228:231], v[70:73], v[104:107]
ds_read_b64_tr_b16 a[236:237], v13 offset:36864
v_mfma_f32_16x16x32_bf16 v[104:107], a[224:227], v[66:69], v[104:107]
ds_read_b64_tr_b16 a[238:239], v13 offset:37120
v_mfma_f32_16x16x32_bf16 v[120:123], a[224:227], a[240:243], v[120:123]
v_mfma_f32_16x16x32_bf16 v[120:123], a[228:231], a[244:247], v[120:123]
buffer_load_dwordx4 v1, s[4:7], s79 offen lds
v_mfma_f32_16x16x32_bf16 v[136:139], a[228:231], a[252:255], v[136:139]
s_lshl1_add_u32 s36, s78, s36
s_add_u32 m0, s76, 106496
ds_read_b128 a[184:187], v6 offset:6144
v_mfma_f32_16x16x32_bf16 v[136:139], a[224:227], a[248:251], v[136:139]
v_mfma_f32_16x16x32_bf16 v[152:155], a[224:227], a[192:195], v[152:155]
v_mfma_f32_16x16x32_bf16 v[152:155], a[228:231], a[196:199], v[152:155]
v_mfma_f32_16x16x32_bf16 v[168:171], a[228:231], a[204:207], v[168:171]
v_mfma_f32_16x16x32_bf16 v[168:171], a[224:227], a[200:203], v[168:171]
v_mfma_f32_16x16x32_bf16 v[184:187], a[224:227], a[208:211], v[184:187]
buffer_load_dwordx4 v3, s[16:19], s39 offen lds
v_mfma_f32_16x16x32_bf16 v[184:187], a[228:231], a[212:215], v[184:187]
s_add_u32 m0, s76, 112640
v_mfma_f32_16x16x32_bf16 v[200:203], a[228:231], a[220:223], v[200:203]
v_mfma_f32_16x16x32_bf16 v[200:203], a[224:227], a[216:219], v[200:203]
s_waitcnt vmcnt(13) lgkmcnt(1)
s_barrier
v_mfma_f32_16x16x32_bf16 v[204:207], a[232:235], a[216:219], v[204:207]
ds_read_b64_tr_b16 a[224:225], v10 offset:0
v_mfma_f32_16x16x32_bf16 v[204:207], a[236:239], a[220:223], v[204:207]
ds_read_b64_tr_b16 a[226:227], v10 offset:256
v_mfma_f32_16x16x32_bf16 v[188:191], a[236:239], a[212:215], v[188:191]
ds_read_b64_tr_b16 a[228:229], v10 offset:4096
v_mfma_f32_16x16x32_bf16 v[188:191], a[232:235], a[208:211], v[188:191]
buffer_load_dwordx4 v3, s[16:19], s39 offen offset:2048 lds
v_mfma_f32_16x16x32_bf16 v[172:175], a[232:235], a[200:203], v[172:175]
s_add_u32 m0, s76, 122880
s_add_u32 s79, s39, 4096
ds_read_b64_tr_b16 a[230:231], v10 offset:4352
v_mfma_f32_16x16x32_bf16 v[172:175], a[236:239], a[204:207], v[172:175]
v_mfma_f32_16x16x32_bf16 v[156:159], a[236:239], a[196:199], v[156:159]
v_mfma_f32_16x16x32_bf16 v[156:159], a[232:235], a[192:195], v[156:159]
ds_read_b128 a[192:195], v6 offset:8192
v_mfma_f32_16x16x32_bf16 v[140:143], a[232:235], a[248:251], v[140:143]
ds_read_b128 a[196:199], v7 offset:8192
v_mfma_f32_16x16x32_bf16 v[140:143], a[236:239], a[252:255], v[140:143]
ds_read_b128 a[204:207], v7 offset:10240
v_mfma_f32_16x16x32_bf16 v[124:127], a[236:239], a[244:247], v[124:127]
buffer_load_dwordx4 v3, s[16:19], s79 offen lds
v_mfma_f32_16x16x32_bf16 v[124:127], a[232:235], a[240:243], v[124:127]
s_add_u32 m0, s76, 110592
s_add_u32 s79, s39, 196608
ds_read_b128 a[200:203], v6 offset:10240
v_mfma_f32_16x16x32_bf16 v[108:111], a[232:235], v[66:69], v[108:111]
ds_read_b128 a[208:211], v6 offset:12288
v_mfma_f32_16x16x32_bf16 v[108:111], a[236:239], v[70:73], v[108:111]
ds_read_b128 a[212:215], v7 offset:12288
v_mfma_f32_16x16x32_bf16 v[92:95], a[236:239], v[62:65], v[92:95]
v_mfma_f32_16x16x32_bf16 v[92:95], a[232:235], v[58:61], v[92:95]
s_waitcnt lgkmcnt(8)
s_cmp_lg_u32 s46, 0
s_cbranch_scc1 L_g1_loop_1023
v_mfma_f32_16x16x32_bf16 a[0:3], a[224:227], a[160:163], a[0:3]
s_waitcnt lgkmcnt(6)
ds_read_b128 a[220:223], v7 offset:14336
v_mfma_f32_16x16x32_bf16 a[0:3], a[228:231], a[164:167], a[0:3]
buffer_load_dwordx4 v3, s[16:19], s79 offen lds
v_mfma_f32_16x16x32_bf16 a[24:27], a[228:231], a[172:175], a[24:27]
s_add_u32 m0, s76, 116736
ds_read_b128 a[216:219], v6 offset:14336
v_mov_b32_e64 v38, 0
v_mfma_f32_16x16x32_bf16 a[24:27], a[224:227], a[168:171], a[24:27]
ds_read_b64_tr_b16 a[232:233], v11 offset:0
v_mfma_f32_16x16x32_bf16 a[48:51], a[224:227], a[176:179], a[48:51]
ds_read_b64_tr_b16 a[234:235], v11 offset:256
v_mfma_f32_16x16x32_bf16 a[48:51], a[228:231], a[180:183], a[48:51]
ds_read_b64_tr_b16 a[236:237], v11 offset:4096
v_mov_b32_e64 v39, 0
v_mfma_f32_16x16x32_bf16 a[72:75], a[228:231], a[188:191], a[72:75]
ds_read_b64_tr_b16 a[238:239], v11 offset:4352
v_mfma_f32_16x16x32_bf16 a[72:75], a[224:227], a[184:187], a[72:75]
s_waitcnt lgkmcnt(11)
ds_read_b32 v16, v17 offset:0
v_mfma_f32_16x16x32_bf16 a[96:99], a[224:227], a[192:195], a[96:99]
s_waitcnt lgkmcnt(11)
buffer_load_dwordx4 v3, s[16:19], s79 offen offset:2048 lds
v_mfma_f32_16x16x32_bf16 a[96:99], a[228:231], a[196:199], a[96:99]
s_waitcnt lgkmcnt(10)
s_add_u32 m0, s76, 126976
s_add_u32 s79, s39, 200704
v_mfma_f32_16x16x32_bf16 a[120:123], a[228:231], a[204:207], a[120:123]
s_waitcnt lgkmcnt(9)
v_mov_b32_e64 v51, 0
v_mfma_f32_16x16x32_bf16 a[120:123], a[224:227], a[200:203], a[120:123]
s_waitcnt lgkmcnt(8)
v_mfma_f32_16x16x32_bf16 v[208:211], a[224:227], a[208:211], v[208:211]
s_waitcnt lgkmcnt(7)
v_mov_b32_e64 v52, 0
v_mfma_f32_16x16x32_bf16 v[208:211], a[228:231], a[212:215], v[208:211]
s_waitcnt lgkmcnt(6)
v_mfma_f32_16x16x32_bf16 v[232:235], a[228:231], a[220:223], v[232:235]
s_waitcnt lgkmcnt(5)
v_mfma_f32_16x16x32_bf16 v[232:235], a[224:227], a[216:219], v[232:235]
s_waitcnt lgkmcnt(3)
buffer_load_dwordx4 v3, s[16:19], s79 offen lds
v_mfma_f32_16x16x32_bf16 v[236:239], a[232:235], a[216:219], v[236:239]
s_waitcnt lgkmcnt(1)
s_mul_i32 s55, s78, 6144
ds_read_b64_tr_b16 a[224:225], v10 offset:8192
v_mfma_f32_16x16x32_bf16 v[236:239], a[236:239], a[220:223], v[236:239]
s_add_u32 s39, s39, s55
s_add_u32 m0, s76, 131072
ds_read_b64_tr_b16 a[226:227], v10 offset:8448
v_mfma_f32_16x16x32_bf16 v[212:215], a[236:239], a[212:215], v[212:215]
ds_read_b64_tr_b16 a[228:229], v10 offset:12288
v_mov_b32 v53, 0
v_mfma_f32_16x16x32_bf16 v[212:215], a[232:235], a[208:211], v[212:215]
ds_read_b64_tr_b16 a[230:231], v10 offset:12544
v_mov_b32_e64 v55, 0
v_mfma_f32_16x16x32_bf16 a[124:127], a[232:235], a[200:203], a[124:127]
v_mfma_f32_16x16x32_bf16 a[124:127], a[236:239], a[204:207], a[124:127]
v_mfma_f32_16x16x32_bf16 a[100:103], a[236:239], a[196:199], a[100:103]
buffer_load_dwordx4 v2, s[8:11], s38 offen lds
v_mfma_f32_16x16x32_bf16 a[100:103], a[232:235], a[192:195], a[100:103]
s_add_u32 m0, s76, 139264
ds_read_b64_tr_b16 a[148:149], v8 offset:0
v_mov_b32_e64 v56, 0
v_mfma_f32_16x16x32_bf16 a[76:79], a[232:235], a[184:187], a[76:79]
ds_read_b64_tr_b16 a[150:151], v8 offset:256
s_and_b32 s71, s3, 7
v_mfma_f32_16x16x32_bf16 a[76:79], a[236:239], a[188:191], a[76:79]
v_mfma_f32_16x16x32_bf16 a[52:55], a[236:239], a[180:183], a[52:55]
s_lshl_b32 s71, s71, 16
v_mov_b32_e64 v57, 0
v_mfma_f32_16x16x32_bf16 a[52:55], a[232:235], a[176:179], a[52:55]
v_mfma_f32_16x16x32_bf16 a[28:31], a[232:235], a[168:171], a[28:31]
s_xor_b32 s70, s70, s71
v_mfma_f32_16x16x32_bf16 a[28:31], a[236:239], a[172:175], a[28:31]
buffer_load_dwordx4 v2, s[12:15], s38 offen lds
v_mfma_f32_16x16x32_bf16 a[4:7], a[236:239], a[164:167], a[4:7]
s_add_u32 m0, s76, 135168
s_add_u32 s79, s38, 229376
s_lshl_b32 s71, s43, 14
v_mfma_f32_16x16x32_bf16 a[4:7], a[232:235], a[160:163], a[4:7]
s_waitcnt lgkmcnt(4)
v_mfma_f32_16x16x32_bf16 a[8:11], a[224:227], a[160:163], a[8:11]
s_waitcnt lgkmcnt(2)
ds_read_b64_tr_b16 a[232:233], v11 offset:8192
v_mfma_f32_16x16x32_bf16 a[8:11], a[228:231], a[164:167], a[8:11]
ds_read_b64_tr_b16 a[234:235], v11 offset:8448
s_add_u32 s70, s70, s71
v_mfma_f32_16x16x32_bf16 a[32:35], a[228:231], a[172:175], a[32:35]
ds_read_b64_tr_b16 a[236:237], v11 offset:12288
v_mfma_f32_16x16x32_bf16 a[32:35], a[224:227], a[168:171], a[32:35]
ds_read_b64_tr_b16 a[238:239], v11 offset:12544
s_mov_b32 s72, s64
v_mfma_f32_16x16x32_bf16 a[56:59], a[224:227], a[176:179], a[56:59]
buffer_load_dwordx4 v2, s[8:11], s79 offen lds
v_mfma_f32_16x16x32_bf16 a[56:59], a[228:231], a[180:183], a[56:59]
s_add_u32 m0, s76, 143360
s_mov_b32 s73, s65
v_mfma_f32_16x16x32_bf16 a[80:83], a[228:231], a[188:191], a[80:83]
v_mfma_f32_16x16x32_bf16 a[80:83], a[224:227], a[184:187], a[80:83]
s_waitcnt lgkmcnt(4)
v_mfma_f32_16x16x32_bf16 a[144:147], a[152:155], a[148:151], a[144:147]
s_mov_b32 s75, 0x00020000
v_mfma_f32_16x16x32_bf16 a[104:107], a[224:227], a[192:195], a[104:107]
v_mfma_f32_16x16x32_bf16 a[104:107], a[228:231], a[196:199], a[104:107]
v_lshlrev_b32_e64 v15, 7, v0
v_mfma_f32_16x16x32_bf16 a[128:131], a[228:231], a[204:207], a[128:131]
buffer_load_dwordx4 v2, s[12:15], s79 offen lds
v_mfma_f32_16x16x32_bf16 a[128:131], a[224:227], a[200:203], a[128:131]
s_mul_i32 s55, s78, 7168
s_add_u32 s38, s38, s55
v_mfma_f32_16x16x32_bf16 v[216:219], a[224:227], a[208:211], v[216:219]
s_cmp_ge_u32 s47, 6291456
s_cselect_b32 s78, 6291456, 0
s_sub_u32 s47, s47, s78
v_mfma_f32_16x16x32_bf16 v[216:219], a[228:231], a[212:215], v[216:219]
s_cmp_lt_u32 s46, 2
s_cselect_b32 s34, 0, s34
v_cmp_gt_u32 vcc, 32, v16
v_mfma_f32_16x16x32_bf16 v[240:243], a[228:231], a[220:223], v[240:243]
v_mfma_f32_16x16x32_bf16 v[240:243], a[224:227], a[216:219], v[240:243]
s_waitcnt lgkmcnt(2)
v_mfma_f32_16x16x32_bf16 v[244:247], a[232:235], a[216:219], v[244:247]
s_waitcnt lgkmcnt(0)
ds_read_b64_tr_b16 a[224:225], v10 offset:16384
v_mfma_f32_16x16x32_bf16 v[244:247], a[236:239], a[220:223], v[244:247]
buffer_load_dword v19, v18, s[32:35], s47 offen
v_mfma_f32_16x16x32_bf16 v[220:223], a[236:239], a[212:215], v[220:223]
s_add_u32 s47, s47, 786432
ds_read_b64_tr_b16 a[226:227], v10 offset:16640
v_mfma_f32_16x16x32_bf16 v[220:223], a[232:235], a[208:211], v[220:223]
ds_read_b64_tr_b16 a[228:229], v10 offset:20480
v_mfma_f32_16x16x32_bf16 a[132:135], a[232:235], a[200:203], a[132:135]
ds_read_b64_tr_b16 a[230:231], v10 offset:20736
v_mfma_f32_16x16x32_bf16 a[132:135], a[236:239], a[204:207], a[132:135]
s_cmp_eq_u64 vcc, 0
s_cselect_b32 s74, 0x900000, 0
s_cselect_b32 s49, 32, 0
v_mfma_f32_16x16x32_bf16 a[108:111], a[236:239], a[196:199], a[108:111]
s_add_u32 s71, s70, 8192
v_mfma_f32_16x16x32_bf16 a[108:111], a[232:235], a[192:195], a[108:111]
v_mfma_f32_16x16x32_bf16 a[84:87], a[232:235], a[184:187], a[84:87]
v_mfma_f32_16x16x32_bf16 a[84:87], a[236:239], a[188:191], a[84:87]
v_mfma_f32_16x16x32_bf16 a[60:63], a[236:239], a[180:183], a[60:63]
v_mfma_f32_16x16x32_bf16 a[60:63], a[232:235], a[176:179], a[60:63]
v_mfma_f32_16x16x32_bf16 a[36:39], a[232:235], a[168:171], a[36:39]
v_mfma_f32_16x16x32_bf16 a[36:39], a[236:239], a[172:175], a[36:39]
v_accvgpr_read_b32 v77, a144
v_mfma_f32_16x16x32_bf16 a[12:15], a[236:239], a[164:167], a[12:15]
v_mfma_f32_16x16x32_bf16 a[12:15], a[232:235], a[160:163], a[12:15]
s_waitcnt lgkmcnt(2)
v_or_b32_e64 v77, 1, v77
v_mfma_f32_16x16x32_bf16 a[16:19], a[160:163], a[224:227], a[16:19]
s_waitcnt lgkmcnt(0)
ds_read_b64_tr_b16 a[232:233], v11 offset:16384
v_mfma_f32_16x16x32_bf16 a[16:19], a[164:167], a[228:231], a[16:19]
buffer_store_dword v77, v5, s[24:27], s37 offen sc1
v_mfma_f32_16x16x32_bf16 a[40:43], a[172:175], a[228:231], a[40:43]
ds_read_b64_tr_b16 a[234:235], v11 offset:16640
v_mfma_f32_16x16x32_bf16 a[40:43], a[168:171], a[224:227], a[40:43]
ds_read_b64_tr_b16 a[236:237], v11 offset:20480
v_mfma_f32_16x16x32_bf16 a[64:67], a[176:179], a[224:227], a[64:67]
ds_read_b64_tr_b16 a[238:239], v11 offset:20736
v_mfma_f32_16x16x32_bf16 a[64:67], a[180:183], a[228:231], a[64:67]
buffer_load_dword v19, v15, s[72:75], s70 offen sc1
v_mfma_f32_16x16x32_bf16 a[88:91], a[188:191], a[228:231], a[88:91]
v_mfma_f32_16x16x32_bf16 a[88:91], a[184:187], a[224:227], a[88:91]
v_mfma_f32_16x16x32_bf16 a[112:115], a[192:195], a[224:227], a[112:115]
v_mfma_f32_16x16x32_bf16 a[112:115], a[196:199], a[228:231], a[112:115]
buffer_load_dword v19, v15, s[72:75], s71 offen sc1
v_mfma_f32_16x16x32_bf16 a[136:139], a[204:207], a[228:231], a[136:139]
v_mfma_f32_16x16x32_bf16 a[136:139], a[200:203], a[224:227], a[136:139]
v_mfma_f32_16x16x32_bf16 v[224:227], a[208:211], a[224:227], v[224:227]
v_mfma_f32_16x16x32_bf16 v[224:227], a[212:215], a[228:231], v[224:227]
v_mfma_f32_16x16x32_bf16 v[248:251], a[220:223], a[228:231], v[248:251]
v_mfma_f32_16x16x32_bf16 v[248:251], a[216:219], a[224:227], v[248:251]
s_waitcnt vmcnt(14) lgkmcnt(0)
s_barrier
v_mfma_f32_16x16x32_bf16 v[252:255], a[216:219], a[232:235], v[252:255]
ds_read_b64_tr_b16 a[224:225], v10 offset:24576
v_mfma_f32_16x16x32_bf16 v[252:255], a[220:223], a[236:239], v[252:255]
ds_read_b64_tr_b16 a[226:227], v10 offset:24832
v_mfma_f32_16x16x32_bf16 v[228:231], a[212:215], a[236:239], v[228:231]
ds_read_b64_tr_b16 a[228:229], v10 offset:28672
v_mfma_f32_16x16x32_bf16 v[228:231], a[208:211], a[232:235], v[228:231]
ds_read_b64_tr_b16 a[230:231], v10 offset:28928
v_mfma_f32_16x16x32_bf16 a[140:143], a[200:203], a[232:235], a[140:143]
v_mfma_f32_16x16x32_bf16 a[140:143], a[204:207], a[236:239], a[140:143]
ds_read_b128 v[58:61], v6 offset:32768
v_mfma_f32_16x16x32_bf16 a[116:119], a[196:199], a[236:239], a[116:119]
v_mfma_f32_16x16x32_bf16 a[116:119], a[192:195], a[232:235], a[116:119]
v_mfma_f32_16x16x32_bf16 a[92:95], a[184:187], a[232:235], a[92:95]
v_mfma_f32_16x16x32_bf16 a[92:95], a[188:191], a[236:239], a[92:95]
v_mfma_f32_16x16x32_bf16 a[68:71], a[180:183], a[236:239], a[68:71]
v_mfma_f32_16x16x32_bf16 a[68:71], a[176:179], a[232:235], a[68:71]
ds_read_b128 v[62:65], v7 offset:32768
v_mfma_f32_16x16x32_bf16 a[44:47], a[168:171], a[232:235], a[44:47]
v_mfma_f32_16x16x32_bf16 a[44:47], a[172:175], a[236:239], a[44:47]
v_mfma_f32_16x16x32_bf16 a[20:23], a[164:167], a[236:239], a[20:23]
v_mfma_f32_16x16x32_bf16 a[20:23], a[160:163], a[232:235], a[20:23]
s_waitcnt lgkmcnt(4)
v_mfma_f32_16x16x32_bf16 v[80:83], a[224:227], a[160:163], v[80:83]
s_waitcnt lgkmcnt(2)
ds_read_b64_tr_b16 a[232:233], v10 offset:32768
v_mfma_f32_16x16x32_bf16 v[80:83], a[228:231], a[164:167], v[80:83]
ds_read_b64_tr_b16 a[234:235], v10 offset:33024
v_mfma_f32_16x16x32_bf16 v[96:99], a[228:231], a[172:175], v[96:99]
ds_read_b64_tr_b16 a[236:237], v10 offset:36864
v_mfma_f32_16x16x32_bf16 v[96:99], a[224:227], a[168:171], v[96:99]
ds_read_b64_tr_b16 a[238:239], v10 offset:37120
v_mfma_f32_16x16x32_bf16 v[112:115], a[224:227], a[176:179], v[112:115]
ds_read_b128 v[70:73], v7 offset:34816
v_mfma_f32_16x16x32_bf16 v[112:115], a[228:231], a[180:183], v[112:115]
v_mfma_f32_16x16x32_bf16 v[128:131], a[228:231], a[188:191], v[128:131]
v_mfma_f32_16x16x32_bf16 v[128:131], a[224:227], a[184:187], v[128:131]
v_mfma_f32_16x16x32_bf16 v[144:147], a[224:227], a[192:195], v[144:147]
v_mfma_f32_16x16x32_bf16 v[144:147], a[228:231], a[196:199], v[144:147]
ds_read_b128 v[66:69], v6 offset:34816
s_and_b32 s75, s2, 1
v_mfma_f32_16x16x32_bf16 v[160:163], a[228:231], a[204:207], v[160:163]
s_sub_u32 s34, 0, s75
v_mfma_f32_16x16x32_bf16 v[160:163], a[224:227], a[200:203], v[160:163]
s_and_b32 s47, s34, 0x15
v_mfma_f32_16x16x32_bf16 v[176:179], a[224:227], a[208:211], v[176:179]
s_xor_b32 s47, s2, s47
v_mfma_f32_16x16x32_bf16 v[176:179], a[228:231], a[212:215], v[176:179]
s_bfe_u32 s76, s47, 0x20001
s_and_b32 s38, s3, 7
v_mfma_f32_16x16x32_bf16 v[192:195], a[228:231], a[220:223], v[192:195]
s_lshr_b32 s46, s2, 6
v_mfma_f32_16x16x32_bf16 v[192:195], a[224:227], a[216:219], v[192:195]
s_waitcnt lgkmcnt(4)
s_lshl_b32 s33, s46, 13
v_mfma_f32_16x16x32_bf16 v[196:199], a[232:235], a[216:219], v[196:199]
s_waitcnt lgkmcnt(2)
ds_read_b64_tr_b16 a[224:225], v11 offset:24576
s_lshl_b32 s32, s76, 15
v_mfma_f32_16x16x32_bf16 v[196:199], a[236:239], a[220:223], v[196:199]
ds_read_b64_tr_b16 a[226:227], v11 offset:24832
s_lshl2_add_u32 s76, s76, s46
v_mfma_f32_16x16x32_bf16 v[180:183], a[236:239], a[212:215], v[180:183]
ds_read_b64_tr_b16 a[228:229], v11 offset:28672
s_bfe_u32 s77, s47, 0x30003
v_mfma_f32_16x16x32_bf16 v[180:183], a[232:235], a[208:211], v[180:183]
ds_read_b64_tr_b16 a[230:231], v11 offset:28928
s_lshl_b32 s39, s43, 12
v_mfma_f32_16x16x32_bf16 v[164:167], a[232:235], a[200:203], v[164:167]
ds_read_b128 a[240:243], v6 offset:36864
s_lshl1_add_u32 s46, s76, s75
v_mfma_f32_16x16x32_bf16 v[164:167], a[236:239], a[204:207], v[164:167]
s_lshl_b32 s68, s46, 17
s_lshl_b32 s46, s75, 12
v_mfma_f32_16x16x32_bf16 v[148:151], a[236:239], a[196:199], v[148:151]
s_add_u32 s46, s46, s33
v_mfma_f32_16x16x32_bf16 v[148:151], a[232:235], a[192:195], v[148:151]
ds_read_b128 a[244:247], v7 offset:36864
s_add_u32 s46, s46, s32
v_mfma_f32_16x16x32_bf16 v[132:135], a[232:235], a[184:187], v[132:135]
s_lshl_b32 s47, s38, 17
s_add_u32 s46, s46, s47
v_mfma_f32_16x16x32_bf16 v[132:135], a[236:239], a[188:191], v[132:135]
s_lshl_b32 s33, s43, 20
v_mfma_f32_16x16x32_bf16 v[116:119], a[236:239], a[180:183], v[116:119]
s_add_u32 s33, s33, s46
v_mfma_f32_16x16x32_bf16 v[116:119], a[232:235], a[176:179], v[116:119]
s_xor_b32 s33, s33, 4096
s_mul_i32 s32, s43, 0x81000
v_mfma_f32_16x16x32_bf16 v[100:103], a[232:235], a[168:171], v[100:103]
s_and_b32 s32, s32, 0x101000
v_mfma_f32_16x16x32_bf16 v[100:103], a[236:239], a[172:175], v[100:103]
s_xor_b32 s32, s32, s46
v_mfma_f32_16x16x32_bf16 v[84:87], a[236:239], a[164:167], v[84:87]
ds_read_b128 a[252:255], v7 offset:38912
s_lshl_b32 s35, s38, 6
v_mfma_f32_16x16x32_bf16 v[84:87], a[232:235], a[160:163], v[84:87]
s_waitcnt lgkmcnt(5)
s_lshl2_add_u32 s46, s77, s43
v_mfma_f32_16x16x32_bf16 v[88:91], a[224:227], a[160:163], v[88:91]
s_waitcnt lgkmcnt(3)
ds_read_b64_tr_b16 a[232:233], v11 offset:32768
s_lshl_b32 s47, s46, 6
v_mfma_f32_16x16x32_bf16 v[88:91], a[228:231], a[164:167], v[88:91]
ds_read_b64_tr_b16 a[234:235], v11 offset:33024
s_add_u32 s68, s68, s47
v_mfma_f32_16x16x32_bf16 v[104:107], a[228:231], a[172:175], v[104:107]
ds_read_b64_tr_b16 a[236:237], v11 offset:36864
s_lshl_b32 s37, s38, 16
v_mfma_f32_16x16x32_bf16 v[104:107], a[224:227], a[168:171], v[104:107]
ds_read_b64_tr_b16 a[238:239], v11 offset:37120
s_lshl_b32 s46, s77, 13
v_mfma_f32_16x16x32_bf16 v[120:123], a[224:227], a[176:179], v[120:123]
s_add_u32 s37, s37, s46
s_lshl_b32 s46, s43, 11
v_mfma_f32_16x16x32_bf16 v[120:123], a[228:231], a[180:183], v[120:123]
ds_read_b128 a[248:251], v6 offset:38912
s_add_u32 s37, s37, s46
v_mfma_f32_16x16x32_bf16 v[136:139], a[228:231], a[188:191], v[136:139]
s_mov_b32 s66, 0x900000
s_lshl3_add_u32 s46, s76, s77
v_mfma_f32_16x16x32_bf16 v[136:139], a[224:227], a[184:187], v[136:139]
s_lshl1_add_u32 s46, s46, s75
v_mfma_f32_16x16x32_bf16 v[152:155], a[224:227], a[192:195], v[152:155]
s_lshl2_add_u32 s46, s46, s43
v_mfma_f32_16x16x32_bf16 v[152:155], a[228:231], a[196:199], v[152:155]
s_xor_b32 s47, s46, 4
v_mfma_f32_16x16x32_bf16 v[168:171], a[228:231], a[204:207], v[168:171]
s_lshl_b32 s70, s46, 13
s_lshl_b32 s69, s47, 13
v_mfma_f32_16x16x32_bf16 v[168:171], a[224:227], a[200:203], v[168:171]
s_lshl_b32 s72, s46, 5
v_mfma_f32_16x16x32_bf16 v[184:187], a[224:227], a[208:211], v[184:187]
s_lshl_b32 s71, s47, 5
v_mfma_f32_16x16x32_bf16 v[184:187], a[228:231], a[212:215], v[184:187]
s_lshl_b32 s73, s76, 11
v_mfma_f32_16x16x32_bf16 v[200:203], a[228:231], a[220:223], v[200:203]
s_add_u32 s73, s73, 32768
s_add_u32 s12, s20, 0x2400000
s_addc_u32 s13, s21, 0
v_mfma_f32_16x16x32_bf16 v[200:203], a[224:227], a[216:219], v[200:203]
s_waitcnt vmcnt(4) lgkmcnt(1)
s_barrier
v_mfma_f32_16x16x32_bf16 v[204:207], a[232:235], a[216:219], v[204:207]
ds_read_b64_tr_b16 a[224:225], v12 offset:0
s_mov_b32 s14, 0x800000
v_mfma_f32_16x16x32_bf16 v[204:207], a[236:239], a[220:223], v[204:207]
ds_read_b64_tr_b16 a[226:227], v12 offset:256
s_mov_b32 s15, 0x00020000
v_mfma_f32_16x16x32_bf16 v[188:191], a[236:239], a[212:215], v[188:191]
ds_read_b64_tr_b16 a[228:229], v12 offset:4096
v_mfma_f32_16x16x32_bf16 v[188:191], a[232:235], a[208:211], v[188:191]
ds_read_b64_tr_b16 a[230:231], v12 offset:4352
v_mfma_f32_16x16x32_bf16 v[172:175], a[232:235], a[200:203], v[172:175]
s_add_u32 s16, s20, 0x3c00000
s_addc_u32 s17, s21, 0
s_mov_b32 s18, 0x14000
v_mfma_f32_16x16x32_bf16 v[172:175], a[236:239], a[204:207], v[172:175]
s_mov_b32 s19, 0x00020000
s_mov_b32 s60, s20
s_mov_b32 s61, s21
v_mfma_f32_16x16x32_bf16 v[156:159], a[236:239], a[196:199], v[156:159]
s_mov_b32 s62, 0
s_mov_b32 s63, 0x00020000
v_mfma_f32_16x16x32_bf16 v[156:159], a[232:235], a[192:195], v[156:159]
ds_read_b128 a[192:195], v6 offset:40960
s_lshl_b32 s74, s59, 12
v_mfma_f32_16x16x32_bf16 v[140:143], a[232:235], a[184:187], v[140:143]
ds_read_b128 a[196:199], v7 offset:40960
s_lshl_b32 s46, s3, 7
v_mfma_f32_16x16x32_bf16 v[140:143], a[236:239], a[188:191], v[140:143]
ds_read_b128 a[204:207], v7 offset:43008
s_add_u32 s74, s74, s46
v_mfma_f32_16x16x32_bf16 v[124:127], a[236:239], a[180:183], v[124:127]
ds_read_b128 a[200:203], v6 offset:43008
s_and_b32 s46, s45, 3
v_mfma_f32_16x16x32_bf16 v[124:127], a[232:235], a[176:179], v[124:127]
s_lshl_b32 s46, s46, 4
s_add_u32 s74, s74, s46
v_mfma_f32_16x16x32_bf16 v[108:111], a[232:235], a[168:171], v[108:111]
ds_read_b128 a[208:211], v6 offset:45056
s_add_u32 s74, s74, 35840
v_mfma_f32_16x16x32_bf16 v[108:111], a[236:239], a[172:175], v[108:111]
ds_read_b128 a[212:215], v7 offset:45056
v_mfma_f32_16x16x32_bf16 v[92:95], a[236:239], a[164:167], v[92:95]
v_mfma_f32_16x16x32_bf16 v[92:95], a[232:235], a[160:163], v[92:95]
s_waitcnt lgkmcnt(8)
v_mfma_f32_16x16x32_bf16 a[0:3], a[224:227], v[58:61], a[0:3]
s_waitcnt lgkmcnt(6)
ds_read_b128 a[220:223], v7 offset:47104
s_mov_b32 s8, s100
v_mfma_f32_16x16x32_bf16 a[0:3], a[228:231], v[62:65], a[0:3]
ds_read_b128 a[216:219], v6 offset:47104
s_mov_b32 s9, s101
v_mfma_f32_16x16x32_bf16 a[24:27], a[228:231], v[70:73], a[24:27]
ds_read_b64_tr_b16 a[232:233], v13 offset:0
s_mov_b32 s10, 0x400000
v_mfma_f32_16x16x32_bf16 a[24:27], a[224:227], v[66:69], a[24:27]
ds_read_b64_tr_b16 a[234:235], v13 offset:256
s_mov_b32 s11, 0x00020000
v_mfma_f32_16x16x32_bf16 a[48:51], a[224:227], a[240:243], a[48:51]
ds_read_b64_tr_b16 a[236:237], v13 offset:4096
v_mfma_f32_16x16x32_bf16 a[48:51], a[228:231], a[244:247], a[48:51]
ds_read_b64_tr_b16 a[238:239], v13 offset:4352
v_mfma_f32_16x16x32_bf16 a[72:75], a[228:231], a[252:255], a[72:75]
v_mfma_f32_16x16x32_bf16 a[72:75], a[224:227], a[248:251], a[72:75]
v_mfma_f32_16x16x32_bf16 a[176:179], a[152:155], a[224:227], 0
v_mfma_f32_16x16x32_bf16 a[176:179], a[152:155], a[228:231], a[176:179]
s_waitcnt lgkmcnt(10)
v_mfma_f32_16x16x32_bf16 a[96:99], a[228:231], a[196:199], a[96:99]
v_mfma_f32_16x16x32_bf16 a[96:99], a[224:227], a[192:195], a[96:99]
s_waitcnt lgkmcnt(8)
v_mfma_f32_16x16x32_bf16 a[120:123], a[224:227], a[200:203], a[120:123]
v_mfma_f32_16x16x32_bf16 a[120:123], a[228:231], a[204:207], a[120:123]
s_waitcnt lgkmcnt(6)
v_mfma_f32_16x16x32_bf16 v[208:211], a[228:231], a[212:215], v[208:211]
v_mfma_f32_16x16x32_bf16 v[208:211], a[224:227], a[208:211], v[208:211]
s_waitcnt lgkmcnt(4)
v_mfma_f32_16x16x32_bf16 v[232:235], a[224:227], a[216:219], v[232:235]
v_mfma_f32_16x16x32_bf16 v[232:235], a[228:231], a[220:223], v[232:235]
s_waitcnt lgkmcnt(2)
v_mfma_f32_16x16x32_bf16 v[236:239], a[232:235], a[216:219], v[236:239]
s_waitcnt lgkmcnt(0)
ds_read_b64_tr_b16 a[224:225], v12 offset:8192
v_mfma_f32_16x16x32_bf16 v[236:239], a[236:239], a[220:223], v[236:239]
ds_read_b64_tr_b16 a[226:227], v12 offset:8448
v_mfma_f32_16x16x32_bf16 v[212:215], a[236:239], a[212:215], v[212:215]
ds_read_b64_tr_b16 a[228:229], v12 offset:12288
v_and_b32_e64 v76, 15, v0
v_mfma_f32_16x16x32_bf16 v[212:215], a[232:235], a[208:211], v[212:215]
ds_read_b64_tr_b16 a[230:231], v12 offset:12544
v_mfma_f32_16x16x32_bf16 a[124:127], a[232:235], a[200:203], a[124:127]
v_mfma_f32_16x16x32_bf16 a[124:127], a[236:239], a[204:207], a[124:127]
v_lshlrev_b32_e64 v76, 3, v76
v_mfma_f32_16x16x32_bf16 a[100:103], a[236:239], a[196:199], a[100:103]
v_mfma_f32_16x16x32_bf16 a[100:103], a[232:235], a[192:195], a[100:103]
v_mfma_f32_16x16x32_bf16 a[176:179], a[156:159], a[232:235], a[176:179]
s_add_u32 s52, s44, 128
v_mfma_f32_16x16x32_bf16 a[176:179], a[156:159], a[236:239], a[176:179]
v_mfma_f32_16x16x32_bf16 a[76:79], a[236:239], a[252:255], a[76:79]
v_mfma_f32_16x16x32_bf16 a[76:79], a[232:235], a[248:251], a[76:79]
v_mfma_f32_16x16x32_bf16 a[52:55], a[232:235], a[240:243], a[52:55]
s_lshl_b32 s52, s52, 3
v_mfma_f32_16x16x32_bf16 a[52:55], a[236:239], a[244:247], a[52:55]
v_mfma_f32_16x16x32_bf16 a[28:31], a[236:239], v[70:73], a[28:31]
v_mfma_f32_16x16x32_bf16 a[28:31], a[232:235], v[66:69], a[28:31]
buffer_load_dwordx2 v[22:23], v76, s[24:27], s52 offen offset:0 sc1
v_mfma_f32_16x16x32_bf16 a[4:7], a[232:235], v[58:61], a[4:7]
v_mfma_f32_16x16x32_bf16 a[4:7], a[236:239], v[62:65], a[4:7]
s_waitcnt lgkmcnt(2)
v_mfma_f32_16x16x32_bf16 a[8:11], a[224:227], v[58:61], a[8:11]
s_waitcnt lgkmcnt(0)
buffer_load_dwordx2 v[24:25], v76, s[24:27], s52 offen offset:128 sc1
v_mfma_f32_16x16x32_bf16 a[8:11], a[228:231], v[62:65], a[8:11]
ds_read_b64_tr_b16 a[232:233], v13 offset:8192
v_mfma_f32_16x16x32_bf16 a[32:35], a[228:231], v[70:73], a[32:35]
ds_read_b64_tr_b16 a[234:235], v13 offset:8448
v_mfma_f32_16x16x32_bf16 a[32:35], a[224:227], v[66:69], a[32:35]
ds_read_b64_tr_b16 a[236:237], v13 offset:12288
v_mfma_f32_16x16x32_bf16 a[56:59], a[224:227], a[240:243], a[56:59]
buffer_load_dwordx2 v[26:27], v76, s[24:27], s52 offen offset:256 sc1
v_mfma_f32_16x16x32_bf16 a[56:59], a[228:231], a[244:247], a[56:59]
ds_read_b64_tr_b16 a[238:239], v13 offset:12544
v_mfma_f32_16x16x32_bf16 a[80:83], a[228:231], a[252:255], a[80:83]
v_mfma_f32_16x16x32_bf16 a[80:83], a[224:227], a[248:251], a[80:83]
buffer_load_dwordx2 v[28:29], v76, s[24:27], s52 offen offset:384 sc1
v_mfma_f32_16x16x32_bf16 a[180:183], a[152:155], a[224:227], 0
v_mfma_f32_16x16x32_bf16 a[180:183], a[152:155], a[228:231], a[180:183]
v_mfma_f32_16x16x32_bf16 a[104:107], a[228:231], a[196:199], a[104:107]
buffer_load_dwordx2 v[30:31], v76, s[24:27], s52 offen offset:512 sc1
v_mfma_f32_16x16x32_bf16 a[104:107], a[224:227], a[192:195], a[104:107]
v_mfma_f32_16x16x32_bf16 a[128:131], a[224:227], a[200:203], a[128:131]
v_mfma_f32_16x16x32_bf16 a[128:131], a[228:231], a[204:207], a[128:131]
v_mfma_f32_16x16x32_bf16 v[216:219], a[228:231], a[212:215], v[216:219]
buffer_load_dwordx2 v[32:33], v76, s[24:27], s52 offen offset:640 sc1
v_mfma_f32_16x16x32_bf16 v[216:219], a[224:227], a[208:211], v[216:219]
v_mfma_f32_16x16x32_bf16 v[240:243], a[224:227], a[216:219], v[240:243]
v_mfma_f32_16x16x32_bf16 v[240:243], a[228:231], a[220:223], v[240:243]
s_waitcnt lgkmcnt(2)
buffer_load_dwordx2 v[34:35], v76, s[24:27], s52 offen offset:768 sc1
v_mfma_f32_16x16x32_bf16 v[244:247], a[232:235], a[216:219], v[244:247]
s_waitcnt lgkmcnt(0)
ds_read_b64_tr_b16 a[224:225], v12 offset:16384
v_mfma_f32_16x16x32_bf16 v[244:247], a[236:239], a[220:223], v[244:247]
ds_read_b64_tr_b16 a[226:227], v12 offset:16640
v_mfma_f32_16x16x32_bf16 v[220:223], a[236:239], a[212:215], v[220:223]
buffer_load_dwordx2 v[36:37], v76, s[24:27], s52 offen offset:896 sc1
v_mfma_f32_16x16x32_bf16 v[220:223], a[232:235], a[208:211], v[220:223]
ds_read_b64_tr_b16 a[228:229], v12 offset:20480
v_mfma_f32_16x16x32_bf16 a[132:135], a[232:235], a[200:203], a[132:135]
ds_read_b64_tr_b16 a[230:231], v12 offset:20736
v_mfma_f32_16x16x32_bf16 a[132:135], a[236:239], a[204:207], a[132:135]
v_mfma_f32_16x16x32_bf16 a[108:111], a[236:239], a[196:199], a[108:111]
v_mfma_f32_16x16x32_bf16 a[108:111], a[232:235], a[192:195], a[108:111]
v_mfma_f32_16x16x32_bf16 a[180:183], a[156:159], a[232:235], a[180:183]
v_mfma_f32_16x16x32_bf16 a[180:183], a[156:159], a[236:239], a[180:183]
v_mfma_f32_16x16x32_bf16 a[84:87], a[236:239], a[252:255], a[84:87]
v_mfma_f32_16x16x32_bf16 a[84:87], a[232:235], a[248:251], a[84:87]
v_mfma_f32_16x16x32_bf16 a[60:63], a[232:235], a[240:243], a[60:63]
v_mfma_f32_16x16x32_bf16 a[60:63], a[236:239], a[244:247], a[60:63]
v_mfma_f32_16x16x32_bf16 a[36:39], a[236:239], v[70:73], a[36:39]
v_mfma_f32_16x16x32_bf16 a[36:39], a[232:235], v[66:69], a[36:39]
v_mfma_f32_16x16x32_bf16 a[12:15], a[232:235], v[58:61], a[12:15]
s_bfe_u32 s53, s2, 0x20003
v_mfma_f32_16x16x32_bf16 a[12:15], a[236:239], v[62:65], a[12:15]
s_waitcnt lgkmcnt(2)
s_lshl2_add_u32 s53, s3, s53
v_mfma_f32_16x16x32_bf16 a[16:19], v[58:61], a[224:227], a[16:19]
s_waitcnt lgkmcnt(0)
ds_read_b64_tr_b16 a[232:233], v13 offset:16384
v_mfma_f32_16x16x32_bf16 a[16:19], v[62:65], a[228:231], a[16:19]
ds_read_b64_tr_b16 a[234:235], v13 offset:16640
s_lshl1_add_u32 s53, s53, s58
v_mfma_f32_16x16x32_bf16 a[40:43], v[70:73], a[228:231], a[40:43]
ds_read_b64_tr_b16 a[236:237], v13 offset:20480
v_mfma_f32_16x16x32_bf16 a[40:43], v[66:69], a[224:227], a[40:43]
ds_read_b64_tr_b16 a[238:239], v13 offset:20736
s_mul_i32 s53, s53, 768
v_mfma_f32_16x16x32_bf16 a[64:67], a[240:243], a[224:227], a[64:67]
v_mfma_f32_16x16x32_bf16 a[64:67], a[244:247], a[228:231], a[64:67]
s_add_u32 s53, s53, 16384
v_mfma_f32_16x16x32_bf16 a[88:91], a[252:255], a[228:231], a[88:91]
buffer_load_dwordx4 v[40:43], v9, s[24:27], s53 offen offset:0 sc1
v_mfma_f32_16x16x32_bf16 a[88:91], a[248:251], a[224:227], a[88:91]
v_mfma_f32_16x16x32_bf16 a[184:187], a[152:155], a[224:227], 0
buffer_load_dwordx4 v[44:47], v9, s[24:27], s53 offen offset:16 sc1
v_mfma_f32_16x16x32_bf16 a[184:187], a[152:155], a[228:231], a[184:187]
v_mfma_f32_16x16x32_bf16 a[112:115], a[196:199], a[228:231], a[112:115]
buffer_load_dwordx4 v[48:51], v9, s[24:27], s53 offen offset:32 sc1
v_mfma_f32_16x16x32_bf16 a[112:115], a[192:195], a[224:227], a[112:115]
v_mfma_f32_16x16x32_bf16 a[136:139], a[200:203], a[224:227], a[136:139]
v_mfma_f32_16x16x32_bf16 a[136:139], a[204:207], a[228:231], a[136:139]
v_mfma_f32_16x16x32_bf16 v[224:227], a[212:215], a[228:231], v[224:227]
v_mfma_f32_16x16x32_bf16 v[224:227], a[208:211], a[224:227], v[224:227]
v_mfma_f32_16x16x32_bf16 v[248:251], a[216:219], a[224:227], v[248:251]
v_mfma_f32_16x16x32_bf16 v[248:251], a[220:223], a[228:231], v[248:251]
s_waitcnt lgkmcnt(2)
v_mfma_f32_16x16x32_bf16 v[252:255], a[216:219], a[232:235], v[252:255]
s_waitcnt lgkmcnt(0)
ds_read_b64_tr_b16 a[224:225], v12 offset:24576
v_and_b32 v78, 15, v0
v_mfma_f32_16x16x32_bf16 v[252:255], a[220:223], a[236:239], v[252:255]
ds_read_b64_tr_b16 a[226:227], v12 offset:24832
v_mfma_f32_16x16x32_bf16 v[228:231], a[212:215], a[236:239], v[228:231]
ds_read_b64_tr_b16 a[228:229], v12 offset:28672
v_lshrrev_b32_e64 v79, 4, v0
v_mfma_f32_16x16x32_bf16 v[228:231], a[208:211], a[232:235], v[228:231]
ds_read_b64_tr_b16 a[230:231], v12 offset:28928
v_mfma_f32_16x16x32_bf16 a[140:143], a[200:203], a[232:235], a[140:143]
v_mfma_f32_16x16x32_bf16 a[140:143], a[204:207], a[236:239], a[140:143]
v_lshlrev_b32_e64 v78, 11, v78
v_mfma_f32_16x16x32_bf16 a[116:119], a[196:199], a[236:239], a[116:119]
v_mfma_f32_16x16x32_bf16 a[116:119], a[192:195], a[232:235], a[116:119]
v_lshl_add_u32 v78, v79, 3, v78
v_mfma_f32_16x16x32_bf16 a[184:187], a[156:159], a[232:235], a[184:187]
v_mfma_f32_16x16x32_bf16 a[184:187], a[156:159], a[236:239], a[184:187]
v_mfma_f32_16x16x32_bf16 a[92:95], a[252:255], a[236:239], a[92:95]
s_add_u32 s47, s68, 0
v_mfma_f32_16x16x32_bf16 a[92:95], a[248:251], a[232:235], a[92:95]
v_mfma_f32_16x16x32_bf16 a[68:71], a[240:243], a[232:235], a[68:71]
buffer_load_dwordx2 a[160:161], v78, s[4:7], s47 offen offset:0
v_mfma_f32_16x16x32_bf16 a[68:71], a[244:247], a[236:239], a[68:71]
v_mfma_f32_16x16x32_bf16 a[44:47], v[70:73], a[236:239], a[44:47]
v_mfma_f32_16x16x32_bf16 a[44:47], v[66:69], a[232:235], a[44:47]
buffer_load_dwordx2 a[162:163], v78, s[4:7], s47 offen offset:32
v_mfma_f32_16x16x32_bf16 a[20:23], v[58:61], a[232:235], a[20:23]
v_mfma_f32_16x16x32_bf16 a[20:23], v[62:65], a[236:239], a[20:23]
s_waitcnt lgkmcnt(2)
s_add_u32 s47, s68, 32768
v_mfma_f32_16x16x32_bf16 v[80:83], a[224:227], v[58:61], v[80:83]
s_waitcnt lgkmcnt(0)
ds_read_b64_tr_b16 a[232:233], v12 offset:32768
v_mfma_f32_16x16x32_bf16 v[80:83], a[228:231], v[62:65], v[80:83]
ds_read_b64_tr_b16 a[234:235], v12 offset:33024
v_mfma_f32_16x16x32_bf16 v[96:99], a[228:231], v[70:73], v[96:99]
buffer_load_dwordx2 a[164:165], v78, s[4:7], s47 offen offset:0
v_mfma_f32_16x16x32_bf16 v[96:99], a[224:227], v[66:69], v[96:99]
ds_read_b64_tr_b16 a[236:237], v12 offset:36864
v_mfma_f32_16x16x32_bf16 v[112:115], a[224:227], a[240:243], v[112:115]
buffer_load_dwordx2 a[166:167], v78, s[4:7], s47 offen offset:32
v_mfma_f32_16x16x32_bf16 v[112:115], a[228:231], a[244:247], v[112:115]
ds_read_b64_tr_b16 a[238:239], v12 offset:37120
v_mfma_f32_16x16x32_bf16 v[128:131], a[228:231], a[252:255], v[128:131]
v_mfma_f32_16x16x32_bf16 v[128:131], a[224:227], a[248:251], v[128:131]
s_add_u32 s47, s68, 65536
v_mfma_f32_16x16x32_bf16 a[188:191], a[152:155], a[224:227], 0
v_mfma_f32_16x16x32_bf16 a[188:191], a[152:155], a[228:231], a[188:191]
buffer_load_dwordx2 a[168:169], v78, s[4:7], s47 offen offset:0
v_mfma_f32_16x16x32_bf16 v[144:147], a[228:231], a[196:199], v[144:147]
v_mfma_f32_16x16x32_bf16 v[144:147], a[224:227], a[192:195], v[144:147]
v_mfma_f32_16x16x32_bf16 v[160:163], a[224:227], a[200:203], v[160:163]
buffer_load_dwordx2 a[170:171], v78, s[4:7], s47 offen offset:32
v_mfma_f32_16x16x32_bf16 v[160:163], a[228:231], a[204:207], v[160:163]
v_mfma_f32_16x16x32_bf16 v[176:179], a[228:231], a[212:215], v[176:179]
s_add_u32 s47, s68, 98304
v_mfma_f32_16x16x32_bf16 v[176:179], a[224:227], a[208:211], v[176:179]
v_mfma_f32_16x16x32_bf16 v[192:195], a[224:227], a[216:219], v[192:195]
v_mfma_f32_16x16x32_bf16 v[192:195], a[228:231], a[220:223], v[192:195]
s_waitcnt lgkmcnt(2)
buffer_load_dwordx2 a[172:173], v78, s[4:7], s47 offen offset:0
v_mfma_f32_16x16x32_bf16 v[196:199], a[232:235], a[216:219], v[196:199]
s_waitcnt lgkmcnt(0)
ds_read_b64_tr_b16 a[224:225], v13 offset:24576
v_mfma_f32_16x16x32_bf16 v[196:199], a[236:239], a[220:223], v[196:199]
buffer_load_dwordx2 a[174:175], v78, s[4:7], s47 offen offset:32
v_mfma_f32_16x16x32_bf16 v[180:183], a[236:239], a[212:215], v[180:183]
ds_read_b64_tr_b16 a[226:227], v13 offset:24832
v_mfma_f32_16x16x32_bf16 v[180:183], a[232:235], a[208:211], v[180:183]
ds_read_b64_tr_b16 a[228:229], v13 offset:28672
v_mfma_f32_16x16x32_bf16 v[164:167], a[232:235], a[200:203], v[164:167]
ds_read_b64_tr_b16 a[230:231], v13 offset:28928
v_mfma_f32_16x16x32_bf16 v[164:167], a[236:239], a[204:207], v[164:167]
v_mfma_f32_16x16x32_bf16 v[148:151], a[236:239], a[196:199], v[148:151]
v_mfma_f32_16x16x32_bf16 v[148:151], a[232:235], a[192:195], v[148:151]
v_mfma_f32_16x16x32_bf16 a[188:191], a[156:159], a[232:235], a[188:191]
v_mfma_f32_16x16x32_bf16 a[188:191], a[156:159], a[236:239], a[188:191]
v_mfma_f32_16x16x32_bf16 v[132:135], a[236:239], a[252:255], v[132:135]
v_mfma_f32_16x16x32_bf16 v[132:135], a[232:235], a[248:251], v[132:135]
v_mfma_f32_16x16x32_bf16 v[116:119], a[232:235], a[240:243], v[116:119]
v_mfma_f32_16x16x32_bf16 v[116:119], a[236:239], a[244:247], v[116:119]
v_mfma_f32_16x16x32_bf16 v[100:103], a[236:239], v[70:73], v[100:103]
v_mfma_f32_16x16x32_bf16 v[100:103], a[232:235], v[66:69], v[100:103]
v_mfma_f32_16x16x32_bf16 v[84:87], a[232:235], v[58:61], v[84:87]
v_mfma_f32_16x16x32_bf16 v[84:87], a[236:239], v[62:65], v[84:87]
s_waitcnt lgkmcnt(2)
v_mfma_f32_16x16x32_bf16 v[88:91], a[224:227], v[58:61], v[88:91]
s_waitcnt lgkmcnt(0)
ds_read_b64_tr_b16 a[232:233], v13 offset:32768
v_mfma_f32_16x16x32_bf16 v[88:91], a[228:231], v[62:65], v[88:91]
ds_read_b64_tr_b16 a[234:235], v13 offset:33024
v_mfma_f32_16x16x32_bf16 v[104:107], a[228:231], v[70:73], v[104:107]
ds_read_b64_tr_b16 a[236:237], v13 offset:36864
v_mfma_f32_16x16x32_bf16 v[104:107], a[224:227], v[66:69], v[104:107]
ds_read_b64_tr_b16 a[238:239], v13 offset:37120
v_mfma_f32_16x16x32_bf16 v[120:123], a[224:227], a[240:243], v[120:123]
v_mfma_f32_16x16x32_bf16 v[120:123], a[228:231], a[244:247], v[120:123]
v_mfma_f32_16x16x32_bf16 v[136:139], a[228:231], a[252:255], v[136:139]
v_mfma_f32_16x16x32_bf16 v[136:139], a[224:227], a[248:251], v[136:139]
v_mfma_f32_16x16x32_bf16 a[148:151], a[152:155], a[224:227], 0
v_mfma_f32_16x16x32_bf16 a[148:151], a[152:155], a[228:231], a[148:151]
v_mfma_f32_16x16x32_bf16 v[152:155], a[228:231], a[196:199], v[152:155]
v_mfma_f32_16x16x32_bf16 v[152:155], a[224:227], a[192:195], v[152:155]
v_mfma_f32_16x16x32_bf16 v[168:171], a[224:227], a[200:203], v[168:171]
v_mfma_f32_16x16x32_bf16 v[168:171], a[228:231], a[204:207], v[168:171]
v_mfma_f32_16x16x32_bf16 v[184:187], a[228:231], a[212:215], v[184:187]
v_mfma_f32_16x16x32_bf16 v[184:187], a[224:227], a[208:211], v[184:187]
v_mfma_f32_16x16x32_bf16 v[200:203], a[224:227], a[216:219], v[200:203]
v_mfma_f32_16x16x32_bf16 v[200:203], a[228:231], a[220:223], v[200:203]
s_waitcnt lgkmcnt(2)
v_mfma_f32_16x16x32_bf16 v[92:95], a[232:235], v[58:61], v[92:95]
s_waitcnt lgkmcnt(0)
v_mfma_f32_16x16x32_bf16 v[92:95], a[236:239], v[62:65], v[92:95]
v_mfma_f32_16x16x32_bf16 v[108:111], a[236:239], v[70:73], v[108:111]
v_mfma_f32_16x16x32_bf16 v[108:111], a[232:235], v[66:69], v[108:111]
v_mfma_f32_16x16x32_bf16 v[124:127], a[232:235], a[240:243], v[124:127]
v_mfma_f32_16x16x32_bf16 v[124:127], a[236:239], a[244:247], v[124:127]
v_mov_b32 v59, 0
v_mfma_f32_16x16x32_bf16 v[140:143], a[236:239], a[252:255], v[140:143]
v_mov_b32_e64 v60, 0
v_mfma_f32_16x16x32_bf16 v[140:143], a[232:235], a[248:251], v[140:143]
v_mov_b32_e64 v61, 0
v_mfma_f32_16x16x32_bf16 a[148:151], a[156:159], a[232:235], a[148:151]
v_mov_b32_e64 v63, 0
v_mfma_f32_16x16x32_bf16 a[148:151], a[156:159], a[236:239], a[148:151]
v_mov_b32_e64 v64, 0
v_mfma_f32_16x16x32_bf16 v[156:159], a[236:239], a[196:199], v[156:159]
v_mov_b32_e64 v65, 0
v_mfma_f32_16x16x32_bf16 v[156:159], a[232:235], a[192:195], v[156:159]
v_mov_b32_e64 v67, 0
v_mfma_f32_16x16x32_bf16 v[172:175], a[232:235], a[200:203], v[172:175]
v_mov_b32_e64 v68, 0
v_mfma_f32_16x16x32_bf16 v[172:175], a[236:239], a[204:207], v[172:175]
v_mov_b32_e64 v69, 0
v_mfma_f32_16x16x32_bf16 v[188:191], a[236:239], a[212:215], v[188:191]
v_mov_b32_e64 v71, 0
v_mfma_f32_16x16x32_bf16 v[188:191], a[232:235], a[208:211], v[188:191]
v_mov_b32_e64 v72, 0
v_mfma_f32_16x16x32_bf16 v[204:207], a[232:235], a[216:219], v[204:207]
v_mov_b32_e64 v73, 0
v_mfma_f32_16x16x32_bf16 v[204:207], a[236:239], a[220:223], v[204:207]
s_waitcnt vmcnt(8)
s_nop 0
v_min3_u32 v74, v40, v41, v42
v_min3_u32 v75, v43, v44, v45
v_min3_u32 v74, v74, v46, v47
v_min3_u32 v75, v75, v48, v49
v_min3_u32 v74, v74, v50, v51
v_min_u32_e64 v74, v74, v75
v_cmp_eq_u32 vcc, 0, v74
s_nop 0
s_and_b32 s40, vcc_lo, 0xffff
s_cselect_b32 s40, 0, s49
s_cmp_lt_u32 s40, 32
s_cbranch_scc1 L_g1_cs_1028
L_g1_ok_1026:
v_lshlrev_b32 v18, 4, v0
v_rcp_f32 v2, v23
v_rcp_f32 v3, v25
v_rcp_f32 v4, v27
v_rcp_f32 v5, v29
v_rcp_f32_e64 v6, v31
s_xor_b32 s47, s37, 0x300000
buffer_load_dwordx4 a[192:195], v18, s[64:67], s47 offen offset:0 sc1
v_rcp_f32 v7, v33
v_rcp_f32 v8, v35
v_rcp_f32_e64 v9, v37
s_mul_i32 s55, s43, 640
s_add_u32 s55, s55, 159744
v_and_b32_e64 v77, 15, v0
v_lshl_add_u32 v77, v77, 2, s55
ds_write_b32 v77, v2 offset:64
ds_write_b32 v77, v3 offset:128
ds_write_b32 v77, v4 offset:192
ds_write_b32 v77, v5 offset:256
ds_write_b32 v77, v6 offset:320
ds_write_b32 v77, v7 offset:384
ds_write_b32 v77, v8 offset:448
ds_write_b32 v77, v9 offset:512
v_lshrrev_b32_e64 v19, 4, v0
v_lshl_add_u32 v19, v19, 4, s55
v_mul_f32 v10, 0xbfb8aa3b, v2
v_mul_f32 v11, 0xbfb8aa3b, v3
v_mul_f32 v12, 0xbfb8aa3b, v4
v_mul_f32 v13, 0xbfb8aa3b, v5
v_mul_f32 v14, 0xbfb8aa3b, v6
buffer_load_dwordx4 a[196:199], v18, s[64:67], s47 offen offset:1024 sc1
v_mul_f32 v15, 0xbfb8aa3b, v7
v_mul_f32 v16, 0xbfb8aa3b, v8
v_mul_f32 v17, 0xbfb8aa3b, v9
s_and_b32 s40, s59, 1
s_lshl_b32 s53, s40, 14
s_lshr_b32 s40, s59, 1
s_lshl_b32 s40, s40, 15
s_add_u32 s53, s53, s40
s_lshl_b32 s40, s3, 17
s_add_u32 s53, s53, s40
s_and_b32 s41, s45, 3
s_lshl_b32 s41, s41, 20
s_add_u32 s54, s53, s41
s_add_u32 s53, s54, 0x402000
s_add_u32 s54, s54, 0xc02000
s_mov_b32 s42, 0xffff0000
v_add_f32 v48, v48, v50
v_add_f32 v49, v49, v51
v_mov_b32_e64 v51, 0
v_accvgpr_read_b32 v74, a176
v_accvgpr_read_b32 v75, a177
v_add_f32_e64 v40, v40, v74
s_xor_b32 s47, s37, 0x380000
buffer_load_dwordx4 a[200:203], v18, s[64:67], s47 offen offset:0 sc1
v_add_f32_e64 v41, v41, v75
v_cvt_pk_bf16_f32 v76, v40, v40
v_cvt_pk_bf16_f32 v77, v41, v41
v_and_b32 v76, s42, v76
v_and_b32 v77, s42, v77
v_sub_f32 v76, v40, v76
v_sub_f32 v77, v41, v77
v_cvt_pk_bf16_f32 v40, v40, v76
v_cvt_pk_bf16_f32 v41, v41, v77
v_accvgpr_read_b32 v74, a180
v_accvgpr_read_b32 v75, a181
v_add_f32 v42, v42, v74
v_add_f32 v43, v43, v75
v_cvt_pk_bf16_f32 v76, v42, v42
v_cvt_pk_bf16_f32 v77, v43, v43
v_and_b32 v76, s42, v76
v_and_b32 v77, s42, v77
v_sub_f32 v76, v42, v76
v_sub_f32 v77, v43, v77
v_cvt_pk_bf16_f32 v42, v42, v76
v_cvt_pk_bf16_f32 v43, v43, v77
v_accvgpr_read_b32 v74, a184
buffer_load_dwordx4 a[204:207], v18, s[64:67], s47 offen offset:1024 sc1
v_accvgpr_read_b32 v75, a185
v_add_f32 v44, v44, v74
v_add_f32 v45, v45, v75
v_cvt_pk_bf16_f32 v76, v44, v44
v_cvt_pk_bf16_f32 v77, v45, v45
v_and_b32 v76, s42, v76
v_and_b32 v77, s42, v77
v_sub_f32 v76, v44, v76
v_sub_f32 v77, v45, v77
v_cvt_pk_bf16_f32 v44, v44, v76
v_cvt_pk_bf16_f32 v45, v45, v77
v_accvgpr_read_b32 v74, a188
v_accvgpr_read_b32 v75, a189
v_add_f32 v46, v46, v74
v_add_f32 v47, v47, v75
v_cvt_pk_bf16_f32 v76, v46, v46
v_cvt_pk_bf16_f32 v77, v47, v47
v_and_b32 v76, s42, v76
v_and_b32 v77, s42, v77
v_sub_f32 v76, v46, v76
v_sub_f32 v77, v47, v77
v_cvt_pk_bf16_f32 v46, v46, v76
s_xor_b32 s47, s37, 0x400000
buffer_load_dwordx4 a[208:211], v18, s[64:67], s47 offen offset:0 sc1
v_cvt_pk_bf16_f32 v47, v47, v77
v_accvgpr_read_b32 v74, a148
v_accvgpr_read_b32 v75, a149
v_add_f32 v48, v48, v74
v_add_f32 v49, v49, v75
v_cvt_pk_bf16_f32 v76, v48, v48
v_cvt_pk_bf16_f32 v77, v49, v49
v_and_b32 v76, s42, v76
v_and_b32 v77, s42, v77
v_sub_f32 v76, v48, v76
v_sub_f32 v77, v49, v77
v_cvt_pk_bf16_f32 v48, v48, v76
v_cvt_pk_bf16_f32 v49, v49, v77
s_lshl_b32 s52, s59, 16
s_lshl_b32 s41, s45, 11
s_add_u32 s41, s41, 18874368
s_add_u32 s52, s52, s41
v_lshlrev_b32 v79, 3, v0
v_mov_b32 v50, v46
v_mov_b32 v54, v47
v_mov_b32 v58, v48
v_mov_b32 v62, v49
buffer_load_dwordx4 a[212:215], v18, s[64:67], s47 offen offset:1024 sc1
v_mfma_f32_16x16x32_bf16 v[80:83], v[50:53], v[22:25], v[80:83]
v_mfma_f32_16x16x32_bf16 v[84:87], v[54:57], v[22:25], v[84:87]
v_mfma_f32_16x16x32_bf16 v[88:91], v[58:61], v[22:25], v[88:91]
v_mfma_f32_16x16x32_bf16 v[92:95], v[62:65], v[22:25], v[92:95]
s_nop 4
v_pk_mul_f32 v[80:81], v[80:81], v[10:11] op_sel:[0,0] op_sel_hi:[1,0]
s_nop 0
v_pk_mul_f32 v[88:89], v[88:89], v[10:11] op_sel:[0,0] op_sel_hi:[1,0]
v_pk_mul_f32 v[82:83], v[82:83], v[10:11] op_sel:[0,0] op_sel_hi:[1,0]
v_pk_mul_f32 v[90:91], v[90:91], v[10:11] op_sel:[0,0] op_sel_hi:[1,0]
v_exp_f32_e64 v80, v80
v_mfma_f32_16x16x32_bf16 v[96:99], v[50:53], v[24:27], v[96:99]
v_exp_f32_e64 v88, v88
v_mfma_f32_16x16x32_bf16 v[100:103], v[54:57], v[24:27], v[100:103]
v_exp_f32 v81, v81
v_exp_f32 v89, v89
v_exp_f32 v82, v82
v_exp_f32 v90, v90
v_exp_f32_e64 v83, v83
v_mfma_f32_16x16x32_bf16 v[104:107], v[58:61], v[24:27], v[104:107]
v_exp_f32_e64 v91, v91
v_pk_fma_f32 v[80:81], v[80:81], v[22:23], v[22:23] op_sel:[0,1,1] op_sel_hi:[1,1,1]
v_pk_fma_f32 v[88:89], v[88:89], v[22:23], v[22:23] op_sel:[0,1,1] op_sel_hi:[1,1,1]
v_pk_fma_f32 v[82:83], v[82:83], v[22:23], v[22:23] op_sel:[0,1,1] op_sel_hi:[1,1,1]
s_xor_b32 s47, s37, 0x500000
buffer_load_dwordx4 a[216:219], v18, s[64:67], s47 offen offset:0 sc1
v_pk_fma_f32 v[90:91], v[90:91], v[22:23], v[22:23] op_sel:[0,1,1] op_sel_hi:[1,1,1]
v_rcp_f32_e64 v80, v80
v_mfma_f32_16x16x32_bf16 v[108:111], v[62:65], v[24:27], v[108:111]
v_rcp_f32 v88, v88
v_rcp_f32 v81, v81
v_rcp_f32 v89, v89
v_rcp_f32 v82, v82
v_rcp_f32 v90, v90
v_rcp_f32 v83, v83
v_rcp_f32_e64 v91, v91
v_pk_mul_f32 v[84:85], v[84:85], v[80:81]
v_pk_mul_f32 v[92:93], v[92:93], v[88:89]
v_pk_mul_f32 v[86:87], v[86:87], v[82:83]
v_pk_mul_f32 v[94:95], v[94:95], v[90:91]
s_add_u32 s40, s54, 0
s_nop 0
v_cvt_pk_bf16_f32 v80, v84, v85
v_cvt_pk_bf16_f32 v82, v92, v93
v_cvt_pk_bf16_f32 v81, v86, v87
v_cvt_pk_bf16_f32 v83, v94, v95
buffer_store_dwordx4 v[80:83], v18, s[20:23], s40 offen sc1
v_pk_mul_f32 v[96:97], v[96:97], v[10:11] op_sel:[0,1] op_sel_hi:[1,1]
v_pk_mul_f32 v[104:105], v[104:105], v[10:11] op_sel:[0,1] op_sel_hi:[1,1]
buffer_load_dwordx4 a[220:223], v18, s[64:67], s47 offen offset:1024 sc1
v_pk_mul_f32 v[98:99], v[98:99], v[10:11] op_sel:[0,1] op_sel_hi:[1,1]
v_pk_mul_f32 v[106:107], v[106:107], v[10:11] op_sel:[0,1] op_sel_hi:[1,1]
v_exp_f32_e64 v96, v96
v_mfma_f32_16x16x32_bf16 v[112:115], v[50:53], v[26:29], v[112:115]
v_exp_f32_e64 v104, v104
v_mfma_f32_16x16x32_bf16 v[116:119], v[54:57], v[26:29], v[116:119]
v_exp_f32 v97, v97
v_exp_f32 v105, v105
v_exp_f32 v98, v98
v_exp_f32 v106, v106
v_exp_f32_e64 v99, v99
v_mfma_f32_16x16x32_bf16 v[120:123], v[58:61], v[26:29], v[120:123]
v_exp_f32_e64 v107, v107
v_pk_fma_f32 v[96:97], v[96:97], v[24:25], v[24:25] op_sel:[0,1,1] op_sel_hi:[1,1,1]
v_pk_fma_f32 v[104:105], v[104:105], v[24:25], v[24:25] op_sel:[0,1,1] op_sel_hi:[1,1,1]
v_pk_fma_f32 v[98:99], v[98:99], v[24:25], v[24:25] op_sel:[0,1,1] op_sel_hi:[1,1,1]
v_pk_fma_f32 v[106:107], v[106:107], v[24:25], v[24:25] op_sel:[0,1,1] op_sel_hi:[1,1,1]
v_rcp_f32_e64 v96, v96
v_mfma_f32_16x16x32_bf16 v[124:127], v[62:65], v[26:29], v[124:127]
v_rcp_f32 v104, v104
v_rcp_f32 v97, v97
v_rcp_f32_e64 v105, v105
s_xor_b32 s47, s37, 0x700000
buffer_load_dwordx4 a[224:227], v18, s[64:67], s47 offen offset:0 sc1
v_rcp_f32 v98, v98
v_rcp_f32 v106, v106
v_rcp_f32 v99, v99
v_rcp_f32 v107, v107
v_pk_mul_f32 v[100:101], v[100:101], v[96:97]
v_pk_mul_f32 v[108:109], v[108:109], v[104:105]
v_pk_mul_f32 v[102:103], v[102:103], v[98:99]
v_pk_mul_f32 v[110:111], v[110:111], v[106:107]
s_add_u32 s40, s54, 1024
v_cvt_pk_bf16_f32 v96, v100, v101
v_cvt_pk_bf16_f32 v98, v108, v109
v_cvt_pk_bf16_f32 v97, v102, v103
v_cvt_pk_bf16_f32 v99, v110, v111
buffer_store_dwordx4 v[96:99], v18, s[20:23], s40 offen sc1
v_pk_mul_f32 v[112:113], v[112:113], v[12:13] op_sel:[0,0] op_sel_hi:[1,0]
v_pk_mul_f32 v[120:121], v[120:121], v[12:13] op_sel:[0,0] op_sel_hi:[1,0]
v_pk_mul_f32 v[114:115], v[114:115], v[12:13] op_sel:[0,0] op_sel_hi:[1,0]
v_pk_mul_f32 v[122:123], v[122:123], v[12:13] op_sel:[0,0] op_sel_hi:[1,0]
v_exp_f32_e64 v112, v112
v_mfma_f32_16x16x32_bf16 v[128:131], v[50:53], v[28:31], v[128:131]
v_exp_f32_e64 v120, v120
v_mfma_f32_16x16x32_bf16 v[132:135], v[54:57], v[28:31], v[132:135]
buffer_load_dwordx4 a[228:231], v18, s[64:67], s47 offen offset:1024 sc1
v_exp_f32 v113, v113
v_exp_f32 v121, v121
v_exp_f32 v114, v114
v_exp_f32 v122, v122
v_exp_f32_e64 v115, v115
v_mfma_f32_16x16x32_bf16 v[136:139], v[58:61], v[28:31], v[136:139]
v_exp_f32_e64 v123, v123
v_pk_fma_f32 v[112:113], v[112:113], v[26:27], v[26:27] op_sel:[0,1,1] op_sel_hi:[1,1,1]
v_pk_fma_f32 v[120:121], v[120:121], v[26:27], v[26:27] op_sel:[0,1,1] op_sel_hi:[1,1,1]
v_pk_fma_f32 v[114:115], v[114:115], v[26:27], v[26:27] op_sel:[0,1,1] op_sel_hi:[1,1,1]
v_pk_fma_f32 v[122:123], v[122:123], v[26:27], v[26:27] op_sel:[0,1,1] op_sel_hi:[1,1,1]
v_rcp_f32_e64 v112, v112
v_mfma_f32_16x16x32_bf16 v[140:143], v[62:65], v[28:31], v[140:143]
v_rcp_f32 v120, v120
v_rcp_f32 v113, v113
v_rcp_f32 v121, v121
v_rcp_f32 v114, v114
v_rcp_f32 v122, v122
v_rcp_f32 v115, v115
v_rcp_f32_e64 v123, v123
v_pk_mul_f32 v[116:117], v[116:117], v[112:113]
v_pk_mul_f32 v[124:125], v[124:125], v[120:121]
s_xor_b32 s47, s37, 0x800000
buffer_load_dwordx4 a[232:235], v18, s[64:67], s47 offen offset:0 sc1
v_pk_mul_f32 v[118:119], v[118:119], v[114:115]
v_pk_mul_f32 v[126:127], v[126:127], v[122:123]
s_add_u32 s40, s54, 2048
v_cvt_pk_bf16_f32 v112, v116, v117
v_cvt_pk_bf16_f32 v114, v124, v125
v_cvt_pk_bf16_f32 v113, v118, v119
v_cvt_pk_bf16_f32 v115, v126, v127
buffer_store_dwordx4 v[112:115], v18, s[20:23], s40 offen sc1
v_pk_mul_f32 v[128:129], v[128:129], v[12:13] op_sel:[0,1] op_sel_hi:[1,1]
v_pk_mul_f32 v[136:137], v[136:137], v[12:13] op_sel:[0,1] op_sel_hi:[1,1]
v_pk_mul_f32 v[130:131], v[130:131], v[12:13] op_sel:[0,1] op_sel_hi:[1,1]
v_pk_mul_f32 v[138:139], v[138:139], v[12:13] op_sel:[0,1] op_sel_hi:[1,1]
v_exp_f32_e64 v128, v128
v_mfma_f32_16x16x32_bf16 v[144:147], v[50:53], v[30:33], v[144:147]
v_exp_f32_e64 v136, v136
v_mfma_f32_16x16x32_bf16 v[148:151], v[54:57], v[30:33], v[148:151]
v_exp_f32 v129, v129
v_exp_f32 v137, v137
v_exp_f32 v130, v130
v_exp_f32 v138, v138
v_exp_f32_e64 v131, v131
v_mfma_f32_16x16x32_bf16 v[152:155], v[58:61], v[30:33], v[152:155]
buffer_load_dwordx4 a[236:239], v18, s[64:67], s47 offen offset:1024 sc1
v_exp_f32_e64 v139, v139
v_pk_fma_f32 v[128:129], v[128:129], v[28:29], v[28:29] op_sel:[0,1,1] op_sel_hi:[1,1,1]
v_pk_fma_f32 v[136:137], v[136:137], v[28:29], v[28:29] op_sel:[0,1,1] op_sel_hi:[1,1,1]
v_pk_fma_f32 v[130:131], v[130:131], v[28:29], v[28:29] op_sel:[0,1,1] op_sel_hi:[1,1,1]
v_pk_fma_f32 v[138:139], v[138:139], v[28:29], v[28:29] op_sel:[0,1,1] op_sel_hi:[1,1,1]
v_rcp_f32_e64 v128, v128
v_mfma_f32_16x16x32_bf16 v[156:159], v[62:65], v[30:33], v[156:159]
v_rcp_f32 v136, v136
v_rcp_f32 v129, v129
v_rcp_f32 v137, v137
v_rcp_f32 v130, v130
v_rcp_f32 v138, v138
v_rcp_f32 v131, v131
v_rcp_f32_e64 v139, v139
v_pk_mul_f32 v[132:133], v[132:133], v[128:129]
v_pk_mul_f32 v[140:141], v[140:141], v[136:137]
v_pk_mul_f32 v[134:135], v[134:135], v[130:131]
v_pk_mul_f32 v[142:143], v[142:143], v[138:139]
s_add_u32 s40, s54, 3072
v_cvt_pk_bf16_f32 v128, v132, v133
v_cvt_pk_bf16_f32 v130, v140, v141
v_cvt_pk_bf16_f32 v129, v134, v135
s_xor_b32 s47, s37, 0x220000
buffer_load_dwordx4 a[240:243], v18, s[64:67], s47 offen offset:0 sc1
v_cvt_pk_bf16_f32 v131, v142, v143
buffer_store_dwordx4 v[128:131], v18, s[20:23], s40 offen sc1
v_pk_mul_f32 v[144:145], v[144:145], v[14:15] op_sel:[0,0] op_sel_hi:[1,0]
v_pk_mul_f32 v[152:153], v[152:153], v[14:15] op_sel:[0,0] op_sel_hi:[1,0]
v_pk_mul_f32 v[146:147], v[146:147], v[14:15] op_sel:[0,0] op_sel_hi:[1,0]
v_pk_mul_f32 v[154:155], v[154:155], v[14:15] op_sel:[0,0] op_sel_hi:[1,0]
v_exp_f32_e64 v144, v144
v_mfma_f32_16x16x32_bf16 v[160:163], v[50:53], v[32:35], v[160:163]
v_exp_f32_e64 v152, v152
v_mfma_f32_16x16x32_bf16 v[164:167], v[54:57], v[32:35], v[164:167]
v_exp_f32 v145, v145
v_exp_f32 v153, v153
v_exp_f32 v146, v146
v_exp_f32 v154, v154
v_exp_f32_e64 v147, v147
v_mfma_f32_16x16x32_bf16 v[168:171], v[58:61], v[32:35], v[168:171]
v_exp_f32_e64 v155, v155
v_pk_fma_f32 v[144:145], v[144:145], v[30:31], v[30:31] op_sel:[0,1,1] op_sel_hi:[1,1,1]
v_pk_fma_f32 v[152:153], v[152:153], v[30:31], v[30:31] op_sel:[0,1,1] op_sel_hi:[1,1,1]
v_pk_fma_f32 v[146:147], v[146:147], v[30:31], v[30:31] op_sel:[0,1,1] op_sel_hi:[1,1,1]
v_pk_fma_f32 v[154:155], v[154:155], v[30:31], v[30:31] op_sel:[0,1,1] op_sel_hi:[1,1,1]
v_rcp_f32_e64 v144, v144
buffer_load_dwordx4 a[244:247], v18, s[64:67], s47 offen offset:1024 sc1
v_mfma_f32_16x16x32_bf16 v[172:175], v[62:65], v[32:35], v[172:175]
v_rcp_f32 v152, v152
v_rcp_f32 v145, v145
v_rcp_f32 v153, v153
v_rcp_f32 v146, v146
v_rcp_f32 v154, v154
v_rcp_f32 v147, v147
v_rcp_f32_e64 v155, v155
v_pk_mul_f32 v[148:149], v[148:149], v[144:145]
v_pk_mul_f32 v[156:157], v[156:157], v[152:153]
v_pk_mul_f32 v[150:151], v[150:151], v[146:147]
v_pk_mul_f32 v[158:159], v[158:159], v[154:155]
s_add_u32 s40, s54, 4096
v_cvt_pk_bf16_f32 v144, v148, v149
v_cvt_pk_bf16_f32 v146, v156, v157
v_cvt_pk_bf16_f32 v145, v150, v151
v_cvt_pk_bf16_f32 v147, v158, v159
buffer_store_dwordx4 v[144:147], v18, s[20:23], s40 offen sc1
v_pk_mul_f32 v[160:161], v[160:161], v[14:15] op_sel:[0,1] op_sel_hi:[1,1]
v_pk_mul_f32 v[168:169], v[168:169], v[14:15] op_sel:[0,1] op_sel_hi:[1,1]
v_pk_mul_f32 v[162:163], v[162:163], v[14:15] op_sel:[0,1] op_sel_hi:[1,1]
v_pk_mul_f32 v[170:171], v[170:171], v[14:15] op_sel:[0,1] op_sel_hi:[1,1]
s_xor_b32 s47, s37, 0x2a0000
buffer_load_dwordx4 a[248:251], v18, s[64:67], s47 offen offset:0 sc1
v_exp_f32_e64 v160, v160
v_mfma_f32_16x16x32_bf16 v[176:179], v[50:53], v[34:37], v[176:179]
v_exp_f32_e64 v168, v168
v_mfma_f32_16x16x32_bf16 v[180:183], v[54:57], v[34:37], v[180:183]
v_exp_f32 v161, v161
v_exp_f32 v169, v169
v_exp_f32 v162, v162
v_exp_f32 v170, v170
v_exp_f32_e64 v163, v163
v_mfma_f32_16x16x32_bf16 v[184:187], v[58:61], v[34:37], v[184:187]
v_exp_f32_e64 v171, v171
v_pk_fma_f32 v[160:161], v[160:161], v[32:33], v[32:33] op_sel:[0,1,1] op_sel_hi:[1,1,1]
v_pk_fma_f32 v[168:169], v[168:169], v[32:33], v[32:33] op_sel:[0,1,1] op_sel_hi:[1,1,1]
v_pk_fma_f32 v[162:163], v[162:163], v[32:33], v[32:33] op_sel:[0,1,1] op_sel_hi:[1,1,1]
v_pk_fma_f32 v[170:171], v[170:171], v[32:33], v[32:33] op_sel:[0,1,1] op_sel_hi:[1,1,1]
v_rcp_f32_e64 v160, v160
v_mfma_f32_16x16x32_bf16 v[188:191], v[62:65], v[34:37], v[188:191]
v_rcp_f32 v168, v168
v_rcp_f32 v161, v161
v_rcp_f32 v169, v169
v_rcp_f32 v162, v162
v_rcp_f32_e64 v170, v170
buffer_load_dwordx4 a[252:255], v18, s[64:67], s47 offen offset:1024 sc1
v_rcp_f32 v163, v163
v_rcp_f32 v171, v171
v_pk_mul_f32 v[164:165], v[164:165], v[160:161]
v_pk_mul_f32 v[172:173], v[172:173], v[168:169]
v_pk_mul_f32 v[166:167], v[166:167], v[162:163]
v_pk_mul_f32 v[174:175], v[174:175], v[170:171]
s_add_u32 s40, s54, 5120
v_cvt_pk_bf16_f32 v160, v164, v165
v_cvt_pk_bf16_f32 v162, v172, v173
v_cvt_pk_bf16_f32 v161, v166, v167
v_cvt_pk_bf16_f32 v163, v174, v175
buffer_store_dwordx4 v[160:163], v18, s[20:23], s40 offen sc1
v_pk_mul_f32 v[176:177], v[176:177], v[16:17] op_sel:[0,0] op_sel_hi:[1,0]
v_pk_mul_f32 v[184:185], v[184:185], v[16:17] op_sel:[0,0] op_sel_hi:[1,0]
v_pk_mul_f32 v[178:179], v[178:179], v[16:17] op_sel:[0,0] op_sel_hi:[1,0]
v_pk_mul_f32 v[186:187], v[186:187], v[16:17] op_sel:[0,0] op_sel_hi:[1,0]
v_exp_f32_e64 v176, v176
v_mfma_f32_16x16x32_bf16 v[192:195], v[50:53], v[36:39], v[192:195]
v_exp_f32_e64 v184, v184
v_mfma_f32_16x16x32_bf16 v[196:199], v[54:57], v[36:39], v[196:199]
v_exp_f32 v177, v177
v_exp_f32 v185, v185
s_xor_b32 s47, s37, 0x200000
buffer_load_dwordx4 a[176:179], v18, s[64:67], s47 offen offset:0 sc1
v_exp_f32 v178, v178
v_exp_f32 v186, v186
v_exp_f32_e64 v179, v179
v_mfma_f32_16x16x32_bf16 v[200:203], v[58:61], v[36:39], v[200:203]
v_exp_f32_e64 v187, v187
v_pk_fma_f32 v[176:177], v[176:177], v[34:35], v[34:35] op_sel:[0,1,1] op_sel_hi:[1,1,1]
v_pk_fma_f32 v[184:185], v[184:185], v[34:35], v[34:35] op_sel:[0,1,1] op_sel_hi:[1,1,1]
v_pk_fma_f32 v[178:179], v[178:179], v[34:35], v[34:35] op_sel:[0,1,1] op_sel_hi:[1,1,1]
v_pk_fma_f32 v[186:187], v[186:187], v[34:35], v[34:35] op_sel:[0,1,1] op_sel_hi:[1,1,1]
v_rcp_f32_e64 v176, v176
v_mfma_f32_16x16x32_bf16 v[204:207], v[62:65], v[36:39], v[204:207]
v_rcp_f32 v184, v184
v_rcp_f32 v177, v177
v_rcp_f32 v185, v185
v_rcp_f32 v178, v178
v_rcp_f32 v186, v186
v_rcp_f32 v179, v179
v_rcp_f32_e64 v187, v187
v_pk_mul_f32 v[180:181], v[180:181], v[176:177]
v_pk_mul_f32 v[188:189], v[188:189], v[184:185]
v_pk_mul_f32 v[182:183], v[182:183], v[178:179]
v_pk_mul_f32 v[190:191], v[190:191], v[186:187]
buffer_load_dwordx4 a[180:183], v18, s[64:67], s47 offen offset:1024 sc1
s_add_u32 s40, s54, 6144
v_cvt_pk_bf16_f32 v176, v180, v181
v_cvt_pk_bf16_f32 v178, v188, v189
v_cvt_pk_bf16_f32 v177, v182, v183
v_cvt_pk_bf16_f32 v179, v190, v191
buffer_store_dwordx4 v[176:179], v18, s[20:23], s40 offen sc1
v_pk_mul_f32 v[192:193], v[192:193], v[16:17] op_sel:[0,1] op_sel_hi:[1,1]
ds_read_b128 v[10:13], v19 offset:512
v_pk_mul_f32 v[200:201], v[200:201], v[16:17] op_sel:[0,1] op_sel_hi:[1,1]
v_pk_mul_f32 v[194:195], v[194:195], v[16:17] op_sel:[0,1] op_sel_hi:[1,1]
v_mov_b32_e64 v58, v42
v_pk_mul_f32 v[202:203], v[202:203], v[16:17] op_sel:[0,1] op_sel_hi:[1,1]
v_mov_b32 v62, v43
v_exp_f32 v192, v192
v_exp_f32 v200, v200
v_mov_b32 v66, v44
v_exp_f32 v193, v193
v_mov_b32 v70, v45
v_exp_f32 v201, v201
v_mov_b32 v50, v40
v_exp_f32 v194, v194
v_exp_f32 v202, v202
s_xor_b32 s47, s37, 0x280000
buffer_load_dwordx4 a[184:187], v18, s[64:67], s47 offen offset:0 sc1
v_mov_b32 v54, v41
v_exp_f32 v195, v195
v_mfma_f32_16x16x32_bf16 v[240:243], v[58:61], v[36:39], v[240:243]
v_exp_f32_e64 v203, v203
v_pk_fma_f32 v[192:193], v[192:193], v[36:37], v[36:37] op_sel:[0,1,1] op_sel_hi:[1,1,1]
v_pk_fma_f32 v[200:201], v[200:201], v[36:37], v[36:37] op_sel:[0,1,1] op_sel_hi:[1,1,1]
v_pk_fma_f32 v[194:195], v[194:195], v[36:37], v[36:37] op_sel:[0,1,1] op_sel_hi:[1,1,1]
v_pk_fma_f32 v[202:203], v[202:203], v[36:37], v[36:37] op_sel:[0,1,1] op_sel_hi:[1,1,1]
v_rcp_f32_e64 v192, v192
v_mfma_f32_16x16x32_bf16 v[244:247], v[62:65], v[36:39], v[244:247]
v_mfma_f32_16x16x32_bf16 v[232:235], v[50:53], v[36:39], v[232:235]
v_mfma_f32_16x16x32_bf16 v[236:239], v[54:57], v[36:39], v[236:239]
v_mfma_f32_16x16x32_bf16 v[248:251], v[36:39], v[66:69], v[248:251]
v_rcp_f32_e64 v200, v200
v_mfma_f32_16x16x32_bf16 v[252:255], v[36:39], v[70:73], v[252:255]
v_rcp_f32 v193, v193
v_rcp_f32 v201, v201
v_rcp_f32 v194, v194
v_rcp_f32 v202, v202
v_rcp_f32 v195, v195
v_rcp_f32 v203, v203
v_pk_mul_f32 v[196:197], v[196:197], v[192:193]
buffer_load_dwordx4 a[188:191], v18, s[64:67], s47 offen offset:1024 sc1
v_pk_mul_f32 v[204:205], v[204:205], v[200:201]
v_pk_mul_f32 v[198:199], v[198:199], v[194:195]
v_pk_mul_f32 v[206:207], v[206:207], v[202:203]
s_add_u32 s40, s54, 7168
v_cvt_pk_bf16_f32 v192, v196, v197
v_cvt_pk_bf16_f32 v194, v204, v205
v_cvt_pk_bf16_f32 v193, v198, v199
v_cvt_pk_bf16_f32 v195, v206, v207
buffer_store_dwordx4 v[192:195], v18, s[20:23], s40 offen sc1
v_pk_mul_f32 v[240:241], v[240:241], v[8:9] op_sel:[0,1] op_sel_hi:[1,1]
ds_read_b128 v[14:17], v19 offset:64
v_pk_mul_f32 v[244:245], v[244:245], v[8:9] op_sel:[0,1] op_sel_hi:[1,1]
v_pk_mul_f32 v[242:243], v[242:243], v[8:9] op_sel:[0,1] op_sel_hi:[1,1]
v_pk_mul_f32 v[246:247], v[246:247], v[8:9] op_sel:[0,1] op_sel_hi:[1,1]
v_cvt_pk_bf16_f32 v112, v240, v241
v_mfma_f32_16x16x32_bf16 a[8:11], v[58:61], v[22:25], a[8:11]
v_cvt_pk_bf16_f32 v114, v244, v245
v_mfma_f32_16x16x32_bf16 a[12:15], v[62:65], v[22:25], a[12:15]
v_cvt_pk_bf16_f32 v113, v242, v243
v_cvt_pk_bf16_f32 v115, v246, v247
v_cvt_pk_bf16_f32 v144, v232, v233
v_mfma_f32_16x16x32_bf16 a[0:3], v[50:53], v[22:25], a[0:3]
v_cvt_pk_bf16_f32 v146, v236, v237
v_cvt_pk_bf16_f32 v145, v234, v235
v_mfma_f32_16x16x32_bf16 a[4:7], v[54:57], v[22:25], a[4:7]
v_cvt_pk_bf16_f32 v147, v238, v239
v_mul_f32 v9, 0x3e8293ee, v9
s_waitcnt lgkmcnt(1)
v_mfma_f32_16x16x32_bf16 a[16:19], v[22:25], v[66:69], a[16:19]
s_nop 0
v_pk_mul_f32 v[248:249], v[248:249], v[10:11]
v_pk_mul_f32 v[252:253], v[252:253], v[10:11]
v_pk_mul_f32 v[250:251], v[250:251], v[12:13]
v_pk_mul_f32 v[254:255], v[254:255], v[12:13]
v_cvt_pk_bf16_f32 v164, v248, v249
v_mfma_f32_16x16x32_bf16 a[20:23], v[22:25], v[70:73], a[20:23]
v_cvt_pk_bf16_f32 v182, v252, v253
v_cvt_pk_bf16_f32 v165, v250, v251
v_cvt_pk_bf16_f32 v183, v254, v255
s_lshl_b32 s41, s58, 11
s_add_u32 s41, s41, 147456
s_lshl2_add_u32 s40, s58, 162304
s_waitcnt vmcnt(28)
v_add_u32_e64 v236, s41, v18
v_accvgpr_read_b32 v240, a160
v_accvgpr_read_b32 v241, a161
v_accvgpr_read_b32 v242, a162
v_accvgpr_read_b32 v243, a163
s_add_u32 s41, s41, 1024
v_mov_b32 v238, s40
v_add_u32 v237, s41, v79
buffer_store_dwordx4 v[112:115], v18, s[20:23], s52 offen sc1
v_accvgpr_read_b32 v244, a164
v_accvgpr_read_b32 v245, a165
v_accvgpr_read_b32 v246, a166
v_accvgpr_read_b32 v247, a167
buffer_store_dwordx2 v[164:165], v79, s[20:23], s52 offen offset:1024 sc1
buffer_store_dwordx2 v[182:183], v79, s[20:23], s52 offen offset:1536 sc1
v_accvgpr_read_b32 v184, a8
v_accvgpr_read_b32 v188, a12
v_accvgpr_read_b32 v248, a168
v_accvgpr_read_b32 v249, a169
v_accvgpr_read_b32 v250, a170
v_accvgpr_read_b32 v251, a171
ds_read_b128 v[10:13], v19 offset:128
v_accvgpr_read_b32 v185, a9
v_accvgpr_read_b32 v189, a13
v_accvgpr_read_b32 v186, a10
v_accvgpr_read_b32 v252, a172
v_accvgpr_read_b32 v253, a173
v_accvgpr_read_b32 v254, a174
v_accvgpr_read_b32 v255, a175
v_mfma_f32_16x16x32_bf16 a[32:35], v[58:61], v[24:27], a[32:35]
v_accvgpr_read_b32 v190, a14
v_accvgpr_read_b32 v187, a11
v_accvgpr_read_b32 v191, a15
v_pk_mul_f32 v[184:185], v[184:185], v[2:3] op_sel:[0,0] op_sel_hi:[1,0]
v_pk_mul_f32 v[188:189], v[188:189], v[2:3] op_sel:[0,0] op_sel_hi:[1,0]
v_pk_mul_f32 v[186:187], v[186:187], v[2:3] op_sel:[0,0] op_sel_hi:[1,0]
v_pk_mul_f32 v[190:191], v[190:191], v[2:3] op_sel:[0,0] op_sel_hi:[1,0]
v_cvt_pk_bf16_f32 v84, v184, v185
v_mfma_f32_16x16x32_bf16 a[36:39], v[62:65], v[24:27], a[36:39]
v_mfma_f32_16x16x32_bf16 a[24:27], v[50:53], v[24:27], a[24:27]
v_cvt_pk_bf16_f32 v86, v188, v189
v_cvt_pk_bf16_f32 v85, v186, v187
v_cvt_pk_bf16_f32 v87, v190, v191
v_mfma_f32_16x16x32_bf16 a[28:31], v[54:57], v[24:27], a[28:31]
v_accvgpr_read_b32 v196, a0
v_accvgpr_read_b32 v200, a4
v_accvgpr_read_b32 v197, a1
v_accvgpr_read_b32 v201, a5
v_mfma_f32_16x16x32_bf16 a[40:43], v[24:27], v[66:69], a[40:43]
v_accvgpr_read_b32 v198, a2
v_accvgpr_read_b32 v202, a6
v_accvgpr_read_b32 v199, a3
v_mfma_f32_16x16x32_bf16 a[44:47], v[24:27], v[70:73], a[44:47]
v_accvgpr_read_b32 v203, a7
v_cvt_pk_bf16_f32 v116, v196, v197
v_cvt_pk_bf16_f32 v118, v200, v201
v_cvt_pk_bf16_f32 v117, v198, v199
v_cvt_pk_bf16_f32 v119, v202, v203
v_mul_f32 v2, 0x3e8293ee, v2
s_waitcnt lgkmcnt(1)
s_nop 0
s_xor_b32 s47, s37, 0x320000
buffer_load_dwordx4 a[0:3], v18, s[64:67], s47 offen offset:0 sc1
v_accvgpr_read_b32 v204, a16
v_accvgpr_read_b32 v192, a20
v_accvgpr_read_b32 v205, a17
v_accvgpr_read_b32 v193, a21
v_accvgpr_read_b32 v206, a18
v_accvgpr_read_b32 v194, a22
v_accvgpr_read_b32 v207, a19
v_accvgpr_read_b32 v195, a23
v_pk_mul_f32 v[204:205], v[204:205], v[14:15]
v_pk_mul_f32 v[192:193], v[192:193], v[14:15]
v_pk_mul_f32 v[206:207], v[206:207], v[16:17]
v_pk_mul_f32 v[194:195], v[194:195], v[16:17]
buffer_load_dwordx4 a[4:7], v18, s[64:67], s47 offen offset:1024 sc1
v_cvt_pk_bf16_f32 v150, v204, v205
v_cvt_pk_bf16_f32 v168, v192, v193
v_cvt_pk_bf16_f32 v151, v206, v207
v_cvt_pk_bf16_f32 v169, v194, v195
v_accvgpr_read_b32 v184, a32
v_accvgpr_read_b32 v188, a36
ds_read_b128 v[14:17], v19 offset:192
v_accvgpr_read_b32 v185, a33
v_accvgpr_read_b32 v189, a37
v_accvgpr_read_b32 v186, a34
v_mfma_f32_16x16x32_bf16 a[56:59], v[58:61], v[26:29], a[56:59]
v_accvgpr_read_b32 v190, a38
v_accvgpr_read_b32 v187, a35
s_xor_b32 s47, s37, 0x3a0000
buffer_load_dwordx4 a[8:11], v18, s[64:67], s47 offen offset:0 sc1
v_accvgpr_read_b32 v191, a39
v_pk_mul_f32 v[184:185], v[184:185], v[2:3] op_sel:[0,1] op_sel_hi:[1,1]
v_pk_mul_f32 v[188:189], v[188:189], v[2:3] op_sel:[0,1] op_sel_hi:[1,1]
v_pk_mul_f32 v[186:187], v[186:187], v[2:3] op_sel:[0,1] op_sel_hi:[1,1]
v_pk_mul_f32 v[190:191], v[190:191], v[2:3] op_sel:[0,1] op_sel_hi:[1,1]
v_cvt_pk_bf16_f32 v88, v184, v185
v_mfma_f32_16x16x32_bf16 a[60:63], v[62:65], v[26:29], a[60:63]
v_mfma_f32_16x16x32_bf16 a[48:51], v[50:53], v[26:29], a[48:51]
v_cvt_pk_bf16_f32 v90, v188, v189
v_cvt_pk_bf16_f32 v89, v186, v187
v_cvt_pk_bf16_f32 v91, v190, v191
v_mfma_f32_16x16x32_bf16 a[52:55], v[54:57], v[26:29], a[52:55]
v_accvgpr_read_b32 v196, a24
buffer_load_dwordx4 a[12:15], v18, s[64:67], s47 offen offset:1024 sc1
v_accvgpr_read_b32 v200, a28
v_accvgpr_read_b32 v197, a25
v_accvgpr_read_b32 v201, a29
v_mfma_f32_16x16x32_bf16 a[64:67], v[26:29], v[66:69], a[64:67]
v_accvgpr_read_b32 v198, a26
v_accvgpr_read_b32 v202, a30
v_accvgpr_read_b32 v199, a27
v_mfma_f32_16x16x32_bf16 a[68:71], v[26:29], v[70:73], a[68:71]
v_accvgpr_read_b32 v203, a31
v_cvt_pk_bf16_f32 v120, v196, v197
v_cvt_pk_bf16_f32 v122, v200, v201
v_cvt_pk_bf16_f32 v121, v198, v199
v_cvt_pk_bf16_f32 v123, v202, v203
v_mul_f32 v3, 0x3e8293ee, v3
s_waitcnt lgkmcnt(1)
s_nop 0
s_xor_b32 s47, s37, 0x420000
buffer_load_dwordx4 a[16:19], v18, s[64:67], s47 offen offset:0 sc1
v_accvgpr_read_b32 v204, a40
v_accvgpr_read_b32 v192, a44
v_accvgpr_read_b32 v205, a41
v_accvgpr_read_b32 v193, a45
v_accvgpr_read_b32 v206, a42
v_accvgpr_read_b32 v194, a46
v_accvgpr_read_b32 v207, a43
v_accvgpr_read_b32 v195, a47
v_pk_mul_f32 v[204:205], v[204:205], v[10:11]
v_mov_b32_e64 v76, 1
s_waitcnt vmcnt(5)
s_mov_b64 exec, 1
buffer_store_dword v76, off, s[16:19], s74 sc1
s_mov_b64 exec, -1
s_nop 0
v_pk_mul_f32 v[192:193], v[192:193], v[10:11]
v_pk_mul_f32 v[206:207], v[206:207], v[12:13]
v_pk_mul_f32 v[194:195], v[194:195], v[12:13]
buffer_load_dwordx4 a[20:23], v18, s[64:67], s47 offen offset:1024 sc1
v_cvt_pk_bf16_f32 v152, v204, v205
v_cvt_pk_bf16_f32 v170, v192, v193
v_cvt_pk_bf16_f32 v153, v206, v207
v_cvt_pk_bf16_f32 v171, v194, v195
v_accvgpr_read_b32 v184, a56
v_accvgpr_read_b32 v188, a60
ds_read_b128 v[10:13], v19 offset:256
v_accvgpr_read_b32 v185, a57
v_accvgpr_read_b32 v189, a61
v_accvgpr_read_b32 v186, a58
v_mfma_f32_16x16x32_bf16 a[80:83], v[58:61], v[28:31], a[80:83]
v_accvgpr_read_b32 v190, a62
v_accvgpr_read_b32 v187, a59
s_xor_b32 s47, s37, 0x520000
buffer_load_dwordx4 a[24:27], v18, s[64:67], s47 offen offset:0 sc1
v_accvgpr_read_b32 v191, a63
v_pk_mul_f32 v[184:185], v[184:185], v[4:5] op_sel:[0,0] op_sel_hi:[1,0]
v_pk_mul_f32 v[188:189], v[188:189], v[4:5] op_sel:[0,0] op_sel_hi:[1,0]
v_pk_mul_f32 v[186:187], v[186:187], v[4:5] op_sel:[0,0] op_sel_hi:[1,0]
v_pk_mul_f32 v[190:191], v[190:191], v[4:5] op_sel:[0,0] op_sel_hi:[1,0]
v_cvt_pk_bf16_f32 v92, v184, v185
v_mfma_f32_16x16x32_bf16 a[84:87], v[62:65], v[28:31], a[84:87]
v_mfma_f32_16x16x32_bf16 a[72:75], v[50:53], v[28:31], a[72:75]
v_cvt_pk_bf16_f32 v94, v188, v189
v_cvt_pk_bf16_f32 v93, v186, v187
v_cvt_pk_bf16_f32 v95, v190, v191
v_mfma_f32_16x16x32_bf16 a[76:79], v[54:57], v[28:31], a[76:79]
v_accvgpr_read_b32 v196, a48
buffer_load_dwordx4 a[28:31], v18, s[64:67], s47 offen offset:1024 sc1
v_accvgpr_read_b32 v200, a52
v_accvgpr_read_b32 v197, a49
v_accvgpr_read_b32 v201, a53
v_mfma_f32_16x16x32_bf16 a[88:91], v[28:31], v[66:69], a[88:91]
v_accvgpr_read_b32 v198, a50
v_accvgpr_read_b32 v202, a54
v_accvgpr_read_b32 v199, a51
v_mfma_f32_16x16x32_bf16 a[92:95], v[28:31], v[70:73], a[92:95]
v_accvgpr_read_b32 v203, a55
v_cvt_pk_bf16_f32 v124, v196, v197
v_cvt_pk_bf16_f32 v126, v200, v201
v_cvt_pk_bf16_f32 v125, v198, v199
v_cvt_pk_bf16_f32 v127, v202, v203
s_xor_b32 s47, s37, 0x720000
buffer_load_dwordx4 a[32:35], v18, s[64:67], s47 offen offset:0 sc1
v_mul_f32 v4, 0x3e8293ee, v4
s_waitcnt lgkmcnt(1)
s_nop 0
v_accvgpr_read_b32 v204, a64
v_accvgpr_read_b32 v192, a68
v_accvgpr_read_b32 v205, a65
v_accvgpr_read_b32 v193, a69
v_accvgpr_read_b32 v206, a66
v_accvgpr_read_b32 v194, a70
v_accvgpr_read_b32 v207, a67
v_accvgpr_read_b32 v195, a71
v_pk_mul_f32 v[204:205], v[204:205], v[14:15]
v_pk_mul_f32 v[192:193], v[192:193], v[14:15]
v_pk_mul_f32 v[206:207], v[206:207], v[16:17]
buffer_load_dwordx4 a[36:39], v18, s[64:67], s47 offen offset:1024 sc1
v_pk_mul_f32 v[194:195], v[194:195], v[16:17]
v_cvt_pk_bf16_f32 v154, v204, v205
v_cvt_pk_bf16_f32 v172, v192, v193
v_cvt_pk_bf16_f32 v155, v206, v207
v_cvt_pk_bf16_f32 v173, v194, v195
v_accvgpr_read_b32 v184, a80
v_accvgpr_read_b32 v188, a84
ds_read_b128 v[14:17], v19 offset:320
v_accvgpr_read_b32 v185, a81
v_accvgpr_read_b32 v189, a85
v_accvgpr_read_b32 v186, a82
v_mfma_f32_16x16x32_bf16 a[104:107], v[58:61], v[30:33], a[104:107]
v_accvgpr_read_b32 v190, a86
s_xor_b32 s47, s37, 0x820000
buffer_load_dwordx4 a[40:43], v18, s[64:67], s47 offen offset:0 sc1
v_accvgpr_read_b32 v187, a83
v_accvgpr_read_b32 v191, a87
v_pk_mul_f32 v[184:185], v[184:185], v[4:5] op_sel:[0,1] op_sel_hi:[1,1]
v_pk_mul_f32 v[188:189], v[188:189], v[4:5] op_sel:[0,1] op_sel_hi:[1,1]
v_pk_mul_f32 v[186:187], v[186:187], v[4:5] op_sel:[0,1] op_sel_hi:[1,1]
v_pk_mul_f32 v[190:191], v[190:191], v[4:5] op_sel:[0,1] op_sel_hi:[1,1]
v_cvt_pk_bf16_f32 v96, v184, v185
v_mfma_f32_16x16x32_bf16 a[108:111], v[62:65], v[30:33], a[108:111]
v_mfma_f32_16x16x32_bf16 a[96:99], v[50:53], v[30:33], a[96:99]
v_cvt_pk_bf16_f32 v98, v188, v189
v_cvt_pk_bf16_f32 v97, v186, v187
v_cvt_pk_bf16_f32 v99, v190, v191
v_mfma_f32_16x16x32_bf16 a[100:103], v[54:57], v[30:33], a[100:103]
buffer_load_dwordx4 a[44:47], v18, s[64:67], s47 offen offset:1024 sc1
v_accvgpr_read_b32 v196, a72
v_accvgpr_read_b32 v200, a76
v_accvgpr_read_b32 v197, a73
v_accvgpr_read_b32 v201, a77
v_mfma_f32_16x16x32_bf16 a[112:115], v[30:33], v[66:69], a[112:115]
v_accvgpr_read_b32 v198, a74
v_accvgpr_read_b32 v202, a78
v_accvgpr_read_b32 v199, a75
v_mfma_f32_16x16x32_bf16 a[116:119], v[30:33], v[70:73], a[116:119]
v_accvgpr_read_b32 v203, a79
v_cvt_pk_bf16_f32 v128, v196, v197
v_cvt_pk_bf16_f32 v130, v200, v201
v_cvt_pk_bf16_f32 v129, v198, v199
s_xor_b32 s47, s37, 0x440000
buffer_load_dwordx4 a[48:51], v18, s[64:67], s47 offen offset:0 sc1
v_cvt_pk_bf16_f32 v131, v202, v203
v_mul_f32 v5, 0x3e8293ee, v5
s_waitcnt lgkmcnt(1)
s_nop 0
v_accvgpr_read_b32 v204, a88
v_accvgpr_read_b32 v192, a92
v_accvgpr_read_b32 v205, a89
v_accvgpr_read_b32 v193, a93
v_accvgpr_read_b32 v206, a90
v_accvgpr_read_b32 v194, a94
v_accvgpr_read_b32 v207, a91
v_accvgpr_read_b32 v195, a95
v_pk_mul_f32 v[204:205], v[204:205], v[10:11]
v_pk_mul_f32 v[192:193], v[192:193], v[10:11]
buffer_load_dwordx4 a[52:55], v18, s[64:67], s47 offen offset:1024 sc1
v_pk_mul_f32 v[206:207], v[206:207], v[12:13]
v_pk_mul_f32 v[194:195], v[194:195], v[12:13]
v_cvt_pk_bf16_f32 v156, v204, v205
v_cvt_pk_bf16_f32 v174, v192, v193
v_cvt_pk_bf16_f32 v157, v206, v207
v_cvt_pk_bf16_f32 v175, v194, v195
v_accvgpr_read_b32 v184, a104
v_accvgpr_read_b32 v188, a108
ds_read_b128 v[10:13], v19 offset:384
v_accvgpr_read_b32 v185, a105
v_accvgpr_read_b32 v189, a109
v_accvgpr_read_b32 v186, a106
v_mfma_f32_16x16x32_bf16 a[128:131], v[58:61], v[32:35], a[128:131]
s_xor_b32 s47, s37, 0x540000
buffer_load_dwordx4 a[56:59], v18, s[64:67], s47 offen offset:0 sc1
v_accvgpr_read_b32 v190, a110
v_accvgpr_read_b32 v187, a107
v_accvgpr_read_b32 v191, a111
v_pk_mul_f32 v[184:185], v[184:185], v[6:7] op_sel:[0,0] op_sel_hi:[1,0]
v_pk_mul_f32 v[188:189], v[188:189], v[6:7] op_sel:[0,0] op_sel_hi:[1,0]
v_pk_mul_f32 v[186:187], v[186:187], v[6:7] op_sel:[0,0] op_sel_hi:[1,0]
v_pk_mul_f32 v[190:191], v[190:191], v[6:7] op_sel:[0,0] op_sel_hi:[1,0]
v_cvt_pk_bf16_f32 v100, v184, v185
v_mfma_f32_16x16x32_bf16 a[132:135], v[62:65], v[32:35], a[132:135]
v_mfma_f32_16x16x32_bf16 a[120:123], v[50:53], v[32:35], a[120:123]
v_cvt_pk_bf16_f32 v102, v188, v189
v_cvt_pk_bf16_f32 v101, v186, v187
v_cvt_pk_bf16_f32 v103, v190, v191
buffer_load_dwordx4 a[60:63], v18, s[64:67], s47 offen offset:1024 sc1
v_mfma_f32_16x16x32_bf16 a[124:127], v[54:57], v[32:35], a[124:127]
v_accvgpr_read_b32 v196, a96
v_accvgpr_read_b32 v200, a100
v_accvgpr_read_b32 v197, a97
v_accvgpr_read_b32 v201, a101
v_mfma_f32_16x16x32_bf16 a[136:139], v[32:35], v[66:69], a[136:139]
v_accvgpr_read_b32 v198, a98
v_accvgpr_read_b32 v202, a102
v_accvgpr_read_b32 v199, a99
v_mfma_f32_16x16x32_bf16 a[140:143], v[32:35], v[70:73], a[140:143]
v_accvgpr_read_b32 v203, a103
v_cvt_pk_bf16_f32 v132, v196, v197
v_cvt_pk_bf16_f32 v134, v200, v201
s_xor_b32 s47, s37, 0x740000
buffer_load_dwordx4 a[64:67], v18, s[64:67], s47 offen offset:0 sc1
v_cvt_pk_bf16_f32 v133, v198, v199
v_cvt_pk_bf16_f32 v135, v202, v203
v_mul_f32 v6, 0x3e8293ee, v6
s_waitcnt lgkmcnt(1)
s_nop 0
v_accvgpr_read_b32 v204, a112
v_accvgpr_read_b32 v192, a116
v_accvgpr_read_b32 v205, a113
v_accvgpr_read_b32 v193, a117
v_accvgpr_read_b32 v206, a114
v_accvgpr_read_b32 v194, a118
v_accvgpr_read_b32 v207, a115
v_accvgpr_read_b32 v195, a119
v_pk_mul_f32 v[204:205], v[204:205], v[14:15]
buffer_load_dwordx4 a[68:71], v18, s[64:67], s47 offen offset:1024 sc1
v_pk_mul_f32 v[192:193], v[192:193], v[14:15]
v_pk_mul_f32 v[206:207], v[206:207], v[16:17]
v_pk_mul_f32 v[194:195], v[194:195], v[16:17]
v_cvt_pk_bf16_f32 v158, v204, v205
v_cvt_pk_bf16_f32 v176, v192, v193
v_cvt_pk_bf16_f32 v159, v206, v207
v_cvt_pk_bf16_f32 v177, v194, v195
v_accvgpr_read_b32 v184, a128
v_accvgpr_read_b32 v188, a132
ds_read_b128 v[14:17], v19 offset:448
v_accvgpr_read_b32 v185, a129
v_accvgpr_read_b32 v189, a133
v_accvgpr_read_b32 v186, a130
s_xor_b32 s47, s37, 0x840000
buffer_load_dwordx4 a[72:75], v18, s[64:67], s47 offen offset:0 sc1
v_mfma_f32_16x16x32_bf16 v[216:219], v[58:61], v[34:37], v[216:219]
v_accvgpr_read_b32 v190, a134
v_accvgpr_read_b32 v187, a131
v_accvgpr_read_b32 v191, a135
v_pk_mul_f32 v[184:185], v[184:185], v[6:7] op_sel:[0,1] op_sel_hi:[1,1]
v_pk_mul_f32 v[188:189], v[188:189], v[6:7] op_sel:[0,1] op_sel_hi:[1,1]
v_pk_mul_f32 v[186:187], v[186:187], v[6:7] op_sel:[0,1] op_sel_hi:[1,1]
v_pk_mul_f32 v[190:191], v[190:191], v[6:7] op_sel:[0,1] op_sel_hi:[1,1]
v_cvt_pk_bf16_f32 v104, v184, v185
v_mfma_f32_16x16x32_bf16 v[220:223], v[62:65], v[34:37], v[220:223]
v_mfma_f32_16x16x32_bf16 v[208:211], v[50:53], v[34:37], v[208:211]
v_cvt_pk_bf16_f32 v106, v188, v189
v_cvt_pk_bf16_f32 v105, v186, v187
buffer_load_dwordx4 a[76:79], v18, s[64:67], s47 offen offset:1024 sc1
v_cvt_pk_bf16_f32 v107, v190, v191
v_mfma_f32_16x16x32_bf16 v[212:215], v[54:57], v[34:37], v[212:215]
v_accvgpr_read_b32 v196, a120
v_accvgpr_read_b32 v200, a124
v_accvgpr_read_b32 v197, a121
v_accvgpr_read_b32 v201, a125
v_mfma_f32_16x16x32_bf16 v[224:227], v[34:37], v[66:69], v[224:227]
v_accvgpr_read_b32 v198, a122
v_accvgpr_read_b32 v202, a126
v_accvgpr_read_b32 v199, a123
v_mfma_f32_16x16x32_bf16 v[228:231], v[34:37], v[70:73], v[228:231]
v_accvgpr_read_b32 v203, a127
v_cvt_pk_bf16_f32 v136, v196, v197
s_xor_b32 s47, s37, 0x240000
buffer_load_dwordx4 a[80:83], v18, s[64:67], s47 offen offset:0 sc1
v_cvt_pk_bf16_f32 v138, v200, v201
v_cvt_pk_bf16_f32 v137, v198, v199
v_cvt_pk_bf16_f32 v139, v202, v203
v_mul_f32 v7, 0x3e8293ee, v7
s_waitcnt lgkmcnt(1)
s_nop 0
v_accvgpr_read_b32 v204, a136
v_accvgpr_read_b32 v192, a140
v_accvgpr_read_b32 v205, a137
v_accvgpr_read_b32 v193, a141
v_accvgpr_read_b32 v206, a138
v_accvgpr_read_b32 v194, a142
v_accvgpr_read_b32 v207, a139
v_accvgpr_read_b32 v195, a143
buffer_load_dwordx4 a[84:87], v18, s[64:67], s47 offen offset:1024 sc1
v_pk_mul_f32 v[204:205], v[204:205], v[10:11]
v_pk_mul_f32 v[192:193], v[192:193], v[10:11]
v_pk_mul_f32 v[206:207], v[206:207], v[12:13]
v_pk_mul_f32 v[194:195], v[194:195], v[12:13]
v_cvt_pk_bf16_f32 v160, v204, v205
v_cvt_pk_bf16_f32 v178, v192, v193
v_cvt_pk_bf16_f32 v161, v206, v207
v_cvt_pk_bf16_f32 v179, v194, v195
v_pk_mul_f32 v[216:217], v[216:217], v[8:9] op_sel:[0,0] op_sel_hi:[1,0]
v_pk_mul_f32 v[220:221], v[220:221], v[8:9] op_sel:[0,0] op_sel_hi:[1,0]
v_pk_mul_f32 v[218:219], v[218:219], v[8:9] op_sel:[0,0] op_sel_hi:[1,0]
v_pk_mul_f32 v[222:223], v[222:223], v[8:9] op_sel:[0,0] op_sel_hi:[1,0]
v_cvt_pk_bf16_f32 v108, v216, v217
s_xor_b32 s47, s37, 0x2c0000
buffer_load_dwordx4 a[88:91], v18, s[64:67], s47 offen offset:0 sc1
v_cvt_pk_bf16_f32 v110, v220, v221
v_cvt_pk_bf16_f32 v109, v218, v219
v_cvt_pk_bf16_f32 v111, v222, v223
v_cvt_pk_bf16_f32 v140, v208, v209
v_cvt_pk_bf16_f32 v142, v212, v213
v_cvt_pk_bf16_f32 v141, v210, v211
v_cvt_pk_bf16_f32 v143, v214, v215
v_mul_f32 v8, 0x3e8293ee, v8
s_waitcnt lgkmcnt(0)
s_nop 0
v_pk_mul_f32 v[224:225], v[224:225], v[14:15]
v_pk_mul_f32 v[228:229], v[228:229], v[14:15]
v_pk_mul_f32 v[226:227], v[226:227], v[16:17]
v_pk_mul_f32 v[230:231], v[230:231], v[16:17]
buffer_load_dwordx4 a[92:95], v18, s[64:67], s47 offen offset:1024 sc1
v_cvt_pk_bf16_f32 v162, v224, v225
v_cvt_pk_bf16_f32 v180, v228, v229
v_cvt_pk_bf16_f32 v163, v226, v227
v_cvt_pk_bf16_f32 v181, v230, v231
v_and_b32 v74, 15, v0
v_lshrrev_b32 v75, 4, v0
v_lshlrev_b32 v75, 2, v75
v_sub_u32 v74, v74, v75
v_mov_b32 v77, 0xf149f2ca
s_mov_b32 s42, 0x80000001
s_brev_b32 s41, 1
v_subrev_u32 v75, 0, v74
v_and_b32_e64 v75, s42, v75
s_xor_b32 s47, s37, 0x340000
buffer_load_dwordx4 a[96:99], v18, s[64:67], s47 offen offset:0 sc1
v_cmp_eq_u32 vcc, 0, v75
s_nop 1
v_cndmask_b32 v228, v77, 0, vcc
v_cmp_eq_u32 vcc, s41, v75
s_nop 1
v_cndmask_b32 v224, v77, 0, vcc
v_subrev_u32 v75, 1, v74
v_and_b32 v75, s42, v75
v_cmp_eq_u32 vcc, 0, v75
s_nop 1
v_cndmask_b32 v229, v77, 0, vcc
v_cmp_eq_u32 vcc, s41, v75
s_nop 1
v_cndmask_b32 v225, v77, 0, vcc
v_subrev_u32 v75, 2, v74
v_and_b32 v75, s42, v75
v_cmp_eq_u32 vcc, 0, v75
s_nop 1
v_cndmask_b32 v230, v77, 0, vcc
buffer_load_dwordx4 a[100:103], v18, s[64:67], s47 offen offset:1024 sc1
v_cmp_eq_u32 vcc, s41, v75
s_nop 1
v_cndmask_b32 v226, v77, 0, vcc
v_subrev_u32 v75, 3, v74
v_and_b32 v75, s42, v75
v_cmp_eq_u32 vcc, 0, v75
s_nop 1
v_cndmask_b32 v231, v77, 0, vcc
v_cmp_eq_u32 vcc, s41, v75
s_nop 1
v_cndmask_b32 v227, v77, 0, vcc
v_cvt_pk_bf16_f32 v40, v224, v225
v_cvt_pk_bf16_f32 v41, v226, v227
v_cvt_pk_bf16_f32 v42, v228, v229
v_cvt_pk_bf16_f32 v43, v230, v231
s_xor_b32 s47, s37, 0x3c0000
buffer_load_dwordx4 a[104:107], v18, s[64:67], s47 offen offset:0 sc1
v_mov_b32 v44, 0x3f803f80
v_pk_ashrrev_i16 v40, 15, v40 op_sel_hi:[0,1]
v_mov_b32 v45, 0x3f803f80
v_pk_ashrrev_i16 v41, 15, v41 op_sel_hi:[0,1]
v_mov_b32 v46, 0x3f803f80
v_pk_ashrrev_i16 v42, 15, v42 op_sel_hi:[0,1]
v_mov_b32 v47, 0x3f803f80
v_pk_ashrrev_i16 v43, 15, v43 op_sel_hi:[0,1]
s_nop 1
v_mfma_f32_16x16x32_bf16 v[184:187], v[84:87], v[120:123], v[224:227]
v_mfma_f32_16x16x32_bf16 v[188:191], v[88:91], v[120:123], v[228:231]
s_nop 6
v_max_f32 v202, v184, v185
v_max_f32 v203, v186, v187
v_max3_f32 v202, v202, v188, v189
buffer_load_dwordx4 a[108:111], v18, s[64:67], s47 offen offset:1024 sc1
v_max3_f32 v203, v203, v190, v191
v_max_f32 v200, v202, v203
v_max_f32 v201, v202, v203
v_mfma_f32_16x16x32_bf16 v[204:207], v[88:91], v[124:127], v[224:227]
v_xor_b32_e64 v76, s35, v18
v_and_b32 v78, 0x3c0, v76
v_add_u32 v76, v76, v78
v_mov_b32 v78, 2
s_mov_b32 exec_lo, 0xf
s_mov_b32 exec_hi, 0xf
buffer_load_dword v78, v76, s[16:19], s73 offen sc1
s_mov_b64 exec, -1
v_permlane16_swap_b32 v200, v201
v_max_f32_e64 v184, v200, v201
v_mfma_f32_16x16x32_bf16 v[208:211], v[92:95], v[124:127], v[228:231]
v_max_f32 v201, v200, v201
s_nop 1
v_permlane32_swap_b32 v184, v201
v_max_f32 v200, v184, v201
v_pk_add_f32 v[202:203], v[202:203], v[200:201] op_sel_hi:[1,0] neg_lo:[0,1] neg_hi:[0,1]
v_max_f32_e64 v222, v204, v205
v_pk_mul_f32 v[202:203], v[202:203], v[2:3] op_sel:[0,1] op_sel_hi:[1,1]
s_xor_b32 s47, s37, 0x600000
buffer_load_dwordx4 a[112:115], v18, s[64:67], s47 offen offset:0 sc1
v_max_f32 v223, v206, v207
v_exp_f32 v202, v202
v_max3_f32 v222, v222, v208, v209
v_exp_f32_e64 v203, v203
v_max3_f32 v223, v223, v210, v211
v_cvt_pk_bf16_f32 v202, v202, v202
v_max_f32_e64 v220, v222, v223
v_cvt_pk_bf16_f32 v203, v203, v203
v_max_f32_e64 v221, v222, v223
v_bfi_b32 v192, v40, 0, v202
s_nop 0
v_permlane16_swap_b32 v220, v221
v_mfma_f32_16x16x32_bf16 v[20:23], v[92:95], v[128:131], v[224:227]
v_bfi_b32 v193, v41, 0, v203
buffer_load_dwordx4 a[116:119], v18, s[64:67], s47 offen offset:1024 sc1
v_max_f32_e64 v204, v220, v221
v_bfi_b32 v194, v42, 0, v202
v_max_f32_e64 v221, v220, v221
v_mfma_f32_16x16x32_bf16 v[24:27], v[96:99], v[128:131], v[228:231]
v_bfi_b32 v195, v43, 0, v203
v_permlane32_swap_b32 v204, v221
v_max_f32 v220, v204, v221
v_mfma_f32_16x16x32_bf16 v[196:199], v[44:47], v[192:195], 0
v_pk_add_f32 v[222:223], v[222:223], v[220:221] op_sel_hi:[1,0] neg_lo:[0,1] neg_hi:[0,1]
v_pk_mul_f32 v[222:223], v[222:223], v[4:5] op_sel:[0,0] op_sel_hi:[1,0]
v_max_f32_e64 v38, v20, v21
v_mfma_f32_16x16x32_bf16 v[184:187], v[150:153], v[192:195], 0
v_exp_f32_e64 v222, v222
s_xor_b32 s47, s37, 0x680000
buffer_load_dwordx4 a[120:123], v18, s[64:67], s47 offen offset:0 sc1
v_max_f32 v39, v22, v23
v_exp_f32 v223, v223
v_max3_f32 v38, v38, v24, v25
v_mfma_f32_16x16x32_bf16 v[188:191], v[168:171], v[192:195], 0
v_cvt_pk_bf16_f32 v222, v222, v222
v_max3_f32 v39, v39, v26, v27
s_add_u32 s40, s53, 1024
v_cvt_pk_bf16_f32 v223, v223, v223
v_max_f32_e64 v36, v38, v39
v_bfi_b32 v212, v40, 0, v222
v_max_f32 v37, v38, v39
v_rcp_f32 v200, v196
v_bfi_b32 v213, v41, 0, v223
buffer_load_dwordx4 a[124:127], v18, s[64:67], s47 offen offset:1024 sc1
v_permlane16_swap_b32 v36, v37
v_mfma_f32_16x16x32_bf16 v[48:51], v[96:99], v[132:135], v[224:227]
v_bfi_b32 v214, v42, 0, v222
v_max_f32 v20, v36, v37
v_pk_mul_f32 v[184:185], v[184:185], v[200:201] op_sel:[0,0] op_sel_hi:[1,0]
v_bfi_b32 v215, v43, 0, v223
v_max_f32_e64 v37, v36, v37
v_mfma_f32_16x16x32_bf16 v[52:55], v[100:103], v[132:135], v[228:231]
v_pk_mul_f32 v[186:187], v[186:187], v[200:201] op_sel:[0,0] op_sel_hi:[1,0]
v_permlane32_swap_b32 v20, v37
v_pk_mul_f32 v[188:189], v[188:189], v[200:201] op_sel:[0,0] op_sel_hi:[1,0]
s_nop 1
v_mfma_f32_16x16x32_bf16 v[216:219], v[44:47], v[212:215], 0
v_max_f32_e64 v36, v20, v37
v_pk_mul_f32 v[190:191], v[190:191], v[200:201] op_sel:[0,0] op_sel_hi:[1,0]
v_pk_add_f32 v[38:39], v[38:39], v[36:37] op_sel_hi:[1,0] neg_lo:[0,1] neg_hi:[0,1]
v_cvt_pk_bf16_f32 v192, v184, v185
v_mfma_f32_16x16x32_bf16 v[204:207], v[152:155], v[212:215], 0
v_pk_mul_f32 v[38:39], v[38:39], v[4:5] op_sel:[0,1] op_sel_hi:[1,1]
v_max_f32_e64 v66, v48, v49
v_cvt_pk_bf16_f32 v194, v188, v189
v_exp_f32 v38, v38
v_max_f32 v67, v50, v51
v_cvt_pk_bf16_f32 v193, v186, v187
v_mfma_f32_16x16x32_bf16 v[208:211], v[170:173], v[212:215], 0
v_exp_f32_e64 v39, v39
v_max3_f32 v66, v66, v52, v53
v_cvt_pk_bf16_f32 v195, v190, v191
s_add_u32 s41, s53, 2048
v_cvt_pk_bf16_f32 v38, v38, v38
v_max3_f32 v67, v67, v54, v55
buffer_store_dwordx4 v[192:195], v18, s[20:23], s40 offen sc1
v_cvt_pk_bf16_f32 v39, v39, v39
v_max_f32_e64 v64, v66, v67
v_mfma_f32_16x16x32_bf16 v[184:187], v[100:103], v[136:139], v[224:227]
v_rcp_f32_e64 v220, v216
v_bfi_b32 v28, v40, 0, v38
v_max_f32_e64 v65, v66, v67
v_bfi_b32 v29, v41, 0, v39
s_nop 0
v_permlane16_swap_b32 v64, v65
v_mfma_f32_16x16x32_bf16 v[188:191], v[104:107], v[136:139], v[228:231]
v_pk_mul_f32 v[204:205], v[204:205], v[220:221] op_sel:[0,0] op_sel_hi:[1,0]
v_bfi_b32 v30, v42, 0, v38
v_max_f32_e64 v48, v64, v65
v_pk_mul_f32 v[206:207], v[206:207], v[220:221] op_sel:[0,0] op_sel_hi:[1,0]
v_bfi_b32 v31, v43, 0, v39
v_max_f32_e64 v65, v64, v65
v_pk_mul_f32 v[208:209], v[208:209], v[220:221] op_sel:[0,0] op_sel_hi:[1,0]
s_nop 0
v_permlane32_swap_b32 v48, v65
v_pk_mul_f32 v[210:211], v[210:211], v[220:221] op_sel:[0,0] op_sel_hi:[1,0]
s_nop 1
v_mfma_f32_16x16x32_bf16 v[32:35], v[44:47], v[28:31], 0
v_max_f32 v64, v48, v65
v_max_f32_e64 v202, v184, v185
v_cvt_pk_bf16_f32 v212, v204, v205
v_pk_add_f32 v[66:67], v[66:67], v[64:65] op_sel_hi:[1,0] neg_lo:[0,1] neg_hi:[0,1]
v_max_f32_e64 v203, v186, v187
v_cvt_pk_bf16_f32 v214, v208, v209
v_mfma_f32_16x16x32_bf16 v[20:23], v[154:157], v[28:31], 0
v_pk_mul_f32 v[66:67], v[66:67], v[6:7] op_sel:[0,0] op_sel_hi:[1,0]
v_max3_f32 v202, v202, v188, v189
v_cvt_pk_bf16_f32 v213, v206, v207
v_exp_f32_e64 v66, v66
v_max3_f32 v203, v203, v190, v191
v_cvt_pk_bf16_f32 v215, v210, v211
v_mfma_f32_16x16x32_bf16 v[24:27], v[172:175], v[28:31], 0
v_exp_f32 v67, v67
v_max_f32 v200, v202, v203
buffer_store_dwordx4 v[212:215], v18, s[20:23], s41 offen sc1
s_add_u32 s42, s53, 3072
v_cvt_pk_bf16_f32 v66, v66, v66
v_max_f32_e64 v201, v202, v203
v_mfma_f32_16x16x32_bf16 v[204:207], v[104:107], v[140:143], v[224:227]
v_cvt_pk_bf16_f32 v67, v67, v67
v_permlane16_swap_b32 v200, v201
v_rcp_f32 v36, v32
v_bfi_b32 v56, v40, 0, v66
v_max_f32_e64 v184, v200, v201
v_mfma_f32_16x16x32_bf16 v[208:211], v[108:111], v[140:143], v[228:231]
v_bfi_b32 v57, v41, 0, v67
v_max_f32_e64 v201, v200, v201
v_pk_mul_f32 v[20:21], v[20:21], v[36:37] op_sel:[0,0] op_sel_hi:[1,0]
v_bfi_b32 v58, v42, 0, v66
v_permlane32_swap_b32 v184, v201
v_pk_mul_f32 v[22:23], v[22:23], v[36:37] op_sel:[0,0] op_sel_hi:[1,0]
v_bfi_b32 v59, v43, 0, v67
v_max_f32 v200, v184, v201
v_pk_mul_f32 v[24:25], v[24:25], v[36:37] op_sel:[0,0] op_sel_hi:[1,0]
v_pk_add_f32 v[202:203], v[202:203], v[200:201] op_sel_hi:[1,0] neg_lo:[0,1] neg_hi:[0,1]
v_max_f32_e64 v222, v204, v205
v_pk_mul_f32 v[26:27], v[26:27], v[36:37] op_sel:[0,0] op_sel_hi:[1,0]
s_nop 1
v_mfma_f32_16x16x32_bf16 v[60:63], v[44:47], v[56:59], 0
v_pk_mul_f32 v[202:203], v[202:203], v[6:7] op_sel:[0,1] op_sel_hi:[1,1]
v_max_f32 v223, v206, v207
v_cvt_pk_bf16_f32 v28, v20, v21
v_exp_f32_e64 v202, v202
v_max3_f32 v222, v222, v208, v209
v_cvt_pk_bf16_f32 v30, v24, v25
v_mfma_f32_16x16x32_bf16 v[48:51], v[156:159], v[56:59], 0
v_exp_f32_e64 v203, v203
v_max3_f32 v223, v223, v210, v211
v_cvt_pk_bf16_f32 v29, v22, v23
v_cvt_pk_bf16_f32 v202, v202, v202
v_max_f32_e64 v220, v222, v223
v_cvt_pk_bf16_f32 v31, v26, v27
v_mfma_f32_16x16x32_bf16 v[52:55], v[174:177], v[56:59], 0
v_cvt_pk_bf16_f32 v203, v203, v203
v_max_f32_e64 v221, v222, v223
buffer_store_dwordx4 v[28:31], v18, s[20:23], s42 offen sc1
s_add_u32 s55, s53, 4096
v_bfi_b32 v192, v40, 0, v202
ds_read_b32 v239, v238
ds_read_b128 v[80:83], v236
ds_read_b64 v[148:149], v237 offset:0
ds_read_b64 v[166:167], v237 offset:512
v_permlane16_swap_b32 v220, v221
v_mfma_f32_16x16x32_bf16 v[20:23], v[108:111], v[144:147], v[224:227]
v_bfi_b32 v193, v41, 0, v203
v_max_f32 v204, v220, v221
v_rcp_f32_e64 v64, v60
v_bfi_b32 v194, v42, 0, v202
v_max_f32_e64 v221, v220, v221
v_mfma_f32_16x16x32_bf16 v[24:27], v[112:115], v[144:147], v[228:231]
v_bfi_b32 v195, v43, 0, v203
v_permlane32_swap_b32 v204, v221
v_pk_mul_f32 v[48:49], v[48:49], v[64:65] op_sel:[0,0] op_sel_hi:[1,0]
v_max_f32 v220, v204, v221
v_pk_mul_f32 v[50:51], v[50:51], v[64:65] op_sel:[0,0] op_sel_hi:[1,0]
s_nop 1
v_mfma_f32_16x16x32_bf16 v[196:199], v[44:47], v[192:195], 0
v_pk_add_f32 v[222:223], v[222:223], v[220:221] op_sel_hi:[1,0] neg_lo:[0,1] neg_hi:[0,1]
s_waitcnt vmcnt(7)
v_cmp_gt_u32 vcc, 1, v78
s_nop 0
s_cmp_lg_u32 vcc_hi, 0
s_cselect_b32 s62, 0, 0x1200000
v_pk_mul_f32 v[52:53], v[52:53], v[64:65] op_sel:[0,0] op_sel_hi:[1,0]
s_add_u32 m0, s39, 0
s_xor_b32 s46, s32, 0xc00000
buffer_load_dwordx4 v18, s[60:63], s46 offen offset:0 sc1 lds
v_pk_mul_f32 v[222:223], v[222:223], v[8:9] op_sel:[0,0] op_sel_hi:[1,0]
v_max_f32_e64 v38, v20, v21
v_pk_mul_f32 v[54:55], v[54:55], v[64:65] op_sel:[0,0] op_sel_hi:[1,0]
s_nop 1
v_mfma_f32_16x16x32_bf16 v[184:187], v[158:161], v[192:195], 0
v_exp_f32 v222, v222
v_max_f32_e64 v39, v22, v23
v_cvt_pk_bf16_f32 v56, v48, v49
buffer_load_dwordx4 v18, s[60:63], s46 offen offset:1024 sc1 lds
v_exp_f32_e64 v223, v223
v_max3_f32 v38, v38, v24, v25
v_cvt_pk_bf16_f32 v58, v52, v53
v_mfma_f32_16x16x32_bf16 v[188:191], v[176:179], v[192:195], 0
v_cvt_pk_bf16_f32 v222, v222, v222
v_max3_f32 v39, v39, v26, v27
v_cvt_pk_bf16_f32 v57, v50, v51
s_add_u32 s40, s53, 5120
buffer_load_dwordx4 v18, s[60:63], s46 offen offset:2048 sc1 lds
v_cvt_pk_bf16_f32 v223, v223, v223
v_max_f32_e64 v36, v38, v39
v_cvt_pk_bf16_f32 v59, v54, v55
v_bfi_b32 v212, v40, 0, v222
v_max_f32_e64 v37, v38, v39
buffer_store_dwordx4 v[56:59], v18, s[20:23], s55 offen sc1
v_rcp_f32_e64 v200, v196
v_bfi_b32 v213, v41, 0, v223
buffer_load_dwordx4 v18, s[60:63], s46 offen offset:3072 sc1 lds
v_permlane16_swap_b32 v36, v37
s_waitcnt lgkmcnt(0)
v_readfirstlane_b32 s49, v239
s_nop 0
s_cmp_eq_u32 s49, 0
s_cbranch_scc1 L_h_sp_1029
L_h_ok_1030:
v_bfi_b32 v214, v42, 0, v222
v_max_f32_e64 v20, v36, v37
v_mfma_f32_16x16x32_bf16 v[48:51], v[80:83], v[116:119], v[224:227]
v_pk_mul_f32 v[184:185], v[184:185], v[200:201] op_sel:[0,0] op_sel_hi:[1,0]
v_bfi_b32 v215, v43, 0, v223
v_max_f32_e64 v37, v36, v37
s_add_u32 m0, s39, 16384
s_xor_b32 s46, s32, 0xe00000
buffer_load_dwordx4 v18, s[60:63], s46 offen offset:0 sc1 lds
v_pk_mul_f32 v[186:187], v[186:187], v[200:201] op_sel:[0,0] op_sel_hi:[1,0]
v_permlane32_swap_b32 v20, v37
v_mfma_f32_16x16x32_bf16 v[52:55], v[84:87], v[116:119], v[228:231]
v_pk_mul_f32 v[188:189], v[188:189], v[200:201] op_sel:[0,0] op_sel_hi:[1,0]
s_nop 1
v_mfma_f32_16x16x32_bf16 v[216:219], v[44:47], v[212:215], 0
v_max_f32_e64 v36, v20, v37
v_pk_mul_f32 v[190:191], v[190:191], v[200:201] op_sel:[0,0] op_sel_hi:[1,0]
v_pk_add_f32 v[38:39], v[38:39], v[36:37] op_sel_hi:[1,0] neg_lo:[0,1] neg_hi:[0,1]
buffer_load_dwordx4 v18, s[60:63], s46 offen offset:1024 sc1 lds
v_cvt_pk_bf16_f32 v192, v184, v185
v_mfma_f32_16x16x32_bf16 v[204:207], v[160:163], v[212:215], 0
v_pk_mul_f32 v[38:39], v[38:39], v[8:9] op_sel:[0,1] op_sel_hi:[1,1]
v_cvt_pk_bf16_f32 v194, v188, v189
v_exp_f32 v38, v38
v_max_f32 v66, v48, v49
v_cvt_pk_bf16_f32 v193, v186, v187
v_mfma_f32_16x16x32_bf16 v[208:211], v[178:181], v[212:215], 0
buffer_load_dwordx4 v18, s[60:63], s46 offen offset:2048 sc1 lds
v_exp_f32 v39, v39
v_max_f32 v67, v50, v51
v_cvt_pk_bf16_f32 v195, v190, v191
s_add_u32 s41, s53, 6144
v_cvt_pk_bf16_f32 v38, v38, v38
v_max3_f32 v66, v66, v52, v53
buffer_store_dwordx4 v[192:195], v18, s[20:23], s40 offen sc1
v_cvt_pk_bf16_f32 v39, v39, v39
buffer_load_dwordx4 v18, s[60:63], s46 offen offset:3072 sc1 lds
v_max3_f32 v67, v67, v54, v55
v_rcp_f32_e64 v220, v216
v_bfi_b32 v28, v40, 0, v38
v_max_f32_e64 v64, v66, v67
v_bfi_b32 v29, v41, 0, v39
v_max_f32_e64 v65, v66, v67
v_pk_mul_f32 v[204:205], v[204:205], v[220:221] op_sel:[0,0] op_sel_hi:[1,0]
v_bfi_b32 v30, v42, 0, v38
v_permlane16_swap_b32 v64, v65
v_pk_mul_f32 v[206:207], v[206:207], v[220:221] op_sel:[0,0] op_sel_hi:[1,0]
v_bfi_b32 v31, v43, 0, v39
v_max_f32 v48, v64, v65
v_pk_mul_f32 v[208:209], v[208:209], v[220:221] op_sel:[0,0] op_sel_hi:[1,0]
v_max_f32_e64 v65, v64, v65
v_pk_mul_f32 v[210:211], v[210:211], v[220:221] op_sel:[0,0] op_sel_hi:[1,0]
s_nop 1
v_mfma_f32_16x16x32_bf16 v[32:35], v[44:47], v[28:31], 0
v_permlane32_swap_b32 v48, v65
v_cvt_pk_bf16_f32 v212, v204, v205
v_max_f32_e64 v64, v48, v65
v_cvt_pk_bf16_f32 v214, v208, v209
v_mfma_f32_16x16x32_bf16 v[20:23], v[162:165], v[28:31], 0
v_pk_add_f32 v[66:67], v[66:67], v[64:65] op_sel_hi:[1,0] neg_lo:[0,1] neg_hi:[0,1]
v_cvt_pk_bf16_f32 v213, v206, v207
v_pk_mul_f32 v[66:67], v[66:67], v[2:3] op_sel:[0,0] op_sel_hi:[1,0]
v_cvt_pk_bf16_f32 v215, v210, v211
v_mfma_f32_16x16x32_bf16 v[24:27], v[180:183], v[28:31], 0
v_exp_f32_e64 v66, v66
buffer_store_dwordx4 v[212:215], v18, s[20:23], s41 offen sc1
s_add_u32 s42, s53, 7168
v_exp_f32_e64 v67, v67
v_cvt_pk_bf16_f32 v66, v66, v66
v_rcp_f32_e64 v36, v32
v_cvt_pk_bf16_f32 v67, v67, v67
v_bfi_b32 v56, v40, 0, v66
v_pk_mul_f32 v[20:21], v[20:21], v[36:37] op_sel:[0,0] op_sel_hi:[1,0]
v_bfi_b32 v57, v41, 0, v67
v_pk_mul_f32 v[22:23], v[22:23], v[36:37] op_sel:[0,0] op_sel_hi:[1,0]
v_bfi_b32 v58, v42, 0, v66
v_pk_mul_f32 v[24:25], v[24:25], v[36:37] op_sel:[0,0] op_sel_hi:[1,0]
v_bfi_b32 v59, v43, 0, v67
v_pk_mul_f32 v[26:27], v[26:27], v[36:37] op_sel:[0,0] op_sel_hi:[1,0]
v_cvt_pk_bf16_f32 v28, v20, v21
v_mfma_f32_16x16x32_bf16 v[60:63], v[44:47], v[56:59], 0
v_cvt_pk_bf16_f32 v30, v24, v25
v_cvt_pk_bf16_f32 v29, v22, v23
v_mfma_f32_16x16x32_bf16 v[48:51], v[148:151], v[56:59], 0
v_cvt_pk_bf16_f32 v31, v26, v27
buffer_store_dwordx4 v[28:31], v18, s[20:23], s42 offen sc1
v_mfma_f32_16x16x32_bf16 v[52:55], v[166:169], v[56:59], 0
s_add_u32 s55, s53, 0
s_nop 0
v_rcp_f32 v64, v60
s_nop 1
v_pk_mul_f32 v[48:49], v[48:49], v[64:65] op_sel:[0,0] op_sel_hi:[1,0]
v_pk_mul_f32 v[50:51], v[50:51], v[64:65] op_sel:[0,0] op_sel_hi:[1,0]
s_nop 0
s_nop 0
v_pk_mul_f32 v[52:53], v[52:53], v[64:65] op_sel:[0,0] op_sel_hi:[1,0]
v_pk_mul_f32 v[54:55], v[54:55], v[64:65] op_sel:[0,0] op_sel_hi:[1,0]
v_cvt_pk_bf16_f32 v56, v48, v49
v_cvt_pk_bf16_f32 v58, v52, v53
v_cvt_pk_bf16_f32 v57, v50, v51
v_cvt_pk_bf16_f32 v59, v54, v55
buffer_store_dwordx4 v[56:59], v18, s[20:23], s55 offen sc1
s_branch L_g1_fin_1002
s_nop 7
s_nop 7
L_g1_cs_1028:
s_cmp_lt_u32 s49, 32
s_cbranch_scc1 L_g1_spin_1027
s_nop 0
buffer_load_dwordx4 v[40:43], v9, s[24:27], s53 offen offset:0 sc1
buffer_load_dwordx4 v[44:47], v9, s[24:27], s53 offen offset:16 sc1
buffer_load_dwordx4 v[48:51], v9, s[24:27], s53 offen offset:32 sc1
s_waitcnt vmcnt(0)
s_nop 0
v_min3_u32 v74, v40, v41, v42
v_min3_u32 v75, v43, v44, v45
v_min3_u32 v74, v74, v46, v47
v_min3_u32 v75, v75, v48, v49
v_min3_u32 v74, v74, v50, v51
v_min_u32_e64 v74, v74, v75
v_cmp_eq_u32 vcc, 0, v74
s_nop 0
s_and_b32 s40, vcc_lo, 0xffff
s_cbranch_scc1 L_g1_cs_1028
s_branch L_g1_ok_1026
L_g1_spin_1027:
s_sleep 4
v_min_u32 v76, 7, v0
v_lshlrev_b32_e64 v76, 2, v76
buffer_load_dword v74, v76, s[28:31], 0 offen sc1
s_waitcnt vmcnt(0)
v_cmp_gt_u32 vcc, 32, v74
s_nop 0
s_cmp_eq_u64 vcc, 0
s_cselect_b32 s49, 32, 0
s_nop 1
s_cmp_lt_u32 s49, 32
s_cbranch_scc1 L_g1_spin_1027
v_and_b32 v76, 15, v0
v_lshlrev_b32 v76, 3, v76
s_add_u32 s52, s44, 128
s_lshl_b32 s52, s52, 3
s_nop 0
buffer_load_dwordx2 v[22:23], v76, s[24:27], s52 offen offset:0 sc1
buffer_load_dwordx2 v[24:25], v76, s[24:27], s52 offen offset:128 sc1
buffer_load_dwordx2 v[26:27], v76, s[24:27], s52 offen offset:256 sc1
buffer_load_dwordx2 v[28:29], v76, s[24:27], s52 offen offset:384 sc1
buffer_load_dwordx2 v[30:31], v76, s[24:27], s52 offen offset:512 sc1
buffer_load_dwordx2 v[32:33], v76, s[24:27], s52 offen offset:640 sc1
buffer_load_dwordx2 v[34:35], v76, s[24:27], s52 offen offset:768 sc1
buffer_load_dwordx2 v[36:37], v76, s[24:27], s52 offen offset:896 sc1
s_bfe_u32 s53, s2, 0x20003
s_lshl2_add_u32 s53, s3, s53
s_lshl1_add_u32 s53, s53, s58
s_mul_i32 s53, s53, 768
s_add_u32 s53, s53, 16384
buffer_load_dwordx4 v[40:43], v9, s[24:27], s53 offen offset:0 sc1
buffer_load_dwordx4 v[44:47], v9, s[24:27], s53 offen offset:16 sc1
buffer_load_dwordx4 v[48:51], v9, s[24:27], s53 offen offset:32 sc1
s_waitcnt vmcnt(0)
s_nop 0
v_min3_u32 v74, v40, v41, v42
v_min3_u32 v75, v43, v44, v45
v_min3_u32 v74, v74, v46, v47
v_min3_u32 v75, v75, v48, v49
v_min3_u32 v74, v74, v50, v51
v_min_u32_e64 v74, v74, v75
v_cmp_eq_u32 vcc, 0, v74
s_nop 0
s_and_b32 s40, vcc_lo, 0xffff
s_cbranch_scc1 L_g1_spin_1027
s_branch L_g1_ok_1026
L_h_sp_1029:
s_sleep 2
s_nop 0
ds_read_b32 v239, v238
ds_read_b128 v[80:83], v236
ds_read_b64 v[148:149], v237 offset:0
ds_read_b64 v[166:167], v237 offset:512
s_waitcnt lgkmcnt(0)
v_readfirstlane_b32 s49, v239
s_nop 0
s_cmp_eq_u32 s49, 0
s_cbranch_scc1 L_h_sp_1029
s_branch L_h_ok_1030
L_g1_w_1007:
s_lshl4_add_u32 s36, s76, s36
s_bfe_u32 s40, s2, 0x20003
s_lshl2_add_u32 s54, s3, s40
s_lshl3_add_u32 s41, s54, s44
s_lshl1_add_u32 s41, s43, s41
s_lshl_b32 s42, s41, 11
s_lshl_b32 s41, s41, 3
s_mul_i32 s37, s54, 1536
s_mul_i32 s40, s58, 768
s_add_u32 s37, s37, s40
s_lshl2_add_u32 s37, s59, s37
s_add_u32 s37, s37, 16384
s_lshr_b32 s40, s2, 3
v_min_u32 v74, 27, v0
v_mul_u32_u24 v75, 9363, v74
v_lshrrev_b32 v75, 16, v75
v_mul_u32_u24 v76, 7, v75
v_sub_u32_e64 v76, v74, v76
v_lshl_add_u32 v75, v75, 5, s40
v_mul_u32_u24 v75, 7168, v75
v_lshl_add_u32 v18, v76, 7, v75
s_cmp_eq_u32 s58, 0
s_cselect_b32 s32, s64, s66
s_cselect_b32 s33, s65, s67
s_cselect_b32 s77, 1, -1
s_mov_b32 s34, 0x700000
s_mul_i32 s47, s3, 918400
s_mov_b32 s35, 0x00020000
s_add_u32 s47, s47, 1835008
s_add_u32 s20, s68, 0x400000
s_addc_u32 s21, s69, 0
s_mov_b32 s22, 0x1300000
s_mov_b32 s23, 0x00020000
s_mov_b32 s24, s68
s_mov_b32 s25, s69
s_mov_b32 s26, 0x20000
s_mov_b32 s27, 0x00020000
s_mov_b32 s28, s70
s_mov_b32 s29, s71
s_mov_b32 s30, 0x100
s_mov_b32 s31, 0x00020000
s_getpc_b64 s[70:71]
L_g1_tp_1031:
s_add_u32 s70, s70, L_pf_tab-L_g1_tp_1031
s_addc_u32 s71, s71, 0
s_and_b32 s55, s2, 1
s_lshl_b32 s55, s55, 5
s_add_u32 s55, s55, s40
s_lshl_b32 s55, s55, 2
s_load_dword s70, s[70:71], s55
v_and_b32 v74, 15, v0
v_lshrrev_b32 v75, 4, v0
v_lshrrev_b32 v76, 1, v74
v_xor_b32 v76, v76, v75
v_lshlrev_b32 v76, 4, v76
v_lshl_add_u32 v77, v74, 7, v76
v_add_u32 v6, 0, v77
v_xor_b32 v7, 64, v6
v_mov_b32 v78, 0x3f803f80
v_cmp_eq_u32 vcc, 0, v74
s_nop 1
v_cndmask_b32 v76, 0, v78, vcc
s_nop 0
v_accvgpr_write_b32 a152, v76
v_accvgpr_write_b32 a153, v76
v_accvgpr_write_b32 a154, v76
v_accvgpr_write_b32 a155, v76
v_cmp_eq_u32 vcc, 1, v74
s_nop 1
v_cndmask_b32 v76, 0, v78, vcc
s_nop 0
v_accvgpr_write_b32 a156, v76
v_accvgpr_write_b32 a157, v76
v_accvgpr_write_b32 a158, v76
v_accvgpr_write_b32 a159, v76
v_lshrrev_b32 v76, 2, v74
v_lshlrev_b32 v76, 6, v76
v_and_b32_e64 v77, 3, v0
v_lshl_add_u32 v76, v77, 3, v76
v_and_b32_e64 v77, 1, v75
v_lshl_add_u32 v76, v77, 5, v76
s_lshl_b32 s40, s58, 13
s_add_u32 s40, s40, 65536
v_lshl_add_u32 v77, v75, 10, v76
v_add_u32 v10, s40, v77
v_xor_b32_e64 v11, 32, v10
v_add_u32 v12, 40960, v10
v_add_u32 v13, 40960, v11
v_lshl_add_u32 v77, v75, 9, v76
s_lshl_b32 s40, s58, 5
v_xor_b32 v77, s40, v77
v_add_u32 v14, 81920, v77
s_and_b32 s40, s59, 1
s_mul_i32 s40, s40, 24576
s_lshr_b32 s55, s59, 2
s_lshl_b32 s55, s55, 9
s_add_u32 s40, s40, s55
s_and_b32 s55, s59, 2
s_lshl_b32 s55, s55, 4
v_xor_b32 v8, s55, v10
v_add_u32 v8, s40, v8
v_mul_u32_u24 v9, 48, v0
v_bfrev_b32 v76, 2
v_cmp_gt_u32 vcc, 16, v0
s_nop 1
v_cndmask_b32 v9, v76, v9, vcc
v_mov_b32 v74, 0
v_mov_b32 v75, 0
v_mov_b32 v76, 0
v_mov_b32_e64 v77, 0
buffer_store_dword v74, v9, s[24:27], s37 offen sc1
s_add_u32 s60, s68, 0x4000000
s_addc_u32 s61, s69, 0
s_nop 0
s_mov_b32 s62, 0x14000
s_mov_b32 s63, 0x00020000
s_mul_i32 s40, s2, 320
s_mov_b64 exec, 0xfffff
buffer_store_dwordx4 v[74:77], v79, s[60:63], s40 offen sc1
s_mov_b64 exec, -1
s_mov_b32 s54, 0xffff0000
s_mov_b32 s60, s72
s_mov_b32 s61, s73
s_nop 0
s_mov_b32 s62, 0x200000
s_mov_b32 s63, 0x00020000
s_add_u32 s64, s68, 0x1800000
s_addc_u32 s65, s69, 0
s_mov_b32 s66, 0x900000
s_mov_b32 s67, 0x00020000
s_lshr_b32 s40, s2, 4
s_lshl_b32 s40, s40, 16
s_and_b32 s69, s2, 15
s_lshl_b32 s68, s69, 7
s_lshl_b32 s69, s69, 12
s_add_u32 s69, s69, s40
s_bfe_u32 s55, s2, 0x30004
s_lshl_b32 s69, s55, 16
s_bfe_u32 s40, s2, 0x30001
s_lshl_b32 s40, s40, 13
s_add_u32 s69, s69, s40
s_and_b32 s66, s69, 0xfff80000
s_add_u32 s66, s66, 0x900000
s_and_b32 s40, s2, 1
s_lshl_b32 s40, s40, 12
s_add_u32 s69, s69, s40
s_lshr_b32 s40, s2, 7
s_lshl_b32 s72, s40, 19
s_add_u32 s69, s69, s72
s_lshl2_add_u32 s40, s55, s40
s_lshl_b32 s40, s40, 16
s_mul_i32 s72, s55, 655360
s_mul_i32 s73, s55, 917504
s_add_u32 s68, s68, s40
s_lshl_b32 s40, s58, 14
s_add_u32 s68, s68, s40
s_lshl_b32 s40, s43, 8
s_add_u32 s69, s69, s40
v_lshrrev_b32 v46, 3, v0
v_lshrrev_b32_e64 v47, 5, v0
v_mad_u32_u24 v46, v47, 12, v46
v_and_b32 v47, 7, v0
v_lshlrev_b32 v47, 4, v47
v_lshl_add_u32 v4, v46, 11, v47
v_bfe_u32 v46, v0, 2, 2
v_lshlrev_b32 v46, 7, v46
v_lshrrev_b32 v47, 4, v0
v_lshl_add_u32 v46, v47, 5, v46
v_and_b32_e64 v47, 3, v0
v_lshl_add_u32 v46, v47, 3, v46
s_add_u32 s40, s76, 147456
v_add_u32_e64 v78, s40, v46
s_lshl_b32 s51, s59, 2
s_and_b32 s78, s59, 3
s_cmp_le_u32 s78, 0
s_cselect_b32 s78, 1, 0
s_mul_i32 s53, s78, 229376
s_add_u32 s53, s53, s38
s_mul_i32 s52, s78, 229376
s_add_u32 s52, s52, s39
s_lshr_b32 s46, s78, 1
s_mul_i32 s46, s46, 32768
s_lshl_b32 s78, s78, 12
s_add_u32 s46, s46, s78
s_add_u32 s46, s46, s76
s_add_u32 m0, s46, 65536
s_nop 0
buffer_load_dwordx4 v2, s[8:11], s53 offen nt lds
s_add_u32 m0, s46, 73600
s_nop 0
buffer_load_dwordx4 v2, s[8:11], s53 offen offset:128 nt lds
s_add_u32 m0, s46, 81920
s_nop 0
buffer_load_dwordx4 v3, s[16:19], s52 offen nt lds
s_and_b32 s78, s59, 3
s_cmp_le_u32 s78, 1
s_cselect_b32 s78, 2, 1
s_mul_i32 s48, s78, 229376
s_add_u32 s48, s48, s38
s_mul_i32 s57, s78, 229376
s_add_u32 s57, s57, s39
s_lshr_b32 s49, s78, 1
s_mul_i32 s49, s49, 32768
s_lshl_b32 s78, s78, 12
s_add_u32 s49, s49, s78
s_add_u32 s49, s49, s76
s_add_u32 m0, s49, 65536
s_nop 0
buffer_load_dwordx4 v2, s[8:11], s48 offen nt lds
s_add_u32 m0, s49, 73600
s_nop 0
buffer_load_dwordx4 v2, s[8:11], s48 offen offset:128 nt lds
s_add_u32 m0, s49, 81920
s_nop 0
buffer_load_dwordx4 v3, s[16:19], s57 offen nt lds
s_bfe_u32 s55, s2, 0x20003
s_lshl_b32 s55, s55, 13
s_add_u32 s55, s55, 8192
s_and_b32 s55, s55, 32767
s_lshl4_add_u32 s79, s55, s36
s_add_u32 m0, s55, s76
s_nop 0
s_nop 0
buffer_load_dwordx4 v1, s[4:7], s79 offen offset:0 lds
s_add_u32 s55, s55, 4096
s_and_b32 s55, s55, 32767
s_lshl4_add_u32 s79, s55, s36
s_add_u32 m0, s55, s76
s_nop 0
s_nop 0
buffer_load_dwordx4 v1, s[4:7], s79 offen offset:0 lds
s_add_u32 s55, s55, 4096
s_and_b32 s55, s55, 32767
s_lshl4_add_u32 s79, s55, s36
s_add_u32 m0, s55, s76
s_nop 0
s_nop 0
buffer_load_dwordx4 v1, s[4:7], s79 offen offset:0 lds
s_add_u32 s55, s55, 4096
s_and_b32 s55, s55, 32767
s_lshl4_add_u32 s79, s55, s36
s_add_u32 m0, s55, s76
s_nop 0
s_nop 0
buffer_load_dwordx4 v1, s[4:7], s79 offen offset:0 lds
s_add_u32 s55, s55, 4096
s_and_b32 s55, s55, 32767
s_lshl4_add_u32 s79, s55, s36
s_add_u32 m0, s55, s76
s_nop 0
s_nop 0
buffer_load_dwordx4 v1, s[4:7], s79 offen offset:0 lds
s_add_u32 s55, s55, 4096
s_and_b32 s55, s55, 32767
s_lshl4_add_u32 s79, s55, s36
s_add_u32 m0, s55, s76
s_nop 0
buffer_load_dwordx4 v1, s[4:7], s79 offen offset:0 lds
s_add_u32 m0, s46, 90112
s_nop 0
buffer_load_dwordx4 v2, s[12:15], s53 offen nt lds
s_add_u32 m0, s46, 98176
s_nop 0
buffer_load_dwordx4 v2, s[12:15], s53 offen offset:128 nt lds
s_add_u32 m0, s49, 90112
s_nop 0
buffer_load_dwordx4 v2, s[12:15], s48 offen nt lds
s_add_u32 m0, s49, 98176
s_nop 0
buffer_load_dwordx4 v2, s[12:15], s48 offen offset:128 nt lds
s_waitcnt vmcnt(4)
s_waitcnt lgkmcnt(0)
s_barrier
ds_read_b64_tr_b16 a[224:225], v10 offset:0
ds_read_b64_tr_b16 a[226:227], v10 offset:256
ds_read_b64_tr_b16 a[228:229], v10 offset:4096
ds_read_b64_tr_b16 a[230:231], v10 offset:4352
ds_read_b128 a[160:163], v6 offset:0
ds_read_b128 a[164:167], v7 offset:0
ds_read_b128 a[172:175], v7 offset:2048
ds_read_b128 a[168:171], v6 offset:2048
ds_read_b128 a[176:179], v6 offset:4096
ds_read_b128 a[180:183], v7 offset:4096
ds_read_b128 a[188:191], v7 offset:6144
ds_read_b128 a[184:187], v6 offset:6144
ds_read_b128 a[192:195], v6 offset:8192
ds_read_b128 a[196:199], v7 offset:8192
ds_read_b128 a[204:207], v7 offset:10240
ds_read_b128 a[200:203], v6 offset:10240
ds_read_b128 a[208:211], v6 offset:12288
ds_read_b128 a[212:215], v7 offset:12288
ds_read_b128 a[220:223], v7 offset:14336
ds_read_b128 a[216:219], v6 offset:14336
s_waitcnt lgkmcnt(15)
v_mfma_f32_16x16x32_bf16 v[80:83], a[224:227], a[160:163], 0
s_waitcnt lgkmcnt(14)
s_bfe_u32 s55, s2, 0x20003
ds_read_b64_tr_b16 a[232:233], v11 offset:0
v_mfma_f32_16x16x32_bf16 v[80:83], a[228:231], a[164:167], v[80:83]
s_waitcnt lgkmcnt(14)
s_lshl_b32 s55, s55, 13
ds_read_b64_tr_b16 a[234:235], v11 offset:256
v_mfma_f32_16x16x32_bf16 v[96:99], a[228:231], a[172:175], 0
s_waitcnt lgkmcnt(14)
s_add_u32 s55, s55, 8192
ds_read_b64_tr_b16 a[236:237], v11 offset:4096
v_mfma_f32_16x16x32_bf16 v[96:99], a[224:227], a[168:171], v[96:99]
s_waitcnt lgkmcnt(14)
s_and_b32 s55, s55, 32767
ds_read_b64_tr_b16 a[238:239], v11 offset:4352
v_mfma_f32_16x16x32_bf16 v[240:243], a[224:227], a[176:179], 0
s_waitcnt lgkmcnt(14)
s_lshl4_add_u32 s79, s55, s36
s_add_u32 m0, s55, s76
v_mfma_f32_16x16x32_bf16 v[240:243], a[228:231], a[180:183], v[240:243]
s_waitcnt lgkmcnt(13)
s_add_u32 m0, m0, 32640
v_mfma_f32_16x16x32_bf16 v[112:115], a[228:231], a[188:191], 0
s_waitcnt lgkmcnt(12)
buffer_load_dwordx4 v1, s[4:7], s79 offen offset:128 lds
v_mfma_f32_16x16x32_bf16 v[112:115], a[224:227], a[184:187], v[112:115]
s_waitcnt lgkmcnt(11)
s_add_u32 s55, s55, 4096
s_and_b32 s55, s55, 32767
v_mfma_f32_16x16x32_bf16 v[128:131], a[224:227], a[192:195], 0
s_waitcnt lgkmcnt(10)
s_lshl4_add_u32 s79, s55, s36
s_add_u32 m0, s55, s76
v_mfma_f32_16x16x32_bf16 v[128:131], a[228:231], a[196:199], v[128:131]
s_waitcnt lgkmcnt(9)
s_add_u32 m0, m0, 32640
v_mfma_f32_16x16x32_bf16 a[0:3], a[228:231], a[204:207], 0
s_waitcnt lgkmcnt(8)
buffer_load_dwordx4 v1, s[4:7], s79 offen offset:128 lds
v_mfma_f32_16x16x32_bf16 a[0:3], a[224:227], a[200:203], a[0:3]
s_waitcnt lgkmcnt(7)
s_add_u32 s55, s55, 4096
s_and_b32 s55, s55, 32767
v_mfma_f32_16x16x32_bf16 a[16:19], a[224:227], a[208:211], 0
s_waitcnt lgkmcnt(6)
s_lshl4_add_u32 s79, s55, s36
s_add_u32 m0, s55, s76
v_mfma_f32_16x16x32_bf16 a[16:19], a[228:231], a[212:215], a[16:19]
s_waitcnt lgkmcnt(5)
s_add_u32 m0, m0, 32640
v_mfma_f32_16x16x32_bf16 a[32:35], a[228:231], a[220:223], 0
s_waitcnt lgkmcnt(4)
buffer_load_dwordx4 v1, s[4:7], s79 offen offset:128 lds
v_mfma_f32_16x16x32_bf16 a[32:35], a[224:227], a[216:219], a[32:35]
s_waitcnt vmcnt(3) lgkmcnt(0)
s_barrier
v_mfma_f32_16x16x32_bf16 a[40:43], a[232:235], a[216:219], 0
s_add_u32 s55, s55, 4096
s_and_b32 s55, s55, 32767
ds_read_b64_tr_b16 a[224:225], v10 offset:512
v_mfma_f32_16x16x32_bf16 a[40:43], a[236:239], a[220:223], a[40:43]
s_lshl4_add_u32 s79, s55, s36
s_add_u32 m0, s55, s76
ds_read_b64_tr_b16 a[226:227], v10 offset:768
v_mfma_f32_16x16x32_bf16 a[24:27], a[236:239], a[212:215], 0
s_add_u32 m0, m0, 32640
ds_read_b64_tr_b16 a[228:229], v10 offset:4608
v_mfma_f32_16x16x32_bf16 a[24:27], a[232:235], a[208:211], a[24:27]
buffer_load_dwordx4 v1, s[4:7], s79 offen offset:128 lds
v_mfma_f32_16x16x32_bf16 a[8:11], a[232:235], a[200:203], 0
s_add_u32 s55, s55, 4096
s_and_b32 s55, s55, 32767
ds_read_b64_tr_b16 a[230:231], v10 offset:4864
v_mfma_f32_16x16x32_bf16 a[8:11], a[236:239], a[204:207], a[8:11]
s_lshl4_add_u32 s79, s55, s36
s_add_u32 m0, s55, s76
s_add_u32 m0, m0, 32640
v_mfma_f32_16x16x32_bf16 v[136:139], a[236:239], a[196:199], 0
buffer_load_dwordx4 v1, s[4:7], s79 offen offset:128 lds
v_mfma_f32_16x16x32_bf16 v[136:139], a[232:235], a[192:195], v[136:139]
s_add_u32 s55, s55, 4096
s_and_b32 s55, s55, 32767
ds_read_b64_tr_b16 a[148:149], v8 offset:0
v_mfma_f32_16x16x32_bf16 v[120:123], a[232:235], a[184:187], 0
s_lshl4_add_u32 s79, s55, s36
s_add_u32 m0, s55, s76
ds_read_b64_tr_b16 a[150:151], v8 offset:256
v_mfma_f32_16x16x32_bf16 v[120:123], a[236:239], a[188:191], v[120:123]
s_add_u32 m0, m0, 32640
v_mfma_f32_16x16x32_bf16 v[248:251], a[236:239], a[180:183], 0
buffer_load_dwordx4 v1, s[4:7], s79 offen offset:128 lds
v_mfma_f32_16x16x32_bf16 v[248:251], a[232:235], a[176:179], v[248:251]
s_and_b32 s78, s59, 3
s_cmp_le_u32 s78, 2
s_cselect_b32 s78, 3, 2
v_mfma_f32_16x16x32_bf16 v[104:107], a[232:235], a[168:171], 0
s_mul_i32 s53, s78, 229376
s_add_u32 s53, s53, s38
s_mul_i32 s52, s78, 229376
v_mfma_f32_16x16x32_bf16 v[104:107], a[236:239], a[172:175], v[104:107]
s_add_u32 s52, s52, s39
s_lshr_b32 s46, s78, 1
s_mul_i32 s46, s46, 32768
v_mfma_f32_16x16x32_bf16 v[88:91], a[236:239], a[164:167], 0
s_lshl_b32 s78, s78, 12
s_add_u32 s46, s46, s78
s_add_u32 s46, s46, s76
v_mfma_f32_16x16x32_bf16 v[88:91], a[232:235], a[160:163], v[88:91]
s_waitcnt lgkmcnt(4)
s_add_u32 m0, s46, 65536
v_mfma_f32_16x16x32_bf16 a[48:51], a[224:227], a[160:163], 0
s_waitcnt lgkmcnt(2)
buffer_load_dwordx4 v2, s[8:11], s53 offen nt lds
v_mfma_f32_16x16x32_bf16 a[48:51], a[228:231], a[164:167], a[48:51]
s_add_u32 m0, s46, 73600
ds_read_b64_tr_b16 a[232:233], v11 offset:512
v_mfma_f32_16x16x32_bf16 a[64:67], a[228:231], a[172:175], 0
buffer_load_dwordx4 v2, s[8:11], s53 offen offset:128 nt lds
v_mfma_f32_16x16x32_bf16 a[64:67], a[224:227], a[168:171], a[64:67]
s_add_u32 m0, s46, 81920
ds_read_b64_tr_b16 a[234:235], v11 offset:768
v_mfma_f32_16x16x32_bf16 a[80:83], a[224:227], a[176:179], 0
buffer_load_dwordx4 v3, s[16:19], s52 offen nt lds
v_mfma_f32_16x16x32_bf16 a[80:83], a[228:231], a[180:183], a[80:83]
s_add_u32 m0, s46, 90112
ds_read_b64_tr_b16 a[236:237], v11 offset:4608
v_mfma_f32_16x16x32_bf16 a[96:99], a[228:231], a[188:191], 0
buffer_load_dwordx4 v2, s[12:15], s53 offen nt lds
v_mfma_f32_16x16x32_bf16 a[96:99], a[224:227], a[184:187], a[96:99]
s_waitcnt lgkmcnt(3)
s_add_u32 m0, s46, 98176
ds_read_b64_tr_b16 a[238:239], v11 offset:4864
v_mfma_f32_16x16x32_bf16 a[144:147], a[152:155], a[148:151], 0
buffer_load_dwordx4 v2, s[12:15], s53 offen offset:128 nt lds
v_mfma_f32_16x16x32_bf16 a[112:115], a[224:227], a[192:195], 0
s_sub_u32 s56, s56, 1
s_cmp_eq_u32 s56, 0
s_cselect_b32 s78, -7, 1
v_mfma_f32_16x16x32_bf16 a[112:115], a[228:231], a[196:199], a[112:115]
s_mul_i32 s55, s78, 917504
s_add_u32 s38, s38, s55
ds_read_b64_tr_b16 a[148:149], v8 offset:4096
v_mfma_f32_16x16x32_bf16 a[128:131], a[228:231], a[204:207], 0
s_mul_i32 s55, s78, 917504
s_add_u32 s39, s39, s55
ds_read_b64_tr_b16 a[150:151], v8 offset:4352
v_mfma_f32_16x16x32_bf16 a[128:131], a[224:227], a[200:203], a[128:131]
s_lshl_b32 s55, s78, 8
s_add_u32 s36, s36, s55
v_and_b32_e64 v44, 7, v0
v_mfma_f32_16x16x32_bf16 v[144:147], a[224:227], a[208:211], 0
s_cmp_ge_u32 s47, 7340032
s_cselect_b32 s78, 7340032, 0
s_sub_u32 s47, s47, s78
v_mfma_f32_16x16x32_bf16 v[144:147], a[228:231], a[212:215], v[144:147]
buffer_load_dword v19, v18, s[32:35], s47 offen
v_mfma_f32_16x16x32_bf16 v[160:163], a[228:231], a[220:223], 0
s_add_u32 s47, s47, 917504
s_add_u32 m0, s76, 155648
v_lshrrev_b32 v45, 4, v0
v_mfma_f32_16x16x32_bf16 v[160:163], a[224:227], a[216:219], v[160:163]
s_waitcnt lgkmcnt(4)
buffer_load_dwordx4 v4, s[60:63], s68 offen nt lds
v_mfma_f32_16x16x32_bf16 v[168:171], a[232:235], a[216:219], 0
s_waitcnt lgkmcnt(2)
s_add_u32 s68, s68, 0x20000
ds_read_b64_tr_b16 a[224:225], v14 offset:0
v_mfma_f32_16x16x32_bf16 v[168:171], a[236:239], a[220:223], v[168:171]
ds_read_b64_tr_b16 a[226:227], v14 offset:256
v_lshl_add_u32 v44, v45, 3, v44
v_mfma_f32_16x16x32_bf16 v[152:155], a[236:239], a[212:215], 0
ds_read_b64_tr_b16 a[228:229], v14 offset:4096
v_mfma_f32_16x16x32_bf16 v[152:155], a[232:235], a[208:211], v[152:155]
ds_read_b64_tr_b16 a[230:231], v14 offset:4352
v_mfma_f32_16x16x32_bf16 a[136:139], a[232:235], a[200:203], 0
v_mfma_f32_16x16x32_bf16 a[136:139], a[236:239], a[204:207], a[136:139]
v_mfma_f32_16x16x32_bf16 a[120:123], a[236:239], a[196:199], 0
v_lshlrev_b32_e64 v44, 4, v44
v_mfma_f32_16x16x32_bf16 a[120:123], a[232:235], a[192:195], a[120:123]
s_waitcnt lgkmcnt(4)
v_mfma_f32_16x16x32_bf16 a[144:147], a[152:155], a[148:151], a[144:147]
v_mfma_f32_16x16x32_bf16 a[104:107], a[232:235], a[184:187], 0
v_mfma_f32_16x16x32_bf16 a[104:107], a[236:239], a[188:191], a[104:107]
v_mfma_f32_16x16x32_bf16 a[88:91], a[236:239], a[180:183], 0
v_bfe_u32 v45, v0, 3, 1
v_mfma_f32_16x16x32_bf16 a[88:91], a[232:235], a[176:179], a[88:91]
v_mfma_f32_16x16x32_bf16 a[72:75], a[232:235], a[168:171], 0
v_mfma_f32_16x16x32_bf16 a[72:75], a[236:239], a[172:175], a[72:75]
v_mfma_f32_16x16x32_bf16 a[56:59], a[236:239], a[164:167], 0
v_mfma_f32_16x16x32_bf16 a[56:59], a[232:235], a[160:163], a[56:59]
s_waitcnt lgkmcnt(2)
v_lshl_add_u32 v44, v45, 11, v44
v_mfma_f32_16x16x32_bf16 v[176:179], a[224:227], a[160:163], 0
s_waitcnt lgkmcnt(0)
ds_read_b64_tr_b16 a[232:233], v14 offset:2048
v_mfma_f32_16x16x32_bf16 v[176:179], a[228:231], a[164:167], v[176:179]
ds_read_b64_tr_b16 a[234:235], v14 offset:2304
v_mfma_f32_16x16x32_bf16 v[184:187], a[228:231], a[172:175], 0
ds_read_b64_tr_b16 a[236:237], v14 offset:6144
v_mfma_f32_16x16x32_bf16 v[184:187], a[224:227], a[168:171], v[184:187]
ds_read_b64_tr_b16 a[238:239], v14 offset:6400
v_mfma_f32_16x16x32_bf16 v[192:195], a[224:227], a[176:179], 0
buffer_load_dwordx4 v[20:23], v44, s[4:7], s42 offen offset:0
v_mfma_f32_16x16x32_bf16 v[192:195], a[228:231], a[180:183], v[192:195]
v_mfma_f32_16x16x32_bf16 v[200:203], a[228:231], a[188:191], 0
buffer_load_dwordx4 v[24:27], v44, s[4:7], s42 offen offset:512
v_mfma_f32_16x16x32_bf16 v[200:203], a[224:227], a[184:187], v[200:203]
v_mfma_f32_16x16x32_bf16 v[208:211], a[224:227], a[192:195], 0
v_mfma_f32_16x16x32_bf16 v[208:211], a[228:231], a[196:199], v[208:211]
buffer_load_dwordx4 v[28:31], v44, s[4:7], s42 offen offset:1024
v_mfma_f32_16x16x32_bf16 v[216:219], a[228:231], a[204:207], 0
v_mfma_f32_16x16x32_bf16 v[216:219], a[224:227], a[200:203], v[216:219]
buffer_load_dwordx4 v[32:35], v44, s[4:7], s42 offen offset:1536
v_mfma_f32_16x16x32_bf16 v[224:227], a[224:227], a[208:211], 0
v_mfma_f32_16x16x32_bf16 v[224:227], a[228:231], a[212:215], v[224:227]
v_mfma_f32_16x16x32_bf16 v[232:235], a[228:231], a[220:223], 0
v_mfma_f32_16x16x32_bf16 v[232:235], a[224:227], a[216:219], v[232:235]
s_waitcnt vmcnt(11) lgkmcnt(0)
s_barrier
v_mfma_f32_16x16x32_bf16 v[236:239], a[232:235], a[216:219], 0
s_add_u32 m0, s76, 0
s_add_u32 s79, s36, 0
ds_read_b64_tr_b16 a[224:225], v10 offset:24576
v_mfma_f32_16x16x32_bf16 v[236:239], a[236:239], a[220:223], v[236:239]
buffer_load_dwordx4 v1, s[4:7], s79 offen lds
v_mfma_f32_16x16x32_bf16 v[228:231], a[236:239], a[212:215], 0
s_add_u32 m0, s76, 4096
s_add_u32 s79, s36, 65536
ds_read_b64_tr_b16 a[226:227], v10 offset:24832
v_mfma_f32_16x16x32_bf16 v[228:231], a[232:235], a[208:211], v[228:231]
ds_read_b64_tr_b16 a[228:229], v10 offset:28672
v_mfma_f32_16x16x32_bf16 v[220:223], a[232:235], a[200:203], 0
ds_read_b64_tr_b16 a[230:231], v10 offset:28928
v_mfma_f32_16x16x32_bf16 v[220:223], a[236:239], a[204:207], v[220:223]
ds_read_b128 v[58:61], v6 offset:32768
v_mfma_f32_16x16x32_bf16 v[212:215], a[236:239], a[196:199], 0
v_mfma_f32_16x16x32_bf16 v[212:215], a[232:235], a[192:195], v[212:215]
v_mfma_f32_16x16x32_bf16 v[204:207], a[232:235], a[184:187], 0
buffer_load_dwordx4 v1, s[4:7], s79 offen lds
v_mfma_f32_16x16x32_bf16 v[204:207], a[236:239], a[188:191], v[204:207]
s_add_u32 m0, s76, 8192
s_add_u32 s79, s36, 131072
v_mfma_f32_16x16x32_bf16 v[196:199], a[236:239], a[180:183], 0
v_mfma_f32_16x16x32_bf16 v[196:199], a[232:235], a[176:179], v[196:199]
ds_read_b128 v[62:65], v7 offset:32768
v_mfma_f32_16x16x32_bf16 v[188:191], a[232:235], a[168:171], 0
v_mfma_f32_16x16x32_bf16 v[188:191], a[236:239], a[172:175], v[188:191]
v_mfma_f32_16x16x32_bf16 v[180:183], a[236:239], a[164:167], 0
v_mfma_f32_16x16x32_bf16 v[180:183], a[232:235], a[160:163], v[180:183]
s_waitcnt lgkmcnt(4)
buffer_load_dwordx4 v1, s[4:7], s79 offen lds
v_mfma_f32_16x16x32_bf16 v[84:87], a[224:227], a[160:163], 0
s_waitcnt lgkmcnt(2)
s_add_u32 m0, s76, 12288
ds_read_b64_tr_b16 a[232:233], v11 offset:24576
v_mfma_f32_16x16x32_bf16 v[84:87], a[228:231], a[164:167], v[84:87]
s_add_u32 s79, s36, 196608
ds_read_b64_tr_b16 a[234:235], v11 offset:24832
v_mfma_f32_16x16x32_bf16 v[100:103], a[228:231], a[172:175], 0
ds_read_b64_tr_b16 a[236:237], v11 offset:28672
v_mfma_f32_16x16x32_bf16 v[100:103], a[224:227], a[168:171], v[100:103]
ds_read_b64_tr_b16 a[238:239], v11 offset:28928
v_mfma_f32_16x16x32_bf16 v[244:247], a[224:227], a[176:179], 0
ds_read_b128 v[70:73], v7 offset:34816
v_mfma_f32_16x16x32_bf16 v[244:247], a[228:231], a[180:183], v[244:247]
v_mfma_f32_16x16x32_bf16 v[116:119], a[228:231], a[188:191], 0
buffer_load_dwordx4 v1, s[4:7], s79 offen lds
v_mfma_f32_16x16x32_bf16 v[116:119], a[224:227], a[184:187], v[116:119]
s_add_u32 m0, s76, 16384
s_add_u32 s79, s36, 262144
v_mfma_f32_16x16x32_bf16 v[132:135], a[224:227], a[192:195], 0
v_mfma_f32_16x16x32_bf16 v[132:135], a[228:231], a[196:199], v[132:135]
ds_read_b128 v[66:69], v6 offset:34816
v_mfma_f32_16x16x32_bf16 a[4:7], a[228:231], a[204:207], 0
v_mfma_f32_16x16x32_bf16 a[4:7], a[224:227], a[200:203], a[4:7]
v_mfma_f32_16x16x32_bf16 a[20:23], a[224:227], a[208:211], 0
v_mfma_f32_16x16x32_bf16 a[20:23], a[228:231], a[212:215], a[20:23]
buffer_load_dwordx4 v1, s[4:7], s79 offen lds
v_mfma_f32_16x16x32_bf16 a[36:39], a[228:231], a[220:223], 0
s_add_u32 m0, s76, 20480
s_add_u32 s79, s36, 327680
v_mfma_f32_16x16x32_bf16 a[36:39], a[224:227], a[216:219], a[36:39]
s_waitcnt lgkmcnt(4)
v_mfma_f32_16x16x32_bf16 a[44:47], a[232:235], a[216:219], 0
s_waitcnt lgkmcnt(2)
ds_read_b64_tr_b16 a[224:225], v10 offset:25088
v_mfma_f32_16x16x32_bf16 a[44:47], a[236:239], a[220:223], a[44:47]
ds_read_b64_tr_b16 a[226:227], v10 offset:25344
v_mfma_f32_16x16x32_bf16 a[28:31], a[236:239], a[212:215], 0
ds_read_b64_tr_b16 a[228:229], v10 offset:29184
v_mfma_f32_16x16x32_bf16 a[28:31], a[232:235], a[208:211], a[28:31]
ds_read_b64_tr_b16 a[230:231], v10 offset:29440
v_mfma_f32_16x16x32_bf16 a[12:15], a[232:235], a[200:203], 0
buffer_load_dwordx4 v1, s[4:7], s79 offen lds
v_mfma_f32_16x16x32_bf16 a[12:15], a[236:239], a[204:207], a[12:15]
s_add_u32 m0, s76, 24576
s_add_u32 s79, s36, 393216
ds_read_b128 a[240:243], v6 offset:36864
v_mfma_f32_16x16x32_bf16 v[140:143], a[236:239], a[196:199], 0
v_mfma_f32_16x16x32_bf16 v[140:143], a[232:235], a[192:195], v[140:143]
ds_read_b128 a[244:247], v7 offset:36864
v_mfma_f32_16x16x32_bf16 v[124:127], a[232:235], a[184:187], 0
v_mfma_f32_16x16x32_bf16 v[124:127], a[236:239], a[188:191], v[124:127]
v_mfma_f32_16x16x32_bf16 v[252:255], a[236:239], a[180:183], 0
v_mfma_f32_16x16x32_bf16 v[252:255], a[232:235], a[176:179], v[252:255]
buffer_load_dwordx4 v1, s[4:7], s79 offen lds
v_mfma_f32_16x16x32_bf16 v[108:111], a[232:235], a[168:171], 0
s_add_u32 m0, s76, 28672
s_add_u32 s79, s36, 458752
v_mfma_f32_16x16x32_bf16 v[108:111], a[236:239], a[172:175], v[108:111]
v_mfma_f32_16x16x32_bf16 v[92:95], a[236:239], a[164:167], 0
ds_read_b128 a[252:255], v7 offset:38912
v_mfma_f32_16x16x32_bf16 v[92:95], a[232:235], a[160:163], v[92:95]
s_waitcnt lgkmcnt(5)
v_mfma_f32_16x16x32_bf16 a[52:55], a[224:227], a[160:163], 0
s_waitcnt lgkmcnt(3)
ds_read_b64_tr_b16 a[232:233], v11 offset:25088
v_mfma_f32_16x16x32_bf16 a[52:55], a[228:231], a[164:167], a[52:55]
ds_read_b64_tr_b16 a[234:235], v11 offset:25344
v_mfma_f32_16x16x32_bf16 a[68:71], a[228:231], a[172:175], 0
buffer_load_dwordx4 v1, s[4:7], s79 offen lds
v_mfma_f32_16x16x32_bf16 a[68:71], a[224:227], a[168:171], a[68:71]
s_add_u32 s36, s36, 128
s_add_u32 m0, s76, 65536
ds_read_b64_tr_b16 a[236:237], v11 offset:29184
v_mfma_f32_16x16x32_bf16 a[84:87], a[224:227], a[176:179], 0
ds_read_b64_tr_b16 a[238:239], v11 offset:29440
v_mfma_f32_16x16x32_bf16 a[84:87], a[228:231], a[180:183], a[84:87]
ds_read_b128 a[248:251], v6 offset:38912
v_mfma_f32_16x16x32_bf16 a[100:103], a[228:231], a[188:191], 0
v_mfma_f32_16x16x32_bf16 a[100:103], a[224:227], a[184:187], a[100:103]
v_mfma_f32_16x16x32_bf16 a[116:119], a[224:227], a[192:195], 0
v_mfma_f32_16x16x32_bf16 a[116:119], a[228:231], a[196:199], a[116:119]
buffer_load_dwordx4 v2, s[8:11], s38 offen nt lds
v_mfma_f32_16x16x32_bf16 a[132:135], a[228:231], a[204:207], 0
s_add_u32 m0, s76, 73600
v_mfma_f32_16x16x32_bf16 a[132:135], a[224:227], a[200:203], a[132:135]
v_mfma_f32_16x16x32_bf16 v[148:151], a[224:227], a[208:211], 0
v_mfma_f32_16x16x32_bf16 v[148:151], a[228:231], a[212:215], v[148:151]
v_mfma_f32_16x16x32_bf16 v[164:167], a[228:231], a[220:223], 0
v_mfma_f32_16x16x32_bf16 v[164:167], a[224:227], a[216:219], v[164:167]
s_waitcnt vmcnt(15) lgkmcnt(1)
s_barrier
v_mfma_f32_16x16x32_bf16 v[172:175], a[232:235], a[216:219], 0
buffer_load_dwordx4 v2, s[8:11], s38 offen offset:128 nt lds
v_mfma_f32_16x16x32_bf16 v[172:175], a[236:239], a[220:223], v[172:175]
s_add_u32 m0, s76, 81920
ds_read_b64_tr_b16 a[224:225], v12 offset:0
v_mfma_f32_16x16x32_bf16 v[156:159], a[236:239], a[212:215], 0
ds_read_b64_tr_b16 a[226:227], v12 offset:256
v_mfma_f32_16x16x32_bf16 v[156:159], a[232:235], a[208:211], v[156:159]
ds_read_b64_tr_b16 a[228:229], v12 offset:4096
v_mfma_f32_16x16x32_bf16 a[140:143], a[232:235], a[200:203], 0
ds_read_b64_tr_b16 a[230:231], v12 offset:4352
v_mfma_f32_16x16x32_bf16 a[140:143], a[236:239], a[204:207], a[140:143]
v_mfma_f32_16x16x32_bf16 a[124:127], a[236:239], a[196:199], 0
v_mfma_f32_16x16x32_bf16 a[124:127], a[232:235], a[192:195], a[124:127]
buffer_load_dwordx4 v3, s[16:19], s39 offen nt lds
v_mfma_f32_16x16x32_bf16 a[108:111], a[232:235], a[184:187], 0
s_add_u32 m0, s76, 69632
s_add_u32 s79, s38, 229376
ds_read_b128 a[192:195], v6 offset:40960
v_mfma_f32_16x16x32_bf16 a[108:111], a[236:239], a[188:191], a[108:111]
ds_read_b128 a[196:199], v7 offset:40960
v_mfma_f32_16x16x32_bf16 a[92:95], a[236:239], a[180:183], 0
ds_read_b128 a[204:207], v7 offset:43008
v_mfma_f32_16x16x32_bf16 a[92:95], a[232:235], a[176:179], a[92:95]
ds_read_b128 a[200:203], v6 offset:43008
v_mfma_f32_16x16x32_bf16 a[76:79], a[232:235], a[168:171], 0
ds_read_b128 a[208:211], v6 offset:45056
v_mfma_f32_16x16x32_bf16 a[76:79], a[236:239], a[172:175], a[76:79]
ds_read_b128 a[212:215], v7 offset:45056
v_mfma_f32_16x16x32_bf16 a[60:63], a[236:239], a[164:167], 0
buffer_load_dwordx4 v2, s[8:11], s79 offen nt lds
v_mfma_f32_16x16x32_bf16 a[60:63], a[232:235], a[160:163], a[60:63]
s_waitcnt lgkmcnt(8)
s_add_u32 m0, s76, 77696
s_mov_b32 s46, 6
v_mfma_f32_16x16x32_bf16 v[80:83], a[224:227], v[58:61], v[80:83]
s_waitcnt lgkmcnt(6)
ds_read_b128 a[220:223], v7 offset:47104
v_mfma_f32_16x16x32_bf16 v[80:83], a[228:231], v[62:65], v[80:83]
ds_read_b128 a[216:219], v6 offset:47104
v_mfma_f32_16x16x32_bf16 v[96:99], a[228:231], v[70:73], v[96:99]
ds_read_b64_tr_b16 a[232:233], v13 offset:0
v_mfma_f32_16x16x32_bf16 v[96:99], a[224:227], v[66:69], v[96:99]
ds_read_b64_tr_b16 a[234:235], v13 offset:256
v_mfma_f32_16x16x32_bf16 v[240:243], a[224:227], a[240:243], v[240:243]
ds_read_b64_tr_b16 a[236:237], v13 offset:4096
v_lshrrev_b32_e64 v46, 4, v0
v_mfma_f32_16x16x32_bf16 v[240:243], a[228:231], a[244:247], v[240:243]
buffer_load_dwordx4 v2, s[8:11], s79 offen offset:128 nt lds
v_mfma_f32_16x16x32_bf16 v[112:115], a[228:231], a[252:255], v[112:115]
s_add_u32 m0, s76, 86016
s_add_u32 s79, s39, 229376
ds_read_b64_tr_b16 a[238:239], v13 offset:4352
v_mfma_f32_16x16x32_bf16 v[112:115], a[224:227], a[248:251], v[112:115]
s_waitcnt lgkmcnt(11)
v_mfma_f32_16x16x32_bf16 v[128:131], a[224:227], a[192:195], v[128:131]
s_waitcnt lgkmcnt(10)
v_lshlrev_b32_e64 v46, 10, v46
v_mfma_f32_16x16x32_bf16 v[128:131], a[228:231], a[196:199], v[128:131]
s_waitcnt lgkmcnt(9)
v_mfma_f32_16x16x32_bf16 a[0:3], a[228:231], a[204:207], a[0:3]
s_waitcnt lgkmcnt(8)
v_mfma_f32_16x16x32_bf16 a[0:3], a[224:227], a[200:203], a[0:3]
s_waitcnt lgkmcnt(7)
v_mfma_f32_16x16x32_bf16 a[16:19], a[224:227], a[208:211], a[16:19]
s_waitcnt lgkmcnt(6)
buffer_load_dwordx4 v3, s[16:19], s79 offen nt lds
v_mfma_f32_16x16x32_bf16 a[16:19], a[228:231], a[212:215], a[16:19]
s_waitcnt lgkmcnt(5)
s_add_u32 s39, s39, 458752
s_add_u32 m0, s76, 90112
v_mfma_f32_16x16x32_bf16 a[32:35], a[228:231], a[220:223], a[32:35]
s_waitcnt lgkmcnt(4)
v_and_b32_e64 v47, 15, v0
v_mfma_f32_16x16x32_bf16 a[32:35], a[224:227], a[216:219], a[32:35]
s_waitcnt lgkmcnt(2)
v_mfma_f32_16x16x32_bf16 a[40:43], a[232:235], a[216:219], a[40:43]
s_waitcnt lgkmcnt(0)
ds_read_b64_tr_b16 a[224:225], v12 offset:512
v_lshl_add_u32 v79, v47, 4, v46
v_mfma_f32_16x16x32_bf16 a[40:43], a[236:239], a[220:223], a[40:43]
ds_read_b64_tr_b16 a[226:227], v12 offset:768
v_mfma_f32_16x16x32_bf16 a[24:27], a[236:239], a[212:215], a[24:27]
ds_read_b64_tr_b16 a[228:229], v12 offset:4608
v_mfma_f32_16x16x32_bf16 a[24:27], a[232:235], a[208:211], a[24:27]
buffer_load_dwordx4 v2, s[12:15], s38 offen nt lds
v_mfma_f32_16x16x32_bf16 a[8:11], a[232:235], a[200:203], a[8:11]
s_add_u32 m0, s76, 98176
ds_read_b64_tr_b16 a[230:231], v12 offset:4864
v_mfma_f32_16x16x32_bf16 a[8:11], a[236:239], a[204:207], a[8:11]
v_mfma_f32_16x16x32_bf16 v[136:139], a[236:239], a[196:199], v[136:139]
ds_read_b64_tr_b16 a[148:149], v8 offset:40960
v_mfma_f32_16x16x32_bf16 v[136:139], a[232:235], a[192:195], v[136:139]
ds_read_b64_tr_b16 a[150:151], v8 offset:41216
v_mfma_f32_16x16x32_bf16 v[120:123], a[232:235], a[248:251], v[120:123]
v_mfma_f32_16x16x32_bf16 v[120:123], a[236:239], a[252:255], v[120:123]
v_mfma_f32_16x16x32_bf16 v[248:251], a[236:239], a[244:247], v[248:251]
buffer_load_dwordx4 v2, s[12:15], s38 offen offset:128 nt lds
v_mfma_f32_16x16x32_bf16 v[248:251], a[232:235], a[240:243], v[248:251]
s_add_u32 m0, s76, 94208
s_add_u32 s79, s38, 229376
v_mfma_f32_16x16x32_bf16 v[104:107], a[232:235], v[66:69], v[104:107]
v_mfma_f32_16x16x32_bf16 v[104:107], a[236:239], v[70:73], v[104:107]
v_mfma_f32_16x16x32_bf16 v[88:91], a[236:239], v[62:65], v[88:91]
v_mfma_f32_16x16x32_bf16 v[88:91], a[232:235], v[58:61], v[88:91]
s_waitcnt lgkmcnt(4)
v_mfma_f32_16x16x32_bf16 a[48:51], a[224:227], v[58:61], a[48:51]
s_waitcnt lgkmcnt(2)
ds_read_b64_tr_b16 a[232:233], v13 offset:512
v_mfma_f32_16x16x32_bf16 a[48:51], a[228:231], v[62:65], a[48:51]
buffer_load_dwordx4 v2, s[12:15], s79 offen nt lds
v_mfma_f32_16x16x32_bf16 a[64:67], a[228:231], v[70:73], a[64:67]
s_add_u32 m0, s76, 102272
ds_read_b64_tr_b16 a[234:235], v13 offset:768
v_mfma_f32_16x16x32_bf16 a[64:67], a[224:227], v[66:69], a[64:67]
ds_read_b64_tr_b16 a[236:237], v13 offset:4608
v_mfma_f32_16x16x32_bf16 a[80:83], a[224:227], a[240:243], a[80:83]
ds_read_b64_tr_b16 a[238:239], v13 offset:4864
v_mfma_f32_16x16x32_bf16 a[80:83], a[228:231], a[244:247], a[80:83]
v_mfma_f32_16x16x32_bf16 a[96:99], a[228:231], a[252:255], a[96:99]
v_mfma_f32_16x16x32_bf16 a[96:99], a[224:227], a[248:251], a[96:99]
s_waitcnt lgkmcnt(4)
v_mfma_f32_16x16x32_bf16 a[144:147], a[152:155], a[148:151], a[144:147]
buffer_load_dwordx4 v2, s[12:15], s79 offen offset:128 nt lds
v_mfma_f32_16x16x32_bf16 a[112:115], a[224:227], a[192:195], a[112:115]
s_add_u32 s38, s38, 458752
s_add_u32 m0, s76, 147456
s_waitcnt vmcnt(18)
v_mfma_f32_16x16x32_bf16 a[112:115], a[228:231], a[196:199], a[112:115]
ds_read_b64_tr_b16 a[148:149], v8 offset:45056
v_mfma_f32_16x16x32_bf16 v[36:39], v[20:23], v[20:23], 0
v_mfma_f32_16x16x32_bf16 a[128:131], a[228:231], a[204:207], a[128:131]
ds_read_b64_tr_b16 a[150:151], v8 offset:45312
v_mfma_f32_16x16x32_bf16 a[128:131], a[224:227], a[200:203], a[128:131]
v_mfma_f32_16x16x32_bf16 v[40:43], v[20:23], a[152:155], 0
v_mfma_f32_16x16x32_bf16 v[144:147], a[224:227], a[208:211], v[144:147]
v_mfma_f32_16x16x32_bf16 v[144:147], a[228:231], a[212:215], v[144:147]
v_mfma_f32_16x16x32_bf16 v[36:39], v[24:27], v[24:27], v[36:39]
v_mfma_f32_16x16x32_bf16 v[160:163], a[228:231], a[220:223], v[160:163]
buffer_load_dwordx4 v4, s[60:63], s68 offen nt lds
v_mfma_f32_16x16x32_bf16 v[160:163], a[224:227], a[216:219], v[160:163]
s_waitcnt lgkmcnt(4)
s_sub_u32 s68, s68, 0x20000
s_add_u32 s68, s68, s72
v_mfma_f32_16x16x32_bf16 v[40:43], v[24:27], a[152:155], v[40:43]
v_mfma_f32_16x16x32_bf16 v[168:171], a[232:235], a[216:219], v[168:171]
s_waitcnt lgkmcnt(2)
s_mov_b32 s60, s74
ds_read_b64_tr_b16 a[224:225], v14 offset:40960
v_mfma_f32_16x16x32_bf16 v[168:171], a[236:239], a[220:223], v[168:171]
s_mov_b32 s61, s75
s_add_u32 s62, s73, 917504
ds_read_b64_tr_b16 a[226:227], v14 offset:41216
v_mfma_f32_16x16x32_bf16 v[36:39], v[28:31], v[28:31], v[36:39]
v_mfma_f32_16x16x32_bf16 v[152:155], a[236:239], a[212:215], v[152:155]
s_add_u32 m0, s76, 151552
ds_read_b64_tr_b16 a[228:229], v14 offset:45056
v_mfma_f32_16x16x32_bf16 v[152:155], a[232:235], a[208:211], v[152:155]
ds_read_b64_tr_b16 a[230:231], v14 offset:45312
v_mfma_f32_16x16x32_bf16 v[40:43], v[28:31], a[152:155], v[40:43]
v_mfma_f32_16x16x32_bf16 a[136:139], a[232:235], a[200:203], a[136:139]
v_mfma_f32_16x16x32_bf16 a[136:139], a[236:239], a[204:207], a[136:139]
buffer_load_dwordx4 v4, s[60:63], s68 offen nt lds
v_mfma_f32_16x16x32_bf16 a[120:123], a[236:239], a[196:199], a[120:123]
s_add_u32 s68, s68, 0x20000
v_mfma_f32_16x16x32_bf16 v[36:39], v[32:35], v[32:35], v[36:39]
v_mfma_f32_16x16x32_bf16 a[120:123], a[232:235], a[192:195], a[120:123]
s_waitcnt lgkmcnt(4)
v_mfma_f32_16x16x32_bf16 v[40:43], v[32:35], a[152:155], v[40:43]
v_mfma_f32_16x16x32_bf16 a[144:147], a[152:155], a[148:151], a[144:147]
v_mfma_f32_16x16x32_bf16 a[104:107], a[232:235], a[248:251], a[104:107]
v_and_b32_e64 v77, 31, v0
v_mfma_f32_16x16x32_bf16 a[104:107], a[236:239], a[252:255], a[104:107]
v_mfma_f32_16x16x32_bf16 a[88:91], a[236:239], a[244:247], a[88:91]
v_lshrrev_b32_e64 v76, 5, v0
v_mfma_f32_16x16x32_bf16 a[88:91], a[232:235], a[240:243], a[88:91]
v_mfma_f32_16x16x32_bf16 a[72:75], a[232:235], v[66:69], a[72:75]
v_lshlrev_b32_e64 v76, 3, v76
v_mfma_f32_16x16x32_bf16 a[72:75], a[236:239], v[70:73], a[72:75]
v_mfma_f32_16x16x32_bf16 a[56:59], a[236:239], v[62:65], a[56:59]
v_lshl_add_u32 v76, v77, 26, v76
v_mfma_f32_16x16x32_bf16 a[56:59], a[232:235], v[58:61], a[56:59]
s_waitcnt lgkmcnt(2)
v_mfma_f32_16x16x32_bf16 v[176:179], a[224:227], v[58:61], v[176:179]
s_waitcnt lgkmcnt(0)
ds_read_b64_tr_b16 a[232:233], v14 offset:43008
s_mov_b32 vcc_lo, 0x00100001
v_mfma_f32_16x16x32_bf16 v[176:179], a[228:231], v[62:65], v[176:179]
ds_read_b64_tr_b16 a[234:235], v14 offset:43264
v_mfma_f32_16x16x32_bf16 v[184:187], a[228:231], v[70:73], v[184:187]
ds_read_b64_tr_b16 a[236:237], v14 offset:47104
s_mov_b32 vcc_hi, 0x10000100
v_mfma_f32_16x16x32_bf16 v[184:187], a[224:227], v[66:69], v[184:187]
ds_read_b64_tr_b16 a[238:239], v14 offset:47360
v_mfma_f32_16x16x32_bf16 v[192:195], a[224:227], a[240:243], v[192:195]
v_mfma_f32_16x16x32_bf16 v[192:195], a[228:231], a[244:247], v[192:195]
v_mfma_f32_16x16x32_bf16 v[200:203], a[228:231], a[252:255], v[200:203]
v_mfma_f32_16x16x32_bf16 v[200:203], a[224:227], a[248:251], v[200:203]
v_mfma_f32_16x16x32_bf16 v[208:211], a[224:227], a[192:195], v[208:211]
v_cndmask_b32 v44, 0, v36, vcc
v_mfma_f32_16x16x32_bf16 v[208:211], a[228:231], a[196:199], v[208:211]
v_mfma_f32_16x16x32_bf16 v[216:219], a[228:231], a[204:207], v[216:219]
s_lshl_b64 vcc, vcc, 1
v_mfma_f32_16x16x32_bf16 v[216:219], a[224:227], a[200:203], v[216:219]
v_mfma_f32_16x16x32_bf16 v[224:227], a[224:227], a[208:211], v[224:227]
v_add_f32_e64 v40, v40, v41
v_mfma_f32_16x16x32_bf16 v[224:227], a[228:231], a[212:215], v[224:227]
v_mfma_f32_16x16x32_bf16 v[232:235], a[228:231], a[220:223], v[232:235]
v_cndmask_b32 v44, v44, v37, vcc
v_mfma_f32_16x16x32_bf16 v[232:235], a[224:227], a[216:219], v[232:235]
s_waitcnt vmcnt(12) lgkmcnt(0)
s_barrier
v_mfma_f32_16x16x32_bf16 v[236:239], a[232:235], a[216:219], v[236:239]
s_sub_u32 s56, s56, 1
ds_read_b64_tr_b16 a[224:225], v12 offset:24576
s_lshl_b64 vcc, vcc, 1
v_mfma_f32_16x16x32_bf16 v[236:239], a[236:239], a[220:223], v[236:239]
s_cmp_eq_u32 s56, 0
s_cselect_b32 s78, -960, 64
ds_read_b64_tr_b16 a[226:227], v12 offset:24832
v_mfma_f32_16x16x32_bf16 v[228:231], a[236:239], a[212:215], v[228:231]
s_add_u32 m0, s76, 32768
s_add_u32 s79, s36, 0
ds_read_b64_tr_b16 a[228:229], v12 offset:28672
v_mfma_f32_16x16x32_bf16 v[228:231], a[232:235], a[208:211], v[228:231]
buffer_load_dwordx4 v1, s[4:7], s79 offen lds
v_mfma_f32_16x16x32_bf16 v[220:223], a[232:235], a[200:203], v[220:223]
s_add_u32 m0, s76, 36864
s_add_u32 s79, s36, 65536
ds_read_b64_tr_b16 a[230:231], v12 offset:28928
v_mfma_f32_16x16x32_bf16 v[220:223], a[236:239], a[204:207], v[220:223]
ds_read_b128 a[160:163], v6 offset:0
v_add_f32 v40, v40, v42
v_mfma_f32_16x16x32_bf16 v[212:215], a[236:239], a[196:199], v[212:215]
v_cndmask_b32 v44, v44, v38, vcc
s_lshl_b64 vcc, vcc, 1
v_mfma_f32_16x16x32_bf16 v[212:215], a[232:235], a[192:195], v[212:215]
v_mfma_f32_16x16x32_bf16 v[204:207], a[232:235], a[248:251], v[204:207]
ds_read_b64_tr_b16 v[54:55], v78 offset:8192
v_mfma_f32_16x16x32_bf16 v[204:207], a[236:239], a[252:255], v[204:207]
ds_read_b64_tr_b16 v[56:57], v78 offset:8704
v_add_f32_e64 v40, v40, v43
v_mfma_f32_16x16x32_bf16 v[196:199], a[236:239], a[244:247], v[196:199]
buffer_load_dwordx4 v1, s[4:7], s79 offen lds
v_mfma_f32_16x16x32_bf16 v[196:199], a[232:235], a[240:243], v[196:199]
s_add_u32 m0, s76, 40960
s_add_u32 s79, s36, 131072
ds_read_b128 a[164:167], v7 offset:0
v_mfma_f32_16x16x32_bf16 v[188:191], a[232:235], v[66:69], v[188:191]
v_cndmask_b32 v44, v44, v39, vcc
v_mfma_f32_16x16x32_bf16 v[188:191], a[236:239], v[70:73], v[188:191]
s_nop 0
v_add_f32_dpp v44, v44, v44 quad_perm:[1,0,3,2] row_mask:0xf bank_mask:0xf
v_mfma_f32_16x16x32_bf16 v[180:183], a[236:239], v[62:65], v[180:183]
v_mfma_f32_16x16x32_bf16 v[180:183], a[232:235], v[58:61], v[180:183]
s_waitcnt lgkmcnt(6)
v_add_f32_dpp v44, v44, v44 quad_perm:[2,3,0,1] row_mask:0xf bank_mask:0xf
v_mfma_f32_16x16x32_bf16 v[84:87], a[224:227], v[58:61], v[84:87]
s_waitcnt lgkmcnt(4)
ds_read_b64_tr_b16 a[232:233], v13 offset:24576
v_mfma_f32_16x16x32_bf16 v[84:87], a[228:231], v[62:65], v[84:87]
buffer_load_dwordx4 v1, s[4:7], s79 offen lds
v_mfma_f32_16x16x32_bf16 v[100:103], a[228:231], v[70:73], v[100:103]
s_add_u32 m0, s76, 45056
s_add_u32 s79, s36, 196608
ds_read_b64_tr_b16 a[234:235], v13 offset:24832
v_mfma_f32_16x16x32_bf16 v[100:103], a[224:227], v[66:69], v[100:103]
ds_read_b64_tr_b16 a[236:237], v13 offset:28672
v_add_f32_dpp v44, v44, v44 row_half_mirror row_mask:0xf bank_mask:0xf
v_mfma_f32_16x16x32_bf16 v[244:247], a[224:227], a[240:243], v[244:247]
ds_read_b64_tr_b16 a[238:239], v13 offset:28928
v_add_f32_dpp v44, v44, v44 row_mirror row_mask:0xf bank_mask:0xf
v_mfma_f32_16x16x32_bf16 v[244:247], a[228:231], a[244:247], v[244:247]
ds_read_b128 a[172:175], v7 offset:2048
v_permlane16_swap_b32 v40, v44
v_mfma_f32_16x16x32_bf16 v[116:119], a[228:231], a[252:255], v[116:119]
v_mfma_f32_16x16x32_bf16 v[116:119], a[224:227], a[248:251], v[116:119]
v_add_f32 v40, v40, v44
v_mfma_f32_16x16x32_bf16 v[132:135], a[224:227], a[192:195], v[132:135]
buffer_load_dwordx4 v1, s[4:7], s79 offen lds
v_mfma_f32_16x16x32_bf16 v[132:135], a[228:231], a[196:199], v[132:135]
s_add_u32 m0, s76, 49152
s_add_u32 s79, s36, 262144
ds_read_b128 a[168:171], v6 offset:2048
v_mfma_f32_16x16x32_bf16 a[4:7], a[228:231], a[204:207], a[4:7]
v_mul_f32 v40, 0x3a800000, v40
v_mfma_f32_16x16x32_bf16 a[4:7], a[224:227], a[200:203], a[4:7]
v_mov_b32_e64 v44, v40
v_mfma_f32_16x16x32_bf16 a[20:23], a[224:227], a[208:211], a[20:23]
v_mfma_f32_16x16x32_bf16 a[20:23], a[228:231], a[212:215], a[20:23]
v_permlane16_swap_b32 v40, v44
v_mfma_f32_16x16x32_bf16 a[36:39], a[228:231], a[220:223], a[36:39]
v_mfma_f32_16x16x32_bf16 a[36:39], a[224:227], a[216:219], a[36:39]
s_waitcnt lgkmcnt(4)
buffer_load_dwordx4 v1, s[4:7], s79 offen lds
v_mfma_f32_16x16x32_bf16 a[44:47], a[232:235], a[216:219], a[44:47]
s_waitcnt lgkmcnt(2)
s_add_u32 m0, s76, 53248
ds_read_b64_tr_b16 a[224:225], v12 offset:25088
v_mfma_f32_16x16x32_bf16 a[44:47], a[236:239], a[220:223], a[44:47]
s_add_u32 s79, s36, 327680
ds_read_b64_tr_b16 a[226:227], v12 offset:25344
v_fma_f32 v44, -v40, v40, v44
v_mfma_f32_16x16x32_bf16 a[28:31], a[236:239], a[212:215], a[28:31]
ds_read_b64_tr_b16 a[228:229], v12 offset:29184
v_cvt_pk_bf16_f32 v74, v40, v40
v_mfma_f32_16x16x32_bf16 a[28:31], a[232:235], a[208:211], a[28:31]
ds_read_b64_tr_b16 a[230:231], v12 offset:29440
v_max_f32 v44, 0, v44
v_mfma_f32_16x16x32_bf16 a[12:15], a[232:235], a[200:203], a[12:15]
ds_read_b128 a[176:179], v6 offset:4096
v_mfma_f32_16x16x32_bf16 a[12:15], a[236:239], a[204:207], a[12:15]
v_xor_b32 v74, 0x80008000, v74
v_mfma_f32_16x16x32_bf16 v[140:143], a[236:239], a[196:199], v[140:143]
buffer_load_dwordx4 v1, s[4:7], s79 offen lds
v_mfma_f32_16x16x32_bf16 v[140:143], a[232:235], a[192:195], v[140:143]
s_add_u32 m0, s76, 57344
s_add_u32 s79, s36, 393216
ds_read_b128 a[180:183], v7 offset:4096
v_mfma_f32_16x16x32_bf16 v[124:127], a[232:235], a[248:251], v[124:127]
buffer_store_dwordx4 v[54:57], v79, s[64:67], s69 offen sc1
v_mfma_f32_16x16x32_bf16 v[124:127], a[236:239], a[252:255], v[124:127]
v_cvt_pk_bf16_f32 v44, v44, v44
s_add_u32 s69, s69, 0x100000
v_mfma_f32_16x16x32_bf16 v[252:255], a[236:239], a[244:247], v[252:255]
v_and_b32_e64 v44, s54, v44
v_mfma_f32_16x16x32_bf16 v[252:255], a[232:235], a[240:243], v[252:255]
v_add_f32 v44, 0x3727c5ac, v44
v_mfma_f32_16x16x32_bf16 v[108:111], a[232:235], v[66:69], v[108:111]
v_mfma_f32_16x16x32_bf16 v[108:111], a[236:239], v[70:73], v[108:111]
buffer_load_dwordx4 v1, s[4:7], s79 offen lds
v_mfma_f32_16x16x32_bf16 v[92:95], a[236:239], v[62:65], v[92:95]
s_add_u32 m0, s76, 61440
s_add_u32 s79, s36, 458752
ds_read_b128 a[188:191], v7 offset:6144
v_mfma_f32_16x16x32_bf16 v[92:95], a[232:235], v[58:61], v[92:95]
s_waitcnt lgkmcnt(5)
v_cvt_pk_bf16_f32 v44, v44, v44
v_mfma_f32_16x16x32_bf16 a[52:55], a[224:227], v[58:61], a[52:55]
s_waitcnt lgkmcnt(3)
ds_read_b64_tr_b16 a[232:233], v13 offset:25088
v_and_b32_e64 v44, s54, v44
v_mfma_f32_16x16x32_bf16 a[52:55], a[228:231], v[62:65], a[52:55]
ds_read_b64_tr_b16 a[234:235], v13 offset:25344
v_mfma_f32_16x16x32_bf16 a[68:71], a[228:231], v[70:73], a[68:71]
ds_read_b64_tr_b16 a[236:237], v13 offset:29184
v_mfma_f32_16x16x32_bf16 a[68:71], a[224:227], v[66:69], a[68:71]
ds_read_b64_tr_b16 a[238:239], v13 offset:29440
v_mfma_f32_16x16x32_bf16 a[84:87], a[224:227], a[240:243], a[84:87]
buffer_load_dwordx4 v1, s[4:7], s79 offen lds
v_mfma_f32_16x16x32_bf16 a[84:87], a[228:231], a[244:247], a[84:87]
s_lshl1_add_u32 s36, s78, s36
s_add_u32 m0, s76, 106496
ds_read_b128 a[184:187], v6 offset:6144
v_mfma_f32_16x16x32_bf16 a[100:103], a[228:231], a[252:255], a[100:103]
v_sqrt_f32 v44, v44
v_mfma_f32_16x16x32_bf16 a[100:103], a[224:227], a[248:251], a[100:103]
v_cvt_pk_bf16_f32 v44, v44, v44
v_mfma_f32_16x16x32_bf16 a[116:119], a[224:227], a[192:195], a[116:119]
v_and_b32_e64 v75, s54, v44
v_mfma_f32_16x16x32_bf16 a[116:119], a[228:231], a[196:199], a[116:119]
buffer_store_dwordx2 v[74:75], v76, s[24:27], s41 offen sc1
v_mfma_f32_16x16x32_bf16 a[132:135], a[228:231], a[204:207], a[132:135]
v_mov_b32 v16, 162368
v_mfma_f32_16x16x32_bf16 a[132:135], a[224:227], a[200:203], a[132:135]
buffer_load_dwordx4 v2, s[8:11], s38 offen lds
v_mfma_f32_16x16x32_bf16 v[148:151], a[224:227], a[208:211], v[148:151]
s_add_u32 m0, s76, 114560
v_mfma_f32_16x16x32_bf16 v[148:151], a[228:231], a[212:215], v[148:151]
v_min_u32_e64 v17, 7, v0
v_mfma_f32_16x16x32_bf16 v[164:167], a[228:231], a[220:223], v[164:167]
v_mfma_f32_16x16x32_bf16 v[164:167], a[224:227], a[216:219], v[164:167]
s_waitcnt vmcnt(13) lgkmcnt(1)
s_barrier
v_mfma_f32_16x16x32_bf16 v[172:175], a[232:235], a[216:219], v[172:175]
ds_read_b64_tr_b16 a[224:225], v10 offset:0
v_lshl_add_u32 v17, v17, 2, v16
v_mfma_f32_16x16x32_bf16 v[172:175], a[236:239], a[220:223], v[172:175]
ds_read_b64_tr_b16 a[226:227], v10 offset:256
v_mfma_f32_16x16x32_bf16 v[156:159], a[236:239], a[212:215], v[156:159]
buffer_load_dwordx4 v2, s[8:11], s38 offen offset:128 lds
v_mfma_f32_16x16x32_bf16 v[156:159], a[232:235], a[208:211], v[156:159]
s_add_u32 m0, s76, 122880
ds_read_b64_tr_b16 a[228:229], v10 offset:4096
v_mfma_f32_16x16x32_bf16 a[140:143], a[232:235], a[200:203], a[140:143]
ds_read_b64_tr_b16 a[230:231], v10 offset:4352
v_mfma_f32_16x16x32_bf16 a[140:143], a[236:239], a[204:207], a[140:143]
v_mfma_f32_16x16x32_bf16 a[124:127], a[236:239], a[196:199], a[124:127]
v_mfma_f32_16x16x32_bf16 a[124:127], a[232:235], a[192:195], a[124:127]
ds_read_b128 a[192:195], v6 offset:8192
v_mfma_f32_16x16x32_bf16 a[108:111], a[232:235], a[248:251], a[108:111]
ds_read_b128 a[196:199], v7 offset:8192
v_mfma_f32_16x16x32_bf16 a[108:111], a[236:239], a[252:255], a[108:111]
buffer_load_dwordx4 v3, s[16:19], s39 offen lds
v_mfma_f32_16x16x32_bf16 a[92:95], a[236:239], a[244:247], a[92:95]
s_add_u32 m0, s76, 110592
s_add_u32 s79, s38, 229376
ds_read_b128 a[204:207], v7 offset:10240
v_mfma_f32_16x16x32_bf16 a[92:95], a[232:235], a[240:243], a[92:95]
ds_read_b128 a[200:203], v6 offset:10240
v_mfma_f32_16x16x32_bf16 a[76:79], a[232:235], v[66:69], a[76:79]
ds_read_b128 a[208:211], v6 offset:12288
v_mfma_f32_16x16x32_bf16 a[76:79], a[236:239], v[70:73], a[76:79]
ds_read_b128 a[212:215], v7 offset:12288
v_mfma_f32_16x16x32_bf16 a[60:63], a[236:239], v[62:65], a[60:63]
v_mfma_f32_16x16x32_bf16 a[60:63], a[232:235], v[58:61], a[60:63]
s_waitcnt lgkmcnt(8)
L_g1_loop_1033:
v_mfma_f32_16x16x32_bf16 v[80:83], a[224:227], a[160:163], v[80:83]
s_waitcnt lgkmcnt(6)
buffer_load_dwordx4 v2, s[8:11], s79 offen lds
v_mfma_f32_16x16x32_bf16 v[80:83], a[228:231], a[164:167], v[80:83]
s_add_u32 m0, s76, 118656
ds_read_b128 a[220:223], v7 offset:14336
v_mfma_f32_16x16x32_bf16 v[96:99], a[228:231], a[172:175], v[96:99]
ds_read_b128 a[216:219], v6 offset:14336
v_mfma_f32_16x16x32_bf16 v[96:99], a[224:227], a[168:171], v[96:99]
ds_read_b64_tr_b16 a[232:233], v11 offset:0
v_mfma_f32_16x16x32_bf16 v[240:243], a[224:227], a[176:179], v[240:243]
ds_read_b64_tr_b16 a[234:235], v11 offset:256
v_mfma_f32_16x16x32_bf16 v[240:243], a[228:231], a[180:183], v[240:243]
ds_read_b64_tr_b16 a[236:237], v11 offset:4096
v_mfma_f32_16x16x32_bf16 v[112:115], a[228:231], a[188:191], v[112:115]
ds_read_b64_tr_b16 a[238:239], v11 offset:4352
v_mfma_f32_16x16x32_bf16 v[112:115], a[224:227], a[184:187], v[112:115]
s_waitcnt lgkmcnt(11)
buffer_load_dwordx4 v2, s[8:11], s79 offen offset:128 lds
v_mfma_f32_16x16x32_bf16 v[128:131], a[224:227], a[192:195], v[128:131]
s_waitcnt lgkmcnt(10)
s_add_u32 m0, s76, 126976
s_add_u32 s79, s39, 229376
v_mfma_f32_16x16x32_bf16 v[128:131], a[228:231], a[196:199], v[128:131]
s_waitcnt lgkmcnt(9)
v_mfma_f32_16x16x32_bf16 a[0:3], a[228:231], a[204:207], a[0:3]
s_waitcnt lgkmcnt(8)
v_mfma_f32_16x16x32_bf16 a[0:3], a[224:227], a[200:203], a[0:3]
s_waitcnt lgkmcnt(7)
v_mfma_f32_16x16x32_bf16 a[16:19], a[224:227], a[208:211], a[16:19]
s_waitcnt lgkmcnt(6)
v_mfma_f32_16x16x32_bf16 a[16:19], a[228:231], a[212:215], a[16:19]
s_waitcnt lgkmcnt(5)
v_mfma_f32_16x16x32_bf16 a[32:35], a[228:231], a[220:223], a[32:35]
s_waitcnt lgkmcnt(4)
buffer_load_dwordx4 v3, s[16:19], s79 offen lds
v_mfma_f32_16x16x32_bf16 a[32:35], a[224:227], a[216:219], a[32:35]
s_waitcnt lgkmcnt(2)
s_mul_i32 s55, s78, 7168
s_add_u32 s39, s39, s55
v_mfma_f32_16x16x32_bf16 a[40:43], a[232:235], a[216:219], a[40:43]
s_waitcnt lgkmcnt(0)
s_add_u32 m0, s76, 131072
ds_read_b64_tr_b16 a[224:225], v10 offset:512
v_mfma_f32_16x16x32_bf16 a[40:43], a[236:239], a[220:223], a[40:43]
ds_read_b64_tr_b16 a[226:227], v10 offset:768
v_mfma_f32_16x16x32_bf16 a[24:27], a[236:239], a[212:215], a[24:27]
ds_read_b64_tr_b16 a[228:229], v10 offset:4608
v_mfma_f32_16x16x32_bf16 a[24:27], a[232:235], a[208:211], a[24:27]
ds_read_b64_tr_b16 a[230:231], v10 offset:4864
v_mfma_f32_16x16x32_bf16 a[8:11], a[232:235], a[200:203], a[8:11]
v_mfma_f32_16x16x32_bf16 a[8:11], a[236:239], a[204:207], a[8:11]
buffer_load_dwordx4 v2, s[12:15], s38 offen lds
v_mfma_f32_16x16x32_bf16 v[136:139], a[236:239], a[196:199], v[136:139]
s_add_u32 m0, s76, 139136
ds_read_b64_tr_b16 a[148:149], v8 offset:0
v_mfma_f32_16x16x32_bf16 v[136:139], a[232:235], a[192:195], v[136:139]
ds_read_b64_tr_b16 a[150:151], v8 offset:256
v_mfma_f32_16x16x32_bf16 v[120:123], a[232:235], a[184:187], v[120:123]
v_mfma_f32_16x16x32_bf16 v[120:123], a[236:239], a[188:191], v[120:123]
v_mfma_f32_16x16x32_bf16 v[248:251], a[236:239], a[180:183], v[248:251]
v_mfma_f32_16x16x32_bf16 v[248:251], a[232:235], a[176:179], v[248:251]
v_mfma_f32_16x16x32_bf16 v[104:107], a[232:235], a[168:171], v[104:107]
buffer_load_dwordx4 v2, s[12:15], s38 offen offset:128 lds
v_mfma_f32_16x16x32_bf16 v[104:107], a[236:239], a[172:175], v[104:107]
s_add_u32 m0, s76, 135168
s_add_u32 s79, s38, 229376
v_mfma_f32_16x16x32_bf16 v[88:91], a[236:239], a[164:167], v[88:91]
v_mfma_f32_16x16x32_bf16 v[88:91], a[232:235], a[160:163], v[88:91]
s_waitcnt lgkmcnt(4)
v_mfma_f32_16x16x32_bf16 a[48:51], a[224:227], a[160:163], a[48:51]
s_waitcnt lgkmcnt(2)
ds_read_b64_tr_b16 a[232:233], v11 offset:512
v_mfma_f32_16x16x32_bf16 a[48:51], a[228:231], a[164:167], a[48:51]
ds_read_b64_tr_b16 a[234:235], v11 offset:768
v_mfma_f32_16x16x32_bf16 a[64:67], a[228:231], a[172:175], a[64:67]
ds_read_b64_tr_b16 a[236:237], v11 offset:4608
v_mfma_f32_16x16x32_bf16 a[64:67], a[224:227], a[168:171], a[64:67]
buffer_load_dwordx4 v2, s[12:15], s79 offen lds
v_mfma_f32_16x16x32_bf16 a[80:83], a[224:227], a[176:179], a[80:83]
s_add_u32 m0, s76, 143232
ds_read_b64_tr_b16 a[238:239], v11 offset:4864
v_mfma_f32_16x16x32_bf16 a[80:83], a[228:231], a[180:183], a[80:83]
v_mfma_f32_16x16x32_bf16 a[96:99], a[228:231], a[188:191], a[96:99]
v_mfma_f32_16x16x32_bf16 a[96:99], a[224:227], a[184:187], a[96:99]
s_waitcnt lgkmcnt(4)
v_mfma_f32_16x16x32_bf16 a[144:147], a[152:155], a[148:151], a[144:147]
v_mfma_f32_16x16x32_bf16 a[112:115], a[224:227], a[192:195], a[112:115]
v_mfma_f32_16x16x32_bf16 a[112:115], a[228:231], a[196:199], a[112:115]
buffer_load_dwordx4 v2, s[12:15], s79 offen offset:128 lds
v_mfma_f32_16x16x32_bf16 a[128:131], a[228:231], a[204:207], a[128:131]
s_mul_i32 s55, s78, 7168
s_add_u32 s38, s38, s55
ds_read_b64_tr_b16 a[148:149], v8 offset:4096
v_mfma_f32_16x16x32_bf16 a[128:131], a[224:227], a[200:203], a[128:131]
s_cmp_ge_u32 s47, 7340032
s_cselect_b32 s78, 7340032, 0
ds_read_b64_tr_b16 a[150:151], v8 offset:4352
v_mfma_f32_16x16x32_bf16 v[144:147], a[224:227], a[208:211], v[144:147]
s_sub_u32 s47, s47, s78
s_cmp_lt_u32 s46, 2
s_cselect_b32 s34, 0, s34
v_mfma_f32_16x16x32_bf16 v[144:147], a[228:231], a[212:215], v[144:147]
v_mfma_f32_16x16x32_bf16 v[160:163], a[228:231], a[220:223], v[160:163]
v_mfma_f32_16x16x32_bf16 v[160:163], a[224:227], a[216:219], v[160:163]
s_waitcnt lgkmcnt(4)
v_mfma_f32_16x16x32_bf16 v[168:171], a[232:235], a[216:219], v[168:171]
s_waitcnt lgkmcnt(2)
buffer_load_dword v19, v18, s[32:35], s47 offen
v_mfma_f32_16x16x32_bf16 v[168:171], a[236:239], a[220:223], v[168:171]
s_add_u32 s47, s47, 917504
ds_read_b64_tr_b16 a[224:225], v14 offset:0
v_mfma_f32_16x16x32_bf16 v[152:155], a[236:239], a[212:215], v[152:155]
ds_read_b64_tr_b16 a[226:227], v14 offset:256
v_mfma_f32_16x16x32_bf16 v[152:155], a[232:235], a[208:211], v[152:155]
ds_read_b64_tr_b16 a[228:229], v14 offset:4096
v_mfma_f32_16x16x32_bf16 a[136:139], a[232:235], a[200:203], a[136:139]
ds_read_b64_tr_b16 a[230:231], v14 offset:4352
v_mfma_f32_16x16x32_bf16 a[136:139], a[236:239], a[204:207], a[136:139]
v_mfma_f32_16x16x32_bf16 a[120:123], a[236:239], a[196:199], a[120:123]
v_mfma_f32_16x16x32_bf16 a[120:123], a[232:235], a[192:195], a[120:123]
s_waitcnt lgkmcnt(4)
v_mfma_f32_16x16x32_bf16 a[144:147], a[152:155], a[148:151], a[144:147]
v_mfma_f32_16x16x32_bf16 a[104:107], a[232:235], a[184:187], a[104:107]
v_mfma_f32_16x16x32_bf16 a[104:107], a[236:239], a[188:191], a[104:107]
v_mfma_f32_16x16x32_bf16 a[88:91], a[236:239], a[180:183], a[88:91]
v_mfma_f32_16x16x32_bf16 a[88:91], a[232:235], a[176:179], a[88:91]
v_mfma_f32_16x16x32_bf16 a[72:75], a[232:235], a[168:171], a[72:75]
v_mfma_f32_16x16x32_bf16 a[72:75], a[236:239], a[172:175], a[72:75]
v_mfma_f32_16x16x32_bf16 a[56:59], a[236:239], a[164:167], a[56:59]
v_mfma_f32_16x16x32_bf16 a[56:59], a[232:235], a[160:163], a[56:59]
s_waitcnt lgkmcnt(2)
v_mfma_f32_16x16x32_bf16 v[176:179], a[224:227], a[160:163], v[176:179]
s_waitcnt lgkmcnt(0)
ds_read_b64_tr_b16 a[232:233], v14 offset:2048
v_mfma_f32_16x16x32_bf16 v[176:179], a[228:231], a[164:167], v[176:179]
ds_read_b64_tr_b16 a[234:235], v14 offset:2304
v_mfma_f32_16x16x32_bf16 v[184:187], a[228:231], a[172:175], v[184:187]
ds_read_b64_tr_b16 a[236:237], v14 offset:6144
v_mfma_f32_16x16x32_bf16 v[184:187], a[224:227], a[168:171], v[184:187]
ds_read_b64_tr_b16 a[238:239], v14 offset:6400
v_mfma_f32_16x16x32_bf16 v[192:195], a[224:227], a[176:179], v[192:195]
v_mfma_f32_16x16x32_bf16 v[192:195], a[228:231], a[180:183], v[192:195]
v_mfma_f32_16x16x32_bf16 v[200:203], a[228:231], a[188:191], v[200:203]
v_mfma_f32_16x16x32_bf16 v[200:203], a[224:227], a[184:187], v[200:203]
v_mfma_f32_16x16x32_bf16 v[208:211], a[224:227], a[192:195], v[208:211]
v_mfma_f32_16x16x32_bf16 v[208:211], a[228:231], a[196:199], v[208:211]
v_mfma_f32_16x16x32_bf16 v[216:219], a[228:231], a[204:207], v[216:219]
v_mfma_f32_16x16x32_bf16 v[216:219], a[224:227], a[200:203], v[216:219]
v_mfma_f32_16x16x32_bf16 v[224:227], a[224:227], a[208:211], v[224:227]
v_mfma_f32_16x16x32_bf16 v[224:227], a[228:231], a[212:215], v[224:227]
v_mfma_f32_16x16x32_bf16 v[232:235], a[228:231], a[220:223], v[232:235]
v_mfma_f32_16x16x32_bf16 v[232:235], a[224:227], a[216:219], v[232:235]
s_waitcnt vmcnt(11) lgkmcnt(0)
s_barrier
v_mfma_f32_16x16x32_bf16 v[236:239], a[232:235], a[216:219], v[236:239]
s_add_u32 m0, s76, 0
s_add_u32 s79, s36, 0
ds_read_b64_tr_b16 a[224:225], v10 offset:24576
v_mfma_f32_16x16x32_bf16 v[236:239], a[236:239], a[220:223], v[236:239]
buffer_load_dwordx4 v1, s[4:7], s79 offen lds
v_mfma_f32_16x16x32_bf16 v[228:231], a[236:239], a[212:215], v[228:231]
s_add_u32 m0, s76, 4096
s_add_u32 s79, s36, 65536
ds_read_b64_tr_b16 a[226:227], v10 offset:24832
v_mfma_f32_16x16x32_bf16 v[228:231], a[232:235], a[208:211], v[228:231]
ds_read_b64_tr_b16 a[228:229], v10 offset:28672
v_mfma_f32_16x16x32_bf16 v[220:223], a[232:235], a[200:203], v[220:223]
ds_read_b64_tr_b16 a[230:231], v10 offset:28928
v_mfma_f32_16x16x32_bf16 v[220:223], a[236:239], a[204:207], v[220:223]
ds_read_b128 v[58:61], v6 offset:32768
v_mfma_f32_16x16x32_bf16 v[212:215], a[236:239], a[196:199], v[212:215]
v_mfma_f32_16x16x32_bf16 v[212:215], a[232:235], a[192:195], v[212:215]
v_mfma_f32_16x16x32_bf16 v[204:207], a[232:235], a[184:187], v[204:207]
buffer_load_dwordx4 v1, s[4:7], s79 offen lds
v_mfma_f32_16x16x32_bf16 v[204:207], a[236:239], a[188:191], v[204:207]
s_sub_u32 s46, s46, 1
ds_read_b64_tr_b16 v[46:47], v78 offset:0
v_mfma_f32_16x16x32_bf16 v[196:199], a[236:239], a[180:183], v[196:199]
s_cmp_eq_u32 s46, s77
s_cbranch_scc1 L_g1_sig_1034
L_g1_sgr_1035:
ds_read_b64_tr_b16 v[48:49], v78 offset:512
v_mfma_f32_16x16x32_bf16 v[196:199], a[232:235], a[176:179], v[196:199]
s_add_u32 m0, s76, 8192
s_add_u32 s79, s36, 131072
ds_read_b128 v[62:65], v7 offset:32768
v_mfma_f32_16x16x32_bf16 v[188:191], a[232:235], a[168:171], v[188:191]
v_mfma_f32_16x16x32_bf16 v[188:191], a[236:239], a[172:175], v[188:191]
v_mfma_f32_16x16x32_bf16 v[180:183], a[236:239], a[164:167], v[180:183]
v_mfma_f32_16x16x32_bf16 v[180:183], a[232:235], a[160:163], v[180:183]
s_waitcnt lgkmcnt(6)
buffer_load_dwordx4 v1, s[4:7], s79 offen lds
v_mfma_f32_16x16x32_bf16 v[84:87], a[224:227], a[160:163], v[84:87]
s_waitcnt lgkmcnt(4)
s_add_u32 m0, s76, 12288
ds_read_b64_tr_b16 a[232:233], v11 offset:24576
v_mfma_f32_16x16x32_bf16 v[84:87], a[228:231], a[164:167], v[84:87]
s_add_u32 s79, s36, 196608
ds_read_b64_tr_b16 a[234:235], v11 offset:24832
v_mfma_f32_16x16x32_bf16 v[100:103], a[228:231], a[172:175], v[100:103]
ds_read_b64_tr_b16 a[236:237], v11 offset:28672
v_mfma_f32_16x16x32_bf16 v[100:103], a[224:227], a[168:171], v[100:103]
ds_read_b64_tr_b16 a[238:239], v11 offset:28928
v_mfma_f32_16x16x32_bf16 v[244:247], a[224:227], a[176:179], v[244:247]
ds_read_b128 v[70:73], v7 offset:34816
v_mfma_f32_16x16x32_bf16 v[244:247], a[228:231], a[180:183], v[244:247]
v_mfma_f32_16x16x32_bf16 v[116:119], a[228:231], a[188:191], v[116:119]
buffer_load_dwordx4 v1, s[4:7], s79 offen lds
v_mfma_f32_16x16x32_bf16 v[116:119], a[224:227], a[184:187], v[116:119]
s_add_u32 m0, s76, 16384
s_add_u32 s79, s36, 262144
v_mfma_f32_16x16x32_bf16 v[132:135], a[224:227], a[192:195], v[132:135]
ds_read_b64_tr_b16 v[50:51], v78 offset:4096
v_mfma_f32_16x16x32_bf16 v[132:135], a[228:231], a[196:199], v[132:135]
ds_read_b64_tr_b16 v[52:53], v78 offset:4608
v_mfma_f32_16x16x32_bf16 a[4:7], a[228:231], a[204:207], a[4:7]
ds_read_b128 v[66:69], v6 offset:34816
v_mfma_f32_16x16x32_bf16 a[4:7], a[224:227], a[200:203], a[4:7]
v_mfma_f32_16x16x32_bf16 a[20:23], a[224:227], a[208:211], a[20:23]
v_mfma_f32_16x16x32_bf16 a[20:23], a[228:231], a[212:215], a[20:23]
buffer_load_dwordx4 v1, s[4:7], s79 offen lds
v_mfma_f32_16x16x32_bf16 a[36:39], a[228:231], a[220:223], a[36:39]
s_add_u32 m0, s76, 20480
s_add_u32 s79, s36, 327680
v_mfma_f32_16x16x32_bf16 a[36:39], a[224:227], a[216:219], a[36:39]
s_waitcnt lgkmcnt(6)
v_mfma_f32_16x16x32_bf16 a[44:47], a[232:235], a[216:219], a[44:47]
s_waitcnt lgkmcnt(4)
ds_read_b64_tr_b16 a[224:225], v10 offset:25088
v_mfma_f32_16x16x32_bf16 a[44:47], a[236:239], a[220:223], a[44:47]
ds_read_b64_tr_b16 a[226:227], v10 offset:25344
v_mfma_f32_16x16x32_bf16 a[28:31], a[236:239], a[212:215], a[28:31]
ds_read_b64_tr_b16 a[228:229], v10 offset:29184
v_mfma_f32_16x16x32_bf16 a[28:31], a[232:235], a[208:211], a[28:31]
ds_read_b64_tr_b16 a[230:231], v10 offset:29440
v_mfma_f32_16x16x32_bf16 a[12:15], a[232:235], a[200:203], a[12:15]
buffer_load_dwordx4 v1, s[4:7], s79 offen lds
v_mfma_f32_16x16x32_bf16 a[12:15], a[236:239], a[204:207], a[12:15]
s_add_u32 m0, s76, 24576
s_add_u32 s79, s36, 393216
ds_read_b128 a[240:243], v6 offset:36864
v_mfma_f32_16x16x32_bf16 v[140:143], a[236:239], a[196:199], v[140:143]
v_mfma_f32_16x16x32_bf16 v[140:143], a[232:235], a[192:195], v[140:143]
ds_read_b128 a[244:247], v7 offset:36864
v_mfma_f32_16x16x32_bf16 v[124:127], a[232:235], a[184:187], v[124:127]
v_mfma_f32_16x16x32_bf16 v[124:127], a[236:239], a[188:191], v[124:127]
v_mfma_f32_16x16x32_bf16 v[252:255], a[236:239], a[180:183], v[252:255]
v_mfma_f32_16x16x32_bf16 v[252:255], a[232:235], a[176:179], v[252:255]
buffer_load_dwordx4 v1, s[4:7], s79 offen lds
v_mfma_f32_16x16x32_bf16 v[108:111], a[232:235], a[168:171], v[108:111]
s_add_u32 m0, s76, 28672
s_add_u32 s79, s36, 458752
v_mfma_f32_16x16x32_bf16 v[108:111], a[236:239], a[172:175], v[108:111]
v_mfma_f32_16x16x32_bf16 v[92:95], a[236:239], a[164:167], v[92:95]
ds_read_b128 a[252:255], v7 offset:38912
v_mfma_f32_16x16x32_bf16 v[92:95], a[232:235], a[160:163], v[92:95]
s_waitcnt lgkmcnt(5)
v_mfma_f32_16x16x32_bf16 a[52:55], a[224:227], a[160:163], a[52:55]
s_waitcnt lgkmcnt(3)
ds_read_b64_tr_b16 a[232:233], v11 offset:25088
v_mfma_f32_16x16x32_bf16 a[52:55], a[228:231], a[164:167], a[52:55]
ds_read_b64_tr_b16 a[234:235], v11 offset:25344
v_mfma_f32_16x16x32_bf16 a[68:71], a[228:231], a[172:175], a[68:71]
buffer_load_dwordx4 v1, s[4:7], s79 offen lds
v_mfma_f32_16x16x32_bf16 a[68:71], a[224:227], a[168:171], a[68:71]
s_add_u32 s36, s36, 128
s_add_u32 m0, s76, 65536
ds_read_b64_tr_b16 a[236:237], v11 offset:29184
v_mfma_f32_16x16x32_bf16 a[84:87], a[224:227], a[176:179], a[84:87]
ds_read_b64_tr_b16 a[238:239], v11 offset:29440
v_mfma_f32_16x16x32_bf16 a[84:87], a[228:231], a[180:183], a[84:87]
ds_read_b128 a[248:251], v6 offset:38912
v_mfma_f32_16x16x32_bf16 a[100:103], a[228:231], a[188:191], a[100:103]
v_mfma_f32_16x16x32_bf16 a[100:103], a[224:227], a[184:187], a[100:103]
v_mfma_f32_16x16x32_bf16 a[116:119], a[224:227], a[192:195], a[116:119]
v_mfma_f32_16x16x32_bf16 a[116:119], a[228:231], a[196:199], a[116:119]
buffer_load_dwordx4 v2, s[8:11], s38 offen lds
v_mfma_f32_16x16x32_bf16 a[132:135], a[228:231], a[204:207], a[132:135]
s_add_u32 m0, s76, 73600
v_mfma_f32_16x16x32_bf16 a[132:135], a[224:227], a[200:203], a[132:135]
v_mfma_f32_16x16x32_bf16 v[148:151], a[224:227], a[208:211], v[148:151]
v_mfma_f32_16x16x32_bf16 v[148:151], a[228:231], a[212:215], v[148:151]
v_mfma_f32_16x16x32_bf16 v[164:167], a[228:231], a[220:223], v[164:167]
v_mfma_f32_16x16x32_bf16 v[164:167], a[224:227], a[216:219], v[164:167]
s_waitcnt vmcnt(10) lgkmcnt(1)
s_barrier
v_mfma_f32_16x16x32_bf16 v[172:175], a[232:235], a[216:219], v[172:175]
buffer_load_dwordx4 v2, s[8:11], s38 offen offset:128 lds
v_mfma_f32_16x16x32_bf16 v[172:175], a[236:239], a[220:223], v[172:175]
s_add_u32 m0, s76, 81920
ds_read_b64_tr_b16 a[224:225], v12 offset:0
v_mfma_f32_16x16x32_bf16 v[156:159], a[236:239], a[212:215], v[156:159]
ds_read_b64_tr_b16 a[226:227], v12 offset:256
v_mfma_f32_16x16x32_bf16 v[156:159], a[232:235], a[208:211], v[156:159]
ds_read_b64_tr_b16 a[228:229], v12 offset:4096
v_mfma_f32_16x16x32_bf16 a[140:143], a[232:235], a[200:203], a[140:143]
ds_read_b64_tr_b16 a[230:231], v12 offset:4352
v_mfma_f32_16x16x32_bf16 a[140:143], a[236:239], a[204:207], a[140:143]
v_mfma_f32_16x16x32_bf16 a[124:127], a[236:239], a[196:199], a[124:127]
v_mfma_f32_16x16x32_bf16 a[124:127], a[232:235], a[192:195], a[124:127]
buffer_load_dwordx4 v3, s[16:19], s39 offen lds
v_mfma_f32_16x16x32_bf16 a[108:111], a[232:235], a[184:187], a[108:111]
s_add_u32 m0, s76, 69632
s_add_u32 s79, s38, 229376
ds_read_b128 a[192:195], v6 offset:40960
v_mfma_f32_16x16x32_bf16 a[108:111], a[236:239], a[188:191], a[108:111]
ds_read_b128 a[196:199], v7 offset:40960
v_mfma_f32_16x16x32_bf16 a[92:95], a[236:239], a[180:183], a[92:95]
ds_read_b128 a[204:207], v7 offset:43008
v_mfma_f32_16x16x32_bf16 a[92:95], a[232:235], a[176:179], a[92:95]
ds_read_b128 a[200:203], v6 offset:43008
v_mfma_f32_16x16x32_bf16 a[76:79], a[232:235], a[168:171], a[76:79]
ds_read_b128 a[208:211], v6 offset:45056
v_mfma_f32_16x16x32_bf16 a[76:79], a[236:239], a[172:175], a[76:79]
ds_read_b128 a[212:215], v7 offset:45056
v_mfma_f32_16x16x32_bf16 a[60:63], a[236:239], a[164:167], a[60:63]
buffer_load_dwordx4 v2, s[8:11], s79 offen lds
v_mfma_f32_16x16x32_bf16 a[60:63], a[232:235], a[160:163], a[60:63]
s_waitcnt lgkmcnt(8)
s_add_u32 m0, s76, 77696
v_mfma_f32_16x16x32_bf16 v[80:83], a[224:227], v[58:61], v[80:83]
s_waitcnt lgkmcnt(6)
ds_read_b128 a[220:223], v7 offset:47104
v_mfma_f32_16x16x32_bf16 v[80:83], a[228:231], v[62:65], v[80:83]
ds_read_b128 a[216:219], v6 offset:47104
v_mfma_f32_16x16x32_bf16 v[96:99], a[228:231], v[70:73], v[96:99]
ds_read_b64_tr_b16 a[232:233], v13 offset:0
v_mfma_f32_16x16x32_bf16 v[96:99], a[224:227], v[66:69], v[96:99]
ds_read_b64_tr_b16 a[234:235], v13 offset:256
v_mfma_f32_16x16x32_bf16 v[240:243], a[224:227], a[240:243], v[240:243]
ds_read_b64_tr_b16 a[236:237], v13 offset:4096
v_mfma_f32_16x16x32_bf16 v[240:243], a[228:231], a[244:247], v[240:243]
buffer_load_dwordx4 v2, s[8:11], s79 offen offset:128 lds
v_mfma_f32_16x16x32_bf16 v[112:115], a[228:231], a[252:255], v[112:115]
s_add_u32 m0, s76, 86016
s_add_u32 s79, s39, 229376
ds_read_b64_tr_b16 a[238:239], v13 offset:4352
v_mfma_f32_16x16x32_bf16 v[112:115], a[224:227], a[248:251], v[112:115]
s_waitcnt lgkmcnt(11)
v_mfma_f32_16x16x32_bf16 v[128:131], a[224:227], a[192:195], v[128:131]
s_waitcnt lgkmcnt(10)
v_mfma_f32_16x16x32_bf16 v[128:131], a[228:231], a[196:199], v[128:131]
s_waitcnt lgkmcnt(9)
v_mfma_f32_16x16x32_bf16 a[0:3], a[228:231], a[204:207], a[0:3]
s_waitcnt lgkmcnt(8)
v_mfma_f32_16x16x32_bf16 a[0:3], a[224:227], a[200:203], a[0:3]
s_waitcnt lgkmcnt(7)
v_mfma_f32_16x16x32_bf16 a[16:19], a[224:227], a[208:211], a[16:19]
s_waitcnt lgkmcnt(6)
buffer_load_dwordx4 v3, s[16:19], s79 offen lds
v_mfma_f32_16x16x32_bf16 a[16:19], a[228:231], a[212:215], a[16:19]
s_waitcnt lgkmcnt(5)
s_add_u32 s39, s39, 458752
s_add_u32 m0, s76, 90112
v_mfma_f32_16x16x32_bf16 a[32:35], a[228:231], a[220:223], a[32:35]
s_waitcnt lgkmcnt(4)
v_mfma_f32_16x16x32_bf16 a[32:35], a[224:227], a[216:219], a[32:35]
s_waitcnt lgkmcnt(2)
v_mfma_f32_16x16x32_bf16 a[40:43], a[232:235], a[216:219], a[40:43]
s_waitcnt lgkmcnt(0)
ds_read_b64_tr_b16 a[224:225], v12 offset:512
v_mfma_f32_16x16x32_bf16 a[40:43], a[236:239], a[220:223], a[40:43]
ds_read_b64_tr_b16 a[226:227], v12 offset:768
v_mfma_f32_16x16x32_bf16 a[24:27], a[236:239], a[212:215], a[24:27]
ds_read_b64_tr_b16 a[228:229], v12 offset:4608
v_mfma_f32_16x16x32_bf16 a[24:27], a[232:235], a[208:211], a[24:27]
buffer_load_dwordx4 v2, s[12:15], s38 offen lds
v_mfma_f32_16x16x32_bf16 a[8:11], a[232:235], a[200:203], a[8:11]
s_add_u32 m0, s76, 98176
ds_read_b64_tr_b16 a[230:231], v12 offset:4864
v_mfma_f32_16x16x32_bf16 a[8:11], a[236:239], a[204:207], a[8:11]
v_mfma_f32_16x16x32_bf16 v[136:139], a[236:239], a[196:199], v[136:139]
ds_read_b64_tr_b16 a[148:149], v8 offset:40960
v_mfma_f32_16x16x32_bf16 v[136:139], a[232:235], a[192:195], v[136:139]
ds_read_b64_tr_b16 a[150:151], v8 offset:41216
v_mfma_f32_16x16x32_bf16 v[120:123], a[232:235], a[248:251], v[120:123]
v_mfma_f32_16x16x32_bf16 v[120:123], a[236:239], a[252:255], v[120:123]
v_mfma_f32_16x16x32_bf16 v[248:251], a[236:239], a[244:247], v[248:251]
buffer_load_dwordx4 v2, s[12:15], s38 offen offset:128 lds
v_mfma_f32_16x16x32_bf16 v[248:251], a[232:235], a[240:243], v[248:251]
s_add_u32 m0, s76, 94208
s_add_u32 s79, s38, 229376
v_mfma_f32_16x16x32_bf16 v[104:107], a[232:235], v[66:69], v[104:107]
v_mfma_f32_16x16x32_bf16 v[104:107], a[236:239], v[70:73], v[104:107]
v_mfma_f32_16x16x32_bf16 v[88:91], a[236:239], v[62:65], v[88:91]
v_mfma_f32_16x16x32_bf16 v[88:91], a[232:235], v[58:61], v[88:91]
s_waitcnt lgkmcnt(4)
v_mfma_f32_16x16x32_bf16 a[48:51], a[224:227], v[58:61], a[48:51]
s_waitcnt lgkmcnt(2)
ds_read_b64_tr_b16 a[232:233], v13 offset:512
v_mfma_f32_16x16x32_bf16 a[48:51], a[228:231], v[62:65], a[48:51]
buffer_load_dwordx4 v2, s[12:15], s79 offen lds
v_mfma_f32_16x16x32_bf16 a[64:67], a[228:231], v[70:73], a[64:67]
s_cmp_lt_i32 s46, s58
s_cbranch_scc1 L_g1_pl_1036
L_g1_plr_1037:
ds_read_b64_tr_b16 a[234:235], v13 offset:768
v_mfma_f32_16x16x32_bf16 a[64:67], a[224:227], v[66:69], a[64:67]
s_add_u32 m0, s76, 102272
ds_read_b64_tr_b16 a[236:237], v13 offset:4608
v_mfma_f32_16x16x32_bf16 a[80:83], a[224:227], a[240:243], a[80:83]
ds_read_b64_tr_b16 a[238:239], v13 offset:4864
v_mfma_f32_16x16x32_bf16 a[80:83], a[228:231], a[244:247], a[80:83]
v_mfma_f32_16x16x32_bf16 a[96:99], a[228:231], a[252:255], a[96:99]
v_mfma_f32_16x16x32_bf16 a[96:99], a[224:227], a[248:251], a[96:99]
s_waitcnt lgkmcnt(4)
v_mfma_f32_16x16x32_bf16 a[144:147], a[152:155], a[148:151], a[144:147]
buffer_load_dwordx4 v2, s[12:15], s79 offen offset:128 lds
v_mfma_f32_16x16x32_bf16 a[112:115], a[224:227], a[192:195], a[112:115]
s_add_u32 s38, s38, 458752
s_add_u32 m0, s76, 147456
v_mfma_f32_16x16x32_bf16 a[112:115], a[228:231], a[196:199], a[112:115]
ds_read_b64_tr_b16 a[148:149], v8 offset:45056
v_mfma_f32_16x16x32_bf16 a[128:131], a[228:231], a[204:207], a[128:131]
ds_read_b64_tr_b16 a[150:151], v8 offset:45312
v_mfma_f32_16x16x32_bf16 a[128:131], a[224:227], a[200:203], a[128:131]
v_mfma_f32_16x16x32_bf16 v[144:147], a[224:227], a[208:211], v[144:147]
v_mfma_f32_16x16x32_bf16 v[144:147], a[228:231], a[212:215], v[144:147]
v_mfma_f32_16x16x32_bf16 v[160:163], a[228:231], a[220:223], v[160:163]
buffer_load_dwordx4 v4, s[60:63], s68 offen nt lds
v_mfma_f32_16x16x32_bf16 v[160:163], a[224:227], a[216:219], v[160:163]
s_waitcnt lgkmcnt(4)
s_add_u32 s68, s68, 0x20000
v_and_b32_e64 v76, 32, v0
v_mfma_f32_16x16x32_bf16 v[168:171], a[232:235], a[216:219], v[168:171]
s_waitcnt lgkmcnt(2)
s_lshl_b32 s79, s58, 14
ds_read_b64_tr_b16 a[224:225], v14 offset:40960
v_mfma_f32_16x16x32_bf16 v[168:171], a[236:239], a[220:223], v[168:171]
ds_read_b64_tr_b16 a[226:227], v14 offset:41216
v_mfma_f32_16x16x32_bf16 v[152:155], a[236:239], a[212:215], v[152:155]
ds_read_b64_tr_b16 a[228:229], v14 offset:45056
v_mfma_f32_16x16x32_bf16 v[152:155], a[232:235], a[208:211], v[152:155]
ds_read_b64_tr_b16 a[230:231], v14 offset:45312
v_mfma_f32_16x16x32_bf16 a[136:139], a[232:235], a[200:203], a[136:139]
s_cmp_eq_u32 s46, 4
s_cselect_b32 s79, s79, 0
s_cselect_b32 s78, -512, 0
v_mfma_f32_16x16x32_bf16 a[136:139], a[236:239], a[204:207], a[136:139]
s_add_u32 s79, s79, s68
v_mad_i32_i24 v76, v76, s78, v4
s_add_u32 m0, s76, 151552
v_mfma_f32_16x16x32_bf16 a[120:123], a[236:239], a[196:199], a[120:123]
buffer_load_dwordx4 v76, s[60:63], s79 offen nt lds
v_mfma_f32_16x16x32_bf16 a[120:123], a[232:235], a[192:195], a[120:123]
s_waitcnt lgkmcnt(4)
s_add_u32 s68, s68, 0x20000
v_mfma_f32_16x16x32_bf16 a[144:147], a[152:155], a[148:151], a[144:147]
v_mfma_f32_16x16x32_bf16 a[104:107], a[232:235], a[248:251], a[104:107]
v_mfma_f32_16x16x32_bf16 a[104:107], a[236:239], a[252:255], a[104:107]
v_mfma_f32_16x16x32_bf16 a[88:91], a[236:239], a[244:247], a[88:91]
v_mfma_f32_16x16x32_bf16 a[88:91], a[232:235], a[240:243], a[88:91]
v_mfma_f32_16x16x32_bf16 a[72:75], a[232:235], v[66:69], a[72:75]
buffer_store_dwordx4 v[46:49], v79, s[64:67], s69 offen sc1
v_mfma_f32_16x16x32_bf16 a[72:75], a[236:239], v[70:73], a[72:75]
s_add_u32 s69, s69, 0x100000
v_mfma_f32_16x16x32_bf16 a[56:59], a[236:239], v[62:65], a[56:59]
v_mfma_f32_16x16x32_bf16 a[56:59], a[232:235], v[58:61], a[56:59]
s_waitcnt lgkmcnt(2)
v_mfma_f32_16x16x32_bf16 v[176:179], a[224:227], v[58:61], v[176:179]
s_waitcnt lgkmcnt(0)
ds_read_b64_tr_b16 a[232:233], v14 offset:43008
v_mfma_f32_16x16x32_bf16 v[176:179], a[228:231], v[62:65], v[176:179]
ds_read_b64_tr_b16 a[234:235], v14 offset:43264
v_mfma_f32_16x16x32_bf16 v[184:187], a[228:231], v[70:73], v[184:187]
ds_read_b64_tr_b16 a[236:237], v14 offset:47104
v_mfma_f32_16x16x32_bf16 v[184:187], a[224:227], v[66:69], v[184:187]
buffer_store_dwordx4 v[50:53], v79, s[64:67], s69 offen sc1
v_mfma_f32_16x16x32_bf16 v[192:195], a[224:227], a[240:243], v[192:195]
s_add_u32 s69, s69, 0x100000
ds_read_b64_tr_b16 a[238:239], v14 offset:47360
v_mfma_f32_16x16x32_bf16 v[192:195], a[228:231], a[244:247], v[192:195]
v_mfma_f32_16x16x32_bf16 v[200:203], a[228:231], a[252:255], v[200:203]
v_mfma_f32_16x16x32_bf16 v[200:203], a[224:227], a[248:251], v[200:203]
v_mfma_f32_16x16x32_bf16 v[208:211], a[224:227], a[192:195], v[208:211]
v_mfma_f32_16x16x32_bf16 v[208:211], a[228:231], a[196:199], v[208:211]
v_mfma_f32_16x16x32_bf16 v[216:219], a[228:231], a[204:207], v[216:219]
v_mfma_f32_16x16x32_bf16 v[216:219], a[224:227], a[200:203], v[216:219]
v_mfma_f32_16x16x32_bf16 v[224:227], a[224:227], a[208:211], v[224:227]
v_mfma_f32_16x16x32_bf16 v[224:227], a[228:231], a[212:215], v[224:227]
v_mfma_f32_16x16x32_bf16 v[232:235], a[228:231], a[220:223], v[232:235]
v_mfma_f32_16x16x32_bf16 v[232:235], a[224:227], a[216:219], v[232:235]
s_waitcnt vmcnt(14) lgkmcnt(0)
s_barrier
v_mfma_f32_16x16x32_bf16 v[236:239], a[232:235], a[216:219], v[236:239]
s_sub_u32 s56, s56, 1
ds_read_b64_tr_b16 a[224:225], v12 offset:24576
v_mfma_f32_16x16x32_bf16 v[236:239], a[236:239], a[220:223], v[236:239]
s_cmp_eq_u32 s56, 0
s_cselect_b32 s78, -960, 64
ds_read_b64_tr_b16 a[226:227], v12 offset:24832
v_mfma_f32_16x16x32_bf16 v[228:231], a[236:239], a[212:215], v[228:231]
s_add_u32 m0, s76, 32768
s_add_u32 s79, s36, 0
ds_read_b64_tr_b16 a[228:229], v12 offset:28672
v_mfma_f32_16x16x32_bf16 v[228:231], a[232:235], a[208:211], v[228:231]
buffer_load_dwordx4 v1, s[4:7], s79 offen lds
v_mfma_f32_16x16x32_bf16 v[220:223], a[232:235], a[200:203], v[220:223]
s_add_u32 m0, s76, 36864
s_add_u32 s79, s36, 65536
ds_read_b64_tr_b16 a[230:231], v12 offset:28928
v_mfma_f32_16x16x32_bf16 v[220:223], a[236:239], a[204:207], v[220:223]
ds_read_b128 a[160:163], v6 offset:0
v_mfma_f32_16x16x32_bf16 v[212:215], a[236:239], a[196:199], v[212:215]
v_mfma_f32_16x16x32_bf16 v[212:215], a[232:235], a[192:195], v[212:215]
v_mfma_f32_16x16x32_bf16 v[204:207], a[232:235], a[248:251], v[204:207]
v_mfma_f32_16x16x32_bf16 v[204:207], a[236:239], a[252:255], v[204:207]
v_mfma_f32_16x16x32_bf16 v[196:199], a[236:239], a[244:247], v[196:199]
buffer_load_dwordx4 v1, s[4:7], s79 offen lds
v_mfma_f32_16x16x32_bf16 v[196:199], a[232:235], a[240:243], v[196:199]
s_add_u32 m0, s76, 40960
s_add_u32 s79, s36, 131072
ds_read_b128 a[164:167], v7 offset:0
v_mfma_f32_16x16x32_bf16 v[188:191], a[232:235], v[66:69], v[188:191]
v_mfma_f32_16x16x32_bf16 v[188:191], a[236:239], v[70:73], v[188:191]
v_mfma_f32_16x16x32_bf16 v[180:183], a[236:239], v[62:65], v[180:183]
v_mfma_f32_16x16x32_bf16 v[180:183], a[232:235], v[58:61], v[180:183]
s_waitcnt lgkmcnt(4)
v_mfma_f32_16x16x32_bf16 v[84:87], a[224:227], v[58:61], v[84:87]
s_waitcnt lgkmcnt(2)
ds_read_b64_tr_b16 a[232:233], v13 offset:24576
v_mfma_f32_16x16x32_bf16 v[84:87], a[228:231], v[62:65], v[84:87]
buffer_load_dwordx4 v1, s[4:7], s79 offen lds
v_mfma_f32_16x16x32_bf16 v[100:103], a[228:231], v[70:73], v[100:103]
s_add_u32 m0, s76, 45056
s_add_u32 s79, s36, 196608
ds_read_b64_tr_b16 a[234:235], v13 offset:24832
v_mfma_f32_16x16x32_bf16 v[100:103], a[224:227], v[66:69], v[100:103]
ds_read_b64_tr_b16 a[236:237], v13 offset:28672
v_mfma_f32_16x16x32_bf16 v[244:247], a[224:227], a[240:243], v[244:247]
ds_read_b64_tr_b16 a[238:239], v13 offset:28928
v_mfma_f32_16x16x32_bf16 v[244:247], a[228:231], a[244:247], v[244:247]
ds_read_b128 a[172:175], v7 offset:2048
v_mfma_f32_16x16x32_bf16 v[116:119], a[228:231], a[252:255], v[116:119]
v_mfma_f32_16x16x32_bf16 v[116:119], a[224:227], a[248:251], v[116:119]
v_mfma_f32_16x16x32_bf16 v[132:135], a[224:227], a[192:195], v[132:135]
buffer_load_dwordx4 v1, s[4:7], s79 offen lds
v_mfma_f32_16x16x32_bf16 v[132:135], a[228:231], a[196:199], v[132:135]
s_add_u32 m0, s76, 49152
s_add_u32 s79, s36, 262144
ds_read_b128 a[168:171], v6 offset:2048
v_mfma_f32_16x16x32_bf16 a[4:7], a[228:231], a[204:207], a[4:7]
v_mfma_f32_16x16x32_bf16 a[4:7], a[224:227], a[200:203], a[4:7]
v_mfma_f32_16x16x32_bf16 a[20:23], a[224:227], a[208:211], a[20:23]
v_mfma_f32_16x16x32_bf16 a[20:23], a[228:231], a[212:215], a[20:23]
v_mfma_f32_16x16x32_bf16 a[36:39], a[228:231], a[220:223], a[36:39]
v_mfma_f32_16x16x32_bf16 a[36:39], a[224:227], a[216:219], a[36:39]
s_waitcnt lgkmcnt(4)
buffer_load_dwordx4 v1, s[4:7], s79 offen lds
v_mfma_f32_16x16x32_bf16 a[44:47], a[232:235], a[216:219], a[44:47]
s_waitcnt lgkmcnt(2)
s_add_u32 m0, s76, 53248
ds_read_b64_tr_b16 a[224:225], v12 offset:25088
v_mfma_f32_16x16x32_bf16 a[44:47], a[236:239], a[220:223], a[44:47]
s_add_u32 s79, s36, 327680
ds_read_b64_tr_b16 a[226:227], v12 offset:25344
v_mfma_f32_16x16x32_bf16 a[28:31], a[236:239], a[212:215], a[28:31]
ds_read_b64_tr_b16 a[228:229], v12 offset:29184
v_mfma_f32_16x16x32_bf16 a[28:31], a[232:235], a[208:211], a[28:31]
ds_read_b64_tr_b16 a[230:231], v12 offset:29440
v_mfma_f32_16x16x32_bf16 a[12:15], a[232:235], a[200:203], a[12:15]
ds_read_b128 a[176:179], v6 offset:4096
v_mfma_f32_16x16x32_bf16 a[12:15], a[236:239], a[204:207], a[12:15]
v_mfma_f32_16x16x32_bf16 v[140:143], a[236:239], a[196:199], v[140:143]
buffer_load_dwordx4 v1, s[4:7], s79 offen lds
v_mfma_f32_16x16x32_bf16 v[140:143], a[232:235], a[192:195], v[140:143]
s_add_u32 m0, s76, 57344
s_add_u32 s79, s36, 393216
ds_read_b128 a[180:183], v7 offset:4096
v_mfma_f32_16x16x32_bf16 v[124:127], a[232:235], a[248:251], v[124:127]
v_mfma_f32_16x16x32_bf16 v[124:127], a[236:239], a[252:255], v[124:127]
v_mfma_f32_16x16x32_bf16 v[252:255], a[236:239], a[244:247], v[252:255]
v_mfma_f32_16x16x32_bf16 v[252:255], a[232:235], a[240:243], v[252:255]
v_mfma_f32_16x16x32_bf16 v[108:111], a[232:235], v[66:69], v[108:111]
v_mfma_f32_16x16x32_bf16 v[108:111], a[236:239], v[70:73], v[108:111]
buffer_load_dwordx4 v1, s[4:7], s79 offen lds
v_mfma_f32_16x16x32_bf16 v[92:95], a[236:239], v[62:65], v[92:95]
s_add_u32 m0, s76, 61440
s_add_u32 s79, s36, 458752
ds_read_b128 a[188:191], v7 offset:6144
v_mfma_f32_16x16x32_bf16 v[92:95], a[232:235], v[58:61], v[92:95]
s_waitcnt lgkmcnt(5)
v_mfma_f32_16x16x32_bf16 a[52:55], a[224:227], v[58:61], a[52:55]
s_waitcnt lgkmcnt(3)
ds_read_b64_tr_b16 a[232:233], v13 offset:25088
v_mfma_f32_16x16x32_bf16 a[52:55], a[228:231], v[62:65], a[52:55]
ds_read_b64_tr_b16 a[234:235], v13 offset:25344
v_mfma_f32_16x16x32_bf16 a[68:71], a[228:231], v[70:73], a[68:71]
ds_read_b64_tr_b16 a[236:237], v13 offset:29184
v_mfma_f32_16x16x32_bf16 a[68:71], a[224:227], v[66:69], a[68:71]
ds_read_b64_tr_b16 a[238:239], v13 offset:29440
v_mfma_f32_16x16x32_bf16 a[84:87], a[224:227], a[240:243], a[84:87]
buffer_load_dwordx4 v1, s[4:7], s79 offen lds
v_mfma_f32_16x16x32_bf16 a[84:87], a[228:231], a[244:247], a[84:87]
s_lshl1_add_u32 s36, s78, s36
s_add_u32 m0, s76, 106496
ds_read_b128 a[184:187], v6 offset:6144
v_mfma_f32_16x16x32_bf16 a[100:103], a[228:231], a[252:255], a[100:103]
v_mfma_f32_16x16x32_bf16 a[100:103], a[224:227], a[248:251], a[100:103]
v_mfma_f32_16x16x32_bf16 a[116:119], a[224:227], a[192:195], a[116:119]
v_mfma_f32_16x16x32_bf16 a[116:119], a[228:231], a[196:199], a[116:119]
v_mfma_f32_16x16x32_bf16 a[132:135], a[228:231], a[204:207], a[132:135]
v_mfma_f32_16x16x32_bf16 a[132:135], a[224:227], a[200:203], a[132:135]
buffer_load_dwordx4 v2, s[8:11], s38 offen lds
v_mfma_f32_16x16x32_bf16 v[148:151], a[224:227], a[208:211], v[148:151]
s_add_u32 m0, s76, 114560
v_mfma_f32_16x16x32_bf16 v[148:151], a[228:231], a[212:215], v[148:151]
v_mfma_f32_16x16x32_bf16 v[164:167], a[228:231], a[220:223], v[164:167]
v_mfma_f32_16x16x32_bf16 v[164:167], a[224:227], a[216:219], v[164:167]
s_waitcnt vmcnt(13) lgkmcnt(1)
s_barrier
v_mfma_f32_16x16x32_bf16 v[172:175], a[232:235], a[216:219], v[172:175]
ds_read_b64_tr_b16 a[224:225], v10 offset:0
v_mfma_f32_16x16x32_bf16 v[172:175], a[236:239], a[220:223], v[172:175]
ds_read_b64_tr_b16 a[226:227], v10 offset:256
v_mfma_f32_16x16x32_bf16 v[156:159], a[236:239], a[212:215], v[156:159]
buffer_load_dwordx4 v2, s[8:11], s38 offen offset:128 lds
v_mfma_f32_16x16x32_bf16 v[156:159], a[232:235], a[208:211], v[156:159]
s_add_u32 m0, s76, 122880
ds_read_b64_tr_b16 a[228:229], v10 offset:4096
v_mfma_f32_16x16x32_bf16 a[140:143], a[232:235], a[200:203], a[140:143]
ds_read_b64_tr_b16 a[230:231], v10 offset:4352
v_mfma_f32_16x16x32_bf16 a[140:143], a[236:239], a[204:207], a[140:143]
v_mfma_f32_16x16x32_bf16 a[124:127], a[236:239], a[196:199], a[124:127]
v_mfma_f32_16x16x32_bf16 a[124:127], a[232:235], a[192:195], a[124:127]
ds_read_b128 a[192:195], v6 offset:8192
v_mfma_f32_16x16x32_bf16 a[108:111], a[232:235], a[248:251], a[108:111]
ds_read_b128 a[196:199], v7 offset:8192
v_mfma_f32_16x16x32_bf16 a[108:111], a[236:239], a[252:255], a[108:111]
buffer_load_dwordx4 v3, s[16:19], s39 offen lds
v_mfma_f32_16x16x32_bf16 a[92:95], a[236:239], a[244:247], a[92:95]
s_add_u32 m0, s76, 110592
s_add_u32 s79, s38, 229376
ds_read_b128 a[204:207], v7 offset:10240
v_mfma_f32_16x16x32_bf16 a[92:95], a[232:235], a[240:243], a[92:95]
ds_read_b128 a[200:203], v6 offset:10240
v_mfma_f32_16x16x32_bf16 a[76:79], a[232:235], v[66:69], a[76:79]
ds_read_b128 a[208:211], v6 offset:12288
v_mfma_f32_16x16x32_bf16 a[76:79], a[236:239], v[70:73], a[76:79]
ds_read_b128 a[212:215], v7 offset:12288
v_mfma_f32_16x16x32_bf16 a[60:63], a[236:239], v[62:65], a[60:63]
v_mfma_f32_16x16x32_bf16 a[60:63], a[232:235], v[58:61], a[60:63]
s_waitcnt lgkmcnt(8)
s_cmp_lg_u32 s46, 0
s_cbranch_scc1 L_g1_loop_1033
v_mfma_f32_16x16x32_bf16 v[80:83], a[224:227], a[160:163], v[80:83]
s_waitcnt lgkmcnt(6)
buffer_load_dwordx4 v2, s[8:11], s79 offen lds
v_mfma_f32_16x16x32_bf16 v[80:83], a[228:231], a[164:167], v[80:83]
s_add_u32 m0, s76, 118656
ds_read_b128 a[220:223], v7 offset:14336
v_mfma_f32_16x16x32_bf16 v[96:99], a[228:231], a[172:175], v[96:99]
ds_read_b128 a[216:219], v6 offset:14336
v_mov_b32_e64 v36, 0
v_mfma_f32_16x16x32_bf16 v[96:99], a[224:227], a[168:171], v[96:99]
ds_read_b64_tr_b16 a[232:233], v11 offset:0
v_mfma_f32_16x16x32_bf16 v[240:243], a[224:227], a[176:179], v[240:243]
ds_read_b64_tr_b16 a[234:235], v11 offset:256
v_mfma_f32_16x16x32_bf16 v[240:243], a[228:231], a[180:183], v[240:243]
ds_read_b64_tr_b16 a[236:237], v11 offset:4096
v_mov_b32_e64 v37, 0
v_mfma_f32_16x16x32_bf16 v[112:115], a[228:231], a[188:191], v[112:115]
ds_read_b64_tr_b16 a[238:239], v11 offset:4352
v_mfma_f32_16x16x32_bf16 v[112:115], a[224:227], a[184:187], v[112:115]
s_waitcnt lgkmcnt(11)
buffer_load_dwordx4 v2, s[8:11], s79 offen offset:128 lds
v_mfma_f32_16x16x32_bf16 v[128:131], a[224:227], a[192:195], v[128:131]
s_waitcnt lgkmcnt(10)
s_add_u32 m0, s76, 126976
ds_read_b32 v16, v17 offset:0
v_mfma_f32_16x16x32_bf16 v[128:131], a[228:231], a[196:199], v[128:131]
s_waitcnt lgkmcnt(10)
s_add_u32 s79, s39, 229376
v_mov_b32 v51, 0
v_mfma_f32_16x16x32_bf16 a[0:3], a[228:231], a[204:207], a[0:3]
s_waitcnt lgkmcnt(9)
v_mfma_f32_16x16x32_bf16 a[0:3], a[224:227], a[200:203], a[0:3]
s_waitcnt lgkmcnt(8)
v_mfma_f32_16x16x32_bf16 a[16:19], a[224:227], a[208:211], a[16:19]
s_waitcnt lgkmcnt(7)
v_mov_b32 v52, 0
v_mfma_f32_16x16x32_bf16 a[16:19], a[228:231], a[212:215], a[16:19]
s_waitcnt lgkmcnt(6)
v_mfma_f32_16x16x32_bf16 a[32:35], a[228:231], a[220:223], a[32:35]
s_waitcnt lgkmcnt(5)
buffer_load_dwordx4 v3, s[16:19], s79 offen lds
v_mfma_f32_16x16x32_bf16 a[32:35], a[224:227], a[216:219], a[32:35]
s_waitcnt lgkmcnt(3)
s_mul_i32 s55, s78, 7168
s_add_u32 s39, s39, s55
v_mfma_f32_16x16x32_bf16 a[40:43], a[232:235], a[216:219], a[40:43]
s_waitcnt lgkmcnt(1)
s_add_u32 m0, s76, 131072
ds_read_b64_tr_b16 a[224:225], v10 offset:512
v_mfma_f32_16x16x32_bf16 a[40:43], a[236:239], a[220:223], a[40:43]
ds_read_b64_tr_b16 a[226:227], v10 offset:768
v_mov_b32 v53, 0
v_mfma_f32_16x16x32_bf16 a[24:27], a[236:239], a[212:215], a[24:27]
ds_read_b64_tr_b16 a[228:229], v10 offset:4608
v_mfma_f32_16x16x32_bf16 a[24:27], a[232:235], a[208:211], a[24:27]
ds_read_b64_tr_b16 a[230:231], v10 offset:4864
v_mov_b32_e64 v55, 0
v_mfma_f32_16x16x32_bf16 a[8:11], a[232:235], a[200:203], a[8:11]
v_mfma_f32_16x16x32_bf16 a[8:11], a[236:239], a[204:207], a[8:11]
buffer_load_dwordx4 v2, s[12:15], s38 offen lds
v_mfma_f32_16x16x32_bf16 v[136:139], a[236:239], a[196:199], v[136:139]
s_add_u32 m0, s76, 139136
ds_read_b64_tr_b16 a[148:149], v8 offset:0
v_mfma_f32_16x16x32_bf16 v[136:139], a[232:235], a[192:195], v[136:139]
ds_read_b64_tr_b16 a[150:151], v8 offset:256
v_mov_b32_e64 v56, 0
v_mfma_f32_16x16x32_bf16 v[120:123], a[232:235], a[184:187], v[120:123]
s_and_b32 s71, s3, 7
v_mfma_f32_16x16x32_bf16 v[120:123], a[236:239], a[188:191], v[120:123]
v_mfma_f32_16x16x32_bf16 v[248:251], a[236:239], a[180:183], v[248:251]
s_lshl_b32 s71, s71, 16
v_mov_b32_e64 v57, 0
v_mfma_f32_16x16x32_bf16 v[248:251], a[232:235], a[176:179], v[248:251]
v_mfma_f32_16x16x32_bf16 v[104:107], a[232:235], a[168:171], v[104:107]
buffer_load_dwordx4 v2, s[12:15], s38 offen offset:128 lds
v_mfma_f32_16x16x32_bf16 v[104:107], a[236:239], a[172:175], v[104:107]
s_add_u32 m0, s76, 135168
s_add_u32 s79, s38, 229376
s_xor_b32 s70, s70, s71
v_mfma_f32_16x16x32_bf16 v[88:91], a[236:239], a[164:167], v[88:91]
s_lshl_b32 s71, s43, 14
v_mfma_f32_16x16x32_bf16 v[88:91], a[232:235], a[160:163], v[88:91]
s_waitcnt lgkmcnt(4)
v_mfma_f32_16x16x32_bf16 a[48:51], a[224:227], a[160:163], a[48:51]
s_waitcnt lgkmcnt(2)
ds_read_b64_tr_b16 a[232:233], v11 offset:512
v_mfma_f32_16x16x32_bf16 a[48:51], a[228:231], a[164:167], a[48:51]
ds_read_b64_tr_b16 a[234:235], v11 offset:768
s_add_u32 s70, s70, s71
v_mfma_f32_16x16x32_bf16 a[64:67], a[228:231], a[172:175], a[64:67]
ds_read_b64_tr_b16 a[236:237], v11 offset:4608
v_mfma_f32_16x16x32_bf16 a[64:67], a[224:227], a[168:171], a[64:67]
buffer_load_dwordx4 v2, s[12:15], s79 offen lds
v_mfma_f32_16x16x32_bf16 a[80:83], a[224:227], a[176:179], a[80:83]
s_add_u32 m0, s76, 143232
ds_read_b64_tr_b16 a[238:239], v11 offset:4864
s_mov_b32 s72, s64
v_mfma_f32_16x16x32_bf16 a[80:83], a[228:231], a[180:183], a[80:83]
s_getpc_b64 s[60:61]
L_g1_pc_1032:
s_sub_u32 s60, s60, L_g1_pc_1032-L_code_start
s_subb_u32 s61, s61, 0
v_mfma_f32_16x16x32_bf16 a[96:99], a[228:231], a[188:191], a[96:99]
s_mov_b32 s73, s65
s_lshr_b32 s40, s2, 3
v_mfma_f32_16x16x32_bf16 a[96:99], a[224:227], a[184:187], a[96:99]
s_waitcnt lgkmcnt(4)
v_mfma_f32_16x16x32_bf16 a[144:147], a[152:155], a[148:151], a[144:147]
s_mov_b32 s75, 0x00020000
v_mfma_f32_16x16x32_bf16 a[112:115], a[224:227], a[192:195], a[112:115]
s_mul_i32 s40, s40, ((L_code_end-L_code_start+4095)>>12)<<7
v_mfma_f32_16x16x32_bf16 a[112:115], a[228:231], a[196:199], a[112:115]
buffer_load_dwordx4 v2, s[12:15], s79 offen offset:128 lds
v_mfma_f32_16x16x32_bf16 a[128:131], a[228:231], a[204:207], a[128:131]
s_mul_i32 s55, s78, 7168
s_add_u32 s38, s38, s55
ds_read_b64_tr_b16 a[148:149], v8 offset:4096
v_mfma_f32_16x16x32_bf16 a[128:131], a[224:227], a[200:203], a[128:131]
s_cmp_ge_u32 s47, 7340032
s_cselect_b32 s78, 7340032, 0
ds_read_b64_tr_b16 a[150:151], v8 offset:4352
v_mfma_f32_16x16x32_bf16 v[144:147], a[224:227], a[208:211], v[144:147]
s_sub_u32 s47, s47, s78
s_cmp_lt_u32 s46, 2
s_cselect_b32 s34, 0, s34
v_mfma_f32_16x16x32_bf16 v[144:147], a[228:231], a[212:215], v[144:147]
v_lshlrev_b32 v15, 7, v0
v_min_u32 v75, ((L_code_end-L_code_start+4095)>>12)-1, v0
v_mfma_f32_16x16x32_bf16 v[160:163], a[228:231], a[220:223], v[160:163]
v_cmp_gt_u32 vcc, 32, v16
v_mfma_f32_16x16x32_bf16 v[160:163], a[224:227], a[216:219], v[160:163]
s_waitcnt lgkmcnt(4)
v_lshl_add_u32 v75, v75, 7, s40
v_mfma_f32_16x16x32_bf16 v[168:171], a[232:235], a[216:219], v[168:171]
s_waitcnt lgkmcnt(2)
buffer_load_dword v19, v18, s[32:35], s47 offen
v_mfma_f32_16x16x32_bf16 v[168:171], a[236:239], a[220:223], v[168:171]
s_add_u32 s47, s47, 917504
ds_read_b64_tr_b16 a[224:225], v14 offset:0
v_min_u32 v75, L_code_end-L_code_start-4, v75
v_mfma_f32_16x16x32_bf16 v[152:155], a[236:239], a[212:215], v[152:155]
ds_read_b64_tr_b16 a[226:227], v14 offset:256
v_mfma_f32_16x16x32_bf16 v[152:155], a[232:235], a[208:211], v[152:155]
ds_read_b64_tr_b16 a[228:229], v14 offset:4096
v_mfma_f32_16x16x32_bf16 a[136:139], a[232:235], a[200:203], a[136:139]
ds_read_b64_tr_b16 a[230:231], v14 offset:4352
v_mfma_f32_16x16x32_bf16 a[136:139], a[236:239], a[204:207], a[136:139]
s_cmp_eq_u64 vcc, 0
s_cselect_b32 s74, 0x900000, 0
s_cselect_b32 s49, 32, 0
v_mfma_f32_16x16x32_bf16 a[120:123], a[236:239], a[196:199], a[120:123]
global_load_dword v19, v75, s[60:61]
v_mfma_f32_16x16x32_bf16 a[120:123], a[232:235], a[192:195], a[120:123]
s_waitcnt lgkmcnt(4)
s_add_u32 s71, s70, 8192
v_mfma_f32_16x16x32_bf16 a[144:147], a[152:155], a[148:151], a[144:147]
v_mfma_f32_16x16x32_bf16 a[104:107], a[232:235], a[184:187], a[104:107]
v_mfma_f32_16x16x32_bf16 a[104:107], a[236:239], a[188:191], a[104:107]
v_mfma_f32_16x16x32_bf16 a[88:91], a[236:239], a[180:183], a[88:91]
v_mfma_f32_16x16x32_bf16 a[88:91], a[232:235], a[176:179], a[88:91]
v_mfma_f32_16x16x32_bf16 a[72:75], a[232:235], a[168:171], a[72:75]
s_nop 2
v_accvgpr_read_b32 v77, a144
v_mfma_f32_16x16x32_bf16 a[72:75], a[236:239], a[172:175], a[72:75]
v_mfma_f32_16x16x32_bf16 a[56:59], a[236:239], a[164:167], a[56:59]
v_or_b32 v77, 1, v77
v_mfma_f32_16x16x32_bf16 a[56:59], a[232:235], a[160:163], a[56:59]
s_waitcnt lgkmcnt(2)
v_mfma_f32_16x16x32_bf16 v[176:179], a[224:227], a[160:163], v[176:179]
s_waitcnt lgkmcnt(0)
buffer_store_dword v77, v9, s[24:27], s37 offen sc1
v_mfma_f32_16x16x32_bf16 v[176:179], a[228:231], a[164:167], v[176:179]
ds_read_b64_tr_b16 a[232:233], v14 offset:2048
v_mfma_f32_16x16x32_bf16 v[184:187], a[228:231], a[172:175], v[184:187]
ds_read_b64_tr_b16 a[234:235], v14 offset:2304
v_mfma_f32_16x16x32_bf16 v[184:187], a[224:227], a[168:171], v[184:187]
ds_read_b64_tr_b16 a[236:237], v14 offset:6144
v_mfma_f32_16x16x32_bf16 v[192:195], a[224:227], a[176:179], v[192:195]
buffer_load_dword v19, v15, s[72:75], s70 offen sc1
v_mfma_f32_16x16x32_bf16 v[192:195], a[228:231], a[180:183], v[192:195]
ds_read_b64_tr_b16 a[238:239], v14 offset:6400
v_mfma_f32_16x16x32_bf16 v[200:203], a[228:231], a[188:191], v[200:203]
v_mfma_f32_16x16x32_bf16 v[200:203], a[224:227], a[184:187], v[200:203]
v_mfma_f32_16x16x32_bf16 v[208:211], a[224:227], a[192:195], v[208:211]
buffer_load_dword v19, v15, s[72:75], s71 offen sc1
v_mfma_f32_16x16x32_bf16 v[208:211], a[228:231], a[196:199], v[208:211]
v_mfma_f32_16x16x32_bf16 v[216:219], a[228:231], a[204:207], v[216:219]
v_mfma_f32_16x16x32_bf16 v[216:219], a[224:227], a[200:203], v[216:219]
v_mfma_f32_16x16x32_bf16 v[224:227], a[224:227], a[208:211], v[224:227]
v_mfma_f32_16x16x32_bf16 v[224:227], a[228:231], a[212:215], v[224:227]
v_mfma_f32_16x16x32_bf16 v[232:235], a[228:231], a[220:223], v[232:235]
v_mfma_f32_16x16x32_bf16 v[232:235], a[224:227], a[216:219], v[232:235]
s_waitcnt vmcnt(15) lgkmcnt(0)
s_barrier
v_mfma_f32_16x16x32_bf16 v[236:239], a[232:235], a[216:219], v[236:239]
ds_read_b64_tr_b16 a[224:225], v10 offset:24576
v_mfma_f32_16x16x32_bf16 v[236:239], a[236:239], a[220:223], v[236:239]
ds_read_b64_tr_b16 a[226:227], v10 offset:24832
v_mfma_f32_16x16x32_bf16 v[228:231], a[236:239], a[212:215], v[228:231]
ds_read_b64_tr_b16 a[228:229], v10 offset:28672
v_mfma_f32_16x16x32_bf16 v[228:231], a[232:235], a[208:211], v[228:231]
ds_read_b64_tr_b16 a[230:231], v10 offset:28928
v_mfma_f32_16x16x32_bf16 v[220:223], a[232:235], a[200:203], v[220:223]
v_mfma_f32_16x16x32_bf16 v[220:223], a[236:239], a[204:207], v[220:223]
ds_read_b128 v[58:61], v6 offset:32768
v_mfma_f32_16x16x32_bf16 v[212:215], a[236:239], a[196:199], v[212:215]
v_mfma_f32_16x16x32_bf16 v[212:215], a[232:235], a[192:195], v[212:215]
v_mfma_f32_16x16x32_bf16 v[204:207], a[232:235], a[184:187], v[204:207]
v_mfma_f32_16x16x32_bf16 v[204:207], a[236:239], a[188:191], v[204:207]
v_mfma_f32_16x16x32_bf16 v[196:199], a[236:239], a[180:183], v[196:199]
v_mfma_f32_16x16x32_bf16 v[196:199], a[232:235], a[176:179], v[196:199]
ds_read_b128 v[62:65], v7 offset:32768
v_mfma_f32_16x16x32_bf16 v[188:191], a[232:235], a[168:171], v[188:191]
v_mfma_f32_16x16x32_bf16 v[188:191], a[236:239], a[172:175], v[188:191]
v_mfma_f32_16x16x32_bf16 v[180:183], a[236:239], a[164:167], v[180:183]
v_mfma_f32_16x16x32_bf16 v[180:183], a[232:235], a[160:163], v[180:183]
s_waitcnt lgkmcnt(4)
v_mfma_f32_16x16x32_bf16 v[84:87], a[224:227], a[160:163], v[84:87]
s_waitcnt lgkmcnt(2)
ds_read_b64_tr_b16 a[232:233], v11 offset:24576
v_mfma_f32_16x16x32_bf16 v[84:87], a[228:231], a[164:167], v[84:87]
ds_read_b64_tr_b16 a[234:235], v11 offset:24832
v_mfma_f32_16x16x32_bf16 v[100:103], a[228:231], a[172:175], v[100:103]
ds_read_b64_tr_b16 a[236:237], v11 offset:28672
v_mfma_f32_16x16x32_bf16 v[100:103], a[224:227], a[168:171], v[100:103]
ds_read_b64_tr_b16 a[238:239], v11 offset:28928
v_mfma_f32_16x16x32_bf16 v[244:247], a[224:227], a[176:179], v[244:247]
ds_read_b128 v[70:73], v7 offset:34816
v_mfma_f32_16x16x32_bf16 v[244:247], a[228:231], a[180:183], v[244:247]
v_mfma_f32_16x16x32_bf16 v[116:119], a[228:231], a[188:191], v[116:119]
v_mfma_f32_16x16x32_bf16 v[116:119], a[224:227], a[184:187], v[116:119]
v_mfma_f32_16x16x32_bf16 v[132:135], a[224:227], a[192:195], v[132:135]
s_and_b32 s75, s2, 1
v_mfma_f32_16x16x32_bf16 v[132:135], a[228:231], a[196:199], v[132:135]
ds_read_b128 v[66:69], v6 offset:34816
s_sub_u32 s34, 0, s75
v_mfma_f32_16x16x32_bf16 a[4:7], a[228:231], a[204:207], a[4:7]
s_and_b32 s47, s34, 0x15
v_mfma_f32_16x16x32_bf16 a[4:7], a[224:227], a[200:203], a[4:7]
s_xor_b32 s47, s2, s47
v_mfma_f32_16x16x32_bf16 a[20:23], a[224:227], a[208:211], a[20:23]
s_bfe_u32 s76, s47, 0x20001
s_and_b32 s38, s3, 7
v_mfma_f32_16x16x32_bf16 a[20:23], a[228:231], a[212:215], a[20:23]
s_lshr_b32 s46, s2, 6
v_mfma_f32_16x16x32_bf16 a[36:39], a[228:231], a[220:223], a[36:39]
s_lshl_b32 s33, s46, 13
v_mfma_f32_16x16x32_bf16 a[36:39], a[224:227], a[216:219], a[36:39]
s_waitcnt lgkmcnt(4)
s_lshl_b32 s32, s76, 15
v_mfma_f32_16x16x32_bf16 a[44:47], a[232:235], a[216:219], a[44:47]
s_waitcnt lgkmcnt(2)
ds_read_b64_tr_b16 a[224:225], v10 offset:25088
s_lshl2_add_u32 s76, s76, s46
v_mfma_f32_16x16x32_bf16 a[44:47], a[236:239], a[220:223], a[44:47]
ds_read_b64_tr_b16 a[226:227], v10 offset:25344
s_bfe_u32 s77, s47, 0x30003
v_mfma_f32_16x16x32_bf16 a[28:31], a[236:239], a[212:215], a[28:31]
ds_read_b64_tr_b16 a[228:229], v10 offset:29184
s_lshl_b32 s39, s43, 12
v_mfma_f32_16x16x32_bf16 a[28:31], a[232:235], a[208:211], a[28:31]
ds_read_b64_tr_b16 a[230:231], v10 offset:29440
s_lshl1_add_u32 s46, s76, s75
v_mfma_f32_16x16x32_bf16 a[12:15], a[232:235], a[200:203], a[12:15]
ds_read_b128 a[240:243], v6 offset:36864
s_lshl_b32 s68, s46, 17
v_mfma_f32_16x16x32_bf16 a[12:15], a[236:239], a[204:207], a[12:15]
s_lshl_b32 s46, s75, 12
s_add_u32 s46, s46, s33
v_mfma_f32_16x16x32_bf16 v[140:143], a[236:239], a[196:199], v[140:143]
s_add_u32 s46, s46, s32
s_lshl_b32 s47, s38, 17
v_mfma_f32_16x16x32_bf16 v[140:143], a[232:235], a[192:195], v[140:143]
ds_read_b128 a[244:247], v7 offset:36864
s_add_u32 s46, s46, s47
v_mfma_f32_16x16x32_bf16 v[124:127], a[232:235], a[184:187], v[124:127]
s_lshl_b32 s33, s43, 20
v_mfma_f32_16x16x32_bf16 v[124:127], a[236:239], a[188:191], v[124:127]
s_add_u32 s33, s33, s46
v_mfma_f32_16x16x32_bf16 v[252:255], a[236:239], a[180:183], v[252:255]
s_xor_b32 s33, s33, 4096
s_mul_i32 s32, s43, 0x81000
v_mfma_f32_16x16x32_bf16 v[252:255], a[232:235], a[176:179], v[252:255]
s_and_b32 s32, s32, 0x101000
v_mfma_f32_16x16x32_bf16 v[108:111], a[232:235], a[168:171], v[108:111]
s_xor_b32 s32, s32, s46
v_mfma_f32_16x16x32_bf16 v[108:111], a[236:239], a[172:175], v[108:111]
s_lshl_b32 s35, s38, 6
v_mfma_f32_16x16x32_bf16 v[92:95], a[236:239], a[164:167], v[92:95]
ds_read_b128 a[252:255], v7 offset:38912
s_lshl2_add_u32 s46, s77, s43
v_mfma_f32_16x16x32_bf16 v[92:95], a[232:235], a[160:163], v[92:95]
s_waitcnt lgkmcnt(5)
s_lshl_b32 s47, s46, 6
s_add_u32 s68, s68, s47
v_mfma_f32_16x16x32_bf16 a[52:55], a[224:227], a[160:163], a[52:55]
s_waitcnt lgkmcnt(3)
ds_read_b64_tr_b16 a[232:233], v11 offset:25088
s_lshl_b32 s37, s38, 16
v_mfma_f32_16x16x32_bf16 a[52:55], a[228:231], a[164:167], a[52:55]
ds_read_b64_tr_b16 a[234:235], v11 offset:25344
s_lshl_b32 s46, s77, 13
v_mfma_f32_16x16x32_bf16 a[68:71], a[228:231], a[172:175], a[68:71]
ds_read_b64_tr_b16 a[236:237], v11 offset:29184
s_add_u32 s37, s37, s46
v_mfma_f32_16x16x32_bf16 a[68:71], a[224:227], a[168:171], a[68:71]
ds_read_b64_tr_b16 a[238:239], v11 offset:29440
s_lshl_b32 s46, s43, 11
v_mfma_f32_16x16x32_bf16 a[84:87], a[224:227], a[176:179], a[84:87]
s_add_u32 s37, s37, s46
s_mov_b32 s66, 0x900000
v_mfma_f32_16x16x32_bf16 a[84:87], a[228:231], a[180:183], a[84:87]
ds_read_b128 a[248:251], v6 offset:38912
s_lshl3_add_u32 s46, s76, s77
v_mfma_f32_16x16x32_bf16 a[100:103], a[228:231], a[188:191], a[100:103]
s_lshl1_add_u32 s46, s46, s75
v_mfma_f32_16x16x32_bf16 a[100:103], a[224:227], a[184:187], a[100:103]
s_lshl2_add_u32 s46, s46, s43
v_mfma_f32_16x16x32_bf16 a[116:119], a[224:227], a[192:195], a[116:119]
s_xor_b32 s47, s46, 4
v_mfma_f32_16x16x32_bf16 a[116:119], a[228:231], a[196:199], a[116:119]
s_lshl_b32 s70, s46, 13
s_lshl_b32 s69, s47, 13
v_mfma_f32_16x16x32_bf16 a[132:135], a[228:231], a[204:207], a[132:135]
s_lshl_b32 s72, s46, 5
v_mfma_f32_16x16x32_bf16 a[132:135], a[224:227], a[200:203], a[132:135]
s_lshl_b32 s71, s47, 5
v_mfma_f32_16x16x32_bf16 v[148:151], a[224:227], a[208:211], v[148:151]
s_lshl_b32 s73, s76, 11
v_mfma_f32_16x16x32_bf16 v[148:151], a[228:231], a[212:215], v[148:151]
s_add_u32 s73, s73, 32768
s_add_u32 s12, s20, 0x2400000
s_addc_u32 s13, s21, 0
v_mfma_f32_16x16x32_bf16 v[164:167], a[228:231], a[220:223], v[164:167]
s_mov_b32 s14, 0x800000
v_mfma_f32_16x16x32_bf16 v[164:167], a[224:227], a[216:219], v[164:167]
s_waitcnt vmcnt(5) lgkmcnt(1)
s_barrier
v_mfma_f32_16x16x32_bf16 v[172:175], a[232:235], a[216:219], v[172:175]
ds_read_b64_tr_b16 a[224:225], v12 offset:0
s_mov_b32 s15, 0x00020000
v_mfma_f32_16x16x32_bf16 v[172:175], a[236:239], a[220:223], v[172:175]
ds_read_b64_tr_b16 a[226:227], v12 offset:256
v_mfma_f32_16x16x32_bf16 v[156:159], a[236:239], a[212:215], v[156:159]
ds_read_b64_tr_b16 a[228:229], v12 offset:4096
v_mfma_f32_16x16x32_bf16 v[156:159], a[232:235], a[208:211], v[156:159]
ds_read_b64_tr_b16 a[230:231], v12 offset:4352
v_mfma_f32_16x16x32_bf16 a[140:143], a[232:235], a[200:203], a[140:143]
s_add_u32 s16, s20, 0x3c00000
s_addc_u32 s17, s21, 0
s_mov_b32 s18, 0x14000
v_mfma_f32_16x16x32_bf16 a[140:143], a[236:239], a[204:207], a[140:143]
s_mov_b32 s19, 0x00020000
s_mov_b32 s60, s20
s_mov_b32 s61, s21
v_mfma_f32_16x16x32_bf16 a[124:127], a[236:239], a[196:199], a[124:127]
s_mov_b32 s62, 0
s_mov_b32 s63, 0x00020000
s_lshl_b32 s74, s59, 12
v_mfma_f32_16x16x32_bf16 a[124:127], a[232:235], a[192:195], a[124:127]
ds_read_b128 a[192:195], v6 offset:40960
s_lshl_b32 s46, s3, 7
v_mfma_f32_16x16x32_bf16 a[108:111], a[232:235], a[184:187], a[108:111]
ds_read_b128 a[196:199], v7 offset:40960
s_add_u32 s74, s74, s46
v_mfma_f32_16x16x32_bf16 a[108:111], a[236:239], a[188:191], a[108:111]
ds_read_b128 a[204:207], v7 offset:43008
s_and_b32 s46, s45, 3
v_mfma_f32_16x16x32_bf16 a[92:95], a[236:239], a[180:183], a[92:95]
ds_read_b128 a[200:203], v6 offset:43008
s_lshl_b32 s46, s46, 4
v_mfma_f32_16x16x32_bf16 a[92:95], a[232:235], a[176:179], a[92:95]
s_add_u32 s74, s74, s46
s_add_u32 s74, s74, 32768
v_mfma_f32_16x16x32_bf16 a[76:79], a[232:235], a[168:171], a[76:79]
ds_read_b128 a[208:211], v6 offset:45056
v_mfma_f32_16x16x32_bf16 a[76:79], a[236:239], a[172:175], a[76:79]
ds_read_b128 a[212:215], v7 offset:45056
v_mfma_f32_16x16x32_bf16 a[60:63], a[236:239], a[164:167], a[60:63]
v_mfma_f32_16x16x32_bf16 a[60:63], a[232:235], a[160:163], a[60:63]
s_waitcnt lgkmcnt(8)
v_mfma_f32_16x16x32_bf16 v[80:83], a[224:227], v[58:61], v[80:83]
s_waitcnt lgkmcnt(6)
ds_read_b128 a[220:223], v7 offset:47104
s_mov_b32 s8, s100
v_mfma_f32_16x16x32_bf16 v[80:83], a[228:231], v[62:65], v[80:83]
ds_read_b128 a[216:219], v6 offset:47104
s_mov_b32 s9, s101
v_mfma_f32_16x16x32_bf16 v[96:99], a[228:231], v[70:73], v[96:99]
ds_read_b64_tr_b16 a[232:233], v13 offset:0
s_mov_b32 s10, 0x400000
v_mfma_f32_16x16x32_bf16 v[96:99], a[224:227], v[66:69], v[96:99]
ds_read_b64_tr_b16 a[234:235], v13 offset:256
s_mov_b32 s11, 0x00020000
v_mfma_f32_16x16x32_bf16 v[240:243], a[224:227], a[240:243], v[240:243]
ds_read_b64_tr_b16 a[236:237], v13 offset:4096
v_mfma_f32_16x16x32_bf16 v[240:243], a[228:231], a[244:247], v[240:243]
ds_read_b64_tr_b16 a[238:239], v13 offset:4352
v_mfma_f32_16x16x32_bf16 v[112:115], a[228:231], a[252:255], v[112:115]
v_mfma_f32_16x16x32_bf16 v[112:115], a[224:227], a[248:251], v[112:115]
v_mfma_f32_16x16x32_bf16 a[176:179], a[152:155], a[224:227], 0
v_mfma_f32_16x16x32_bf16 a[176:179], a[152:155], a[228:231], a[176:179]
s_waitcnt lgkmcnt(10)
v_mfma_f32_16x16x32_bf16 v[128:131], a[228:231], a[196:199], v[128:131]
v_mfma_f32_16x16x32_bf16 v[128:131], a[224:227], a[192:195], v[128:131]
s_waitcnt lgkmcnt(8)
v_mfma_f32_16x16x32_bf16 a[0:3], a[224:227], a[200:203], a[0:3]
v_mfma_f32_16x16x32_bf16 a[0:3], a[228:231], a[204:207], a[0:3]
s_waitcnt lgkmcnt(6)
v_mfma_f32_16x16x32_bf16 a[16:19], a[228:231], a[212:215], a[16:19]
v_mfma_f32_16x16x32_bf16 a[16:19], a[224:227], a[208:211], a[16:19]
s_waitcnt lgkmcnt(4)
v_mfma_f32_16x16x32_bf16 a[32:35], a[224:227], a[216:219], a[32:35]
v_mfma_f32_16x16x32_bf16 a[32:35], a[228:231], a[220:223], a[32:35]
s_waitcnt lgkmcnt(2)
v_mfma_f32_16x16x32_bf16 a[40:43], a[232:235], a[216:219], a[40:43]
s_waitcnt lgkmcnt(0)
ds_read_b64_tr_b16 a[224:225], v12 offset:512
v_mfma_f32_16x16x32_bf16 a[40:43], a[236:239], a[220:223], a[40:43]
ds_read_b64_tr_b16 a[226:227], v12 offset:768
v_mfma_f32_16x16x32_bf16 a[24:27], a[236:239], a[212:215], a[24:27]
ds_read_b64_tr_b16 a[228:229], v12 offset:4608
v_and_b32 v76, 15, v0
v_mfma_f32_16x16x32_bf16 a[24:27], a[232:235], a[208:211], a[24:27]
ds_read_b64_tr_b16 a[230:231], v12 offset:4864
v_mfma_f32_16x16x32_bf16 a[8:11], a[232:235], a[200:203], a[8:11]
v_mfma_f32_16x16x32_bf16 a[8:11], a[236:239], a[204:207], a[8:11]
v_lshlrev_b32_e64 v76, 3, v76
v_mfma_f32_16x16x32_bf16 v[136:139], a[236:239], a[196:199], v[136:139]
v_mfma_f32_16x16x32_bf16 v[136:139], a[232:235], a[192:195], v[136:139]
v_mfma_f32_16x16x32_bf16 a[180:183], a[152:155], a[232:235], 0
s_add_u32 s52, s44, 0
v_mfma_f32_16x16x32_bf16 a[180:183], a[152:155], a[236:239], a[180:183]
v_mfma_f32_16x16x32_bf16 v[120:123], a[236:239], a[252:255], v[120:123]
v_mfma_f32_16x16x32_bf16 v[120:123], a[232:235], a[248:251], v[120:123]
v_mfma_f32_16x16x32_bf16 v[248:251], a[232:235], a[240:243], v[248:251]
s_lshl_b32 s52, s52, 3
v_mfma_f32_16x16x32_bf16 v[248:251], a[236:239], a[244:247], v[248:251]
v_mfma_f32_16x16x32_bf16 v[104:107], a[236:239], v[70:73], v[104:107]
v_mfma_f32_16x16x32_bf16 v[104:107], a[232:235], v[66:69], v[104:107]
buffer_load_dwordx2 v[20:21], v76, s[24:27], s52 offen offset:0 sc1
v_mfma_f32_16x16x32_bf16 v[88:91], a[232:235], v[58:61], v[88:91]
v_mfma_f32_16x16x32_bf16 v[88:91], a[236:239], v[62:65], v[88:91]
s_waitcnt lgkmcnt(2)
v_mfma_f32_16x16x32_bf16 a[48:51], a[224:227], v[58:61], a[48:51]
s_waitcnt lgkmcnt(0)
buffer_load_dwordx2 v[22:23], v76, s[24:27], s52 offen offset:128 sc1
v_mfma_f32_16x16x32_bf16 a[48:51], a[228:231], v[62:65], a[48:51]
ds_read_b64_tr_b16 a[232:233], v13 offset:512
v_mfma_f32_16x16x32_bf16 a[64:67], a[228:231], v[70:73], a[64:67]
ds_read_b64_tr_b16 a[234:235], v13 offset:768
v_mfma_f32_16x16x32_bf16 a[64:67], a[224:227], v[66:69], a[64:67]
ds_read_b64_tr_b16 a[236:237], v13 offset:4608
v_mfma_f32_16x16x32_bf16 a[80:83], a[224:227], a[240:243], a[80:83]
buffer_load_dwordx2 v[24:25], v76, s[24:27], s52 offen offset:256 sc1
v_mfma_f32_16x16x32_bf16 a[80:83], a[228:231], a[244:247], a[80:83]
ds_read_b64_tr_b16 a[238:239], v13 offset:4864
v_mfma_f32_16x16x32_bf16 a[96:99], a[228:231], a[252:255], a[96:99]
v_mfma_f32_16x16x32_bf16 a[96:99], a[224:227], a[248:251], a[96:99]
buffer_load_dwordx2 v[26:27], v76, s[24:27], s52 offen offset:384 sc1
v_mfma_f32_16x16x32_bf16 a[184:187], a[152:155], a[224:227], 0
v_mfma_f32_16x16x32_bf16 a[184:187], a[152:155], a[228:231], a[184:187]
v_mfma_f32_16x16x32_bf16 a[112:115], a[228:231], a[196:199], a[112:115]
buffer_load_dwordx2 v[28:29], v76, s[24:27], s52 offen offset:512 sc1
v_mfma_f32_16x16x32_bf16 a[112:115], a[224:227], a[192:195], a[112:115]
v_mfma_f32_16x16x32_bf16 a[128:131], a[224:227], a[200:203], a[128:131]
v_mfma_f32_16x16x32_bf16 a[128:131], a[228:231], a[204:207], a[128:131]
v_mfma_f32_16x16x32_bf16 v[144:147], a[228:231], a[212:215], v[144:147]
buffer_load_dwordx2 v[30:31], v76, s[24:27], s52 offen offset:640 sc1
v_mfma_f32_16x16x32_bf16 v[144:147], a[224:227], a[208:211], v[144:147]
v_mfma_f32_16x16x32_bf16 v[160:163], a[224:227], a[216:219], v[160:163]
v_mfma_f32_16x16x32_bf16 v[160:163], a[228:231], a[220:223], v[160:163]
s_waitcnt lgkmcnt(2)
buffer_load_dwordx2 v[32:33], v76, s[24:27], s52 offen offset:768 sc1
v_mfma_f32_16x16x32_bf16 v[168:171], a[232:235], a[216:219], v[168:171]
s_waitcnt lgkmcnt(0)
ds_read_b64_tr_b16 a[224:225], v14 offset:40960
v_mfma_f32_16x16x32_bf16 v[168:171], a[236:239], a[220:223], v[168:171]
ds_read_b64_tr_b16 a[226:227], v14 offset:41216
v_mfma_f32_16x16x32_bf16 v[152:155], a[236:239], a[212:215], v[152:155]
buffer_load_dwordx2 v[34:35], v76, s[24:27], s52 offen offset:896 sc1
v_mfma_f32_16x16x32_bf16 v[152:155], a[232:235], a[208:211], v[152:155]
ds_read_b64_tr_b16 a[228:229], v14 offset:45056
v_mfma_f32_16x16x32_bf16 a[136:139], a[232:235], a[200:203], a[136:139]
ds_read_b64_tr_b16 a[230:231], v14 offset:45312
v_mfma_f32_16x16x32_bf16 a[136:139], a[236:239], a[204:207], a[136:139]
v_mfma_f32_16x16x32_bf16 a[120:123], a[236:239], a[196:199], a[120:123]
v_mfma_f32_16x16x32_bf16 a[120:123], a[232:235], a[192:195], a[120:123]
v_mfma_f32_16x16x32_bf16 a[188:191], a[152:155], a[232:235], 0
v_mfma_f32_16x16x32_bf16 a[188:191], a[152:155], a[236:239], a[188:191]
v_mfma_f32_16x16x32_bf16 a[104:107], a[236:239], a[252:255], a[104:107]
v_mfma_f32_16x16x32_bf16 a[104:107], a[232:235], a[248:251], a[104:107]
v_mfma_f32_16x16x32_bf16 a[88:91], a[232:235], a[240:243], a[88:91]
v_mfma_f32_16x16x32_bf16 a[88:91], a[236:239], a[244:247], a[88:91]
v_mfma_f32_16x16x32_bf16 a[72:75], a[236:239], v[70:73], a[72:75]
v_mfma_f32_16x16x32_bf16 a[72:75], a[232:235], v[66:69], a[72:75]
v_mfma_f32_16x16x32_bf16 a[56:59], a[232:235], v[58:61], a[56:59]
s_bfe_u32 s53, s2, 0x20003
v_mfma_f32_16x16x32_bf16 a[56:59], a[236:239], v[62:65], a[56:59]
s_waitcnt lgkmcnt(2)
s_lshl2_add_u32 s53, s3, s53
v_mfma_f32_16x16x32_bf16 v[176:179], a[224:227], v[58:61], v[176:179]
s_waitcnt lgkmcnt(0)
ds_read_b64_tr_b16 a[232:233], v14 offset:43008
v_mfma_f32_16x16x32_bf16 v[176:179], a[228:231], v[62:65], v[176:179]
ds_read_b64_tr_b16 a[234:235], v14 offset:43264
s_lshl1_add_u32 s53, s53, s58
v_mfma_f32_16x16x32_bf16 v[184:187], a[228:231], v[70:73], v[184:187]
ds_read_b64_tr_b16 a[236:237], v14 offset:47104
v_mfma_f32_16x16x32_bf16 v[184:187], a[224:227], v[66:69], v[184:187]
ds_read_b64_tr_b16 a[238:239], v14 offset:47360
s_mul_i32 s53, s53, 768
v_mfma_f32_16x16x32_bf16 v[192:195], a[224:227], a[240:243], v[192:195]
v_mfma_f32_16x16x32_bf16 v[192:195], a[228:231], a[244:247], v[192:195]
s_add_u32 s53, s53, 16384
v_mfma_f32_16x16x32_bf16 v[200:203], a[228:231], a[252:255], v[200:203]
buffer_load_dwordx4 v[40:43], v9, s[24:27], s53 offen offset:0 sc1
v_mfma_f32_16x16x32_bf16 v[200:203], a[224:227], a[248:251], v[200:203]
v_mfma_f32_16x16x32_bf16 a[148:151], a[152:155], a[224:227], 0
buffer_load_dwordx4 v[44:47], v9, s[24:27], s53 offen offset:16 sc1
v_mfma_f32_16x16x32_bf16 a[148:151], a[152:155], a[228:231], a[148:151]
v_mfma_f32_16x16x32_bf16 v[208:211], a[228:231], a[196:199], v[208:211]
buffer_load_dwordx4 v[48:51], v9, s[24:27], s53 offen offset:32 sc1
v_mfma_f32_16x16x32_bf16 v[208:211], a[224:227], a[192:195], v[208:211]
v_mfma_f32_16x16x32_bf16 v[216:219], a[224:227], a[200:203], v[216:219]
v_mfma_f32_16x16x32_bf16 v[216:219], a[228:231], a[204:207], v[216:219]
v_mfma_f32_16x16x32_bf16 v[224:227], a[228:231], a[212:215], v[224:227]
v_mfma_f32_16x16x32_bf16 v[224:227], a[224:227], a[208:211], v[224:227]
v_mfma_f32_16x16x32_bf16 v[232:235], a[224:227], a[216:219], v[232:235]
v_mfma_f32_16x16x32_bf16 v[232:235], a[228:231], a[220:223], v[232:235]
s_waitcnt lgkmcnt(2)
v_mfma_f32_16x16x32_bf16 v[236:239], a[232:235], a[216:219], v[236:239]
s_waitcnt lgkmcnt(0)
ds_read_b64_tr_b16 a[224:225], v12 offset:24576
v_and_b32_e64 v78, 15, v0
v_mfma_f32_16x16x32_bf16 v[236:239], a[236:239], a[220:223], v[236:239]
ds_read_b64_tr_b16 a[226:227], v12 offset:24832
v_mfma_f32_16x16x32_bf16 v[228:231], a[236:239], a[212:215], v[228:231]
ds_read_b64_tr_b16 a[228:229], v12 offset:28672
v_lshrrev_b32_e64 v79, 4, v0
v_mfma_f32_16x16x32_bf16 v[228:231], a[232:235], a[208:211], v[228:231]
ds_read_b64_tr_b16 a[230:231], v12 offset:28928
v_mfma_f32_16x16x32_bf16 v[220:223], a[232:235], a[200:203], v[220:223]
v_mfma_f32_16x16x32_bf16 v[220:223], a[236:239], a[204:207], v[220:223]
v_lshlrev_b32_e64 v78, 11, v78
v_mfma_f32_16x16x32_bf16 v[212:215], a[236:239], a[196:199], v[212:215]
v_mfma_f32_16x16x32_bf16 v[212:215], a[232:235], a[192:195], v[212:215]
v_lshl_add_u32 v78, v79, 3, v78
v_mfma_f32_16x16x32_bf16 a[148:151], a[156:159], a[232:235], a[148:151]
v_mfma_f32_16x16x32_bf16 a[148:151], a[156:159], a[236:239], a[148:151]
v_mfma_f32_16x16x32_bf16 v[204:207], a[236:239], a[252:255], v[204:207]
s_add_u32 s47, s68, 0
v_mfma_f32_16x16x32_bf16 v[204:207], a[232:235], a[248:251], v[204:207]
v_mfma_f32_16x16x32_bf16 v[196:199], a[232:235], a[240:243], v[196:199]
buffer_load_dwordx2 a[160:161], v78, s[4:7], s47 offen offset:0
v_mfma_f32_16x16x32_bf16 v[196:199], a[236:239], a[244:247], v[196:199]
v_mfma_f32_16x16x32_bf16 v[188:191], a[236:239], v[70:73], v[188:191]
v_mfma_f32_16x16x32_bf16 v[188:191], a[232:235], v[66:69], v[188:191]
buffer_load_dwordx2 a[162:163], v78, s[4:7], s47 offen offset:32
v_mfma_f32_16x16x32_bf16 v[180:183], a[232:235], v[58:61], v[180:183]
v_mfma_f32_16x16x32_bf16 v[180:183], a[236:239], v[62:65], v[180:183]
s_waitcnt lgkmcnt(2)
s_add_u32 s47, s68, 32768
v_mfma_f32_16x16x32_bf16 v[84:87], a[224:227], v[58:61], v[84:87]
s_waitcnt lgkmcnt(0)
ds_read_b64_tr_b16 a[232:233], v13 offset:24576
v_mfma_f32_16x16x32_bf16 v[84:87], a[228:231], v[62:65], v[84:87]
ds_read_b64_tr_b16 a[234:235], v13 offset:24832
v_mfma_f32_16x16x32_bf16 v[100:103], a[228:231], v[70:73], v[100:103]
buffer_load_dwordx2 a[164:165], v78, s[4:7], s47 offen offset:0
v_mfma_f32_16x16x32_bf16 v[100:103], a[224:227], v[66:69], v[100:103]
ds_read_b64_tr_b16 a[236:237], v13 offset:28672
v_mfma_f32_16x16x32_bf16 v[244:247], a[224:227], a[240:243], v[244:247]
buffer_load_dwordx2 a[166:167], v78, s[4:7], s47 offen offset:32
v_mfma_f32_16x16x32_bf16 v[244:247], a[228:231], a[244:247], v[244:247]
ds_read_b64_tr_b16 a[238:239], v13 offset:28928
v_mfma_f32_16x16x32_bf16 v[116:119], a[228:231], a[252:255], v[116:119]
v_mfma_f32_16x16x32_bf16 v[116:119], a[224:227], a[248:251], v[116:119]
s_add_u32 s47, s68, 65536
v_mfma_f32_16x16x32_bf16 a[176:179], a[156:159], a[224:227], a[176:179]
v_mfma_f32_16x16x32_bf16 a[176:179], a[156:159], a[228:231], a[176:179]
buffer_load_dwordx2 a[168:169], v78, s[4:7], s47 offen offset:0
v_mfma_f32_16x16x32_bf16 v[132:135], a[228:231], a[196:199], v[132:135]
v_mfma_f32_16x16x32_bf16 v[132:135], a[224:227], a[192:195], v[132:135]
v_mfma_f32_16x16x32_bf16 a[4:7], a[224:227], a[200:203], a[4:7]
buffer_load_dwordx2 a[170:171], v78, s[4:7], s47 offen offset:32
v_mfma_f32_16x16x32_bf16 a[4:7], a[228:231], a[204:207], a[4:7]
v_mfma_f32_16x16x32_bf16 a[20:23], a[228:231], a[212:215], a[20:23]
s_add_u32 s47, s68, 98304
v_mfma_f32_16x16x32_bf16 a[20:23], a[224:227], a[208:211], a[20:23]
v_mfma_f32_16x16x32_bf16 a[36:39], a[224:227], a[216:219], a[36:39]
v_mfma_f32_16x16x32_bf16 a[36:39], a[228:231], a[220:223], a[36:39]
s_waitcnt lgkmcnt(2)
buffer_load_dwordx2 a[172:173], v78, s[4:7], s47 offen offset:0
v_mfma_f32_16x16x32_bf16 a[44:47], a[232:235], a[216:219], a[44:47]
s_waitcnt lgkmcnt(0)
ds_read_b64_tr_b16 a[224:225], v12 offset:25088
v_mfma_f32_16x16x32_bf16 a[44:47], a[236:239], a[220:223], a[44:47]
buffer_load_dwordx2 a[174:175], v78, s[4:7], s47 offen offset:32
v_mfma_f32_16x16x32_bf16 a[28:31], a[236:239], a[212:215], a[28:31]
ds_read_b64_tr_b16 a[226:227], v12 offset:25344
v_mfma_f32_16x16x32_bf16 a[28:31], a[232:235], a[208:211], a[28:31]
ds_read_b64_tr_b16 a[228:229], v12 offset:29184
v_mfma_f32_16x16x32_bf16 a[12:15], a[232:235], a[200:203], a[12:15]
ds_read_b64_tr_b16 a[230:231], v12 offset:29440
v_mfma_f32_16x16x32_bf16 a[12:15], a[236:239], a[204:207], a[12:15]
v_mfma_f32_16x16x32_bf16 v[140:143], a[236:239], a[196:199], v[140:143]
v_mfma_f32_16x16x32_bf16 v[140:143], a[232:235], a[192:195], v[140:143]
v_mfma_f32_16x16x32_bf16 a[180:183], a[156:159], a[232:235], a[180:183]
v_mfma_f32_16x16x32_bf16 a[180:183], a[156:159], a[236:239], a[180:183]
v_mfma_f32_16x16x32_bf16 v[124:127], a[236:239], a[252:255], v[124:127]
v_mfma_f32_16x16x32_bf16 v[124:127], a[232:235], a[248:251], v[124:127]
v_mfma_f32_16x16x32_bf16 v[252:255], a[232:235], a[240:243], v[252:255]
v_mfma_f32_16x16x32_bf16 v[252:255], a[236:239], a[244:247], v[252:255]
v_mfma_f32_16x16x32_bf16 v[108:111], a[236:239], v[70:73], v[108:111]
v_mfma_f32_16x16x32_bf16 v[108:111], a[232:235], v[66:69], v[108:111]
v_mfma_f32_16x16x32_bf16 v[92:95], a[232:235], v[58:61], v[92:95]
v_mfma_f32_16x16x32_bf16 v[92:95], a[236:239], v[62:65], v[92:95]
s_waitcnt lgkmcnt(2)
v_mfma_f32_16x16x32_bf16 a[52:55], a[224:227], v[58:61], a[52:55]
s_waitcnt lgkmcnt(0)
ds_read_b64_tr_b16 a[232:233], v13 offset:25088
v_mfma_f32_16x16x32_bf16 a[52:55], a[228:231], v[62:65], a[52:55]
ds_read_b64_tr_b16 a[234:235], v13 offset:25344
v_mfma_f32_16x16x32_bf16 a[68:71], a[228:231], v[70:73], a[68:71]
ds_read_b64_tr_b16 a[236:237], v13 offset:29184
v_mfma_f32_16x16x32_bf16 a[68:71], a[224:227], v[66:69], a[68:71]
ds_read_b64_tr_b16 a[238:239], v13 offset:29440
v_mfma_f32_16x16x32_bf16 a[84:87], a[224:227], a[240:243], a[84:87]
v_mfma_f32_16x16x32_bf16 a[84:87], a[228:231], a[244:247], a[84:87]
v_mfma_f32_16x16x32_bf16 a[100:103], a[228:231], a[252:255], a[100:103]
v_mfma_f32_16x16x32_bf16 a[100:103], a[224:227], a[248:251], a[100:103]
v_mfma_f32_16x16x32_bf16 a[184:187], a[156:159], a[224:227], a[184:187]
v_mfma_f32_16x16x32_bf16 a[184:187], a[156:159], a[228:231], a[184:187]
v_mfma_f32_16x16x32_bf16 a[116:119], a[228:231], a[196:199], a[116:119]
v_mfma_f32_16x16x32_bf16 a[116:119], a[224:227], a[192:195], a[116:119]
v_mfma_f32_16x16x32_bf16 a[132:135], a[224:227], a[200:203], a[132:135]
v_mfma_f32_16x16x32_bf16 a[132:135], a[228:231], a[204:207], a[132:135]
v_mfma_f32_16x16x32_bf16 v[148:151], a[228:231], a[212:215], v[148:151]
v_mfma_f32_16x16x32_bf16 v[148:151], a[224:227], a[208:211], v[148:151]
v_mfma_f32_16x16x32_bf16 v[164:167], a[224:227], a[216:219], v[164:167]
v_mfma_f32_16x16x32_bf16 v[164:167], a[228:231], a[220:223], v[164:167]
s_waitcnt lgkmcnt(2)
v_mfma_f32_16x16x32_bf16 a[60:63], a[232:235], v[58:61], a[60:63]
s_waitcnt lgkmcnt(0)
v_mfma_f32_16x16x32_bf16 a[60:63], a[236:239], v[62:65], a[60:63]
v_mfma_f32_16x16x32_bf16 a[76:79], a[236:239], v[70:73], a[76:79]
v_mfma_f32_16x16x32_bf16 a[76:79], a[232:235], v[66:69], a[76:79]
v_mfma_f32_16x16x32_bf16 a[92:95], a[232:235], a[240:243], a[92:95]
v_mfma_f32_16x16x32_bf16 a[92:95], a[236:239], a[244:247], a[92:95]
v_mov_b32 v59, 0
v_mfma_f32_16x16x32_bf16 a[108:111], a[236:239], a[252:255], a[108:111]
v_mov_b32_e64 v60, 0
v_mfma_f32_16x16x32_bf16 a[108:111], a[232:235], a[248:251], a[108:111]
v_mfma_f32_16x16x32_bf16 a[188:191], a[156:159], a[232:235], a[188:191]
v_mov_b32_e64 v61, 0
v_mfma_f32_16x16x32_bf16 a[188:191], a[156:159], a[236:239], a[188:191]
v_mfma_f32_16x16x32_bf16 a[124:127], a[236:239], a[196:199], a[124:127]
v_mov_b32_e64 v63, 0
v_mfma_f32_16x16x32_bf16 a[124:127], a[232:235], a[192:195], a[124:127]
v_mov_b32_e64 v64, 0
v_mfma_f32_16x16x32_bf16 a[140:143], a[232:235], a[200:203], a[140:143]
v_mfma_f32_16x16x32_bf16 a[140:143], a[236:239], a[204:207], a[140:143]
v_mov_b32_e64 v65, 0
v_mfma_f32_16x16x32_bf16 v[156:159], a[236:239], a[212:215], v[156:159]
v_mfma_f32_16x16x32_bf16 v[156:159], a[232:235], a[208:211], v[156:159]
v_mfma_f32_16x16x32_bf16 v[172:175], a[232:235], a[216:219], v[172:175]
v_mfma_f32_16x16x32_bf16 v[172:175], a[236:239], a[220:223], v[172:175]
s_waitcnt vmcnt(8)
s_nop 0
v_min3_u32 v74, v40, v41, v42
v_min3_u32 v75, v43, v44, v45
v_min3_u32 v74, v74, v46, v47
v_min3_u32 v75, v75, v48, v49
v_min3_u32 v74, v74, v50, v51
v_min_u32_e64 v74, v74, v75
v_cmp_eq_u32 vcc, 0, v74
s_nop 0
s_and_b32 s40, vcc_lo, 0xffff
s_cselect_b32 s40, 0, s49
s_cmp_lt_u32 s40, 32
s_cbranch_scc1 L_g1_cs_1040
L_g1_ok_1038:
v_lshlrev_b32 v18, 4, v0
v_rcp_f32 v1, v21
v_rcp_f32 v2, v23
v_rcp_f32 v3, v25
v_rcp_f32 v4, v27
v_rcp_f32_e64 v5, v29
s_xor_b32 s47, s37, 0x300000
buffer_load_dwordx4 a[192:195], v18, s[64:67], s47 offen offset:0 sc1
v_rcp_f32 v6, v31
v_rcp_f32 v7, v33
v_rcp_f32_e64 v8, v35
v_mul_f32 v10, 0xbfb8aa3b, v1
v_mul_f32 v11, 0xbfb8aa3b, v2
v_mul_f32 v12, 0xbfb8aa3b, v3
v_mul_f32 v13, 0xbfb8aa3b, v4
v_mul_f32 v14, 0xbfb8aa3b, v5
v_mul_f32 v15, 0xbfb8aa3b, v6
v_mul_f32 v16, 0xbfb8aa3b, v7
v_mul_f32 v17, 0xbfb8aa3b, v8
s_and_b32 s40, s59, 1
s_lshl_b32 s53, s40, 14
s_lshr_b32 s40, s59, 1
s_lshl_b32 s40, s40, 15
buffer_load_dwordx4 a[196:199], v18, s[64:67], s47 offen offset:1024 sc1
s_add_u32 s53, s53, s40
s_lshl_b32 s40, s3, 17
s_add_u32 s53, s53, s40
s_and_b32 s41, s45, 3
s_lshl_b32 s41, s41, 20
s_add_u32 s54, s53, s41
s_add_u32 s54, s54, 0x800000
s_bfe_u32 s41, s2, 0x10003
s_lshl_b32 s41, s41, 20
s_add_u32 s55, s53, s41
s_add_u32 s55, s55, 0x1000000
s_lshl_b32 s40, s58, 9
s_add_u32 s55, s55, s40
v_lshrrev_b32_e64 v76, 5, v0
v_lshl_add_u32 v19, v76, 9, v18
s_xor_b32 s47, s37, 0x380000
buffer_load_dwordx4 a[200:203], v18, s[64:67], s47 offen offset:0 sc1
s_mov_b32 s42, 0xffff0000
v_add_f32 v48, v48, v50
v_add_f32 v49, v49, v51
v_mov_b32_e64 v51, 0
v_accvgpr_read_b32 v74, a176
v_accvgpr_read_b32 v75, a177
v_add_f32 v40, v40, v74
v_add_f32 v41, v41, v75
v_cvt_pk_bf16_f32 v76, v40, v40
v_cvt_pk_bf16_f32 v77, v41, v41
v_and_b32 v76, s42, v76
v_and_b32 v77, s42, v77
v_sub_f32 v76, v40, v76
v_sub_f32 v77, v41, v77
v_cvt_pk_bf16_f32 v40, v40, v76
buffer_load_dwordx4 a[204:207], v18, s[64:67], s47 offen offset:1024 sc1
v_cvt_pk_bf16_f32 v41, v41, v77
v_accvgpr_read_b32 v74, a180
v_accvgpr_read_b32 v75, a181
v_add_f32 v42, v42, v74
v_add_f32 v43, v43, v75
v_cvt_pk_bf16_f32 v76, v42, v42
v_cvt_pk_bf16_f32 v77, v43, v43
v_and_b32 v76, s42, v76
v_and_b32 v77, s42, v77
v_sub_f32 v76, v42, v76
v_sub_f32 v77, v43, v77
v_cvt_pk_bf16_f32 v42, v42, v76
v_cvt_pk_bf16_f32 v43, v43, v77
v_accvgpr_read_b32 v74, a184
v_accvgpr_read_b32 v75, a185
s_xor_b32 s47, s37, 0x400000
buffer_load_dwordx4 a[208:211], v18, s[64:67], s47 offen offset:0 sc1
v_add_f32 v44, v44, v74
v_add_f32 v45, v45, v75
v_cvt_pk_bf16_f32 v76, v44, v44
v_cvt_pk_bf16_f32 v77, v45, v45
v_and_b32 v76, s42, v76
v_and_b32 v77, s42, v77
v_sub_f32 v76, v44, v76
v_sub_f32 v77, v45, v77
v_cvt_pk_bf16_f32 v44, v44, v76
v_cvt_pk_bf16_f32 v45, v45, v77
v_accvgpr_read_b32 v74, a188
v_accvgpr_read_b32 v75, a189
v_add_f32 v46, v46, v74
v_add_f32 v47, v47, v75
v_cvt_pk_bf16_f32 v76, v46, v46
buffer_load_dwordx4 a[212:215], v18, s[64:67], s47 offen offset:1024 sc1
v_cvt_pk_bf16_f32 v77, v47, v47
v_and_b32 v76, s42, v76
v_and_b32 v77, s42, v77
v_sub_f32 v76, v46, v76
v_sub_f32 v77, v47, v77
v_cvt_pk_bf16_f32 v46, v46, v76
v_cvt_pk_bf16_f32 v47, v47, v77
v_accvgpr_read_b32 v74, a148
v_accvgpr_read_b32 v75, a149
v_add_f32 v48, v48, v74
v_add_f32 v49, v49, v75
v_cvt_pk_bf16_f32 v76, v48, v48
v_cvt_pk_bf16_f32 v77, v49, v49
v_and_b32 v76, s42, v76
v_and_b32 v77, s42, v77
s_xor_b32 s47, s37, 0x500000
buffer_load_dwordx4 a[216:219], v18, s[64:67], s47 offen offset:0 sc1
v_sub_f32 v76, v48, v76
v_sub_f32 v77, v49, v77
v_cvt_pk_bf16_f32 v48, v48, v76
v_cvt_pk_bf16_f32 v49, v49, v77
v_mov_b32 v50, v40
v_mov_b32 v54, v41
v_mov_b32 v58, v42
v_mov_b32 v62, v43
v_mfma_f32_16x16x32_bf16 v[80:83], v[50:53], v[20:23], v[80:83]
v_mfma_f32_16x16x32_bf16 v[84:87], v[54:57], v[20:23], v[84:87]
v_mfma_f32_16x16x32_bf16 v[88:91], v[58:61], v[20:23], v[88:91]
v_mfma_f32_16x16x32_bf16 v[92:95], v[62:65], v[20:23], v[92:95]
s_nop 4
v_pk_mul_f32 v[80:81], v[80:81], v[10:11] op_sel:[0,0] op_sel_hi:[1,0]
s_nop 0
v_pk_mul_f32 v[88:89], v[88:89], v[10:11] op_sel:[0,0] op_sel_hi:[1,0]
v_pk_mul_f32 v[82:83], v[82:83], v[10:11] op_sel:[0,0] op_sel_hi:[1,0]
buffer_load_dwordx4 a[220:223], v18, s[64:67], s47 offen offset:1024 sc1
v_pk_mul_f32 v[90:91], v[90:91], v[10:11] op_sel:[0,0] op_sel_hi:[1,0]
v_exp_f32_e64 v80, v80
v_mfma_f32_16x16x32_bf16 v[96:99], v[50:53], v[22:25], v[96:99]
v_exp_f32_e64 v88, v88
v_mfma_f32_16x16x32_bf16 v[100:103], v[54:57], v[22:25], v[100:103]
v_exp_f32 v81, v81
v_exp_f32 v89, v89
v_exp_f32 v82, v82
v_exp_f32 v90, v90
v_exp_f32_e64 v83, v83
v_mfma_f32_16x16x32_bf16 v[104:107], v[58:61], v[22:25], v[104:107]
v_exp_f32_e64 v91, v91
v_pk_fma_f32 v[80:81], v[80:81], v[20:21], v[20:21] op_sel:[0,1,1] op_sel_hi:[1,1,1]
v_pk_fma_f32 v[88:89], v[88:89], v[20:21], v[20:21] op_sel:[0,1,1] op_sel_hi:[1,1,1]
v_pk_fma_f32 v[82:83], v[82:83], v[20:21], v[20:21] op_sel:[0,1,1] op_sel_hi:[1,1,1]
s_xor_b32 s47, s37, 0x700000
buffer_load_dwordx4 a[224:227], v18, s[64:67], s47 offen offset:0 sc1
v_pk_fma_f32 v[90:91], v[90:91], v[20:21], v[20:21] op_sel:[0,1,1] op_sel_hi:[1,1,1]
v_rcp_f32_e64 v80, v80
v_mfma_f32_16x16x32_bf16 v[108:111], v[62:65], v[22:25], v[108:111]
v_rcp_f32 v88, v88
v_rcp_f32 v81, v81
v_rcp_f32 v89, v89
v_rcp_f32 v82, v82
v_rcp_f32 v90, v90
v_rcp_f32 v83, v83
v_rcp_f32_e64 v91, v91
v_pk_mul_f32 v[84:85], v[84:85], v[80:81]
v_pk_mul_f32 v[92:93], v[92:93], v[88:89]
v_pk_mul_f32 v[86:87], v[86:87], v[82:83]
v_pk_mul_f32 v[94:95], v[94:95], v[90:91]
s_add_u32 s40, s54, 0
s_nop 0
buffer_load_dwordx4 a[228:231], v18, s[64:67], s47 offen offset:1024 sc1
v_cvt_pk_bf16_f32 v80, v84, v85
v_cvt_pk_bf16_f32 v82, v92, v93
v_cvt_pk_bf16_f32 v81, v86, v87
v_cvt_pk_bf16_f32 v83, v94, v95
buffer_store_dwordx4 v[80:83], v18, s[20:23], s40 offen sc1
v_pk_mul_f32 v[96:97], v[96:97], v[10:11] op_sel:[0,1] op_sel_hi:[1,1]
v_pk_mul_f32 v[104:105], v[104:105], v[10:11] op_sel:[0,1] op_sel_hi:[1,1]
v_pk_mul_f32 v[98:99], v[98:99], v[10:11] op_sel:[0,1] op_sel_hi:[1,1]
v_pk_mul_f32 v[106:107], v[106:107], v[10:11] op_sel:[0,1] op_sel_hi:[1,1]
v_exp_f32_e64 v96, v96
v_mfma_f32_16x16x32_bf16 v[240:243], v[50:53], v[24:27], v[240:243]
v_exp_f32_e64 v104, v104
v_mfma_f32_16x16x32_bf16 v[244:247], v[54:57], v[24:27], v[244:247]
v_exp_f32 v97, v97
v_exp_f32 v105, v105
s_xor_b32 s47, s37, 0x800000
buffer_load_dwordx4 a[232:235], v18, s[64:67], s47 offen offset:0 sc1
v_exp_f32 v98, v98
v_exp_f32 v106, v106
v_exp_f32_e64 v99, v99
v_mfma_f32_16x16x32_bf16 v[248:251], v[58:61], v[24:27], v[248:251]
v_exp_f32_e64 v107, v107
v_pk_fma_f32 v[96:97], v[96:97], v[22:23], v[22:23] op_sel:[0,1,1] op_sel_hi:[1,1,1]
v_pk_fma_f32 v[104:105], v[104:105], v[22:23], v[22:23] op_sel:[0,1,1] op_sel_hi:[1,1,1]
v_pk_fma_f32 v[98:99], v[98:99], v[22:23], v[22:23] op_sel:[0,1,1] op_sel_hi:[1,1,1]
v_pk_fma_f32 v[106:107], v[106:107], v[22:23], v[22:23] op_sel:[0,1,1] op_sel_hi:[1,1,1]
v_rcp_f32_e64 v96, v96
v_mfma_f32_16x16x32_bf16 v[252:255], v[62:65], v[24:27], v[252:255]
v_rcp_f32 v104, v104
v_rcp_f32 v97, v97
v_rcp_f32 v105, v105
v_rcp_f32 v98, v98
buffer_load_dwordx4 a[236:239], v18, s[64:67], s47 offen offset:1024 sc1
v_rcp_f32 v106, v106
v_rcp_f32 v99, v99
v_rcp_f32_e64 v107, v107
v_pk_mul_f32 v[100:101], v[100:101], v[96:97]
v_pk_mul_f32 v[108:109], v[108:109], v[104:105]
v_pk_mul_f32 v[102:103], v[102:103], v[98:99]
v_pk_mul_f32 v[110:111], v[110:111], v[106:107]
s_add_u32 s40, s54, 1024
v_cvt_pk_bf16_f32 v96, v100, v101
v_cvt_pk_bf16_f32 v98, v108, v109
v_cvt_pk_bf16_f32 v97, v102, v103
v_cvt_pk_bf16_f32 v99, v110, v111
buffer_store_dwordx4 v[96:99], v18, s[20:23], s40 offen sc1
v_pk_mul_f32 v[240:241], v[240:241], v[12:13] op_sel:[0,0] op_sel_hi:[1,0]
v_pk_mul_f32 v[248:249], v[248:249], v[12:13] op_sel:[0,0] op_sel_hi:[1,0]
s_xor_b32 s47, s37, 0x220000
buffer_load_dwordx4 a[240:243], v18, s[64:67], s47 offen offset:0 sc1
v_pk_mul_f32 v[242:243], v[242:243], v[12:13] op_sel:[0,0] op_sel_hi:[1,0]
v_pk_mul_f32 v[250:251], v[250:251], v[12:13] op_sel:[0,0] op_sel_hi:[1,0]
v_exp_f32_e64 v240, v240
v_mfma_f32_16x16x32_bf16 v[112:115], v[50:53], v[26:29], v[112:115]
v_exp_f32_e64 v248, v248
v_mfma_f32_16x16x32_bf16 v[116:119], v[54:57], v[26:29], v[116:119]
v_exp_f32 v241, v241
v_exp_f32 v249, v249
v_exp_f32 v242, v242
v_exp_f32 v250, v250
v_exp_f32_e64 v243, v243
v_mfma_f32_16x16x32_bf16 v[120:123], v[58:61], v[26:29], v[120:123]
v_exp_f32_e64 v251, v251
v_pk_fma_f32 v[240:241], v[240:241], v[24:25], v[24:25] op_sel:[0,1,1] op_sel_hi:[1,1,1]
v_pk_fma_f32 v[248:249], v[248:249], v[24:25], v[24:25] op_sel:[0,1,1] op_sel_hi:[1,1,1]
buffer_load_dwordx4 a[244:247], v18, s[64:67], s47 offen offset:1024 sc1
v_pk_fma_f32 v[242:243], v[242:243], v[24:25], v[24:25] op_sel:[0,1,1] op_sel_hi:[1,1,1]
v_pk_fma_f32 v[250:251], v[250:251], v[24:25], v[24:25] op_sel:[0,1,1] op_sel_hi:[1,1,1]
v_rcp_f32_e64 v240, v240
v_mfma_f32_16x16x32_bf16 v[124:127], v[62:65], v[26:29], v[124:127]
v_rcp_f32 v248, v248
v_rcp_f32 v241, v241
v_rcp_f32 v249, v249
v_rcp_f32 v242, v242
v_rcp_f32 v250, v250
v_rcp_f32 v243, v243
v_rcp_f32_e64 v251, v251
v_pk_mul_f32 v[244:245], v[244:245], v[240:241]
v_pk_mul_f32 v[252:253], v[252:253], v[248:249]
v_pk_mul_f32 v[246:247], v[246:247], v[242:243]
v_pk_mul_f32 v[254:255], v[254:255], v[250:251]
s_xor_b32 s47, s37, 0x2a0000
buffer_load_dwordx4 a[248:251], v18, s[64:67], s47 offen offset:0 sc1
s_add_u32 s40, s54, 2048
v_cvt_pk_bf16_f32 v240, v244, v245
v_cvt_pk_bf16_f32 v242, v252, v253
v_cvt_pk_bf16_f32 v241, v246, v247
v_cvt_pk_bf16_f32 v243, v254, v255
buffer_store_dwordx4 v[240:243], v18, s[20:23], s40 offen sc1
v_pk_mul_f32 v[112:113], v[112:113], v[12:13] op_sel:[0,1] op_sel_hi:[1,1]
v_pk_mul_f32 v[120:121], v[120:121], v[12:13] op_sel:[0,1] op_sel_hi:[1,1]
v_pk_mul_f32 v[114:115], v[114:115], v[12:13] op_sel:[0,1] op_sel_hi:[1,1]
v_pk_mul_f32 v[122:123], v[122:123], v[12:13] op_sel:[0,1] op_sel_hi:[1,1]
v_exp_f32_e64 v112, v112
v_mfma_f32_16x16x32_bf16 v[128:131], v[50:53], v[28:31], v[128:131]
v_exp_f32_e64 v120, v120
v_mfma_f32_16x16x32_bf16 v[132:135], v[54:57], v[28:31], v[132:135]
v_exp_f32_e64 v113, v113
buffer_load_dwordx4 a[252:255], v18, s[64:67], s47 offen offset:1024 sc1
v_exp_f32 v121, v121
v_exp_f32 v114, v114
v_exp_f32 v122, v122
v_exp_f32 v115, v115
v_mfma_f32_16x16x32_bf16 v[136:139], v[58:61], v[28:31], v[136:139]
v_exp_f32_e64 v123, v123
v_pk_fma_f32 v[112:113], v[112:113], v[26:27], v[26:27] op_sel:[0,1,1] op_sel_hi:[1,1,1]
v_pk_fma_f32 v[120:121], v[120:121], v[26:27], v[26:27] op_sel:[0,1,1] op_sel_hi:[1,1,1]
v_pk_fma_f32 v[114:115], v[114:115], v[26:27], v[26:27] op_sel:[0,1,1] op_sel_hi:[1,1,1]
v_pk_fma_f32 v[122:123], v[122:123], v[26:27], v[26:27] op_sel:[0,1,1] op_sel_hi:[1,1,1]
v_rcp_f32_e64 v112, v112
v_mfma_f32_16x16x32_bf16 v[140:143], v[62:65], v[28:31], v[140:143]
v_rcp_f32 v120, v120
v_rcp_f32 v113, v113
v_rcp_f32_e64 v121, v121
s_xor_b32 s47, s37, 0x200000
buffer_load_dwordx4 a[176:179], v18, s[64:67], s47 offen offset:0 sc1
v_rcp_f32 v114, v114
v_rcp_f32 v122, v122
v_rcp_f32 v115, v115
v_rcp_f32 v123, v123
v_pk_mul_f32 v[116:117], v[116:117], v[112:113]
v_pk_mul_f32 v[124:125], v[124:125], v[120:121]
v_pk_mul_f32 v[118:119], v[118:119], v[114:115]
v_pk_mul_f32 v[126:127], v[126:127], v[122:123]
s_add_u32 s40, s54, 3072
v_cvt_pk_bf16_f32 v112, v116, v117
v_cvt_pk_bf16_f32 v114, v124, v125
v_cvt_pk_bf16_f32 v113, v118, v119
v_cvt_pk_bf16_f32 v115, v126, v127
buffer_store_dwordx4 v[112:115], v18, s[20:23], s40 offen sc1
v_pk_mul_f32 v[128:129], v[128:129], v[14:15] op_sel:[0,0] op_sel_hi:[1,0]
buffer_load_dwordx4 a[180:183], v18, s[64:67], s47 offen offset:1024 sc1
v_pk_mul_f32 v[136:137], v[136:137], v[14:15] op_sel:[0,0] op_sel_hi:[1,0]
v_pk_mul_f32 v[130:131], v[130:131], v[14:15] op_sel:[0,0] op_sel_hi:[1,0]
v_pk_mul_f32 v[138:139], v[138:139], v[14:15] op_sel:[0,0] op_sel_hi:[1,0]
v_exp_f32_e64 v128, v128
v_mfma_f32_16x16x32_bf16 a[0:3], v[50:53], v[30:33], a[0:3]
v_exp_f32_e64 v136, v136
v_mfma_f32_16x16x32_bf16 a[4:7], v[54:57], v[30:33], a[4:7]
v_exp_f32 v129, v129
v_exp_f32 v137, v137
v_exp_f32 v130, v130
v_exp_f32 v138, v138
v_exp_f32_e64 v131, v131
v_mfma_f32_16x16x32_bf16 a[8:11], v[58:61], v[30:33], a[8:11]
v_exp_f32_e64 v139, v139
v_pk_fma_f32 v[128:129], v[128:129], v[28:29], v[28:29] op_sel:[0,1,1] op_sel_hi:[1,1,1]
s_xor_b32 s47, s37, 0x280000
buffer_load_dwordx4 a[184:187], v18, s[64:67], s47 offen offset:0 sc1
v_pk_fma_f32 v[136:137], v[136:137], v[28:29], v[28:29] op_sel:[0,1,1] op_sel_hi:[1,1,1]
v_pk_fma_f32 v[130:131], v[130:131], v[28:29], v[28:29] op_sel:[0,1,1] op_sel_hi:[1,1,1]
v_pk_fma_f32 v[138:139], v[138:139], v[28:29], v[28:29] op_sel:[0,1,1] op_sel_hi:[1,1,1]
v_rcp_f32_e64 v128, v128
v_mfma_f32_16x16x32_bf16 a[12:15], v[62:65], v[30:33], a[12:15]
v_rcp_f32 v136, v136
v_rcp_f32 v129, v129
v_rcp_f32 v137, v137
v_rcp_f32 v130, v130
v_rcp_f32 v138, v138
v_rcp_f32 v131, v131
v_rcp_f32_e64 v139, v139
v_pk_mul_f32 v[132:133], v[132:133], v[128:129]
v_pk_mul_f32 v[140:141], v[140:141], v[136:137]
v_pk_mul_f32 v[134:135], v[134:135], v[130:131]
buffer_load_dwordx4 a[188:191], v18, s[64:67], s47 offen offset:1024 sc1
v_pk_mul_f32 v[142:143], v[142:143], v[138:139]
s_add_u32 s40, s54, 4096
v_cvt_pk_bf16_f32 v128, v132, v133
v_cvt_pk_bf16_f32 v130, v140, v141
v_cvt_pk_bf16_f32 v129, v134, v135
v_cvt_pk_bf16_f32 v131, v142, v143
buffer_store_dwordx4 v[128:131], v18, s[20:23], s40 offen sc1
v_accvgpr_read_b32 v96, a0
v_accvgpr_read_b32 v97, a1
v_mfma_f32_16x16x32_bf16 a[16:19], v[50:53], v[32:35], a[16:19]
v_accvgpr_read_b32 v98, a2
v_accvgpr_read_b32 v99, a3
v_accvgpr_read_b32 v100, a4
v_accvgpr_read_b32 v101, a5
v_accvgpr_read_b32 v102, a6
v_accvgpr_read_b32 v103, a7
v_accvgpr_read_b32 v104, a8
v_mfma_f32_16x16x32_bf16 a[20:23], v[54:57], v[32:35], a[20:23]
v_accvgpr_read_b32 v105, a9
v_accvgpr_read_b32 v106, a10
s_waitcnt vmcnt(25)
s_nop 0
v_accvgpr_read_b32 v107, a11
v_accvgpr_read_b32 v240, a160
v_accvgpr_read_b32 v241, a161
v_accvgpr_read_b32 v242, a162
v_accvgpr_read_b32 v243, a163
v_accvgpr_read_b32 v108, a12
v_accvgpr_read_b32 v109, a13
v_accvgpr_read_b32 v110, a14
v_accvgpr_read_b32 v111, a15
v_accvgpr_read_b32 v244, a164
v_accvgpr_read_b32 v245, a165
v_accvgpr_read_b32 v246, a166
v_accvgpr_read_b32 v247, a167
v_mfma_f32_16x16x32_bf16 a[24:27], v[58:61], v[32:35], a[24:27]
v_pk_mul_f32 v[96:97], v[96:97], v[14:15] op_sel:[0,1] op_sel_hi:[1,1]
v_pk_mul_f32 v[104:105], v[104:105], v[14:15] op_sel:[0,1] op_sel_hi:[1,1]
v_pk_mul_f32 v[98:99], v[98:99], v[14:15] op_sel:[0,1] op_sel_hi:[1,1]
v_accvgpr_read_b32 v248, a168
v_accvgpr_read_b32 v249, a169
v_accvgpr_read_b32 v250, a170
v_accvgpr_read_b32 v251, a171
v_pk_mul_f32 v[106:107], v[106:107], v[14:15] op_sel:[0,1] op_sel_hi:[1,1]
s_xor_b32 s47, s37, 0x320000
buffer_load_dwordx4 a[0:3], v18, s[64:67], s47 offen offset:0 sc1
v_exp_f32 v96, v96
v_exp_f32 v104, v104
v_exp_f32_e64 v97, v97
v_accvgpr_read_b32 v252, a172
v_accvgpr_read_b32 v253, a173
v_accvgpr_read_b32 v254, a174
v_accvgpr_read_b32 v255, a175
v_mfma_f32_16x16x32_bf16 a[28:31], v[62:65], v[32:35], a[28:31]
v_exp_f32 v105, v105
v_exp_f32 v98, v98
v_exp_f32 v106, v106
v_exp_f32 v99, v99
v_exp_f32_e64 v107, v107
v_pk_fma_f32 v[96:97], v[96:97], v[30:31], v[30:31] op_sel:[0,1,1] op_sel_hi:[1,1,1]
v_pk_fma_f32 v[104:105], v[104:105], v[30:31], v[30:31] op_sel:[0,1,1] op_sel_hi:[1,1,1]
v_pk_fma_f32 v[98:99], v[98:99], v[30:31], v[30:31] op_sel:[0,1,1] op_sel_hi:[1,1,1]
v_pk_fma_f32 v[106:107], v[106:107], v[30:31], v[30:31] op_sel:[0,1,1] op_sel_hi:[1,1,1]
v_rcp_f32 v96, v96
v_rcp_f32 v104, v104
buffer_load_dwordx4 a[4:7], v18, s[64:67], s47 offen offset:1024 sc1
v_rcp_f32 v97, v97
v_rcp_f32 v105, v105
v_rcp_f32 v98, v98
v_rcp_f32 v106, v106
v_rcp_f32 v99, v99
v_rcp_f32 v107, v107
v_pk_mul_f32 v[100:101], v[100:101], v[96:97]
v_pk_mul_f32 v[108:109], v[108:109], v[104:105]
v_pk_mul_f32 v[102:103], v[102:103], v[98:99]
v_pk_mul_f32 v[110:111], v[110:111], v[106:107]
s_add_u32 s40, s54, 5120
v_cvt_pk_bf16_f32 v96, v100, v101
v_cvt_pk_bf16_f32 v98, v108, v109
v_cvt_pk_bf16_f32 v97, v102, v103
v_cvt_pk_bf16_f32 v99, v110, v111
s_xor_b32 s47, s37, 0x3a0000
buffer_load_dwordx4 a[8:11], v18, s[64:67], s47 offen offset:0 sc1
buffer_store_dwordx4 v[96:99], v18, s[20:23], s40 offen sc1
v_accvgpr_read_b32 v80, a16
v_accvgpr_read_b32 v81, a17
v_mfma_f32_16x16x32_bf16 a[32:35], v[50:53], v[34:37], a[32:35]
v_accvgpr_read_b32 v82, a18
v_accvgpr_read_b32 v83, a19
v_accvgpr_read_b32 v84, a20
v_accvgpr_read_b32 v85, a21
v_accvgpr_read_b32 v86, a22
v_accvgpr_read_b32 v87, a23
v_accvgpr_read_b32 v88, a24
v_mfma_f32_16x16x32_bf16 a[36:39], v[54:57], v[34:37], a[36:39]
v_accvgpr_read_b32 v89, a25
v_accvgpr_read_b32 v90, a26
v_accvgpr_read_b32 v91, a27
buffer_load_dwordx4 a[12:15], v18, s[64:67], s47 offen offset:1024 sc1
v_accvgpr_read_b32 v92, a28
v_accvgpr_read_b32 v93, a29
v_accvgpr_read_b32 v94, a30
v_accvgpr_read_b32 v95, a31
v_mfma_f32_16x16x32_bf16 a[40:43], v[58:61], v[34:37], a[40:43]
v_pk_mul_f32 v[80:81], v[80:81], v[16:17] op_sel:[0,0] op_sel_hi:[1,0]
v_pk_mul_f32 v[88:89], v[88:89], v[16:17] op_sel:[0,0] op_sel_hi:[1,0]
v_pk_mul_f32 v[82:83], v[82:83], v[16:17] op_sel:[0,0] op_sel_hi:[1,0]
v_pk_mul_f32 v[90:91], v[90:91], v[16:17] op_sel:[0,0] op_sel_hi:[1,0]
v_exp_f32 v80, v80
v_exp_f32 v88, v88
v_exp_f32_e64 v81, v81
v_mfma_f32_16x16x32_bf16 a[44:47], v[62:65], v[34:37], a[44:47]
v_exp_f32 v89, v89
v_exp_f32 v82, v82
s_xor_b32 s47, s37, 0x420000
buffer_load_dwordx4 a[16:19], v18, s[64:67], s47 offen offset:0 sc1
v_exp_f32 v90, v90
v_exp_f32 v83, v83
v_exp_f32_e64 v91, v91
v_pk_fma_f32 v[80:81], v[80:81], v[32:33], v[32:33] op_sel:[0,1,1] op_sel_hi:[1,1,1]
v_pk_fma_f32 v[88:89], v[88:89], v[32:33], v[32:33] op_sel:[0,1,1] op_sel_hi:[1,1,1]
v_pk_fma_f32 v[82:83], v[82:83], v[32:33], v[32:33] op_sel:[0,1,1] op_sel_hi:[1,1,1]
v_pk_fma_f32 v[90:91], v[90:91], v[32:33], v[32:33] op_sel:[0,1,1] op_sel_hi:[1,1,1]
v_rcp_f32 v80, v80
v_rcp_f32 v88, v88
v_rcp_f32 v81, v81
v_rcp_f32 v89, v89
v_rcp_f32 v82, v82
v_rcp_f32 v90, v90
v_rcp_f32 v83, v83
v_rcp_f32 v91, v91
buffer_load_dwordx4 a[20:23], v18, s[64:67], s47 offen offset:1024 sc1
v_pk_mul_f32 v[84:85], v[84:85], v[80:81]
v_pk_mul_f32 v[92:93], v[92:93], v[88:89]
v_pk_mul_f32 v[86:87], v[86:87], v[82:83]
v_pk_mul_f32 v[94:95], v[94:95], v[90:91]
s_add_u32 s40, s54, 6144
v_cvt_pk_bf16_f32 v80, v84, v85
v_cvt_pk_bf16_f32 v82, v92, v93
v_cvt_pk_bf16_f32 v81, v86, v87
v_cvt_pk_bf16_f32 v83, v94, v95
buffer_store_dwordx4 v[80:83], v18, s[20:23], s40 offen sc1
v_accvgpr_read_b32 v96, a32
v_accvgpr_read_b32 v97, a33
v_mov_b32_e64 v50, v44
v_accvgpr_read_b32 v98, a34
v_accvgpr_read_b32 v99, a35
s_xor_b32 s47, s37, 0x520000
buffer_load_dwordx4 a[24:27], v18, s[64:67], s47 offen offset:0 sc1
v_accvgpr_read_b32 v100, a36
v_mov_b32_e64 v54, v45
v_accvgpr_read_b32 v101, a37
v_accvgpr_read_b32 v102, a38
v_accvgpr_read_b32 v103, a39
v_accvgpr_read_b32 v104, a40
v_mov_b32_e64 v58, v46
v_accvgpr_read_b32 v105, a41
v_accvgpr_read_b32 v106, a42
v_accvgpr_read_b32 v107, a43
v_mov_b32_e64 v62, v47
v_accvgpr_read_b32 v108, a44
v_accvgpr_read_b32 v109, a45
v_accvgpr_read_b32 v110, a46
v_accvgpr_read_b32 v111, a47
buffer_load_dwordx4 a[28:31], v18, s[64:67], s47 offen offset:1024 sc1
v_mfma_f32_16x16x32_bf16 a[48:51], v[50:53], v[20:23], a[48:51]
v_pk_mul_f32 v[96:97], v[96:97], v[16:17] op_sel:[0,1] op_sel_hi:[1,1]
v_pk_mul_f32 v[104:105], v[104:105], v[16:17] op_sel:[0,1] op_sel_hi:[1,1]
v_pk_mul_f32 v[98:99], v[98:99], v[16:17] op_sel:[0,1] op_sel_hi:[1,1]
v_pk_mul_f32 v[106:107], v[106:107], v[16:17] op_sel:[0,1] op_sel_hi:[1,1]
v_exp_f32_e64 v96, v96
v_mfma_f32_16x16x32_bf16 a[52:55], v[54:57], v[20:23], a[52:55]
v_exp_f32 v104, v104
v_exp_f32 v97, v97
v_mfma_f32_16x16x32_bf16 a[56:59], v[58:61], v[20:23], a[56:59]
v_exp_f32 v105, v105
v_exp_f32 v98, v98
v_exp_f32_e64 v106, v106
v_mfma_f32_16x16x32_bf16 a[60:63], v[62:65], v[20:23], a[60:63]
v_exp_f32_e64 v99, v99
s_xor_b32 s47, s37, 0x720000
buffer_load_dwordx4 a[32:35], v18, s[64:67], s47 offen offset:0 sc1
v_exp_f32_e64 v107, v107
v_pk_fma_f32 v[96:97], v[96:97], v[34:35], v[34:35] op_sel:[0,1,1] op_sel_hi:[1,1,1]
v_pk_fma_f32 v[104:105], v[104:105], v[34:35], v[34:35] op_sel:[0,1,1] op_sel_hi:[1,1,1]
v_pk_fma_f32 v[98:99], v[98:99], v[34:35], v[34:35] op_sel:[0,1,1] op_sel_hi:[1,1,1]
v_pk_fma_f32 v[106:107], v[106:107], v[34:35], v[34:35] op_sel:[0,1,1] op_sel_hi:[1,1,1]
v_rcp_f32 v96, v96
v_rcp_f32 v104, v104
v_rcp_f32 v97, v97
v_rcp_f32 v105, v105
v_rcp_f32 v98, v98
v_rcp_f32 v106, v106
v_rcp_f32 v99, v99
v_rcp_f32 v107, v107
v_pk_mul_f32 v[100:101], v[100:101], v[96:97]
v_pk_mul_f32 v[108:109], v[108:109], v[104:105]
buffer_load_dwordx4 a[36:39], v18, s[64:67], s47 offen offset:1024 sc1
v_pk_mul_f32 v[102:103], v[102:103], v[98:99]
v_pk_mul_f32 v[110:111], v[110:111], v[106:107]
s_add_u32 s40, s54, 7168
v_cvt_pk_bf16_f32 v96, v100, v101
v_cvt_pk_bf16_f32 v98, v108, v109
v_cvt_pk_bf16_f32 v97, v102, v103
v_cvt_pk_bf16_f32 v99, v110, v111
buffer_store_dwordx4 v[96:99], v18, s[20:23], s40 offen sc1
v_accvgpr_read_b32 v80, a48
v_accvgpr_read_b32 v81, a49
v_mfma_f32_16x16x32_bf16 a[64:67], v[50:53], v[22:25], a[64:67]
v_accvgpr_read_b32 v82, a50
v_accvgpr_read_b32 v83, a51
v_accvgpr_read_b32 v84, a52
v_accvgpr_read_b32 v85, a53
s_xor_b32 s47, s37, 0x820000
buffer_load_dwordx4 a[40:43], v18, s[64:67], s47 offen offset:0 sc1
v_accvgpr_read_b32 v86, a54
v_accvgpr_read_b32 v87, a55
v_accvgpr_read_b32 v88, a56
v_mfma_f32_16x16x32_bf16 a[68:71], v[54:57], v[22:25], a[68:71]
v_accvgpr_read_b32 v89, a57
v_accvgpr_read_b32 v90, a58
v_accvgpr_read_b32 v91, a59
v_accvgpr_read_b32 v92, a60
v_accvgpr_read_b32 v93, a61
v_accvgpr_read_b32 v94, a62
v_accvgpr_read_b32 v95, a63
v_mfma_f32_16x16x32_bf16 a[72:75], v[58:61], v[22:25], a[72:75]
v_pk_mul_f32 v[80:81], v[80:81], v[10:11] op_sel:[0,0] op_sel_hi:[1,0]
v_pk_mul_f32 v[88:89], v[88:89], v[10:11] op_sel:[0,0] op_sel_hi:[1,0]
v_pk_mul_f32 v[82:83], v[82:83], v[10:11] op_sel:[0,0] op_sel_hi:[1,0]
buffer_load_dwordx4 a[44:47], v18, s[64:67], s47 offen offset:1024 sc1
v_pk_mul_f32 v[90:91], v[90:91], v[10:11] op_sel:[0,0] op_sel_hi:[1,0]
v_exp_f32 v80, v80
v_exp_f32 v88, v88
v_exp_f32_e64 v81, v81
v_mfma_f32_16x16x32_bf16 a[76:79], v[62:65], v[22:25], a[76:79]
v_exp_f32 v89, v89
v_exp_f32 v82, v82
v_exp_f32 v90, v90
v_exp_f32 v83, v83
v_exp_f32_e64 v91, v91
v_pk_fma_f32 v[80:81], v[80:81], v[20:21], v[20:21] op_sel:[0,1,1] op_sel_hi:[1,1,1]
v_pk_fma_f32 v[88:89], v[88:89], v[20:21], v[20:21] op_sel:[0,1,1] op_sel_hi:[1,1,1]
v_pk_fma_f32 v[82:83], v[82:83], v[20:21], v[20:21] op_sel:[0,1,1] op_sel_hi:[1,1,1]
v_pk_fma_f32 v[90:91], v[90:91], v[20:21], v[20:21] op_sel:[0,1,1] op_sel_hi:[1,1,1]
v_rcp_f32_e64 v80, v80
s_xor_b32 s47, s37, 0x440000
buffer_load_dwordx4 a[48:51], v18, s[64:67], s47 offen offset:0 sc1
v_rcp_f32 v88, v88
v_rcp_f32 v81, v81
v_rcp_f32 v89, v89
v_rcp_f32 v82, v82
v_rcp_f32 v90, v90
v_rcp_f32 v83, v83
v_rcp_f32_e64 v91, v91
v_pk_mul_f32 v[84:85], v[84:85], v[80:81]
v_pk_mul_f32 v[92:93], v[92:93], v[88:89]
v_pk_mul_f32 v[86:87], v[86:87], v[82:83]
v_pk_mul_f32 v[94:95], v[94:95], v[90:91]
s_add_u32 s40, s54, 4286578688
v_cvt_pk_bf16_f32 v80, v84, v85
v_cvt_pk_bf16_f32 v82, v92, v93
v_cvt_pk_bf16_f32 v81, v86, v87
buffer_load_dwordx4 a[52:55], v18, s[64:67], s47 offen offset:1024 sc1
v_cvt_pk_bf16_f32 v83, v94, v95
buffer_store_dwordx4 v[80:83], v18, s[20:23], s40 offen sc1
v_accvgpr_read_b32 v96, a64
v_accvgpr_read_b32 v97, a65
v_mfma_f32_16x16x32_bf16 a[80:83], v[50:53], v[24:27], a[80:83]
v_accvgpr_read_b32 v98, a66
v_accvgpr_read_b32 v99, a67
v_accvgpr_read_b32 v100, a68
v_accvgpr_read_b32 v101, a69
v_accvgpr_read_b32 v102, a70
v_accvgpr_read_b32 v103, a71
v_accvgpr_read_b32 v104, a72
v_mfma_f32_16x16x32_bf16 a[84:87], v[54:57], v[24:27], a[84:87]
v_accvgpr_read_b32 v105, a73
v_accvgpr_read_b32 v106, a74
s_xor_b32 s47, s37, 0x540000
buffer_load_dwordx4 a[56:59], v18, s[64:67], s47 offen offset:0 sc1
v_accvgpr_read_b32 v107, a75
v_accvgpr_read_b32 v108, a76
v_accvgpr_read_b32 v109, a77
v_accvgpr_read_b32 v110, a78
v_accvgpr_read_b32 v111, a79
v_mfma_f32_16x16x32_bf16 a[88:91], v[58:61], v[24:27], a[88:91]
v_pk_mul_f32 v[96:97], v[96:97], v[10:11] op_sel:[0,1] op_sel_hi:[1,1]
v_pk_mul_f32 v[104:105], v[104:105], v[10:11] op_sel:[0,1] op_sel_hi:[1,1]
v_pk_mul_f32 v[98:99], v[98:99], v[10:11] op_sel:[0,1] op_sel_hi:[1,1]
v_pk_mul_f32 v[106:107], v[106:107], v[10:11] op_sel:[0,1] op_sel_hi:[1,1]
v_exp_f32 v96, v96
v_exp_f32 v104, v104
v_exp_f32_e64 v97, v97
v_mfma_f32_16x16x32_bf16 a[92:95], v[62:65], v[24:27], a[92:95]
v_exp_f32_e64 v105, v105
buffer_load_dwordx4 a[60:63], v18, s[64:67], s47 offen offset:1024 sc1
v_exp_f32 v98, v98
v_exp_f32 v106, v106
v_exp_f32 v99, v99
v_exp_f32 v107, v107
v_pk_fma_f32 v[96:97], v[96:97], v[22:23], v[22:23] op_sel:[0,1,1] op_sel_hi:[1,1,1]
v_pk_fma_f32 v[104:105], v[104:105], v[22:23], v[22:23] op_sel:[0,1,1] op_sel_hi:[1,1,1]
v_pk_fma_f32 v[98:99], v[98:99], v[22:23], v[22:23] op_sel:[0,1,1] op_sel_hi:[1,1,1]
v_pk_fma_f32 v[106:107], v[106:107], v[22:23], v[22:23] op_sel:[0,1,1] op_sel_hi:[1,1,1]
v_rcp_f32 v96, v96
v_rcp_f32 v104, v104
v_rcp_f32 v97, v97
v_rcp_f32 v105, v105
v_rcp_f32 v98, v98
v_rcp_f32 v106, v106
v_rcp_f32_e64 v99, v99
s_xor_b32 s47, s37, 0x740000
buffer_load_dwordx4 a[64:67], v18, s[64:67], s47 offen offset:0 sc1
v_rcp_f32_e64 v107, v107
v_pk_mul_f32 v[100:101], v[100:101], v[96:97]
v_mov_b32_e64 v76, 1
s_waitcnt vmcnt(8)
s_mov_b64 exec, 1
buffer_store_dword v76, off, s[16:19], s74 sc1
s_mov_b64 exec, -1
s_nop 0
v_pk_mul_f32 v[108:109], v[108:109], v[104:105]
v_pk_mul_f32 v[102:103], v[102:103], v[98:99]
v_pk_mul_f32 v[110:111], v[110:111], v[106:107]
s_add_u32 s40, s54, 4286579712
v_cvt_pk_bf16_f32 v96, v100, v101
v_cvt_pk_bf16_f32 v98, v108, v109
v_cvt_pk_bf16_f32 v97, v102, v103
v_cvt_pk_bf16_f32 v99, v110, v111
buffer_store_dwordx4 v[96:99], v18, s[20:23], s40 offen sc1
v_accvgpr_read_b32 v80, a80
v_accvgpr_read_b32 v81, a81
v_mfma_f32_16x16x32_bf16 a[96:99], v[50:53], v[26:29], a[96:99]
v_accvgpr_read_b32 v82, a82
buffer_load_dwordx4 a[68:71], v18, s[64:67], s47 offen offset:1024 sc1
v_accvgpr_read_b32 v83, a83
v_accvgpr_read_b32 v84, a84
v_accvgpr_read_b32 v85, a85
v_accvgpr_read_b32 v86, a86
v_accvgpr_read_b32 v87, a87
v_accvgpr_read_b32 v88, a88
v_mfma_f32_16x16x32_bf16 a[100:103], v[54:57], v[26:29], a[100:103]
v_accvgpr_read_b32 v89, a89
v_accvgpr_read_b32 v90, a90
v_accvgpr_read_b32 v91, a91
v_accvgpr_read_b32 v92, a92
v_accvgpr_read_b32 v93, a93
v_accvgpr_read_b32 v94, a94
v_accvgpr_read_b32 v95, a95
v_mfma_f32_16x16x32_bf16 a[104:107], v[58:61], v[26:29], a[104:107]
s_xor_b32 s47, s37, 0x840000
buffer_load_dwordx4 a[72:75], v18, s[64:67], s47 offen offset:0 sc1
v_pk_mul_f32 v[80:81], v[80:81], v[12:13] op_sel:[0,0] op_sel_hi:[1,0]
v_pk_mul_f32 v[88:89], v[88:89], v[12:13] op_sel:[0,0] op_sel_hi:[1,0]
v_pk_mul_f32 v[82:83], v[82:83], v[12:13] op_sel:[0,0] op_sel_hi:[1,0]
v_pk_mul_f32 v[90:91], v[90:91], v[12:13] op_sel:[0,0] op_sel_hi:[1,0]
v_exp_f32 v80, v80
v_exp_f32 v88, v88
v_exp_f32_e64 v81, v81
v_mfma_f32_16x16x32_bf16 a[108:111], v[62:65], v[26:29], a[108:111]
v_exp_f32 v89, v89
v_exp_f32 v82, v82
v_exp_f32 v90, v90
v_exp_f32 v83, v83
v_exp_f32_e64 v91, v91
v_pk_fma_f32 v[80:81], v[80:81], v[24:25], v[24:25] op_sel:[0,1,1] op_sel_hi:[1,1,1]
v_pk_fma_f32 v[88:89], v[88:89], v[24:25], v[24:25] op_sel:[0,1,1] op_sel_hi:[1,1,1]
buffer_load_dwordx4 a[76:79], v18, s[64:67], s47 offen offset:1024 sc1
v_pk_fma_f32 v[82:83], v[82:83], v[24:25], v[24:25] op_sel:[0,1,1] op_sel_hi:[1,1,1]
v_pk_fma_f32 v[90:91], v[90:91], v[24:25], v[24:25] op_sel:[0,1,1] op_sel_hi:[1,1,1]
v_rcp_f32 v80, v80
v_rcp_f32 v88, v88
v_rcp_f32 v81, v81
v_rcp_f32 v89, v89
v_rcp_f32 v82, v82
v_rcp_f32 v90, v90
v_rcp_f32 v83, v83
v_rcp_f32 v91, v91
v_pk_mul_f32 v[84:85], v[84:85], v[80:81]
v_pk_mul_f32 v[92:93], v[92:93], v[88:89]
v_pk_mul_f32 v[86:87], v[86:87], v[82:83]
v_pk_mul_f32 v[94:95], v[94:95], v[90:91]
s_add_u32 s40, s54, 4286580736
s_xor_b32 s47, s37, 0x240000
buffer_load_dwordx4 a[80:83], v18, s[64:67], s47 offen offset:0 sc1
v_cvt_pk_bf16_f32 v80, v84, v85
v_cvt_pk_bf16_f32 v82, v92, v93
v_cvt_pk_bf16_f32 v81, v86, v87
v_cvt_pk_bf16_f32 v83, v94, v95
buffer_store_dwordx4 v[80:83], v18, s[20:23], s40 offen sc1
v_accvgpr_read_b32 v96, a96
v_accvgpr_read_b32 v97, a97
v_mfma_f32_16x16x32_bf16 a[112:115], v[50:53], v[28:31], a[112:115]
v_accvgpr_read_b32 v98, a98
v_accvgpr_read_b32 v99, a99
v_accvgpr_read_b32 v100, a100
v_accvgpr_read_b32 v101, a101
v_accvgpr_read_b32 v102, a102
v_accvgpr_read_b32 v103, a103
v_accvgpr_read_b32 v104, a104
buffer_load_dwordx4 a[84:87], v18, s[64:67], s47 offen offset:1024 sc1
v_mfma_f32_16x16x32_bf16 a[116:119], v[54:57], v[28:31], a[116:119]
v_accvgpr_read_b32 v105, a105
v_accvgpr_read_b32 v106, a106
v_accvgpr_read_b32 v107, a107
v_accvgpr_read_b32 v108, a108
v_accvgpr_read_b32 v109, a109
v_accvgpr_read_b32 v110, a110
v_accvgpr_read_b32 v111, a111
v_mfma_f32_16x16x32_bf16 a[120:123], v[58:61], v[28:31], a[120:123]
v_pk_mul_f32 v[96:97], v[96:97], v[12:13] op_sel:[0,1] op_sel_hi:[1,1]
v_pk_mul_f32 v[104:105], v[104:105], v[12:13] op_sel:[0,1] op_sel_hi:[1,1]
v_pk_mul_f32 v[98:99], v[98:99], v[12:13] op_sel:[0,1] op_sel_hi:[1,1]
v_pk_mul_f32 v[106:107], v[106:107], v[12:13] op_sel:[0,1] op_sel_hi:[1,1]
v_exp_f32 v96, v96
v_exp_f32 v104, v104
s_xor_b32 s47, s37, 0x2c0000
buffer_load_dwordx4 a[88:91], v18, s[64:67], s47 offen offset:0 sc1
v_exp_f32_e64 v97, v97
v_mfma_f32_16x16x32_bf16 a[124:127], v[62:65], v[28:31], a[124:127]
v_exp_f32 v105, v105
v_exp_f32 v98, v98
v_exp_f32 v106, v106
v_exp_f32 v99, v99
v_exp_f32_e64 v107, v107
v_pk_fma_f32 v[96:97], v[96:97], v[26:27], v[26:27] op_sel:[0,1,1] op_sel_hi:[1,1,1]
v_pk_fma_f32 v[104:105], v[104:105], v[26:27], v[26:27] op_sel:[0,1,1] op_sel_hi:[1,1,1]
v_pk_fma_f32 v[98:99], v[98:99], v[26:27], v[26:27] op_sel:[0,1,1] op_sel_hi:[1,1,1]
v_pk_fma_f32 v[106:107], v[106:107], v[26:27], v[26:27] op_sel:[0,1,1] op_sel_hi:[1,1,1]
v_rcp_f32 v96, v96
v_rcp_f32 v104, v104
v_rcp_f32 v97, v97
v_rcp_f32 v105, v105
buffer_load_dwordx4 a[92:95], v18, s[64:67], s47 offen offset:1024 sc1
v_rcp_f32 v98, v98
v_rcp_f32 v106, v106
v_rcp_f32 v99, v99
v_rcp_f32 v107, v107
v_pk_mul_f32 v[100:101], v[100:101], v[96:97]
v_pk_mul_f32 v[108:109], v[108:109], v[104:105]
v_pk_mul_f32 v[102:103], v[102:103], v[98:99]
v_pk_mul_f32 v[110:111], v[110:111], v[106:107]
s_add_u32 s40, s54, 4286581760
v_cvt_pk_bf16_f32 v96, v100, v101
v_cvt_pk_bf16_f32 v98, v108, v109
v_cvt_pk_bf16_f32 v97, v102, v103
v_cvt_pk_bf16_f32 v99, v110, v111
buffer_store_dwordx4 v[96:99], v18, s[20:23], s40 offen sc1
v_accvgpr_read_b32 v80, a112
s_xor_b32 s47, s37, 0x340000
buffer_load_dwordx4 a[96:99], v18, s[64:67], s47 offen offset:0 sc1
v_accvgpr_read_b32 v81, a113
v_mfma_f32_16x16x32_bf16 a[128:131], v[50:53], v[30:33], a[128:131]
v_accvgpr_read_b32 v82, a114
v_accvgpr_read_b32 v83, a115
v_accvgpr_read_b32 v84, a116
v_accvgpr_read_b32 v85, a117
v_accvgpr_read_b32 v86, a118
v_accvgpr_read_b32 v87, a119
v_accvgpr_read_b32 v88, a120
v_mfma_f32_16x16x32_bf16 a[132:135], v[54:57], v[30:33], a[132:135]
v_accvgpr_read_b32 v89, a121
v_accvgpr_read_b32 v90, a122
v_accvgpr_read_b32 v91, a123
v_accvgpr_read_b32 v92, a124
v_accvgpr_read_b32 v93, a125
buffer_load_dwordx4 a[100:103], v18, s[64:67], s47 offen offset:1024 sc1
v_accvgpr_read_b32 v94, a126
v_accvgpr_read_b32 v95, a127
v_mfma_f32_16x16x32_bf16 a[136:139], v[58:61], v[30:33], a[136:139]
v_pk_mul_f32 v[80:81], v[80:81], v[14:15] op_sel:[0,0] op_sel_hi:[1,0]
v_pk_mul_f32 v[88:89], v[88:89], v[14:15] op_sel:[0,0] op_sel_hi:[1,0]
v_pk_mul_f32 v[82:83], v[82:83], v[14:15] op_sel:[0,0] op_sel_hi:[1,0]
v_pk_mul_f32 v[90:91], v[90:91], v[14:15] op_sel:[0,0] op_sel_hi:[1,0]
v_exp_f32 v80, v80
v_exp_f32 v88, v88
v_exp_f32_e64 v81, v81
v_mfma_f32_16x16x32_bf16 a[140:143], v[62:65], v[30:33], a[140:143]
v_exp_f32 v89, v89
v_exp_f32 v82, v82
v_exp_f32 v90, v90
v_exp_f32 v83, v83
s_xor_b32 s47, s37, 0x3c0000
buffer_load_dwordx4 a[104:107], v18, s[64:67], s47 offen offset:0 sc1
v_exp_f32_e64 v91, v91
v_pk_fma_f32 v[80:81], v[80:81], v[28:29], v[28:29] op_sel:[0,1,1] op_sel_hi:[1,1,1]
v_pk_fma_f32 v[88:89], v[88:89], v[28:29], v[28:29] op_sel:[0,1,1] op_sel_hi:[1,1,1]
v_pk_fma_f32 v[82:83], v[82:83], v[28:29], v[28:29] op_sel:[0,1,1] op_sel_hi:[1,1,1]
v_pk_fma_f32 v[90:91], v[90:91], v[28:29], v[28:29] op_sel:[0,1,1] op_sel_hi:[1,1,1]
v_rcp_f32 v80, v80
v_rcp_f32 v88, v88
v_rcp_f32 v81, v81
v_rcp_f32 v89, v89
v_rcp_f32 v82, v82
v_rcp_f32 v90, v90
v_rcp_f32 v83, v83
v_rcp_f32 v91, v91
v_pk_mul_f32 v[84:85], v[84:85], v[80:81]
v_pk_mul_f32 v[92:93], v[92:93], v[88:89]
buffer_load_dwordx4 a[108:111], v18, s[64:67], s47 offen offset:1024 sc1
v_pk_mul_f32 v[86:87], v[86:87], v[82:83]
v_pk_mul_f32 v[94:95], v[94:95], v[90:91]
s_add_u32 s40, s54, 4286582784
v_cvt_pk_bf16_f32 v80, v84, v85
v_cvt_pk_bf16_f32 v82, v92, v93
v_cvt_pk_bf16_f32 v81, v86, v87
v_cvt_pk_bf16_f32 v83, v94, v95
buffer_store_dwordx4 v[80:83], v18, s[20:23], s40 offen sc1
v_accvgpr_read_b32 v96, a128
v_accvgpr_read_b32 v97, a129
v_mfma_f32_16x16x32_bf16 v[144:147], v[50:53], v[32:35], v[144:147]
v_accvgpr_read_b32 v98, a130
v_accvgpr_read_b32 v99, a131
v_accvgpr_read_b32 v100, a132
v_accvgpr_read_b32 v101, a133
s_xor_b32 s47, s37, 0x600000
buffer_load_dwordx4 a[112:115], v18, s[64:67], s47 offen offset:0 sc1
v_accvgpr_read_b32 v102, a134
v_accvgpr_read_b32 v103, a135
v_accvgpr_read_b32 v104, a136
v_mfma_f32_16x16x32_bf16 v[148:151], v[54:57], v[32:35], v[148:151]
v_accvgpr_read_b32 v105, a137
v_accvgpr_read_b32 v106, a138
v_accvgpr_read_b32 v107, a139
v_accvgpr_read_b32 v108, a140
v_accvgpr_read_b32 v109, a141
v_accvgpr_read_b32 v110, a142
v_accvgpr_read_b32 v111, a143
v_mfma_f32_16x16x32_bf16 v[152:155], v[58:61], v[32:35], v[152:155]
v_pk_mul_f32 v[96:97], v[96:97], v[14:15] op_sel:[0,1] op_sel_hi:[1,1]
v_pk_mul_f32 v[104:105], v[104:105], v[14:15] op_sel:[0,1] op_sel_hi:[1,1]
v_pk_mul_f32 v[98:99], v[98:99], v[14:15] op_sel:[0,1] op_sel_hi:[1,1]
buffer_load_dwordx4 a[116:119], v18, s[64:67], s47 offen offset:1024 sc1
v_pk_mul_f32 v[106:107], v[106:107], v[14:15] op_sel:[0,1] op_sel_hi:[1,1]
v_exp_f32 v96, v96
v_exp_f32 v104, v104
v_exp_f32_e64 v97, v97
v_mfma_f32_16x16x32_bf16 v[156:159], v[62:65], v[32:35], v[156:159]
v_exp_f32 v105, v105
v_exp_f32 v98, v98
v_exp_f32 v106, v106
v_exp_f32 v99, v99
v_exp_f32 v107, v107
v_xor_b32 v76, s35, v18
v_and_b32 v78, 0x3c0, v76
v_add_u32 v76, v76, v78
v_mov_b32 v78, 2
s_mov_b32 exec_lo, 0xf
s_mov_b32 exec_hi, 0xf
buffer_load_dword v78, v76, s[16:19], s73 offen sc1
s_mov_b64 exec, -1
s_nop 0
v_pk_fma_f32 v[96:97], v[96:97], v[30:31], v[30:31] op_sel:[0,1,1] op_sel_hi:[1,1,1]
v_pk_fma_f32 v[104:105], v[104:105], v[30:31], v[30:31] op_sel:[0,1,1] op_sel_hi:[1,1,1]
v_pk_fma_f32 v[98:99], v[98:99], v[30:31], v[30:31] op_sel:[0,1,1] op_sel_hi:[1,1,1]
v_pk_fma_f32 v[106:107], v[106:107], v[30:31], v[30:31] op_sel:[0,1,1] op_sel_hi:[1,1,1]
v_rcp_f32_e64 v96, v96
s_xor_b32 s47, s37, 0x680000
buffer_load_dwordx4 a[120:123], v18, s[64:67], s47 offen offset:0 sc1
v_rcp_f32 v104, v104
v_rcp_f32 v97, v97
v_rcp_f32 v105, v105
v_rcp_f32 v98, v98
v_rcp_f32 v106, v106
v_rcp_f32 v99, v99
v_rcp_f32_e64 v107, v107
v_pk_mul_f32 v[100:101], v[100:101], v[96:97]
v_pk_mul_f32 v[108:109], v[108:109], v[104:105]
v_pk_mul_f32 v[102:103], v[102:103], v[98:99]
v_pk_mul_f32 v[110:111], v[110:111], v[106:107]
s_add_u32 s40, s54, 4286583808
v_cvt_pk_bf16_f32 v96, v100, v101
v_cvt_pk_bf16_f32 v98, v108, v109
v_cvt_pk_bf16_f32 v97, v102, v103
buffer_load_dwordx4 a[124:127], v18, s[64:67], s47 offen offset:1024 sc1
v_cvt_pk_bf16_f32 v99, v110, v111
buffer_store_dwordx4 v[96:99], v18, s[20:23], s40 offen sc1
v_pk_mul_f32 v[144:145], v[144:145], v[16:17] op_sel:[0,0] op_sel_hi:[1,0]
v_pk_mul_f32 v[152:153], v[152:153], v[16:17] op_sel:[0,0] op_sel_hi:[1,0]
v_pk_mul_f32 v[146:147], v[146:147], v[16:17] op_sel:[0,0] op_sel_hi:[1,0]
v_pk_mul_f32 v[154:155], v[154:155], v[16:17] op_sel:[0,0] op_sel_hi:[1,0]
v_exp_f32_e64 v144, v144
v_mfma_f32_16x16x32_bf16 v[160:163], v[50:53], v[34:37], v[160:163]
v_exp_f32_e64 v152, v152
v_mfma_f32_16x16x32_bf16 v[164:167], v[54:57], v[34:37], v[164:167]
v_exp_f32 v145, v145
v_exp_f32 v153, v153
v_exp_f32 v146, v146
v_exp_f32 v154, v154
v_exp_f32_e64 v147, v147
v_mfma_f32_16x16x32_bf16 v[168:171], v[58:61], v[34:37], v[168:171]
v_exp_f32_e64 v155, v155
v_pk_fma_f32 v[144:145], v[144:145], v[32:33], v[32:33] op_sel:[0,1,1] op_sel_hi:[1,1,1]
v_pk_fma_f32 v[152:153], v[152:153], v[32:33], v[32:33] op_sel:[0,1,1] op_sel_hi:[1,1,1]
v_pk_fma_f32 v[146:147], v[146:147], v[32:33], v[32:33] op_sel:[0,1,1] op_sel_hi:[1,1,1]
v_pk_fma_f32 v[154:155], v[154:155], v[32:33], v[32:33] op_sel:[0,1,1] op_sel_hi:[1,1,1]
v_rcp_f32_e64 v144, v144
v_mfma_f32_16x16x32_bf16 v[172:175], v[62:65], v[34:37], v[172:175]
v_rcp_f32 v152, v152
v_rcp_f32 v145, v145
v_rcp_f32 v153, v153
v_rcp_f32 v146, v146
v_rcp_f32 v154, v154
v_rcp_f32 v147, v147
v_rcp_f32_e64 v155, v155
v_pk_mul_f32 v[148:149], v[148:149], v[144:145]
v_pk_mul_f32 v[156:157], v[156:157], v[152:153]
v_pk_mul_f32 v[150:151], v[150:151], v[146:147]
v_pk_mul_f32 v[158:159], v[158:159], v[154:155]
s_add_u32 s40, s54, 4286584832
v_cvt_pk_bf16_f32 v144, v148, v149
v_cvt_pk_bf16_f32 v146, v156, v157
v_cvt_pk_bf16_f32 v145, v150, v151
v_cvt_pk_bf16_f32 v147, v158, v159
buffer_store_dwordx4 v[144:147], v18, s[20:23], s40 offen sc1
v_pk_mul_f32 v[160:161], v[160:161], v[16:17] op_sel:[0,1] op_sel_hi:[1,1]
v_mov_b32_e64 v50, v48
v_pk_mul_f32 v[168:169], v[168:169], v[16:17] op_sel:[0,1] op_sel_hi:[1,1]
v_pk_mul_f32 v[162:163], v[162:163], v[16:17] op_sel:[0,1] op_sel_hi:[1,1]
v_pk_mul_f32 v[170:171], v[170:171], v[16:17] op_sel:[0,1] op_sel_hi:[1,1]
v_mov_b32 v54, v49
v_exp_f32 v160, v160
v_exp_f32 v168, v168
v_exp_f32 v161, v161
v_mfma_f32_16x16x32_bf16 v[176:179], v[50:53], v[20:23], v[176:179]
v_exp_f32 v169, v169
v_exp_f32 v162, v162
v_exp_f32 v170, v170
v_exp_f32 v163, v163
v_mfma_f32_16x16x32_bf16 v[180:183], v[54:57], v[20:23], v[180:183]
v_exp_f32_e64 v171, v171
v_pk_fma_f32 v[160:161], v[160:161], v[34:35], v[34:35] op_sel:[0,1,1] op_sel_hi:[1,1,1]
v_pk_fma_f32 v[168:169], v[168:169], v[34:35], v[34:35] op_sel:[0,1,1] op_sel_hi:[1,1,1]
v_pk_fma_f32 v[162:163], v[162:163], v[34:35], v[34:35] op_sel:[0,1,1] op_sel_hi:[1,1,1]
v_pk_fma_f32 v[170:171], v[170:171], v[34:35], v[34:35] op_sel:[0,1,1] op_sel_hi:[1,1,1]
v_rcp_f32_e64 v160, v160
v_mfma_f32_16x16x32_bf16 v[184:187], v[50:53], v[22:25], v[184:187]
v_mfma_f32_16x16x32_bf16 v[188:191], v[54:57], v[22:25], v[188:191]
v_rcp_f32 v168, v168
v_rcp_f32 v161, v161
v_rcp_f32 v169, v169
v_rcp_f32 v162, v162
v_rcp_f32 v170, v170
v_rcp_f32 v163, v163
v_rcp_f32_e64 v171, v171
v_pk_mul_f32 v[164:165], v[164:165], v[160:161]
v_pk_mul_f32 v[172:173], v[172:173], v[168:169]
v_pk_mul_f32 v[166:167], v[166:167], v[162:163]
v_pk_mul_f32 v[174:175], v[174:175], v[170:171]
s_add_u32 s40, s54, 4286585856
v_cvt_pk_bf16_f32 v160, v164, v165
v_cvt_pk_bf16_f32 v162, v172, v173
v_cvt_pk_bf16_f32 v161, v166, v167
v_cvt_pk_bf16_f32 v163, v174, v175
buffer_store_dwordx4 v[160:163], v18, s[20:23], s40 offen sc1
v_pk_mul_f32 v[176:177], v[176:177], v[10:11] op_sel:[0,0] op_sel_hi:[1,0]
v_pk_mul_f32 v[184:185], v[184:185], v[10:11] op_sel:[0,1] op_sel_hi:[1,1]
v_pk_mul_f32 v[178:179], v[178:179], v[10:11] op_sel:[0,0] op_sel_hi:[1,0]
v_pk_mul_f32 v[186:187], v[186:187], v[10:11] op_sel:[0,1] op_sel_hi:[1,1]
v_exp_f32_e64 v176, v176
v_mfma_f32_16x16x32_bf16 v[192:195], v[50:53], v[24:27], v[192:195]
v_exp_f32_e64 v184, v184
v_mfma_f32_16x16x32_bf16 v[196:199], v[54:57], v[24:27], v[196:199]
v_exp_f32 v177, v177
v_exp_f32 v185, v185
v_exp_f32 v178, v178
v_exp_f32 v186, v186
v_exp_f32_e64 v179, v179
v_mfma_f32_16x16x32_bf16 v[200:203], v[50:53], v[26:29], v[200:203]
v_exp_f32_e64 v187, v187
v_pk_fma_f32 v[176:177], v[176:177], v[20:21], v[20:21] op_sel:[0,1,1] op_sel_hi:[1,1,1]
v_pk_fma_f32 v[184:185], v[184:185], v[22:23], v[22:23] op_sel:[0,1,1] op_sel_hi:[1,1,1]
v_pk_fma_f32 v[178:179], v[178:179], v[20:21], v[20:21] op_sel:[0,1,1] op_sel_hi:[1,1,1]
v_pk_fma_f32 v[186:187], v[186:187], v[22:23], v[22:23] op_sel:[0,1,1] op_sel_hi:[1,1,1]
v_rcp_f32_e64 v176, v176
v_mfma_f32_16x16x32_bf16 v[204:207], v[54:57], v[26:29], v[204:207]
v_rcp_f32 v184, v184
v_rcp_f32 v177, v177
v_rcp_f32 v185, v185
v_rcp_f32 v178, v178
v_rcp_f32 v186, v186
v_rcp_f32 v179, v179
v_rcp_f32_e64 v187, v187
v_pk_mul_f32 v[180:181], v[180:181], v[176:177]
v_pk_mul_f32 v[188:189], v[188:189], v[184:185]
v_pk_mul_f32 v[182:183], v[182:183], v[178:179]
v_pk_mul_f32 v[190:191], v[190:191], v[186:187]
s_add_u32 s40, s55, 0
s_nop 0
v_cvt_pk_bf16_f32 v176, v180, v181
v_cvt_pk_bf16_f32 v178, v188, v189
v_cvt_pk_bf16_f32 v177, v182, v183
v_cvt_pk_bf16_f32 v179, v190, v191
v_permlane32_swap_b32 v176, v178
s_nop 0
v_permlane32_swap_b32 v177, v179
s_nop 0
buffer_store_dwordx4 v[176:179], v19, s[20:23], s40 offen sc1
v_pk_mul_f32 v[192:193], v[192:193], v[12:13] op_sel:[0,0] op_sel_hi:[1,0]
v_pk_mul_f32 v[200:201], v[200:201], v[12:13] op_sel:[0,1] op_sel_hi:[1,1]
v_pk_mul_f32 v[194:195], v[194:195], v[12:13] op_sel:[0,0] op_sel_hi:[1,0]
v_pk_mul_f32 v[202:203], v[202:203], v[12:13] op_sel:[0,1] op_sel_hi:[1,1]
v_exp_f32_e64 v192, v192
v_mfma_f32_16x16x32_bf16 v[208:211], v[50:53], v[28:31], v[208:211]
v_exp_f32_e64 v200, v200
v_mfma_f32_16x16x32_bf16 v[212:215], v[54:57], v[28:31], v[212:215]
v_exp_f32 v193, v193
v_exp_f32 v201, v201
v_exp_f32 v194, v194
v_exp_f32 v202, v202
v_exp_f32_e64 v195, v195
s_waitcnt vmcnt(6)
v_cmp_gt_u32 vcc, 1, v78
s_nop 0
s_cmp_lg_u32 vcc_hi, 0
s_cselect_b32 s62, 0, 0x1200000
v_mfma_f32_16x16x32_bf16 v[216:219], v[50:53], v[30:33], v[216:219]
s_add_u32 m0, s39, 0
s_xor_b32 s46, s32, 0xc00000
buffer_load_dwordx4 v18, s[60:63], s46 offen offset:0 sc1 lds
v_exp_f32 v203, v203
v_pk_fma_f32 v[192:193], v[192:193], v[24:25], v[24:25] op_sel:[0,1,1] op_sel_hi:[1,1,1]
v_pk_fma_f32 v[200:201], v[200:201], v[26:27], v[26:27] op_sel:[0,1,1] op_sel_hi:[1,1,1]
v_pk_fma_f32 v[194:195], v[194:195], v[24:25], v[24:25] op_sel:[0,1,1] op_sel_hi:[1,1,1]
v_pk_fma_f32 v[202:203], v[202:203], v[26:27], v[26:27] op_sel:[0,1,1] op_sel_hi:[1,1,1]
v_rcp_f32_e64 v192, v192
v_mfma_f32_16x16x32_bf16 v[220:223], v[54:57], v[30:33], v[220:223]
buffer_load_dwordx4 v18, s[60:63], s46 offen offset:1024 sc1 lds
v_rcp_f32 v200, v200
v_rcp_f32 v193, v193
v_rcp_f32 v201, v201
v_rcp_f32 v194, v194
v_rcp_f32 v202, v202
v_rcp_f32 v195, v195
v_rcp_f32_e64 v203, v203
v_pk_mul_f32 v[196:197], v[196:197], v[192:193]
buffer_load_dwordx4 v18, s[60:63], s46 offen offset:2048 sc1 lds
v_pk_mul_f32 v[204:205], v[204:205], v[200:201]
v_pk_mul_f32 v[198:199], v[198:199], v[194:195]
v_pk_mul_f32 v[206:207], v[206:207], v[202:203]
s_add_u32 s40, s55, 2048
v_cvt_pk_bf16_f32 v192, v196, v197
v_cvt_pk_bf16_f32 v194, v204, v205
v_cvt_pk_bf16_f32 v193, v198, v199
v_cvt_pk_bf16_f32 v195, v206, v207
buffer_load_dwordx4 v18, s[60:63], s46 offen offset:3072 sc1 lds
v_permlane32_swap_b32 v192, v194
v_permlane32_swap_b32 v193, v195
buffer_store_dwordx4 v[192:195], v19, s[20:23], s40 offen sc1
v_pk_mul_f32 v[208:209], v[208:209], v[14:15] op_sel:[0,0] op_sel_hi:[1,0]
v_pk_mul_f32 v[216:217], v[216:217], v[14:15] op_sel:[0,1] op_sel_hi:[1,1]
v_pk_mul_f32 v[210:211], v[210:211], v[14:15] op_sel:[0,0] op_sel_hi:[1,0]
v_pk_mul_f32 v[218:219], v[218:219], v[14:15] op_sel:[0,1] op_sel_hi:[1,1]
v_exp_f32_e64 v208, v208
s_add_u32 m0, s39, 16384
s_xor_b32 s46, s32, 0xe00000
buffer_load_dwordx4 v18, s[60:63], s46 offen offset:0 sc1 lds
v_mfma_f32_16x16x32_bf16 v[224:227], v[50:53], v[32:35], v[224:227]
v_exp_f32_e64 v216, v216
v_mfma_f32_16x16x32_bf16 v[228:231], v[54:57], v[32:35], v[228:231]
v_exp_f32 v209, v209
v_exp_f32 v217, v217
v_exp_f32 v210, v210
v_exp_f32 v218, v218
v_exp_f32_e64 v211, v211
buffer_load_dwordx4 v18, s[60:63], s46 offen offset:1024 sc1 lds
v_mfma_f32_16x16x32_bf16 v[232:235], v[50:53], v[34:37], v[232:235]
v_exp_f32_e64 v219, v219
v_pk_fma_f32 v[208:209], v[208:209], v[28:29], v[28:29] op_sel:[0,1,1] op_sel_hi:[1,1,1]
v_pk_fma_f32 v[216:217], v[216:217], v[30:31], v[30:31] op_sel:[0,1,1] op_sel_hi:[1,1,1]
v_pk_fma_f32 v[210:211], v[210:211], v[28:29], v[28:29] op_sel:[0,1,1] op_sel_hi:[1,1,1]
v_pk_fma_f32 v[218:219], v[218:219], v[30:31], v[30:31] op_sel:[0,1,1] op_sel_hi:[1,1,1]
v_rcp_f32_e64 v208, v208
v_mfma_f32_16x16x32_bf16 v[236:239], v[54:57], v[34:37], v[236:239]
buffer_load_dwordx4 v18, s[60:63], s46 offen offset:2048 sc1 lds
v_rcp_f32 v216, v216
v_rcp_f32 v209, v209
v_rcp_f32 v217, v217
v_rcp_f32 v210, v210
v_rcp_f32 v218, v218
v_rcp_f32 v211, v211
v_rcp_f32_e64 v219, v219
v_pk_mul_f32 v[212:213], v[212:213], v[208:209]
buffer_load_dwordx4 v18, s[60:63], s46 offen offset:3072 sc1 lds
v_pk_mul_f32 v[220:221], v[220:221], v[216:217]
v_pk_mul_f32 v[214:215], v[214:215], v[210:211]
v_pk_mul_f32 v[222:223], v[222:223], v[218:219]
s_add_u32 s40, s55, 4096
v_cvt_pk_bf16_f32 v208, v212, v213
v_cvt_pk_bf16_f32 v210, v220, v221
v_cvt_pk_bf16_f32 v209, v214, v215
v_cvt_pk_bf16_f32 v211, v222, v223
v_permlane32_swap_b32 v208, v210
s_nop 0
v_permlane32_swap_b32 v209, v211
s_nop 0
buffer_store_dwordx4 v[208:211], v19, s[20:23], s40 offen sc1
v_pk_mul_f32 v[224:225], v[224:225], v[16:17] op_sel:[0,0] op_sel_hi:[1,0]
v_pk_mul_f32 v[232:233], v[232:233], v[16:17] op_sel:[0,1] op_sel_hi:[1,1]
v_pk_mul_f32 v[226:227], v[226:227], v[16:17] op_sel:[0,0] op_sel_hi:[1,0]
v_pk_mul_f32 v[234:235], v[234:235], v[16:17] op_sel:[0,1] op_sel_hi:[1,1]
v_exp_f32 v224, v224
v_exp_f32 v232, v232
v_exp_f32 v225, v225
v_exp_f32 v233, v233
v_exp_f32 v226, v226
v_exp_f32 v234, v234
v_exp_f32 v227, v227
v_exp_f32 v235, v235
v_pk_fma_f32 v[224:225], v[224:225], v[32:33], v[32:33] op_sel:[0,1,1] op_sel_hi:[1,1,1]
v_pk_fma_f32 v[232:233], v[232:233], v[34:35], v[34:35] op_sel:[0,1,1] op_sel_hi:[1,1,1]
v_pk_fma_f32 v[226:227], v[226:227], v[32:33], v[32:33] op_sel:[0,1,1] op_sel_hi:[1,1,1]
v_pk_fma_f32 v[234:235], v[234:235], v[34:35], v[34:35] op_sel:[0,1,1] op_sel_hi:[1,1,1]
v_rcp_f32 v224, v224
v_rcp_f32 v232, v232
v_rcp_f32 v225, v225
v_rcp_f32 v233, v233
v_rcp_f32 v226, v226
v_rcp_f32 v234, v234
v_rcp_f32 v227, v227
v_rcp_f32 v235, v235
v_pk_mul_f32 v[228:229], v[228:229], v[224:225]
v_pk_mul_f32 v[236:237], v[236:237], v[232:233]
v_pk_mul_f32 v[230:231], v[230:231], v[226:227]
v_pk_mul_f32 v[238:239], v[238:239], v[234:235]
s_add_u32 s40, s55, 6144
v_cvt_pk_bf16_f32 v224, v228, v229
v_cvt_pk_bf16_f32 v226, v236, v237
v_cvt_pk_bf16_f32 v225, v230, v231
v_cvt_pk_bf16_f32 v227, v238, v239
v_permlane32_swap_b32 v224, v226
s_nop 0
v_permlane32_swap_b32 v225, v227
buffer_store_dwordx4 v[224:227], v19, s[20:23], s40 offen sc1
s_branch L_g1_fin_1002
s_nop 7
s_nop 7
L_g1_sig_1034:
v_mov_b32_e64 v74, 1
v_mov_b32 v75, 0
s_mov_b64 exec, 1
buffer_atomic_add v74, v75, s[28:31], s51 offen sc1
s_mov_b64 exec, -1
s_branch L_g1_sgr_1035
L_g1_pl_1036:
v_lshlrev_b32_e64 v74, 2, v0
s_mov_b32 m0, 162368
s_mov_b64 exec, 0xff
buffer_load_dword v74, s[28:31], 0 offen sc1 lds
s_mov_b64 exec, -1
s_branch L_g1_plr_1037
L_g1_cs_1040:
s_cmp_lt_u32 s49, 32
s_cbranch_scc1 L_g1_spin_1039
buffer_load_dwordx4 v[40:43], v9, s[24:27], s53 offen offset:0 sc1
buffer_load_dwordx4 v[44:47], v9, s[24:27], s53 offen offset:16 sc1
buffer_load_dwordx4 v[48:51], v9, s[24:27], s53 offen offset:32 sc1
s_waitcnt vmcnt(0)
s_nop 0
v_min3_u32 v74, v40, v41, v42
v_min3_u32 v75, v43, v44, v45
v_min3_u32 v74, v74, v46, v47
v_min3_u32 v75, v75, v48, v49
v_min3_u32 v74, v74, v50, v51
v_min_u32_e64 v74, v74, v75
v_cmp_eq_u32 vcc, 0, v74
s_nop 0
s_and_b32 s40, vcc_lo, 0xffff
s_cbranch_scc1 L_g1_cs_1040
s_branch L_g1_ok_1038
L_g1_spin_1039:
s_sleep 4
v_min_u32 v76, 7, v0
v_lshlrev_b32_e64 v76, 2, v76
buffer_load_dword v74, v76, s[28:31], 0 offen sc1
s_waitcnt vmcnt(0)
v_cmp_gt_u32 vcc, 32, v74
s_nop 0
s_cmp_eq_u64 vcc, 0
s_cselect_b32 s49, 32, 0
s_nop 1
s_cmp_lt_u32 s49, 32
s_cbranch_scc1 L_g1_spin_1039
v_and_b32 v76, 15, v0
v_lshlrev_b32 v76, 3, v76
s_add_u32 s52, s44, 0
s_lshl_b32 s52, s52, 3
buffer_load_dwordx2 v[20:21], v76, s[24:27], s52 offen offset:0 sc1
buffer_load_dwordx2 v[22:23], v76, s[24:27], s52 offen offset:128 sc1
buffer_load_dwordx2 v[24:25], v76, s[24:27], s52 offen offset:256 sc1
buffer_load_dwordx2 v[26:27], v76, s[24:27], s52 offen offset:384 sc1
buffer_load_dwordx2 v[28:29], v76, s[24:27], s52 offen offset:512 sc1
buffer_load_dwordx2 v[30:31], v76, s[24:27], s52 offen offset:640 sc1
buffer_load_dwordx2 v[32:33], v76, s[24:27], s52 offen offset:768 sc1
buffer_load_dwordx2 v[34:35], v76, s[24:27], s52 offen offset:896 sc1
s_bfe_u32 s53, s2, 0x20003
s_lshl2_add_u32 s53, s3, s53
s_lshl1_add_u32 s53, s53, s58
s_mul_i32 s53, s53, 768
s_add_u32 s53, s53, 16384
buffer_load_dwordx4 v[40:43], v9, s[24:27], s53 offen offset:0 sc1
buffer_load_dwordx4 v[44:47], v9, s[24:27], s53 offen offset:16 sc1
buffer_load_dwordx4 v[48:51], v9, s[24:27], s53 offen offset:32 sc1
s_waitcnt vmcnt(0)
s_nop 0
v_min3_u32 v74, v40, v41, v42
v_min3_u32 v75, v43, v44, v45
v_min3_u32 v74, v74, v46, v47
v_min3_u32 v75, v75, v48, v49
v_min3_u32 v74, v74, v50, v51
v_min_u32_e64 v74, v74, v75
v_cmp_eq_u32 vcc, 0, v74
s_nop 0
s_and_b32 s40, vcc_lo, 0xffff
s_cbranch_scc1 L_g1_spin_1039
s_branch L_g1_ok_1038
L_g1_fin_1002:
s_cmp_eq_u32 s62, 0
s_cbranch_scc1 L_p2_slow_1048
L_p2_back_1049:
v_add_u32 v2, 65536, v18
v_add_u32 v3, 131072, v18
v_xor_b32_e64 v13, s35, v18
v_and_b32 v14, 0x3c0, v13
v_add_u32_e64 v13, v13, v14
s_mov_b32 s24, s16
s_mov_b32 s25, s17
s_mov_b32 s27, 0x00020000
s_cmp_eq_u32 s43, 0
s_cselect_b32 s26, 0x14000, 0
s_lshl3_add_u32 s49, s76, s77
s_lshl_b32 s49, s49, 7
s_add_u32 s49, s49, 0x10000
s_cmp_lg_u32 s62, 0
s_cbranch_scc1 L_p2_w_1050
s_waitcnt vmcnt(4)
L_p2_w_1050:
s_waitcnt vmcnt(7)
s_barrier
ds_read_b128 v[144:147], v18 offset:0
ds_read_b128 v[148:151], v18 offset:8192
ds_read_b128 v[152:155], v18 offset:1024
ds_read_b128 v[156:159], v18 offset:9216
ds_read_b128 v[160:163], v18 offset:2048
ds_read_b128 v[164:167], v18 offset:10240
ds_read_b128 v[168:171], v18 offset:3072
ds_read_b128 v[172:175], v18 offset:11264
v_mov_b32 v20, 1
s_mov_b64 exec, 1
buffer_atomic_add v20, off, s[24:27], s49 sc0 sc1
s_mov_b64 exec, -1
v_mov_b32 v79, 2
s_mov_b32 exec_lo, 0xf00
s_mov_b32 exec_hi, 0xf00
buffer_load_dword v79, v13, s[16:19], s73 offen sc1
s_mov_b64 exec, -1
v_and_b32 v9, 15, v0
v_lshrrev_b32 v10, 4, v0
v_lshlrev_b32 v9, 11, v9
v_and_b32_e64 v11, 1, v10
v_lshl_add_u32 v11, v11, 5, v9
v_lshrrev_b32_e64 v12, 1, v10
v_lshl_add_u32 v5, v12, 4, v11
v_mov_b32 v7, 2
v_mov_b32 v8, 0
s_mov_b32 s36, 0xffff0000
s_waitcnt lgkmcnt(7)
v_mfma_f32_16x16x32_bf16 v[80:83], a[176:179], v[144:147], 0
s_waitcnt lgkmcnt(6)
ds_read_b128 v[176:179], v18 offset:4096
v_mfma_f32_16x16x32_bf16 v[80:83], a[184:187], v[148:151], v[80:83]
v_cmp_gt_u32 vcc, 1, v78
s_nop 0
s_cmp_lg_u32 vcc_lo, 0
s_cbranch_scc1 L_p2_sp_1056
L_p2_sr_1057:
v_mfma_f32_16x16x32_bf16 v[84:87], a[188:191], v[148:151], 0
s_add_u32 m0, s39, 32768
s_xor_b32 s46, s32, 0x800000
ds_read_b128 v[180:183], v18 offset:12288
v_mfma_f32_16x16x32_bf16 v[84:87], a[180:183], v[144:147], v[84:87]
s_waitcnt lgkmcnt(7)
buffer_load_dwordx4 v18, s[20:23], s46 offen offset:0 sc1 lds
v_mfma_f32_16x16x32_bf16 v[92:95], a[180:183], v[152:155], 0
s_waitcnt lgkmcnt(6)
ds_read_b128 v[184:187], v18 offset:5120
v_mfma_f32_16x16x32_bf16 v[92:95], a[188:191], v[156:159], v[92:95]
buffer_load_dwordx4 v18, s[20:23], s46 offen offset:1024 sc1 lds
v_mfma_f32_16x16x32_bf16 v[88:91], a[184:187], v[156:159], 0
ds_read_b128 v[188:191], v18 offset:13312
v_mfma_f32_16x16x32_bf16 v[88:91], a[176:179], v[152:155], v[88:91]
s_waitcnt lgkmcnt(7)
buffer_load_dwordx4 v18, s[20:23], s46 offen offset:2048 sc1 lds
v_mfma_f32_16x16x32_bf16 v[96:99], a[176:179], v[160:163], 0
s_waitcnt lgkmcnt(6)
ds_read_b128 v[192:195], v18 offset:6144
v_mfma_f32_16x16x32_bf16 v[96:99], a[184:187], v[164:167], v[96:99]
buffer_load_dwordx4 v18, s[20:23], s46 offen offset:3072 sc1 lds
v_mfma_f32_16x16x32_bf16 v[100:103], a[188:191], v[164:167], 0
s_add_u32 m0, s39, 49152
s_xor_b32 s46, s32, 0xa00000
ds_read_b128 v[196:199], v18 offset:14336
v_mfma_f32_16x16x32_bf16 v[100:103], a[180:183], v[160:163], v[100:103]
s_waitcnt lgkmcnt(7)
buffer_load_dwordx4 v18, s[20:23], s46 offen offset:0 sc1 lds
v_mfma_f32_16x16x32_bf16 v[108:111], a[180:183], v[168:171], 0
s_waitcnt lgkmcnt(6)
ds_read_b128 v[200:203], v18 offset:7168
v_mfma_f32_16x16x32_bf16 v[108:111], a[188:191], v[172:175], v[108:111]
buffer_load_dwordx4 v18, s[20:23], s46 offen offset:1024 sc1 lds
v_mfma_f32_16x16x32_bf16 v[104:107], a[184:187], v[172:175], 0
ds_read_b128 v[204:207], v18 offset:15360
v_mfma_f32_16x16x32_bf16 v[104:107], a[176:179], v[168:171], v[104:107]
s_waitcnt lgkmcnt(4)
buffer_load_dwordx4 v18, s[20:23], s46 offen offset:2048 sc1 lds
v_mfma_f32_16x16x32_bf16 v[112:115], a[176:179], v[176:179], 0
s_cmp_lg_u32 s62, 0
s_cbranch_scc1 L_p2_w_1058
s_waitcnt vmcnt(9)
L_p2_w_1058:
s_waitcnt vmcnt(11)
s_barrier
v_mfma_f32_16x16x32_bf16 v[112:115], a[184:187], v[180:183], v[112:115]
buffer_load_dwordx4 v18, s[20:23], s46 offen offset:3072 sc1 lds
v_mfma_f32_16x16x32_bf16 v[116:119], a[188:191], v[180:183], 0
ds_read_b128 v[144:147], v18 offset:16384
ds_read_b128 v[148:151], v18 offset:24576
v_mfma_f32_16x16x32_bf16 v[116:119], a[180:183], v[176:179], v[116:119]
v_mfma_f32_16x16x32_bf16 v[124:127], a[180:183], v[184:187], 0
ds_read_b128 v[152:155], v18 offset:17408
v_mfma_f32_16x16x32_bf16 v[124:127], a[188:191], v[188:191], v[124:127]
v_mov_b32 v21, 1
s_mov_b64 exec, 1
buffer_atomic_add v21, off, s[24:27], s49 sc0 sc1
s_mov_b64 exec, -1
v_mfma_f32_16x16x32_bf16 v[120:123], a[184:187], v[188:191], 0
ds_read_b128 v[156:159], v18 offset:25600
v_mfma_f32_16x16x32_bf16 v[120:123], a[176:179], v[184:187], v[120:123]
s_waitcnt lgkmcnt(4)
v_mfma_f32_16x16x32_bf16 v[128:131], a[176:179], v[192:195], 0
ds_read_b128 v[160:163], v18 offset:18432
v_mfma_f32_16x16x32_bf16 v[128:131], a[184:187], v[196:199], v[128:131]
v_mfma_f32_16x16x32_bf16 v[132:135], a[188:191], v[196:199], 0
ds_read_b128 v[164:167], v18 offset:26624
v_mfma_f32_16x16x32_bf16 v[132:135], a[180:183], v[192:195], v[132:135]
v_mfma_f32_16x16x32_bf16 v[140:143], a[180:183], v[200:203], 0
ds_read_b128 v[168:171], v18 offset:19456
v_mfma_f32_16x16x32_bf16 v[140:143], a[188:191], v[204:207], v[140:143]
v_mfma_f32_16x16x32_bf16 v[136:139], a[184:187], v[204:207], 0
ds_read_b128 v[172:175], v18 offset:27648
v_mfma_f32_16x16x32_bf16 v[136:139], a[176:179], v[200:203], v[136:139]
s_waitcnt lgkmcnt(4)
v_mfma_f32_16x16x32_bf16 v[80:83], a[192:195], v[144:147], v[80:83]
ds_read_b128 v[176:179], v18 offset:20480
v_mfma_f32_16x16x32_bf16 v[80:83], a[200:203], v[148:151], v[80:83]
v_mfma_f32_16x16x32_bf16 v[84:87], a[204:207], v[148:151], v[84:87]
ds_read_b128 v[180:183], v18 offset:28672
v_mfma_f32_16x16x32_bf16 v[84:87], a[196:199], v[144:147], v[84:87]
v_mfma_f32_16x16x32_bf16 v[92:95], a[196:199], v[152:155], v[92:95]
ds_read_b128 v[184:187], v18 offset:21504
v_mfma_f32_16x16x32_bf16 v[92:95], a[204:207], v[156:159], v[92:95]
s_waitcnt vmcnt(9)
v_cmp_gt_u32 vcc, 1, v79
s_nop 0
s_cmp_lg_u64 vcc, 0
s_cbranch_scc1 L_p2_sp_1059
L_p2_sr_1060:
v_mfma_f32_16x16x32_bf16 v[88:91], a[200:203], v[156:159], v[88:91]
s_add_u32 m0, s39, 65536
s_xor_b32 s46, s32, 0xc40000
ds_read_b128 v[188:191], v18 offset:29696
v_mfma_f32_16x16x32_bf16 v[88:91], a[192:195], v[152:155], v[88:91]
s_waitcnt lgkmcnt(4)
buffer_load_dwordx4 v18, s[20:23], s46 offen offset:0 sc1 lds
v_mfma_f32_16x16x32_bf16 v[96:99], a[192:195], v[160:163], v[96:99]
ds_read_b128 v[192:195], v18 offset:22528
v_mfma_f32_16x16x32_bf16 v[96:99], a[200:203], v[164:167], v[96:99]
buffer_load_dwordx4 v18, s[20:23], s46 offen offset:1024 sc1 lds
v_mfma_f32_16x16x32_bf16 v[100:103], a[204:207], v[164:167], v[100:103]
ds_read_b128 v[196:199], v18 offset:30720
v_mfma_f32_16x16x32_bf16 v[100:103], a[196:199], v[160:163], v[100:103]
buffer_load_dwordx4 v18, s[20:23], s46 offen offset:2048 sc1 lds
v_mfma_f32_16x16x32_bf16 v[108:111], a[196:199], v[168:171], v[108:111]
ds_read_b128 v[200:203], v18 offset:23552
v_mfma_f32_16x16x32_bf16 v[108:111], a[204:207], v[172:175], v[108:111]
buffer_load_dwordx4 v18, s[20:23], s46 offen offset:3072 sc1 lds
v_mfma_f32_16x16x32_bf16 v[104:107], a[200:203], v[172:175], v[104:107]
ds_read_b128 v[204:207], v18 offset:31744
v_mfma_f32_16x16x32_bf16 v[104:107], a[192:195], v[168:171], v[104:107]
s_waitcnt lgkmcnt(4)
s_add_u32 m0, s39, 0
s_xor_b32 s46, s32, 0xe40000
v_mfma_f32_16x16x32_bf16 v[112:115], a[192:195], v[176:179], v[112:115]
s_waitcnt vmcnt(9)
s_barrier
v_mfma_f32_16x16x32_bf16 v[112:115], a[200:203], v[180:183], v[112:115]
buffer_load_dwordx4 v18, s[20:23], s46 offen offset:0 sc1 lds
v_mfma_f32_16x16x32_bf16 v[116:119], a[204:207], v[180:183], v[116:119]
s_mov_b32 s28, s64
s_mov_b32 s29, s65
ds_read_b128 v[144:147], v18 offset:32768
v_mfma_f32_16x16x32_bf16 v[116:119], a[196:199], v[176:179], v[116:119]
v_mov_b32 v22, 1
s_mov_b64 exec, 1
buffer_atomic_add v22, off, s[24:27], s49 sc0 sc1
s_mov_b64 exec, -1
v_mfma_f32_16x16x32_bf16 v[124:127], a[196:199], v[184:187], v[124:127]
s_mov_b32 s31, 0x00020000
s_andn2_b32 s40, 1, s34
ds_read_b128 v[148:151], v18 offset:40960
v_mfma_f32_16x16x32_bf16 v[124:127], a[204:207], v[188:191], v[124:127]
buffer_load_dwordx4 v18, s[20:23], s46 offen offset:1024 sc1 lds
v_mfma_f32_16x16x32_bf16 v[120:123], a[200:203], v[188:191], v[120:123]
s_xor_b32 s41, s32, 0x880000
s_add_u32 s42, s39, 81920
ds_read_b128 v[152:155], v18 offset:33792
v_mfma_f32_16x16x32_bf16 v[120:123], a[192:195], v[184:187], v[120:123]
s_waitcnt lgkmcnt(3)
ds_read_b128 v[156:159], v18 offset:41984
v_mfma_f32_16x16x32_bf16 v[128:131], a[192:195], v[192:195], v[128:131]
s_lshr_b32 s44, s39, 2
s_add_u32 s44, s44, 147456
ds_read_b128 v[160:163], v18 offset:34816
v_mfma_f32_16x16x32_bf16 v[128:131], a[200:203], v[196:199], v[128:131]
buffer_load_dwordx4 v18, s[20:23], s46 offen offset:2048 sc1 lds
v_mfma_f32_16x16x32_bf16 v[132:135], a[204:207], v[196:199], v[132:135]
ds_read_b128 v[164:167], v18 offset:43008
v_mfma_f32_16x16x32_bf16 v[132:135], a[196:199], v[192:195], v[132:135]
v_add_u32 v24, s44, v18
v_mov_b32 v25, 147456
v_mfma_f32_16x16x32_bf16 v[140:143], a[196:199], v[200:203], v[140:143]
ds_read_b128 v[168:171], v18 offset:35840
v_mfma_f32_16x16x32_bf16 v[140:143], a[204:207], v[204:207], v[140:143]
buffer_load_dwordx4 v18, s[20:23], s46 offen offset:3072 sc1 lds
v_mfma_f32_16x16x32_bf16 v[136:139], a[200:203], v[204:207], v[136:139]
ds_read_b128 v[172:175], v18 offset:44032
v_mfma_f32_16x16x32_bf16 v[136:139], a[192:195], v[200:203], v[136:139]
s_waitcnt lgkmcnt(4)
v_mov_b32 v78, 2
s_mov_b32 exec_lo, 0xf0f0000
s_mov_b32 exec_hi, 0xf0f0000
buffer_load_dword v78, v13, s[16:19], s73 offen sc1
s_mov_b64 exec, -1
v_mfma_f32_16x16x32_bf16 v[80:83], a[208:211], v[144:147], v[80:83]
s_xor_b32 s47, s37, 0x620000
ds_read_b128 v[176:179], v18 offset:36864
v_mfma_f32_16x16x32_bf16 v[80:83], a[216:219], v[148:151], v[80:83]
buffer_load_dwordx4 a[160:163], v18, s[64:67], s47 offen offset:0 sc1
v_mfma_f32_16x16x32_bf16 v[84:87], a[220:223], v[148:151], v[84:87]
ds_read_b128 v[180:183], v18 offset:45056
v_mfma_f32_16x16x32_bf16 v[84:87], a[212:215], v[144:147], v[84:87]
v_mfma_f32_16x16x32_bf16 v[92:95], a[212:215], v[152:155], v[92:95]
ds_read_b128 v[184:187], v18 offset:37888
v_mfma_f32_16x16x32_bf16 v[92:95], a[220:223], v[156:159], v[92:95]
buffer_load_dwordx4 a[164:167], v18, s[64:67], s47 offen offset:1024 sc1
v_mfma_f32_16x16x32_bf16 v[88:91], a[216:219], v[156:159], v[88:91]
ds_read_b128 v[188:191], v18 offset:46080
v_mfma_f32_16x16x32_bf16 v[88:91], a[208:211], v[152:155], v[88:91]
s_waitcnt lgkmcnt(4)
v_mfma_f32_16x16x32_bf16 v[96:99], a[208:211], v[160:163], v[96:99]
s_xor_b32 s47, s37, 0x6a0000
ds_read_b128 v[192:195], v18 offset:38912
v_mfma_f32_16x16x32_bf16 v[96:99], a[216:219], v[164:167], v[96:99]
buffer_load_dwordx4 a[168:171], v18, s[64:67], s47 offen offset:0 sc1
v_mfma_f32_16x16x32_bf16 v[100:103], a[220:223], v[164:167], v[100:103]
ds_read_b128 v[196:199], v18 offset:47104
v_mfma_f32_16x16x32_bf16 v[100:103], a[212:215], v[160:163], v[100:103]
v_mfma_f32_16x16x32_bf16 v[108:111], a[212:215], v[168:171], v[108:111]
ds_read_b128 v[200:203], v18 offset:39936
v_mfma_f32_16x16x32_bf16 v[108:111], a[220:223], v[172:175], v[108:111]
buffer_load_dwordx4 a[172:175], v18, s[64:67], s47 offen offset:1024 sc1
v_mfma_f32_16x16x32_bf16 v[104:107], a[216:219], v[172:175], v[104:107]
ds_read_b128 v[204:207], v18 offset:48128
v_mfma_f32_16x16x32_bf16 v[104:107], a[208:211], v[168:171], v[104:107]
s_waitcnt lgkmcnt(4)
s_add_u32 m0, s39, 16384
s_xor_b32 s46, s32, 0x840000
v_mfma_f32_16x16x32_bf16 v[112:115], a[208:211], v[176:179], v[112:115]
s_waitcnt vmcnt(15)
s_barrier
v_mfma_f32_16x16x32_bf16 v[112:115], a[216:219], v[180:183], v[112:115]
buffer_load_dwordx4 v18, s[20:23], s46 offen offset:0 sc1 lds
v_mfma_f32_16x16x32_bf16 v[116:119], a[220:223], v[180:183], v[116:119]
ds_read_b128 v[144:147], v18 offset:49152
ds_read_b128 v[148:151], v18 offset:57344
v_mfma_f32_16x16x32_bf16 v[116:119], a[212:215], v[176:179], v[116:119]
v_mov_b32 v23, 1
s_mov_b64 exec, 1
buffer_atomic_add v23, off, s[24:27], s49 sc0 sc1
s_mov_b64 exec, -1
v_mfma_f32_16x16x32_bf16 v[124:127], a[212:215], v[184:187], v[124:127]
ds_read_b128 v[152:155], v18 offset:50176
v_mfma_f32_16x16x32_bf16 v[124:127], a[220:223], v[188:191], v[124:127]
buffer_load_dwordx4 v18, s[20:23], s46 offen offset:1024 sc1 lds
v_mfma_f32_16x16x32_bf16 v[120:123], a[216:219], v[188:191], v[120:123]
ds_read_b128 v[156:159], v18 offset:58368
v_mfma_f32_16x16x32_bf16 v[120:123], a[208:211], v[184:187], v[120:123]
s_waitcnt lgkmcnt(4)
ds_write_b32 v24, v20 offset:0
v_mfma_f32_16x16x32_bf16 v[128:131], a[208:211], v[192:195], v[128:131]
ds_read_b128 v[160:163], v18 offset:51200
v_mfma_f32_16x16x32_bf16 v[128:131], a[216:219], v[196:199], v[128:131]
buffer_load_dwordx4 v18, s[20:23], s46 offen offset:2048 sc1 lds
v_mfma_f32_16x16x32_bf16 v[132:135], a[220:223], v[196:199], v[132:135]
ds_read_b128 v[164:167], v18 offset:59392
v_mfma_f32_16x16x32_bf16 v[132:135], a[212:215], v[192:195], v[132:135]
s_waitcnt vmcnt(29)
s_mov_b64 exec, 1
buffer_store_dword v7, v8, s[16:19], s74 offen sc1
s_mov_b64 exec, -1
v_mfma_f32_16x16x32_bf16 v[140:143], a[212:215], v[200:203], v[140:143]
ds_read_b128 v[168:171], v18 offset:52224
v_mfma_f32_16x16x32_bf16 v[140:143], a[220:223], v[204:207], v[140:143]
buffer_load_dwordx4 v18, s[20:23], s46 offen offset:3072 sc1 lds
v_mfma_f32_16x16x32_bf16 v[136:139], a[216:219], v[204:207], v[136:139]
ds_read_b128 v[172:175], v18 offset:60416
v_mfma_f32_16x16x32_bf16 v[136:139], a[208:211], v[200:203], v[136:139]
s_waitcnt lgkmcnt(5)
v_mfma_f32_16x16x32_bf16 v[80:83], a[224:227], v[144:147], v[80:83]
s_xor_b32 s47, s37, 0x640000
ds_read_b128 v[176:179], v18 offset:53248
v_mfma_f32_16x16x32_bf16 v[80:83], a[232:235], v[148:151], v[80:83]
buffer_load_dwordx4 a[128:131], v18, s[64:67], s47 offen offset:0 sc1
v_mfma_f32_16x16x32_bf16 v[84:87], a[236:239], v[148:151], v[84:87]
ds_read_b128 v[180:183], v18 offset:61440
v_mfma_f32_16x16x32_bf16 v[84:87], a[228:231], v[144:147], v[84:87]
v_mfma_f32_16x16x32_bf16 v[92:95], a[228:231], v[152:155], v[92:95]
ds_read_b128 v[184:187], v18 offset:54272
v_mfma_f32_16x16x32_bf16 v[92:95], a[236:239], v[156:159], v[92:95]
buffer_load_dwordx4 a[132:135], v18, s[64:67], s47 offen offset:1024 sc1
v_mfma_f32_16x16x32_bf16 v[88:91], a[232:235], v[156:159], v[88:91]
ds_read_b128 v[188:191], v18 offset:62464
v_mfma_f32_16x16x32_bf16 v[88:91], a[224:227], v[152:155], v[88:91]
s_waitcnt lgkmcnt(4)
v_mfma_f32_16x16x32_bf16 v[96:99], a[224:227], v[160:163], v[96:99]
s_xor_b32 s47, s37, 0x6c0000
ds_read_b128 v[192:195], v18 offset:55296
v_mfma_f32_16x16x32_bf16 v[96:99], a[232:235], v[164:167], v[96:99]
buffer_load_dwordx4 a[136:139], v18, s[64:67], s47 offen offset:0 sc1
v_mfma_f32_16x16x32_bf16 v[100:103], a[236:239], v[164:167], v[100:103]
ds_read_b128 v[196:199], v18 offset:63488
v_mfma_f32_16x16x32_bf16 v[100:103], a[228:231], v[160:163], v[100:103]
v_mfma_f32_16x16x32_bf16 v[108:111], a[228:231], v[168:171], v[108:111]
ds_read_b128 v[200:203], v18 offset:56320
v_mfma_f32_16x16x32_bf16 v[108:111], a[236:239], v[172:175], v[108:111]
buffer_load_dwordx4 a[140:143], v18, s[64:67], s47 offen offset:1024 sc1
v_mfma_f32_16x16x32_bf16 v[104:107], a[232:235], v[172:175], v[104:107]
ds_read_b128 v[204:207], v18 offset:64512
v_mfma_f32_16x16x32_bf16 v[104:107], a[224:227], v[168:171], v[104:107]
s_waitcnt lgkmcnt(4)
s_add_u32 m0, s39, 32768
s_xor_b32 s46, s32, 0xa40000
v_mfma_f32_16x16x32_bf16 v[112:115], a[224:227], v[176:179], v[112:115]
s_waitcnt vmcnt(20)
s_barrier
v_mfma_f32_16x16x32_bf16 v[112:115], a[232:235], v[180:183], v[112:115]
buffer_load_dwordx4 v18, s[20:23], s46 offen offset:0 sc1 lds
v_mfma_f32_16x16x32_bf16 v[116:119], a[236:239], v[180:183], v[116:119]
ds_read_b128 v[144:147], v2 offset:0
ds_read_b128 v[148:151], v2 offset:8192
v_mfma_f32_16x16x32_bf16 v[116:119], a[228:231], v[176:179], v[116:119]
v_mov_b32 v20, 1
s_mov_b64 exec, 1
buffer_atomic_add v20, off, s[24:27], s49 sc0 sc1
s_mov_b64 exec, -1
v_mfma_f32_16x16x32_bf16 v[124:127], a[228:231], v[184:187], v[124:127]
ds_read_b128 v[152:155], v2 offset:1024
v_mfma_f32_16x16x32_bf16 v[124:127], a[236:239], v[188:191], v[124:127]
buffer_load_dwordx4 v18, s[20:23], s46 offen offset:1024 sc1 lds
v_mfma_f32_16x16x32_bf16 v[120:123], a[232:235], v[188:191], v[120:123]
ds_read_b128 v[156:159], v2 offset:9216
v_mfma_f32_16x16x32_bf16 v[120:123], a[224:227], v[184:187], v[120:123]
s_waitcnt lgkmcnt(4)
ds_write_b32 v24, v21 offset:4
v_mfma_f32_16x16x32_bf16 v[128:131], a[224:227], v[192:195], v[128:131]
ds_read_b32 v26, v25 offset:0
v_mfma_f32_16x16x32_bf16 v[128:131], a[232:235], v[196:199], v[128:131]
buffer_load_dwordx4 v18, s[20:23], s46 offen offset:2048 sc1 lds
v_mfma_f32_16x16x32_bf16 v[132:135], a[236:239], v[196:199], v[132:135]
ds_read_b128 v[160:163], v2 offset:2048
v_mfma_f32_16x16x32_bf16 v[132:135], a[228:231], v[192:195], v[132:135]
ds_read_b128 v[164:167], v2 offset:10240
v_mfma_f32_16x16x32_bf16 v[140:143], a[228:231], v[200:203], v[140:143]
ds_read_b128 v[168:171], v2 offset:3072
v_mfma_f32_16x16x32_bf16 v[140:143], a[236:239], v[204:207], v[140:143]
buffer_load_dwordx4 v18, s[20:23], s46 offen offset:3072 sc1 lds
v_mfma_f32_16x16x32_bf16 v[136:139], a[232:235], v[204:207], v[136:139]
ds_read_b128 v[172:175], v2 offset:11264
v_mfma_f32_16x16x32_bf16 v[136:139], a[224:227], v[200:203], v[136:139]
s_waitcnt lgkmcnt(6)
v_mfma_f32_16x16x32_bf16 v[80:83], a[240:243], v[144:147], v[80:83]
s_xor_b32 s47, s37, 0x660000
ds_read_b128 v[176:179], v2 offset:4096
v_mfma_f32_16x16x32_bf16 v[80:83], a[248:251], v[148:151], v[80:83]
buffer_load_dwordx4 a[144:147], v18, s[64:67], s47 offen offset:0 sc1
v_mfma_f32_16x16x32_bf16 v[84:87], a[252:255], v[148:151], v[84:87]
ds_read_b128 v[180:183], v2 offset:12288
v_mfma_f32_16x16x32_bf16 v[84:87], a[244:247], v[144:147], v[84:87]
v_mfma_f32_16x16x32_bf16 v[92:95], a[244:247], v[152:155], v[92:95]
ds_read_b128 v[184:187], v2 offset:5120
v_mfma_f32_16x16x32_bf16 v[92:95], a[252:255], v[156:159], v[92:95]
buffer_load_dwordx4 a[148:151], v18, s[64:67], s47 offen offset:1024 sc1
v_mfma_f32_16x16x32_bf16 v[88:91], a[248:251], v[156:159], v[88:91]
ds_read_b128 v[188:191], v2 offset:13312
v_mfma_f32_16x16x32_bf16 v[88:91], a[240:243], v[152:155], v[88:91]
s_waitcnt lgkmcnt(4)
s_waitcnt vmcnt(21)
v_cmp_gt_u32 vcc, 1, v78
s_nop 0
s_cmp_lg_u64 vcc, 0
s_cbranch_scc1 L_p2_sp_1061
L_p2_sr_1062:
v_mfma_f32_16x16x32_bf16 v[96:99], a[240:243], v[160:163], v[96:99]
s_xor_b32 s47, s37, 0x6e0000
ds_read_b128 v[192:195], v2 offset:6144
v_mfma_f32_16x16x32_bf16 v[96:99], a[248:251], v[164:167], v[96:99]
buffer_load_dwordx4 a[152:155], v18, s[64:67], s47 offen offset:0 sc1
v_mfma_f32_16x16x32_bf16 v[100:103], a[252:255], v[164:167], v[100:103]
ds_read_b128 v[196:199], v2 offset:14336
v_mfma_f32_16x16x32_bf16 v[100:103], a[244:247], v[160:163], v[100:103]
v_readfirstlane_b32 s45, v26
s_xor_b32 s46, s32, 0xcc0000
s_cmp_lt_u32 s45, 7
s_addc_u32 s40, s40, 0
v_mfma_f32_16x16x32_bf16 v[108:111], a[244:247], v[168:171], v[108:111]
s_add_u32 s44, s39, 49152
s_cmp_gt_u32 s40, 0
ds_read_b128 v[200:203], v2 offset:7168
v_mfma_f32_16x16x32_bf16 v[108:111], a[252:255], v[172:175], v[108:111]
buffer_load_dwordx4 a[156:159], v18, s[64:67], s47 offen offset:1024 sc1
v_mfma_f32_16x16x32_bf16 v[104:107], a[248:251], v[172:175], v[104:107]
s_cselect_b32 s46, s46, s41
s_cselect_b32 m0, s44, s42
ds_read_b128 v[204:207], v2 offset:15360
v_mfma_f32_16x16x32_bf16 v[104:107], a[240:243], v[168:171], v[104:107]
s_waitcnt lgkmcnt(4)
s_cselect_b32 s28, 0, -1
s_cselect_b32 s44, 0, 0x4000
v_mfma_f32_16x16x32_bf16 v[112:115], a[240:243], v[176:179], v[112:115]
s_waitcnt vmcnt(24)
s_barrier
v_mfma_f32_16x16x32_bf16 v[112:115], a[248:251], v[180:183], v[112:115]
buffer_load_dwordx4 v18, s[20:23], s46 offen offset:0 sc1 lds
v_mfma_f32_16x16x32_bf16 v[116:119], a[252:255], v[180:183], v[116:119]
ds_read_b128 v[144:147], v18 offset:0
ds_read_b128 v[148:151], v18 offset:8192
v_mfma_f32_16x16x32_bf16 v[116:119], a[244:247], v[176:179], v[116:119]
v_mov_b32 v21, 1
s_mov_b64 exec, 1
buffer_atomic_add v21, off, s[24:27], s49 sc0 sc1
s_mov_b64 exec, -1
v_mfma_f32_16x16x32_bf16 v[124:127], a[244:247], v[184:187], v[124:127]
ds_read_b128 v[152:155], v18 offset:1024
ds_read_b128 v[156:159], v18 offset:9216
v_mfma_f32_16x16x32_bf16 v[124:127], a[252:255], v[188:191], v[124:127]
buffer_load_dwordx4 v18, s[20:23], s46 offen offset:1024 sc1 lds
v_mfma_f32_16x16x32_bf16 v[120:123], a[248:251], v[188:191], v[120:123]
ds_write_b32 v24, v22 offset:8
ds_read_b32 v26, v25 offset:4
v_mfma_f32_16x16x32_bf16 v[120:123], a[240:243], v[184:187], v[120:123]
s_waitcnt lgkmcnt(6)
s_add_u32 s42, s42, s44
s_lshl_b32 s44, s44, 7
s_add_u32 s41, s41, s44
v_mfma_f32_16x16x32_bf16 v[128:131], a[240:243], v[192:195], v[128:131]
ds_read_b128 v[160:163], v18 offset:2048
v_mfma_f32_16x16x32_bf16 v[128:131], a[248:251], v[196:199], v[128:131]
buffer_load_dwordx4 v18, s[20:23], s46 offen offset:2048 sc1 lds
v_mfma_f32_16x16x32_bf16 v[132:135], a[252:255], v[196:199], v[132:135]
ds_read_b128 v[164:167], v18 offset:10240
v_mfma_f32_16x16x32_bf16 v[132:135], a[244:247], v[192:195], v[132:135]
s_and_b32 s47, s28, 0x6a0000
s_xor_b32 s47, s47, s37
v_mfma_f32_16x16x32_bf16 v[140:143], a[244:247], v[200:203], v[140:143]
ds_read_b128 v[168:171], v18 offset:3072
v_mfma_f32_16x16x32_bf16 v[140:143], a[252:255], v[204:207], v[140:143]
buffer_load_dwordx4 v18, s[20:23], s46 offen offset:3072 sc1 lds
v_mfma_f32_16x16x32_bf16 v[136:139], a[248:251], v[204:207], v[136:139]
ds_read_b128 v[172:175], v18 offset:11264
v_mfma_f32_16x16x32_bf16 v[136:139], a[240:243], v[200:203], v[136:139]
s_waitcnt lgkmcnt(6)
v_mfma_f32_16x16x32_bf16 v[80:83], a[0:3], v[144:147], v[80:83]
s_xor_b32 s47, s47, 0x260000
ds_read_b128 v[176:179], v18 offset:4096
v_mfma_f32_16x16x32_bf16 v[80:83], a[8:11], v[148:151], v[80:83]
buffer_load_dwordx4 a[240:243], v18, s[64:67], s47 offen offset:0 sc1
v_mfma_f32_16x16x32_bf16 v[84:87], a[12:15], v[148:151], v[84:87]
ds_read_b128 v[180:183], v18 offset:12288
v_mfma_f32_16x16x32_bf16 v[84:87], a[4:7], v[144:147], v[84:87]
v_mfma_f32_16x16x32_bf16 v[92:95], a[4:7], v[152:155], v[92:95]
ds_read_b128 v[184:187], v18 offset:5120
v_mfma_f32_16x16x32_bf16 v[92:95], a[12:15], v[156:159], v[92:95]
buffer_load_dwordx4 a[244:247], v18, s[64:67], s47 offen offset:1024 sc1
v_mfma_f32_16x16x32_bf16 v[88:91], a[8:11], v[156:159], v[88:91]
s_and_b32 s47, s28, 0x720000
s_xor_b32 s47, s47, s37
ds_read_b128 v[188:191], v18 offset:13312
v_mfma_f32_16x16x32_bf16 v[88:91], a[0:3], v[152:155], v[88:91]
s_waitcnt lgkmcnt(4)
v_mfma_f32_16x16x32_bf16 v[96:99], a[0:3], v[160:163], v[96:99]
s_xor_b32 s47, s47, 0x2e0000
ds_read_b128 v[192:195], v18 offset:6144
v_mfma_f32_16x16x32_bf16 v[96:99], a[8:11], v[164:167], v[96:99]
buffer_load_dwordx4 a[248:251], v18, s[64:67], s47 offen offset:0 sc1
v_mfma_f32_16x16x32_bf16 v[100:103], a[12:15], v[164:167], v[100:103]
ds_read_b128 v[196:199], v18 offset:14336
v_mfma_f32_16x16x32_bf16 v[100:103], a[4:7], v[160:163], v[100:103]
v_readfirstlane_b32 s45, v26
s_xor_b32 s46, s32, 0xec0000
s_cmp_lt_u32 s45, 7
s_addc_u32 s40, s40, 0
v_mfma_f32_16x16x32_bf16 v[108:111], a[4:7], v[168:171], v[108:111]
s_add_u32 s44, s39, 65536
s_cmp_gt_u32 s40, 1
ds_read_b128 v[200:203], v18 offset:7168
v_mfma_f32_16x16x32_bf16 v[108:111], a[12:15], v[172:175], v[108:111]
buffer_load_dwordx4 a[252:255], v18, s[64:67], s47 offen offset:1024 sc1
v_mfma_f32_16x16x32_bf16 v[104:107], a[8:11], v[172:175], v[104:107]
s_cselect_b32 s46, s46, s41
s_cselect_b32 m0, s44, s42
ds_read_b128 v[204:207], v18 offset:15360
v_mfma_f32_16x16x32_bf16 v[104:107], a[0:3], v[168:171], v[104:107]
s_waitcnt lgkmcnt(4)
s_cselect_b32 s28, 0, -1
s_cselect_b32 s44, 0, 0x4000
v_mfma_f32_16x16x32_bf16 v[112:115], a[0:3], v[176:179], v[112:115]
s_waitcnt vmcnt(22)
s_barrier
v_mfma_f32_16x16x32_bf16 v[112:115], a[8:11], v[180:183], v[112:115]
buffer_load_dwordx4 v18, s[20:23], s46 offen offset:0 sc1 lds
v_mfma_f32_16x16x32_bf16 v[116:119], a[12:15], v[180:183], v[116:119]
ds_read_b128 v[144:147], v18 offset:16384
ds_read_b128 v[148:151], v18 offset:24576
v_mfma_f32_16x16x32_bf16 v[116:119], a[4:7], v[176:179], v[116:119]
v_mov_b32 v22, 1
s_mov_b64 exec, 1
buffer_atomic_add v22, off, s[24:27], s49 sc0 sc1
s_mov_b64 exec, -1
v_mfma_f32_16x16x32_bf16 v[124:127], a[4:7], v[184:187], v[124:127]
ds_read_b128 v[152:155], v18 offset:17408
ds_read_b128 v[156:159], v18 offset:25600
v_mfma_f32_16x16x32_bf16 v[124:127], a[12:15], v[188:191], v[124:127]
buffer_load_dwordx4 v18, s[20:23], s46 offen offset:1024 sc1 lds
v_mfma_f32_16x16x32_bf16 v[120:123], a[8:11], v[188:191], v[120:123]
ds_write_b32 v24, v23 offset:12
ds_read_b32 v26, v25 offset:8
v_mfma_f32_16x16x32_bf16 v[120:123], a[0:3], v[184:187], v[120:123]
s_waitcnt lgkmcnt(6)
s_add_u32 s42, s42, s44
s_lshl_b32 s44, s44, 7
s_add_u32 s41, s41, s44
v_mfma_f32_16x16x32_bf16 v[128:131], a[0:3], v[192:195], v[128:131]
ds_read_b128 v[160:163], v18 offset:18432
v_mfma_f32_16x16x32_bf16 v[128:131], a[8:11], v[196:199], v[128:131]
buffer_load_dwordx4 v18, s[20:23], s46 offen offset:2048 sc1 lds
v_mfma_f32_16x16x32_bf16 v[132:135], a[12:15], v[196:199], v[132:135]
ds_read_b128 v[164:167], v18 offset:26624
v_mfma_f32_16x16x32_bf16 v[132:135], a[4:7], v[192:195], v[132:135]
s_and_b32 s47, s28, 0x4a0000
s_xor_b32 s47, s47, s37
v_mfma_f32_16x16x32_bf16 v[140:143], a[4:7], v[200:203], v[140:143]
ds_read_b128 v[168:171], v18 offset:19456
v_mfma_f32_16x16x32_bf16 v[140:143], a[12:15], v[204:207], v[140:143]
buffer_load_dwordx4 v18, s[20:23], s46 offen offset:3072 sc1 lds
v_mfma_f32_16x16x32_bf16 v[136:139], a[8:11], v[204:207], v[136:139]
ds_read_b128 v[172:175], v18 offset:27648
v_mfma_f32_16x16x32_bf16 v[136:139], a[0:3], v[200:203], v[136:139]
s_waitcnt lgkmcnt(6)
v_mov_b32_e64 v79, 2
s_mov_b32 exec_lo, 0xf000
s_mov_b32 exec_hi, 0xf000
buffer_load_dword v79, v13, s[16:19], s73 offen sc1
s_mov_b64 exec, -1
v_mfma_f32_16x16x32_bf16 v[80:83], a[16:19], v[144:147], v[80:83]
s_xor_b32 s47, s47, 0x360000
ds_read_b128 v[176:179], v18 offset:20480
v_mfma_f32_16x16x32_bf16 v[80:83], a[24:27], v[148:151], v[80:83]
buffer_load_dwordx4 a[0:3], v18, s[64:67], s47 offen offset:0 sc1
v_mfma_f32_16x16x32_bf16 v[84:87], a[28:31], v[148:151], v[84:87]
ds_read_b128 v[180:183], v18 offset:28672
v_mfma_f32_16x16x32_bf16 v[84:87], a[20:23], v[144:147], v[84:87]
v_mfma_f32_16x16x32_bf16 v[92:95], a[20:23], v[152:155], v[92:95]
ds_read_b128 v[184:187], v18 offset:21504
v_mfma_f32_16x16x32_bf16 v[92:95], a[28:31], v[156:159], v[92:95]
buffer_load_dwordx4 a[4:7], v18, s[64:67], s47 offen offset:1024 sc1
v_mfma_f32_16x16x32_bf16 v[88:91], a[24:27], v[156:159], v[88:91]
s_and_b32 s47, s28, 0xb20000
s_xor_b32 s47, s47, s37
ds_read_b128 v[188:191], v18 offset:29696
v_mfma_f32_16x16x32_bf16 v[88:91], a[16:19], v[152:155], v[88:91]
s_waitcnt lgkmcnt(4)
v_mfma_f32_16x16x32_bf16 v[96:99], a[16:19], v[160:163], v[96:99]
s_xor_b32 s47, s47, 0x3e0000
ds_read_b128 v[192:195], v18 offset:22528
v_mfma_f32_16x16x32_bf16 v[96:99], a[24:27], v[164:167], v[96:99]
buffer_load_dwordx4 a[8:11], v18, s[64:67], s47 offen offset:0 sc1
v_mfma_f32_16x16x32_bf16 v[100:103], a[28:31], v[164:167], v[100:103]
ds_read_b128 v[196:199], v18 offset:30720
v_mfma_f32_16x16x32_bf16 v[100:103], a[20:23], v[160:163], v[100:103]
v_readfirstlane_b32 s45, v26
s_xor_b32 s46, s32, 0x8c0000
s_cmp_lt_u32 s45, 7
s_addc_u32 s40, s40, 0
v_mfma_f32_16x16x32_bf16 v[108:111], a[20:23], v[168:171], v[108:111]
s_add_u32 s44, s39, 0
s_cmp_gt_u32 s40, 2
ds_read_b128 v[200:203], v18 offset:23552
v_mfma_f32_16x16x32_bf16 v[108:111], a[28:31], v[172:175], v[108:111]
buffer_load_dwordx4 a[12:15], v18, s[64:67], s47 offen offset:1024 sc1
v_mfma_f32_16x16x32_bf16 v[104:107], a[24:27], v[172:175], v[104:107]
s_cselect_b32 s46, s46, s41
s_cselect_b32 m0, s44, s42
ds_read_b128 v[204:207], v18 offset:31744
v_mfma_f32_16x16x32_bf16 v[104:107], a[16:19], v[168:171], v[104:107]
s_waitcnt lgkmcnt(4)
s_cselect_b32 s28, 0, -1
s_cselect_b32 s44, 0, 0x4000
v_mfma_f32_16x16x32_bf16 v[112:115], a[16:19], v[176:179], v[112:115]
s_waitcnt vmcnt(23)
s_barrier
v_mfma_f32_16x16x32_bf16 v[112:115], a[24:27], v[180:183], v[112:115]
buffer_load_dwordx4 v18, s[20:23], s46 offen offset:0 sc1 lds
v_mfma_f32_16x16x32_bf16 v[116:119], a[28:31], v[180:183], v[116:119]
ds_read_b128 v[144:147], v18 offset:32768
ds_read_b128 v[148:151], v18 offset:40960
v_mfma_f32_16x16x32_bf16 v[116:119], a[20:23], v[176:179], v[116:119]
v_mov_b32 v23, 1
s_mov_b64 exec, 1
buffer_atomic_add v23, off, s[24:27], s49 sc0 sc1
s_mov_b64 exec, -1
v_mfma_f32_16x16x32_bf16 v[124:127], a[20:23], v[184:187], v[124:127]
ds_read_b128 v[152:155], v18 offset:33792
ds_read_b128 v[156:159], v18 offset:41984
v_mfma_f32_16x16x32_bf16 v[124:127], a[28:31], v[188:191], v[124:127]
buffer_load_dwordx4 v18, s[20:23], s46 offen offset:1024 sc1 lds
v_mfma_f32_16x16x32_bf16 v[120:123], a[24:27], v[188:191], v[120:123]
ds_write_b32 v24, v20 offset:0
ds_read_b32 v26, v25 offset:12
v_mfma_f32_16x16x32_bf16 v[120:123], a[16:19], v[184:187], v[120:123]
s_waitcnt lgkmcnt(6)
s_add_u32 s42, s42, s44
s_lshl_b32 s44, s44, 7
s_add_u32 s41, s41, s44
v_mfma_f32_16x16x32_bf16 v[128:131], a[16:19], v[192:195], v[128:131]
ds_read_b128 v[160:163], v18 offset:34816
v_mfma_f32_16x16x32_bf16 v[128:131], a[24:27], v[196:199], v[128:131]
buffer_load_dwordx4 v18, s[20:23], s46 offen offset:2048 sc1 lds
v_mfma_f32_16x16x32_bf16 v[132:135], a[28:31], v[196:199], v[132:135]
ds_read_b128 v[164:167], v18 offset:43008
v_mfma_f32_16x16x32_bf16 v[132:135], a[20:23], v[192:195], v[132:135]
s_and_b32 s47, s28, 0x80000
s_xor_b32 s47, s47, s37
v_mfma_f32_16x16x32_bf16 v[140:143], a[20:23], v[200:203], v[140:143]
ds_read_b128 v[168:171], v18 offset:35840
v_mfma_f32_16x16x32_bf16 v[140:143], a[28:31], v[204:207], v[140:143]
buffer_load_dwordx4 v18, s[20:23], s46 offen offset:3072 sc1 lds
v_mfma_f32_16x16x32_bf16 v[136:139], a[24:27], v[204:207], v[136:139]
ds_read_b128 v[172:175], v18 offset:44032
v_mfma_f32_16x16x32_bf16 v[136:139], a[16:19], v[200:203], v[136:139]
s_waitcnt lgkmcnt(6)
v_mfma_f32_16x16x32_bf16 v[80:83], a[32:35], v[144:147], v[80:83]
s_xor_b32 s47, s47, 0x460000
ds_read_b128 v[176:179], v18 offset:36864
v_mfma_f32_16x16x32_bf16 v[80:83], a[40:43], v[148:151], v[80:83]
buffer_load_dwordx4 a[16:19], v18, s[64:67], s47 offen offset:0 sc1
v_mfma_f32_16x16x32_bf16 v[84:87], a[44:47], v[148:151], v[84:87]
ds_read_b128 v[180:183], v18 offset:45056
v_mfma_f32_16x16x32_bf16 v[84:87], a[36:39], v[144:147], v[84:87]
v_mov_b32 v78, 2
s_cmp_gt_u32 s40, 0
s_cselect_b32 exec_lo, 0, 0xf0f0f0f
s_mov_b32 exec_hi, 0x0
buffer_load_dword v78, v13, s[16:19], s73 offen sc1
s_mov_b64 exec, -1
s_cselect_b32 s45, 3, 5
v_lshl_add_u32 v14, s45, 14, v18
v_mfma_f32_16x16x32_bf16 v[92:95], a[36:39], v[152:155], v[92:95]
ds_read_b128 v[184:187], v18 offset:37888
v_mfma_f32_16x16x32_bf16 v[92:95], a[44:47], v[156:159], v[92:95]
buffer_load_dwordx4 a[20:23], v18, s[64:67], s47 offen offset:1024 sc1
v_mfma_f32_16x16x32_bf16 v[88:91], a[40:43], v[156:159], v[88:91]
s_and_b32 s47, s28, 0x80000
s_xor_b32 s47, s47, s37
ds_read_b128 v[188:191], v18 offset:46080
v_mfma_f32_16x16x32_bf16 v[88:91], a[32:35], v[152:155], v[88:91]
s_waitcnt lgkmcnt(4)
v_mfma_f32_16x16x32_bf16 v[96:99], a[32:35], v[160:163], v[96:99]
s_xor_b32 s47, s47, 0x560000
ds_read_b128 v[192:195], v18 offset:38912
v_mfma_f32_16x16x32_bf16 v[96:99], a[40:43], v[164:167], v[96:99]
buffer_load_dwordx4 a[24:27], v18, s[64:67], s47 offen offset:0 sc1
v_mfma_f32_16x16x32_bf16 v[100:103], a[44:47], v[164:167], v[100:103]
ds_read_b128 v[196:199], v18 offset:47104
v_mfma_f32_16x16x32_bf16 v[100:103], a[36:39], v[160:163], v[100:103]
v_readfirstlane_b32 s45, v26
s_xor_b32 s46, s32, 0xac0000
s_cmp_lt_u32 s45, 7
s_addc_u32 s40, s40, 0
v_mfma_f32_16x16x32_bf16 v[108:111], a[36:39], v[168:171], v[108:111]
s_add_u32 s44, s39, 16384
s_cmp_gt_u32 s40, 3
ds_read_b128 v[200:203], v18 offset:39936
v_mfma_f32_16x16x32_bf16 v[108:111], a[44:47], v[172:175], v[108:111]
buffer_load_dwordx4 a[28:31], v18, s[64:67], s47 offen offset:1024 sc1
v_mfma_f32_16x16x32_bf16 v[104:107], a[40:43], v[172:175], v[104:107]
s_cselect_b32 s46, s46, s41
s_cselect_b32 m0, s44, s42
ds_read_b128 v[204:207], v18 offset:48128
v_mfma_f32_16x16x32_bf16 v[104:107], a[32:35], v[168:171], v[104:107]
s_waitcnt lgkmcnt(4)
s_cselect_b32 s28, 0, -1
s_cselect_b32 s44, 0, 0x4000
v_mfma_f32_16x16x32_bf16 v[112:115], a[32:35], v[176:179], v[112:115]
s_waitcnt vmcnt(19)
s_barrier
v_mfma_f32_16x16x32_bf16 v[112:115], a[40:43], v[180:183], v[112:115]
buffer_load_dwordx4 v18, s[20:23], s46 offen offset:0 sc1 lds
v_mfma_f32_16x16x32_bf16 v[116:119], a[44:47], v[180:183], v[116:119]
ds_read_b128 v[144:147], v14 offset:0
ds_read_b128 v[148:151], v14 offset:8192
v_mfma_f32_16x16x32_bf16 v[116:119], a[36:39], v[176:179], v[116:119]
ds_read_b128 v[152:155], v14 offset:1024
v_mfma_f32_16x16x32_bf16 v[124:127], a[36:39], v[184:187], v[124:127]
ds_read_b128 v[156:159], v14 offset:9216
ds_write_b32 v24, v21 offset:4
v_mfma_f32_16x16x32_bf16 v[124:127], a[44:47], v[188:191], v[124:127]
buffer_load_dwordx4 v18, s[20:23], s46 offen offset:1024 sc1 lds
v_mfma_f32_16x16x32_bf16 v[120:123], a[40:43], v[188:191], v[120:123]
ds_read_b32 v26, v25 offset:0
v_mfma_f32_16x16x32_bf16 v[120:123], a[32:35], v[184:187], v[120:123]
s_waitcnt lgkmcnt(6)
s_add_u32 s42, s42, s44
s_lshl_b32 s44, s44, 7
s_add_u32 s41, s41, s44
v_mfma_f32_16x16x32_bf16 v[128:131], a[32:35], v[192:195], v[128:131]
ds_read_b128 v[160:163], v14 offset:2048
v_mfma_f32_16x16x32_bf16 v[128:131], a[40:43], v[196:199], v[128:131]
buffer_load_dwordx4 v18, s[20:23], s46 offen offset:2048 sc1 lds
v_mfma_f32_16x16x32_bf16 v[132:135], a[44:47], v[196:199], v[132:135]
ds_read_b128 v[164:167], v14 offset:10240
v_mfma_f32_16x16x32_bf16 v[132:135], a[36:39], v[192:195], v[132:135]
s_and_b32 s47, s28, 0x80000
s_xor_b32 s47, s47, s37
v_mfma_f32_16x16x32_bf16 v[140:143], a[36:39], v[200:203], v[140:143]
ds_read_b128 v[168:171], v14 offset:3072
v_mfma_f32_16x16x32_bf16 v[140:143], a[44:47], v[204:207], v[140:143]
buffer_load_dwordx4 v18, s[20:23], s46 offen offset:3072 sc1 lds
v_mfma_f32_16x16x32_bf16 v[136:139], a[40:43], v[204:207], v[136:139]
ds_read_b128 v[172:175], v14 offset:11264
v_mfma_f32_16x16x32_bf16 v[136:139], a[32:35], v[200:203], v[136:139]
s_waitcnt lgkmcnt(6)
s_cmp_le_u32 s40, 0
s_cbranch_scc1 L_p2_j_1051
v_mfma_f32_16x16x32_bf16 v[80:83], a[240:243], v[144:147], v[80:83]
s_xor_b32 s47, s47, 0x760000
ds_read_b128 v[176:179], v18 offset:53248
v_mfma_f32_16x16x32_bf16 v[80:83], a[248:251], v[148:151], v[80:83]
buffer_load_dwordx4 a[32:35], v18, s[64:67], s47 offen offset:0 sc1
v_mfma_f32_16x16x32_bf16 v[84:87], a[252:255], v[148:151], v[84:87]
ds_read_b128 v[180:183], v18 offset:61440
v_mfma_f32_16x16x32_bf16 v[84:87], a[244:247], v[144:147], v[84:87]
s_cmp_gt_u32 s40, 1
s_cselect_b32 exec_lo, 0, 0xf0f0f0f
s_mov_b32 exec_hi, 0x0
buffer_load_dword v78, v13, s[16:19], s73 offen sc1
s_mov_b64 exec, -1
s_cselect_b32 s45, 4, 5
v_lshl_add_u32 v14, s45, 14, v18
v_mfma_f32_16x16x32_bf16 v[92:95], a[244:247], v[152:155], v[92:95]
ds_read_b128 v[184:187], v18 offset:54272
v_mfma_f32_16x16x32_bf16 v[92:95], a[252:255], v[156:159], v[92:95]
buffer_load_dwordx4 a[36:39], v18, s[64:67], s47 offen offset:1024 sc1
v_mfma_f32_16x16x32_bf16 v[88:91], a[248:251], v[156:159], v[88:91]
s_and_b32 s47, s28, 0x80000
s_xor_b32 s47, s47, s37
ds_read_b128 v[188:191], v18 offset:62464
v_mfma_f32_16x16x32_bf16 v[88:91], a[240:243], v[152:155], v[88:91]
s_waitcnt lgkmcnt(4)
s_waitcnt vmcnt(19)
v_cmp_gt_u32 vcc, 1, v79
s_nop 0
s_cmp_lg_u64 vcc, 0
s_cbranch_scc1 L_p2_sp_1063
L_p2_sr_1064:
v_mfma_f32_16x16x32_bf16 v[96:99], a[240:243], v[160:163], v[96:99]
s_xor_b32 s47, s47, 0x860000
ds_read_b128 v[192:195], v18 offset:55296
v_mfma_f32_16x16x32_bf16 v[96:99], a[248:251], v[164:167], v[96:99]
buffer_load_dwordx4 a[40:43], v18, s[64:67], s47 offen offset:0 sc1
v_mfma_f32_16x16x32_bf16 v[100:103], a[252:255], v[164:167], v[100:103]
ds_read_b128 v[196:199], v18 offset:63488
v_mfma_f32_16x16x32_bf16 v[100:103], a[244:247], v[160:163], v[100:103]
v_readfirstlane_b32 s45, v26
s_xor_b32 s46, s32, 0xa60000
s_cmp_lt_u32 s45, 7
s_addc_u32 s40, s40, 0
v_mfma_f32_16x16x32_bf16 v[108:111], a[244:247], v[168:171], v[108:111]
s_add_u32 s44, s39, 32768
s_cmp_gt_u32 s40, 4
ds_read_b128 v[200:203], v18 offset:56320
v_mfma_f32_16x16x32_bf16 v[108:111], a[252:255], v[172:175], v[108:111]
buffer_load_dwordx4 a[44:47], v18, s[64:67], s47 offen offset:1024 sc1
v_mfma_f32_16x16x32_bf16 v[104:107], a[248:251], v[172:175], v[104:107]
s_cselect_b32 s46, s46, s41
s_cselect_b32 m0, s44, s42
ds_read_b128 v[204:207], v18 offset:64512
v_mfma_f32_16x16x32_bf16 v[104:107], a[240:243], v[168:171], v[104:107]
s_waitcnt lgkmcnt(4)
s_cselect_b32 s28, 0, -1
s_cselect_b32 s44, 0, 0x4000
v_mfma_f32_16x16x32_bf16 v[112:115], a[240:243], v[176:179], v[112:115]
s_waitcnt vmcnt(17)
s_barrier
v_mfma_f32_16x16x32_bf16 v[112:115], a[248:251], v[180:183], v[112:115]
buffer_load_dwordx4 v18, s[20:23], s46 offen offset:0 sc1 lds
v_mfma_f32_16x16x32_bf16 v[116:119], a[252:255], v[180:183], v[116:119]
ds_read_b128 v[144:147], v14 offset:0
ds_read_b128 v[148:151], v14 offset:8192
v_mfma_f32_16x16x32_bf16 v[116:119], a[244:247], v[176:179], v[116:119]
ds_read_b128 v[152:155], v14 offset:1024
v_mfma_f32_16x16x32_bf16 v[124:127], a[244:247], v[184:187], v[124:127]
ds_read_b128 v[156:159], v14 offset:9216
ds_write_b32 v24, v22 offset:8
v_mfma_f32_16x16x32_bf16 v[124:127], a[252:255], v[188:191], v[124:127]
buffer_load_dwordx4 v18, s[20:23], s46 offen offset:1024 sc1 lds
v_mfma_f32_16x16x32_bf16 v[120:123], a[248:251], v[188:191], v[120:123]
ds_read_b32 v26, v25 offset:4
v_mfma_f32_16x16x32_bf16 v[120:123], a[240:243], v[184:187], v[120:123]
s_waitcnt lgkmcnt(6)
s_add_u32 s42, s42, s44
s_lshl_b32 s44, s44, 7
s_add_u32 s41, s41, s44
v_mfma_f32_16x16x32_bf16 v[128:131], a[240:243], v[192:195], v[128:131]
ds_read_b128 v[160:163], v14 offset:2048
v_mfma_f32_16x16x32_bf16 v[128:131], a[248:251], v[196:199], v[128:131]
buffer_load_dwordx4 v18, s[20:23], s46 offen offset:2048 sc1 lds
v_mfma_f32_16x16x32_bf16 v[132:135], a[252:255], v[196:199], v[132:135]
ds_read_b128 v[164:167], v14 offset:10240
v_mfma_f32_16x16x32_bf16 v[132:135], a[244:247], v[192:195], v[132:135]
s_and_b32 s47, s28, 0x3f0000
s_xor_b32 s47, s47, s37
v_mfma_f32_16x16x32_bf16 v[140:143], a[244:247], v[200:203], v[140:143]
ds_read_b128 v[168:171], v14 offset:3072
v_mfma_f32_16x16x32_bf16 v[140:143], a[252:255], v[204:207], v[140:143]
buffer_load_dwordx4 v18, s[20:23], s46 offen offset:3072 sc1 lds
v_mfma_f32_16x16x32_bf16 v[136:139], a[248:251], v[204:207], v[136:139]
ds_read_b128 v[172:175], v14 offset:11264
v_mfma_f32_16x16x32_bf16 v[136:139], a[240:243], v[200:203], v[136:139]
s_waitcnt lgkmcnt(6)
s_cmp_le_u32 s40, 1
s_cbranch_scc1 L_p2_v_1052
v_mfma_f32_16x16x32_bf16 v[80:83], a[0:3], v[144:147], v[80:83]
s_xor_b32 s47, s47, 0x730000
ds_read_b128 v[176:179], v2 offset:4096
v_mfma_f32_16x16x32_bf16 v[80:83], a[8:11], v[148:151], v[80:83]
buffer_load_dwordx4 a[240:243], v18, s[64:67], s47 offen offset:0 sc1
v_mfma_f32_16x16x32_bf16 v[84:87], a[12:15], v[148:151], v[84:87]
ds_read_b128 v[180:183], v2 offset:12288
v_mfma_f32_16x16x32_bf16 v[84:87], a[4:7], v[144:147], v[84:87]
s_cmp_gt_u32 s40, 2
s_cselect_b32 exec_lo, 0, 0xf0f0f0f
s_mov_b32 exec_hi, 0x0
buffer_load_dword v78, v13, s[16:19], s73 offen sc1
s_mov_b64 exec, -1
s_cselect_b32 s45, 0, 5
v_lshl_add_u32 v14, s45, 14, v18
v_mfma_f32_16x16x32_bf16 v[92:95], a[4:7], v[152:155], v[92:95]
ds_read_b128 v[184:187], v2 offset:5120
v_mfma_f32_16x16x32_bf16 v[92:95], a[12:15], v[156:159], v[92:95]
buffer_load_dwordx4 a[244:247], v18, s[64:67], s47 offen offset:1024 sc1
v_mfma_f32_16x16x32_bf16 v[88:91], a[8:11], v[156:159], v[88:91]
s_and_b32 s47, s28, 0xdf0000
s_xor_b32 s47, s47, s37
ds_read_b128 v[188:191], v2 offset:13312
v_mfma_f32_16x16x32_bf16 v[88:91], a[0:3], v[152:155], v[88:91]
s_waitcnt lgkmcnt(4)
v_mfma_f32_16x16x32_bf16 v[96:99], a[0:3], v[160:163], v[96:99]
s_xor_b32 s47, s47, 0x830000
ds_read_b128 v[192:195], v2 offset:6144
v_mfma_f32_16x16x32_bf16 v[96:99], a[8:11], v[164:167], v[96:99]
buffer_load_dwordx4 a[248:251], v18, s[64:67], s47 offen offset:0 sc1
v_mfma_f32_16x16x32_bf16 v[100:103], a[12:15], v[164:167], v[100:103]
ds_read_b128 v[196:199], v2 offset:14336
v_mfma_f32_16x16x32_bf16 v[100:103], a[4:7], v[160:163], v[100:103]
v_readfirstlane_b32 s45, v26
s_xor_b32 s46, s32, 0x860000
s_cmp_lt_u32 s45, 7
s_addc_u32 s40, s40, 0
v_mfma_f32_16x16x32_bf16 v[108:111], a[4:7], v[168:171], v[108:111]
s_add_u32 s44, s39, 49152
s_cmp_gt_u32 s40, 5
ds_read_b128 v[200:203], v2 offset:7168
v_mfma_f32_16x16x32_bf16 v[108:111], a[12:15], v[172:175], v[108:111]
buffer_load_dwordx4 a[252:255], v18, s[64:67], s47 offen offset:1024 sc1
v_mfma_f32_16x16x32_bf16 v[104:107], a[8:11], v[172:175], v[104:107]
s_cselect_b32 s46, s46, s41
s_cselect_b32 m0, s44, s42
ds_read_b128 v[204:207], v2 offset:15360
v_mfma_f32_16x16x32_bf16 v[104:107], a[0:3], v[168:171], v[104:107]
s_waitcnt lgkmcnt(4)
s_cselect_b32 s28, 0, -1
s_cselect_b32 s44, 0, 0x4000
v_mfma_f32_16x16x32_bf16 v[112:115], a[0:3], v[176:179], v[112:115]
s_waitcnt vmcnt(16)
s_barrier
v_mfma_f32_16x16x32_bf16 v[112:115], a[8:11], v[180:183], v[112:115]
buffer_load_dwordx4 v18, s[20:23], s46 offen offset:0 sc1 lds
v_mfma_f32_16x16x32_bf16 v[116:119], a[12:15], v[180:183], v[116:119]
ds_read_b128 v[144:147], v14 offset:0
ds_read_b128 v[148:151], v14 offset:8192
v_mfma_f32_16x16x32_bf16 v[116:119], a[4:7], v[176:179], v[116:119]
ds_read_b128 v[152:155], v14 offset:1024
v_mfma_f32_16x16x32_bf16 v[124:127], a[4:7], v[184:187], v[124:127]
ds_read_b128 v[156:159], v14 offset:9216
ds_write_b32 v24, v23 offset:12
v_mfma_f32_16x16x32_bf16 v[124:127], a[12:15], v[188:191], v[124:127]
buffer_load_dwordx4 v18, s[20:23], s46 offen offset:1024 sc1 lds
v_mfma_f32_16x16x32_bf16 v[120:123], a[8:11], v[188:191], v[120:123]
ds_read_b32 v26, v25 offset:8
v_mfma_f32_16x16x32_bf16 v[120:123], a[0:3], v[184:187], v[120:123]
s_waitcnt lgkmcnt(6)
s_add_u32 s42, s42, s44
s_lshl_b32 s44, s44, 7
s_add_u32 s41, s41, s44
v_mfma_f32_16x16x32_bf16 v[128:131], a[0:3], v[192:195], v[128:131]
ds_read_b128 v[160:163], v14 offset:2048
v_mfma_f32_16x16x32_bf16 v[128:131], a[8:11], v[196:199], v[128:131]
buffer_load_dwordx4 v18, s[20:23], s46 offen offset:2048 sc1 lds
v_mfma_f32_16x16x32_bf16 v[132:135], a[12:15], v[196:199], v[132:135]
ds_read_b128 v[164:167], v14 offset:10240
v_mfma_f32_16x16x32_bf16 v[132:135], a[4:7], v[192:195], v[132:135]
s_and_b32 s47, s28, 0x3f0000
s_xor_b32 s47, s47, s37
v_mfma_f32_16x16x32_bf16 v[140:143], a[4:7], v[200:203], v[140:143]
ds_read_b128 v[168:171], v14 offset:3072
v_mfma_f32_16x16x32_bf16 v[140:143], a[12:15], v[204:207], v[140:143]
buffer_load_dwordx4 v18, s[20:23], s46 offen offset:3072 sc1 lds
v_mfma_f32_16x16x32_bf16 v[136:139], a[8:11], v[204:207], v[136:139]
ds_read_b128 v[172:175], v14 offset:11264
v_mfma_f32_16x16x32_bf16 v[136:139], a[0:3], v[200:203], v[136:139]
s_waitcnt lgkmcnt(6)
s_cmp_le_u32 s40, 2
s_cbranch_scc1 L_p2_v_1053
v_mfma_f32_16x16x32_bf16 v[80:83], a[16:19], v[144:147], v[80:83]
s_xor_b32 s47, s47, 0x430000
ds_read_b128 v[176:179], v18 offset:4096
v_mfma_f32_16x16x32_bf16 v[80:83], a[24:27], v[148:151], v[80:83]
buffer_load_dwordx4 a[0:3], v18, s[64:67], s47 offen offset:0 sc1
v_mfma_f32_16x16x32_bf16 v[84:87], a[28:31], v[148:151], v[84:87]
ds_read_b128 v[180:183], v18 offset:12288
v_mfma_f32_16x16x32_bf16 v[84:87], a[20:23], v[144:147], v[84:87]
s_cmp_gt_u32 s40, 3
s_cselect_b32 exec_lo, 0, 0xf0f0f0f
s_mov_b32 exec_hi, 0x0
buffer_load_dword v78, v13, s[16:19], s73 offen sc1
s_mov_b64 exec, -1
s_cselect_b32 s45, 1, 5
v_lshl_add_u32 v14, s45, 14, v18
v_mfma_f32_16x16x32_bf16 v[92:95], a[20:23], v[152:155], v[92:95]
ds_read_b128 v[184:187], v18 offset:5120
v_mfma_f32_16x16x32_bf16 v[92:95], a[28:31], v[156:159], v[92:95]
buffer_load_dwordx4 a[4:7], v18, s[64:67], s47 offen offset:1024 sc1
v_mfma_f32_16x16x32_bf16 v[88:91], a[24:27], v[156:159], v[88:91]
s_and_b32 s47, s28, 0xdf0000
s_xor_b32 s47, s47, s37
ds_read_b128 v[188:191], v18 offset:13312
v_mfma_f32_16x16x32_bf16 v[88:91], a[16:19], v[152:155], v[88:91]
s_waitcnt lgkmcnt(4)
v_mfma_f32_16x16x32_bf16 v[96:99], a[16:19], v[160:163], v[96:99]
s_xor_b32 s47, s47, 0x530000
ds_read_b128 v[192:195], v18 offset:6144
v_mfma_f32_16x16x32_bf16 v[96:99], a[24:27], v[164:167], v[96:99]
buffer_load_dwordx4 a[8:11], v18, s[64:67], s47 offen offset:0 sc1
v_mfma_f32_16x16x32_bf16 v[100:103], a[28:31], v[164:167], v[100:103]
ds_read_b128 v[196:199], v18 offset:14336
v_mfma_f32_16x16x32_bf16 v[100:103], a[20:23], v[160:163], v[100:103]
v_readfirstlane_b32 s45, v26
s_xor_b32 s46, s32, 0xe60000
s_cmp_lt_u32 s45, 7
s_addc_u32 s40, s40, 0
v_mfma_f32_16x16x32_bf16 v[108:111], a[20:23], v[168:171], v[108:111]
s_add_u32 s44, s39, 65536
s_cmp_gt_u32 s40, 6
ds_read_b128 v[200:203], v18 offset:7168
v_mfma_f32_16x16x32_bf16 v[108:111], a[28:31], v[172:175], v[108:111]
buffer_load_dwordx4 a[12:15], v18, s[64:67], s47 offen offset:1024 sc1
v_mfma_f32_16x16x32_bf16 v[104:107], a[24:27], v[172:175], v[104:107]
s_cselect_b32 s46, s46, s41
s_cselect_b32 m0, s44, s42
ds_read_b128 v[204:207], v18 offset:15360
v_mfma_f32_16x16x32_bf16 v[104:107], a[16:19], v[168:171], v[104:107]
s_waitcnt lgkmcnt(4)
s_cselect_b32 s28, 0, -1
s_cselect_b32 s44, 0, 0x4000
v_mfma_f32_16x16x32_bf16 v[112:115], a[16:19], v[176:179], v[112:115]
s_waitcnt vmcnt(16)
s_barrier
v_mfma_f32_16x16x32_bf16 v[112:115], a[24:27], v[180:183], v[112:115]
buffer_load_dwordx4 v18, s[20:23], s46 offen offset:0 sc1 lds
v_mfma_f32_16x16x32_bf16 v[116:119], a[28:31], v[180:183], v[116:119]
ds_read_b128 v[144:147], v14 offset:0
ds_read_b128 v[148:151], v14 offset:8192
v_mfma_f32_16x16x32_bf16 v[116:119], a[20:23], v[176:179], v[116:119]
ds_read_b128 v[152:155], v14 offset:1024
v_mfma_f32_16x16x32_bf16 v[124:127], a[20:23], v[184:187], v[124:127]
ds_read_b128 v[156:159], v14 offset:9216
v_mfma_f32_16x16x32_bf16 v[124:127], a[28:31], v[188:191], v[124:127]
buffer_load_dwordx4 v18, s[20:23], s46 offen offset:1024 sc1 lds
v_mfma_f32_16x16x32_bf16 v[120:123], a[24:27], v[188:191], v[120:123]
ds_read_b32 v26, v25 offset:12
v_mfma_f32_16x16x32_bf16 v[120:123], a[16:19], v[184:187], v[120:123]
s_waitcnt lgkmcnt(5)
s_add_u32 s42, s42, s44
s_lshl_b32 s44, s44, 7
s_add_u32 s41, s41, s44
v_mfma_f32_16x16x32_bf16 v[128:131], a[16:19], v[192:195], v[128:131]
ds_read_b128 v[160:163], v14 offset:2048
v_mfma_f32_16x16x32_bf16 v[128:131], a[24:27], v[196:199], v[128:131]
buffer_load_dwordx4 v18, s[20:23], s46 offen offset:2048 sc1 lds
v_mfma_f32_16x16x32_bf16 v[132:135], a[28:31], v[196:199], v[132:135]
ds_read_b128 v[164:167], v14 offset:10240
v_mfma_f32_16x16x32_bf16 v[132:135], a[20:23], v[192:195], v[132:135]
s_and_b32 s47, s28, 0x7d0000
s_xor_b32 s47, s47, s37
v_mfma_f32_16x16x32_bf16 v[140:143], a[20:23], v[200:203], v[140:143]
ds_read_b128 v[168:171], v14 offset:3072
v_mfma_f32_16x16x32_bf16 v[140:143], a[28:31], v[204:207], v[140:143]
buffer_load_dwordx4 v18, s[20:23], s46 offen offset:3072 sc1 lds
v_mfma_f32_16x16x32_bf16 v[136:139], a[24:27], v[204:207], v[136:139]
ds_read_b128 v[172:175], v14 offset:11264
v_mfma_f32_16x16x32_bf16 v[136:139], a[16:19], v[200:203], v[136:139]
s_waitcnt lgkmcnt(5)
s_cmp_le_u32 s40, 3
s_cbranch_scc1 L_p2_v_1054
v_mfma_f32_16x16x32_bf16 v[80:83], a[32:35], v[144:147], v[80:83]
s_xor_b32 s47, s47, 0x330000
ds_read_b128 v[176:179], v18 offset:20480
v_mfma_f32_16x16x32_bf16 v[80:83], a[40:43], v[148:151], v[80:83]
buffer_load_dwordx4 a[16:19], v18, s[64:67], s47 offen offset:0 sc1
v_mfma_f32_16x16x32_bf16 v[84:87], a[44:47], v[148:151], v[84:87]
ds_read_b128 v[180:183], v18 offset:28672
v_mfma_f32_16x16x32_bf16 v[84:87], a[36:39], v[144:147], v[84:87]
s_cmp_gt_u32 s40, 4
s_cselect_b32 exec_lo, 0, 0xf0f0f0f
s_mov_b32 exec_hi, 0x0
buffer_load_dword v78, v13, s[16:19], s73 offen sc1
s_mov_b64 exec, -1
s_cselect_b32 s45, 2, 5
v_lshl_add_u32 v14, s45, 14, v18
v_mfma_f32_16x16x32_bf16 v[92:95], a[36:39], v[152:155], v[92:95]
ds_read_b128 v[184:187], v18 offset:21504
v_mfma_f32_16x16x32_bf16 v[92:95], a[44:47], v[156:159], v[92:95]
buffer_load_dwordx4 a[20:23], v18, s[64:67], s47 offen offset:1024 sc1
v_mfma_f32_16x16x32_bf16 v[88:91], a[40:43], v[156:159], v[88:91]
s_and_b32 s47, s28, 0x650000
s_xor_b32 s47, s47, s37
ds_read_b128 v[188:191], v18 offset:29696
v_mfma_f32_16x16x32_bf16 v[88:91], a[32:35], v[152:155], v[88:91]
s_waitcnt lgkmcnt(4)
v_mfma_f32_16x16x32_bf16 v[96:99], a[32:35], v[160:163], v[96:99]
s_xor_b32 s47, s47, 0x3b0000
ds_read_b128 v[192:195], v18 offset:22528
v_mfma_f32_16x16x32_bf16 v[96:99], a[40:43], v[164:167], v[96:99]
buffer_load_dwordx4 a[24:27], v18, s[64:67], s47 offen offset:0 sc1
v_mfma_f32_16x16x32_bf16 v[100:103], a[44:47], v[164:167], v[100:103]
ds_read_b128 v[196:199], v18 offset:30720
v_mfma_f32_16x16x32_bf16 v[100:103], a[36:39], v[160:163], v[100:103]
v_readfirstlane_b32 s45, v26
s_xor_b32 s46, s32, 0xc60000
s_cmp_lt_u32 s45, 7
s_addc_u32 s40, s40, 0
v_mfma_f32_16x16x32_bf16 v[108:111], a[36:39], v[168:171], v[108:111]
s_add_u32 s44, s39, 0
s_cmp_gt_u32 s40, 7
ds_read_b128 v[200:203], v18 offset:23552
v_mfma_f32_16x16x32_bf16 v[108:111], a[44:47], v[172:175], v[108:111]
buffer_load_dwordx4 a[28:31], v18, s[64:67], s47 offen offset:1024 sc1
v_mfma_f32_16x16x32_bf16 v[104:107], a[40:43], v[172:175], v[104:107]
s_cselect_b32 s46, s46, s41
s_cselect_b32 m0, s44, s42
ds_read_b128 v[204:207], v18 offset:31744
v_mfma_f32_16x16x32_bf16 v[104:107], a[32:35], v[168:171], v[104:107]
s_waitcnt lgkmcnt(4)
s_cselect_b32 s28, 0, -1
s_cselect_b32 s44, 0, 0x4000
v_mfma_f32_16x16x32_bf16 v[112:115], a[32:35], v[176:179], v[112:115]
s_waitcnt vmcnt(16)
s_barrier
v_mfma_f32_16x16x32_bf16 v[112:115], a[40:43], v[180:183], v[112:115]
buffer_load_dwordx4 v18, s[20:23], s46 offen offset:0 sc1 lds
v_mfma_f32_16x16x32_bf16 v[116:119], a[44:47], v[180:183], v[116:119]
ds_read_b128 v[144:147], v14 offset:0
v_mfma_f32_16x16x32_bf16 v[116:119], a[36:39], v[176:179], v[116:119]
ds_read_b128 v[148:151], v14 offset:8192
v_mfma_f32_16x16x32_bf16 v[124:127], a[36:39], v[184:187], v[124:127]
ds_read_b128 v[152:155], v14 offset:1024
v_mfma_f32_16x16x32_bf16 v[124:127], a[44:47], v[188:191], v[124:127]
buffer_load_dwordx4 v18, s[20:23], s46 offen offset:1024 sc1 lds
v_mfma_f32_16x16x32_bf16 v[120:123], a[40:43], v[188:191], v[120:123]
ds_read_b128 v[156:159], v14 offset:9216
v_mfma_f32_16x16x32_bf16 v[120:123], a[32:35], v[184:187], v[120:123]
s_waitcnt lgkmcnt(4)
s_add_u32 s42, s42, s44
s_lshl_b32 s44, s44, 7
s_add_u32 s41, s41, s44
v_mfma_f32_16x16x32_bf16 v[128:131], a[32:35], v[192:195], v[128:131]
ds_read_b128 v[160:163], v14 offset:2048
v_mfma_f32_16x16x32_bf16 v[128:131], a[40:43], v[196:199], v[128:131]
buffer_load_dwordx4 v18, s[20:23], s46 offen offset:2048 sc1 lds
v_mfma_f32_16x16x32_bf16 v[132:135], a[44:47], v[196:199], v[132:135]
ds_read_b128 v[164:167], v14 offset:10240
v_mfma_f32_16x16x32_bf16 v[132:135], a[36:39], v[192:195], v[132:135]
s_and_b32 s47, s28, 0x5d0000
s_xor_b32 s47, s47, s37
v_mfma_f32_16x16x32_bf16 v[140:143], a[36:39], v[200:203], v[140:143]
ds_read_b128 v[168:171], v14 offset:3072
v_mfma_f32_16x16x32_bf16 v[140:143], a[44:47], v[204:207], v[140:143]
buffer_load_dwordx4 v18, s[20:23], s46 offen offset:3072 sc1 lds
v_mfma_f32_16x16x32_bf16 v[136:139], a[40:43], v[204:207], v[136:139]
ds_read_b128 v[172:175], v14 offset:11264
v_mfma_f32_16x16x32_bf16 v[136:139], a[32:35], v[200:203], v[136:139]
s_waitcnt lgkmcnt(4)
s_cmp_le_u32 s40, 4
s_cbranch_scc1 L_p2_j_1051
v_mfma_f32_16x16x32_bf16 v[80:83], a[240:243], v[144:147], v[80:83]
s_xor_b32 s47, s47, 0x230000
ds_read_b128 v[176:179], v18 offset:36864
v_mfma_f32_16x16x32_bf16 v[80:83], a[248:251], v[148:151], v[80:83]
buffer_load_dwordx4 a[32:35], v18, s[64:67], s47 offen offset:0 sc1
v_mfma_f32_16x16x32_bf16 v[84:87], a[252:255], v[148:151], v[84:87]
ds_read_b128 v[180:183], v18 offset:45056
v_mfma_f32_16x16x32_bf16 v[84:87], a[244:247], v[144:147], v[84:87]
s_cmp_gt_u32 s40, 5
s_cselect_b32 exec_lo, 0, 0xf0f0f0f
s_mov_b32 exec_hi, 0x0
buffer_load_dword v78, v13, s[16:19], s73 offen sc1
s_mov_b64 exec, -1
s_cselect_b32 s45, 3, 5
v_lshl_add_u32 v14, s45, 14, v18
v_mfma_f32_16x16x32_bf16 v[92:95], a[244:247], v[152:155], v[92:95]
ds_read_b128 v[184:187], v18 offset:37888
v_mfma_f32_16x16x32_bf16 v[92:95], a[252:255], v[156:159], v[92:95]
buffer_load_dwordx4 a[36:39], v18, s[64:67], s47 offen offset:1024 sc1
v_mfma_f32_16x16x32_bf16 v[88:91], a[248:251], v[156:159], v[88:91]
s_and_b32 s47, s28, 0xa50000
s_xor_b32 s47, s47, s37
ds_read_b128 v[188:191], v18 offset:46080
v_mfma_f32_16x16x32_bf16 v[88:91], a[240:243], v[152:155], v[88:91]
s_waitcnt lgkmcnt(4)
v_mfma_f32_16x16x32_bf16 v[96:99], a[240:243], v[160:163], v[96:99]
s_xor_b32 s47, s47, 0x2b0000
ds_read_b128 v[192:195], v18 offset:38912
v_mfma_f32_16x16x32_bf16 v[96:99], a[248:251], v[164:167], v[96:99]
buffer_load_dwordx4 a[40:43], v18, s[64:67], s47 offen offset:0 sc1
v_mfma_f32_16x16x32_bf16 v[100:103], a[252:255], v[164:167], v[100:103]
ds_read_b128 v[196:199], v18 offset:47104
v_mfma_f32_16x16x32_bf16 v[100:103], a[244:247], v[160:163], v[100:103]
v_mfma_f32_16x16x32_bf16 v[108:111], a[244:247], v[168:171], v[108:111]
ds_read_b128 v[200:203], v18 offset:39936
v_mfma_f32_16x16x32_bf16 v[108:111], a[252:255], v[172:175], v[108:111]
buffer_load_dwordx4 a[44:47], v18, s[64:67], s47 offen offset:1024 sc1
v_mfma_f32_16x16x32_bf16 v[104:107], a[248:251], v[172:175], v[104:107]
ds_read_b128 v[204:207], v18 offset:48128
v_mfma_f32_16x16x32_bf16 v[104:107], a[240:243], v[168:171], v[104:107]
s_waitcnt lgkmcnt(4)
s_mov_b32 s46, s41
s_mov_b32 m0, s42
v_mfma_f32_16x16x32_bf16 v[112:115], a[240:243], v[176:179], v[112:115]
s_waitcnt vmcnt(16)
s_barrier
v_mfma_f32_16x16x32_bf16 v[112:115], a[248:251], v[180:183], v[112:115]
buffer_load_dwordx4 v18, s[20:23], s46 offen offset:0 sc1 lds
v_mfma_f32_16x16x32_bf16 v[116:119], a[252:255], v[180:183], v[116:119]
ds_read_b128 v[144:147], v14 offset:0
v_mfma_f32_16x16x32_bf16 v[116:119], a[244:247], v[176:179], v[116:119]
ds_read_b128 v[148:151], v14 offset:8192
v_mfma_f32_16x16x32_bf16 v[124:127], a[244:247], v[184:187], v[124:127]
ds_read_b128 v[152:155], v14 offset:1024
v_mfma_f32_16x16x32_bf16 v[124:127], a[252:255], v[188:191], v[124:127]
buffer_load_dwordx4 v18, s[20:23], s46 offen offset:1024 sc1 lds
v_mfma_f32_16x16x32_bf16 v[120:123], a[248:251], v[188:191], v[120:123]
ds_read_b128 v[156:159], v14 offset:9216
v_mfma_f32_16x16x32_bf16 v[120:123], a[240:243], v[184:187], v[120:123]
s_waitcnt lgkmcnt(4)
s_add_u32 s42, s42, 0x4000
s_add_u32 s41, s41, 0x200000
v_mfma_f32_16x16x32_bf16 v[128:131], a[240:243], v[192:195], v[128:131]
ds_read_b128 v[160:163], v14 offset:2048
v_mfma_f32_16x16x32_bf16 v[128:131], a[248:251], v[196:199], v[128:131]
buffer_load_dwordx4 v18, s[20:23], s46 offen offset:2048 sc1 lds
v_mfma_f32_16x16x32_bf16 v[132:135], a[252:255], v[196:199], v[132:135]
ds_read_b128 v[164:167], v14 offset:10240
v_mfma_f32_16x16x32_bf16 v[132:135], a[244:247], v[192:195], v[132:135]
v_mfma_f32_16x16x32_bf16 v[140:143], a[244:247], v[200:203], v[140:143]
ds_read_b128 v[168:171], v14 offset:3072
v_mfma_f32_16x16x32_bf16 v[140:143], a[252:255], v[204:207], v[140:143]
buffer_load_dwordx4 v18, s[20:23], s46 offen offset:3072 sc1 lds
v_mfma_f32_16x16x32_bf16 v[136:139], a[248:251], v[204:207], v[136:139]
ds_read_b128 v[172:175], v14 offset:11264
v_mfma_f32_16x16x32_bf16 v[136:139], a[240:243], v[200:203], v[136:139]
s_waitcnt lgkmcnt(4)
s_cmp_le_u32 s40, 5
s_cbranch_scc1 L_p2_v_1052
v_mfma_f32_16x16x32_bf16 v[80:83], a[0:3], v[144:147], v[80:83]
s_xor_b32 s47, s37, 0x4c0000
ds_read_b128 v[176:179], v18 offset:53248
v_mfma_f32_16x16x32_bf16 v[80:83], a[8:11], v[148:151], v[80:83]
buffer_load_dwordx4 a[240:243], v18, s[64:67], s47 offen offset:0 sc1
v_mfma_f32_16x16x32_bf16 v[84:87], a[12:15], v[148:151], v[84:87]
ds_read_b128 v[180:183], v18 offset:61440
v_mfma_f32_16x16x32_bf16 v[84:87], a[4:7], v[144:147], v[84:87]
s_cmp_gt_u32 s40, 6
s_cselect_b32 exec_lo, 0, 0xf0f0f0f
s_mov_b32 exec_hi, 0x0
buffer_load_dword v78, v13, s[16:19], s73 offen sc1
s_mov_b64 exec, -1
s_cselect_b32 s45, 4, 5
v_lshl_add_u32 v14, s45, 14, v18
v_mfma_f32_16x16x32_bf16 v[92:95], a[4:7], v[152:155], v[92:95]
ds_read_b128 v[184:187], v18 offset:54272
v_mfma_f32_16x16x32_bf16 v[92:95], a[12:15], v[156:159], v[92:95]
buffer_load_dwordx4 a[244:247], v18, s[64:67], s47 offen offset:1024 sc1
v_mfma_f32_16x16x32_bf16 v[88:91], a[8:11], v[156:159], v[88:91]
ds_read_b128 v[188:191], v18 offset:62464
v_mfma_f32_16x16x32_bf16 v[88:91], a[0:3], v[152:155], v[88:91]
s_waitcnt lgkmcnt(4)
v_mfma_f32_16x16x32_bf16 v[96:99], a[0:3], v[160:163], v[96:99]
s_xor_b32 s47, s37, 0x5c0000
ds_read_b128 v[192:195], v18 offset:55296
v_mfma_f32_16x16x32_bf16 v[96:99], a[8:11], v[164:167], v[96:99]
buffer_load_dwordx4 a[248:251], v18, s[64:67], s47 offen offset:0 sc1
v_mfma_f32_16x16x32_bf16 v[100:103], a[12:15], v[164:167], v[100:103]
ds_read_b128 v[196:199], v18 offset:63488
v_mfma_f32_16x16x32_bf16 v[100:103], a[4:7], v[160:163], v[100:103]
v_mfma_f32_16x16x32_bf16 v[108:111], a[4:7], v[168:171], v[108:111]
ds_read_b128 v[200:203], v18 offset:56320
v_mfma_f32_16x16x32_bf16 v[108:111], a[12:15], v[172:175], v[108:111]
buffer_load_dwordx4 a[252:255], v18, s[64:67], s47 offen offset:1024 sc1
v_mfma_f32_16x16x32_bf16 v[104:107], a[8:11], v[172:175], v[104:107]
ds_read_b128 v[204:207], v18 offset:64512
v_mfma_f32_16x16x32_bf16 v[104:107], a[0:3], v[168:171], v[104:107]
s_waitcnt lgkmcnt(4)
s_mov_b32 s46, s41
s_mov_b32 m0, s42
v_mfma_f32_16x16x32_bf16 v[112:115], a[0:3], v[176:179], v[112:115]
s_waitcnt vmcnt(16)
s_barrier
v_mfma_f32_16x16x32_bf16 v[112:115], a[8:11], v[180:183], v[112:115]
buffer_load_dwordx4 v18, s[20:23], s46 offen offset:0 sc1 lds
v_mfma_f32_16x16x32_bf16 v[116:119], a[12:15], v[180:183], v[116:119]
ds_read_b128 v[144:147], v14 offset:0
v_mfma_f32_16x16x32_bf16 v[116:119], a[4:7], v[176:179], v[116:119]
ds_read_b128 v[148:151], v14 offset:8192
v_mfma_f32_16x16x32_bf16 v[124:127], a[4:7], v[184:187], v[124:127]
ds_read_b128 v[152:155], v14 offset:1024
v_mfma_f32_16x16x32_bf16 v[124:127], a[12:15], v[188:191], v[124:127]
buffer_load_dwordx4 v18, s[20:23], s46 offen offset:1024 sc1 lds
v_mfma_f32_16x16x32_bf16 v[120:123], a[8:11], v[188:191], v[120:123]
ds_read_b128 v[156:159], v14 offset:9216
v_mfma_f32_16x16x32_bf16 v[120:123], a[0:3], v[184:187], v[120:123]
s_waitcnt lgkmcnt(4)
s_add_u32 s42, s42, 0x4000
s_add_u32 s41, s41, 0x200000
v_mfma_f32_16x16x32_bf16 v[128:131], a[0:3], v[192:195], v[128:131]
ds_read_b128 v[160:163], v14 offset:2048
v_mfma_f32_16x16x32_bf16 v[128:131], a[8:11], v[196:199], v[128:131]
buffer_load_dwordx4 v18, s[20:23], s46 offen offset:2048 sc1 lds
v_mfma_f32_16x16x32_bf16 v[132:135], a[12:15], v[196:199], v[132:135]
ds_read_b128 v[164:167], v14 offset:10240
v_mfma_f32_16x16x32_bf16 v[132:135], a[4:7], v[192:195], v[132:135]
v_mfma_f32_16x16x32_bf16 v[140:143], a[4:7], v[200:203], v[140:143]
ds_read_b128 v[168:171], v14 offset:3072
v_mfma_f32_16x16x32_bf16 v[140:143], a[12:15], v[204:207], v[140:143]
buffer_load_dwordx4 v18, s[20:23], s46 offen offset:3072 sc1 lds
v_mfma_f32_16x16x32_bf16 v[136:139], a[8:11], v[204:207], v[136:139]
ds_read_b128 v[172:175], v14 offset:11264
v_mfma_f32_16x16x32_bf16 v[136:139], a[0:3], v[200:203], v[136:139]
s_waitcnt lgkmcnt(4)
s_cmp_le_u32 s40, 6
s_cbranch_scc1 L_p2_v_1053
v_mfma_f32_16x16x32_bf16 v[80:83], a[16:19], v[144:147], v[80:83]
s_xor_b32 s47, s37, 0x7c0000
ds_read_b128 v[176:179], v2 offset:4096
v_mfma_f32_16x16x32_bf16 v[80:83], a[24:27], v[148:151], v[80:83]
buffer_load_dwordx4 a[0:3], v18, s[64:67], s47 offen offset:0 sc1
v_mfma_f32_16x16x32_bf16 v[84:87], a[28:31], v[148:151], v[84:87]
ds_read_b128 v[180:183], v2 offset:12288
v_mfma_f32_16x16x32_bf16 v[84:87], a[20:23], v[144:147], v[84:87]
s_cmp_gt_u32 s40, 7
s_cselect_b32 exec_lo, 0, 0xf0f0f0f
s_mov_b32 exec_hi, 0x0
buffer_load_dword v78, v13, s[16:19], s73 offen sc1
s_mov_b64 exec, -1
s_cselect_b32 s45, 0, 5
v_lshl_add_u32 v14, s45, 14, v18
v_mfma_f32_16x16x32_bf16 v[92:95], a[20:23], v[152:155], v[92:95]
ds_read_b128 v[184:187], v2 offset:5120
v_mfma_f32_16x16x32_bf16 v[92:95], a[28:31], v[156:159], v[92:95]
buffer_load_dwordx4 a[4:7], v18, s[64:67], s47 offen offset:1024 sc1
v_mfma_f32_16x16x32_bf16 v[88:91], a[24:27], v[156:159], v[88:91]
ds_read_b128 v[188:191], v2 offset:13312
v_mfma_f32_16x16x32_bf16 v[88:91], a[16:19], v[152:155], v[88:91]
s_waitcnt lgkmcnt(4)
v_mfma_f32_16x16x32_bf16 v[96:99], a[16:19], v[160:163], v[96:99]
s_xor_b32 s47, s37, 0x8c0000
ds_read_b128 v[192:195], v2 offset:6144
v_mfma_f32_16x16x32_bf16 v[96:99], a[24:27], v[164:167], v[96:99]
buffer_load_dwordx4 a[8:11], v18, s[64:67], s47 offen offset:0 sc1
v_mfma_f32_16x16x32_bf16 v[100:103], a[28:31], v[164:167], v[100:103]
ds_read_b128 v[196:199], v2 offset:14336
v_mfma_f32_16x16x32_bf16 v[100:103], a[20:23], v[160:163], v[100:103]
v_mfma_f32_16x16x32_bf16 v[108:111], a[20:23], v[168:171], v[108:111]
ds_read_b128 v[200:203], v2 offset:7168
v_mfma_f32_16x16x32_bf16 v[108:111], a[28:31], v[172:175], v[108:111]
buffer_load_dwordx4 a[12:15], v18, s[64:67], s47 offen offset:1024 sc1
v_mfma_f32_16x16x32_bf16 v[104:107], a[24:27], v[172:175], v[104:107]
ds_read_b128 v[204:207], v2 offset:15360
v_mfma_f32_16x16x32_bf16 v[104:107], a[16:19], v[168:171], v[104:107]
s_waitcnt lgkmcnt(4)
s_mov_b32 s46, s41
s_mov_b32 m0, s42
v_mfma_f32_16x16x32_bf16 v[112:115], a[16:19], v[176:179], v[112:115]
s_waitcnt vmcnt(16)
s_barrier
v_mfma_f32_16x16x32_bf16 v[112:115], a[24:27], v[180:183], v[112:115]
buffer_load_dwordx4 v18, s[20:23], s46 offen offset:0 sc1 lds
v_mfma_f32_16x16x32_bf16 v[116:119], a[28:31], v[180:183], v[116:119]
ds_read_b128 v[144:147], v14 offset:0
v_mfma_f32_16x16x32_bf16 v[116:119], a[20:23], v[176:179], v[116:119]
ds_read_b128 v[148:151], v14 offset:8192
v_mfma_f32_16x16x32_bf16 v[124:127], a[20:23], v[184:187], v[124:127]
ds_read_b128 v[152:155], v14 offset:1024
v_mfma_f32_16x16x32_bf16 v[124:127], a[28:31], v[188:191], v[124:127]
buffer_load_dwordx4 v18, s[20:23], s46 offen offset:1024 sc1 lds
v_mfma_f32_16x16x32_bf16 v[120:123], a[24:27], v[188:191], v[120:123]
ds_read_b128 v[156:159], v14 offset:9216
v_mfma_f32_16x16x32_bf16 v[120:123], a[16:19], v[184:187], v[120:123]
s_waitcnt lgkmcnt(4)
s_add_u32 s42, s42, 0x4000
s_add_u32 s41, s41, 0x200000
v_mfma_f32_16x16x32_bf16 v[128:131], a[16:19], v[192:195], v[128:131]
ds_read_b128 v[160:163], v14 offset:2048
v_mfma_f32_16x16x32_bf16 v[128:131], a[24:27], v[196:199], v[128:131]
buffer_load_dwordx4 v18, s[20:23], s46 offen offset:2048 sc1 lds
v_mfma_f32_16x16x32_bf16 v[132:135], a[28:31], v[196:199], v[132:135]
ds_read_b128 v[164:167], v14 offset:10240
v_mfma_f32_16x16x32_bf16 v[132:135], a[20:23], v[192:195], v[132:135]
v_mfma_f32_16x16x32_bf16 v[140:143], a[20:23], v[200:203], v[140:143]
ds_read_b128 v[168:171], v14 offset:3072
v_mfma_f32_16x16x32_bf16 v[140:143], a[28:31], v[204:207], v[140:143]
buffer_load_dwordx4 v18, s[20:23], s46 offen offset:3072 sc1 lds
v_mfma_f32_16x16x32_bf16 v[136:139], a[24:27], v[204:207], v[136:139]
ds_read_b128 v[172:175], v14 offset:11264
v_mfma_f32_16x16x32_bf16 v[136:139], a[16:19], v[200:203], v[136:139]
s_waitcnt lgkmcnt(4)
s_cmp_le_u32 s40, 7
s_cbranch_scc1 L_p2_v_1054
v_mfma_f32_16x16x32_bf16 v[80:83], a[32:35], v[144:147], v[80:83]
s_xor_b32 s47, s37, 0x4e0000
ds_read_b128 v[176:179], v18 offset:4096
v_mfma_f32_16x16x32_bf16 v[80:83], a[40:43], v[148:151], v[80:83]
buffer_load_dwordx4 a[16:19], v18, s[64:67], s47 offen offset:0 sc1
v_mfma_f32_16x16x32_bf16 v[84:87], a[44:47], v[148:151], v[84:87]
ds_read_b128 v[180:183], v18 offset:12288
v_mfma_f32_16x16x32_bf16 v[84:87], a[36:39], v[144:147], v[84:87]
s_cmp_gt_u32 s40, 8
s_cselect_b32 exec_lo, 0, 0xf0f0f0f
s_mov_b32 exec_hi, 0x0
buffer_load_dword v78, v13, s[16:19], s73 offen sc1
s_mov_b64 exec, -1
v_mfma_f32_16x16x32_bf16 v[92:95], a[36:39], v[152:155], v[92:95]
ds_read_b128 v[184:187], v18 offset:5120
v_mfma_f32_16x16x32_bf16 v[92:95], a[44:47], v[156:159], v[92:95]
buffer_load_dwordx4 a[20:23], v18, s[64:67], s47 offen offset:1024 sc1
v_mfma_f32_16x16x32_bf16 v[88:91], a[40:43], v[156:159], v[88:91]
ds_read_b128 v[188:191], v18 offset:13312
v_mfma_f32_16x16x32_bf16 v[88:91], a[32:35], v[152:155], v[88:91]
s_waitcnt lgkmcnt(4)
v_mfma_f32_16x16x32_bf16 v[96:99], a[32:35], v[160:163], v[96:99]
s_xor_b32 s47, s37, 0x5e0000
ds_read_b128 v[192:195], v18 offset:6144
v_mfma_f32_16x16x32_bf16 v[96:99], a[40:43], v[164:167], v[96:99]
buffer_load_dwordx4 a[24:27], v18, s[64:67], s47 offen offset:0 sc1
v_mfma_f32_16x16x32_bf16 v[100:103], a[44:47], v[164:167], v[100:103]
ds_read_b128 v[196:199], v18 offset:14336
v_mfma_f32_16x16x32_bf16 v[100:103], a[36:39], v[160:163], v[100:103]
v_mfma_f32_16x16x32_bf16 v[108:111], a[36:39], v[168:171], v[108:111]
ds_read_b128 v[200:203], v18 offset:7168
v_mfma_f32_16x16x32_bf16 v[108:111], a[44:47], v[172:175], v[108:111]
buffer_load_dwordx4 a[28:31], v18, s[64:67], s47 offen offset:1024 sc1
v_mfma_f32_16x16x32_bf16 v[104:107], a[40:43], v[172:175], v[104:107]
ds_read_b128 v[204:207], v18 offset:15360
v_mfma_f32_16x16x32_bf16 v[104:107], a[32:35], v[168:171], v[104:107]
s_waitcnt lgkmcnt(4)
s_mov_b32 s46, s41
s_mov_b32 m0, s42
v_mfma_f32_16x16x32_bf16 v[112:115], a[32:35], v[176:179], v[112:115]
s_waitcnt vmcnt(21)
s_barrier
v_mfma_f32_16x16x32_bf16 v[112:115], a[40:43], v[180:183], v[112:115]
buffer_load_dwordx4 v18, s[20:23], s46 offen offset:0 sc1 lds
v_mfma_f32_16x16x32_bf16 v[116:119], a[44:47], v[180:183], v[116:119]
ds_read_b128 v[144:147], v2 offset:16384
v_mfma_f32_16x16x32_bf16 v[116:119], a[36:39], v[176:179], v[116:119]
ds_read_b128 v[148:151], v2 offset:24576
v_mfma_f32_16x16x32_bf16 v[124:127], a[36:39], v[184:187], v[124:127]
ds_read_b128 v[152:155], v2 offset:17408
v_mfma_f32_16x16x32_bf16 v[124:127], a[44:47], v[188:191], v[124:127]
buffer_load_dwordx4 v18, s[20:23], s46 offen offset:1024 sc1 lds
v_mfma_f32_16x16x32_bf16 v[120:123], a[40:43], v[188:191], v[120:123]
ds_read_b128 v[156:159], v2 offset:25600
v_mfma_f32_16x16x32_bf16 v[120:123], a[32:35], v[184:187], v[120:123]
s_waitcnt lgkmcnt(4)
s_add_u32 s42, s42, 0x4000
s_add_u32 s41, s41, 0x200000
v_mfma_f32_16x16x32_bf16 v[128:131], a[32:35], v[192:195], v[128:131]
ds_read_b128 v[160:163], v2 offset:18432
v_mfma_f32_16x16x32_bf16 v[128:131], a[40:43], v[196:199], v[128:131]
buffer_load_dwordx4 v18, s[20:23], s46 offen offset:2048 sc1 lds
v_mfma_f32_16x16x32_bf16 v[132:135], a[44:47], v[196:199], v[132:135]
ds_read_b128 v[164:167], v2 offset:26624
v_mfma_f32_16x16x32_bf16 v[132:135], a[36:39], v[192:195], v[132:135]
v_mfma_f32_16x16x32_bf16 v[140:143], a[36:39], v[200:203], v[140:143]
ds_read_b128 v[168:171], v2 offset:19456
v_mfma_f32_16x16x32_bf16 v[140:143], a[44:47], v[204:207], v[140:143]
buffer_load_dwordx4 v18, s[20:23], s46 offen offset:3072 sc1 lds
v_mfma_f32_16x16x32_bf16 v[136:139], a[40:43], v[204:207], v[136:139]
ds_read_b128 v[172:175], v2 offset:27648
v_mfma_f32_16x16x32_bf16 v[136:139], a[32:35], v[200:203], v[136:139]
s_waitcnt lgkmcnt(4)
L_p2_j_1051:
v_mfma_f32_16x16x32_bf16 v[80:83], a[48:51], v[144:147], v[80:83]
s_xor_b32 s47, s37, 0x7e0000
ds_read_b128 v[176:179], v2 offset:20480
v_mfma_f32_16x16x32_bf16 v[80:83], a[56:59], v[148:151], v[80:83]
buffer_load_dwordx4 a[32:35], v18, s[64:67], s47 offen offset:0 sc1
v_mfma_f32_16x16x32_bf16 v[84:87], a[60:63], v[148:151], v[84:87]
ds_read_b128 v[180:183], v2 offset:28672
v_mfma_f32_16x16x32_bf16 v[84:87], a[52:55], v[144:147], v[84:87]
v_mfma_f32_16x16x32_bf16 v[92:95], a[52:55], v[152:155], v[92:95]
ds_read_b128 v[184:187], v2 offset:21504
v_mfma_f32_16x16x32_bf16 v[92:95], a[60:63], v[156:159], v[92:95]
buffer_load_dwordx4 a[36:39], v18, s[64:67], s47 offen offset:1024 sc1
v_mfma_f32_16x16x32_bf16 v[88:91], a[56:59], v[156:159], v[88:91]
ds_read_b128 v[188:191], v2 offset:29696
v_mfma_f32_16x16x32_bf16 v[88:91], a[48:51], v[152:155], v[88:91]
s_waitcnt lgkmcnt(4)
v_mfma_f32_16x16x32_bf16 v[96:99], a[48:51], v[160:163], v[96:99]
s_xor_b32 s47, s37, 0x8e0000
ds_read_b128 v[192:195], v2 offset:22528
v_mfma_f32_16x16x32_bf16 v[96:99], a[56:59], v[164:167], v[96:99]
buffer_load_dwordx4 a[40:43], v18, s[64:67], s47 offen offset:0 sc1
v_mfma_f32_16x16x32_bf16 v[100:103], a[60:63], v[164:167], v[100:103]
ds_read_b128 v[196:199], v2 offset:30720
v_mfma_f32_16x16x32_bf16 v[100:103], a[52:55], v[160:163], v[100:103]
v_mfma_f32_16x16x32_bf16 v[108:111], a[52:55], v[168:171], v[108:111]
ds_read_b128 v[200:203], v2 offset:23552
v_mfma_f32_16x16x32_bf16 v[108:111], a[60:63], v[172:175], v[108:111]
buffer_load_dwordx4 a[44:47], v18, s[64:67], s47 offen offset:1024 sc1
v_mfma_f32_16x16x32_bf16 v[104:107], a[56:59], v[172:175], v[104:107]
ds_read_b128 v[204:207], v2 offset:31744
v_mfma_f32_16x16x32_bf16 v[104:107], a[48:51], v[168:171], v[104:107]
s_waitcnt lgkmcnt(4)
L_p2_k_1055:
v_mfma_f32_16x16x32_bf16 v[112:115], a[48:51], v[176:179], v[112:115]
s_waitcnt vmcnt(21)
s_barrier
v_mfma_f32_16x16x32_bf16 v[112:115], a[56:59], v[180:183], v[112:115]
s_xor_b32 s47, s37, 0x480000
ds_read_b128 v[144:147], v2 offset:32768
v_mfma_f32_16x16x32_bf16 v[116:119], a[60:63], v[180:183], v[116:119]
ds_read_b128 v[148:151], v2 offset:40960
v_mfma_f32_16x16x32_bf16 v[116:119], a[52:55], v[176:179], v[116:119]
buffer_load_dwordx4 a[176:179], v18, s[64:67], s47 offen offset:0 sc1
v_mfma_f32_16x16x32_bf16 v[124:127], a[52:55], v[184:187], v[124:127]
ds_read_b128 v[152:155], v2 offset:33792
v_mfma_f32_16x16x32_bf16 v[124:127], a[60:63], v[188:191], v[124:127]
v_mfma_f32_16x16x32_bf16 v[120:123], a[56:59], v[188:191], v[120:123]
ds_read_b128 v[156:159], v2 offset:41984
v_mfma_f32_16x16x32_bf16 v[120:123], a[48:51], v[184:187], v[120:123]
s_waitcnt lgkmcnt(4)
buffer_load_dwordx4 a[180:183], v18, s[64:67], s47 offen offset:1024 sc1
v_mfma_f32_16x16x32_bf16 v[128:131], a[48:51], v[192:195], v[128:131]
s_xor_b32 s47, s37, 0x580000
ds_read_b128 v[160:163], v2 offset:34816
v_mfma_f32_16x16x32_bf16 v[128:131], a[56:59], v[196:199], v[128:131]
v_mfma_f32_16x16x32_bf16 v[132:135], a[60:63], v[196:199], v[132:135]
ds_read_b128 v[164:167], v2 offset:43008
v_mfma_f32_16x16x32_bf16 v[132:135], a[52:55], v[192:195], v[132:135]
buffer_load_dwordx4 a[184:187], v18, s[64:67], s47 offen offset:0 sc1
v_mfma_f32_16x16x32_bf16 v[140:143], a[52:55], v[200:203], v[140:143]
ds_read_b128 v[168:171], v2 offset:35840
v_mfma_f32_16x16x32_bf16 v[140:143], a[60:63], v[204:207], v[140:143]
v_mfma_f32_16x16x32_bf16 v[136:139], a[56:59], v[204:207], v[136:139]
ds_read_b128 v[172:175], v2 offset:44032
v_mfma_f32_16x16x32_bf16 v[136:139], a[48:51], v[200:203], v[136:139]
s_waitcnt lgkmcnt(4)
buffer_load_dwordx4 a[188:191], v18, s[64:67], s47 offen offset:1024 sc1
v_mfma_f32_16x16x32_bf16 v[80:83], a[64:67], v[144:147], v[80:83]
ds_read_b128 v[176:179], v2 offset:36864
v_mfma_f32_16x16x32_bf16 v[80:83], a[72:75], v[148:151], v[80:83]
v_mfma_f32_16x16x32_bf16 v[84:87], a[76:79], v[148:151], v[84:87]
ds_read_b128 v[180:183], v2 offset:45056
v_mfma_f32_16x16x32_bf16 v[84:87], a[68:71], v[144:147], v[84:87]
v_mfma_f32_16x16x32_bf16 v[92:95], a[68:71], v[152:155], v[92:95]
ds_read_b128 v[184:187], v2 offset:37888
v_mfma_f32_16x16x32_bf16 v[92:95], a[76:79], v[156:159], v[92:95]
v_mfma_f32_16x16x32_bf16 v[88:91], a[72:75], v[156:159], v[88:91]
ds_read_b128 v[188:191], v2 offset:46080
v_mfma_f32_16x16x32_bf16 v[88:91], a[64:67], v[152:155], v[88:91]
s_waitcnt lgkmcnt(4)
v_mfma_f32_16x16x32_bf16 v[96:99], a[64:67], v[160:163], v[96:99]
ds_read_b128 v[192:195], v2 offset:38912
v_mfma_f32_16x16x32_bf16 v[96:99], a[72:75], v[164:167], v[96:99]
v_mfma_f32_16x16x32_bf16 v[100:103], a[76:79], v[164:167], v[100:103]
ds_read_b128 v[196:199], v2 offset:47104
v_mfma_f32_16x16x32_bf16 v[100:103], a[68:71], v[160:163], v[100:103]
v_mfma_f32_16x16x32_bf16 v[108:111], a[68:71], v[168:171], v[108:111]
ds_read_b128 v[200:203], v2 offset:39936
v_mfma_f32_16x16x32_bf16 v[108:111], a[76:79], v[172:175], v[108:111]
v_mfma_f32_16x16x32_bf16 v[104:107], a[72:75], v[172:175], v[104:107]
ds_read_b128 v[204:207], v2 offset:48128
v_mfma_f32_16x16x32_bf16 v[104:107], a[64:67], v[168:171], v[104:107]
s_waitcnt lgkmcnt(4)
v_mfma_f32_16x16x32_bf16 v[112:115], a[64:67], v[176:179], v[112:115]
s_waitcnt vmcnt(17)
s_barrier
v_mfma_f32_16x16x32_bf16 v[112:115], a[72:75], v[180:183], v[112:115]
ds_read_b128 v[144:147], v2 offset:49152
v_mfma_f32_16x16x32_bf16 v[116:119], a[76:79], v[180:183], v[116:119]
ds_read_b128 v[148:151], v2 offset:57344
v_mfma_f32_16x16x32_bf16 v[116:119], a[68:71], v[176:179], v[116:119]
s_waitcnt vmcnt(15)
v_cmp_gt_u32 vcc, 2, v78
s_nop 0
s_cmp_lg_u32 vcc_lo, 0
s_cbranch_scc1 L_p2_sp_1065
L_p2_sr_1066:
v_mfma_f32_16x16x32_bf16 v[124:127], a[68:71], v[184:187], v[124:127]
s_add_u32 m0, s39, 0
s_xor_b32 s46, s32, 0x1000000
ds_read_b128 v[152:155], v2 offset:50176
v_mfma_f32_16x16x32_bf16 v[124:127], a[76:79], v[188:191], v[124:127]
buffer_load_dwordx4 v18, s[20:23], s46 offen offset:0 sc1 lds
v_mfma_f32_16x16x32_bf16 v[120:123], a[72:75], v[188:191], v[120:123]
ds_read_b128 v[156:159], v2 offset:58368
v_mfma_f32_16x16x32_bf16 v[120:123], a[64:67], v[184:187], v[120:123]
s_waitcnt lgkmcnt(4)
buffer_load_dwordx4 v18, s[20:23], s46 offen offset:1024 sc1 lds
v_mfma_f32_16x16x32_bf16 v[128:131], a[64:67], v[192:195], v[128:131]
ds_read_b128 v[160:163], v2 offset:51200
v_mfma_f32_16x16x32_bf16 v[128:131], a[72:75], v[196:199], v[128:131]
buffer_load_dwordx4 v18, s[20:23], s46 offen offset:2048 sc1 lds
v_mfma_f32_16x16x32_bf16 v[132:135], a[76:79], v[196:199], v[132:135]
ds_read_b128 v[164:167], v2 offset:59392
v_mfma_f32_16x16x32_bf16 v[132:135], a[68:71], v[192:195], v[132:135]
buffer_load_dwordx4 v18, s[20:23], s46 offen offset:3072 sc1 lds
v_mfma_f32_16x16x32_bf16 v[140:143], a[68:71], v[200:203], v[140:143]
s_add_u32 m0, s39, 16384
s_xor_b32 s46, s32, 0x1040000
ds_read_b128 v[168:171], v2 offset:52224
v_mfma_f32_16x16x32_bf16 v[140:143], a[76:79], v[204:207], v[140:143]
buffer_load_dwordx4 v18, s[20:23], s46 offen offset:0 sc1 lds
v_mfma_f32_16x16x32_bf16 v[136:139], a[72:75], v[204:207], v[136:139]
ds_read_b128 v[172:175], v2 offset:60416
v_mfma_f32_16x16x32_bf16 v[136:139], a[64:67], v[200:203], v[136:139]
s_waitcnt lgkmcnt(4)
buffer_load_dwordx4 v18, s[20:23], s46 offen offset:1024 sc1 lds
v_mfma_f32_16x16x32_bf16 v[80:83], a[80:83], v[144:147], v[80:83]
ds_read_b128 v[176:179], v2 offset:53248
v_mfma_f32_16x16x32_bf16 v[80:83], a[88:91], v[148:151], v[80:83]
buffer_load_dwordx4 v18, s[20:23], s46 offen offset:2048 sc1 lds
v_mfma_f32_16x16x32_bf16 v[84:87], a[92:95], v[148:151], v[84:87]
ds_read_b128 v[180:183], v2 offset:61440
v_mfma_f32_16x16x32_bf16 v[84:87], a[84:87], v[144:147], v[84:87]
buffer_load_dwordx4 v18, s[20:23], s46 offen offset:3072 sc1 lds
v_mfma_f32_16x16x32_bf16 v[92:95], a[84:87], v[152:155], v[92:95]
ds_read_b128 v[184:187], v2 offset:54272
v_mfma_f32_16x16x32_bf16 v[92:95], a[92:95], v[156:159], v[92:95]
v_mfma_f32_16x16x32_bf16 v[88:91], a[88:91], v[156:159], v[88:91]
ds_read_b128 v[188:191], v2 offset:62464
v_mfma_f32_16x16x32_bf16 v[88:91], a[80:83], v[152:155], v[88:91]
s_waitcnt lgkmcnt(4)
v_mfma_f32_16x16x32_bf16 v[96:99], a[80:83], v[160:163], v[96:99]
ds_read_b128 v[192:195], v2 offset:55296
v_mfma_f32_16x16x32_bf16 v[96:99], a[88:91], v[164:167], v[96:99]
v_mfma_f32_16x16x32_bf16 v[100:103], a[92:95], v[164:167], v[100:103]
ds_read_b128 v[196:199], v2 offset:63488
v_mfma_f32_16x16x32_bf16 v[100:103], a[84:87], v[160:163], v[100:103]
v_mfma_f32_16x16x32_bf16 v[108:111], a[84:87], v[168:171], v[108:111]
ds_read_b128 v[200:203], v2 offset:56320
v_mfma_f32_16x16x32_bf16 v[108:111], a[92:95], v[172:175], v[108:111]
v_mfma_f32_16x16x32_bf16 v[104:107], a[88:91], v[172:175], v[104:107]
ds_read_b128 v[204:207], v2 offset:64512
v_mfma_f32_16x16x32_bf16 v[104:107], a[80:83], v[168:171], v[104:107]
s_waitcnt lgkmcnt(4)
v_mfma_f32_16x16x32_bf16 v[112:115], a[80:83], v[176:179], v[112:115]
s_waitcnt vmcnt(16)
s_barrier
v_mfma_f32_16x16x32_bf16 v[112:115], a[88:91], v[180:183], v[112:115]
s_add_u32 m0, s39, 32768
s_xor_b32 s46, s32, 0x1080000
ds_read_b128 v[144:147], v3 offset:0
v_mfma_f32_16x16x32_bf16 v[116:119], a[92:95], v[180:183], v[116:119]
ds_read_b128 v[148:151], v3 offset:8192
v_mfma_f32_16x16x32_bf16 v[116:119], a[84:87], v[176:179], v[116:119]
buffer_load_dwordx4 v18, s[20:23], s46 offen offset:0 sc1 lds
v_mfma_f32_16x16x32_bf16 v[124:127], a[84:87], v[184:187], v[124:127]
ds_read_b128 v[152:155], v3 offset:1024
v_mfma_f32_16x16x32_bf16 v[124:127], a[92:95], v[188:191], v[124:127]
v_mfma_f32_16x16x32_bf16 v[120:123], a[88:91], v[188:191], v[120:123]
ds_read_b128 v[156:159], v3 offset:9216
v_mfma_f32_16x16x32_bf16 v[120:123], a[80:83], v[184:187], v[120:123]
s_waitcnt lgkmcnt(4)
buffer_load_dwordx4 v18, s[20:23], s46 offen offset:1024 sc1 lds
v_mfma_f32_16x16x32_bf16 v[128:131], a[80:83], v[192:195], v[128:131]
ds_read_b128 v[160:163], v3 offset:2048
v_mfma_f32_16x16x32_bf16 v[128:131], a[88:91], v[196:199], v[128:131]
v_mfma_f32_16x16x32_bf16 v[132:135], a[92:95], v[196:199], v[132:135]
ds_read_b128 v[164:167], v3 offset:10240
v_mfma_f32_16x16x32_bf16 v[132:135], a[84:87], v[192:195], v[132:135]
buffer_load_dwordx4 v18, s[20:23], s46 offen offset:2048 sc1 lds
v_mfma_f32_16x16x32_bf16 v[140:143], a[84:87], v[200:203], v[140:143]
ds_read_b128 v[168:171], v3 offset:3072
v_mfma_f32_16x16x32_bf16 v[140:143], a[92:95], v[204:207], v[140:143]
v_mfma_f32_16x16x32_bf16 v[136:139], a[88:91], v[204:207], v[136:139]
ds_read_b128 v[172:175], v3 offset:11264
v_mfma_f32_16x16x32_bf16 v[136:139], a[80:83], v[200:203], v[136:139]
s_waitcnt lgkmcnt(4)
buffer_load_dwordx4 v18, s[20:23], s46 offen offset:3072 sc1 lds
v_mfma_f32_16x16x32_bf16 v[80:83], a[96:99], v[144:147], v[80:83]
s_xor_b32 s47, s37, 0x780000
ds_read_b128 v[176:179], v3 offset:4096
v_mfma_f32_16x16x32_bf16 v[80:83], a[104:107], v[148:151], v[80:83]
v_mfma_f32_16x16x32_bf16 v[84:87], a[108:111], v[148:151], v[84:87]
ds_read_b128 v[180:183], v3 offset:12288
v_mfma_f32_16x16x32_bf16 v[84:87], a[100:103], v[144:147], v[84:87]
buffer_load_dwordx4 a[192:195], v18, s[64:67], s47 offen offset:0 sc1
v_mfma_f32_16x16x32_bf16 v[92:95], a[100:103], v[152:155], v[92:95]
ds_read_b128 v[184:187], v3 offset:5120
v_mfma_f32_16x16x32_bf16 v[92:95], a[108:111], v[156:159], v[92:95]
v_mfma_f32_16x16x32_bf16 v[88:91], a[104:107], v[156:159], v[88:91]
ds_read_b128 v[188:191], v3 offset:13312
v_mfma_f32_16x16x32_bf16 v[88:91], a[96:99], v[152:155], v[88:91]
s_waitcnt lgkmcnt(4)
buffer_load_dwordx4 a[196:199], v18, s[64:67], s47 offen offset:1024 sc1
v_mfma_f32_16x16x32_bf16 v[96:99], a[96:99], v[160:163], v[96:99]
s_xor_b32 s47, s37, 0x880000
ds_read_b128 v[192:195], v3 offset:6144
v_mfma_f32_16x16x32_bf16 v[96:99], a[104:107], v[164:167], v[96:99]
v_mfma_f32_16x16x32_bf16 v[100:103], a[108:111], v[164:167], v[100:103]
ds_read_b128 v[196:199], v3 offset:14336
v_mfma_f32_16x16x32_bf16 v[100:103], a[100:103], v[160:163], v[100:103]
buffer_load_dwordx4 a[200:203], v18, s[64:67], s47 offen offset:0 sc1
v_mfma_f32_16x16x32_bf16 v[108:111], a[100:103], v[168:171], v[108:111]
ds_read_b128 v[200:203], v3 offset:7168
v_mfma_f32_16x16x32_bf16 v[108:111], a[108:111], v[172:175], v[108:111]
v_mfma_f32_16x16x32_bf16 v[104:107], a[104:107], v[172:175], v[104:107]
ds_read_b128 v[204:207], v3 offset:15360
v_mfma_f32_16x16x32_bf16 v[104:107], a[96:99], v[168:171], v[104:107]
s_waitcnt lgkmcnt(4)
buffer_load_dwordx4 a[204:207], v18, s[64:67], s47 offen offset:1024 sc1
v_mfma_f32_16x16x32_bf16 v[112:115], a[96:99], v[176:179], v[112:115]
s_waitcnt vmcnt(12)
s_barrier
v_mfma_f32_16x16x32_bf16 v[112:115], a[104:107], v[180:183], v[112:115]
s_add_u32 m0, s39, 49152
s_xor_b32 s46, s32, 0x10c0000
ds_read_b128 v[144:147], v18 offset:0
v_mfma_f32_16x16x32_bf16 v[116:119], a[108:111], v[180:183], v[116:119]
ds_read_b128 v[148:151], v18 offset:8192
v_mfma_f32_16x16x32_bf16 v[116:119], a[100:103], v[176:179], v[116:119]
buffer_load_dwordx4 v18, s[20:23], s46 offen offset:0 sc1 lds
v_mfma_f32_16x16x32_bf16 v[124:127], a[100:103], v[184:187], v[124:127]
ds_read_b128 v[152:155], v18 offset:1024
v_mfma_f32_16x16x32_bf16 v[124:127], a[108:111], v[188:191], v[124:127]
v_mfma_f32_16x16x32_bf16 v[120:123], a[104:107], v[188:191], v[120:123]
ds_read_b128 v[156:159], v18 offset:9216
v_mfma_f32_16x16x32_bf16 v[120:123], a[96:99], v[184:187], v[120:123]
s_waitcnt lgkmcnt(4)
buffer_load_dwordx4 v18, s[20:23], s46 offen offset:1024 sc1 lds
v_mfma_f32_16x16x32_bf16 v[128:131], a[96:99], v[192:195], v[128:131]
ds_read_b128 v[160:163], v18 offset:2048
v_mfma_f32_16x16x32_bf16 v[128:131], a[104:107], v[196:199], v[128:131]
v_mfma_f32_16x16x32_bf16 v[132:135], a[108:111], v[196:199], v[132:135]
ds_read_b128 v[164:167], v18 offset:10240
v_mfma_f32_16x16x32_bf16 v[132:135], a[100:103], v[192:195], v[132:135]
buffer_load_dwordx4 v18, s[20:23], s46 offen offset:2048 sc1 lds
v_mfma_f32_16x16x32_bf16 v[140:143], a[100:103], v[200:203], v[140:143]
ds_read_b128 v[168:171], v18 offset:3072
v_mfma_f32_16x16x32_bf16 v[140:143], a[108:111], v[204:207], v[140:143]
v_mfma_f32_16x16x32_bf16 v[136:139], a[104:107], v[204:207], v[136:139]
ds_read_b128 v[172:175], v18 offset:11264
v_mfma_f32_16x16x32_bf16 v[136:139], a[96:99], v[200:203], v[136:139]
s_waitcnt lgkmcnt(4)
buffer_load_dwordx4 v18, s[20:23], s46 offen offset:3072 sc1 lds
v_mfma_f32_16x16x32_bf16 v[80:83], a[112:115], v[144:147], v[80:83]
s_xor_b32 s47, s37, 0x4a0000
ds_read_b128 v[176:179], v18 offset:4096
v_mfma_f32_16x16x32_bf16 v[80:83], a[120:123], v[148:151], v[80:83]
v_mfma_f32_16x16x32_bf16 v[84:87], a[124:127], v[148:151], v[84:87]
ds_read_b128 v[180:183], v18 offset:12288
v_mfma_f32_16x16x32_bf16 v[84:87], a[116:119], v[144:147], v[84:87]
buffer_load_dwordx4 a[208:211], v18, s[64:67], s47 offen offset:0 sc1
v_mfma_f32_16x16x32_bf16 v[92:95], a[116:119], v[152:155], v[92:95]
ds_read_b128 v[184:187], v18 offset:5120
v_mfma_f32_16x16x32_bf16 v[92:95], a[124:127], v[156:159], v[92:95]
v_mfma_f32_16x16x32_bf16 v[88:91], a[120:123], v[156:159], v[88:91]
ds_read_b128 v[188:191], v18 offset:13312
v_mfma_f32_16x16x32_bf16 v[88:91], a[112:115], v[152:155], v[88:91]
s_waitcnt lgkmcnt(4)
buffer_load_dwordx4 a[212:215], v18, s[64:67], s47 offen offset:1024 sc1
v_mfma_f32_16x16x32_bf16 v[96:99], a[112:115], v[160:163], v[96:99]
s_xor_b32 s47, s37, 0x5a0000
ds_read_b128 v[192:195], v18 offset:6144
v_mfma_f32_16x16x32_bf16 v[96:99], a[120:123], v[164:167], v[96:99]
v_mfma_f32_16x16x32_bf16 v[100:103], a[124:127], v[164:167], v[100:103]
ds_read_b128 v[196:199], v18 offset:14336
v_mfma_f32_16x16x32_bf16 v[100:103], a[116:119], v[160:163], v[100:103]
buffer_load_dwordx4 a[216:219], v18, s[64:67], s47 offen offset:0 sc1
v_mfma_f32_16x16x32_bf16 v[108:111], a[116:119], v[168:171], v[108:111]
ds_read_b128 v[200:203], v18 offset:7168
v_mfma_f32_16x16x32_bf16 v[108:111], a[124:127], v[172:175], v[108:111]
v_mfma_f32_16x16x32_bf16 v[104:107], a[120:123], v[172:175], v[104:107]
ds_read_b128 v[204:207], v18 offset:15360
v_mfma_f32_16x16x32_bf16 v[104:107], a[112:115], v[168:171], v[104:107]
s_waitcnt lgkmcnt(4)
buffer_load_dwordx4 a[220:223], v18, s[64:67], s47 offen offset:1024 sc1
v_mfma_f32_16x16x32_bf16 v[112:115], a[112:115], v[176:179], v[112:115]
s_waitcnt vmcnt(16)
s_barrier
v_mfma_f32_16x16x32_bf16 v[112:115], a[120:123], v[180:183], v[112:115]
s_add_u32 m0, s39, 65536
s_xor_b32 s46, s33, 0x0
ds_read_b128 v[144:147], v18 offset:16384
v_mfma_f32_16x16x32_bf16 v[116:119], a[124:127], v[180:183], v[116:119]
ds_read_b128 v[148:151], v18 offset:24576
v_mfma_f32_16x16x32_bf16 v[116:119], a[116:119], v[176:179], v[116:119]
buffer_load_dwordx4 v18, s[20:23], s46 offen offset:0 sc1 lds
v_mfma_f32_16x16x32_bf16 v[124:127], a[116:119], v[184:187], v[124:127]
ds_read_b128 v[152:155], v18 offset:17408
v_mfma_f32_16x16x32_bf16 v[124:127], a[124:127], v[188:191], v[124:127]
v_mfma_f32_16x16x32_bf16 v[120:123], a[120:123], v[188:191], v[120:123]
ds_read_b128 v[156:159], v18 offset:25600
v_mfma_f32_16x16x32_bf16 v[120:123], a[112:115], v[184:187], v[120:123]
s_waitcnt lgkmcnt(4)
buffer_load_dwordx4 v18, s[20:23], s46 offen offset:1024 sc1 lds
v_mfma_f32_16x16x32_bf16 v[128:131], a[112:115], v[192:195], v[128:131]
ds_read_b128 v[160:163], v18 offset:18432
v_mfma_f32_16x16x32_bf16 v[128:131], a[120:123], v[196:199], v[128:131]
v_mfma_f32_16x16x32_bf16 v[132:135], a[124:127], v[196:199], v[132:135]
ds_read_b128 v[164:167], v18 offset:26624
v_mfma_f32_16x16x32_bf16 v[132:135], a[116:119], v[192:195], v[132:135]
buffer_load_dwordx4 v18, s[20:23], s46 offen offset:2048 sc1 lds
v_mfma_f32_16x16x32_bf16 v[140:143], a[116:119], v[200:203], v[140:143]
ds_read_b128 v[168:171], v18 offset:19456
v_mfma_f32_16x16x32_bf16 v[140:143], a[124:127], v[204:207], v[140:143]
v_mfma_f32_16x16x32_bf16 v[136:139], a[120:123], v[204:207], v[136:139]
ds_read_b128 v[172:175], v18 offset:27648
v_mfma_f32_16x16x32_bf16 v[136:139], a[112:115], v[200:203], v[136:139]
s_waitcnt lgkmcnt(4)
buffer_load_dwordx4 v18, s[20:23], s46 offen offset:3072 sc1 lds
v_mfma_f32_16x16x32_bf16 v[80:83], a[160:163], v[144:147], v[80:83]
s_xor_b32 s47, s37, 0x7a0000
ds_read_b128 v[176:179], v18 offset:20480
v_mfma_f32_16x16x32_bf16 v[80:83], a[168:171], v[148:151], v[80:83]
v_mfma_f32_16x16x32_bf16 v[84:87], a[172:175], v[148:151], v[84:87]
ds_read_b128 v[180:183], v18 offset:28672
v_mfma_f32_16x16x32_bf16 v[84:87], a[164:167], v[144:147], v[84:87]
buffer_load_dwordx4 a[224:227], v18, s[64:67], s47 offen offset:0 sc1
v_mfma_f32_16x16x32_bf16 v[92:95], a[164:167], v[152:155], v[92:95]
ds_read_b128 v[184:187], v18 offset:21504
v_mfma_f32_16x16x32_bf16 v[92:95], a[172:175], v[156:159], v[92:95]
v_mfma_f32_16x16x32_bf16 v[88:91], a[168:171], v[156:159], v[88:91]
ds_read_b128 v[188:191], v18 offset:29696
v_mfma_f32_16x16x32_bf16 v[88:91], a[160:163], v[152:155], v[88:91]
s_waitcnt lgkmcnt(4)
buffer_load_dwordx4 a[228:231], v18, s[64:67], s47 offen offset:1024 sc1
v_mfma_f32_16x16x32_bf16 v[96:99], a[160:163], v[160:163], v[96:99]
s_xor_b32 s47, s37, 0x8a0000
ds_read_b128 v[192:195], v18 offset:22528
v_mfma_f32_16x16x32_bf16 v[96:99], a[168:171], v[164:167], v[96:99]
v_mfma_f32_16x16x32_bf16 v[100:103], a[172:175], v[164:167], v[100:103]
ds_read_b128 v[196:199], v18 offset:30720
v_mfma_f32_16x16x32_bf16 v[100:103], a[164:167], v[160:163], v[100:103]
buffer_load_dwordx4 a[232:235], v18, s[64:67], s47 offen offset:0 sc1
v_mfma_f32_16x16x32_bf16 v[108:111], a[164:167], v[168:171], v[108:111]
ds_read_b128 v[200:203], v18 offset:23552
v_mfma_f32_16x16x32_bf16 v[108:111], a[172:175], v[172:175], v[108:111]
v_mfma_f32_16x16x32_bf16 v[104:107], a[168:171], v[172:175], v[104:107]
ds_read_b128 v[204:207], v18 offset:31744
v_mfma_f32_16x16x32_bf16 v[104:107], a[160:163], v[168:171], v[104:107]
s_waitcnt lgkmcnt(4)
buffer_load_dwordx4 a[236:239], v18, s[64:67], s47 offen offset:1024 sc1
v_mfma_f32_16x16x32_bf16 v[112:115], a[160:163], v[176:179], v[112:115]
s_waitcnt vmcnt(20)
s_barrier
v_mfma_f32_16x16x32_bf16 v[112:115], a[168:171], v[180:183], v[112:115]
s_add_u32 m0, s39, 81920
s_xor_b32 s46, s33, 0x40000
ds_read_b128 v[144:147], v18 offset:32768
v_mfma_f32_16x16x32_bf16 v[116:119], a[172:175], v[180:183], v[116:119]
ds_read_b128 v[148:151], v18 offset:40960
v_mfma_f32_16x16x32_bf16 v[116:119], a[164:167], v[176:179], v[116:119]
buffer_load_dwordx4 v18, s[20:23], s46 offen offset:0 sc1 lds
v_mfma_f32_16x16x32_bf16 v[124:127], a[164:167], v[184:187], v[124:127]
ds_read_b128 v[152:155], v18 offset:33792
v_mfma_f32_16x16x32_bf16 v[124:127], a[172:175], v[188:191], v[124:127]
v_mfma_f32_16x16x32_bf16 v[120:123], a[168:171], v[188:191], v[120:123]
ds_read_b128 v[156:159], v18 offset:41984
v_mfma_f32_16x16x32_bf16 v[120:123], a[160:163], v[184:187], v[120:123]
s_waitcnt lgkmcnt(4)
buffer_load_dwordx4 v18, s[20:23], s46 offen offset:1024 sc1 lds
v_mfma_f32_16x16x32_bf16 v[128:131], a[160:163], v[192:195], v[128:131]
ds_read_b128 v[160:163], v18 offset:34816
v_mfma_f32_16x16x32_bf16 v[128:131], a[168:171], v[196:199], v[128:131]
v_mfma_f32_16x16x32_bf16 v[132:135], a[172:175], v[196:199], v[132:135]
ds_read_b128 v[164:167], v18 offset:43008
v_mfma_f32_16x16x32_bf16 v[132:135], a[164:167], v[192:195], v[132:135]
buffer_load_dwordx4 v18, s[20:23], s46 offen offset:2048 sc1 lds
v_mfma_f32_16x16x32_bf16 v[140:143], a[164:167], v[200:203], v[140:143]
ds_read_b128 v[168:171], v18 offset:35840
v_mfma_f32_16x16x32_bf16 v[140:143], a[172:175], v[204:207], v[140:143]
v_mfma_f32_16x16x32_bf16 v[136:139], a[168:171], v[204:207], v[136:139]
ds_read_b128 v[172:175], v18 offset:44032
v_mfma_f32_16x16x32_bf16 v[136:139], a[160:163], v[200:203], v[136:139]
s_waitcnt lgkmcnt(4)
buffer_load_dwordx4 v18, s[20:23], s46 offen offset:3072 sc1 lds
v_mfma_f32_16x16x32_bf16 v[80:83], a[128:131], v[144:147], v[80:83]
s_xor_b32 s47, s37, 0x0
ds_read_b128 v[176:179], v18 offset:36864
v_mfma_f32_16x16x32_bf16 v[80:83], a[136:139], v[148:151], v[80:83]
v_mfma_f32_16x16x32_bf16 v[84:87], a[140:143], v[148:151], v[84:87]
ds_read_b128 v[180:183], v18 offset:45056
v_mfma_f32_16x16x32_bf16 v[84:87], a[132:135], v[144:147], v[84:87]
buffer_load_dwordx4 a[48:51], v18, s[64:67], s47 offen offset:0 sc1
v_mfma_f32_16x16x32_bf16 v[92:95], a[132:135], v[152:155], v[92:95]
ds_read_b128 v[184:187], v18 offset:37888
v_mfma_f32_16x16x32_bf16 v[92:95], a[140:143], v[156:159], v[92:95]
v_mfma_f32_16x16x32_bf16 v[88:91], a[136:139], v[156:159], v[88:91]
ds_read_b128 v[188:191], v18 offset:46080
v_mfma_f32_16x16x32_bf16 v[88:91], a[128:131], v[152:155], v[88:91]
s_waitcnt lgkmcnt(4)
buffer_load_dwordx4 a[52:55], v18, s[64:67], s47 offen offset:1024 sc1
v_mfma_f32_16x16x32_bf16 v[96:99], a[128:131], v[160:163], v[96:99]
s_xor_b32 s47, s37, 0x80000
ds_read_b128 v[192:195], v18 offset:38912
v_mfma_f32_16x16x32_bf16 v[96:99], a[136:139], v[164:167], v[96:99]
v_mfma_f32_16x16x32_bf16 v[100:103], a[140:143], v[164:167], v[100:103]
ds_read_b128 v[196:199], v18 offset:47104
v_mfma_f32_16x16x32_bf16 v[100:103], a[132:135], v[160:163], v[100:103]
buffer_load_dwordx4 a[56:59], v18, s[64:67], s47 offen offset:0 sc1
v_mfma_f32_16x16x32_bf16 v[108:111], a[132:135], v[168:171], v[108:111]
ds_read_b128 v[200:203], v18 offset:39936
v_mfma_f32_16x16x32_bf16 v[108:111], a[140:143], v[172:175], v[108:111]
v_mfma_f32_16x16x32_bf16 v[104:107], a[136:139], v[172:175], v[104:107]
ds_read_b128 v[204:207], v18 offset:48128
v_mfma_f32_16x16x32_bf16 v[104:107], a[128:131], v[168:171], v[104:107]
s_waitcnt lgkmcnt(4)
buffer_load_dwordx4 a[60:63], v18, s[64:67], s47 offen offset:1024 sc1
v_mfma_f32_16x16x32_bf16 v[112:115], a[128:131], v[176:179], v[112:115]
s_waitcnt vmcnt(20)
s_barrier
v_mfma_f32_16x16x32_bf16 v[112:115], a[136:139], v[180:183], v[112:115]
ds_read_b128 v[144:147], v18 offset:49152
v_mfma_f32_16x16x32_bf16 v[116:119], a[140:143], v[180:183], v[116:119]
ds_read_b128 v[148:151], v18 offset:57344
v_mfma_f32_16x16x32_bf16 v[116:119], a[132:135], v[176:179], v[116:119]
v_mov_b32 v79, 2
s_mov_b32 exec_lo, 0x0
s_mov_b32 exec_hi, 0xf0f0f0f
buffer_load_dword v79, v13, s[16:19], s73 offen sc1
s_mov_b64 exec, -1
v_mfma_f32_16x16x32_bf16 v[124:127], a[132:135], v[184:187], v[124:127]
s_add_u32 m0, s39, 98304
s_xor_b32 s46, s33, 0x80000
ds_read_b128 v[152:155], v18 offset:50176
v_mfma_f32_16x16x32_bf16 v[124:127], a[140:143], v[188:191], v[124:127]
buffer_load_dwordx4 v18, s[20:23], s46 offen offset:0 sc1 lds
v_mfma_f32_16x16x32_bf16 v[120:123], a[136:139], v[188:191], v[120:123]
ds_read_b128 v[156:159], v18 offset:58368
v_mfma_f32_16x16x32_bf16 v[120:123], a[128:131], v[184:187], v[120:123]
s_waitcnt lgkmcnt(4)
buffer_load_dwordx4 v18, s[20:23], s46 offen offset:1024 sc1 lds
v_mfma_f32_16x16x32_bf16 v[128:131], a[128:131], v[192:195], v[128:131]
ds_read_b128 v[160:163], v18 offset:51200
v_mfma_f32_16x16x32_bf16 v[128:131], a[136:139], v[196:199], v[128:131]
buffer_load_dwordx4 v18, s[20:23], s46 offen offset:2048 sc1 lds
v_mfma_f32_16x16x32_bf16 v[132:135], a[140:143], v[196:199], v[132:135]
ds_read_b128 v[164:167], v18 offset:59392
v_mfma_f32_16x16x32_bf16 v[132:135], a[132:135], v[192:195], v[132:135]
buffer_load_dwordx4 v18, s[20:23], s46 offen offset:3072 sc1 lds
v_mfma_f32_16x16x32_bf16 v[140:143], a[132:135], v[200:203], v[140:143]
s_xor_b32 s47, s37, 0x100000
ds_read_b128 v[168:171], v18 offset:52224
v_mfma_f32_16x16x32_bf16 v[140:143], a[140:143], v[204:207], v[140:143]
buffer_load_dwordx4 a[64:67], v18, s[64:67], s47 offen offset:0 sc1
v_mfma_f32_16x16x32_bf16 v[136:139], a[136:139], v[204:207], v[136:139]
ds_read_b128 v[172:175], v18 offset:60416
v_mfma_f32_16x16x32_bf16 v[136:139], a[128:131], v[200:203], v[136:139]
s_waitcnt lgkmcnt(4)
buffer_load_dwordx4 a[68:71], v18, s[64:67], s47 offen offset:1024 sc1
v_mfma_f32_16x16x32_bf16 v[80:83], a[144:147], v[144:147], v[80:83]
s_xor_b32 s47, s37, 0x180000
ds_read_b128 v[176:179], v18 offset:53248
v_mfma_f32_16x16x32_bf16 v[80:83], a[152:155], v[148:151], v[80:83]
buffer_load_dwordx4 a[72:75], v18, s[64:67], s47 offen offset:0 sc1
v_mfma_f32_16x16x32_bf16 v[84:87], a[156:159], v[148:151], v[84:87]
ds_read_b128 v[180:183], v18 offset:61440
v_mfma_f32_16x16x32_bf16 v[84:87], a[148:151], v[144:147], v[84:87]
buffer_load_dwordx4 a[76:79], v18, s[64:67], s47 offen offset:1024 sc1
v_mfma_f32_16x16x32_bf16 v[92:95], a[148:151], v[152:155], v[92:95]
ds_read_b128 v[184:187], v18 offset:54272
v_mfma_f32_16x16x32_bf16 v[92:95], a[156:159], v[156:159], v[92:95]
v_mfma_f32_16x16x32_bf16 v[88:91], a[152:155], v[156:159], v[88:91]
ds_read_b128 v[188:191], v18 offset:62464
v_mfma_f32_16x16x32_bf16 v[88:91], a[144:147], v[152:155], v[88:91]
s_waitcnt lgkmcnt(4)
v_mfma_f32_16x16x32_bf16 v[96:99], a[144:147], v[160:163], v[96:99]
ds_read_b128 v[192:195], v18 offset:55296
v_mfma_f32_16x16x32_bf16 v[96:99], a[152:155], v[164:167], v[96:99]
v_mfma_f32_16x16x32_bf16 v[100:103], a[156:159], v[164:167], v[100:103]
ds_read_b128 v[196:199], v18 offset:63488
v_mfma_f32_16x16x32_bf16 v[100:103], a[148:151], v[160:163], v[100:103]
v_mfma_f32_16x16x32_bf16 v[108:111], a[148:151], v[168:171], v[108:111]
ds_read_b128 v[200:203], v18 offset:56320
v_mfma_f32_16x16x32_bf16 v[108:111], a[156:159], v[172:175], v[108:111]
v_mfma_f32_16x16x32_bf16 v[104:107], a[152:155], v[172:175], v[104:107]
ds_read_b128 v[204:207], v18 offset:64512
v_mfma_f32_16x16x32_bf16 v[104:107], a[144:147], v[168:171], v[104:107]
s_waitcnt lgkmcnt(4)
v_mfma_f32_16x16x32_bf16 v[112:115], a[144:147], v[176:179], v[112:115]
s_waitcnt vmcnt(21)
s_barrier
v_mfma_f32_16x16x32_bf16 v[112:115], a[152:155], v[180:183], v[112:115]
s_add_u32 m0, s39, 114688
s_xor_b32 s46, s33, 0xc0000
ds_read_b128 v[144:147], v2 offset:0
v_mfma_f32_16x16x32_bf16 v[116:119], a[156:159], v[180:183], v[116:119]
ds_read_b128 v[148:151], v2 offset:4096
v_mfma_f32_16x16x32_bf16 v[116:119], a[148:151], v[176:179], v[116:119]
buffer_load_dwordx4 v18, s[20:23], s46 offen offset:0 sc1 lds
v_mfma_f32_16x16x32_bf16 v[124:127], a[148:151], v[184:187], v[124:127]
ds_read_b128 v[152:155], v2 offset:8192
v_mfma_f32_16x16x32_bf16 v[124:127], a[156:159], v[188:191], v[124:127]
v_mfma_f32_16x16x32_bf16 v[120:123], a[152:155], v[188:191], v[120:123]
ds_read_b128 v[156:159], v2 offset:12288
v_mfma_f32_16x16x32_bf16 v[120:123], a[144:147], v[184:187], v[120:123]
s_waitcnt lgkmcnt(4)
buffer_load_dwordx4 v18, s[20:23], s46 offen offset:1024 sc1 lds
v_mfma_f32_16x16x32_bf16 v[128:131], a[144:147], v[192:195], v[128:131]
ds_read_b128 v[160:163], v2 offset:1024
v_mfma_f32_16x16x32_bf16 v[128:131], a[152:155], v[196:199], v[128:131]
v_mfma_f32_16x16x32_bf16 v[132:135], a[156:159], v[196:199], v[132:135]
ds_read_b128 v[164:167], v2 offset:5120
v_mfma_f32_16x16x32_bf16 v[132:135], a[148:151], v[192:195], v[132:135]
buffer_load_dwordx4 v18, s[20:23], s46 offen offset:2048 sc1 lds
v_mfma_f32_16x16x32_bf16 v[140:143], a[148:151], v[200:203], v[140:143]
ds_read_b128 v[168:171], v2 offset:9216
v_mfma_f32_16x16x32_bf16 v[140:143], a[156:159], v[204:207], v[140:143]
v_mfma_f32_16x16x32_bf16 v[136:139], a[152:155], v[204:207], v[136:139]
ds_read_b128 v[172:175], v2 offset:13312
v_mfma_f32_16x16x32_bf16 v[136:139], a[144:147], v[200:203], v[136:139]
s_waitcnt lgkmcnt(4)
buffer_load_dwordx4 v18, s[20:23], s46 offen offset:3072 sc1 lds
v_mfma_f32_16x16x32_bf16 v[112:115], a[176:179], v[144:147], v[112:115]
s_xor_b32 s47, s37, 0x20000
ds_read_b128 v[176:179], v2 offset:2048
v_mfma_f32_16x16x32_bf16 v[112:115], a[184:187], v[148:151], v[112:115]
v_mfma_f32_16x16x32_bf16 v[112:115], a[192:195], v[152:155], v[112:115]
ds_read_b128 v[180:183], v2 offset:6144
v_mfma_f32_16x16x32_bf16 v[112:115], a[200:203], v[156:159], v[112:115]
buffer_load_dwordx4 a[80:83], v18, s[64:67], s47 offen offset:0 sc1
v_mfma_f32_16x16x32_bf16 v[116:119], a[204:207], v[156:159], v[116:119]
ds_read_b128 v[184:187], v2 offset:10240
v_mfma_f32_16x16x32_bf16 v[116:119], a[196:199], v[152:155], v[116:119]
v_mfma_f32_16x16x32_bf16 v[116:119], a[188:191], v[148:151], v[116:119]
ds_read_b128 v[188:191], v2 offset:14336
v_mfma_f32_16x16x32_bf16 v[116:119], a[180:183], v[144:147], v[116:119]
s_waitcnt lgkmcnt(4)
buffer_load_dwordx4 a[84:87], v18, s[64:67], s47 offen offset:1024 sc1
v_mfma_f32_16x16x32_bf16 v[124:127], a[180:183], v[160:163], v[124:127]
s_xor_b32 s47, s37, 0xa0000
ds_read_b128 v[192:195], v2 offset:3072
v_mfma_f32_16x16x32_bf16 v[124:127], a[188:191], v[164:167], v[124:127]
v_mfma_f32_16x16x32_bf16 v[124:127], a[196:199], v[168:171], v[124:127]
ds_read_b128 v[196:199], v2 offset:7168
v_mfma_f32_16x16x32_bf16 v[124:127], a[204:207], v[172:175], v[124:127]
buffer_load_dwordx4 a[88:91], v18, s[64:67], s47 offen offset:0 sc1
v_mfma_f32_16x16x32_bf16 v[120:123], a[200:203], v[172:175], v[120:123]
ds_read_b128 v[200:203], v2 offset:11264
v_mfma_f32_16x16x32_bf16 v[120:123], a[192:195], v[168:171], v[120:123]
v_mfma_f32_16x16x32_bf16 v[120:123], a[184:187], v[164:167], v[120:123]
ds_read_b128 v[204:207], v2 offset:15360
v_mfma_f32_16x16x32_bf16 v[120:123], a[176:179], v[160:163], v[120:123]
s_waitcnt lgkmcnt(4)
buffer_load_dwordx4 a[92:95], v18, s[64:67], s47 offen offset:1024 sc1
v_mfma_f32_16x16x32_bf16 v[128:131], a[176:179], v[176:179], v[128:131]
s_waitcnt vmcnt(21)
s_barrier
v_mfma_f32_16x16x32_bf16 v[128:131], a[184:187], v[180:183], v[128:131]
ds_read_b128 v[144:147], v2 offset:16384
v_mfma_f32_16x16x32_bf16 v[128:131], a[192:195], v[184:187], v[128:131]
ds_read_b128 v[148:151], v2 offset:20480
v_mfma_f32_16x16x32_bf16 v[128:131], a[200:203], v[188:191], v[128:131]
s_waitcnt vmcnt(16)
v_cmp_gt_u32 vcc, 2, v79
s_nop 0
s_cmp_lg_u32 vcc_hi, 0
s_cbranch_scc1 L_p2_sp_1067
L_p2_sr_1068:
v_mfma_f32_16x16x32_bf16 v[132:135], a[204:207], v[188:191], v[132:135]
s_add_u32 m0, s39, 131072
s_xor_b32 s46, s33, 0x400000
ds_read_b128 v[152:155], v2 offset:24576
v_mfma_f32_16x16x32_bf16 v[132:135], a[196:199], v[184:187], v[132:135]
buffer_load_dwordx4 v18, s[20:23], s46 offen offset:0 sc1 lds
v_mfma_f32_16x16x32_bf16 v[132:135], a[188:191], v[180:183], v[132:135]
ds_read_b128 v[156:159], v2 offset:28672
v_mfma_f32_16x16x32_bf16 v[132:135], a[180:183], v[176:179], v[132:135]
s_waitcnt lgkmcnt(4)
buffer_load_dwordx4 v18, s[20:23], s46 offen offset:1024 sc1 lds
v_mfma_f32_16x16x32_bf16 v[140:143], a[180:183], v[192:195], v[140:143]
ds_read_b128 v[160:163], v2 offset:17408
v_mfma_f32_16x16x32_bf16 v[140:143], a[188:191], v[196:199], v[140:143]
buffer_load_dwordx4 v18, s[20:23], s46 offen offset:2048 sc1 lds
v_mfma_f32_16x16x32_bf16 v[140:143], a[196:199], v[200:203], v[140:143]
ds_read_b128 v[164:167], v2 offset:21504
v_mfma_f32_16x16x32_bf16 v[140:143], a[204:207], v[204:207], v[140:143]
buffer_load_dwordx4 v18, s[20:23], s46 offen offset:3072 sc1 lds
v_mfma_f32_16x16x32_bf16 v[136:139], a[200:203], v[204:207], v[136:139]
s_xor_b32 s47, s37, 0x120000
ds_read_b128 v[168:171], v2 offset:25600
v_mfma_f32_16x16x32_bf16 v[136:139], a[192:195], v[200:203], v[136:139]
buffer_load_dwordx4 a[96:99], v18, s[64:67], s47 offen offset:0 sc1
v_mfma_f32_16x16x32_bf16 v[136:139], a[184:187], v[196:199], v[136:139]
ds_read_b128 v[172:175], v2 offset:29696
v_mfma_f32_16x16x32_bf16 v[136:139], a[176:179], v[192:195], v[136:139]
s_waitcnt lgkmcnt(4)
buffer_load_dwordx4 a[100:103], v18, s[64:67], s47 offen offset:1024 sc1
v_mfma_f32_16x16x32_bf16 v[112:115], a[208:211], v[144:147], v[112:115]
s_xor_b32 s47, s37, 0x1a0000
ds_read_b128 v[176:179], v2 offset:18432
v_lshlrev_b32_e64 v9, 16, v240
v_mfma_f32_16x16x32_bf16 v[112:115], a[216:219], v[148:151], v[112:115]
buffer_load_dwordx4 a[104:107], v18, s[64:67], s47 offen offset:0 sc1
v_mfma_f32_16x16x32_bf16 v[112:115], a[224:227], v[152:155], v[112:115]
ds_read_b128 v[180:183], v2 offset:22528
v_and_b32_e64 v10, s36, v240
v_mfma_f32_16x16x32_bf16 v[112:115], a[232:235], v[156:159], v[112:115]
buffer_load_dwordx4 a[108:111], v18, s[64:67], s47 offen offset:1024 sc1
v_mfma_f32_16x16x32_bf16 v[116:119], a[236:239], v[156:159], v[116:119]
ds_read_b128 v[184:187], v2 offset:26624
v_add_f32_e64 v80, v80, v9
v_mfma_f32_16x16x32_bf16 v[116:119], a[228:231], v[152:155], v[116:119]
v_add_f32_e64 v81, v81, v10
v_mfma_f32_16x16x32_bf16 v[116:119], a[220:223], v[148:151], v[116:119]
ds_read_b128 v[188:191], v2 offset:30720
v_lshlrev_b32_e64 v9, 16, v241
v_mfma_f32_16x16x32_bf16 v[116:119], a[212:215], v[144:147], v[116:119]
s_waitcnt lgkmcnt(4)
v_and_b32 v10, s36, v241
v_mfma_f32_16x16x32_bf16 v[124:127], a[212:215], v[160:163], v[124:127]
ds_read_b128 v[192:195], v2 offset:19456
v_add_f32_e64 v82, v82, v9
v_mfma_f32_16x16x32_bf16 v[124:127], a[220:223], v[164:167], v[124:127]
v_add_f32_e64 v83, v83, v10
v_mfma_f32_16x16x32_bf16 v[124:127], a[228:231], v[168:171], v[124:127]
ds_read_b128 v[196:199], v2 offset:23552
v_lshlrev_b32_e64 v9, 16, v242
v_mfma_f32_16x16x32_bf16 v[124:127], a[236:239], v[172:175], v[124:127]
v_and_b32_e64 v10, s36, v242
v_mfma_f32_16x16x32_bf16 v[120:123], a[232:235], v[172:175], v[120:123]
ds_read_b128 v[200:203], v2 offset:27648
v_add_f32_e64 v84, v84, v9
v_mfma_f32_16x16x32_bf16 v[120:123], a[224:227], v[168:171], v[120:123]
v_add_f32_e64 v85, v85, v10
v_mfma_f32_16x16x32_bf16 v[120:123], a[216:219], v[164:167], v[120:123]
ds_read_b128 v[204:207], v2 offset:31744
v_lshlrev_b32_e64 v9, 16, v243
v_mfma_f32_16x16x32_bf16 v[120:123], a[208:211], v[160:163], v[120:123]
s_waitcnt lgkmcnt(4)
v_and_b32 v10, s36, v243
v_mfma_f32_16x16x32_bf16 v[128:131], a[208:211], v[176:179], v[128:131]
s_waitcnt vmcnt(20)
s_barrier
v_mfma_f32_16x16x32_bf16 v[128:131], a[216:219], v[180:183], v[128:131]
s_add_u32 m0, s39, 0
s_xor_b32 s46, s33, 0x440000
ds_read_b128 v[144:147], v2 offset:32768
v_mfma_f32_16x16x32_bf16 v[128:131], a[224:227], v[184:187], v[128:131]
ds_read_b128 v[148:151], v2 offset:36864
v_add_f32 v86, v86, v9
v_mfma_f32_16x16x32_bf16 v[128:131], a[232:235], v[188:191], v[128:131]
buffer_load_dwordx4 v18, s[20:23], s46 offen offset:0 sc1 lds
v_mfma_f32_16x16x32_bf16 v[132:135], a[236:239], v[188:191], v[132:135]
ds_read_b128 v[152:155], v2 offset:40960
v_add_f32_e64 v87, v87, v10
v_mfma_f32_16x16x32_bf16 v[132:135], a[228:231], v[184:187], v[132:135]
v_mfma_f32_16x16x32_bf16 v[132:135], a[220:223], v[180:183], v[132:135]
ds_read_b128 v[156:159], v2 offset:45056
v_mfma_f32_16x16x32_bf16 v[132:135], a[212:215], v[176:179], v[132:135]
s_waitcnt lgkmcnt(4)
buffer_load_dwordx4 v18, s[20:23], s46 offen offset:1024 sc1 lds
v_mfma_f32_16x16x32_bf16 v[140:143], a[212:215], v[192:195], v[140:143]
ds_read_b128 v[160:163], v2 offset:33792
v_mfma_f32_16x16x32_bf16 v[140:143], a[220:223], v[196:199], v[140:143]
v_mfma_f32_16x16x32_bf16 v[140:143], a[228:231], v[200:203], v[140:143]
ds_read_b128 v[164:167], v2 offset:37888
v_mfma_f32_16x16x32_bf16 v[140:143], a[236:239], v[204:207], v[140:143]
buffer_load_dwordx4 v18, s[20:23], s46 offen offset:2048 sc1 lds
v_mfma_f32_16x16x32_bf16 v[136:139], a[232:235], v[204:207], v[136:139]
ds_read_b128 v[168:171], v2 offset:41984
v_mfma_f32_16x16x32_bf16 v[136:139], a[224:227], v[200:203], v[136:139]
v_mfma_f32_16x16x32_bf16 v[136:139], a[216:219], v[196:199], v[136:139]
ds_read_b128 v[172:175], v2 offset:46080
v_mfma_f32_16x16x32_bf16 v[136:139], a[208:211], v[192:195], v[136:139]
s_waitcnt lgkmcnt(4)
buffer_load_dwordx4 v18, s[20:23], s46 offen offset:3072 sc1 lds
v_mfma_f32_16x16x32_bf16 v[112:115], a[240:243], v[144:147], v[112:115]
s_xor_b32 s47, s37, 0x40000
ds_read_b128 v[176:179], v2 offset:34816
v_lshlrev_b32_e64 v9, 16, v244
v_mfma_f32_16x16x32_bf16 v[112:115], a[248:251], v[148:151], v[112:115]
v_and_b32_e64 v10, s36, v244
v_mfma_f32_16x16x32_bf16 v[112:115], a[0:3], v[152:155], v[112:115]
ds_read_b128 v[180:183], v2 offset:38912
v_add_f32_e64 v88, v88, v9
v_mfma_f32_16x16x32_bf16 v[112:115], a[8:11], v[156:159], v[112:115]
buffer_load_dwordx4 a[112:115], v18, s[64:67], s47 offen offset:0 sc1
v_mfma_f32_16x16x32_bf16 v[116:119], a[12:15], v[156:159], v[116:119]
ds_read_b128 v[184:187], v2 offset:43008
v_add_f32_e64 v89, v89, v10
v_mfma_f32_16x16x32_bf16 v[116:119], a[4:7], v[152:155], v[116:119]
v_lshlrev_b32_e64 v9, 16, v245
v_mfma_f32_16x16x32_bf16 v[116:119], a[252:255], v[148:151], v[116:119]
ds_read_b128 v[188:191], v2 offset:47104
v_and_b32_e64 v10, s36, v245
v_mfma_f32_16x16x32_bf16 v[116:119], a[244:247], v[144:147], v[116:119]
s_waitcnt lgkmcnt(4)
buffer_load_dwordx4 a[116:119], v18, s[64:67], s47 offen offset:1024 sc1
v_mfma_f32_16x16x32_bf16 v[124:127], a[244:247], v[160:163], v[124:127]
s_xor_b32 s47, s37, 0xc0000
ds_read_b128 v[192:195], v2 offset:35840
v_add_f32 v90, v90, v9
v_mfma_f32_16x16x32_bf16 v[124:127], a[252:255], v[164:167], v[124:127]
v_add_f32_e64 v91, v91, v10
v_mfma_f32_16x16x32_bf16 v[124:127], a[4:7], v[168:171], v[124:127]
ds_read_b128 v[196:199], v2 offset:39936
v_lshlrev_b32_e64 v9, 16, v246
v_mfma_f32_16x16x32_bf16 v[124:127], a[12:15], v[172:175], v[124:127]
buffer_load_dwordx4 a[120:123], v18, s[64:67], s47 offen offset:0 sc1
v_mfma_f32_16x16x32_bf16 v[120:123], a[8:11], v[172:175], v[120:123]
ds_read_b128 v[200:203], v2 offset:44032
v_and_b32_e64 v10, s36, v246
v_mfma_f32_16x16x32_bf16 v[120:123], a[0:3], v[168:171], v[120:123]
v_add_f32_e64 v92, v92, v9
v_mfma_f32_16x16x32_bf16 v[120:123], a[248:251], v[164:167], v[120:123]
ds_read_b128 v[204:207], v2 offset:48128
v_add_f32_e64 v93, v93, v10
v_mfma_f32_16x16x32_bf16 v[120:123], a[240:243], v[160:163], v[120:123]
s_waitcnt lgkmcnt(4)
buffer_load_dwordx4 a[124:127], v18, s[64:67], s47 offen offset:1024 sc1
v_mfma_f32_16x16x32_bf16 v[128:131], a[240:243], v[176:179], v[128:131]
s_waitcnt vmcnt(20)
s_barrier
v_mfma_f32_16x16x32_bf16 v[128:131], a[248:251], v[180:183], v[128:131]
s_add_u32 m0, s39, 16384
s_xor_b32 s46, s33, 0x480000
ds_read_b128 v[144:147], v2 offset:49152
v_mfma_f32_16x16x32_bf16 v[128:131], a[0:3], v[184:187], v[128:131]
ds_read_b128 v[148:151], v2 offset:53248
v_lshlrev_b32 v9, 16, v247
v_mfma_f32_16x16x32_bf16 v[128:131], a[8:11], v[188:191], v[128:131]
buffer_load_dwordx4 v18, s[20:23], s46 offen offset:0 sc1 lds
v_mfma_f32_16x16x32_bf16 v[132:135], a[12:15], v[188:191], v[132:135]
ds_read_b128 v[152:155], v2 offset:57344
v_and_b32_e64 v10, s36, v247
v_mfma_f32_16x16x32_bf16 v[132:135], a[4:7], v[184:187], v[132:135]
v_add_f32_e64 v94, v94, v9
v_mfma_f32_16x16x32_bf16 v[132:135], a[252:255], v[180:183], v[132:135]
ds_read_b128 v[156:159], v2 offset:61440
v_add_f32_e64 v95, v95, v10
v_mfma_f32_16x16x32_bf16 v[132:135], a[244:247], v[176:179], v[132:135]
s_waitcnt lgkmcnt(4)
buffer_load_dwordx4 v18, s[20:23], s46 offen offset:1024 sc1 lds
v_mfma_f32_16x16x32_bf16 v[140:143], a[244:247], v[192:195], v[140:143]
ds_read_b128 v[160:163], v2 offset:50176
v_mfma_f32_16x16x32_bf16 v[140:143], a[252:255], v[196:199], v[140:143]
v_mfma_f32_16x16x32_bf16 v[140:143], a[4:7], v[200:203], v[140:143]
ds_read_b128 v[164:167], v2 offset:54272
v_mfma_f32_16x16x32_bf16 v[140:143], a[12:15], v[204:207], v[140:143]
buffer_load_dwordx4 v18, s[20:23], s46 offen offset:2048 sc1 lds
v_mfma_f32_16x16x32_bf16 v[136:139], a[8:11], v[204:207], v[136:139]
ds_read_b128 v[168:171], v2 offset:58368
v_mfma_f32_16x16x32_bf16 v[136:139], a[0:3], v[200:203], v[136:139]
v_mfma_f32_16x16x32_bf16 v[136:139], a[248:251], v[196:199], v[136:139]
ds_read_b128 v[172:175], v2 offset:62464
v_mfma_f32_16x16x32_bf16 v[136:139], a[240:243], v[192:195], v[136:139]
s_waitcnt lgkmcnt(4)
buffer_load_dwordx4 v18, s[20:23], s46 offen offset:3072 sc1 lds
v_mfma_f32_16x16x32_bf16 v[112:115], a[16:19], v[144:147], v[112:115]
s_xor_b32 s47, s37, 0x140000
ds_read_b128 v[176:179], v2 offset:51200
v_lshlrev_b32_e64 v9, 16, v248
v_mfma_f32_16x16x32_bf16 v[112:115], a[24:27], v[148:151], v[112:115]
v_and_b32_e64 v10, s36, v248
v_mfma_f32_16x16x32_bf16 v[112:115], a[32:35], v[152:155], v[112:115]
ds_read_b128 v[180:183], v2 offset:55296
v_add_f32_e64 v96, v96, v9
v_mfma_f32_16x16x32_bf16 v[112:115], a[40:43], v[156:159], v[112:115]
buffer_load_dwordx4 a[160:163], v18, s[64:67], s47 offen offset:0 sc1
v_mfma_f32_16x16x32_bf16 v[116:119], a[44:47], v[156:159], v[116:119]
ds_read_b128 v[184:187], v2 offset:59392
v_add_f32_e64 v97, v97, v10
v_mfma_f32_16x16x32_bf16 v[116:119], a[36:39], v[152:155], v[116:119]
v_lshlrev_b32_e64 v9, 16, v249
v_mfma_f32_16x16x32_bf16 v[116:119], a[28:31], v[148:151], v[116:119]
ds_read_b128 v[188:191], v2 offset:63488
v_and_b32_e64 v10, s36, v249
v_mfma_f32_16x16x32_bf16 v[116:119], a[20:23], v[144:147], v[116:119]
s_waitcnt lgkmcnt(4)
buffer_load_dwordx4 a[164:167], v18, s[64:67], s47 offen offset:1024 sc1
v_mfma_f32_16x16x32_bf16 v[124:127], a[20:23], v[160:163], v[124:127]
s_xor_b32 s47, s37, 0x1c0000
ds_read_b128 v[192:195], v2 offset:52224
v_add_f32 v98, v98, v9
v_mfma_f32_16x16x32_bf16 v[124:127], a[28:31], v[164:167], v[124:127]
v_add_f32_e64 v99, v99, v10
v_mfma_f32_16x16x32_bf16 v[124:127], a[36:39], v[168:171], v[124:127]
ds_read_b128 v[196:199], v2 offset:56320
v_lshlrev_b32_e64 v9, 16, v250
v_mfma_f32_16x16x32_bf16 v[124:127], a[44:47], v[172:175], v[124:127]
buffer_load_dwordx4 a[168:171], v18, s[64:67], s47 offen offset:0 sc1
v_mfma_f32_16x16x32_bf16 v[120:123], a[40:43], v[172:175], v[120:123]
ds_read_b128 v[200:203], v2 offset:60416
v_and_b32_e64 v10, s36, v250
v_mfma_f32_16x16x32_bf16 v[120:123], a[32:35], v[168:171], v[120:123]
v_add_f32_e64 v100, v100, v9
v_mfma_f32_16x16x32_bf16 v[120:123], a[24:27], v[164:167], v[120:123]
ds_read_b128 v[204:207], v2 offset:64512
v_add_f32_e64 v101, v101, v10
v_mfma_f32_16x16x32_bf16 v[120:123], a[16:19], v[160:163], v[120:123]
s_waitcnt lgkmcnt(4)
buffer_load_dwordx4 a[172:175], v18, s[64:67], s47 offen offset:1024 sc1
v_mfma_f32_16x16x32_bf16 v[128:131], a[16:19], v[176:179], v[128:131]
s_waitcnt vmcnt(20)
s_barrier
v_mfma_f32_16x16x32_bf16 v[128:131], a[24:27], v[180:183], v[128:131]
s_add_u32 m0, s39, 32768
s_xor_b32 s46, s33, 0x4c0000
ds_read_b128 v[144:147], v3 offset:0
v_mfma_f32_16x16x32_bf16 v[128:131], a[32:35], v[184:187], v[128:131]
ds_read_b128 v[148:151], v3 offset:4096
v_lshlrev_b32 v9, 16, v251
v_mfma_f32_16x16x32_bf16 v[128:131], a[40:43], v[188:191], v[128:131]
buffer_load_dwordx4 v18, s[20:23], s46 offen offset:0 sc1 lds
v_mfma_f32_16x16x32_bf16 v[132:135], a[44:47], v[188:191], v[132:135]
ds_read_b128 v[152:155], v3 offset:8192
v_and_b32_e64 v10, s36, v251
v_mfma_f32_16x16x32_bf16 v[132:135], a[36:39], v[184:187], v[132:135]
v_add_f32_e64 v102, v102, v9
v_mfma_f32_16x16x32_bf16 v[132:135], a[28:31], v[180:183], v[132:135]
ds_read_b128 v[156:159], v3 offset:12288
v_add_f32_e64 v103, v103, v10
v_mfma_f32_16x16x32_bf16 v[132:135], a[20:23], v[176:179], v[132:135]
s_waitcnt lgkmcnt(4)
buffer_load_dwordx4 v18, s[20:23], s46 offen offset:1024 sc1 lds
v_mfma_f32_16x16x32_bf16 v[140:143], a[20:23], v[192:195], v[140:143]
ds_read_b128 v[160:163], v3 offset:1024
v_mfma_f32_16x16x32_bf16 v[140:143], a[28:31], v[196:199], v[140:143]
v_mfma_f32_16x16x32_bf16 v[140:143], a[36:39], v[200:203], v[140:143]
ds_read_b128 v[164:167], v3 offset:5120
v_mfma_f32_16x16x32_bf16 v[140:143], a[44:47], v[204:207], v[140:143]
buffer_load_dwordx4 v18, s[20:23], s46 offen offset:2048 sc1 lds
v_mfma_f32_16x16x32_bf16 v[136:139], a[40:43], v[204:207], v[136:139]
ds_read_b128 v[168:171], v3 offset:9216
v_mfma_f32_16x16x32_bf16 v[136:139], a[32:35], v[200:203], v[136:139]
v_mfma_f32_16x16x32_bf16 v[136:139], a[24:27], v[196:199], v[136:139]
ds_read_b128 v[172:175], v3 offset:13312
v_mfma_f32_16x16x32_bf16 v[136:139], a[16:19], v[192:195], v[136:139]
s_waitcnt lgkmcnt(4)
buffer_load_dwordx4 v18, s[20:23], s46 offen offset:3072 sc1 lds
v_mfma_f32_16x16x32_bf16 v[112:115], a[48:51], v[144:147], v[112:115]
s_xor_b32 s47, s37, 0x60000
ds_read_b128 v[176:179], v3 offset:2048
v_lshlrev_b32_e64 v9, 16, v252
v_mfma_f32_16x16x32_bf16 v[112:115], a[56:59], v[148:151], v[112:115]
v_and_b32_e64 v10, s36, v252
v_mfma_f32_16x16x32_bf16 v[112:115], a[64:67], v[152:155], v[112:115]
ds_read_b128 v[180:183], v3 offset:6144
v_add_f32_e64 v104, v104, v9
v_mfma_f32_16x16x32_bf16 v[112:115], a[72:75], v[156:159], v[112:115]
buffer_load_dwordx4 a[128:131], v18, s[64:67], s47 offen offset:0 sc1
v_mfma_f32_16x16x32_bf16 v[116:119], a[76:79], v[156:159], v[116:119]
ds_read_b128 v[184:187], v3 offset:10240
v_add_f32_e64 v105, v105, v10
v_mfma_f32_16x16x32_bf16 v[116:119], a[68:71], v[152:155], v[116:119]
v_lshlrev_b32_e64 v9, 16, v253
v_mfma_f32_16x16x32_bf16 v[116:119], a[60:63], v[148:151], v[116:119]
ds_read_b128 v[188:191], v3 offset:14336
v_and_b32_e64 v10, s36, v253
v_mfma_f32_16x16x32_bf16 v[116:119], a[52:55], v[144:147], v[116:119]
s_waitcnt lgkmcnt(4)
buffer_load_dwordx4 a[132:135], v18, s[64:67], s47 offen offset:1024 sc1
v_mfma_f32_16x16x32_bf16 v[124:127], a[52:55], v[160:163], v[124:127]
s_xor_b32 s47, s37, 0xe0000
ds_read_b128 v[192:195], v3 offset:3072
v_add_f32 v106, v106, v9
v_mfma_f32_16x16x32_bf16 v[124:127], a[60:63], v[164:167], v[124:127]
v_add_f32_e64 v107, v107, v10
v_mfma_f32_16x16x32_bf16 v[124:127], a[68:71], v[168:171], v[124:127]
ds_read_b128 v[196:199], v3 offset:7168
v_lshlrev_b32_e64 v9, 16, v254
v_mfma_f32_16x16x32_bf16 v[124:127], a[76:79], v[172:175], v[124:127]
buffer_load_dwordx4 a[136:139], v18, s[64:67], s47 offen offset:0 sc1
v_mfma_f32_16x16x32_bf16 v[120:123], a[72:75], v[172:175], v[120:123]
ds_read_b128 v[200:203], v3 offset:11264
v_and_b32_e64 v10, s36, v254
v_mfma_f32_16x16x32_bf16 v[120:123], a[64:67], v[168:171], v[120:123]
v_add_f32_e64 v108, v108, v9
v_mfma_f32_16x16x32_bf16 v[120:123], a[56:59], v[164:167], v[120:123]
ds_read_b128 v[204:207], v3 offset:15360
v_add_f32_e64 v109, v109, v10
v_mfma_f32_16x16x32_bf16 v[120:123], a[48:51], v[160:163], v[120:123]
s_waitcnt lgkmcnt(4)
buffer_load_dwordx4 a[140:143], v18, s[64:67], s47 offen offset:1024 sc1
v_mfma_f32_16x16x32_bf16 v[128:131], a[48:51], v[176:179], v[128:131]
s_waitcnt vmcnt(20)
s_barrier
v_mfma_f32_16x16x32_bf16 v[128:131], a[56:59], v[180:183], v[128:131]
s_add_u32 m0, s39, 49152
s_xor_b32 s46, s33, 0x1000
ds_read_b128 v[144:147], v18 offset:0
v_mfma_f32_16x16x32_bf16 v[128:131], a[64:67], v[184:187], v[128:131]
ds_read_b128 v[148:151], v18 offset:4096
v_lshlrev_b32 v9, 16, v255
v_mfma_f32_16x16x32_bf16 v[128:131], a[72:75], v[188:191], v[128:131]
buffer_load_dwordx4 v18, s[20:23], s46 offen offset:0 sc1 lds
v_mfma_f32_16x16x32_bf16 v[132:135], a[76:79], v[188:191], v[132:135]
s_add_u32 m0, s39, 50176
s_xor_b32 s46, s33, 0x41000
ds_read_b128 v[152:155], v18 offset:8192
v_mfma_f32_16x16x32_bf16 v[132:135], a[68:71], v[184:187], v[132:135]
v_and_b32_e64 v10, s36, v255
v_mfma_f32_16x16x32_bf16 v[132:135], a[60:63], v[180:183], v[132:135]
ds_read_b128 v[156:159], v18 offset:12288
v_add_f32_e64 v110, v110, v9
v_mfma_f32_16x16x32_bf16 v[132:135], a[52:55], v[176:179], v[132:135]
s_waitcnt lgkmcnt(4)
buffer_load_dwordx4 v18, s[20:23], s46 offen offset:0 sc1 lds
v_mfma_f32_16x16x32_bf16 v[140:143], a[52:55], v[192:195], v[140:143]
s_add_u32 m0, s39, 51200
s_xor_b32 s46, s33, 0x81000
ds_read_b128 v[160:163], v18 offset:1024
v_mfma_f32_16x16x32_bf16 v[140:143], a[60:63], v[196:199], v[140:143]
v_add_f32 v111, v111, v10
v_mfma_f32_16x16x32_bf16 v[140:143], a[68:71], v[200:203], v[140:143]
ds_read_b128 v[164:167], v18 offset:5120
v_mfma_f32_16x16x32_bf16 v[140:143], a[76:79], v[204:207], v[140:143]
buffer_load_dwordx4 v18, s[20:23], s46 offen offset:0 sc1 lds
v_mfma_f32_16x16x32_bf16 v[136:139], a[72:75], v[204:207], v[136:139]
s_add_u32 m0, s39, 52224
s_xor_b32 s46, s33, 0xc1000
ds_read_b128 v[168:171], v18 offset:9216
v_mfma_f32_16x16x32_bf16 v[136:139], a[64:67], v[200:203], v[136:139]
v_mfma_f32_16x16x32_bf16 v[136:139], a[56:59], v[196:199], v[136:139]
ds_read_b128 v[172:175], v18 offset:13312
v_mfma_f32_16x16x32_bf16 v[136:139], a[48:51], v[192:195], v[136:139]
s_waitcnt lgkmcnt(4)
buffer_load_dwordx4 v18, s[20:23], s46 offen offset:0 sc1 lds
v_mfma_f32_16x16x32_bf16 v[112:115], a[80:83], v[144:147], v[112:115]
s_xor_b32 s47, s37, 0x160000
ds_read_b128 v[176:179], v18 offset:2048
v_mfma_f32_16x16x32_bf16 v[112:115], a[88:91], v[148:151], v[112:115]
v_mfma_f32_16x16x32_bf16 v[112:115], a[96:99], v[152:155], v[112:115]
ds_read_b128 v[180:183], v18 offset:6144
v_mfma_f32_16x16x32_bf16 v[112:115], a[104:107], v[156:159], v[112:115]
buffer_load_dwordx4 a[144:147], v18, s[64:67], s47 offen offset:0 sc1
v_mfma_f32_16x16x32_bf16 v[116:119], a[108:111], v[156:159], v[116:119]
ds_read_b128 v[184:187], v18 offset:10240
v_mfma_f32_16x16x32_bf16 v[116:119], a[100:103], v[152:155], v[116:119]
v_mfma_f32_16x16x32_bf16 v[116:119], a[92:95], v[148:151], v[116:119]
ds_read_b128 v[188:191], v18 offset:14336
v_mfma_f32_16x16x32_bf16 v[116:119], a[84:87], v[144:147], v[116:119]
s_waitcnt lgkmcnt(4)
buffer_load_dwordx4 a[148:151], v18, s[64:67], s47 offen offset:1024 sc1
v_mfma_f32_16x16x32_bf16 v[124:127], a[84:87], v[160:163], v[124:127]
s_xor_b32 s47, s37, 0x1e0000
ds_read_b128 v[192:195], v18 offset:3072
v_mfma_f32_16x16x32_bf16 v[124:127], a[92:95], v[164:167], v[124:127]
v_mfma_f32_16x16x32_bf16 v[124:127], a[100:103], v[168:171], v[124:127]
ds_read_b128 v[196:199], v18 offset:7168
v_mfma_f32_16x16x32_bf16 v[124:127], a[108:111], v[172:175], v[124:127]
buffer_load_dwordx4 a[152:155], v18, s[64:67], s47 offen offset:0 sc1
v_mfma_f32_16x16x32_bf16 v[120:123], a[104:107], v[172:175], v[120:123]
ds_read_b128 v[200:203], v18 offset:11264
v_mfma_f32_16x16x32_bf16 v[120:123], a[96:99], v[168:171], v[120:123]
v_mfma_f32_16x16x32_bf16 v[120:123], a[88:91], v[164:167], v[120:123]
ds_read_b128 v[204:207], v18 offset:15360
v_mfma_f32_16x16x32_bf16 v[120:123], a[80:83], v[160:163], v[120:123]
s_waitcnt lgkmcnt(4)
buffer_load_dwordx4 a[156:159], v18, s[64:67], s47 offen offset:1024 sc1
v_mfma_f32_16x16x32_bf16 v[128:131], a[80:83], v[176:179], v[128:131]
s_waitcnt vmcnt(16)
s_barrier
v_mfma_f32_16x16x32_bf16 v[128:131], a[88:91], v[180:183], v[128:131]
s_add_u32 m0, s39, 65536
s_xor_b32 s46, s33, 0x401000
ds_read_b128 v[144:147], v18 offset:16384
v_mfma_f32_16x16x32_bf16 v[128:131], a[96:99], v[184:187], v[128:131]
ds_read_b128 v[148:151], v18 offset:20480
v_mfma_f32_16x16x32_bf16 v[128:131], a[104:107], v[188:191], v[128:131]
buffer_load_dwordx4 v18, s[20:23], s46 offen offset:0 sc1 lds
v_mfma_f32_16x16x32_bf16 v[132:135], a[108:111], v[188:191], v[132:135]
s_add_u32 m0, s39, 66560
s_xor_b32 s46, s33, 0x441000
ds_read_b128 v[152:155], v18 offset:24576
v_mfma_f32_16x16x32_bf16 v[132:135], a[100:103], v[184:187], v[132:135]
v_mfma_f32_16x16x32_bf16 v[132:135], a[92:95], v[180:183], v[132:135]
ds_read_b128 v[156:159], v18 offset:28672
v_mfma_f32_16x16x32_bf16 v[132:135], a[84:87], v[176:179], v[132:135]
s_waitcnt lgkmcnt(4)
buffer_load_dwordx4 v18, s[20:23], s46 offen offset:0 sc1 lds
v_mfma_f32_16x16x32_bf16 v[140:143], a[84:87], v[192:195], v[140:143]
s_add_u32 m0, s39, 67584
s_xor_b32 s46, s33, 0x481000
ds_read_b128 v[160:163], v18 offset:17408
v_mfma_f32_16x16x32_bf16 v[140:143], a[92:95], v[196:199], v[140:143]
v_mfma_f32_16x16x32_bf16 v[140:143], a[100:103], v[200:203], v[140:143]
ds_read_b128 v[164:167], v18 offset:21504
v_mfma_f32_16x16x32_bf16 v[140:143], a[108:111], v[204:207], v[140:143]
buffer_load_dwordx4 v18, s[20:23], s46 offen offset:0 sc1 lds
v_mfma_f32_16x16x32_bf16 v[136:139], a[104:107], v[204:207], v[136:139]
s_add_u32 m0, s39, 68608
s_xor_b32 s46, s33, 0x4c1000
ds_read_b128 v[168:171], v18 offset:25600
v_mfma_f32_16x16x32_bf16 v[136:139], a[96:99], v[200:203], v[136:139]
v_mfma_f32_16x16x32_bf16 v[136:139], a[88:91], v[196:199], v[136:139]
ds_read_b128 v[172:175], v18 offset:29696
v_mfma_f32_16x16x32_bf16 v[136:139], a[80:83], v[192:195], v[136:139]
s_waitcnt lgkmcnt(4)
buffer_load_dwordx4 v18, s[20:23], s46 offen offset:0 sc1 lds
v_mfma_f32_16x16x32_bf16 v[112:115], a[112:115], v[144:147], v[112:115]
ds_read_b128 v[176:179], v18 offset:18432
v_mfma_f32_16x16x32_bf16 v[112:115], a[120:123], v[148:151], v[112:115]
v_mfma_f32_16x16x32_bf16 v[112:115], a[160:163], v[152:155], v[112:115]
ds_read_b128 v[180:183], v18 offset:22528
v_mfma_f32_16x16x32_bf16 v[112:115], a[168:171], v[156:159], v[112:115]
v_mfma_f32_16x16x32_bf16 v[116:119], a[172:175], v[156:159], v[116:119]
ds_read_b128 v[184:187], v18 offset:26624
v_mfma_f32_16x16x32_bf16 v[116:119], a[164:167], v[152:155], v[116:119]
v_mfma_f32_16x16x32_bf16 v[116:119], a[124:127], v[148:151], v[116:119]
ds_read_b128 v[188:191], v18 offset:30720
v_mfma_f32_16x16x32_bf16 v[116:119], a[116:119], v[144:147], v[116:119]
s_waitcnt lgkmcnt(4)
v_mfma_f32_16x16x32_bf16 v[124:127], a[116:119], v[160:163], v[124:127]
ds_read_b128 v[192:195], v18 offset:19456
v_mfma_f32_16x16x32_bf16 v[124:127], a[124:127], v[164:167], v[124:127]
v_mfma_f32_16x16x32_bf16 v[124:127], a[164:167], v[168:171], v[124:127]
ds_read_b128 v[196:199], v18 offset:23552
v_mfma_f32_16x16x32_bf16 v[124:127], a[172:175], v[172:175], v[124:127]
v_mfma_f32_16x16x32_bf16 v[120:123], a[168:171], v[172:175], v[120:123]
ds_read_b128 v[200:203], v18 offset:27648
v_mfma_f32_16x16x32_bf16 v[120:123], a[160:163], v[168:171], v[120:123]
v_mfma_f32_16x16x32_bf16 v[120:123], a[120:123], v[164:167], v[120:123]
ds_read_b128 v[204:207], v18 offset:31744
v_mfma_f32_16x16x32_bf16 v[120:123], a[112:115], v[160:163], v[120:123]
s_waitcnt lgkmcnt(4)
v_mfma_f32_16x16x32_bf16 v[128:131], a[112:115], v[176:179], v[128:131]
s_waitcnt vmcnt(4)
s_barrier
v_mfma_f32_16x16x32_bf16 v[128:131], a[120:123], v[180:183], v[128:131]
s_add_u32 m0, s39, 81920
s_xor_b32 s46, s33, 0x1400
ds_read_b128 v[144:147], v18 offset:32768
v_mfma_f32_16x16x32_bf16 v[128:131], a[160:163], v[184:187], v[128:131]
ds_read_b128 v[148:151], v18 offset:36864
v_mfma_f32_16x16x32_bf16 v[128:131], a[168:171], v[188:191], v[128:131]
buffer_load_dwordx4 v18, s[20:23], s46 offen offset:0 sc1 lds
v_mfma_f32_16x16x32_bf16 v[132:135], a[172:175], v[188:191], v[132:135]
s_add_u32 m0, s39, 82944
s_xor_b32 s46, s33, 0x41400
ds_read_b128 v[152:155], v18 offset:40960
v_mfma_f32_16x16x32_bf16 v[132:135], a[164:167], v[184:187], v[132:135]
v_mfma_f32_16x16x32_bf16 v[132:135], a[124:127], v[180:183], v[132:135]
ds_read_b128 v[156:159], v18 offset:45056
v_mfma_f32_16x16x32_bf16 v[132:135], a[116:119], v[176:179], v[132:135]
s_waitcnt lgkmcnt(4)
buffer_load_dwordx4 v18, s[20:23], s46 offen offset:0 sc1 lds
v_mfma_f32_16x16x32_bf16 v[140:143], a[116:119], v[192:195], v[140:143]
s_add_u32 m0, s39, 83968
s_xor_b32 s46, s33, 0x81400
ds_read_b128 v[160:163], v18 offset:33792
v_mfma_f32_16x16x32_bf16 v[140:143], a[124:127], v[196:199], v[140:143]
v_mfma_f32_16x16x32_bf16 v[140:143], a[164:167], v[200:203], v[140:143]
ds_read_b128 v[164:167], v18 offset:37888
v_mfma_f32_16x16x32_bf16 v[140:143], a[172:175], v[204:207], v[140:143]
buffer_load_dwordx4 v18, s[20:23], s46 offen offset:0 sc1 lds
v_mfma_f32_16x16x32_bf16 v[136:139], a[168:171], v[204:207], v[136:139]
s_add_u32 m0, s39, 84992
s_xor_b32 s46, s33, 0xc1400
ds_read_b128 v[168:171], v18 offset:41984
v_mfma_f32_16x16x32_bf16 v[136:139], a[160:163], v[200:203], v[136:139]
v_mfma_f32_16x16x32_bf16 v[136:139], a[120:123], v[196:199], v[136:139]
ds_read_b128 v[172:175], v18 offset:46080
v_mfma_f32_16x16x32_bf16 v[136:139], a[112:115], v[192:195], v[136:139]
s_waitcnt lgkmcnt(4)
buffer_load_dwordx4 v18, s[20:23], s46 offen offset:0 sc1 lds
v_mfma_f32_16x16x32_bf16 v[112:115], a[128:131], v[144:147], v[112:115]
s_add_u32 m0, s39, 98304
s_xor_b32 s46, s33, 0x401400
ds_read_b128 v[176:179], v18 offset:34816
v_mfma_f32_16x16x32_bf16 v[112:115], a[136:139], v[148:151], v[112:115]
v_mfma_f32_16x16x32_bf16 v[112:115], a[144:147], v[152:155], v[112:115]
ds_read_b128 v[180:183], v18 offset:38912
v_mfma_f32_16x16x32_bf16 v[112:115], a[152:155], v[156:159], v[112:115]
buffer_load_dwordx4 v18, s[20:23], s46 offen offset:0 sc1 lds
v_mfma_f32_16x16x32_bf16 v[116:119], a[156:159], v[156:159], v[116:119]
s_add_u32 m0, s39, 99328
s_xor_b32 s46, s33, 0x441400
ds_read_b128 v[184:187], v18 offset:43008
v_mfma_f32_16x16x32_bf16 v[116:119], a[148:151], v[152:155], v[116:119]
v_mfma_f32_16x16x32_bf16 v[116:119], a[140:143], v[148:151], v[116:119]
ds_read_b128 v[188:191], v18 offset:47104
v_mfma_f32_16x16x32_bf16 v[116:119], a[132:135], v[144:147], v[116:119]
s_waitcnt lgkmcnt(4)
buffer_load_dwordx4 v18, s[20:23], s46 offen offset:0 sc1 lds
v_mfma_f32_16x16x32_bf16 v[124:127], a[132:135], v[160:163], v[124:127]
s_add_u32 m0, s39, 100352
s_xor_b32 s46, s33, 0x481400
ds_read_b128 v[192:195], v18 offset:35840
v_mfma_f32_16x16x32_bf16 v[124:127], a[140:143], v[164:167], v[124:127]
v_mfma_f32_16x16x32_bf16 v[124:127], a[148:151], v[168:171], v[124:127]
ds_read_b128 v[196:199], v18 offset:39936
v_mfma_f32_16x16x32_bf16 v[124:127], a[156:159], v[172:175], v[124:127]
buffer_load_dwordx4 v18, s[20:23], s46 offen offset:0 sc1 lds
v_mfma_f32_16x16x32_bf16 v[120:123], a[152:155], v[172:175], v[120:123]
s_add_u32 m0, s39, 101376
s_xor_b32 s46, s33, 0x4c1400
ds_read_b128 v[200:203], v18 offset:44032
v_mfma_f32_16x16x32_bf16 v[120:123], a[144:147], v[168:171], v[120:123]
v_mfma_f32_16x16x32_bf16 v[120:123], a[136:139], v[164:167], v[120:123]
ds_read_b128 v[204:207], v18 offset:48128
v_mfma_f32_16x16x32_bf16 v[120:123], a[128:131], v[160:163], v[120:123]
s_waitcnt lgkmcnt(4)
buffer_load_dwordx4 v18, s[20:23], s46 offen offset:0 sc1 lds
v_mfma_f32_16x16x32_bf16 v[128:131], a[128:131], v[176:179], v[128:131]
s_waitcnt vmcnt(16)
s_barrier
v_mfma_f32_16x16x32_bf16 v[128:131], a[136:139], v[180:183], v[128:131]
ds_read_b128 v[144:147], v18 offset:49152
v_cvt_pk_bf16_f32 v112, v112, v113
v_mfma_f32_16x16x32_bf16 v[128:131], a[144:147], v[184:187], v[128:131]
ds_read_b128 v[148:151], v18 offset:53248
v_cvt_pk_bf16_f32 v113, v114, v115
v_mfma_f32_16x16x32_bf16 v[128:131], a[152:155], v[188:191], v[128:131]
v_cvt_pk_bf16_f32 v114, v116, v117
v_cvt_pk_bf16_f32 v115, v118, v119
v_mfma_f32_16x16x32_bf16 v[132:135], a[156:159], v[188:191], v[132:135]
ds_read_b128 v[152:155], v18 offset:57344
v_mfma_f32_16x16x32_bf16 v[132:135], a[148:151], v[184:187], v[132:135]
buffer_store_dwordx4 v[112:115], v18, s[12:15], s69 offen offset:0 sc1
v_mfma_f32_16x16x32_bf16 v[132:135], a[140:143], v[180:183], v[132:135]
ds_read_b128 v[156:159], v18 offset:61440
v_cvt_pk_bf16_f32 v120, v120, v121
v_mfma_f32_16x16x32_bf16 v[132:135], a[132:135], v[176:179], v[132:135]
s_waitcnt lgkmcnt(4)
v_cvt_pk_bf16_f32 v121, v122, v123
v_cvt_pk_bf16_f32 v122, v124, v125
v_mfma_f32_16x16x32_bf16 v[140:143], a[132:135], v[192:195], v[140:143]
ds_read_b128 v[160:163], v18 offset:50176
v_cvt_pk_bf16_f32 v123, v126, v127
v_mfma_f32_16x16x32_bf16 v[140:143], a[140:143], v[196:199], v[140:143]
buffer_store_dwordx4 v[120:123], v18, s[12:15], s69 offen offset:1024 sc1
v_mfma_f32_16x16x32_bf16 v[140:143], a[148:151], v[200:203], v[140:143]
ds_read_b128 v[164:167], v18 offset:54272
v_mfma_f32_16x16x32_bf16 v[140:143], a[156:159], v[204:207], v[140:143]
v_mfma_f32_16x16x32_bf16 v[136:139], a[152:155], v[204:207], v[136:139]
ds_read_b128 v[168:171], v18 offset:58368
v_mfma_f32_16x16x32_bf16 v[136:139], a[144:147], v[200:203], v[136:139]
v_mfma_f32_16x16x32_bf16 v[136:139], a[136:139], v[196:199], v[136:139]
ds_read_b128 v[172:175], v18 offset:62464
v_mfma_f32_16x16x32_bf16 v[136:139], a[128:131], v[192:195], v[136:139]
s_waitcnt lgkmcnt(4)
v_mfma_f32_16x16x32_bf16 v[80:83], a[176:179], v[144:147], v[80:83]
ds_read_b128 v[176:179], v18 offset:51200
v_cvt_pk_bf16_f32 v128, v128, v129
v_mfma_f32_16x16x32_bf16 v[80:83], a[184:187], v[148:151], v[80:83]
v_cvt_pk_bf16_f32 v129, v130, v131
v_cvt_pk_bf16_f32 v130, v132, v133
v_mfma_f32_16x16x32_bf16 v[80:83], a[192:195], v[152:155], v[80:83]
ds_read_b128 v[180:183], v18 offset:55296
v_cvt_pk_bf16_f32 v131, v134, v135
v_mfma_f32_16x16x32_bf16 v[80:83], a[200:203], v[156:159], v[80:83]
buffer_store_dwordx4 v[128:131], v18, s[12:15], s69 offen offset:2048 sc1
v_mfma_f32_16x16x32_bf16 v[84:87], a[204:207], v[156:159], v[84:87]
ds_read_b128 v[184:187], v18 offset:59392
v_cvt_pk_bf16_f32 v136, v136, v137
v_mfma_f32_16x16x32_bf16 v[84:87], a[196:199], v[152:155], v[84:87]
v_cvt_pk_bf16_f32 v137, v138, v139
v_cvt_pk_bf16_f32 v138, v140, v141
v_mfma_f32_16x16x32_bf16 v[84:87], a[188:191], v[148:151], v[84:87]
ds_read_b128 v[188:191], v18 offset:63488
v_cvt_pk_bf16_f32 v139, v142, v143
v_mfma_f32_16x16x32_bf16 v[84:87], a[180:183], v[144:147], v[84:87]
s_waitcnt lgkmcnt(4)
buffer_store_dwordx4 v[136:139], v18, s[12:15], s69 offen offset:3072 sc1
v_mfma_f32_16x16x32_bf16 v[84:87], a[212:215], v[160:163], v[84:87]
ds_read_b128 v[192:195], v18 offset:52224
v_mfma_f32_16x16x32_bf16 v[84:87], a[220:223], v[164:167], v[84:87]
v_mfma_f32_16x16x32_bf16 v[84:87], a[228:231], v[168:171], v[84:87]
ds_read_b128 v[196:199], v18 offset:56320
v_mfma_f32_16x16x32_bf16 v[84:87], a[236:239], v[172:175], v[84:87]
v_mfma_f32_16x16x32_bf16 v[80:83], a[232:235], v[172:175], v[80:83]
ds_read_b128 v[200:203], v18 offset:60416
v_mfma_f32_16x16x32_bf16 v[80:83], a[224:227], v[168:171], v[80:83]
v_mfma_f32_16x16x32_bf16 v[80:83], a[216:219], v[164:167], v[80:83]
ds_read_b128 v[204:207], v18 offset:64512
v_mfma_f32_16x16x32_bf16 v[80:83], a[208:211], v[160:163], v[80:83]
s_waitcnt lgkmcnt(4)
v_mfma_f32_16x16x32_bf16 v[80:83], a[240:243], v[176:179], v[80:83]
s_waitcnt vmcnt(12)
s_barrier
v_mfma_f32_16x16x32_bf16 v[80:83], a[248:251], v[180:183], v[80:83]
ds_read_b128 v[144:147], v2 offset:0
v_mfma_f32_16x16x32_bf16 v[80:83], a[0:3], v[184:187], v[80:83]
ds_read_b128 v[148:151], v2 offset:4096
v_mfma_f32_16x16x32_bf16 v[80:83], a[8:11], v[188:191], v[80:83]
v_mfma_f32_16x16x32_bf16 v[84:87], a[12:15], v[188:191], v[84:87]
ds_read_b128 v[152:155], v2 offset:8192
v_mfma_f32_16x16x32_bf16 v[84:87], a[4:7], v[184:187], v[84:87]
v_mfma_f32_16x16x32_bf16 v[84:87], a[252:255], v[180:183], v[84:87]
ds_read_b128 v[156:159], v2 offset:12288
v_mfma_f32_16x16x32_bf16 v[84:87], a[244:247], v[176:179], v[84:87]
s_waitcnt lgkmcnt(4)
v_mfma_f32_16x16x32_bf16 v[84:87], a[20:23], v[192:195], v[84:87]
ds_read_b128 v[160:163], v2 offset:1024
v_mfma_f32_16x16x32_bf16 v[84:87], a[28:31], v[196:199], v[84:87]
v_mfma_f32_16x16x32_bf16 v[84:87], a[36:39], v[200:203], v[84:87]
ds_read_b128 v[164:167], v2 offset:5120
v_mfma_f32_16x16x32_bf16 v[84:87], a[44:47], v[204:207], v[84:87]
v_mfma_f32_16x16x32_bf16 v[80:83], a[40:43], v[204:207], v[80:83]
ds_read_b128 v[168:171], v2 offset:9216
v_mfma_f32_16x16x32_bf16 v[80:83], a[32:35], v[200:203], v[80:83]
v_mfma_f32_16x16x32_bf16 v[80:83], a[24:27], v[196:199], v[80:83]
ds_read_b128 v[172:175], v2 offset:13312
v_mfma_f32_16x16x32_bf16 v[80:83], a[16:19], v[192:195], v[80:83]
s_waitcnt lgkmcnt(4)
v_mfma_f32_16x16x32_bf16 v[80:83], a[48:51], v[144:147], v[80:83]
ds_read_b128 v[176:179], v2 offset:2048
v_mfma_f32_16x16x32_bf16 v[80:83], a[56:59], v[148:151], v[80:83]
v_mfma_f32_16x16x32_bf16 v[80:83], a[64:67], v[152:155], v[80:83]
ds_read_b128 v[180:183], v2 offset:6144
v_mfma_f32_16x16x32_bf16 v[80:83], a[72:75], v[156:159], v[80:83]
v_mfma_f32_16x16x32_bf16 v[84:87], a[76:79], v[156:159], v[84:87]
ds_read_b128 v[184:187], v2 offset:10240
v_mfma_f32_16x16x32_bf16 v[84:87], a[68:71], v[152:155], v[84:87]
v_mfma_f32_16x16x32_bf16 v[84:87], a[60:63], v[148:151], v[84:87]
ds_read_b128 v[188:191], v2 offset:14336
v_mfma_f32_16x16x32_bf16 v[84:87], a[52:55], v[144:147], v[84:87]
s_waitcnt lgkmcnt(4)
v_mfma_f32_16x16x32_bf16 v[84:87], a[84:87], v[160:163], v[84:87]
ds_read_b128 v[192:195], v2 offset:3072
v_mfma_f32_16x16x32_bf16 v[84:87], a[92:95], v[164:167], v[84:87]
v_mfma_f32_16x16x32_bf16 v[84:87], a[100:103], v[168:171], v[84:87]
ds_read_b128 v[196:199], v2 offset:7168
v_mfma_f32_16x16x32_bf16 v[84:87], a[108:111], v[172:175], v[84:87]
v_mfma_f32_16x16x32_bf16 v[80:83], a[104:107], v[172:175], v[80:83]
ds_read_b128 v[200:203], v2 offset:11264
v_mfma_f32_16x16x32_bf16 v[80:83], a[96:99], v[168:171], v[80:83]
v_mfma_f32_16x16x32_bf16 v[80:83], a[88:91], v[164:167], v[80:83]
ds_read_b128 v[204:207], v2 offset:15360
v_mfma_f32_16x16x32_bf16 v[80:83], a[80:83], v[160:163], v[80:83]
s_waitcnt lgkmcnt(4)
v_mfma_f32_16x16x32_bf16 v[80:83], a[112:115], v[176:179], v[80:83]
s_waitcnt vmcnt(8)
s_barrier
v_mfma_f32_16x16x32_bf16 v[80:83], a[120:123], v[180:183], v[80:83]
s_add_u32 m0, s39, 114688
s_xor_b32 s46, s33, 0x1800
ds_read_b128 v[144:147], v2 offset:16384
v_mfma_f32_16x16x32_bf16 v[80:83], a[160:163], v[184:187], v[80:83]
ds_read_b128 v[148:151], v2 offset:20480
v_mfma_f32_16x16x32_bf16 v[80:83], a[168:171], v[188:191], v[80:83]
buffer_load_dwordx4 v18, s[20:23], s46 offen offset:0 sc1 lds
v_mfma_f32_16x16x32_bf16 v[84:87], a[172:175], v[188:191], v[84:87]
s_add_u32 m0, s39, 115712
s_xor_b32 s46, s33, 0x41800
ds_read_b128 v[152:155], v2 offset:24576
v_mfma_f32_16x16x32_bf16 v[84:87], a[164:167], v[184:187], v[84:87]
v_mfma_f32_16x16x32_bf16 v[84:87], a[124:127], v[180:183], v[84:87]
ds_read_b128 v[156:159], v2 offset:28672
v_mfma_f32_16x16x32_bf16 v[84:87], a[116:119], v[176:179], v[84:87]
s_waitcnt lgkmcnt(4)
buffer_load_dwordx4 v18, s[20:23], s46 offen offset:0 sc1 lds
v_mfma_f32_16x16x32_bf16 v[84:87], a[132:135], v[192:195], v[84:87]
s_add_u32 m0, s39, 116736
s_xor_b32 s46, s33, 0x81800
ds_read_b128 v[160:163], v2 offset:17408
v_mfma_f32_16x16x32_bf16 v[84:87], a[140:143], v[196:199], v[84:87]
v_mfma_f32_16x16x32_bf16 v[84:87], a[148:151], v[200:203], v[84:87]
ds_read_b128 v[164:167], v2 offset:21504
v_mfma_f32_16x16x32_bf16 v[84:87], a[156:159], v[204:207], v[84:87]
buffer_load_dwordx4 v18, s[20:23], s46 offen offset:0 sc1 lds
v_mfma_f32_16x16x32_bf16 v[80:83], a[152:155], v[204:207], v[80:83]
s_add_u32 m0, s39, 117760
s_xor_b32 s46, s33, 0xc1800
ds_read_b128 v[168:171], v2 offset:25600
v_mfma_f32_16x16x32_bf16 v[80:83], a[144:147], v[200:203], v[80:83]
v_mfma_f32_16x16x32_bf16 v[80:83], a[136:139], v[196:199], v[80:83]
ds_read_b128 v[172:175], v2 offset:29696
v_mfma_f32_16x16x32_bf16 v[80:83], a[128:131], v[192:195], v[80:83]
s_waitcnt lgkmcnt(4)
buffer_load_dwordx4 v18, s[20:23], s46 offen offset:0 sc1 lds
v_mfma_f32_16x16x32_bf16 v[88:91], a[176:179], v[144:147], v[88:91]
s_add_u32 m0, s39, 131072
s_xor_b32 s46, s33, 0x401800
ds_read_b128 v[176:179], v2 offset:18432
v_mfma_f32_16x16x32_bf16 v[88:91], a[184:187], v[148:151], v[88:91]
v_mfma_f32_16x16x32_bf16 v[88:91], a[192:195], v[152:155], v[88:91]
ds_read_b128 v[180:183], v2 offset:22528
v_mfma_f32_16x16x32_bf16 v[88:91], a[200:203], v[156:159], v[88:91]
buffer_load_dwordx4 v18, s[20:23], s46 offen offset:0 sc1 lds
v_mfma_f32_16x16x32_bf16 v[92:95], a[204:207], v[156:159], v[92:95]
s_add_u32 m0, s39, 132096
s_xor_b32 s46, s33, 0x441800
ds_read_b128 v[184:187], v2 offset:26624
v_mfma_f32_16x16x32_bf16 v[92:95], a[196:199], v[152:155], v[92:95]
v_mfma_f32_16x16x32_bf16 v[92:95], a[188:191], v[148:151], v[92:95]
ds_read_b128 v[188:191], v2 offset:30720
v_mfma_f32_16x16x32_bf16 v[92:95], a[180:183], v[144:147], v[92:95]
s_waitcnt lgkmcnt(4)
buffer_load_dwordx4 v18, s[20:23], s46 offen offset:0 sc1 lds
v_mfma_f32_16x16x32_bf16 v[92:95], a[212:215], v[160:163], v[92:95]
s_add_u32 m0, s39, 133120
s_xor_b32 s46, s33, 0x481800
ds_read_b128 v[192:195], v2 offset:19456
v_mfma_f32_16x16x32_bf16 v[92:95], a[220:223], v[164:167], v[92:95]
v_mfma_f32_16x16x32_bf16 v[92:95], a[228:231], v[168:171], v[92:95]
ds_read_b128 v[196:199], v2 offset:23552
v_mfma_f32_16x16x32_bf16 v[92:95], a[236:239], v[172:175], v[92:95]
buffer_load_dwordx4 v18, s[20:23], s46 offen offset:0 sc1 lds
v_mfma_f32_16x16x32_bf16 v[88:91], a[232:235], v[172:175], v[88:91]
s_add_u32 m0, s39, 134144
s_xor_b32 s46, s33, 0x4c1800
ds_read_b128 v[200:203], v2 offset:27648
v_mfma_f32_16x16x32_bf16 v[88:91], a[224:227], v[168:171], v[88:91]
v_mfma_f32_16x16x32_bf16 v[88:91], a[216:219], v[164:167], v[88:91]
ds_read_b128 v[204:207], v2 offset:31744
v_mfma_f32_16x16x32_bf16 v[88:91], a[208:211], v[160:163], v[88:91]
s_waitcnt lgkmcnt(4)
buffer_load_dwordx4 v18, s[20:23], s46 offen offset:0 sc1 lds
v_mfma_f32_16x16x32_bf16 v[88:91], a[240:243], v[176:179], v[88:91]
s_waitcnt vmcnt(12)
s_barrier
v_mfma_f32_16x16x32_bf16 v[88:91], a[248:251], v[180:183], v[88:91]
ds_read_b128 v[144:147], v2 offset:32768
v_mfma_f32_16x16x32_bf16 v[88:91], a[0:3], v[184:187], v[88:91]
ds_read_b128 v[148:151], v2 offset:36864
v_mfma_f32_16x16x32_bf16 v[88:91], a[8:11], v[188:191], v[88:91]
s_waitcnt vmcnt(8)
buffer_store_dword v7, v8, s[16:19], s71 offen sc1
v_mfma_f32_16x16x32_bf16 v[92:95], a[12:15], v[188:191], v[92:95]
s_add_u32 m0, s39, 0
s_xor_b32 s46, s33, 0x1c00
ds_read_b128 v[152:155], v2 offset:40960
v_mfma_f32_16x16x32_bf16 v[92:95], a[4:7], v[184:187], v[92:95]
v_mfma_f32_16x16x32_bf16 v[92:95], a[252:255], v[180:183], v[92:95]
ds_read_b128 v[156:159], v2 offset:45056
v_mfma_f32_16x16x32_bf16 v[92:95], a[244:247], v[176:179], v[92:95]
s_waitcnt lgkmcnt(4)
buffer_load_dwordx4 v18, s[20:23], s46 offen offset:0 sc1 lds
v_mfma_f32_16x16x32_bf16 v[92:95], a[20:23], v[192:195], v[92:95]
s_add_u32 m0, s39, 1024
s_xor_b32 s46, s33, 0x41c00
ds_read_b128 v[160:163], v2 offset:33792
v_mfma_f32_16x16x32_bf16 v[92:95], a[28:31], v[196:199], v[92:95]
v_mfma_f32_16x16x32_bf16 v[92:95], a[36:39], v[200:203], v[92:95]
ds_read_b128 v[164:167], v2 offset:37888
v_mfma_f32_16x16x32_bf16 v[92:95], a[44:47], v[204:207], v[92:95]
buffer_load_dwordx4 v18, s[20:23], s46 offen offset:0 sc1 lds
v_mfma_f32_16x16x32_bf16 v[88:91], a[40:43], v[204:207], v[88:91]
s_add_u32 m0, s39, 2048
s_xor_b32 s46, s33, 0x81c00
ds_read_b128 v[168:171], v2 offset:41984
v_mfma_f32_16x16x32_bf16 v[88:91], a[32:35], v[200:203], v[88:91]
v_mfma_f32_16x16x32_bf16 v[88:91], a[24:27], v[196:199], v[88:91]
ds_read_b128 v[172:175], v2 offset:46080
v_mfma_f32_16x16x32_bf16 v[88:91], a[16:19], v[192:195], v[88:91]
s_waitcnt lgkmcnt(4)
buffer_load_dwordx4 v18, s[20:23], s46 offen offset:0 sc1 lds
v_mfma_f32_16x16x32_bf16 v[88:91], a[48:51], v[144:147], v[88:91]
s_add_u32 m0, s39, 3072
s_xor_b32 s46, s33, 0xc1c00
ds_read_b128 v[176:179], v2 offset:34816
v_mfma_f32_16x16x32_bf16 v[88:91], a[56:59], v[148:151], v[88:91]
v_mfma_f32_16x16x32_bf16 v[88:91], a[64:67], v[152:155], v[88:91]
ds_read_b128 v[180:183], v2 offset:38912
v_mfma_f32_16x16x32_bf16 v[88:91], a[72:75], v[156:159], v[88:91]
buffer_load_dwordx4 v18, s[20:23], s46 offen offset:0 sc1 lds
v_mfma_f32_16x16x32_bf16 v[92:95], a[76:79], v[156:159], v[92:95]
ds_read_b128 v[184:187], v2 offset:43008
v_mfma_f32_16x16x32_bf16 v[92:95], a[68:71], v[152:155], v[92:95]
v_mfma_f32_16x16x32_bf16 v[92:95], a[60:63], v[148:151], v[92:95]
ds_read_b128 v[188:191], v2 offset:47104
v_mfma_f32_16x16x32_bf16 v[92:95], a[52:55], v[144:147], v[92:95]
s_waitcnt lgkmcnt(4)
v_mfma_f32_16x16x32_bf16 v[92:95], a[84:87], v[160:163], v[92:95]
ds_read_b128 v[192:195], v2 offset:35840
v_mfma_f32_16x16x32_bf16 v[92:95], a[92:95], v[164:167], v[92:95]
v_mfma_f32_16x16x32_bf16 v[92:95], a[100:103], v[168:171], v[92:95]
ds_read_b128 v[196:199], v2 offset:39936
v_mfma_f32_16x16x32_bf16 v[92:95], a[108:111], v[172:175], v[92:95]
v_mfma_f32_16x16x32_bf16 v[88:91], a[104:107], v[172:175], v[88:91]
ds_read_b128 v[200:203], v2 offset:44032
v_mfma_f32_16x16x32_bf16 v[88:91], a[96:99], v[168:171], v[88:91]
v_mfma_f32_16x16x32_bf16 v[88:91], a[88:91], v[164:167], v[88:91]
ds_read_b128 v[204:207], v2 offset:48128
v_mfma_f32_16x16x32_bf16 v[88:91], a[80:83], v[160:163], v[88:91]
s_waitcnt lgkmcnt(4)
v_mfma_f32_16x16x32_bf16 v[88:91], a[112:115], v[176:179], v[88:91]
s_waitcnt vmcnt(9)
s_barrier
v_mfma_f32_16x16x32_bf16 v[88:91], a[120:123], v[180:183], v[88:91]
s_add_u32 m0, s39, 16384
s_xor_b32 s46, s33, 0x401c00
ds_read_b128 v[144:147], v2 offset:49152
v_mfma_f32_16x16x32_bf16 v[88:91], a[160:163], v[184:187], v[88:91]
ds_read_b128 v[148:151], v2 offset:53248
v_mfma_f32_16x16x32_bf16 v[88:91], a[168:171], v[188:191], v[88:91]
buffer_load_dwordx4 v18, s[20:23], s46 offen offset:0 sc1 lds
v_mfma_f32_16x16x32_bf16 v[92:95], a[172:175], v[188:191], v[92:95]
s_add_u32 m0, s39, 17408
s_xor_b32 s46, s33, 0x441c00
ds_read_b128 v[152:155], v2 offset:57344
v_mfma_f32_16x16x32_bf16 v[92:95], a[164:167], v[184:187], v[92:95]
v_mfma_f32_16x16x32_bf16 v[92:95], a[124:127], v[180:183], v[92:95]
ds_read_b128 v[156:159], v2 offset:61440
v_mfma_f32_16x16x32_bf16 v[92:95], a[116:119], v[176:179], v[92:95]
s_waitcnt lgkmcnt(4)
buffer_load_dwordx4 v18, s[20:23], s46 offen offset:0 sc1 lds
v_mfma_f32_16x16x32_bf16 v[92:95], a[132:135], v[192:195], v[92:95]
s_add_u32 m0, s39, 18432
s_xor_b32 s46, s33, 0x481c00
ds_read_b128 v[160:163], v2 offset:50176
v_mfma_f32_16x16x32_bf16 v[92:95], a[140:143], v[196:199], v[92:95]
v_mfma_f32_16x16x32_bf16 v[92:95], a[148:151], v[200:203], v[92:95]
ds_read_b128 v[164:167], v2 offset:54272
v_mfma_f32_16x16x32_bf16 v[92:95], a[156:159], v[204:207], v[92:95]
buffer_load_dwordx4 v18, s[20:23], s46 offen offset:0 sc1 lds
v_mfma_f32_16x16x32_bf16 v[88:91], a[152:155], v[204:207], v[88:91]
s_add_u32 m0, s39, 19456
s_xor_b32 s46, s33, 0x4c1c00
ds_read_b128 v[168:171], v2 offset:58368
v_mfma_f32_16x16x32_bf16 v[88:91], a[144:147], v[200:203], v[88:91]
v_mfma_f32_16x16x32_bf16 v[88:91], a[136:139], v[196:199], v[88:91]
ds_read_b128 v[172:175], v2 offset:62464
v_mfma_f32_16x16x32_bf16 v[88:91], a[128:131], v[192:195], v[88:91]
s_waitcnt lgkmcnt(4)
buffer_load_dwordx4 v18, s[20:23], s46 offen offset:0 sc1 lds
v_mfma_f32_16x16x32_bf16 v[96:99], a[176:179], v[144:147], v[96:99]
ds_read_b128 v[176:179], v2 offset:51200
v_mfma_f32_16x16x32_bf16 v[96:99], a[184:187], v[148:151], v[96:99]
v_mfma_f32_16x16x32_bf16 v[96:99], a[192:195], v[152:155], v[96:99]
ds_read_b128 v[180:183], v2 offset:55296
v_mfma_f32_16x16x32_bf16 v[96:99], a[200:203], v[156:159], v[96:99]
v_mfma_f32_16x16x32_bf16 v[100:103], a[204:207], v[156:159], v[100:103]
ds_read_b128 v[184:187], v2 offset:59392
v_mfma_f32_16x16x32_bf16 v[100:103], a[196:199], v[152:155], v[100:103]
v_mfma_f32_16x16x32_bf16 v[100:103], a[188:191], v[148:151], v[100:103]
ds_read_b128 v[188:191], v2 offset:63488
v_mfma_f32_16x16x32_bf16 v[100:103], a[180:183], v[144:147], v[100:103]
s_waitcnt lgkmcnt(4)
v_mfma_f32_16x16x32_bf16 v[100:103], a[212:215], v[160:163], v[100:103]
ds_read_b128 v[192:195], v2 offset:52224
v_mfma_f32_16x16x32_bf16 v[100:103], a[220:223], v[164:167], v[100:103]
v_mfma_f32_16x16x32_bf16 v[100:103], a[228:231], v[168:171], v[100:103]
ds_read_b128 v[196:199], v2 offset:56320
v_mfma_f32_16x16x32_bf16 v[100:103], a[236:239], v[172:175], v[100:103]
v_mfma_f32_16x16x32_bf16 v[96:99], a[232:235], v[172:175], v[96:99]
ds_read_b128 v[200:203], v2 offset:60416
v_mfma_f32_16x16x32_bf16 v[96:99], a[224:227], v[168:171], v[96:99]
v_mfma_f32_16x16x32_bf16 v[96:99], a[216:219], v[164:167], v[96:99]
ds_read_b128 v[204:207], v2 offset:64512
v_mfma_f32_16x16x32_bf16 v[96:99], a[208:211], v[160:163], v[96:99]
s_waitcnt lgkmcnt(4)
v_mfma_f32_16x16x32_bf16 v[96:99], a[240:243], v[176:179], v[96:99]
s_waitcnt vmcnt(9)
s_barrier
v_mfma_f32_16x16x32_bf16 v[96:99], a[248:251], v[180:183], v[96:99]
ds_read_b128 v[144:147], v3 offset:0
v_mfma_f32_16x16x32_bf16 v[96:99], a[0:3], v[184:187], v[96:99]
ds_read_b128 v[148:151], v3 offset:4096
v_mfma_f32_16x16x32_bf16 v[96:99], a[8:11], v[188:191], v[96:99]
buffer_load_dword v6, v8, s[16:19], s72 offen sc1
v_mfma_f32_16x16x32_bf16 v[100:103], a[12:15], v[188:191], v[100:103]
ds_read_b128 v[152:155], v3 offset:8192
v_mfma_f32_16x16x32_bf16 v[100:103], a[4:7], v[184:187], v[100:103]
v_mfma_f32_16x16x32_bf16 v[100:103], a[252:255], v[180:183], v[100:103]
ds_read_b128 v[156:159], v3 offset:12288
v_mfma_f32_16x16x32_bf16 v[100:103], a[244:247], v[176:179], v[100:103]
s_waitcnt lgkmcnt(4)
v_mfma_f32_16x16x32_bf16 v[100:103], a[20:23], v[192:195], v[100:103]
ds_read_b128 v[160:163], v3 offset:1024
v_mfma_f32_16x16x32_bf16 v[100:103], a[28:31], v[196:199], v[100:103]
v_mfma_f32_16x16x32_bf16 v[100:103], a[36:39], v[200:203], v[100:103]
ds_read_b128 v[164:167], v3 offset:5120
v_mfma_f32_16x16x32_bf16 v[100:103], a[44:47], v[204:207], v[100:103]
v_mfma_f32_16x16x32_bf16 v[96:99], a[40:43], v[204:207], v[96:99]
ds_read_b128 v[168:171], v3 offset:9216
v_mfma_f32_16x16x32_bf16 v[96:99], a[32:35], v[200:203], v[96:99]
v_mfma_f32_16x16x32_bf16 v[96:99], a[24:27], v[196:199], v[96:99]
ds_read_b128 v[172:175], v3 offset:13312
v_mfma_f32_16x16x32_bf16 v[96:99], a[16:19], v[192:195], v[96:99]
s_waitcnt lgkmcnt(4)
v_mfma_f32_16x16x32_bf16 v[96:99], a[48:51], v[144:147], v[96:99]
ds_read_b128 v[176:179], v3 offset:2048
v_mfma_f32_16x16x32_bf16 v[96:99], a[56:59], v[148:151], v[96:99]
v_mfma_f32_16x16x32_bf16 v[96:99], a[64:67], v[152:155], v[96:99]
ds_read_b128 v[180:183], v3 offset:6144
v_mfma_f32_16x16x32_bf16 v[96:99], a[72:75], v[156:159], v[96:99]
v_mfma_f32_16x16x32_bf16 v[100:103], a[76:79], v[156:159], v[100:103]
ds_read_b128 v[184:187], v3 offset:10240
v_mfma_f32_16x16x32_bf16 v[100:103], a[68:71], v[152:155], v[100:103]
v_mfma_f32_16x16x32_bf16 v[100:103], a[60:63], v[148:151], v[100:103]
ds_read_b128 v[188:191], v3 offset:14336
v_mfma_f32_16x16x32_bf16 v[100:103], a[52:55], v[144:147], v[100:103]
s_waitcnt lgkmcnt(4)
v_mfma_f32_16x16x32_bf16 v[100:103], a[84:87], v[160:163], v[100:103]
ds_read_b128 v[192:195], v3 offset:3072
v_mfma_f32_16x16x32_bf16 v[100:103], a[92:95], v[164:167], v[100:103]
v_mfma_f32_16x16x32_bf16 v[100:103], a[100:103], v[168:171], v[100:103]
ds_read_b128 v[196:199], v3 offset:7168
v_mfma_f32_16x16x32_bf16 v[100:103], a[108:111], v[172:175], v[100:103]
v_mfma_f32_16x16x32_bf16 v[96:99], a[104:107], v[172:175], v[96:99]
ds_read_b128 v[200:203], v3 offset:11264
v_mfma_f32_16x16x32_bf16 v[96:99], a[96:99], v[168:171], v[96:99]
v_mfma_f32_16x16x32_bf16 v[96:99], a[88:91], v[164:167], v[96:99]
ds_read_b128 v[204:207], v3 offset:15360
v_mfma_f32_16x16x32_bf16 v[96:99], a[80:83], v[160:163], v[96:99]
s_waitcnt lgkmcnt(4)
v_mfma_f32_16x16x32_bf16 v[96:99], a[112:115], v[176:179], v[96:99]
s_waitcnt vmcnt(5)
s_barrier
v_mfma_f32_16x16x32_bf16 v[96:99], a[120:123], v[180:183], v[96:99]
ds_read_b128 v[144:147], v18 offset:0
v_mfma_f32_16x16x32_bf16 v[96:99], a[160:163], v[184:187], v[96:99]
ds_read_b128 v[148:151], v18 offset:4096
v_mfma_f32_16x16x32_bf16 v[96:99], a[168:171], v[188:191], v[96:99]
s_waitcnt vmcnt(0)
v_readfirstlane_b32 s48, v6
v_mfma_f32_16x16x32_bf16 v[100:103], a[172:175], v[188:191], v[100:103]
s_add_u32 s47, s70, 4096
ds_read_b128 v[152:155], v18 offset:8192
v_mfma_f32_16x16x32_bf16 v[100:103], a[164:167], v[184:187], v[100:103]
v_mfma_f32_16x16x32_bf16 v[100:103], a[124:127], v[180:183], v[100:103]
ds_read_b128 v[156:159], v18 offset:12288
v_mfma_f32_16x16x32_bf16 v[100:103], a[116:119], v[176:179], v[100:103]
s_waitcnt lgkmcnt(4)
buffer_load_dwordx4 v[116:119], v18, s[12:15], s70 offen offset:0 sc1
v_mfma_f32_16x16x32_bf16 v[100:103], a[132:135], v[192:195], v[100:103]
ds_read_b128 v[160:163], v18 offset:1024
v_mfma_f32_16x16x32_bf16 v[100:103], a[140:143], v[196:199], v[100:103]
v_mfma_f32_16x16x32_bf16 v[100:103], a[148:151], v[200:203], v[100:103]
ds_read_b128 v[164:167], v18 offset:5120
v_mfma_f32_16x16x32_bf16 v[100:103], a[156:159], v[204:207], v[100:103]
buffer_load_dwordx4 v[124:127], v18, s[12:15], s70 offen offset:1024 sc1
v_mfma_f32_16x16x32_bf16 v[96:99], a[152:155], v[204:207], v[96:99]
ds_read_b128 v[168:171], v18 offset:9216
v_mfma_f32_16x16x32_bf16 v[96:99], a[144:147], v[200:203], v[96:99]
v_mfma_f32_16x16x32_bf16 v[96:99], a[136:139], v[196:199], v[96:99]
ds_read_b128 v[172:175], v18 offset:13312
v_mfma_f32_16x16x32_bf16 v[96:99], a[128:131], v[192:195], v[96:99]
s_waitcnt lgkmcnt(4)
buffer_load_dwordx4 v[132:135], v18, s[12:15], s70 offen offset:2048 sc1
v_mfma_f32_16x16x32_bf16 v[104:107], a[176:179], v[144:147], v[104:107]
ds_read_b128 v[176:179], v18 offset:2048
v_mfma_f32_16x16x32_bf16 v[104:107], a[184:187], v[148:151], v[104:107]
v_mfma_f32_16x16x32_bf16 v[104:107], a[192:195], v[152:155], v[104:107]
ds_read_b128 v[180:183], v18 offset:6144
v_mfma_f32_16x16x32_bf16 v[104:107], a[200:203], v[156:159], v[104:107]
buffer_load_dwordx4 v[140:143], v18, s[12:15], s70 offen offset:3072 sc1
v_mfma_f32_16x16x32_bf16 v[108:111], a[204:207], v[156:159], v[108:111]
ds_read_b128 v[184:187], v18 offset:10240
v_mfma_f32_16x16x32_bf16 v[108:111], a[196:199], v[152:155], v[108:111]
v_mfma_f32_16x16x32_bf16 v[108:111], a[188:191], v[148:151], v[108:111]
ds_read_b128 v[188:191], v18 offset:14336
v_mfma_f32_16x16x32_bf16 v[108:111], a[180:183], v[144:147], v[108:111]
s_waitcnt lgkmcnt(4)
v_mfma_f32_16x16x32_bf16 v[108:111], a[212:215], v[160:163], v[108:111]
ds_read_b128 v[192:195], v18 offset:3072
v_mfma_f32_16x16x32_bf16 v[108:111], a[220:223], v[164:167], v[108:111]
v_mfma_f32_16x16x32_bf16 v[108:111], a[228:231], v[168:171], v[108:111]
ds_read_b128 v[196:199], v18 offset:7168
v_mfma_f32_16x16x32_bf16 v[108:111], a[236:239], v[172:175], v[108:111]
v_mfma_f32_16x16x32_bf16 v[104:107], a[232:235], v[172:175], v[104:107]
ds_read_b128 v[200:203], v18 offset:11264
v_mfma_f32_16x16x32_bf16 v[104:107], a[224:227], v[168:171], v[104:107]
v_mfma_f32_16x16x32_bf16 v[104:107], a[216:219], v[164:167], v[104:107]
ds_read_b128 v[204:207], v18 offset:15360
v_mfma_f32_16x16x32_bf16 v[104:107], a[208:211], v[160:163], v[104:107]
s_waitcnt lgkmcnt(4)
v_mfma_f32_16x16x32_bf16 v[104:107], a[240:243], v[176:179], v[104:107]
s_waitcnt vmcnt(5)
s_barrier
v_mfma_f32_16x16x32_bf16 v[104:107], a[248:251], v[180:183], v[104:107]
ds_read_b128 v[144:147], v18 offset:16384
v_mfma_f32_16x16x32_bf16 v[104:107], a[0:3], v[184:187], v[104:107]
ds_read_b128 v[148:151], v18 offset:20480
v_mfma_f32_16x16x32_bf16 v[104:107], a[8:11], v[188:191], v[104:107]
s_cmp_lg_u32 s48, 0
s_cselect_b32 s10, s10, 0
v_mfma_f32_16x16x32_bf16 v[108:111], a[12:15], v[188:191], v[108:111]
ds_read_b128 v[152:155], v18 offset:24576
v_mfma_f32_16x16x32_bf16 v[108:111], a[4:7], v[184:187], v[108:111]
s_waitcnt vmcnt(3)
v_lshlrev_b32_e64 v208, 16, v116
v_mfma_f32_16x16x32_bf16 v[108:111], a[252:255], v[180:183], v[108:111]
ds_read_b128 v[156:159], v18 offset:28672
v_and_b32_e64 v209, s36, v116
v_mfma_f32_16x16x32_bf16 v[108:111], a[244:247], v[176:179], v[108:111]
s_waitcnt lgkmcnt(4)
v_lshlrev_b32 v210, 16, v117
v_and_b32_e64 v211, s36, v117
v_mfma_f32_16x16x32_bf16 v[108:111], a[20:23], v[192:195], v[108:111]
ds_read_b128 v[160:163], v18 offset:17408
v_lshlrev_b32_e64 v212, 16, v118
v_mfma_f32_16x16x32_bf16 v[108:111], a[28:31], v[196:199], v[108:111]
v_and_b32_e64 v213, s36, v118
v_mfma_f32_16x16x32_bf16 v[108:111], a[36:39], v[200:203], v[108:111]
ds_read_b128 v[164:167], v18 offset:21504
v_lshlrev_b32_e64 v214, 16, v119
v_mfma_f32_16x16x32_bf16 v[108:111], a[44:47], v[204:207], v[108:111]
v_and_b32_e64 v215, s36, v119
v_mfma_f32_16x16x32_bf16 v[104:107], a[40:43], v[204:207], v[104:107]
ds_read_b128 v[168:171], v18 offset:25600
v_add_f32_e64 v208, v80, v208
v_mfma_f32_16x16x32_bf16 v[104:107], a[32:35], v[200:203], v[104:107]
v_add_f32 v209, v81, v209
v_add_f32 v210, v82, v210
v_mfma_f32_16x16x32_bf16 v[104:107], a[24:27], v[196:199], v[104:107]
ds_read_b128 v[172:175], v18 offset:29696
v_add_f32_e64 v211, v83, v211
v_mfma_f32_16x16x32_bf16 v[104:107], a[16:19], v[192:195], v[104:107]
s_waitcnt lgkmcnt(4)
v_add_f32 v212, v84, v212
v_add_f32_e64 v213, v85, v213
v_mfma_f32_16x16x32_bf16 v[104:107], a[48:51], v[144:147], v[104:107]
ds_read_b128 v[176:179], v18 offset:18432
v_add_f32_e64 v214, v86, v214
v_mfma_f32_16x16x32_bf16 v[104:107], a[56:59], v[148:151], v[104:107]
v_add_f32_e64 v215, v87, v215
v_mfma_f32_16x16x32_bf16 v[104:107], a[64:67], v[152:155], v[104:107]
ds_read_b128 v[180:183], v18 offset:22528
v_cvt_pk_bf16_f32 v240, v208, v209
v_mfma_f32_16x16x32_bf16 v[104:107], a[72:75], v[156:159], v[104:107]
v_cvt_pk_bf16_f32 v241, v210, v211
v_cvt_pk_bf16_f32 v242, v212, v213
v_mfma_f32_16x16x32_bf16 v[108:111], a[76:79], v[156:159], v[108:111]
ds_read_b128 v[184:187], v18 offset:26624
v_cvt_pk_bf16_f32 v243, v214, v215
v_mfma_f32_16x16x32_bf16 v[108:111], a[68:71], v[152:155], v[108:111]
s_add_u32 s44, s68, 0
v_permlane16_swap_b32 v240, v242
v_mfma_f32_16x16x32_bf16 v[108:111], a[60:63], v[148:151], v[108:111]
ds_read_b128 v[188:191], v18 offset:30720
v_mfma_f32_16x16x32_bf16 v[108:111], a[52:55], v[144:147], v[108:111]
s_waitcnt lgkmcnt(4)
v_permlane16_swap_b32 v241, v243
v_mfma_f32_16x16x32_bf16 v[108:111], a[84:87], v[160:163], v[108:111]
ds_read_b128 v[192:195], v18 offset:19456
v_mfma_f32_16x16x32_bf16 v[108:111], a[92:95], v[164:167], v[108:111]
buffer_store_dwordx4 v[240:243], v5, s[8:11], s44 offen sc1
v_mfma_f32_16x16x32_bf16 v[108:111], a[100:103], v[168:171], v[108:111]
ds_read_b128 v[196:199], v18 offset:23552
v_mfma_f32_16x16x32_bf16 v[108:111], a[108:111], v[172:175], v[108:111]
s_waitcnt vmcnt(3)
v_lshlrev_b32 v216, 16, v124
v_mfma_f32_16x16x32_bf16 v[104:107], a[104:107], v[172:175], v[104:107]
ds_read_b128 v[200:203], v18 offset:27648
v_and_b32_e64 v217, s36, v124
v_mfma_f32_16x16x32_bf16 v[104:107], a[96:99], v[168:171], v[104:107]
v_lshlrev_b32 v218, 16, v125
v_and_b32 v219, s36, v125
v_mfma_f32_16x16x32_bf16 v[104:107], a[88:91], v[164:167], v[104:107]
ds_read_b128 v[204:207], v18 offset:31744
v_lshlrev_b32_e64 v220, 16, v126
v_mfma_f32_16x16x32_bf16 v[104:107], a[80:83], v[160:163], v[104:107]
s_waitcnt lgkmcnt(4)
v_and_b32 v221, s36, v126
v_mfma_f32_16x16x32_bf16 v[104:107], a[112:115], v[176:179], v[104:107]
v_lshlrev_b32 v222, 16, v127
v_and_b32 v223, s36, v127
v_mfma_f32_16x16x32_bf16 v[104:107], a[120:123], v[180:183], v[104:107]
v_add_f32 v216, v88, v216
v_add_f32 v217, v89, v217
v_mfma_f32_16x16x32_bf16 v[104:107], a[160:163], v[184:187], v[104:107]
v_add_f32 v218, v90, v218
v_add_f32 v219, v91, v219
v_mfma_f32_16x16x32_bf16 v[104:107], a[168:171], v[188:191], v[104:107]
v_add_f32 v220, v92, v220
v_add_f32 v221, v93, v221
v_mfma_f32_16x16x32_bf16 v[108:111], a[172:175], v[188:191], v[108:111]
v_add_f32 v222, v94, v222
v_add_f32 v223, v95, v223
v_mfma_f32_16x16x32_bf16 v[108:111], a[164:167], v[184:187], v[108:111]
v_cvt_pk_bf16_f32 v244, v216, v217
v_cvt_pk_bf16_f32 v245, v218, v219
v_mfma_f32_16x16x32_bf16 v[108:111], a[124:127], v[180:183], v[108:111]
v_cvt_pk_bf16_f32 v246, v220, v221
v_cvt_pk_bf16_f32 v247, v222, v223
v_mfma_f32_16x16x32_bf16 v[108:111], a[116:119], v[176:179], v[108:111]
s_waitcnt lgkmcnt(0)
s_add_u32 s44, s68, 32768
v_mfma_f32_16x16x32_bf16 v[108:111], a[132:135], v[192:195], v[108:111]
v_permlane16_swap_b32 v244, v246
v_mfma_f32_16x16x32_bf16 v[108:111], a[140:143], v[196:199], v[108:111]
v_permlane16_swap_b32 v245, v247
v_mfma_f32_16x16x32_bf16 v[108:111], a[148:151], v[200:203], v[108:111]
buffer_store_dwordx4 v[244:247], v5, s[8:11], s44 offen sc1
v_mfma_f32_16x16x32_bf16 v[108:111], a[156:159], v[204:207], v[108:111]
s_waitcnt vmcnt(3)
v_lshlrev_b32_e64 v224, 16, v132
v_mfma_f32_16x16x32_bf16 v[104:107], a[152:155], v[204:207], v[104:107]
v_and_b32_e64 v225, s36, v132
v_mfma_f32_16x16x32_bf16 v[104:107], a[144:147], v[200:203], v[104:107]
v_lshlrev_b32 v226, 16, v133
v_and_b32 v227, s36, v133
v_mfma_f32_16x16x32_bf16 v[104:107], a[136:139], v[196:199], v[104:107]
v_lshlrev_b32 v228, 16, v134
v_and_b32 v229, s36, v134
v_mfma_f32_16x16x32_bf16 v[104:107], a[128:131], v[192:195], v[104:107]
v_lshlrev_b32 v230, 16, v135
v_and_b32 v231, s36, v135
v_add_f32 v224, v96, v224
v_add_f32 v225, v97, v225
v_add_f32 v226, v98, v226
v_add_f32 v227, v99, v227
v_add_f32 v228, v100, v228
v_add_f32 v229, v101, v229
v_add_f32 v230, v102, v230
v_add_f32 v231, v103, v231
v_cvt_pk_bf16_f32 v248, v224, v225
v_cvt_pk_bf16_f32 v249, v226, v227
v_cvt_pk_bf16_f32 v250, v228, v229
v_cvt_pk_bf16_f32 v251, v230, v231
s_add_u32 s44, s68, 65536
v_permlane16_swap_b32 v248, v250
v_permlane16_swap_b32 v249, v251
buffer_store_dwordx4 v[248:251], v5, s[8:11], s44 offen sc1
s_waitcnt vmcnt(3)
v_lshlrev_b32 v232, 16, v140
v_and_b32 v233, s36, v140
v_lshlrev_b32 v234, 16, v141
v_and_b32 v235, s36, v141
v_lshlrev_b32 v236, 16, v142
v_and_b32 v237, s36, v142
v_lshlrev_b32 v238, 16, v143
v_and_b32_e64 v239, s36, v143
s_cmp_eq_u32 s48, 0
s_cbranch_scc1 L_p2_spin_1069
v_pk_add_f32 v[232:233], v[104:105], v[232:233]
v_pk_add_f32 v[234:235], v[106:107], v[234:235]
v_pk_add_f32 v[236:237], v[108:109], v[236:237]
v_pk_add_f32 v[238:239], v[110:111], v[238:239]
v_cvt_pk_bf16_f32 v252, v232, v233
v_cvt_pk_bf16_f32 v253, v234, v235
v_cvt_pk_bf16_f32 v254, v236, v237
v_cvt_pk_bf16_f32 v255, v238, v239
s_add_u32 s44, s68, 98304
v_permlane16_swap_b32 v252, v254
v_permlane16_swap_b32 v253, v255
buffer_store_dwordx4 v[252:255], v5, s[8:11], s44 offen sc1
L_p2_end_1070:
L_g1_done_1001:
s_endpgm
s_nop 7
L_p2_v_1052:
v_mfma_f32_16x16x32_bf16 v[80:83], a[48:51], v[144:147], v[80:83]
s_xor_b32 s47, s37, 0x4c0000
ds_read_b128 v[176:179], v2 offset:20480
v_mfma_f32_16x16x32_bf16 v[80:83], a[56:59], v[148:151], v[80:83]
buffer_load_dwordx4 a[240:243], v18, s[64:67], s47 offen offset:0 sc1
v_mfma_f32_16x16x32_bf16 v[84:87], a[60:63], v[148:151], v[84:87]
ds_read_b128 v[180:183], v2 offset:28672
v_mfma_f32_16x16x32_bf16 v[84:87], a[52:55], v[144:147], v[84:87]
v_mfma_f32_16x16x32_bf16 v[92:95], a[52:55], v[152:155], v[92:95]
ds_read_b128 v[184:187], v2 offset:21504
v_mfma_f32_16x16x32_bf16 v[92:95], a[60:63], v[156:159], v[92:95]
buffer_load_dwordx4 a[244:247], v18, s[64:67], s47 offen offset:1024 sc1
v_mfma_f32_16x16x32_bf16 v[88:91], a[56:59], v[156:159], v[88:91]
ds_read_b128 v[188:191], v2 offset:29696
v_mfma_f32_16x16x32_bf16 v[88:91], a[48:51], v[152:155], v[88:91]
s_waitcnt lgkmcnt(4)
v_mfma_f32_16x16x32_bf16 v[96:99], a[48:51], v[160:163], v[96:99]
s_xor_b32 s47, s37, 0x5c0000
ds_read_b128 v[192:195], v2 offset:22528
v_mfma_f32_16x16x32_bf16 v[96:99], a[56:59], v[164:167], v[96:99]
buffer_load_dwordx4 a[248:251], v18, s[64:67], s47 offen offset:0 sc1
v_mfma_f32_16x16x32_bf16 v[100:103], a[60:63], v[164:167], v[100:103]
ds_read_b128 v[196:199], v2 offset:30720
v_mfma_f32_16x16x32_bf16 v[100:103], a[52:55], v[160:163], v[100:103]
v_mfma_f32_16x16x32_bf16 v[108:111], a[52:55], v[168:171], v[108:111]
ds_read_b128 v[200:203], v2 offset:23552
v_mfma_f32_16x16x32_bf16 v[108:111], a[60:63], v[172:175], v[108:111]
buffer_load_dwordx4 a[252:255], v18, s[64:67], s47 offen offset:1024 sc1
v_mfma_f32_16x16x32_bf16 v[104:107], a[56:59], v[172:175], v[104:107]
ds_read_b128 v[204:207], v2 offset:31744
v_mfma_f32_16x16x32_bf16 v[104:107], a[48:51], v[168:171], v[104:107]
s_waitcnt lgkmcnt(4)
s_branch L_p2_k_1055
L_p2_v_1053:
v_mfma_f32_16x16x32_bf16 v[80:83], a[48:51], v[144:147], v[80:83]
s_xor_b32 s47, s37, 0x7c0000
ds_read_b128 v[176:179], v2 offset:20480
v_mfma_f32_16x16x32_bf16 v[80:83], a[56:59], v[148:151], v[80:83]
buffer_load_dwordx4 a[0:3], v18, s[64:67], s47 offen offset:0 sc1
v_mfma_f32_16x16x32_bf16 v[84:87], a[60:63], v[148:151], v[84:87]
ds_read_b128 v[180:183], v2 offset:28672
v_mfma_f32_16x16x32_bf16 v[84:87], a[52:55], v[144:147], v[84:87]
v_mfma_f32_16x16x32_bf16 v[92:95], a[52:55], v[152:155], v[92:95]
ds_read_b128 v[184:187], v2 offset:21504
v_mfma_f32_16x16x32_bf16 v[92:95], a[60:63], v[156:159], v[92:95]
buffer_load_dwordx4 a[4:7], v18, s[64:67], s47 offen offset:1024 sc1
v_mfma_f32_16x16x32_bf16 v[88:91], a[56:59], v[156:159], v[88:91]
ds_read_b128 v[188:191], v2 offset:29696
v_mfma_f32_16x16x32_bf16 v[88:91], a[48:51], v[152:155], v[88:91]
s_waitcnt lgkmcnt(4)
v_mfma_f32_16x16x32_bf16 v[96:99], a[48:51], v[160:163], v[96:99]
s_xor_b32 s47, s37, 0x8c0000
ds_read_b128 v[192:195], v2 offset:22528
v_mfma_f32_16x16x32_bf16 v[96:99], a[56:59], v[164:167], v[96:99]
buffer_load_dwordx4 a[8:11], v18, s[64:67], s47 offen offset:0 sc1
v_mfma_f32_16x16x32_bf16 v[100:103], a[60:63], v[164:167], v[100:103]
ds_read_b128 v[196:199], v2 offset:30720
v_mfma_f32_16x16x32_bf16 v[100:103], a[52:55], v[160:163], v[100:103]
v_mfma_f32_16x16x32_bf16 v[108:111], a[52:55], v[168:171], v[108:111]
ds_read_b128 v[200:203], v2 offset:23552
v_mfma_f32_16x16x32_bf16 v[108:111], a[60:63], v[172:175], v[108:111]
buffer_load_dwordx4 a[12:15], v18, s[64:67], s47 offen offset:1024 sc1
v_mfma_f32_16x16x32_bf16 v[104:107], a[56:59], v[172:175], v[104:107]
ds_read_b128 v[204:207], v2 offset:31744
v_mfma_f32_16x16x32_bf16 v[104:107], a[48:51], v[168:171], v[104:107]
s_waitcnt lgkmcnt(4)
s_branch L_p2_k_1055
L_p2_v_1054:
v_mfma_f32_16x16x32_bf16 v[80:83], a[48:51], v[144:147], v[80:83]
s_xor_b32 s47, s37, 0x4e0000
ds_read_b128 v[176:179], v2 offset:20480
v_mfma_f32_16x16x32_bf16 v[80:83], a[56:59], v[148:151], v[80:83]
buffer_load_dwordx4 a[16:19], v18, s[64:67], s47 offen offset:0 sc1
v_mfma_f32_16x16x32_bf16 v[84:87], a[60:63], v[148:151], v[84:87]
ds_read_b128 v[180:183], v2 offset:28672
v_mfma_f32_16x16x32_bf16 v[84:87], a[52:55], v[144:147], v[84:87]
v_mfma_f32_16x16x32_bf16 v[92:95], a[52:55], v[152:155], v[92:95]
ds_read_b128 v[184:187], v2 offset:21504
v_mfma_f32_16x16x32_bf16 v[92:95], a[60:63], v[156:159], v[92:95]
buffer_load_dwordx4 a[20:23], v18, s[64:67], s47 offen offset:1024 sc1
v_mfma_f32_16x16x32_bf16 v[88:91], a[56:59], v[156:159], v[88:91]
ds_read_b128 v[188:191], v2 offset:29696
v_mfma_f32_16x16x32_bf16 v[88:91], a[48:51], v[152:155], v[88:91]
s_waitcnt lgkmcnt(4)
v_mfma_f32_16x16x32_bf16 v[96:99], a[48:51], v[160:163], v[96:99]
s_xor_b32 s47, s37, 0x5e0000
ds_read_b128 v[192:195], v2 offset:22528
v_mfma_f32_16x16x32_bf16 v[96:99], a[56:59], v[164:167], v[96:99]
buffer_load_dwordx4 a[24:27], v18, s[64:67], s47 offen offset:0 sc1
v_mfma_f32_16x16x32_bf16 v[100:103], a[60:63], v[164:167], v[100:103]
ds_read_b128 v[196:199], v2 offset:30720
v_mfma_f32_16x16x32_bf16 v[100:103], a[52:55], v[160:163], v[100:103]
v_mfma_f32_16x16x32_bf16 v[108:111], a[52:55], v[168:171], v[108:111]
ds_read_b128 v[200:203], v2 offset:23552
v_mfma_f32_16x16x32_bf16 v[108:111], a[60:63], v[172:175], v[108:111]
buffer_load_dwordx4 a[28:31], v18, s[64:67], s47 offen offset:1024 sc1
v_mfma_f32_16x16x32_bf16 v[104:107], a[56:59], v[172:175], v[104:107]
ds_read_b128 v[204:207], v2 offset:31744
v_mfma_f32_16x16x32_bf16 v[104:107], a[48:51], v[168:171], v[104:107]
s_waitcnt lgkmcnt(4)
s_branch L_p2_k_1055
s_nop 7
L_p2_spin_1069:
s_sleep 2
buffer_load_dword v6, v8, s[16:19], s72 offen sc1
s_waitcnt vmcnt(0)
v_readfirstlane_b32 s48, v6
s_nop 1
s_cmp_lt_u32 s48, 2
s_cbranch_scc1 L_p2_spin_1069
buffer_load_dwordx4 v[116:119], v18, s[12:15], s70 offen offset:0 sc1
buffer_load_dwordx4 v[124:127], v18, s[12:15], s70 offen offset:1024 sc1
buffer_load_dwordx4 v[132:135], v18, s[12:15], s70 offen offset:2048 sc1
buffer_load_dwordx4 v[140:143], v18, s[12:15], s70 offen offset:3072 sc1
s_mov_b32 s10, 0x400000
s_waitcnt vmcnt(3)
v_lshlrev_b32 v208, 16, v116
v_and_b32 v209, s36, v116
v_lshlrev_b32 v210, 16, v117
v_and_b32 v211, s36, v117
v_lshlrev_b32 v212, 16, v118
v_and_b32 v213, s36, v118
v_lshlrev_b32 v214, 16, v119
v_and_b32_e64 v215, s36, v119
v_pk_add_f32 v[208:209], v[80:81], v[208:209]
v_pk_add_f32 v[210:211], v[82:83], v[210:211]
v_pk_add_f32 v[212:213], v[84:85], v[212:213]
v_pk_add_f32 v[214:215], v[86:87], v[214:215]
v_cvt_pk_bf16_f32 v240, v208, v209
v_cvt_pk_bf16_f32 v241, v210, v211
v_cvt_pk_bf16_f32 v242, v212, v213
v_cvt_pk_bf16_f32 v243, v214, v215
s_add_u32 s44, s68, 0
v_permlane16_swap_b32 v240, v242
v_permlane16_swap_b32 v241, v243
buffer_store_dwordx4 v[240:243], v5, s[8:11], s44 offen sc1
s_waitcnt vmcnt(3)
v_lshlrev_b32 v216, 16, v124
v_and_b32 v217, s36, v124
v_lshlrev_b32 v218, 16, v125
v_and_b32 v219, s36, v125
v_lshlrev_b32 v220, 16, v126
v_and_b32 v221, s36, v126
v_lshlrev_b32 v222, 16, v127
v_and_b32 v223, s36, v127
v_pk_add_f32 v[216:217], v[88:89], v[216:217]
v_pk_add_f32 v[218:219], v[90:91], v[218:219]
v_pk_add_f32 v[220:221], v[92:93], v[220:221]
v_pk_add_f32 v[222:223], v[94:95], v[222:223]
v_cvt_pk_bf16_f32 v244, v216, v217
v_cvt_pk_bf16_f32 v245, v218, v219
v_cvt_pk_bf16_f32 v246, v220, v221
v_cvt_pk_bf16_f32 v247, v222, v223
s_add_u32 s44, s68, 32768
v_permlane16_swap_b32 v244, v246
v_permlane16_swap_b32 v245, v247
buffer_store_dwordx4 v[244:247], v5, s[8:11], s44 offen sc1
s_waitcnt vmcnt(3)
v_lshlrev_b32 v224, 16, v132
v_and_b32 v225, s36, v132
v_lshlrev_b32 v226, 16, v133
v_and_b32 v227, s36, v133
v_lshlrev_b32 v228, 16, v134
v_and_b32 v229, s36, v134
v_lshlrev_b32 v230, 16, v135
v_and_b32_e64 v231, s36, v135
v_pk_add_f32 v[224:225], v[96:97], v[224:225]
v_pk_add_f32 v[226:227], v[98:99], v[226:227]
v_pk_add_f32 v[228:229], v[100:101], v[228:229]
v_pk_add_f32 v[230:231], v[102:103], v[230:231]
v_cvt_pk_bf16_f32 v248, v224, v225
v_cvt_pk_bf16_f32 v249, v226, v227
v_cvt_pk_bf16_f32 v250, v228, v229
v_cvt_pk_bf16_f32 v251, v230, v231
s_add_u32 s44, s68, 65536
v_permlane16_swap_b32 v248, v250
v_permlane16_swap_b32 v249, v251
buffer_store_dwordx4 v[248:251], v5, s[8:11], s44 offen sc1
s_waitcnt vmcnt(3)
v_lshlrev_b32 v232, 16, v140
v_and_b32 v233, s36, v140
v_lshlrev_b32 v234, 16, v141
v_and_b32 v235, s36, v141
v_lshlrev_b32 v236, 16, v142
v_and_b32 v237, s36, v142
v_lshlrev_b32 v238, 16, v143
v_and_b32_e64 v239, s36, v143
v_pk_add_f32 v[232:233], v[104:105], v[232:233]
v_pk_add_f32 v[234:235], v[106:107], v[234:235]
v_pk_add_f32 v[236:237], v[108:109], v[236:237]
v_pk_add_f32 v[238:239], v[110:111], v[238:239]
v_cvt_pk_bf16_f32 v252, v232, v233
v_cvt_pk_bf16_f32 v253, v234, v235
v_cvt_pk_bf16_f32 v254, v236, v237
v_cvt_pk_bf16_f32 v255, v238, v239
s_add_u32 s44, s68, 98304
v_permlane16_swap_b32 v252, v254
v_permlane16_swap_b32 v253, v255
buffer_store_dwordx4 v[252:255], v5, s[8:11], s44 offen sc1
s_branch L_p2_end_1070
s_nop 7
L_p2_sp_1056:
s_sleep 2
v_mov_b32 v78, 2
s_mov_b32 exec_lo, 0xf
s_mov_b32 exec_hi, 0x0
buffer_load_dword v78, v13, s[16:19], s73 offen sc1
s_mov_b64 exec, -1
s_waitcnt vmcnt(0)
v_cmp_gt_u32 vcc, 1, v78
s_nop 0
s_cmp_lg_u32 vcc_lo, 0
s_cbranch_scc1 L_p2_sp_1056
s_branch L_p2_sr_1057
L_p2_sp_1059:
s_sleep 2
v_mov_b32_e64 v79, 2
s_mov_b32 exec_lo, 0xf00
s_mov_b32 exec_hi, 0xf00
buffer_load_dword v79, v13, s[16:19], s73 offen sc1
s_mov_b64 exec, -1
s_waitcnt vmcnt(0)
v_cmp_gt_u32 vcc, 1, v79
s_nop 0
s_cmp_lg_u64 vcc, 0
s_cbranch_scc1 L_p2_sp_1059
s_branch L_p2_sr_1060
L_p2_sp_1061:
s_sleep 2
v_mov_b32_e64 v78, 2
s_mov_b32 exec_lo, 0xf0f0000
s_mov_b32 exec_hi, 0xf0f0000
buffer_load_dword v78, v13, s[16:19], s73 offen sc1
s_mov_b64 exec, -1
s_waitcnt vmcnt(0)
v_cmp_gt_u32 vcc, 1, v78
s_nop 0
s_cmp_lg_u64 vcc, 0
s_cbranch_scc1 L_p2_sp_1061
s_branch L_p2_sr_1062
L_p2_sp_1063:
s_sleep 2
v_mov_b32_e64 v79, 2
s_mov_b32 exec_lo, 0xf000
s_mov_b32 exec_hi, 0xf000
buffer_load_dword v79, v13, s[16:19], s73 offen sc1
s_mov_b64 exec, -1
s_waitcnt vmcnt(0)
v_cmp_gt_u32 vcc, 1, v79
s_nop 0
s_cmp_lg_u64 vcc, 0
s_cbranch_scc1 L_p2_sp_1063
s_branch L_p2_sr_1064
L_p2_sp_1065:
s_sleep 2
v_mov_b32_e64 v78, 2
s_mov_b32 exec_lo, 0xf0f0f0f
s_mov_b32 exec_hi, 0x0
buffer_load_dword v78, v13, s[16:19], s73 offen sc1
s_mov_b64 exec, -1
s_waitcnt vmcnt(0)
v_cmp_gt_u32 vcc, 2, v78
s_nop 0
s_cmp_lg_u32 vcc_lo, 0
s_cbranch_scc1 L_p2_sp_1065
s_branch L_p2_sr_1066
L_p2_sp_1067:
s_sleep 2
v_mov_b32 v79, 2
s_mov_b32 exec_lo, 0x0
s_mov_b32 exec_hi, 0xf0f0f0f
buffer_load_dword v79, v13, s[16:19], s73 offen sc1
s_mov_b64 exec, -1
s_waitcnt vmcnt(0)
v_cmp_gt_u32 vcc, 2, v79
s_nop 0
s_cmp_lg_u32 vcc_hi, 0
s_cbranch_scc1 L_p2_sp_1067
s_branch L_p2_sr_1068
L_p2_slow_1048:
v_mov_b32_e64 v76, 2
s_waitcnt vmcnt(0)
s_mov_b64 exec, 1
buffer_store_dword v76, off, s[16:19], s74 sc1
s_mov_b64 exec, -1
L_p2_slow2_1071:
v_xor_b32 v76, s35, v18
v_and_b32 v78, 0x3c0, v76
v_add_u32 v76, v76, v78
v_mov_b32 v78, 2
s_mov_b32 exec_lo, 0xf
s_mov_b32 exec_hi, 0xf
buffer_load_dword v78, v76, s[16:19], s73 offen sc1
s_mov_b64 exec, -1
s_waitcnt vmcnt(0)
v_cmp_gt_u32 vcc, 1, v78
s_nop 0
s_cmp_lg_u32 vcc_hi, 0
s_cbranch_scc1 L_p2_slow2_1071
s_add_u32 m0, s39, 0
s_nop 0
s_xor_b32 s46, s32, 0xc00000
buffer_load_dwordx4 v18, s[20:23], s46 offen offset:0 sc1 lds
buffer_load_dwordx4 v18, s[20:23], s46 offen offset:1024 sc1 lds
buffer_load_dwordx4 v18, s[20:23], s46 offen offset:2048 sc1 lds
buffer_load_dwordx4 v18, s[20:23], s46 offen offset:3072 sc1 lds
s_add_u32 m0, s39, 16384
s_xor_b32 s46, s32, 0xe00000
buffer_load_dwordx4 v18, s[20:23], s46 offen offset:0 sc1 lds
buffer_load_dwordx4 v18, s[20:23], s46 offen offset:1024 sc1 lds
buffer_load_dwordx4 v18, s[20:23], s46 offen offset:2048 sc1 lds
buffer_load_dwordx4 v18, s[20:23], s46 offen offset:3072 sc1 lds
s_branch L_p2_back_1049
L_pf_tab:
.long 0x200000, 0x280000, 0x300000, 0x380000, 0x400000, 0x500000, 0x700000, 0x800000
.long 0x220000, 0x2a0000, 0x320000, 0x3a0000, 0x420000, 0x520000, 0x720000, 0x820000
.long 0x440000, 0x540000, 0x740000, 0x840000, 0x240000, 0x2c0000, 0x340000, 0x3c0000
.long 0x600000, 0x680000, 0x620000, 0x6a0000, 0x640000, 0x6c0000, 0x660000, 0x6e0000
.long 0x200000, 0x280000, 0x300000, 0x380000, 0x400000, 0x500000, 0x700000, 0x800000
.long 0x220000, 0x2a0000, 0x320000, 0x3a0000, 0x420000, 0x520000, 0x720000, 0x820000
.long 0x440000, 0x540000, 0x740000, 0x840000, 0x240000, 0x2c0000, 0x340000, 0x3c0000
.long 0x600000, 0x680000, 0x620000, 0x6a0000, 0x640000, 0x6c0000, 0x660000, 0x6e0000
L_code_end:
.section .rodata,"a"
.p2align 6
.amdhsa_kernel g1_kernel
  .amdhsa_next_free_vgpr 512
  .amdhsa_next_free_sgpr 102
  .amdhsa_accum_offset 256
  .amdhsa_group_segment_fixed_size 0
  .amdhsa_kernarg_size 80
  .amdhsa_user_sgpr_count 2
  .amdhsa_user_sgpr_kernarg_segment_ptr 1
  .amdhsa_system_sgpr_workgroup_id_x 1
.end_amdhsa_kernel
```
